```python
import torch

def _softmax(x, axis=-1):
    return torch.softmax(x, dim=axis)

def _gelu(x):
    return torch.nn.functional.gelu(x, approximate='tanh')

def _silu(x):
    return torch.nn.functional.silu(x)

def _sigmoid(x):
    return torch.sigmoid(x)

def _layernorm(x, axis=-1, eps=1e-05):
    m = x.mean(dim=axis, keepdim=True)
    v = x.var(dim=axis, keepdim=True, unbiased=False)
    return (x - m) / torch.sqrt(v + eps)

def _scatter_add(tgt, idx, src, axis=0):
    return tgt.clone().index_add_(axis, idx, src)

def _segment_sum(src, seg, n):
    out = torch.zeros((n,) + src.shape[1:], dtype=src.dtype)
    return out.index_add_(0, seg, src)

def _pad(x, pw):
    flat = tuple((v for pair in reversed(pw) for v in pair))
    return torch.nn.functional.pad(x, flat)
kernel_name = 'parallel_sum__memory_aug_recurrent_mem_tr__glu_gated_geglu__prompt'

def setup_inputs():

    _w = lambda a: (lambda t: t.to(torch.bfloat16) if t.is_floating_point() else t)(torch.as_tensor(a))

    def _A_setup():
        B, S, Dm = (1, 2048, 1024)
        H, Dh = (32, 128)
        M, seg = (8, 32)
        seg = min(seg, S)
        S = S // seg * seg
        return {'x': _w((lambda *s: torch.randn(*s, dtype=torch.bfloat16) * 0.05)(B, S, Dm)), 'mem0': _w((lambda *s: torch.randn(*s, dtype=torch.bfloat16) * 0.2)(B, M, Dm)), 'Wq': _w((lambda *s: torch.randn(*s, dtype=torch.bfloat16) * 1.6)(Dm, H, Dh) * Dm ** (-0.5)), 'Wk': _w((lambda *s: torch.randn(*s, dtype=torch.bfloat16) * 1.6)(Dm, H, Dh) * Dm ** (-0.5)), 'Wv': _w((lambda *s: torch.randn(*s, dtype=torch.bfloat16) * 0.2)(Dm, H, Dh) * Dm ** (-0.5)), 'Wo': _w((lambda *s: torch.randn(*s, dtype=torch.bfloat16) * 0.2)(H, Dh, Dm) * (H * Dh) ** (-0.5)), 'seg_len': seg}
    _A_in = _A_setup()

    def _B_setup():
        B, S, Dm, Df = (1, 2048, 1024, 3584)
        return {'x': _w((lambda *s: torch.randn(*s, dtype=torch.bfloat16) * 0.05)(B, S, Dm)), 'w_gate': _w((lambda *s: torch.randn(*s, dtype=torch.bfloat16) * 0.4)(Dm, Df) * Dm ** (-0.5)), 'w_up': _w((lambda *s: torch.randn(*s, dtype=torch.bfloat16) * 0.4)(Dm, Df) * Dm ** (-0.5)), 'w_down': _w((lambda *s: torch.randn(*s, dtype=torch.bfloat16) * 0.4)(Df, Dm) * Df ** (-0.5))}
    _B_in = _B_setup()
    return {'A_x': _A_in['x'], 'A_mem0': _A_in['mem0'], 'A_Wq': _A_in['Wq'], 'A_Wk': _A_in['Wk'], 'A_Wv': _A_in['Wv'], 'A_Wo': _A_in['Wo'], 'A_seg_len': _A_in['seg_len'], 'B_x': _B_in['x'], 'B_w_gate': _B_in['w_gate'], 'B_w_up': _B_in['w_up'], 'B_w_down': _B_in['w_down']}

def reference(A_x, A_mem0, A_Wq, A_Wk, A_Wv, A_Wo, A_seg_len, B_x, B_w_gate, B_w_up, B_w_down):

    def _A_ref(x, mem0, Wq, Wk, Wv, Wo, seg_len):
        B, S, Dm = x.shape
        H, Dh = (Wq.shape[1], Wq.shape[2])
        M = mem0.shape[1]
        scale = Dh ** (-0.5)
        n_seg = S // seg_len
        L = M + seg_len
        idx = torch.arange(L)
        mask = (idx[:, None] < M) | (idx[:, None] >= idx[None, :])
        mem = mem0
        outs = []
        for s in range(n_seg):
            xs = x[:, s * seg_len:(s + 1) * seg_len, :].clone()
            h = torch.concatenate([mem, xs], axis=1)
            q = torch.einsum('btd,dhe->bhte', h, Wq)
            k = torch.einsum('btd,dhe->bhte', h, Wk)
            v = torch.einsum('btd,dhe->bhte', h, Wv)
            scores = torch.einsum('bhqe,bhke->bhqk', q, k) * scale
            scores = torch.where(mask[None, None], scores, -1000000000.0)
            p = _softmax(scores, axis=-1)
            o = torch.einsum('bhqk,bhke->bhqe', p, v)
            o = torch.einsum('bhte,hed->btd', o, Wo)
            mem = o[:, :M, :].clone()
            outs.append(o[:, M:, :])
        return torch.concatenate(outs, axis=1)

    def _B_ref(x, w_gate, w_up, w_down):
        g = torch.einsum('bsd,df->bsf', x, w_gate)
        u = torch.einsum('bsd,df->bsf', x, w_up)
        h = _gelu(g) * u
        return torch.einsum('bsf,fd->bsd', h, w_down)
    x = A_x
    xn = _layernorm(x, axis=-1)
    return x + _A_ref(xn, A_mem0, A_Wq, A_Wk, A_Wv, A_Wo, A_seg_len) + _B_ref(xn, B_w_gate, B_w_up, B_w_down)
```

```asm
; @launch grid=(256,1,1) block=(256,1,1) lds=163840
.amdgcn_target "amdgcn-amd-amdhsa--gfx950"
.text
.globl parallel_sum__memory_aug_recurrent_mem_tr__glu_gated_geglu__prompt_kernel
.p2align 8
.type parallel_sum__memory_aug_recurrent_mem_tr__glu_gated_geglu__prompt_kernel,@function
parallel_sum__memory_aug_recurrent_mem_tr__glu_gated_geglu__prompt_kernel:
    s_cmp_lt_u32 s2, 256
    s_cbranch_scc1 L_start
    s_endpgm
L_start:
    s_load_dwordx8 s[40:47], s[0:1], 0
    s_load_dwordx4 s[48:51], s[0:1], 32
    s_load_dwordx8 s[56:63], s[0:1], 64
    s_load_dwordx4 s[64:67], s[0:1], 96
    v_lshrrev_b32 v2, 6, v0
    v_and_b32 v1, 63, v0
    v_readfirstlane_b32 s3, v2
    s_waitcnt lgkmcnt(0)
    s_mov_b32 s8, s66
    s_and_b32 s9, s67, 0xffff
    s_mov_b32 s10, 268435456
    s_mov_b32 s11, 0x20000
    s_getreg_b32 s31, hwreg(HW_REG_XCC_ID)
    s_and_b32 s31, s31, 7
    s_cmp_eq_u32 s3, 0
    s_cbranch_scc1 R_6
    s_and_b32 s16, s2, 7
    s_lshr_b32 s17, s2, 3
    s_lshl_b32 s17, s17, 2
    s_add_u32 s17, s17, s16
    s_sub_u32 s17, s17, 4
    s_sub_u32 s18, s2, 96
    s_cmp_ge_u32 s2, 192
    s_cselect_b32 s19, s18, s17
    s_cbranch_scc1 L_su_go
    s_cmp_lt_u32 s16, 4
    s_cbranch_scc1 L_su_pre
L_su_go:
    s_mov_b32 s24, s40
    s_and_b32 s25, s41, 0xffff
    s_mov_b32 s26, 4194304
    s_mov_b32 s27, 0x20000
    s_mov_b32 s12, s66
    s_and_b32 s13, s67, 0xffff
    s_mov_b32 s14, 4456448
    s_mov_b32 s15, 0x20000
    v_lshlrev_b32 v2, 4, v1
    s_mul_i32 s19, s19, 3
    s_add_u32 s19, s19, s3
    s_sub_u32 s19, s19, 1
    s_mul_i32 s34, s19, 3
    s_add_u32 s36, s34, 1
    s_add_u32 s38, s34, 2
    s_lshl_b32 s17, s34, 11
    buffer_load_dwordx4 v[64:67], v2, s[24:27], s17 offen offset:0
    buffer_load_dwordx4 v[68:71], v2, s[24:27], s17 offen offset:1024
    s_lshl_b32 s17, s36, 11
    buffer_load_dwordx4 v[72:75], v2, s[24:27], s17 offen offset:0
    buffer_load_dwordx4 v[76:79], v2, s[24:27], s17 offen offset:1024
    s_lshl_b32 s17, s38, 11
    buffer_load_dwordx4 v[80:83], v2, s[24:27], s17 offen offset:0
    buffer_load_dwordx4 v[84:87], v2, s[24:27], s17 offen offset:1024
    s_sub_u32 s18, s19, 277
    s_mul_i32 s18, s18, 3
    s_add_u32 s18, s18, 1440
    s_cmp_ge_u32 s19, 277
    s_cselect_b32 s18, s18, 4096
    s_add_u32 s17, s18, 0
    s_lshl_b32 s17, s17, 11
    buffer_load_dwordx4 v[16:19], v2, s[24:27], s17 offen offset:0
    buffer_load_dwordx4 v[20:23], v2, s[24:27], s17 offen offset:1024
    s_add_u32 s17, s18, 1
    s_lshl_b32 s17, s17, 11
    buffer_load_dwordx4 v[24:27], v2, s[24:27], s17 offen offset:0
    buffer_load_dwordx4 v[28:31], v2, s[24:27], s17 offen offset:1024
    s_add_u32 s17, s18, 2
    s_lshl_b32 s17, s17, 11
    buffer_load_dwordx4 v[32:35], v2, s[24:27], s17 offen offset:0
    buffer_load_dwordx4 v[36:39], v2, s[24:27], s17 offen offset:1024
    s_mov_b32 s28, s42
    s_and_b32 s29, s43, 0xffff
    s_mov_b32 s30, 16384
    s_mov_b32 s31, 0x20000
    s_bfe_u32 s17, s19, 0x40002
    s_lshl_b32 s17, s17, 7
    s_and_b32 s16, s19, 3
    s_lshl_b32 s16, s16, 5
    s_add_u32 s17, s17, s16
    v_bfe_u32 v8, v1, 2, 3
    v_lshlrev_b32 v8, 11, v8
    v_and_b32 v9, 3, v1
    v_lshl_add_u32 v8, v9, 3, v8
    v_lshrrev_b32 v9, 5, v1
    v_lshl_add_u32 v8, v9, 2, v8
    buffer_load_dword v10, v8, s[28:31], s17 offen
    v_mov_b32 v96, v2
    v_mov_b32 v148, v2
    v_mov_b32 v200, v2
    s_waitcnt vmcnt(7)
    v_lshlrev_b32 v108, 16, v64
    v_lshlrev_b32 v160, 16, v72
    v_lshlrev_b32 v212, 16, v80
    v_and_b32 v109, 0xffff0000, v64
    v_and_b32 v161, 0xffff0000, v72
    v_and_b32 v213, 0xffff0000, v80
    v_lshlrev_b32 v110, 16, v65
    v_lshlrev_b32 v162, 16, v73
    v_lshlrev_b32 v214, 16, v81
    v_and_b32 v111, 0xffff0000, v65
    v_and_b32 v163, 0xffff0000, v73
    v_and_b32 v215, 0xffff0000, v81
    v_lshlrev_b32 v112, 16, v66
    v_lshlrev_b32 v164, 16, v74
    v_lshlrev_b32 v216, 16, v82
    v_and_b32 v113, 0xffff0000, v66
    v_and_b32 v165, 0xffff0000, v74
    v_and_b32 v217, 0xffff0000, v82
    v_lshlrev_b32 v114, 16, v67
    v_lshlrev_b32 v166, 16, v75
    v_lshlrev_b32 v218, 16, v83
    v_and_b32 v115, 0xffff0000, v67
    v_and_b32 v167, 0xffff0000, v75
    v_and_b32 v219, 0xffff0000, v83
    v_lshlrev_b32 v116, 16, v68
    v_lshlrev_b32 v168, 16, v76
    v_lshlrev_b32 v220, 16, v84
    v_and_b32 v117, 0xffff0000, v68
    v_and_b32 v169, 0xffff0000, v76
    v_and_b32 v221, 0xffff0000, v84
    v_lshlrev_b32 v118, 16, v69
    v_lshlrev_b32 v170, 16, v77
    v_lshlrev_b32 v222, 16, v85
    v_and_b32 v119, 0xffff0000, v69
    v_and_b32 v171, 0xffff0000, v77
    v_and_b32 v223, 0xffff0000, v85
    v_lshlrev_b32 v120, 16, v70
    v_lshlrev_b32 v172, 16, v78
    v_lshlrev_b32 v224, 16, v86
    v_and_b32 v121, 0xffff0000, v70
    v_and_b32 v173, 0xffff0000, v78
    v_and_b32 v225, 0xffff0000, v86
    v_lshlrev_b32 v122, 16, v71
    v_lshlrev_b32 v174, 16, v79
    v_lshlrev_b32 v226, 16, v87
    v_and_b32 v123, 0xffff0000, v71
    v_and_b32 v175, 0xffff0000, v79
    v_and_b32 v227, 0xffff0000, v87
    v_add_f32 v126, v108, v109
    v_add_f32 v178, v160, v161
    v_add_f32 v230, v212, v213
    v_add_f32 v126, v126, v110
    v_add_f32 v178, v178, v162
    v_add_f32 v230, v230, v214
    v_add_f32 v126, v126, v111
    v_add_f32 v178, v178, v163
    v_add_f32 v230, v230, v215
    v_add_f32 v126, v126, v112
    v_add_f32 v178, v178, v164
    v_add_f32 v230, v230, v216
    v_add_f32 v126, v126, v113
    v_add_f32 v178, v178, v165
    v_add_f32 v230, v230, v217
    v_add_f32 v126, v126, v114
    v_add_f32 v178, v178, v166
    v_add_f32 v230, v230, v218
    v_add_f32 v126, v126, v115
    v_add_f32 v178, v178, v167
    v_add_f32 v230, v230, v219
    v_add_f32 v126, v126, v116
    v_add_f32 v178, v178, v168
    v_add_f32 v230, v230, v220
    v_add_f32 v126, v126, v117
    v_add_f32 v178, v178, v169
    v_add_f32 v230, v230, v221
    v_add_f32 v126, v126, v118
    v_add_f32 v178, v178, v170
    v_add_f32 v230, v230, v222
    v_add_f32 v126, v126, v119
    v_add_f32 v178, v178, v171
    v_add_f32 v230, v230, v223
    v_add_f32 v126, v126, v120
    v_add_f32 v178, v178, v172
    v_add_f32 v230, v230, v224
    v_add_f32 v126, v126, v121
    v_add_f32 v178, v178, v173
    v_add_f32 v230, v230, v225
    v_add_f32 v126, v126, v122
    v_add_f32 v178, v178, v174
    v_add_f32 v230, v230, v226
    v_add_f32 v126, v126, v123
    v_add_f32 v178, v178, v175
    v_add_f32 v230, v230, v227
    v_add_f32_dpp v126, v126, v126 row_ror:1 row_mask:0xf bank_mask:0xf
    v_add_f32_dpp v178, v178, v178 row_ror:1 row_mask:0xf bank_mask:0xf
    v_add_f32_dpp v230, v230, v230 row_ror:1 row_mask:0xf bank_mask:0xf
    v_add_f32_dpp v126, v126, v126 row_ror:2 row_mask:0xf bank_mask:0xf
    v_add_f32_dpp v178, v178, v178 row_ror:2 row_mask:0xf bank_mask:0xf
    v_add_f32_dpp v230, v230, v230 row_ror:2 row_mask:0xf bank_mask:0xf
    v_add_f32_dpp v126, v126, v126 row_ror:4 row_mask:0xf bank_mask:0xf
    v_add_f32_dpp v178, v178, v178 row_ror:4 row_mask:0xf bank_mask:0xf
    v_add_f32_dpp v230, v230, v230 row_ror:4 row_mask:0xf bank_mask:0xf
    v_add_f32_dpp v126, v126, v126 row_ror:8 row_mask:0xf bank_mask:0xf
    v_add_f32_dpp v178, v178, v178 row_ror:8 row_mask:0xf bank_mask:0xf
    v_add_f32_dpp v230, v230, v230 row_ror:8 row_mask:0xf bank_mask:0xf
    v_mov_b32 v127, v126
    v_mov_b32 v179, v178
    v_mov_b32 v231, v230
    v_permlane16_swap_b32 v126, v127
    v_permlane16_swap_b32 v178, v179
    v_permlane16_swap_b32 v230, v231
    v_add_f32 v126, v126, v127
    v_add_f32 v178, v178, v179
    v_add_f32 v230, v230, v231
    v_mov_b32 v127, v126
    v_mov_b32 v179, v178
    v_mov_b32 v231, v230
    v_permlane32_swap_b32 v126, v127
    v_permlane32_swap_b32 v178, v179
    v_permlane32_swap_b32 v230, v231
    v_add_f32 v126, v126, v127
    v_add_f32 v178, v178, v179
    v_add_f32 v230, v230, v231
    v_mul_f32 v126, 0x3a800000, v126
    v_mul_f32 v178, 0x3a800000, v178
    v_mul_f32 v230, 0x3a800000, v230
    v_sub_f32 v128, v108, v126
    v_sub_f32 v180, v160, v178
    v_sub_f32 v232, v212, v230
    v_mul_f32 v129, v128, v128
    v_mul_f32 v181, v180, v180
    v_mul_f32 v233, v232, v232
    v_sub_f32 v128, v109, v126
    v_sub_f32 v180, v161, v178
    v_sub_f32 v232, v213, v230
    v_fmac_f32 v129, v128, v128
    v_fmac_f32 v181, v180, v180
    v_fmac_f32 v233, v232, v232
    v_sub_f32 v128, v110, v126
    v_sub_f32 v180, v162, v178
    v_sub_f32 v232, v214, v230
    v_fmac_f32 v129, v128, v128
    v_fmac_f32 v181, v180, v180
    v_fmac_f32 v233, v232, v232
    v_sub_f32 v128, v111, v126
    v_sub_f32 v180, v163, v178
    v_sub_f32 v232, v215, v230
    v_fmac_f32 v129, v128, v128
    v_fmac_f32 v181, v180, v180
    v_fmac_f32 v233, v232, v232
    v_sub_f32 v128, v112, v126
    v_sub_f32 v180, v164, v178
    v_sub_f32 v232, v216, v230
    v_fmac_f32 v129, v128, v128
    v_fmac_f32 v181, v180, v180
    v_fmac_f32 v233, v232, v232
    v_sub_f32 v128, v113, v126
    v_sub_f32 v180, v165, v178
    v_sub_f32 v232, v217, v230
    v_fmac_f32 v129, v128, v128
    v_fmac_f32 v181, v180, v180
    v_fmac_f32 v233, v232, v232
    v_sub_f32 v128, v114, v126
    v_sub_f32 v180, v166, v178
    v_sub_f32 v232, v218, v230
    v_fmac_f32 v129, v128, v128
    v_fmac_f32 v181, v180, v180
    v_fmac_f32 v233, v232, v232
    v_sub_f32 v128, v115, v126
    v_sub_f32 v180, v167, v178
    v_sub_f32 v232, v219, v230
    v_fmac_f32 v129, v128, v128
    v_fmac_f32 v181, v180, v180
    v_fmac_f32 v233, v232, v232
    v_sub_f32 v128, v116, v126
    v_sub_f32 v180, v168, v178
    v_sub_f32 v232, v220, v230
    v_fmac_f32 v129, v128, v128
    v_fmac_f32 v181, v180, v180
    v_fmac_f32 v233, v232, v232
    v_sub_f32 v128, v117, v126
    v_sub_f32 v180, v169, v178
    v_sub_f32 v232, v221, v230
    v_fmac_f32 v129, v128, v128
    v_fmac_f32 v181, v180, v180
    v_fmac_f32 v233, v232, v232
    v_sub_f32 v128, v118, v126
    v_sub_f32 v180, v170, v178
    v_sub_f32 v232, v222, v230
    v_fmac_f32 v129, v128, v128
    v_fmac_f32 v181, v180, v180
    v_fmac_f32 v233, v232, v232
    v_sub_f32 v128, v119, v126
    v_sub_f32 v180, v171, v178
    v_sub_f32 v232, v223, v230
    v_fmac_f32 v129, v128, v128
    v_fmac_f32 v181, v180, v180
    v_fmac_f32 v233, v232, v232
    v_sub_f32 v128, v120, v126
    v_sub_f32 v180, v172, v178
    v_sub_f32 v232, v224, v230
    v_fmac_f32 v129, v128, v128
    v_fmac_f32 v181, v180, v180
    v_fmac_f32 v233, v232, v232
    v_sub_f32 v128, v121, v126
    v_sub_f32 v180, v173, v178
    v_sub_f32 v232, v225, v230
    v_fmac_f32 v129, v128, v128
    v_fmac_f32 v181, v180, v180
    v_fmac_f32 v233, v232, v232
    v_sub_f32 v128, v122, v126
    v_sub_f32 v180, v174, v178
    v_sub_f32 v232, v226, v230
    v_fmac_f32 v129, v128, v128
    v_fmac_f32 v181, v180, v180
    v_fmac_f32 v233, v232, v232
    v_sub_f32 v128, v123, v126
    v_sub_f32 v180, v175, v178
    v_sub_f32 v232, v227, v230
    v_fmac_f32 v129, v128, v128
    v_fmac_f32 v181, v180, v180
    v_fmac_f32 v233, v232, v232
    v_add_f32_dpp v129, v129, v129 row_ror:1 row_mask:0xf bank_mask:0xf
    v_add_f32_dpp v181, v181, v181 row_ror:1 row_mask:0xf bank_mask:0xf
    v_add_f32_dpp v233, v233, v233 row_ror:1 row_mask:0xf bank_mask:0xf
    v_add_f32_dpp v129, v129, v129 row_ror:2 row_mask:0xf bank_mask:0xf
    v_add_f32_dpp v181, v181, v181 row_ror:2 row_mask:0xf bank_mask:0xf
    v_add_f32_dpp v233, v233, v233 row_ror:2 row_mask:0xf bank_mask:0xf
    v_add_f32_dpp v129, v129, v129 row_ror:4 row_mask:0xf bank_mask:0xf
    v_add_f32_dpp v181, v181, v181 row_ror:4 row_mask:0xf bank_mask:0xf
    v_add_f32_dpp v233, v233, v233 row_ror:4 row_mask:0xf bank_mask:0xf
    v_add_f32_dpp v129, v129, v129 row_ror:8 row_mask:0xf bank_mask:0xf
    v_add_f32_dpp v181, v181, v181 row_ror:8 row_mask:0xf bank_mask:0xf
    v_add_f32_dpp v233, v233, v233 row_ror:8 row_mask:0xf bank_mask:0xf
    v_mov_b32 v127, v129
    v_mov_b32 v179, v181
    v_mov_b32 v231, v233
    v_permlane16_swap_b32 v129, v127
    v_permlane16_swap_b32 v181, v179
    v_permlane16_swap_b32 v233, v231
    v_add_f32 v129, v129, v127
    v_add_f32 v181, v181, v179
    v_add_f32 v233, v233, v231
    v_mov_b32 v127, v129
    v_mov_b32 v179, v181
    v_mov_b32 v231, v233
    v_permlane32_swap_b32 v129, v127
    v_permlane32_swap_b32 v181, v179
    v_permlane32_swap_b32 v233, v231
    v_add_f32 v129, v129, v127
    v_add_f32 v181, v181, v179
    v_add_f32 v233, v233, v231
    v_mul_f32 v129, 0x3a800000, v129
    v_mul_f32 v181, 0x3a800000, v181
    v_mul_f32 v233, 0x3a800000, v233
    v_cvt_pk_bf16_f32 v126, v126, v126
    v_cvt_pk_bf16_f32 v178, v178, v178
    v_cvt_pk_bf16_f32 v230, v230, v230
    v_lshlrev_b32 v126, 16, v126
    v_lshlrev_b32 v178, 16, v178
    v_lshlrev_b32 v230, 16, v230
    v_cvt_pk_bf16_f32 v129, v129, v129
    v_cvt_pk_bf16_f32 v181, v181, v181
    v_cvt_pk_bf16_f32 v233, v233, v233
    v_lshlrev_b32 v129, 16, v129
    v_lshlrev_b32 v181, 16, v181
    v_lshlrev_b32 v233, 16, v233
    v_add_f32 v129, 0x3727c5ac, v129
    v_add_f32 v181, 0x3727c5ac, v181
    v_add_f32 v233, 0x3727c5ac, v233
    v_cvt_pk_bf16_f32 v129, v129, v129
    v_cvt_pk_bf16_f32 v181, v181, v181
    v_cvt_pk_bf16_f32 v233, v233, v233
    v_lshlrev_b32 v129, 16, v129
    v_lshlrev_b32 v181, 16, v181
    v_lshlrev_b32 v233, 16, v233
    v_sqrt_f32 v129, v129
    v_sqrt_f32 v181, v181
    v_sqrt_f32 v233, v233
    v_cvt_pk_bf16_f32 v129, v129, v129
    v_cvt_pk_bf16_f32 v181, v181, v181
    v_cvt_pk_bf16_f32 v233, v233, v233
    v_lshlrev_b32 v129, 16, v129
    v_lshlrev_b32 v181, 16, v181
    v_lshlrev_b32 v233, 16, v233
    v_rcp_f32 v130, v129
    v_rcp_f32 v182, v181
    v_rcp_f32 v234, v233
    v_sub_f32 v108, v108, v126
    v_sub_f32 v160, v160, v178
    v_sub_f32 v212, v212, v230
    v_sub_f32 v109, v109, v126
    v_sub_f32 v161, v161, v178
    v_sub_f32 v213, v213, v230
    v_cvt_pk_bf16_f32 v64, v108, v109
    v_cvt_pk_bf16_f32 v72, v160, v161
    v_cvt_pk_bf16_f32 v80, v212, v213
    v_lshlrev_b32 v108, 16, v64
    v_lshlrev_b32 v160, 16, v72
    v_lshlrev_b32 v212, 16, v80
    v_and_b32 v109, 0xffff0000, v64
    v_and_b32 v161, 0xffff0000, v72
    v_and_b32 v213, 0xffff0000, v80
    v_mul_f32 v131, v108, v130
    v_mul_f32 v183, v160, v182
    v_mul_f32 v235, v212, v234
    v_fma_f32 v108, -v131, v129, v108
    v_fma_f32 v160, -v183, v181, v160
    v_fma_f32 v212, -v235, v233, v212
    v_fma_f32 v131, v108, v130, v131
    v_fma_f32 v183, v160, v182, v183
    v_fma_f32 v235, v212, v234, v235
    v_mul_f32 v132, v109, v130
    v_mul_f32 v184, v161, v182
    v_mul_f32 v236, v213, v234
    v_fma_f32 v109, -v132, v129, v109
    v_fma_f32 v161, -v184, v181, v161
    v_fma_f32 v213, -v236, v233, v213
    v_fma_f32 v132, v109, v130, v132
    v_fma_f32 v184, v161, v182, v184
    v_fma_f32 v236, v213, v234, v236
    v_cvt_pk_bf16_f32 v64, v131, v132
    v_cvt_pk_bf16_f32 v72, v183, v184
    v_cvt_pk_bf16_f32 v80, v235, v236
    v_sub_f32 v110, v110, v126
    v_sub_f32 v162, v162, v178
    v_sub_f32 v214, v214, v230
    v_sub_f32 v111, v111, v126
    v_sub_f32 v163, v163, v178
    v_sub_f32 v215, v215, v230
    v_cvt_pk_bf16_f32 v65, v110, v111
    v_cvt_pk_bf16_f32 v73, v162, v163
    v_cvt_pk_bf16_f32 v81, v214, v215
    v_lshlrev_b32 v110, 16, v65
    v_lshlrev_b32 v162, 16, v73
    v_lshlrev_b32 v214, 16, v81
    v_and_b32 v111, 0xffff0000, v65
    v_and_b32 v163, 0xffff0000, v73
    v_and_b32 v215, 0xffff0000, v81
    v_mul_f32 v131, v110, v130
    v_mul_f32 v183, v162, v182
    v_mul_f32 v235, v214, v234
    v_fma_f32 v110, -v131, v129, v110
    v_fma_f32 v162, -v183, v181, v162
    v_fma_f32 v214, -v235, v233, v214
    v_fma_f32 v131, v110, v130, v131
    v_fma_f32 v183, v162, v182, v183
    v_fma_f32 v235, v214, v234, v235
    v_mul_f32 v132, v111, v130
    v_mul_f32 v184, v163, v182
    v_mul_f32 v236, v215, v234
    v_fma_f32 v111, -v132, v129, v111
    v_fma_f32 v163, -v184, v181, v163
    v_fma_f32 v215, -v236, v233, v215
    v_fma_f32 v132, v111, v130, v132
    v_fma_f32 v184, v163, v182, v184
    v_fma_f32 v236, v215, v234, v236
    v_cvt_pk_bf16_f32 v65, v131, v132
    v_cvt_pk_bf16_f32 v73, v183, v184
    v_cvt_pk_bf16_f32 v81, v235, v236
    v_sub_f32 v112, v112, v126
    v_sub_f32 v164, v164, v178
    v_sub_f32 v216, v216, v230
    v_sub_f32 v113, v113, v126
    v_sub_f32 v165, v165, v178
    v_sub_f32 v217, v217, v230
    v_cvt_pk_bf16_f32 v66, v112, v113
    v_cvt_pk_bf16_f32 v74, v164, v165
    v_cvt_pk_bf16_f32 v82, v216, v217
    v_lshlrev_b32 v112, 16, v66
    v_lshlrev_b32 v164, 16, v74
    v_lshlrev_b32 v216, 16, v82
    v_and_b32 v113, 0xffff0000, v66
    v_and_b32 v165, 0xffff0000, v74
    v_and_b32 v217, 0xffff0000, v82
    v_mul_f32 v131, v112, v130
    v_mul_f32 v183, v164, v182
    v_mul_f32 v235, v216, v234
    v_fma_f32 v112, -v131, v129, v112
    v_fma_f32 v164, -v183, v181, v164
    v_fma_f32 v216, -v235, v233, v216
    v_fma_f32 v131, v112, v130, v131
    v_fma_f32 v183, v164, v182, v183
    v_fma_f32 v235, v216, v234, v235
    v_mul_f32 v132, v113, v130
    v_mul_f32 v184, v165, v182
    v_mul_f32 v236, v217, v234
    v_fma_f32 v113, -v132, v129, v113
    v_fma_f32 v165, -v184, v181, v165
    v_fma_f32 v217, -v236, v233, v217
    v_fma_f32 v132, v113, v130, v132
    v_fma_f32 v184, v165, v182, v184
    v_fma_f32 v236, v217, v234, v236
    v_cvt_pk_bf16_f32 v66, v131, v132
    v_cvt_pk_bf16_f32 v74, v183, v184
    v_cvt_pk_bf16_f32 v82, v235, v236
    v_sub_f32 v114, v114, v126
    v_sub_f32 v166, v166, v178
    v_sub_f32 v218, v218, v230
    v_sub_f32 v115, v115, v126
    v_sub_f32 v167, v167, v178
    v_sub_f32 v219, v219, v230
    v_cvt_pk_bf16_f32 v67, v114, v115
    v_cvt_pk_bf16_f32 v75, v166, v167
    v_cvt_pk_bf16_f32 v83, v218, v219
    v_lshlrev_b32 v114, 16, v67
    v_lshlrev_b32 v166, 16, v75
    v_lshlrev_b32 v218, 16, v83
    v_and_b32 v115, 0xffff0000, v67
    v_and_b32 v167, 0xffff0000, v75
    v_and_b32 v219, 0xffff0000, v83
    v_mul_f32 v131, v114, v130
    v_mul_f32 v183, v166, v182
    v_mul_f32 v235, v218, v234
    v_fma_f32 v114, -v131, v129, v114
    v_fma_f32 v166, -v183, v181, v166
    v_fma_f32 v218, -v235, v233, v218
    v_fma_f32 v131, v114, v130, v131
    v_fma_f32 v183, v166, v182, v183
    v_fma_f32 v235, v218, v234, v235
    v_mul_f32 v132, v115, v130
    v_mul_f32 v184, v167, v182
    v_mul_f32 v236, v219, v234
    v_fma_f32 v115, -v132, v129, v115
    v_fma_f32 v167, -v184, v181, v167
    v_fma_f32 v219, -v236, v233, v219
    v_fma_f32 v132, v115, v130, v132
    v_fma_f32 v184, v167, v182, v184
    v_fma_f32 v236, v219, v234, v236
    v_cvt_pk_bf16_f32 v67, v131, v132
    v_cvt_pk_bf16_f32 v75, v183, v184
    v_cvt_pk_bf16_f32 v83, v235, v236
    v_sub_f32 v116, v116, v126
    v_sub_f32 v168, v168, v178
    v_sub_f32 v220, v220, v230
    v_sub_f32 v117, v117, v126
    v_sub_f32 v169, v169, v178
    v_sub_f32 v221, v221, v230
    v_cvt_pk_bf16_f32 v68, v116, v117
    v_cvt_pk_bf16_f32 v76, v168, v169
    v_cvt_pk_bf16_f32 v84, v220, v221
    v_lshlrev_b32 v116, 16, v68
    v_lshlrev_b32 v168, 16, v76
    v_lshlrev_b32 v220, 16, v84
    v_and_b32 v117, 0xffff0000, v68
    v_and_b32 v169, 0xffff0000, v76
    v_and_b32 v221, 0xffff0000, v84
    v_mul_f32 v131, v116, v130
    v_mul_f32 v183, v168, v182
    v_mul_f32 v235, v220, v234
    v_fma_f32 v116, -v131, v129, v116
    v_fma_f32 v168, -v183, v181, v168
    v_fma_f32 v220, -v235, v233, v220
    v_fma_f32 v131, v116, v130, v131
    v_fma_f32 v183, v168, v182, v183
    v_fma_f32 v235, v220, v234, v235
    v_mul_f32 v132, v117, v130
    v_mul_f32 v184, v169, v182
    v_mul_f32 v236, v221, v234
    v_fma_f32 v117, -v132, v129, v117
    v_fma_f32 v169, -v184, v181, v169
    v_fma_f32 v221, -v236, v233, v221
    v_fma_f32 v132, v117, v130, v132
    v_fma_f32 v184, v169, v182, v184
    v_fma_f32 v236, v221, v234, v236
    v_cvt_pk_bf16_f32 v68, v131, v132
    v_cvt_pk_bf16_f32 v76, v183, v184
    v_cvt_pk_bf16_f32 v84, v235, v236
    v_sub_f32 v118, v118, v126
    v_sub_f32 v170, v170, v178
    v_sub_f32 v222, v222, v230
    v_sub_f32 v119, v119, v126
    v_sub_f32 v171, v171, v178
    v_sub_f32 v223, v223, v230
    v_cvt_pk_bf16_f32 v69, v118, v119
    v_cvt_pk_bf16_f32 v77, v170, v171
    v_cvt_pk_bf16_f32 v85, v222, v223
    v_lshlrev_b32 v118, 16, v69
    v_lshlrev_b32 v170, 16, v77
    v_lshlrev_b32 v222, 16, v85
    v_and_b32 v119, 0xffff0000, v69
    v_and_b32 v171, 0xffff0000, v77
    v_and_b32 v223, 0xffff0000, v85
    v_mul_f32 v131, v118, v130
    v_mul_f32 v183, v170, v182
    v_mul_f32 v235, v222, v234
    v_fma_f32 v118, -v131, v129, v118
    v_fma_f32 v170, -v183, v181, v170
    v_fma_f32 v222, -v235, v233, v222
    v_fma_f32 v131, v118, v130, v131
    v_fma_f32 v183, v170, v182, v183
    v_fma_f32 v235, v222, v234, v235
    v_mul_f32 v132, v119, v130
    v_mul_f32 v184, v171, v182
    v_mul_f32 v236, v223, v234
    v_fma_f32 v119, -v132, v129, v119
    v_fma_f32 v171, -v184, v181, v171
    v_fma_f32 v223, -v236, v233, v223
    v_fma_f32 v132, v119, v130, v132
    v_fma_f32 v184, v171, v182, v184
    v_fma_f32 v236, v223, v234, v236
    v_cvt_pk_bf16_f32 v69, v131, v132
    v_cvt_pk_bf16_f32 v77, v183, v184
    v_cvt_pk_bf16_f32 v85, v235, v236
    v_sub_f32 v120, v120, v126
    v_sub_f32 v172, v172, v178
    v_sub_f32 v224, v224, v230
    v_sub_f32 v121, v121, v126
    v_sub_f32 v173, v173, v178
    v_sub_f32 v225, v225, v230
    v_cvt_pk_bf16_f32 v70, v120, v121
    v_cvt_pk_bf16_f32 v78, v172, v173
    v_cvt_pk_bf16_f32 v86, v224, v225
    v_lshlrev_b32 v120, 16, v70
    v_lshlrev_b32 v172, 16, v78
    v_lshlrev_b32 v224, 16, v86
    v_and_b32 v121, 0xffff0000, v70
    v_and_b32 v173, 0xffff0000, v78
    v_and_b32 v225, 0xffff0000, v86
    v_mul_f32 v131, v120, v130
    v_mul_f32 v183, v172, v182
    v_mul_f32 v235, v224, v234
    v_fma_f32 v120, -v131, v129, v120
    v_fma_f32 v172, -v183, v181, v172
    v_fma_f32 v224, -v235, v233, v224
    v_fma_f32 v131, v120, v130, v131
    v_fma_f32 v183, v172, v182, v183
    v_fma_f32 v235, v224, v234, v235
    v_mul_f32 v132, v121, v130
    v_mul_f32 v184, v173, v182
    v_mul_f32 v236, v225, v234
    v_fma_f32 v121, -v132, v129, v121
    v_fma_f32 v173, -v184, v181, v173
    v_fma_f32 v225, -v236, v233, v225
    v_fma_f32 v132, v121, v130, v132
    v_fma_f32 v184, v173, v182, v184
    v_fma_f32 v236, v225, v234, v236
    v_cvt_pk_bf16_f32 v70, v131, v132
    v_cvt_pk_bf16_f32 v78, v183, v184
    v_cvt_pk_bf16_f32 v86, v235, v236
    v_sub_f32 v122, v122, v126
    v_sub_f32 v174, v174, v178
    v_sub_f32 v226, v226, v230
    v_sub_f32 v123, v123, v126
    v_sub_f32 v175, v175, v178
    v_sub_f32 v227, v227, v230
    v_cvt_pk_bf16_f32 v71, v122, v123
    v_cvt_pk_bf16_f32 v79, v174, v175
    v_cvt_pk_bf16_f32 v87, v226, v227
    v_lshlrev_b32 v122, 16, v71
    v_lshlrev_b32 v174, 16, v79
    v_lshlrev_b32 v226, 16, v87
    v_and_b32 v123, 0xffff0000, v71
    v_and_b32 v175, 0xffff0000, v79
    v_and_b32 v227, 0xffff0000, v87
    v_mul_f32 v131, v122, v130
    v_mul_f32 v183, v174, v182
    v_mul_f32 v235, v226, v234
    v_fma_f32 v122, -v131, v129, v122
    v_fma_f32 v174, -v183, v181, v174
    v_fma_f32 v226, -v235, v233, v226
    v_fma_f32 v131, v122, v130, v131
    v_fma_f32 v183, v174, v182, v183
    v_fma_f32 v235, v226, v234, v235
    v_mul_f32 v132, v123, v130
    v_mul_f32 v184, v175, v182
    v_mul_f32 v236, v227, v234
    v_fma_f32 v123, -v132, v129, v123
    v_fma_f32 v175, -v184, v181, v175
    v_fma_f32 v227, -v236, v233, v227
    v_fma_f32 v132, v123, v130, v132
    v_fma_f32 v184, v175, v182, v184
    v_fma_f32 v236, v227, v234, v236
    v_cvt_pk_bf16_f32 v71, v131, v132
    v_cvt_pk_bf16_f32 v79, v183, v184
    v_cvt_pk_bf16_f32 v87, v235, v236
    s_mul_i32 s35, s34, 2176
    s_mul_i32 s37, s36, 2176
    s_mul_i32 s39, s38, 2176
    buffer_store_dwordx4 v[64:67], v96, s[12:15], s35 offen sc1
    buffer_store_dwordx4 v[72:75], v148, s[12:15], s37 offen sc1
    buffer_store_dwordx4 v[80:83], v200, s[12:15], s39 offen sc1
    buffer_store_dwordx4 v[68:71], v96, s[12:15], s35 offen offset:1024 sc1
    buffer_store_dwordx4 v[76:79], v148, s[12:15], s37 offen offset:1024 sc1
    buffer_store_dwordx4 v[84:87], v200, s[12:15], s39 offen offset:1024 sc1
    s_cmp_lt_u32 s19, 277
    s_cbranch_scc1 L_su_one
    s_mov_b32 s34, s18
    s_add_u32 s36, s18, 1
    s_add_u32 s38, s18, 2
    v_mov_b32 v96, v2
    v_mov_b32 v148, v2
    v_mov_b32 v200, v2
    s_waitcnt vmcnt(7)
    v_lshlrev_b32 v108, 16, v16
    v_lshlrev_b32 v160, 16, v24
    v_lshlrev_b32 v212, 16, v32
    v_and_b32 v109, 0xffff0000, v16
    v_and_b32 v161, 0xffff0000, v24
    v_and_b32 v213, 0xffff0000, v32
    v_lshlrev_b32 v110, 16, v17
    v_lshlrev_b32 v162, 16, v25
    v_lshlrev_b32 v214, 16, v33
    v_and_b32 v111, 0xffff0000, v17
    v_and_b32 v163, 0xffff0000, v25
    v_and_b32 v215, 0xffff0000, v33
    v_lshlrev_b32 v112, 16, v18
    v_lshlrev_b32 v164, 16, v26
    v_lshlrev_b32 v216, 16, v34
    v_and_b32 v113, 0xffff0000, v18
    v_and_b32 v165, 0xffff0000, v26
    v_and_b32 v217, 0xffff0000, v34
    v_lshlrev_b32 v114, 16, v19
    v_lshlrev_b32 v166, 16, v27
    v_lshlrev_b32 v218, 16, v35
    v_and_b32 v115, 0xffff0000, v19
    v_and_b32 v167, 0xffff0000, v27
    v_and_b32 v219, 0xffff0000, v35
    v_lshlrev_b32 v116, 16, v20
    v_lshlrev_b32 v168, 16, v28
    v_lshlrev_b32 v220, 16, v36
    v_and_b32 v117, 0xffff0000, v20
    v_and_b32 v169, 0xffff0000, v28
    v_and_b32 v221, 0xffff0000, v36
    v_lshlrev_b32 v118, 16, v21
    v_lshlrev_b32 v170, 16, v29
    v_lshlrev_b32 v222, 16, v37
    v_and_b32 v119, 0xffff0000, v21
    v_and_b32 v171, 0xffff0000, v29
    v_and_b32 v223, 0xffff0000, v37
    v_lshlrev_b32 v120, 16, v22
    v_lshlrev_b32 v172, 16, v30
    v_lshlrev_b32 v224, 16, v38
    v_and_b32 v121, 0xffff0000, v22
    v_and_b32 v173, 0xffff0000, v30
    v_and_b32 v225, 0xffff0000, v38
    v_lshlrev_b32 v122, 16, v23
    v_lshlrev_b32 v174, 16, v31
    v_lshlrev_b32 v226, 16, v39
    v_and_b32 v123, 0xffff0000, v23
    v_and_b32 v175, 0xffff0000, v31
    v_and_b32 v227, 0xffff0000, v39
    v_add_f32 v126, v108, v109
    v_add_f32 v178, v160, v161
    v_add_f32 v230, v212, v213
    v_add_f32 v126, v126, v110
    v_add_f32 v178, v178, v162
    v_add_f32 v230, v230, v214
    v_add_f32 v126, v126, v111
    v_add_f32 v178, v178, v163
    v_add_f32 v230, v230, v215
    v_add_f32 v126, v126, v112
    v_add_f32 v178, v178, v164
    v_add_f32 v230, v230, v216
    v_add_f32 v126, v126, v113
    v_add_f32 v178, v178, v165
    v_add_f32 v230, v230, v217
    v_add_f32 v126, v126, v114
    v_add_f32 v178, v178, v166
    v_add_f32 v230, v230, v218
    v_add_f32 v126, v126, v115
    v_add_f32 v178, v178, v167
    v_add_f32 v230, v230, v219
    v_add_f32 v126, v126, v116
    v_add_f32 v178, v178, v168
    v_add_f32 v230, v230, v220
    v_add_f32 v126, v126, v117
    v_add_f32 v178, v178, v169
    v_add_f32 v230, v230, v221
    v_add_f32 v126, v126, v118
    v_add_f32 v178, v178, v170
    v_add_f32 v230, v230, v222
    v_add_f32 v126, v126, v119
    v_add_f32 v178, v178, v171
    v_add_f32 v230, v230, v223
    v_add_f32 v126, v126, v120
    v_add_f32 v178, v178, v172
    v_add_f32 v230, v230, v224
    v_add_f32 v126, v126, v121
    v_add_f32 v178, v178, v173
    v_add_f32 v230, v230, v225
    v_add_f32 v126, v126, v122
    v_add_f32 v178, v178, v174
    v_add_f32 v230, v230, v226
    v_add_f32 v126, v126, v123
    v_add_f32 v178, v178, v175
    v_add_f32 v230, v230, v227
    v_add_f32_dpp v126, v126, v126 row_ror:1 row_mask:0xf bank_mask:0xf
    v_add_f32_dpp v178, v178, v178 row_ror:1 row_mask:0xf bank_mask:0xf
    v_add_f32_dpp v230, v230, v230 row_ror:1 row_mask:0xf bank_mask:0xf
    v_add_f32_dpp v126, v126, v126 row_ror:2 row_mask:0xf bank_mask:0xf
    v_add_f32_dpp v178, v178, v178 row_ror:2 row_mask:0xf bank_mask:0xf
    v_add_f32_dpp v230, v230, v230 row_ror:2 row_mask:0xf bank_mask:0xf
    v_add_f32_dpp v126, v126, v126 row_ror:4 row_mask:0xf bank_mask:0xf
    v_add_f32_dpp v178, v178, v178 row_ror:4 row_mask:0xf bank_mask:0xf
    v_add_f32_dpp v230, v230, v230 row_ror:4 row_mask:0xf bank_mask:0xf
    v_add_f32_dpp v126, v126, v126 row_ror:8 row_mask:0xf bank_mask:0xf
    v_add_f32_dpp v178, v178, v178 row_ror:8 row_mask:0xf bank_mask:0xf
    v_add_f32_dpp v230, v230, v230 row_ror:8 row_mask:0xf bank_mask:0xf
    v_mov_b32 v127, v126
    v_mov_b32 v179, v178
    v_mov_b32 v231, v230
    v_permlane16_swap_b32 v126, v127
    v_permlane16_swap_b32 v178, v179
    v_permlane16_swap_b32 v230, v231
    v_add_f32 v126, v126, v127
    v_add_f32 v178, v178, v179
    v_add_f32 v230, v230, v231
    v_mov_b32 v127, v126
    v_mov_b32 v179, v178
    v_mov_b32 v231, v230
    v_permlane32_swap_b32 v126, v127
    v_permlane32_swap_b32 v178, v179
    v_permlane32_swap_b32 v230, v231
    v_add_f32 v126, v126, v127
    v_add_f32 v178, v178, v179
    v_add_f32 v230, v230, v231
    v_mul_f32 v126, 0x3a800000, v126
    v_mul_f32 v178, 0x3a800000, v178
    v_mul_f32 v230, 0x3a800000, v230
    v_sub_f32 v128, v108, v126
    v_sub_f32 v180, v160, v178
    v_sub_f32 v232, v212, v230
    v_mul_f32 v129, v128, v128
    v_mul_f32 v181, v180, v180
    v_mul_f32 v233, v232, v232
    v_sub_f32 v128, v109, v126
    v_sub_f32 v180, v161, v178
    v_sub_f32 v232, v213, v230
    v_fmac_f32 v129, v128, v128
    v_fmac_f32 v181, v180, v180
    v_fmac_f32 v233, v232, v232
    v_sub_f32 v128, v110, v126
    v_sub_f32 v180, v162, v178
    v_sub_f32 v232, v214, v230
    v_fmac_f32 v129, v128, v128
    v_fmac_f32 v181, v180, v180
    v_fmac_f32 v233, v232, v232
    v_sub_f32 v128, v111, v126
    v_sub_f32 v180, v163, v178
    v_sub_f32 v232, v215, v230
    v_fmac_f32 v129, v128, v128
    v_fmac_f32 v181, v180, v180
    v_fmac_f32 v233, v232, v232
    v_sub_f32 v128, v112, v126
    v_sub_f32 v180, v164, v178
    v_sub_f32 v232, v216, v230
    v_fmac_f32 v129, v128, v128
    v_fmac_f32 v181, v180, v180
    v_fmac_f32 v233, v232, v232
    v_sub_f32 v128, v113, v126
    v_sub_f32 v180, v165, v178
    v_sub_f32 v232, v217, v230
    v_fmac_f32 v129, v128, v128
    v_fmac_f32 v181, v180, v180
    v_fmac_f32 v233, v232, v232
    v_sub_f32 v128, v114, v126
    v_sub_f32 v180, v166, v178
    v_sub_f32 v232, v218, v230
    v_fmac_f32 v129, v128, v128
    v_fmac_f32 v181, v180, v180
    v_fmac_f32 v233, v232, v232
    v_sub_f32 v128, v115, v126
    v_sub_f32 v180, v167, v178
    v_sub_f32 v232, v219, v230
    v_fmac_f32 v129, v128, v128
    v_fmac_f32 v181, v180, v180
    v_fmac_f32 v233, v232, v232
    v_sub_f32 v128, v116, v126
    v_sub_f32 v180, v168, v178
    v_sub_f32 v232, v220, v230
    v_fmac_f32 v129, v128, v128
    v_fmac_f32 v181, v180, v180
    v_fmac_f32 v233, v232, v232
    v_sub_f32 v128, v117, v126
    v_sub_f32 v180, v169, v178
    v_sub_f32 v232, v221, v230
    v_fmac_f32 v129, v128, v128
    v_fmac_f32 v181, v180, v180
    v_fmac_f32 v233, v232, v232
    v_sub_f32 v128, v118, v126
    v_sub_f32 v180, v170, v178
    v_sub_f32 v232, v222, v230
    v_fmac_f32 v129, v128, v128
    v_fmac_f32 v181, v180, v180
    v_fmac_f32 v233, v232, v232
    v_sub_f32 v128, v119, v126
    v_sub_f32 v180, v171, v178
    v_sub_f32 v232, v223, v230
    v_fmac_f32 v129, v128, v128
    v_fmac_f32 v181, v180, v180
    v_fmac_f32 v233, v232, v232
    v_sub_f32 v128, v120, v126
    v_sub_f32 v180, v172, v178
    v_sub_f32 v232, v224, v230
    v_fmac_f32 v129, v128, v128
    v_fmac_f32 v181, v180, v180
    v_fmac_f32 v233, v232, v232
    v_sub_f32 v128, v121, v126
    v_sub_f32 v180, v173, v178
    v_sub_f32 v232, v225, v230
    v_fmac_f32 v129, v128, v128
    v_fmac_f32 v181, v180, v180
    v_fmac_f32 v233, v232, v232
    v_sub_f32 v128, v122, v126
    v_sub_f32 v180, v174, v178
    v_sub_f32 v232, v226, v230
    v_fmac_f32 v129, v128, v128
    v_fmac_f32 v181, v180, v180
    v_fmac_f32 v233, v232, v232
    v_sub_f32 v128, v123, v126
    v_sub_f32 v180, v175, v178
    v_sub_f32 v232, v227, v230
    v_fmac_f32 v129, v128, v128
    v_fmac_f32 v181, v180, v180
    v_fmac_f32 v233, v232, v232
    v_add_f32_dpp v129, v129, v129 row_ror:1 row_mask:0xf bank_mask:0xf
    v_add_f32_dpp v181, v181, v181 row_ror:1 row_mask:0xf bank_mask:0xf
    v_add_f32_dpp v233, v233, v233 row_ror:1 row_mask:0xf bank_mask:0xf
    v_add_f32_dpp v129, v129, v129 row_ror:2 row_mask:0xf bank_mask:0xf
    v_add_f32_dpp v181, v181, v181 row_ror:2 row_mask:0xf bank_mask:0xf
    v_add_f32_dpp v233, v233, v233 row_ror:2 row_mask:0xf bank_mask:0xf
    v_add_f32_dpp v129, v129, v129 row_ror:4 row_mask:0xf bank_mask:0xf
    v_add_f32_dpp v181, v181, v181 row_ror:4 row_mask:0xf bank_mask:0xf
    v_add_f32_dpp v233, v233, v233 row_ror:4 row_mask:0xf bank_mask:0xf
    v_add_f32_dpp v129, v129, v129 row_ror:8 row_mask:0xf bank_mask:0xf
    v_add_f32_dpp v181, v181, v181 row_ror:8 row_mask:0xf bank_mask:0xf
    v_add_f32_dpp v233, v233, v233 row_ror:8 row_mask:0xf bank_mask:0xf
    v_mov_b32 v127, v129
    v_mov_b32 v179, v181
    v_mov_b32 v231, v233
    v_permlane16_swap_b32 v129, v127
    v_permlane16_swap_b32 v181, v179
    v_permlane16_swap_b32 v233, v231
    v_add_f32 v129, v129, v127
    v_add_f32 v181, v181, v179
    v_add_f32 v233, v233, v231
    v_mov_b32 v127, v129
    v_mov_b32 v179, v181
    v_mov_b32 v231, v233
    v_permlane32_swap_b32 v129, v127
    v_permlane32_swap_b32 v181, v179
    v_permlane32_swap_b32 v233, v231
    v_add_f32 v129, v129, v127
    v_add_f32 v181, v181, v179
    v_add_f32 v233, v233, v231
    v_mul_f32 v129, 0x3a800000, v129
    v_mul_f32 v181, 0x3a800000, v181
    v_mul_f32 v233, 0x3a800000, v233
    v_cvt_pk_bf16_f32 v126, v126, v126
    v_cvt_pk_bf16_f32 v178, v178, v178
    v_cvt_pk_bf16_f32 v230, v230, v230
    v_lshlrev_b32 v126, 16, v126
    v_lshlrev_b32 v178, 16, v178
    v_lshlrev_b32 v230, 16, v230
    v_cvt_pk_bf16_f32 v129, v129, v129
    v_cvt_pk_bf16_f32 v181, v181, v181
    v_cvt_pk_bf16_f32 v233, v233, v233
    v_lshlrev_b32 v129, 16, v129
    v_lshlrev_b32 v181, 16, v181
    v_lshlrev_b32 v233, 16, v233
    v_add_f32 v129, 0x3727c5ac, v129
    v_add_f32 v181, 0x3727c5ac, v181
    v_add_f32 v233, 0x3727c5ac, v233
    v_cvt_pk_bf16_f32 v129, v129, v129
    v_cvt_pk_bf16_f32 v181, v181, v181
    v_cvt_pk_bf16_f32 v233, v233, v233
    v_lshlrev_b32 v129, 16, v129
    v_lshlrev_b32 v181, 16, v181
    v_lshlrev_b32 v233, 16, v233
    v_sqrt_f32 v129, v129
    v_sqrt_f32 v181, v181
    v_sqrt_f32 v233, v233
    v_cvt_pk_bf16_f32 v129, v129, v129
    v_cvt_pk_bf16_f32 v181, v181, v181
    v_cvt_pk_bf16_f32 v233, v233, v233
    v_lshlrev_b32 v129, 16, v129
    v_lshlrev_b32 v181, 16, v181
    v_lshlrev_b32 v233, 16, v233
    v_rcp_f32 v130, v129
    v_rcp_f32 v182, v181
    v_rcp_f32 v234, v233
    v_sub_f32 v108, v108, v126
    v_sub_f32 v160, v160, v178
    v_sub_f32 v212, v212, v230
    v_sub_f32 v109, v109, v126
    v_sub_f32 v161, v161, v178
    v_sub_f32 v213, v213, v230
    v_cvt_pk_bf16_f32 v16, v108, v109
    v_cvt_pk_bf16_f32 v24, v160, v161
    v_cvt_pk_bf16_f32 v32, v212, v213
    v_lshlrev_b32 v108, 16, v16
    v_lshlrev_b32 v160, 16, v24
    v_lshlrev_b32 v212, 16, v32
    v_and_b32 v109, 0xffff0000, v16
    v_and_b32 v161, 0xffff0000, v24
    v_and_b32 v213, 0xffff0000, v32
    v_mul_f32 v131, v108, v130
    v_mul_f32 v183, v160, v182
    v_mul_f32 v235, v212, v234
    v_fma_f32 v108, -v131, v129, v108
    v_fma_f32 v160, -v183, v181, v160
    v_fma_f32 v212, -v235, v233, v212
    v_fma_f32 v131, v108, v130, v131
    v_fma_f32 v183, v160, v182, v183
    v_fma_f32 v235, v212, v234, v235
    v_mul_f32 v132, v109, v130
    v_mul_f32 v184, v161, v182
    v_mul_f32 v236, v213, v234
    v_fma_f32 v109, -v132, v129, v109
    v_fma_f32 v161, -v184, v181, v161
    v_fma_f32 v213, -v236, v233, v213
    v_fma_f32 v132, v109, v130, v132
    v_fma_f32 v184, v161, v182, v184
    v_fma_f32 v236, v213, v234, v236
    v_cvt_pk_bf16_f32 v16, v131, v132
    v_cvt_pk_bf16_f32 v24, v183, v184
    v_cvt_pk_bf16_f32 v32, v235, v236
    v_sub_f32 v110, v110, v126
    v_sub_f32 v162, v162, v178
    v_sub_f32 v214, v214, v230
    v_sub_f32 v111, v111, v126
    v_sub_f32 v163, v163, v178
    v_sub_f32 v215, v215, v230
    v_cvt_pk_bf16_f32 v17, v110, v111
    v_cvt_pk_bf16_f32 v25, v162, v163
    v_cvt_pk_bf16_f32 v33, v214, v215
    v_lshlrev_b32 v110, 16, v17
    v_lshlrev_b32 v162, 16, v25
    v_lshlrev_b32 v214, 16, v33
    v_and_b32 v111, 0xffff0000, v17
    v_and_b32 v163, 0xffff0000, v25
    v_and_b32 v215, 0xffff0000, v33
    v_mul_f32 v131, v110, v130
    v_mul_f32 v183, v162, v182
    v_mul_f32 v235, v214, v234
    v_fma_f32 v110, -v131, v129, v110
    v_fma_f32 v162, -v183, v181, v162
    v_fma_f32 v214, -v235, v233, v214
    v_fma_f32 v131, v110, v130, v131
    v_fma_f32 v183, v162, v182, v183
    v_fma_f32 v235, v214, v234, v235
    v_mul_f32 v132, v111, v130
    v_mul_f32 v184, v163, v182
    v_mul_f32 v236, v215, v234
    v_fma_f32 v111, -v132, v129, v111
    v_fma_f32 v163, -v184, v181, v163
    v_fma_f32 v215, -v236, v233, v215
    v_fma_f32 v132, v111, v130, v132
    v_fma_f32 v184, v163, v182, v184
    v_fma_f32 v236, v215, v234, v236
    v_cvt_pk_bf16_f32 v17, v131, v132
    v_cvt_pk_bf16_f32 v25, v183, v184
    v_cvt_pk_bf16_f32 v33, v235, v236
    v_sub_f32 v112, v112, v126
    v_sub_f32 v164, v164, v178
    v_sub_f32 v216, v216, v230
    v_sub_f32 v113, v113, v126
    v_sub_f32 v165, v165, v178
    v_sub_f32 v217, v217, v230
    v_cvt_pk_bf16_f32 v18, v112, v113
    v_cvt_pk_bf16_f32 v26, v164, v165
    v_cvt_pk_bf16_f32 v34, v216, v217
    v_lshlrev_b32 v112, 16, v18
    v_lshlrev_b32 v164, 16, v26
    v_lshlrev_b32 v216, 16, v34
    v_and_b32 v113, 0xffff0000, v18
    v_and_b32 v165, 0xffff0000, v26
    v_and_b32 v217, 0xffff0000, v34
    v_mul_f32 v131, v112, v130
    v_mul_f32 v183, v164, v182
    v_mul_f32 v235, v216, v234
    v_fma_f32 v112, -v131, v129, v112
    v_fma_f32 v164, -v183, v181, v164
    v_fma_f32 v216, -v235, v233, v216
    v_fma_f32 v131, v112, v130, v131
    v_fma_f32 v183, v164, v182, v183
    v_fma_f32 v235, v216, v234, v235
    v_mul_f32 v132, v113, v130
    v_mul_f32 v184, v165, v182
    v_mul_f32 v236, v217, v234
    v_fma_f32 v113, -v132, v129, v113
    v_fma_f32 v165, -v184, v181, v165
    v_fma_f32 v217, -v236, v233, v217
    v_fma_f32 v132, v113, v130, v132
    v_fma_f32 v184, v165, v182, v184
    v_fma_f32 v236, v217, v234, v236
    v_cvt_pk_bf16_f32 v18, v131, v132
    v_cvt_pk_bf16_f32 v26, v183, v184
    v_cvt_pk_bf16_f32 v34, v235, v236
    v_sub_f32 v114, v114, v126
    v_sub_f32 v166, v166, v178
    v_sub_f32 v218, v218, v230
    v_sub_f32 v115, v115, v126
    v_sub_f32 v167, v167, v178
    v_sub_f32 v219, v219, v230
    v_cvt_pk_bf16_f32 v19, v114, v115
    v_cvt_pk_bf16_f32 v27, v166, v167
    v_cvt_pk_bf16_f32 v35, v218, v219
    v_lshlrev_b32 v114, 16, v19
    v_lshlrev_b32 v166, 16, v27
    v_lshlrev_b32 v218, 16, v35
    v_and_b32 v115, 0xffff0000, v19
    v_and_b32 v167, 0xffff0000, v27
    v_and_b32 v219, 0xffff0000, v35
    v_mul_f32 v131, v114, v130
    v_mul_f32 v183, v166, v182
    v_mul_f32 v235, v218, v234
    v_fma_f32 v114, -v131, v129, v114
    v_fma_f32 v166, -v183, v181, v166
    v_fma_f32 v218, -v235, v233, v218
    v_fma_f32 v131, v114, v130, v131
    v_fma_f32 v183, v166, v182, v183
    v_fma_f32 v235, v218, v234, v235
    v_mul_f32 v132, v115, v130
    v_mul_f32 v184, v167, v182
    v_mul_f32 v236, v219, v234
    v_fma_f32 v115, -v132, v129, v115
    v_fma_f32 v167, -v184, v181, v167
    v_fma_f32 v219, -v236, v233, v219
    v_fma_f32 v132, v115, v130, v132
    v_fma_f32 v184, v167, v182, v184
    v_fma_f32 v236, v219, v234, v236
    v_cvt_pk_bf16_f32 v19, v131, v132
    v_cvt_pk_bf16_f32 v27, v183, v184
    v_cvt_pk_bf16_f32 v35, v235, v236
    v_sub_f32 v116, v116, v126
    v_sub_f32 v168, v168, v178
    v_sub_f32 v220, v220, v230
    v_sub_f32 v117, v117, v126
    v_sub_f32 v169, v169, v178
    v_sub_f32 v221, v221, v230
    v_cvt_pk_bf16_f32 v20, v116, v117
    v_cvt_pk_bf16_f32 v28, v168, v169
    v_cvt_pk_bf16_f32 v36, v220, v221
    v_lshlrev_b32 v116, 16, v20
    v_lshlrev_b32 v168, 16, v28
    v_lshlrev_b32 v220, 16, v36
    v_and_b32 v117, 0xffff0000, v20
    v_and_b32 v169, 0xffff0000, v28
    v_and_b32 v221, 0xffff0000, v36
    v_mul_f32 v131, v116, v130
    v_mul_f32 v183, v168, v182
    v_mul_f32 v235, v220, v234
    v_fma_f32 v116, -v131, v129, v116
    v_fma_f32 v168, -v183, v181, v168
    v_fma_f32 v220, -v235, v233, v220
    v_fma_f32 v131, v116, v130, v131
    v_fma_f32 v183, v168, v182, v183
    v_fma_f32 v235, v220, v234, v235
    v_mul_f32 v132, v117, v130
    v_mul_f32 v184, v169, v182
    v_mul_f32 v236, v221, v234
    v_fma_f32 v117, -v132, v129, v117
    v_fma_f32 v169, -v184, v181, v169
    v_fma_f32 v221, -v236, v233, v221
    v_fma_f32 v132, v117, v130, v132
    v_fma_f32 v184, v169, v182, v184
    v_fma_f32 v236, v221, v234, v236
    v_cvt_pk_bf16_f32 v20, v131, v132
    v_cvt_pk_bf16_f32 v28, v183, v184
    v_cvt_pk_bf16_f32 v36, v235, v236
    v_sub_f32 v118, v118, v126
    v_sub_f32 v170, v170, v178
    v_sub_f32 v222, v222, v230
    v_sub_f32 v119, v119, v126
    v_sub_f32 v171, v171, v178
    v_sub_f32 v223, v223, v230
    v_cvt_pk_bf16_f32 v21, v118, v119
    v_cvt_pk_bf16_f32 v29, v170, v171
    v_cvt_pk_bf16_f32 v37, v222, v223
    v_lshlrev_b32 v118, 16, v21
    v_lshlrev_b32 v170, 16, v29
    v_lshlrev_b32 v222, 16, v37
    v_and_b32 v119, 0xffff0000, v21
    v_and_b32 v171, 0xffff0000, v29
    v_and_b32 v223, 0xffff0000, v37
    v_mul_f32 v131, v118, v130
    v_mul_f32 v183, v170, v182
    v_mul_f32 v235, v222, v234
    v_fma_f32 v118, -v131, v129, v118
    v_fma_f32 v170, -v183, v181, v170
    v_fma_f32 v222, -v235, v233, v222
    v_fma_f32 v131, v118, v130, v131
    v_fma_f32 v183, v170, v182, v183
    v_fma_f32 v235, v222, v234, v235
    v_mul_f32 v132, v119, v130
    v_mul_f32 v184, v171, v182
    v_mul_f32 v236, v223, v234
    v_fma_f32 v119, -v132, v129, v119
    v_fma_f32 v171, -v184, v181, v171
    v_fma_f32 v223, -v236, v233, v223
    v_fma_f32 v132, v119, v130, v132
    v_fma_f32 v184, v171, v182, v184
    v_fma_f32 v236, v223, v234, v236
    v_cvt_pk_bf16_f32 v21, v131, v132
    v_cvt_pk_bf16_f32 v29, v183, v184
    v_cvt_pk_bf16_f32 v37, v235, v236
    v_sub_f32 v120, v120, v126
    v_sub_f32 v172, v172, v178
    v_sub_f32 v224, v224, v230
    v_sub_f32 v121, v121, v126
    v_sub_f32 v173, v173, v178
    v_sub_f32 v225, v225, v230
    v_cvt_pk_bf16_f32 v22, v120, v121
    v_cvt_pk_bf16_f32 v30, v172, v173
    v_cvt_pk_bf16_f32 v38, v224, v225
    v_lshlrev_b32 v120, 16, v22
    v_lshlrev_b32 v172, 16, v30
    v_lshlrev_b32 v224, 16, v38
    v_and_b32 v121, 0xffff0000, v22
    v_and_b32 v173, 0xffff0000, v30
    v_and_b32 v225, 0xffff0000, v38
    v_mul_f32 v131, v120, v130
    v_mul_f32 v183, v172, v182
    v_mul_f32 v235, v224, v234
    v_fma_f32 v120, -v131, v129, v120
    v_fma_f32 v172, -v183, v181, v172
    v_fma_f32 v224, -v235, v233, v224
    v_fma_f32 v131, v120, v130, v131
    v_fma_f32 v183, v172, v182, v183
    v_fma_f32 v235, v224, v234, v235
    v_mul_f32 v132, v121, v130
    v_mul_f32 v184, v173, v182
    v_mul_f32 v236, v225, v234
    v_fma_f32 v121, -v132, v129, v121
    v_fma_f32 v173, -v184, v181, v173
    v_fma_f32 v225, -v236, v233, v225
    v_fma_f32 v132, v121, v130, v132
    v_fma_f32 v184, v173, v182, v184
    v_fma_f32 v236, v225, v234, v236
    v_cvt_pk_bf16_f32 v22, v131, v132
    v_cvt_pk_bf16_f32 v30, v183, v184
    v_cvt_pk_bf16_f32 v38, v235, v236
    v_sub_f32 v122, v122, v126
    v_sub_f32 v174, v174, v178
    v_sub_f32 v226, v226, v230
    v_sub_f32 v123, v123, v126
    v_sub_f32 v175, v175, v178
    v_sub_f32 v227, v227, v230
    v_cvt_pk_bf16_f32 v23, v122, v123
    v_cvt_pk_bf16_f32 v31, v174, v175
    v_cvt_pk_bf16_f32 v39, v226, v227
    v_lshlrev_b32 v122, 16, v23
    v_lshlrev_b32 v174, 16, v31
    v_lshlrev_b32 v226, 16, v39
    v_and_b32 v123, 0xffff0000, v23
    v_and_b32 v175, 0xffff0000, v31
    v_and_b32 v227, 0xffff0000, v39
    v_mul_f32 v131, v122, v130
    v_mul_f32 v183, v174, v182
    v_mul_f32 v235, v226, v234
    v_fma_f32 v122, -v131, v129, v122
    v_fma_f32 v174, -v183, v181, v174
    v_fma_f32 v226, -v235, v233, v226
    v_fma_f32 v131, v122, v130, v131
    v_fma_f32 v183, v174, v182, v183
    v_fma_f32 v235, v226, v234, v235
    v_mul_f32 v132, v123, v130
    v_mul_f32 v184, v175, v182
    v_mul_f32 v236, v227, v234
    v_fma_f32 v123, -v132, v129, v123
    v_fma_f32 v175, -v184, v181, v175
    v_fma_f32 v227, -v236, v233, v227
    v_fma_f32 v132, v123, v130, v132
    v_fma_f32 v184, v175, v182, v184
    v_fma_f32 v236, v227, v234, v236
    v_cvt_pk_bf16_f32 v23, v131, v132
    v_cvt_pk_bf16_f32 v31, v183, v184
    v_cvt_pk_bf16_f32 v39, v235, v236
    s_mul_i32 s35, s34, 2176
    s_mul_i32 s37, s36, 2176
    s_mul_i32 s39, s38, 2176
    buffer_store_dwordx4 v[16:19], v96, s[12:15], s35 offen sc1
    buffer_store_dwordx4 v[24:27], v148, s[12:15], s37 offen sc1
    buffer_store_dwordx4 v[32:35], v200, s[12:15], s39 offen sc1
    buffer_store_dwordx4 v[20:23], v96, s[12:15], s35 offen offset:1024 sc1
    buffer_store_dwordx4 v[28:31], v148, s[12:15], s37 offen offset:1024 sc1
    buffer_store_dwordx4 v[36:39], v200, s[12:15], s39 offen offset:1024 sc1
L_su_one:
    v_mov_b32 v4, -1
    v_mov_b32 v5, -1
    v_mov_b32 v6, -1
    v_mov_b32 v7, -1
    s_mul_i32 s16, s19, 6
    s_cmp_ge_u32 s16, 1728
    s_cbranch_scc1 Ps_7
    s_cmp_ge_u32 s16, 1024
    s_cselect_b32 s17, 64, 0
    s_add_u32 s17, s17, s16
    s_lshl_b32 s17, s17, 10
    s_add_u32 s17, s17, 104857600
    buffer_store_dwordx4 v[4:7], v2, s[8:11], s17 offen sc1
Ps_7:
    s_add_u32 s16, s16, 1
    s_cmp_ge_u32 s16, 1728
    s_cbranch_scc1 Ps_8
    s_cmp_ge_u32 s16, 1024
    s_cselect_b32 s17, 64, 0
    s_add_u32 s17, s17, s16
    s_lshl_b32 s17, s17, 10
    s_add_u32 s17, s17, 104857600
    buffer_store_dwordx4 v[4:7], v2, s[8:11], s17 offen sc1
Ps_8:
    s_add_u32 s16, s16, 1
    s_cmp_ge_u32 s16, 1728
    s_cbranch_scc1 Ps_9
    s_cmp_ge_u32 s16, 1024
    s_cselect_b32 s17, 64, 0
    s_add_u32 s17, s17, s16
    s_lshl_b32 s17, s17, 10
    s_add_u32 s17, s17, 104857600
    buffer_store_dwordx4 v[4:7], v2, s[8:11], s17 offen sc1
Ps_9:
    s_add_u32 s16, s16, 1
    s_cmp_ge_u32 s16, 1728
    s_cbranch_scc1 Ps_10
    s_cmp_ge_u32 s16, 1024
    s_cselect_b32 s17, 64, 0
    s_add_u32 s17, s17, s16
    s_lshl_b32 s17, s17, 10
    s_add_u32 s17, s17, 104857600
    buffer_store_dwordx4 v[4:7], v2, s[8:11], s17 offen sc1
Ps_10:
    s_add_u32 s16, s16, 1
    s_cmp_ge_u32 s16, 1728
    s_cbranch_scc1 Ps_11
    s_cmp_ge_u32 s16, 1024
    s_cselect_b32 s17, 64, 0
    s_add_u32 s17, s17, s16
    s_lshl_b32 s17, s17, 10
    s_add_u32 s17, s17, 104857600
    buffer_store_dwordx4 v[4:7], v2, s[8:11], s17 offen sc1
Ps_11:
    s_add_u32 s16, s16, 1
    s_cmp_ge_u32 s16, 1728
    s_cbranch_scc1 Ps_12
    s_cmp_ge_u32 s16, 1024
    s_cselect_b32 s17, 64, 0
    s_add_u32 s17, s17, s16
    s_lshl_b32 s17, s17, 10
    s_add_u32 s17, s17, 104857600
    buffer_store_dwordx4 v[4:7], v2, s[8:11], s17 offen sc1
Ps_12:
    s_add_u32 s16, s16, 1
    v_lshlrev_b32 v9, 2, v1
    s_cmp_lt_u32 s19, 224
    s_cbranch_scc1 Pz_13
    v_mov_b32 v8, 0
    s_sub_u32 s17, s19, 224
    s_lshl_b32 s17, s17, 8
    s_add_u32 s17, s17, 113246208
    buffer_store_dword v8, v9, s[8:11], s17 offen sc1
Pz_13:
    s_cmp_ge_u32 s19, 256
    s_cbranch_scc1 Pm_14
    s_lshl_b32 s16, s19, 8
    s_add_u32 s16, s16, 105906176
    s_waitcnt vmcnt(6)
    buffer_store_dword v10, v9, s[8:11], s16 offen sc1
Pm_14:
    s_branch L_su_end
L_su_pre:
L_su_end:
    s_branch R_1
R_6:
    s_mov_b32 s20, s64
    s_and_b32 s21, s65, 0xffff
    s_mov_b32 s22, 256
    s_mov_b32 s23, 0x20000
    s_mov_b32 s30, 0
    s_cmp_lg_u32 s2, 0
    s_cbranch_scc1 R_4
    s_memrealtime s[24:25]
    s_waitcnt lgkmcnt(0)
    s_lshl_b32 s24, s24, 3
    s_bitset1_b32 s24, 31
    v_mov_b32 v2, s24
    buffer_store_dword v2, off, s[20:23], 0 sc1
    s_branch R_5
R_4:
    buffer_load_dword v60, off, s[20:23], 0 sc1
    s_waitcnt vmcnt(0)
    v_readfirstlane_b32 s24, v60
    s_memrealtime s[26:27]
    s_waitcnt lgkmcnt(0)
    s_add_u32 s26, s26, 64
    s_lshl_b32 s26, s26, 3
    s_sub_u32 s26, s26, s24
    s_bitset0_b32 s26, 31
    s_cmp_eq_u32 s24, 0
    s_cselect_b32 s26, -1, s26
    s_cmp_lt_u32 s26, 120000
    s_cbranch_scc1 R_5
    s_sleep 2
    s_add_u32 s30, s30, 1
    s_cmp_lt_u32 s30, 65536
    s_cbranch_scc1 R_4
    s_branch L_abort
R_5:
    s_mov_b32 s101, s24
    s_or_b32 s25, s24, s31
    v_mov_b32 v2, s25
    s_lshl_b32 s26, s2, 2
    s_add_u32 s26, s26, 112197632
    s_mov_b64 exec, 1
    buffer_store_dword v2, off, s[8:11], s26 sc1
    s_mov_b64 exec, -1
    v_lshlrev_b32 v3, 2, v1
    s_mov_b32 s26, 112197632
    s_mov_b32 s30, 0
    s_cmp_eq_u32 s2, 0
    s_cbranch_scc1 R_2
    s_mov_b32 s25, 128
R_15:
    s_sleep 4
    buffer_load_dword v5, off, s[20:23], s25 sc1
    s_waitcnt vmcnt(0)
    v_cmp_ne_u32 vcc, s24, v5
    s_cbranch_vccz R_2
    s_add_u32 s30, s30, 1
    s_cmp_lt_u32 s30, 65536
    s_cbranch_scc1 R_15
    s_branch L_abort
R_2:
    buffer_load_dword v8, v3, s[8:11], s26 offen offset:0 sc1
    buffer_load_dword v9, v3, s[8:11], s26 offen offset:256 sc1
    buffer_load_dword v10, v3, s[8:11], s26 offen offset:512 sc1
    buffer_load_dword v11, v3, s[8:11], s26 offen offset:768 sc1
    s_waitcnt vmcnt(0)
    v_xor_b32 v8, s24, v8
    v_xor_b32 v9, s24, v9
    v_xor_b32 v10, s24, v10
    v_xor_b32 v11, s24, v11
    v_or_b32 v5, v8, v9
    v_or3_b32 v5, v5, v10, v11
    v_cmp_lt_u32 vcc, 7, v5
    s_cbranch_vccz R_3
    s_sleep 2
    s_add_u32 s30, s30, 1
    s_cmp_lt_u32 s30, 65536
    s_cbranch_scc1 R_2
    s_branch L_abort
R_3:
    s_cmp_lg_u32 s2, 0
    s_cbranch_scc1 R_16
    v_mov_b32 v5, s24
    s_mov_b32 s25, 128
    buffer_store_dword v5, off, s[20:23], s25 sc1
R_16:
    s_mov_b32 s32, 0
    s_mov_b32 s25, 0
    v_cmp_eq_u32 vcc, 0, v8
    s_nop 0
    s_bcnt1_i32_b64 s27, vcc
    s_add_u32 s25, s25, s27
    v_cmp_eq_u32 vcc, 0, v9
    s_nop 0
    s_bcnt1_i32_b64 s27, vcc
    s_add_u32 s25, s25, s27
    v_cmp_eq_u32 vcc, 0, v10
    s_nop 0
    s_bcnt1_i32_b64 s27, vcc
    s_add_u32 s25, s25, s27
    v_cmp_eq_u32 vcc, 0, v11
    s_nop 0
    s_bcnt1_i32_b64 s27, vcc
    s_add_u32 s25, s25, s27
    v_writelane_b32 v5, s25, 0
    s_mov_b32 s25, 0
    v_cmp_eq_u32 vcc, 1, v8
    s_nop 0
    s_bcnt1_i32_b64 s27, vcc
    s_add_u32 s25, s25, s27
    v_cmp_eq_u32 vcc, 1, v9
    s_nop 0
    s_bcnt1_i32_b64 s27, vcc
    s_add_u32 s25, s25, s27
    v_cmp_eq_u32 vcc, 1, v10
    s_nop 0
    s_bcnt1_i32_b64 s27, vcc
    s_add_u32 s25, s25, s27
    v_cmp_eq_u32 vcc, 1, v11
    s_nop 0
    s_bcnt1_i32_b64 s27, vcc
    s_add_u32 s25, s25, s27
    v_writelane_b32 v5, s25, 1
    s_mov_b32 s25, 0
    v_cmp_eq_u32 vcc, 2, v8
    s_nop 0
    s_bcnt1_i32_b64 s27, vcc
    s_add_u32 s25, s25, s27
    v_cmp_eq_u32 vcc, 2, v9
    s_nop 0
    s_bcnt1_i32_b64 s27, vcc
    s_add_u32 s25, s25, s27
    v_cmp_eq_u32 vcc, 2, v10
    s_nop 0
    s_bcnt1_i32_b64 s27, vcc
    s_add_u32 s25, s25, s27
    v_cmp_eq_u32 vcc, 2, v11
    s_nop 0
    s_bcnt1_i32_b64 s27, vcc
    s_add_u32 s25, s25, s27
    v_writelane_b32 v5, s25, 2
    s_mov_b32 s25, 0
    v_cmp_eq_u32 vcc, 3, v8
    s_nop 0
    s_bcnt1_i32_b64 s27, vcc
    s_add_u32 s25, s25, s27
    v_cmp_eq_u32 vcc, 3, v9
    s_nop 0
    s_bcnt1_i32_b64 s27, vcc
    s_add_u32 s25, s25, s27
    v_cmp_eq_u32 vcc, 3, v10
    s_nop 0
    s_bcnt1_i32_b64 s27, vcc
    s_add_u32 s25, s25, s27
    v_cmp_eq_u32 vcc, 3, v11
    s_nop 0
    s_bcnt1_i32_b64 s27, vcc
    s_add_u32 s25, s25, s27
    v_writelane_b32 v5, s25, 3
    s_mov_b32 s25, 0
    v_cmp_eq_u32 vcc, 4, v8
    s_nop 0
    s_bcnt1_i32_b64 s27, vcc
    s_add_u32 s25, s25, s27
    v_cmp_eq_u32 vcc, 4, v9
    s_nop 0
    s_bcnt1_i32_b64 s27, vcc
    s_add_u32 s25, s25, s27
    v_cmp_eq_u32 vcc, 4, v10
    s_nop 0
    s_bcnt1_i32_b64 s27, vcc
    s_add_u32 s25, s25, s27
    v_cmp_eq_u32 vcc, 4, v11
    s_nop 0
    s_bcnt1_i32_b64 s27, vcc
    s_add_u32 s25, s25, s27
    v_writelane_b32 v5, s25, 4
    s_mov_b32 s25, 0
    v_cmp_eq_u32 vcc, 5, v8
    s_nop 0
    s_bcnt1_i32_b64 s27, vcc
    s_add_u32 s25, s25, s27
    v_cmp_eq_u32 vcc, 5, v9
    s_nop 0
    s_bcnt1_i32_b64 s27, vcc
    s_add_u32 s25, s25, s27
    v_cmp_eq_u32 vcc, 5, v10
    s_nop 0
    s_bcnt1_i32_b64 s27, vcc
    s_add_u32 s25, s25, s27
    v_cmp_eq_u32 vcc, 5, v11
    s_nop 0
    s_bcnt1_i32_b64 s27, vcc
    s_add_u32 s25, s25, s27
    v_writelane_b32 v5, s25, 5
    s_mov_b32 s25, 0
    v_cmp_eq_u32 vcc, 6, v8
    s_nop 0
    s_bcnt1_i32_b64 s27, vcc
    s_add_u32 s25, s25, s27
    v_cmp_eq_u32 vcc, 6, v9
    s_nop 0
    s_bcnt1_i32_b64 s27, vcc
    s_add_u32 s25, s25, s27
    v_cmp_eq_u32 vcc, 6, v10
    s_nop 0
    s_bcnt1_i32_b64 s27, vcc
    s_add_u32 s25, s25, s27
    v_cmp_eq_u32 vcc, 6, v11
    s_nop 0
    s_bcnt1_i32_b64 s27, vcc
    s_add_u32 s25, s25, s27
    v_writelane_b32 v5, s25, 6
    s_mov_b32 s25, 0
    v_cmp_eq_u32 vcc, 7, v8
    s_nop 0
    s_bcnt1_i32_b64 s27, vcc
    s_add_u32 s25, s25, s27
    v_cmp_eq_u32 vcc, 7, v9
    s_nop 0
    s_bcnt1_i32_b64 s27, vcc
    s_add_u32 s25, s25, s27
    v_cmp_eq_u32 vcc, 7, v10
    s_nop 0
    s_bcnt1_i32_b64 s27, vcc
    s_add_u32 s25, s25, s27
    v_cmp_eq_u32 vcc, 7, v11
    s_nop 0
    s_bcnt1_i32_b64 s27, vcc
    s_add_u32 s25, s25, s27
    v_writelane_b32 v5, s25, 7
    v_add_u32 v2, 0, v1
    v_cmp_eq_u32 vcc, s31, v8
    v_cmp_gt_u32 s[26:27], s2, v2
    s_nop 0
    s_and_b64 vcc, vcc, s[26:27]
    s_bcnt1_i32_b64 s27, vcc
    s_add_u32 s32, s32, s27
    v_add_u32 v2, 64, v1
    v_cmp_eq_u32 vcc, s31, v9
    v_cmp_gt_u32 s[26:27], s2, v2
    s_nop 0
    s_and_b64 vcc, vcc, s[26:27]
    s_bcnt1_i32_b64 s27, vcc
    s_add_u32 s32, s32, s27
    v_add_u32 v2, 128, v1
    v_cmp_eq_u32 vcc, s31, v10
    v_cmp_gt_u32 s[26:27], s2, v2
    s_nop 0
    s_and_b64 vcc, vcc, s[26:27]
    s_bcnt1_i32_b64 s27, vcc
    s_add_u32 s32, s32, s27
    v_add_u32 v2, 192, v1
    v_cmp_eq_u32 vcc, s31, v11
    v_cmp_gt_u32 s[26:27], s2, v2
    s_nop 0
    s_and_b64 vcc, vcc, s[26:27]
    s_bcnt1_i32_b64 s27, vcc
    s_add_u32 s32, s32, s27
    v_writelane_b32 v5, s32, 8
    v_writelane_b32 v5, s101, 9
    v_mov_b32 v4, 159744
    v_lshl_add_u32 v3, v1, 2, v4
    s_mov_b64 exec, 0x3ff
    ds_write_b32 v3, v5
    s_mov_b64 exec, -1
    s_waitcnt lgkmcnt(0)
R_1:
    s_barrier
    s_getreg_b32 s31, hwreg(HW_REG_XCC_ID)
    s_and_b32 s31, s31, 7
    v_mov_b32 v12, 159744
    v_and_b32 v3, 15, v1
    v_lshl_add_u32 v3, v3, 2, v12
    ds_read_b32 v13, v3
    s_waitcnt lgkmcnt(0)
    v_readlane_b32 s32, v13, 8
    v_readlane_b32 s101, v13, 9
    s_mov_b32 s33, 0
    s_mov_b32 s25, 256
    v_readlane_b32 s24, v13, 0
    s_nop 0
    s_min_u32 s25, s25, s24
    s_cmp_gt_u32 s31, 0
    s_cselect_b32 s24, s24, 0
    s_add_u32 s33, s33, s24
    v_readlane_b32 s24, v13, 1
    s_nop 0
    s_min_u32 s25, s25, s24
    s_cmp_gt_u32 s31, 1
    s_cselect_b32 s24, s24, 0
    s_add_u32 s33, s33, s24
    v_readlane_b32 s24, v13, 2
    s_nop 0
    s_min_u32 s25, s25, s24
    s_cmp_gt_u32 s31, 2
    s_cselect_b32 s24, s24, 0
    s_add_u32 s33, s33, s24
    v_readlane_b32 s24, v13, 3
    s_nop 0
    s_min_u32 s25, s25, s24
    s_cmp_gt_u32 s31, 3
    s_cselect_b32 s24, s24, 0
    s_add_u32 s33, s33, s24
    v_readlane_b32 s24, v13, 4
    s_nop 0
    s_min_u32 s25, s25, s24
    s_cmp_gt_u32 s31, 4
    s_cselect_b32 s24, s24, 0
    s_add_u32 s33, s33, s24
    v_readlane_b32 s24, v13, 5
    s_nop 0
    s_min_u32 s25, s25, s24
    s_cmp_gt_u32 s31, 5
    s_cselect_b32 s24, s24, 0
    s_add_u32 s33, s33, s24
    v_readlane_b32 s24, v13, 6
    s_nop 0
    s_min_u32 s25, s25, s24
    s_cmp_gt_u32 s31, 6
    s_cselect_b32 s24, s24, 0
    s_add_u32 s33, s33, s24
    v_readlane_b32 s24, v13, 7
    s_nop 0
    s_min_u32 s25, s25, s24
    s_cmp_gt_u32 s31, 7
    s_cselect_b32 s24, s24, 0
    s_add_u32 s33, s33, s24
    s_add_u32 s33, s33, s32
    s_barrier
    s_cmp_lt_u32 s25, 32
    s_cbranch_scc1 Rs_17
    s_mov_b32 s18, 0
    s_mov_b32 s16, s31
    s_mov_b32 s17, s32
    s_cmp_lt_u32 s31, 4
    s_cselect_b32 s29, 1, 0
    s_cmp_lt_u32 s32, 24
    s_cselect_b32 s29, s29, 0
    s_branch Re_18
Rs_17:
    s_mov_b32 s18, 1
    s_mul_i32 s16, s33, 2731
    s_lshr_b32 s16, s16, 16
    s_mul_i32 s24, s16, 24
    s_sub_u32 s17, s33, s24
    s_cmp_lt_u32 s33, 96
    s_cselect_b32 s29, 1, 0
Re_18:
    s_mov_b32 s35, s18
    s_mov_b32 s96, 0
    s_sub_u32 s98, s31, 4
    s_cmp_lt_u32 s31, 4
    s_cselect_b32 s98, 5, s98
    s_mov_b32 s96, 1
    s_cmp_eq_u32 s18, 0
    s_cbranch_scc1 Cl_19
    s_cmp_lt_u32 s33, 128
    s_cselect_b32 s98, 5, 4
Cl_19:
    s_lshl_b32 s97, s98, 7
    s_add_u32 s97, s97, 113246336
    s_mov_b32 s100, 0
    s_cmp_eq_u32 s98, 4
    s_cselect_b32 s83, 128, 32
    s_lshl_b32 s34, s31, 3
    s_add_u32 s34, s34, s32
    s_sub_u32 s34, s34, 24
    s_cmp_ge_u32 s31, 4
    s_cselect_b32 s34, s32, s34
    s_cmp_eq_u32 s35, 0
    s_cbranch_scc1 Cl_20
    s_sub_u32 s34, s33, 96
    s_cmp_eq_u32 s98, 4
    s_cselect_b32 s20, 32, 0
    s_sub_u32 s34, s34, s20
Cl_20:
    s_cmp_eq_u32 s29, 0
    s_cbranch_scc1 L_worker0
    s_setprio 3
    s_cmp_ge_u32 s17, 8
    s_cbranch_scc1 L_vr
    s_lshl_b32 s26, s16, 3
    s_add_u32 s26, s26, s17
    v_lshrrev_b32 v2, 4, v1
    v_and_b32 v3, 15, v1
    v_lshlrev_b32 v4, 1, v2
    v_xor_b32 v3, v3, v4
    s_lshl_b32 s20, s3, 4
    v_add_u32 v2, s20, v2
    v_lshlrev_b32 v2, 13, v2
    v_lshlrev_b32 v3, 4, v3
    v_mov_b32 v4, v3
    v_add_u32 v4, v2, v4
    v_add_u32 v32, 0, v4
    v_mov_b32 v4, v3
    v_add_u32 v4, v2, v4
    v_add_u32 v33, 32768, v4
    v_xor_b32 v4, 128, v3
    v_add_u32 v4, v2, v4
    v_add_u32 v34, 65536, v4
    v_xor_b32 v4, 128, v3
    v_add_u32 v4, v2, v4
    v_add_u32 v35, 98304, v4
    v_lshrrev_b32 v2, 3, v1
    v_and_b32 v3, 7, v1
    v_bfe_u32 v4, v1, 4, 1
    v_lshlrev_b32 v4, 1, v4
    v_xor_b32 v3, v3, v4
    v_add_u32 v2, s20, v2
    v_lshlrev_b32 v2, 13, v2
    v_lshlrev_b32 v3, 4, v3
    v_add_u32 v36, v2, v3
    v_xor_b32 v3, 64, v3
    v_add_u32 v37, v2, v3
    v_add_u32 v37, 65536, v37
    v_lshrrev_b32 v2, 4, v1
    v_bfe_u32 v3, v1, 2, 2
    v_lshl_add_u32 v4, v2, 3, v3
    v_and_b32 v5, 3, v1
    v_lshlrev_b32 v5, 3, v5
    v_and_b32 v2, 1, v2
    v_lshl_or_b32 v15, v2, 2, v3
    v_xor_b32 v15, s3, v15
    v_lshlrev_b32 v15, 5, v15
    v_lshl_add_u32 v38, v4, 8, v5
    v_add_u32 v39, v38, v15
    v_xor_b32 v15, 128, v15
    v_add_u32 v40, v38, v15
    v_lshrrev_b32 v3, 1, v3
    v_lshl_or_b32 v15, v2, 1, v3
    v_xor_b32 v15, s3, v15
    v_lshlrev_b32 v15, 5, v15
    v_lshl_add_u32 v6, v4, 7, v5
    v_add_u32 v6, v6, v15
    v_add_u32 v7, 65536, v6
    s_mov_b32 s12, s44
    s_and_b32 s13, s45, 0xffff
    s_mov_b32 s14, 8388608
    s_mov_b32 s15, 0x20000
    s_mov_b32 s28, s46
    s_and_b32 s29, s47, 0xffff
    s_mov_b32 s30, 8388608
    s_mov_b32 s31, 0x20000
    s_lshl_b32 s22, s26, 8
    s_lshl_b32 s23, s3, 12
    s_lshl_b32 s24, s3, 11
    s_add_u32 s24, s24, 16384
    s_add_u32 m0, s23, 0
    s_nop 0
    buffer_load_dwordx4 v32, s[12:15], s22 offen lds
    s_add_u32 m0, s23, 1024
    s_nop 0
    buffer_load_dwordx4 v33, s[12:15], s22 offen lds
    s_add_u32 m0, s23, 2048
    s_nop 0
    buffer_load_dwordx4 v34, s[12:15], s22 offen lds
    s_add_u32 m0, s23, 3072
    s_nop 0
    buffer_load_dwordx4 v35, s[12:15], s22 offen lds
    s_add_u32 m0, s24, 0
    s_nop 0
    buffer_load_dwordx4 v36, s[28:31], s22 offen lds
    s_add_u32 m0, s24, 1024
    s_nop 0
    buffer_load_dwordx4 v37, s[28:31], s22 offen lds
    s_add_u32 s22, s22, 524288
    s_waitcnt vmcnt(6)
    s_barrier
    s_cmp_lg_u32 s3, 0
    s_cbranch_scc1 Ia_21
    v_mov_b32 v61, s101
    s_lshl_b32 s21, s2, 2
    s_add_u32 s21, s21, 112198656
    s_mov_b64 exec, 1
    buffer_store_dword v61, off, s[8:11], s21 sc1
    s_mov_b64 exec, -1
Ia_21:
    s_add_u32 m0, s23, 24576
    s_nop 0
    buffer_load_dwordx4 v32, s[12:15], s22 offen lds
    s_add_u32 m0, s23, 25600
    s_nop 0
    buffer_load_dwordx4 v33, s[12:15], s22 offen lds
    s_add_u32 m0, s23, 26624
    s_nop 0
    buffer_load_dwordx4 v34, s[12:15], s22 offen lds
    s_add_u32 m0, s23, 27648
    s_nop 0
    buffer_load_dwordx4 v35, s[12:15], s22 offen lds
    s_add_u32 m0, s24, 24576
    s_nop 0
    buffer_load_dwordx4 v36, s[28:31], s22 offen lds
    s_add_u32 m0, s24, 25600
    s_nop 0
    buffer_load_dwordx4 v37, s[28:31], s22 offen lds
    s_add_u32 s22, s22, 524288
    s_add_u32 m0, s23, 49152
    s_nop 0
    buffer_load_dwordx4 v32, s[12:15], s22 offen lds
    s_add_u32 m0, s23, 50176
    s_nop 0
    buffer_load_dwordx4 v33, s[12:15], s22 offen lds
    s_add_u32 m0, s23, 51200
    s_nop 0
    buffer_load_dwordx4 v34, s[12:15], s22 offen lds
    s_add_u32 m0, s23, 52224
    s_nop 0
    buffer_load_dwordx4 v35, s[12:15], s22 offen lds
    s_add_u32 m0, s24, 49152
    s_nop 0
    buffer_load_dwordx4 v36, s[28:31], s22 offen lds
    s_add_u32 m0, s24, 50176
    s_nop 0
    buffer_load_dwordx4 v37, s[28:31], s22 offen lds
    s_add_u32 s22, s22, 524288
    s_add_u32 m0, s23, 73728
    s_nop 0
    buffer_load_dwordx4 v32, s[12:15], s22 offen lds
    s_add_u32 m0, s23, 74752
    s_nop 0
    buffer_load_dwordx4 v33, s[12:15], s22 offen lds
    s_add_u32 m0, s23, 75776
    s_nop 0
    buffer_load_dwordx4 v34, s[12:15], s22 offen lds
    s_add_u32 m0, s23, 76800
    s_nop 0
    buffer_load_dwordx4 v35, s[12:15], s22 offen lds
    s_add_u32 m0, s24, 73728
    s_nop 0
    buffer_load_dwordx4 v36, s[28:31], s22 offen lds
    s_add_u32 m0, s24, 74752
    s_nop 0
    buffer_load_dwordx4 v37, s[28:31], s22 offen lds
    s_add_u32 s22, s22, 524288
    s_add_u32 m0, s23, 98304
    s_nop 0
    buffer_load_dwordx4 v32, s[12:15], s22 offen lds
    s_add_u32 m0, s23, 99328
    s_nop 0
    buffer_load_dwordx4 v33, s[12:15], s22 offen lds
    s_add_u32 m0, s23, 100352
    s_nop 0
    buffer_load_dwordx4 v34, s[12:15], s22 offen lds
    s_add_u32 m0, s23, 101376
    s_nop 0
    buffer_load_dwordx4 v35, s[12:15], s22 offen lds
    s_add_u32 m0, s24, 98304
    s_nop 0
    buffer_load_dwordx4 v36, s[28:31], s22 offen lds
    s_add_u32 m0, s24, 99328
    s_nop 0
    buffer_load_dwordx4 v37, s[28:31], s22 offen lds
    s_add_u32 s22, s22, 524288
    s_lshl_b32 s25, s26, 8
    s_add_u32 s25, s25, 128
    s_lshl_b32 s27, s3, 11
    s_add_u32 m0, s23, 122880
    s_nop 0
    buffer_load_dwordx4 v32, s[12:15], s22 offen lds
    s_add_u32 m0, s23, 123904
    s_nop 0
    buffer_load_dwordx4 v33, s[12:15], s22 offen lds
    s_add_u32 m0, s23, 124928
    s_nop 0
    buffer_load_dwordx4 v34, s[12:15], s22 offen lds
    s_add_u32 m0, s23, 125952
    s_nop 0
    buffer_load_dwordx4 v35, s[12:15], s22 offen lds
    s_add_u32 m0, s24, 122880
    s_nop 0
    buffer_load_dwordx4 v36, s[28:31], s22 offen lds
    s_add_u32 m0, s24, 123904
    s_nop 0
    buffer_load_dwordx4 v37, s[28:31], s22 offen lds
    s_add_u32 s22, s22, 524288
    s_waitcnt vmcnt(30)
    s_barrier
    v_add_u32 v41, 0, v39
    v_add_u32 v42, 0, v40
    v_add_u32 v43, 16384, v6
    ds_read_b64_tr_b16 a[0:1], v41 offset:0
    ds_read_b64_tr_b16 a[8:9], v42 offset:0
    ds_read_b64_tr_b16 v[128:129], v43 offset:0
    ds_read_b64_tr_b16 a[2:3], v41 offset:1024
    ds_read_b64_tr_b16 a[10:11], v42 offset:1024
    ds_read_b64_tr_b16 v[130:131], v43 offset:512
    ds_read_b64_tr_b16 a[4:5], v41 offset:8192
    ds_read_b64_tr_b16 a[12:13], v42 offset:8192
    ds_read_b64_tr_b16 v[132:133], v43 offset:4096
    ds_read_b64_tr_b16 a[6:7], v41 offset:9216
    ds_read_b64_tr_b16 a[14:15], v42 offset:9216
    ds_read_b64_tr_b16 v[134:135], v43 offset:4608
    s_waitcnt lgkmcnt(0)
    s_barrier
    s_add_u32 m0, s23, 0
    s_nop 0
    buffer_load_dwordx4 v32, s[12:15], s22 offen lds
    s_add_u32 m0, s23, 1024
    s_nop 0
    buffer_load_dwordx4 v33, s[12:15], s22 offen lds
    s_add_u32 m0, s23, 2048
    s_nop 0
    buffer_load_dwordx4 v34, s[12:15], s22 offen lds
    s_add_u32 m0, s23, 3072
    s_nop 0
    buffer_load_dwordx4 v35, s[12:15], s22 offen lds
    s_add_u32 m0, s24, 0
    s_nop 0
    buffer_load_dwordx4 v36, s[28:31], s22 offen lds
    s_add_u32 m0, s24, 1024
    s_nop 0
    buffer_load_dwordx4 v37, s[28:31], s22 offen lds
    s_add_u32 s22, s22, 524288
    s_waitcnt vmcnt(30)
    s_barrier
    v_add_u32 v41, 24576, v39
    v_add_u32 v42, 24576, v40
    v_add_u32 v43, 40960, v6
    ds_read_b64_tr_b16 a[16:17], v41 offset:0
    ds_read_b64_tr_b16 a[24:25], v42 offset:0
    ds_read_b64_tr_b16 v[136:137], v43 offset:0
    ds_read_b64_tr_b16 a[18:19], v41 offset:1024
    ds_read_b64_tr_b16 a[26:27], v42 offset:1024
    ds_read_b64_tr_b16 v[138:139], v43 offset:512
    ds_read_b64_tr_b16 a[20:21], v41 offset:8192
    ds_read_b64_tr_b16 a[28:29], v42 offset:8192
    ds_read_b64_tr_b16 v[140:141], v43 offset:4096
    ds_read_b64_tr_b16 a[22:23], v41 offset:9216
    ds_read_b64_tr_b16 a[30:31], v42 offset:9216
    ds_read_b64_tr_b16 v[142:143], v43 offset:4608
    s_waitcnt lgkmcnt(0)
    s_barrier
    s_add_u32 m0, s23, 24576
    s_nop 0
    buffer_load_dwordx4 v32, s[12:15], s22 offen lds
    s_add_u32 m0, s23, 25600
    s_nop 0
    buffer_load_dwordx4 v33, s[12:15], s22 offen lds
    s_add_u32 m0, s23, 26624
    s_nop 0
    buffer_load_dwordx4 v34, s[12:15], s22 offen lds
    s_add_u32 m0, s23, 27648
    s_nop 0
    buffer_load_dwordx4 v35, s[12:15], s22 offen lds
    s_add_u32 m0, s24, 24576
    s_nop 0
    buffer_load_dwordx4 v36, s[28:31], s22 offen lds
    s_add_u32 m0, s24, 25600
    s_nop 0
    buffer_load_dwordx4 v37, s[28:31], s22 offen lds
    s_add_u32 s22, s22, 524288
    s_waitcnt vmcnt(30)
    s_barrier
    v_add_u32 v41, 49152, v39
    v_add_u32 v42, 49152, v40
    v_add_u32 v43, 65536, v6
    ds_read_b64_tr_b16 a[32:33], v41 offset:0
    ds_read_b64_tr_b16 a[40:41], v42 offset:0
    ds_read_b64_tr_b16 v[144:145], v43 offset:0
    ds_read_b64_tr_b16 a[34:35], v41 offset:1024
    ds_read_b64_tr_b16 a[42:43], v42 offset:1024
    ds_read_b64_tr_b16 v[146:147], v43 offset:512
    ds_read_b64_tr_b16 a[36:37], v41 offset:8192
    ds_read_b64_tr_b16 a[44:45], v42 offset:8192
    ds_read_b64_tr_b16 v[148:149], v43 offset:4096
    ds_read_b64_tr_b16 a[38:39], v41 offset:9216
    ds_read_b64_tr_b16 a[46:47], v42 offset:9216
    ds_read_b64_tr_b16 v[150:151], v43 offset:4608
    s_waitcnt lgkmcnt(0)
    s_barrier
    s_add_u32 m0, s23, 49152
    s_nop 0
    buffer_load_dwordx4 v32, s[12:15], s22 offen lds
    s_add_u32 m0, s23, 50176
    s_nop 0
    buffer_load_dwordx4 v33, s[12:15], s22 offen lds
    s_add_u32 m0, s23, 51200
    s_nop 0
    buffer_load_dwordx4 v34, s[12:15], s22 offen lds
    s_add_u32 m0, s23, 52224
    s_nop 0
    buffer_load_dwordx4 v35, s[12:15], s22 offen lds
    s_add_u32 m0, s24, 49152
    s_nop 0
    buffer_load_dwordx4 v36, s[28:31], s22 offen lds
    s_add_u32 m0, s24, 50176
    s_nop 0
    buffer_load_dwordx4 v37, s[28:31], s22 offen lds
    s_add_u32 s22, s22, 524288
    s_waitcnt vmcnt(30)
    s_barrier
    v_add_u32 v41, 73728, v39
    v_add_u32 v42, 73728, v40
    v_add_u32 v43, 90112, v6
    ds_read_b64_tr_b16 a[48:49], v41 offset:0
    ds_read_b64_tr_b16 a[56:57], v42 offset:0
    ds_read_b64_tr_b16 v[152:153], v43 offset:0
    ds_read_b64_tr_b16 a[50:51], v41 offset:1024
    ds_read_b64_tr_b16 a[58:59], v42 offset:1024
    ds_read_b64_tr_b16 v[154:155], v43 offset:512
    ds_read_b64_tr_b16 a[52:53], v41 offset:8192
    ds_read_b64_tr_b16 a[60:61], v42 offset:8192
    ds_read_b64_tr_b16 v[156:157], v43 offset:4096
    ds_read_b64_tr_b16 a[54:55], v41 offset:9216
    ds_read_b64_tr_b16 a[62:63], v42 offset:9216
    ds_read_b64_tr_b16 v[158:159], v43 offset:4608
    s_waitcnt lgkmcnt(0)
    s_barrier
    s_add_u32 m0, s23, 73728
    s_nop 0
    buffer_load_dwordx4 v32, s[12:15], s22 offen lds
    s_add_u32 m0, s23, 74752
    s_nop 0
    buffer_load_dwordx4 v33, s[12:15], s22 offen lds
    s_add_u32 m0, s23, 75776
    s_nop 0
    buffer_load_dwordx4 v34, s[12:15], s22 offen lds
    s_add_u32 m0, s23, 76800
    s_nop 0
    buffer_load_dwordx4 v35, s[12:15], s22 offen lds
    s_add_u32 m0, s24, 73728
    s_nop 0
    buffer_load_dwordx4 v36, s[28:31], s22 offen lds
    s_add_u32 m0, s24, 74752
    s_nop 0
    buffer_load_dwordx4 v37, s[28:31], s22 offen lds
    s_add_u32 s22, s22, 524288
    s_waitcnt vmcnt(30)
    s_barrier
    v_add_u32 v41, 98304, v39
    v_add_u32 v42, 98304, v40
    v_add_u32 v43, 114688, v6
    ds_read_b64_tr_b16 a[64:65], v41 offset:0
    ds_read_b64_tr_b16 a[72:73], v42 offset:0
    ds_read_b64_tr_b16 v[160:161], v43 offset:0
    ds_read_b64_tr_b16 a[66:67], v41 offset:1024
    ds_read_b64_tr_b16 a[74:75], v42 offset:1024
    ds_read_b64_tr_b16 v[162:163], v43 offset:512
    ds_read_b64_tr_b16 a[68:69], v41 offset:8192
    ds_read_b64_tr_b16 a[76:77], v42 offset:8192
    ds_read_b64_tr_b16 v[164:165], v43 offset:4096
    ds_read_b64_tr_b16 a[70:71], v41 offset:9216
    ds_read_b64_tr_b16 a[78:79], v42 offset:9216
    ds_read_b64_tr_b16 v[166:167], v43 offset:4608
    s_waitcnt lgkmcnt(0)
    s_barrier
    s_add_u32 m0, s23, 98304
    s_nop 0
    buffer_load_dwordx4 v32, s[12:15], s22 offen lds
    s_add_u32 m0, s23, 99328
    s_nop 0
    buffer_load_dwordx4 v33, s[12:15], s22 offen lds
    s_add_u32 m0, s23, 100352
    s_nop 0
    buffer_load_dwordx4 v34, s[12:15], s22 offen lds
    s_add_u32 m0, s23, 101376
    s_nop 0
    buffer_load_dwordx4 v35, s[12:15], s22 offen lds
    s_add_u32 m0, s24, 98304
    s_nop 0
    buffer_load_dwordx4 v36, s[28:31], s22 offen lds
    s_add_u32 m0, s24, 99328
    s_nop 0
    buffer_load_dwordx4 v37, s[28:31], s22 offen lds
    s_add_u32 s22, s22, 524288
    s_waitcnt vmcnt(30)
    s_barrier
    v_add_u32 v41, 122880, v39
    v_add_u32 v42, 122880, v40
    v_add_u32 v43, 139264, v6
    ds_read_b64_tr_b16 a[80:81], v41 offset:0
    ds_read_b64_tr_b16 a[88:89], v42 offset:0
    ds_read_b64_tr_b16 v[168:169], v43 offset:0
    ds_read_b64_tr_b16 a[82:83], v41 offset:1024
    ds_read_b64_tr_b16 a[90:91], v42 offset:1024
    ds_read_b64_tr_b16 v[170:171], v43 offset:512
    ds_read_b64_tr_b16 a[84:85], v41 offset:8192
    ds_read_b64_tr_b16 a[92:93], v42 offset:8192
    ds_read_b64_tr_b16 v[172:173], v43 offset:4096
    ds_read_b64_tr_b16 a[86:87], v41 offset:9216
    ds_read_b64_tr_b16 a[94:95], v42 offset:9216
    ds_read_b64_tr_b16 v[174:175], v43 offset:4608
    s_waitcnt lgkmcnt(0)
    s_barrier
    s_add_u32 m0, s23, 122880
    s_nop 0
    buffer_load_dwordx4 v32, s[12:15], s22 offen lds
    s_add_u32 m0, s23, 123904
    s_nop 0
    buffer_load_dwordx4 v33, s[12:15], s22 offen lds
    s_add_u32 m0, s23, 124928
    s_nop 0
    buffer_load_dwordx4 v34, s[12:15], s22 offen lds
    s_add_u32 m0, s23, 125952
    s_nop 0
    buffer_load_dwordx4 v35, s[12:15], s22 offen lds
    s_add_u32 m0, s24, 122880
    s_nop 0
    buffer_load_dwordx4 v36, s[28:31], s22 offen lds
    s_add_u32 m0, s24, 123904
    s_nop 0
    buffer_load_dwordx4 v37, s[28:31], s22 offen lds
    s_add_u32 s22, s22, 524288
    s_waitcnt vmcnt(30)
    s_barrier
    v_add_u32 v41, 0, v39
    v_add_u32 v42, 0, v40
    v_add_u32 v43, 16384, v6
    ds_read_b64_tr_b16 a[96:97], v41 offset:0
    ds_read_b64_tr_b16 a[104:105], v42 offset:0
    ds_read_b64_tr_b16 v[176:177], v43 offset:0
    ds_read_b64_tr_b16 a[98:99], v41 offset:1024
    ds_read_b64_tr_b16 a[106:107], v42 offset:1024
    ds_read_b64_tr_b16 v[178:179], v43 offset:512
    ds_read_b64_tr_b16 a[100:101], v41 offset:8192
    ds_read_b64_tr_b16 a[108:109], v42 offset:8192
    ds_read_b64_tr_b16 v[180:181], v43 offset:4096
    ds_read_b64_tr_b16 a[102:103], v41 offset:9216
    ds_read_b64_tr_b16 a[110:111], v42 offset:9216
    ds_read_b64_tr_b16 v[182:183], v43 offset:4608
    s_waitcnt lgkmcnt(0)
    s_barrier
    s_add_u32 m0, s23, 0
    s_nop 0
    buffer_load_dwordx4 v32, s[12:15], s22 offen lds
    s_add_u32 m0, s23, 1024
    s_nop 0
    buffer_load_dwordx4 v33, s[12:15], s22 offen lds
    s_add_u32 m0, s23, 2048
    s_nop 0
    buffer_load_dwordx4 v34, s[12:15], s22 offen lds
    s_add_u32 m0, s23, 3072
    s_nop 0
    buffer_load_dwordx4 v35, s[12:15], s22 offen lds
    s_add_u32 m0, s24, 0
    s_nop 0
    buffer_load_dwordx4 v36, s[28:31], s22 offen lds
    s_add_u32 m0, s24, 1024
    s_nop 0
    buffer_load_dwordx4 v37, s[28:31], s22 offen lds
    s_add_u32 s22, s22, 524288
    s_waitcnt vmcnt(30)
    s_barrier
    v_add_u32 v41, 24576, v39
    v_add_u32 v42, 24576, v40
    v_add_u32 v43, 40960, v6
    ds_read_b64_tr_b16 a[112:113], v41 offset:0
    ds_read_b64_tr_b16 a[120:121], v42 offset:0
    ds_read_b64_tr_b16 v[184:185], v43 offset:0
    ds_read_b64_tr_b16 a[114:115], v41 offset:1024
    ds_read_b64_tr_b16 a[122:123], v42 offset:1024
    ds_read_b64_tr_b16 v[186:187], v43 offset:512
    ds_read_b64_tr_b16 a[116:117], v41 offset:8192
    ds_read_b64_tr_b16 a[124:125], v42 offset:8192
    ds_read_b64_tr_b16 v[188:189], v43 offset:4096
    ds_read_b64_tr_b16 a[118:119], v41 offset:9216
    ds_read_b64_tr_b16 a[126:127], v42 offset:9216
    ds_read_b64_tr_b16 v[190:191], v43 offset:4608
    s_waitcnt lgkmcnt(0)
    s_barrier
    s_add_u32 m0, s23, 24576
    s_nop 0
    buffer_load_dwordx4 v32, s[12:15], s22 offen lds
    s_add_u32 m0, s23, 25600
    s_nop 0
    buffer_load_dwordx4 v33, s[12:15], s22 offen lds
    s_add_u32 m0, s23, 26624
    s_nop 0
    buffer_load_dwordx4 v34, s[12:15], s22 offen lds
    s_add_u32 m0, s23, 27648
    s_nop 0
    buffer_load_dwordx4 v35, s[12:15], s22 offen lds
    s_add_u32 m0, s24, 24576
    s_nop 0
    buffer_load_dwordx4 v36, s[28:31], s22 offen lds
    s_add_u32 m0, s24, 25600
    s_nop 0
    buffer_load_dwordx4 v37, s[28:31], s22 offen lds
    s_add_u32 s22, s22, 524288
    s_waitcnt vmcnt(30)
    s_barrier
    v_add_u32 v41, 49152, v39
    v_add_u32 v42, 49152, v40
    v_add_u32 v43, 65536, v6
    ds_read_b64_tr_b16 a[128:129], v41 offset:0
    ds_read_b64_tr_b16 a[136:137], v42 offset:0
    ds_read_b64_tr_b16 v[192:193], v43 offset:0
    ds_read_b64_tr_b16 a[130:131], v41 offset:1024
    ds_read_b64_tr_b16 a[138:139], v42 offset:1024
    ds_read_b64_tr_b16 v[194:195], v43 offset:512
    ds_read_b64_tr_b16 a[132:133], v41 offset:8192
    ds_read_b64_tr_b16 a[140:141], v42 offset:8192
    ds_read_b64_tr_b16 v[196:197], v43 offset:4096
    ds_read_b64_tr_b16 a[134:135], v41 offset:9216
    ds_read_b64_tr_b16 a[142:143], v42 offset:9216
    ds_read_b64_tr_b16 v[198:199], v43 offset:4608
    s_waitcnt lgkmcnt(0)
    s_barrier
    s_add_u32 m0, s23, 49152
    s_nop 0
    buffer_load_dwordx4 v32, s[12:15], s22 offen lds
    s_add_u32 m0, s23, 50176
    s_nop 0
    buffer_load_dwordx4 v33, s[12:15], s22 offen lds
    s_add_u32 m0, s23, 51200
    s_nop 0
    buffer_load_dwordx4 v34, s[12:15], s22 offen lds
    s_add_u32 m0, s23, 52224
    s_nop 0
    buffer_load_dwordx4 v35, s[12:15], s22 offen lds
    s_add_u32 m0, s24, 49152
    s_nop 0
    buffer_load_dwordx4 v36, s[28:31], s22 offen lds
    s_add_u32 m0, s24, 50176
    s_nop 0
    buffer_load_dwordx4 v37, s[28:31], s22 offen lds
    s_add_u32 s22, s22, 524288
    s_waitcnt vmcnt(30)
    s_barrier
    v_add_u32 v41, 73728, v39
    v_add_u32 v42, 73728, v40
    v_add_u32 v43, 90112, v6
    ds_read_b64_tr_b16 a[144:145], v41 offset:0
    ds_read_b64_tr_b16 a[152:153], v42 offset:0
    ds_read_b64_tr_b16 v[200:201], v43 offset:0
    ds_read_b64_tr_b16 a[146:147], v41 offset:1024
    ds_read_b64_tr_b16 a[154:155], v42 offset:1024
    ds_read_b64_tr_b16 v[202:203], v43 offset:512
    ds_read_b64_tr_b16 a[148:149], v41 offset:8192
    ds_read_b64_tr_b16 a[156:157], v42 offset:8192
    ds_read_b64_tr_b16 v[204:205], v43 offset:4096
    ds_read_b64_tr_b16 a[150:151], v41 offset:9216
    ds_read_b64_tr_b16 a[158:159], v42 offset:9216
    ds_read_b64_tr_b16 v[206:207], v43 offset:4608
    s_waitcnt lgkmcnt(0)
    s_barrier
    s_add_u32 m0, s23, 73728
    s_nop 0
    buffer_load_dwordx4 v32, s[12:15], s22 offen lds
    s_add_u32 m0, s23, 74752
    s_nop 0
    buffer_load_dwordx4 v33, s[12:15], s22 offen lds
    s_add_u32 m0, s23, 75776
    s_nop 0
    buffer_load_dwordx4 v34, s[12:15], s22 offen lds
    s_add_u32 m0, s23, 76800
    s_nop 0
    buffer_load_dwordx4 v35, s[12:15], s22 offen lds
    s_add_u32 m0, s24, 73728
    s_nop 0
    buffer_load_dwordx4 v36, s[28:31], s22 offen lds
    s_add_u32 m0, s24, 74752
    s_nop 0
    buffer_load_dwordx4 v37, s[28:31], s22 offen lds
    s_add_u32 s22, s22, 524288
    s_waitcnt vmcnt(30)
    s_barrier
    v_add_u32 v41, 98304, v39
    v_add_u32 v42, 98304, v40
    v_add_u32 v43, 114688, v6
    ds_read_b64_tr_b16 a[160:161], v41 offset:0
    ds_read_b64_tr_b16 a[168:169], v42 offset:0
    ds_read_b64_tr_b16 v[208:209], v43 offset:0
    ds_read_b64_tr_b16 a[162:163], v41 offset:1024
    ds_read_b64_tr_b16 a[170:171], v42 offset:1024
    ds_read_b64_tr_b16 v[210:211], v43 offset:512
    ds_read_b64_tr_b16 a[164:165], v41 offset:8192
    ds_read_b64_tr_b16 a[172:173], v42 offset:8192
    ds_read_b64_tr_b16 v[212:213], v43 offset:4096
    ds_read_b64_tr_b16 a[166:167], v41 offset:9216
    ds_read_b64_tr_b16 a[174:175], v42 offset:9216
    ds_read_b64_tr_b16 v[214:215], v43 offset:4608
    s_waitcnt lgkmcnt(0)
    s_barrier
    s_add_u32 s21, s25, 6291456
    s_add_u32 m0, s27, 98304
    s_nop 0
    buffer_load_dwordx4 v36, s[28:31], s21 offen lds
    s_add_u32 m0, s27, 99328
    s_nop 0
    buffer_load_dwordx4 v37, s[28:31], s21 offen lds
    s_add_u32 s21, s25, 6815744
    s_add_u32 m0, s27, 106496
    s_nop 0
    buffer_load_dwordx4 v36, s[28:31], s21 offen lds
    s_add_u32 m0, s27, 107520
    s_nop 0
    buffer_load_dwordx4 v37, s[28:31], s21 offen lds
    s_add_u32 s21, s25, 7340032
    s_add_u32 m0, s27, 114688
    s_nop 0
    buffer_load_dwordx4 v36, s[28:31], s21 offen lds
    s_add_u32 m0, s27, 115712
    s_nop 0
    buffer_load_dwordx4 v37, s[28:31], s21 offen lds
    s_waitcnt vmcnt(30)
    s_barrier
    v_add_u32 v41, 122880, v39
    v_add_u32 v42, 122880, v40
    v_add_u32 v43, 139264, v6
    ds_read_b64_tr_b16 a[176:177], v41 offset:0
    ds_read_b64_tr_b16 a[184:185], v42 offset:0
    ds_read_b64_tr_b16 v[216:217], v43 offset:0
    ds_read_b64_tr_b16 a[178:179], v41 offset:1024
    ds_read_b64_tr_b16 a[186:187], v42 offset:1024
    ds_read_b64_tr_b16 v[218:219], v43 offset:512
    ds_read_b64_tr_b16 a[180:181], v41 offset:8192
    ds_read_b64_tr_b16 a[188:189], v42 offset:8192
    ds_read_b64_tr_b16 v[220:221], v43 offset:4096
    ds_read_b64_tr_b16 a[182:183], v41 offset:9216
    ds_read_b64_tr_b16 a[190:191], v42 offset:9216
    ds_read_b64_tr_b16 v[222:223], v43 offset:4608
    s_waitcnt lgkmcnt(0)
    s_barrier
    s_add_u32 s21, s25, 7864320
    s_add_u32 m0, s27, 122880
    s_nop 0
    buffer_load_dwordx4 v36, s[28:31], s21 offen lds
    s_add_u32 m0, s27, 123904
    s_nop 0
    buffer_load_dwordx4 v37, s[28:31], s21 offen lds
    s_waitcnt vmcnt(26)
    s_barrier
    v_add_u32 v41, 0, v39
    v_add_u32 v42, 0, v40
    v_add_u32 v43, 16384, v6
    ds_read_b64_tr_b16 a[192:193], v41 offset:0
    ds_read_b64_tr_b16 a[200:201], v42 offset:0
    ds_read_b64_tr_b16 v[224:225], v43 offset:0
    ds_read_b64_tr_b16 a[194:195], v41 offset:1024
    ds_read_b64_tr_b16 a[202:203], v42 offset:1024
    ds_read_b64_tr_b16 v[226:227], v43 offset:512
    ds_read_b64_tr_b16 a[196:197], v41 offset:8192
    ds_read_b64_tr_b16 a[204:205], v42 offset:8192
    ds_read_b64_tr_b16 v[228:229], v43 offset:4096
    ds_read_b64_tr_b16 a[198:199], v41 offset:9216
    ds_read_b64_tr_b16 a[206:207], v42 offset:9216
    ds_read_b64_tr_b16 v[230:231], v43 offset:4608
    s_waitcnt lgkmcnt(0)
    s_barrier
    s_add_u32 s21, s25, 0
    s_add_u32 m0, s27, 0
    s_nop 0
    buffer_load_dwordx4 v36, s[28:31], s21 offen lds
    s_add_u32 m0, s27, 1024
    s_nop 0
    buffer_load_dwordx4 v37, s[28:31], s21 offen lds
    s_add_u32 s21, s25, 524288
    s_add_u32 m0, s27, 8192
    s_nop 0
    buffer_load_dwordx4 v36, s[28:31], s21 offen lds
    s_add_u32 m0, s27, 9216
    s_nop 0
    buffer_load_dwordx4 v37, s[28:31], s21 offen lds
    s_add_u32 s21, s25, 1048576
    s_add_u32 m0, s27, 16384
    s_nop 0
    buffer_load_dwordx4 v36, s[28:31], s21 offen lds
    s_add_u32 m0, s27, 17408
    s_nop 0
    buffer_load_dwordx4 v37, s[28:31], s21 offen lds
    s_waitcnt vmcnt(26)
    s_barrier
    v_add_u32 v41, 24576, v39
    v_add_u32 v42, 24576, v40
    v_add_u32 v43, 40960, v6
    ds_read_b64_tr_b16 a[208:209], v41 offset:0
    ds_read_b64_tr_b16 a[216:217], v42 offset:0
    ds_read_b64_tr_b16 v[232:233], v43 offset:0
    ds_read_b64_tr_b16 a[210:211], v41 offset:1024
    ds_read_b64_tr_b16 a[218:219], v42 offset:1024
    ds_read_b64_tr_b16 v[234:235], v43 offset:512
    ds_read_b64_tr_b16 a[212:213], v41 offset:8192
    ds_read_b64_tr_b16 a[220:221], v42 offset:8192
    ds_read_b64_tr_b16 v[236:237], v43 offset:4096
    ds_read_b64_tr_b16 a[214:215], v41 offset:9216
    ds_read_b64_tr_b16 a[222:223], v42 offset:9216
    ds_read_b64_tr_b16 v[238:239], v43 offset:4608
    s_waitcnt lgkmcnt(0)
    s_barrier
    s_add_u32 s21, s25, 1572864
    s_add_u32 m0, s27, 24576
    s_nop 0
    buffer_load_dwordx4 v36, s[28:31], s21 offen lds
    s_add_u32 m0, s27, 25600
    s_nop 0
    buffer_load_dwordx4 v37, s[28:31], s21 offen lds
    s_add_u32 s21, s25, 2097152
    s_add_u32 m0, s27, 32768
    s_nop 0
    buffer_load_dwordx4 v36, s[28:31], s21 offen lds
    s_add_u32 m0, s27, 33792
    s_nop 0
    buffer_load_dwordx4 v37, s[28:31], s21 offen lds
    s_add_u32 s21, s25, 2621440
    s_add_u32 m0, s27, 40960
    s_nop 0
    buffer_load_dwordx4 v36, s[28:31], s21 offen lds
    s_add_u32 m0, s27, 41984
    s_nop 0
    buffer_load_dwordx4 v37, s[28:31], s21 offen lds
    s_waitcnt vmcnt(26)
    s_barrier
    v_add_u32 v41, 49152, v39
    v_add_u32 v42, 49152, v40
    v_add_u32 v43, 65536, v6
    ds_read_b64_tr_b16 a[224:225], v41 offset:0
    ds_read_b64_tr_b16 a[232:233], v42 offset:0
    ds_read_b64_tr_b16 v[240:241], v43 offset:0
    ds_read_b64_tr_b16 a[226:227], v41 offset:1024
    ds_read_b64_tr_b16 a[234:235], v42 offset:1024
    ds_read_b64_tr_b16 v[242:243], v43 offset:512
    ds_read_b64_tr_b16 a[228:229], v41 offset:8192
    ds_read_b64_tr_b16 a[236:237], v42 offset:8192
    ds_read_b64_tr_b16 v[244:245], v43 offset:4096
    ds_read_b64_tr_b16 a[230:231], v41 offset:9216
    ds_read_b64_tr_b16 a[238:239], v42 offset:9216
    ds_read_b64_tr_b16 v[246:247], v43 offset:4608
    s_waitcnt lgkmcnt(0)
    s_barrier
    s_add_u32 s21, s25, 3145728
    s_add_u32 m0, s27, 49152
    s_nop 0
    buffer_load_dwordx4 v36, s[28:31], s21 offen lds
    s_add_u32 m0, s27, 50176
    s_nop 0
    buffer_load_dwordx4 v37, s[28:31], s21 offen lds
    s_add_u32 s21, s25, 3670016
    s_add_u32 m0, s27, 57344
    s_nop 0
    buffer_load_dwordx4 v36, s[28:31], s21 offen lds
    s_add_u32 m0, s27, 58368
    s_nop 0
    buffer_load_dwordx4 v37, s[28:31], s21 offen lds
    s_add_u32 s21, s25, 4194304
    s_add_u32 m0, s27, 65536
    s_nop 0
    buffer_load_dwordx4 v36, s[28:31], s21 offen lds
    s_add_u32 m0, s27, 66560
    s_nop 0
    buffer_load_dwordx4 v37, s[28:31], s21 offen lds
    s_waitcnt vmcnt(26)
    s_barrier
    v_add_u32 v41, 73728, v39
    v_add_u32 v42, 73728, v40
    v_add_u32 v43, 90112, v6
    ds_read_b64_tr_b16 a[240:241], v41 offset:0
    ds_read_b64_tr_b16 a[248:249], v42 offset:0
    ds_read_b64_tr_b16 v[248:249], v43 offset:0
    ds_read_b64_tr_b16 a[242:243], v41 offset:1024
    ds_read_b64_tr_b16 a[250:251], v42 offset:1024
    ds_read_b64_tr_b16 v[250:251], v43 offset:512
    ds_read_b64_tr_b16 a[244:245], v41 offset:8192
    ds_read_b64_tr_b16 a[252:253], v42 offset:8192
    ds_read_b64_tr_b16 v[252:253], v43 offset:4096
    ds_read_b64_tr_b16 a[246:247], v41 offset:9216
    ds_read_b64_tr_b16 a[254:255], v42 offset:9216
    ds_read_b64_tr_b16 v[254:255], v43 offset:4608
    s_waitcnt lgkmcnt(0)
    s_barrier
    v_lshlrev_b32 v2, 4, v1
    s_add_u32 s21, s25, 4718592
    s_add_u32 m0, s27, 73728
    s_nop 0
    buffer_load_dwordx4 v36, s[28:31], s21 offen lds
    s_add_u32 m0, s27, 74752
    s_nop 0
    buffer_load_dwordx4 v37, s[28:31], s21 offen lds
    s_add_u32 s21, s25, 5242880
    s_add_u32 m0, s27, 81920
    s_nop 0
    buffer_load_dwordx4 v36, s[28:31], s21 offen lds
    s_add_u32 m0, s27, 82944
    s_nop 0
    buffer_load_dwordx4 v37, s[28:31], s21 offen lds
    s_add_u32 s21, s25, 5767168
    s_add_u32 m0, s27, 90112
    s_nop 0
    buffer_load_dwordx4 v36, s[28:31], s21 offen lds
    s_add_u32 m0, s27, 91136
    s_nop 0
    buffer_load_dwordx4 v37, s[28:31], s21 offen lds
    s_lshl_b32 s24, s3, 11
    v_lshlrev_b32 v2, 4, v1
    v_add_u32 v15, s24, v2
    s_waitcnt vmcnt(0)
    s_barrier
    ds_read_b64_tr_b16 v[32:33], v6 offset:0
    ds_read_b64_tr_b16 v[34:35], v6 offset:512
    ds_read_b64_tr_b16 v[36:37], v6 offset:4096
    ds_read_b64_tr_b16 v[38:39], v6 offset:4608
    ds_read_b64_tr_b16 v[40:41], v6 offset:8192
    ds_read_b64_tr_b16 v[42:43], v6 offset:8704
    ds_read_b64_tr_b16 v[44:45], v6 offset:12288
    ds_read_b64_tr_b16 v[46:47], v6 offset:12800
    ds_read_b64_tr_b16 v[48:49], v6 offset:16384
    ds_read_b64_tr_b16 v[50:51], v6 offset:16896
    ds_read_b64_tr_b16 v[52:53], v6 offset:20480
    ds_read_b64_tr_b16 v[54:55], v6 offset:20992
    ds_read_b64_tr_b16 v[56:57], v6 offset:24576
    ds_read_b64_tr_b16 v[58:59], v6 offset:25088
    ds_read_b64_tr_b16 v[60:61], v6 offset:28672
    ds_read_b64_tr_b16 v[62:63], v6 offset:29184
    ds_read_b64_tr_b16 v[64:65], v6 offset:32768
    ds_read_b64_tr_b16 v[66:67], v6 offset:33280
    ds_read_b64_tr_b16 v[68:69], v6 offset:36864
    ds_read_b64_tr_b16 v[70:71], v6 offset:37376
    ds_read_b64_tr_b16 v[72:73], v6 offset:40960
    ds_read_b64_tr_b16 v[74:75], v6 offset:41472
    ds_read_b64_tr_b16 v[76:77], v6 offset:45056
    ds_read_b64_tr_b16 v[78:79], v6 offset:45568
    ds_read_b64_tr_b16 v[80:81], v6 offset:49152
    ds_read_b64_tr_b16 v[82:83], v6 offset:49664
    ds_read_b64_tr_b16 v[84:85], v6 offset:53248
    ds_read_b64_tr_b16 v[86:87], v6 offset:53760
    ds_read_b64_tr_b16 v[88:89], v6 offset:57344
    ds_read_b64_tr_b16 v[90:91], v6 offset:57856
    ds_read_b64_tr_b16 v[92:93], v6 offset:61440
    ds_read_b64_tr_b16 v[94:95], v6 offset:61952
    s_waitcnt lgkmcnt(0)
    s_barrier
    ds_write_b128 v15, v[32:35] offset:0
    ds_write_b128 v15, v[36:39] offset:1024
    ds_write_b128 v15, v[40:43] offset:8192
    ds_write_b128 v15, v[44:47] offset:9216
    ds_write_b128 v15, v[48:51] offset:16384
    ds_write_b128 v15, v[52:55] offset:17408
    ds_write_b128 v15, v[56:59] offset:24576
    ds_write_b128 v15, v[60:63] offset:25600
    ds_write_b128 v15, v[64:67] offset:32768
    ds_write_b128 v15, v[68:71] offset:33792
    ds_write_b128 v15, v[72:75] offset:40960
    ds_write_b128 v15, v[76:79] offset:41984
    ds_write_b128 v15, v[80:83] offset:49152
    ds_write_b128 v15, v[84:87] offset:50176
    ds_write_b128 v15, v[88:91] offset:57344
    ds_write_b128 v15, v[92:95] offset:58368
    s_waitcnt lgkmcnt(0)
    v_add_u32 v15, 65536, v15
    ds_read_b64_tr_b16 v[32:33], v7 offset:0
    ds_read_b64_tr_b16 v[34:35], v7 offset:512
    ds_read_b64_tr_b16 v[36:37], v7 offset:4096
    ds_read_b64_tr_b16 v[38:39], v7 offset:4608
    ds_read_b64_tr_b16 v[40:41], v7 offset:8192
    ds_read_b64_tr_b16 v[42:43], v7 offset:8704
    ds_read_b64_tr_b16 v[44:45], v7 offset:12288
    ds_read_b64_tr_b16 v[46:47], v7 offset:12800
    ds_read_b64_tr_b16 v[48:49], v7 offset:16384
    ds_read_b64_tr_b16 v[50:51], v7 offset:16896
    ds_read_b64_tr_b16 v[52:53], v7 offset:20480
    ds_read_b64_tr_b16 v[54:55], v7 offset:20992
    ds_read_b64_tr_b16 v[56:57], v7 offset:24576
    ds_read_b64_tr_b16 v[58:59], v7 offset:25088
    ds_read_b64_tr_b16 v[60:61], v7 offset:28672
    ds_read_b64_tr_b16 v[62:63], v7 offset:29184
    ds_read_b64_tr_b16 v[64:65], v7 offset:32768
    ds_read_b64_tr_b16 v[66:67], v7 offset:33280
    ds_read_b64_tr_b16 v[68:69], v7 offset:36864
    ds_read_b64_tr_b16 v[70:71], v7 offset:37376
    ds_read_b64_tr_b16 v[72:73], v7 offset:40960
    ds_read_b64_tr_b16 v[74:75], v7 offset:41472
    ds_read_b64_tr_b16 v[76:77], v7 offset:45056
    ds_read_b64_tr_b16 v[78:79], v7 offset:45568
    ds_read_b64_tr_b16 v[80:81], v7 offset:49152
    ds_read_b64_tr_b16 v[82:83], v7 offset:49664
    ds_read_b64_tr_b16 v[84:85], v7 offset:53248
    ds_read_b64_tr_b16 v[86:87], v7 offset:53760
    ds_read_b64_tr_b16 v[88:89], v7 offset:57344
    ds_read_b64_tr_b16 v[90:91], v7 offset:57856
    ds_read_b64_tr_b16 v[92:93], v7 offset:61440
    ds_read_b64_tr_b16 v[94:95], v7 offset:61952
    s_waitcnt lgkmcnt(0)
    s_barrier
    ds_write_b128 v15, v[32:35] offset:0
    ds_write_b128 v15, v[36:39] offset:1024
    ds_write_b128 v15, v[40:43] offset:8192
    ds_write_b128 v15, v[44:47] offset:9216
    ds_write_b128 v15, v[48:51] offset:16384
    ds_write_b128 v15, v[52:55] offset:17408
    ds_write_b128 v15, v[56:59] offset:24576
    ds_write_b128 v15, v[60:63] offset:25600
    ds_write_b128 v15, v[64:67] offset:32768
    ds_write_b128 v15, v[68:71] offset:33792
    ds_write_b128 v15, v[72:75] offset:40960
    ds_write_b128 v15, v[76:79] offset:41984
    ds_write_b128 v15, v[80:83] offset:49152
    ds_write_b128 v15, v[84:87] offset:50176
    ds_write_b128 v15, v[88:91] offset:57344
    ds_write_b128 v15, v[92:95] offset:58368
    s_waitcnt lgkmcnt(0)
    v_mov_b32 v7, v15
    v_subrev_u32 v6, 65536, v15
    v_bfe_u32 v3, v1, 3, 1
    v_mov_b32 v15, 0x44444444
    v_mul_u32_u24 v3, 0xaaaa, v3
    v_lshl_or_b32 v3, v3, 16, v3
    v_add_u32 v3, v15, v3
    v_and_b32 v32, 15, v1
    v_bfe_u32 v33, v1, 4, 1
    v_lshlrev_b32 v33, 2, v33
    v_sub_u32 v32, v32, v33
    v_mov_b32 v33, 0x3f80
    v_mov_b32 v34, 0x3f800000
    v_cmp_eq_u32 vcc, 0, v32
    s_nop 1
    v_cndmask_b32 v24, 0, v33, vcc
    v_cmp_eq_u32 vcc, 1, v32
    s_nop 1
    v_cndmask_b32 v24, v24, v34, vcc
    v_cmp_eq_u32 vcc, 2, v32
    s_nop 1
    v_cndmask_b32 v25, 0, v33, vcc
    v_cmp_eq_u32 vcc, 3, v32
    s_nop 1
    v_cndmask_b32 v25, v25, v34, vcc
    v_cmp_eq_u32 vcc, 8, v32
    s_nop 1
    v_cndmask_b32 v26, 0, v33, vcc
    v_cmp_eq_u32 vcc, 9, v32
    s_nop 1
    v_cndmask_b32 v26, v26, v34, vcc
    v_cmp_eq_u32 vcc, 10, v32
    s_nop 1
    v_cndmask_b32 v27, 0, v33, vcc
    v_cmp_eq_u32 vcc, 11, v32
    s_nop 1
    v_cndmask_b32 v27, v27, v34, vcc
    s_lshl_b32 s20, s3, 8
    s_lshl_b32 s21, s3, 10
    v_add_u32 v8, s21, v2
    v_lshrrev_b32 v34, 4, v1
    v_and_b32 v33, 7, v1
    v_lshlrev_b32 v33, 4, v33
    v_lshl_add_u32 v12, v34, 7, v33
    s_lshl_b32 s21, s3, 9
    v_add_u32 v12, s21, v12
    v_and_b32 v33, 15, v1
    v_lshrrev_b32 v34, 4, v1
    v_lshlrev_b32 v10, 4, v33
    v_lshl_add_u32 v10, v34, 2, v10
    v_add_u32 v10, s20, v10
    v_lshlrev_b32 v11, 4, v33
    v_lshl_add_u32 v11, v34, 7, v11
    s_lshl_b32 s21, s3, 9
    s_lshl_b32 s22, s17, 11
    s_add_u32 s21, s21, s22
    v_add_u32 v11, s21, v11
    s_mul_i32 s21, s3, 3072
    s_add_u32 s21, s21, 131072
    v_add_u32 v13, s21, v2
    v_and_b32 v35, 7, v1
    v_bfe_u32 v36, v1, 3, 1
    v_lshl_add_u32 v37, v34, 4, v35
    v_lshlrev_b32 v37, 4, v37
    v_lshl_add_u32 v14, v36, 10, v37
    v_add_u32 v14, 131072, v14
    v_lshl_add_u32 v37, v34, 1, v36
    v_lshrrev_b32 v38, 2, v37
    v_add_u32 v38, 2, v38
    v_lshl_add_u32 v38, v38, 4, v35
    v_lshlrev_b32 v38, 4, v38
    v_and_b32 v37, 3, v37
    v_lshl_add_u32 v0, v37, 2, v38
    v_add_u32 v0, 133120, v0
    s_lshl_b32 s27, s3, 11
    v_add_u32 v1, s27, v2
    v_add_u32 v1, 143360, v1
    v_and_b32 v5, 0x30, v2
    v_lshlrev_b32 v5, 6, v5
    s_lshl_b32 s20, s3, 12
    v_add_u32 v5, s20, v5
    s_mov_b32 s34, 0x00ff00ff
    s_mov_b32 s35, 0x00ff00ff
    s_mov_b32 s36, 0xff00ff00
    s_mov_b32 s37, 0xff00ff00
    s_mov_b32 s38, 0x3e0293ee
    s_mov_b32 s19, 0
    v_mov_b32 v60, v14
    s_mov_b32 s20, s64
    s_and_b32 s21, s65, 0xffff
    s_mov_b32 s22, 256
    s_mov_b32 s23, 0x20000
    s_mov_b32 s30, 0
    s_mov_b32 s24, 192
Ip_22:
    buffer_load_dword v14, off, s[20:23], s24 sc1
    s_waitcnt vmcnt(0)
    v_cmp_ne_u32 vcc, s101, v14
    s_cbranch_vccz Ig_23
    s_sleep 4
    s_add_u32 s30, s30, 1
    s_cmp_lt_u32 s30, 65536
    s_cbranch_scc1 Ip_22
    s_branch L_abort
Ig_23:
    v_mov_b32 v14, v60
    s_cmp_lg_u32 s3, 0
    s_cbranch_scc1 Rd_24
    s_mov_b32 s20, 113253120
    v_mov_b32 v61, 1
    s_mov_b64 exec, 1
    buffer_atomic_add v61, off, s[8:11], s20 sc1
    s_mov_b64 exec, -1
Rd_24:
    s_and_b32 s20, s19, 7
    s_cbranch_scc1 Kw_25
Kc_27:
    s_lshr_b32 s20, s19, 3
    s_lshl_b32 s20, s20, 10
    s_lshr_b32 s21, s26, 1
    s_lshl_b32 s21, s21, 6
    s_add_u32 s20, s20, s21
    s_add_u32 s20, s20, 113262592
    s_mov_b32 s30, 0
    s_mov_b32 s21, 0xffff
    s_movk_i32 s22, 0x404
Kp_26:
    buffer_load_dword v15, off, s[8:11], s20 sc1
    s_waitcnt vmcnt(0)
    v_and_b32 v15, s21, v15
    v_cmp_ne_u32 vcc, s22, v15
    s_cbranch_vccz Kw_25
    s_sleep 4
    s_add_u32 s30, s30, 1
    s_cmp_lt_u32 s30, 65536
    s_cbranch_scc1 Kp_26
    s_branch L_abort
Kw_25:
    s_lshl_b32 s20, s19, 5
    s_add_u32 s20, s20, s26
    s_lshl_b32 s20, s20, 13
    s_add_u32 s21, s20, 38797312
    s_add_u32 s20, s20, 22020096
    s_add_u32 m0, s27, 143360
    s_nop 0
    buffer_load_dwordx4 v8, s[8:11], s20 offen sc1 lds
    s_add_u32 m0, s27, 151552
    s_nop 0
    buffer_load_dwordx4 v8, s[8:11], s21 offen sc1 lds
    s_add_u32 s20, s20, 4096
    s_add_u32 s21, s21, 4096
    s_add_u32 m0, s27, 144384
    s_nop 0
    buffer_load_dwordx4 v8, s[8:11], s20 offen sc1 lds
    s_add_u32 m0, s27, 152576
    s_nop 0
    buffer_load_dwordx4 v8, s[8:11], s21 offen sc1 lds
    s_waitcnt vmcnt(0)
    s_barrier
L_A_step:
    s_mov_b32 s30, 0
    s_mov_b32 s32, 0
    s_and_b32 s39, s19, 3
    s_lshl_b32 s39, s39, 16
    s_lshl_b32 s21, s16, 14
    s_add_u32 s25, s39, s21
    s_add_u32 s20, s25, 105906176
    s_add_u32 s21, s20, 4096
    s_add_u32 s22, s20, 8192
    s_add_u32 s23, s20, 12288
    v_mov_b32 v112, 0
    v_mov_b32 v113, 0
    v_mov_b32 v114, 0
    v_mov_b32 v115, 0
    v_mov_b32 v116, 0
    v_mov_b32 v117, 0
    v_mov_b32 v118, 0
    v_mov_b32 v119, 0
    v_mov_b32 v120, 0
    v_mov_b32 v121, 0
    v_mov_b32 v122, 0
    v_mov_b32 v123, 0
    v_mov_b32 v124, 0
    v_mov_b32 v125, 0
    v_mov_b32 v126, 0
    v_mov_b32 v127, 0
    s_lshr_b32 s28, s39, 1
    s_add_u32 s28, s28, 106692608
    s_lshl_b32 s68, s19, 5
    s_add_u32 s68, s68, s26
    s_lshl_b32 s68, s68, 13
    s_add_u32 s68, s68, 22282240
    s_cmp_eq_u32 s3, 1
    s_cbranch_scc1 L_A_w1
    s_cmp_eq_u32 s3, 2
    s_cbranch_scc1 L_A_w2
    s_cmp_eq_u32 s3, 3
    s_cbranch_scc1 L_A_w3
L_A_w0:
    ds_read_b128 v[96:99], v6 offset:0
    ds_read_b128 v[100:103], v6 offset:1024
    ds_read_b128 v[104:107], v6 offset:8192
    ds_read_b128 v[108:111], v6 offset:9216
    buffer_load_dword v28, v5, s[8:11], s20 offen sc1
    s_sleep 1
    buffer_load_dword v29, v5, s[8:11], s20 offen sc1
    s_sleep 1
    buffer_load_dword v30, v5, s[8:11], s20 offen sc1
L_A_poll0:
    s_waitcnt vmcnt(2)
    v_cmp_eq_u32 vcc, -1, v28
    s_cbranch_vccz L_A_pre0
    buffer_load_dword v28, v5, s[8:11], s20 offen sc1
    s_waitcnt vmcnt(2)
    v_cmp_eq_u32 vcc, -1, v29
    s_cbranch_vccz L_A_pre0
    buffer_load_dword v29, v5, s[8:11], s20 offen sc1
    s_waitcnt vmcnt(2)
    v_cmp_eq_u32 vcc, -1, v30
    s_cbranch_vccz L_A_pre0
    buffer_load_dword v30, v5, s[8:11], s20 offen sc1
    s_add_u32 s30, s30, 1
    s_cmp_lt_u32 s30, 65536
    s_cbranch_scc1 L_A_poll0
    s_branch L_abort
L_A_w1:
    ds_read_b128 v[96:99], v6 offset:32768
    ds_read_b128 v[100:103], v6 offset:33792
    ds_read_b128 v[104:107], v6 offset:40960
    ds_read_b128 v[108:111], v6 offset:41984
    buffer_load_dword v28, v5, s[8:11], s20 offen sc1
    s_sleep 1
    buffer_load_dword v29, v5, s[8:11], s20 offen sc1
    s_sleep 1
    buffer_load_dword v30, v5, s[8:11], s20 offen sc1
L_A_poll1:
    s_waitcnt vmcnt(2)
    v_cmp_eq_u32 vcc, -1, v28
    s_cbranch_vccz L_A_pre1
    buffer_load_dword v28, v5, s[8:11], s20 offen sc1
    s_waitcnt vmcnt(2)
    v_cmp_eq_u32 vcc, -1, v29
    s_cbranch_vccz L_A_pre1
    buffer_load_dword v29, v5, s[8:11], s20 offen sc1
    s_waitcnt vmcnt(2)
    v_cmp_eq_u32 vcc, -1, v30
    s_cbranch_vccz L_A_pre1
    buffer_load_dword v30, v5, s[8:11], s20 offen sc1
    s_add_u32 s30, s30, 1
    s_cmp_lt_u32 s30, 65536
    s_cbranch_scc1 L_A_poll1
    s_branch L_abort
L_A_w2:
    ds_read_b128 v[96:99], v7 offset:0
    ds_read_b128 v[100:103], v7 offset:1024
    ds_read_b128 v[104:107], v7 offset:8192
    ds_read_b128 v[108:111], v7 offset:9216
    buffer_load_dword v28, v5, s[8:11], s20 offen sc1
    s_sleep 1
    buffer_load_dword v29, v5, s[8:11], s20 offen sc1
    s_sleep 1
    buffer_load_dword v30, v5, s[8:11], s20 offen sc1
L_A_poll2:
    s_waitcnt vmcnt(2)
    v_cmp_eq_u32 vcc, -1, v28
    s_cbranch_vccz L_A_pre2
    buffer_load_dword v28, v5, s[8:11], s20 offen sc1
    s_waitcnt vmcnt(2)
    v_cmp_eq_u32 vcc, -1, v29
    s_cbranch_vccz L_A_pre2
    buffer_load_dword v29, v5, s[8:11], s20 offen sc1
    s_waitcnt vmcnt(2)
    v_cmp_eq_u32 vcc, -1, v30
    s_cbranch_vccz L_A_pre2
    buffer_load_dword v30, v5, s[8:11], s20 offen sc1
    s_add_u32 s30, s30, 1
    s_cmp_lt_u32 s30, 65536
    s_cbranch_scc1 L_A_poll2
    s_branch L_abort
L_A_w3:
    ds_read_b128 v[96:99], v7 offset:32768
    ds_read_b128 v[100:103], v7 offset:33792
    ds_read_b128 v[104:107], v7 offset:40960
    ds_read_b128 v[108:111], v7 offset:41984
    buffer_load_dword v28, v5, s[8:11], s20 offen sc1
    s_sleep 1
    buffer_load_dword v29, v5, s[8:11], s20 offen sc1
    s_sleep 1
    buffer_load_dword v30, v5, s[8:11], s20 offen sc1
L_A_poll3:
    s_waitcnt vmcnt(2)
    v_cmp_eq_u32 vcc, -1, v28
    s_cbranch_vccz L_A_pre3
    buffer_load_dword v28, v5, s[8:11], s20 offen sc1
    s_waitcnt vmcnt(2)
    v_cmp_eq_u32 vcc, -1, v29
    s_cbranch_vccz L_A_pre3
    buffer_load_dword v29, v5, s[8:11], s20 offen sc1
    s_waitcnt vmcnt(2)
    v_cmp_eq_u32 vcc, -1, v30
    s_cbranch_vccz L_A_pre3
    buffer_load_dword v30, v5, s[8:11], s20 offen sc1
    s_add_u32 s30, s30, 1
    s_cmp_lt_u32 s30, 65536
    s_cbranch_scc1 L_A_poll3
    s_branch L_abort
L_A_redo:
    s_nop 7
    s_add_u32 s20, s25, 105906176
    s_add_u32 s21, s20, 4096
    s_add_u32 s22, s20, 8192
    s_add_u32 s23, s20, 12288
    v_mov_b32 v112, 0
    v_mov_b32 v113, 0
    v_mov_b32 v114, 0
    v_mov_b32 v115, 0
    v_mov_b32 v116, 0
    v_mov_b32 v117, 0
    v_mov_b32 v118, 0
    v_mov_b32 v119, 0
    v_mov_b32 v120, 0
    v_mov_b32 v121, 0
    v_mov_b32 v122, 0
    v_mov_b32 v123, 0
    v_mov_b32 v124, 0
    v_mov_b32 v125, 0
    v_mov_b32 v126, 0
    v_mov_b32 v127, 0
    s_add_u32 s32, s32, 1
    s_cmp_ge_u32 s32, 65536
    s_cbranch_scc1 L_abort
    buffer_load_dwordx4 v[32:35], v2, s[8:11], s20 offen offset:0 sc1
    buffer_load_dwordx4 v[36:39], v2, s[8:11], s20 offen offset:1024 sc1
    buffer_load_dwordx4 v[40:43], v2, s[8:11], s20 offen offset:2048 sc1
    buffer_load_dwordx4 v[44:47], v2, s[8:11], s20 offen offset:3072 sc1
    ds_read_b128 v[96:99], v6 offset:0
    ds_read_b128 v[100:103], v6 offset:1024
    ds_read_b128 v[104:107], v6 offset:8192
    ds_read_b128 v[108:111], v6 offset:9216
    s_branch L_A_go0
L_A_pre0:
    buffer_load_dwordx4 v[32:35], v2, s[8:11], s20 offen offset:0 sc1
    buffer_load_dwordx4 v[36:39], v2, s[8:11], s20 offen offset:1024 sc1
    buffer_load_dwordx4 v[40:43], v2, s[8:11], s20 offen offset:2048 sc1
    buffer_load_dwordx4 v[44:47], v2, s[8:11], s20 offen offset:3072 sc1
    s_barrier
L_A_go0:
    buffer_load_dwordx4 v[48:51], v2, s[8:11], s21 offen offset:0 sc1
    buffer_load_dwordx4 v[52:55], v2, s[8:11], s21 offen offset:1024 sc1
    buffer_load_dwordx4 v[56:59], v2, s[8:11], s21 offen offset:2048 sc1
    s_waitcnt vmcnt(6) lgkmcnt(2)
    v_smfmac_f32_16x16x64_bf16 v[112:115], v[32:35], a[0:7], v3
    buffer_load_dwordx4 v[60:63], v2, s[8:11], s21 offen offset:3072 sc1
    v_smfmac_f32_16x16x64_bf16 v[124:127], v[32:35], v[96:103], v3
    ds_read_b128 v[16:19], v6 offset:16384
    v_smfmac_f32_16x16x64_bf16 v[116:119], v[32:35], a[8:15], v3
    ds_read_b128 v[20:23], v6 offset:17408
    v_smfmac_f32_16x16x64_bf16 v[120:123], v[32:35], v[128:135], v3
    s_waitcnt vmcnt(6) lgkmcnt(2)
    v_smfmac_f32_16x16x64_bf16 v[112:115], v[36:39], a[16:23], v3
    buffer_load_dwordx4 v[64:67], v2, s[8:11], s22 offen offset:0 sc1
    v_smfmac_f32_16x16x64_bf16 v[124:127], v[36:39], v[104:111], v3
    ds_read_b128 v[96:99], v6 offset:24576
    v_smfmac_f32_16x16x64_bf16 v[116:119], v[36:39], a[24:31], v3
    ds_read_b128 v[100:103], v6 offset:25600
    v_max_u32 v15, v32, v36
    v_smfmac_f32_16x16x64_bf16 v[120:123], v[36:39], v[136:143], v3
    s_waitcnt vmcnt(6) lgkmcnt(2)
    v_smfmac_f32_16x16x64_bf16 v[112:115], v[40:43], a[32:39], v3
    buffer_load_dwordx4 v[68:71], v2, s[8:11], s22 offen offset:1024 sc1
    v_smfmac_f32_16x16x64_bf16 v[124:127], v[40:43], v[16:23], v3
    ds_read_b128 v[104:107], v6 offset:32768
    v_smfmac_f32_16x16x64_bf16 v[116:119], v[40:43], a[40:47], v3
    ds_read_b128 v[108:111], v6 offset:33792
    v_smfmac_f32_16x16x64_bf16 v[120:123], v[40:43], v[144:151], v3
    s_waitcnt vmcnt(6) lgkmcnt(2)
    v_smfmac_f32_16x16x64_bf16 v[112:115], v[44:47], a[48:55], v3
    buffer_load_dwordx4 v[72:75], v2, s[8:11], s22 offen offset:2048 sc1
    v_smfmac_f32_16x16x64_bf16 v[124:127], v[44:47], v[96:103], v3
    ds_read_b128 v[16:19], v6 offset:40960
    v_smfmac_f32_16x16x64_bf16 v[116:119], v[44:47], a[56:63], v3
    ds_read_b128 v[20:23], v6 offset:41984
    v_max3_u32 v15, v15, v40, v44
    v_smfmac_f32_16x16x64_bf16 v[120:123], v[44:47], v[152:159], v3
    s_waitcnt vmcnt(6) lgkmcnt(2)
    v_smfmac_f32_16x16x64_bf16 v[112:115], v[48:51], a[64:71], v3
    buffer_load_dwordx4 v[76:79], v2, s[8:11], s22 offen offset:3072 sc1
    v_smfmac_f32_16x16x64_bf16 v[124:127], v[48:51], v[104:111], v3
    ds_read_b128 v[96:99], v6 offset:49152
    v_smfmac_f32_16x16x64_bf16 v[116:119], v[48:51], a[72:79], v3
    ds_read_b128 v[100:103], v6 offset:50176
    v_smfmac_f32_16x16x64_bf16 v[120:123], v[48:51], v[160:167], v3
    s_waitcnt vmcnt(6) lgkmcnt(2)
    v_smfmac_f32_16x16x64_bf16 v[112:115], v[52:55], a[80:87], v3
    buffer_load_dwordx4 v[80:83], v2, s[8:11], s23 offen offset:0 sc1
    v_smfmac_f32_16x16x64_bf16 v[124:127], v[52:55], v[16:23], v3
    ds_read_b128 v[104:107], v6 offset:57344
    v_smfmac_f32_16x16x64_bf16 v[116:119], v[52:55], a[88:95], v3
    ds_read_b128 v[108:111], v6 offset:58368
    v_max3_u32 v15, v15, v48, v52
    v_smfmac_f32_16x16x64_bf16 v[120:123], v[52:55], v[168:175], v3
    s_waitcnt vmcnt(6) lgkmcnt(2)
    v_smfmac_f32_16x16x64_bf16 v[112:115], v[56:59], a[96:103], v3
    buffer_load_dwordx4 v[84:87], v2, s[8:11], s23 offen offset:1024 sc1
    v_smfmac_f32_16x16x64_bf16 v[124:127], v[56:59], v[96:103], v3
    ds_read_b128 v[16:19], v7 offset:0
    v_smfmac_f32_16x16x64_bf16 v[116:119], v[56:59], a[104:111], v3
    ds_read_b128 v[20:23], v7 offset:1024
    v_smfmac_f32_16x16x64_bf16 v[120:123], v[56:59], v[176:183], v3
    s_waitcnt vmcnt(6) lgkmcnt(2)
    v_smfmac_f32_16x16x64_bf16 v[112:115], v[60:63], a[112:119], v3
    buffer_load_dwordx4 v[88:91], v2, s[8:11], s23 offen offset:2048 sc1
    v_smfmac_f32_16x16x64_bf16 v[124:127], v[60:63], v[104:111], v3
    ds_read_b128 v[96:99], v7 offset:8192
    v_smfmac_f32_16x16x64_bf16 v[116:119], v[60:63], a[120:127], v3
    ds_read_b128 v[100:103], v7 offset:9216
    v_max3_u32 v15, v15, v56, v60
    v_smfmac_f32_16x16x64_bf16 v[120:123], v[60:63], v[184:191], v3
    s_waitcnt vmcnt(6) lgkmcnt(2)
    v_smfmac_f32_16x16x64_bf16 v[112:115], v[64:67], a[128:135], v3
    buffer_load_dwordx4 v[92:95], v2, s[8:11], s23 offen offset:3072 sc1
    v_smfmac_f32_16x16x64_bf16 v[124:127], v[64:67], v[16:23], v3
    ds_read_b128 v[104:107], v7 offset:16384
    v_smfmac_f32_16x16x64_bf16 v[116:119], v[64:67], a[136:143], v3
    ds_read_b128 v[108:111], v7 offset:17408
    v_smfmac_f32_16x16x64_bf16 v[120:123], v[64:67], v[192:199], v3
    s_waitcnt vmcnt(6) lgkmcnt(2)
    v_smfmac_f32_16x16x64_bf16 v[112:115], v[68:71], a[144:151], v3
    v_smfmac_f32_16x16x64_bf16 v[124:127], v[68:71], v[96:103], v3
    ds_read_b128 v[16:19], v7 offset:24576
    v_smfmac_f32_16x16x64_bf16 v[116:119], v[68:71], a[152:159], v3
    ds_read_b128 v[20:23], v7 offset:25600
    v_max3_u32 v15, v15, v64, v68
    v_smfmac_f32_16x16x64_bf16 v[120:123], v[68:71], v[200:207], v3
    s_waitcnt vmcnt(5) lgkmcnt(2)
    v_smfmac_f32_16x16x64_bf16 v[112:115], v[72:75], a[160:167], v3
    v_smfmac_f32_16x16x64_bf16 v[124:127], v[72:75], v[104:111], v3
    ds_read_b128 v[96:99], v7 offset:32768
    v_smfmac_f32_16x16x64_bf16 v[116:119], v[72:75], a[168:175], v3
    ds_read_b128 v[100:103], v7 offset:33792
    v_smfmac_f32_16x16x64_bf16 v[120:123], v[72:75], v[208:215], v3
    s_waitcnt vmcnt(4) lgkmcnt(2)
    v_smfmac_f32_16x16x64_bf16 v[112:115], v[76:79], a[176:183], v3
    v_smfmac_f32_16x16x64_bf16 v[124:127], v[76:79], v[16:23], v3
    ds_read_b128 v[104:107], v7 offset:40960
    v_smfmac_f32_16x16x64_bf16 v[116:119], v[76:79], a[184:191], v3
    ds_read_b128 v[108:111], v7 offset:41984
    v_max3_u32 v15, v15, v72, v76
    v_smfmac_f32_16x16x64_bf16 v[120:123], v[76:79], v[216:223], v3
    s_waitcnt vmcnt(3) lgkmcnt(2)
    v_smfmac_f32_16x16x64_bf16 v[112:115], v[80:83], a[192:199], v3
    v_smfmac_f32_16x16x64_bf16 v[124:127], v[80:83], v[96:103], v3
    ds_read_b128 v[16:19], v7 offset:49152
    v_smfmac_f32_16x16x64_bf16 v[116:119], v[80:83], a[200:207], v3
    ds_read_b128 v[20:23], v7 offset:50176
    v_smfmac_f32_16x16x64_bf16 v[120:123], v[80:83], v[224:231], v3
    s_waitcnt vmcnt(2) lgkmcnt(2)
    v_smfmac_f32_16x16x64_bf16 v[112:115], v[84:87], a[208:215], v3
    v_smfmac_f32_16x16x64_bf16 v[124:127], v[84:87], v[104:111], v3
    ds_read_b128 v[96:99], v7 offset:57344
    v_smfmac_f32_16x16x64_bf16 v[116:119], v[84:87], a[216:223], v3
    ds_read_b128 v[100:103], v7 offset:58368
    v_max3_u32 v15, v15, v80, v84
    v_smfmac_f32_16x16x64_bf16 v[120:123], v[84:87], v[232:239], v3
    s_waitcnt vmcnt(1) lgkmcnt(2)
    v_smfmac_f32_16x16x64_bf16 v[112:115], v[88:91], a[224:231], v3
    v_smfmac_f32_16x16x64_bf16 v[124:127], v[88:91], v[16:23], v3
    v_smfmac_f32_16x16x64_bf16 v[116:119], v[88:91], a[232:239], v3
    v_smfmac_f32_16x16x64_bf16 v[120:123], v[88:91], v[240:247], v3
    s_waitcnt vmcnt(0) lgkmcnt(0)
    v_smfmac_f32_16x16x64_bf16 v[112:115], v[92:95], a[240:247], v3
    v_max3_u32 v15, v15, v88, v92
    v_smfmac_f32_16x16x64_bf16 v[120:123], v[92:95], v[248:255], v3
    v_cmp_eq_u32 vcc, -1, v15
    v_smfmac_f32_16x16x64_bf16 v[116:119], v[92:95], a[248:255], v3
    v_smfmac_f32_16x16x64_bf16 v[124:127], v[92:95], v[96:103], v3
    s_branch L_A_g1
L_A_pre1:
    buffer_load_dwordx4 v[48:51], v2, s[8:11], s21 offen offset:0 sc1
    buffer_load_dwordx4 v[52:55], v2, s[8:11], s21 offen offset:1024 sc1
    buffer_load_dwordx4 v[56:59], v2, s[8:11], s21 offen offset:2048 sc1
    buffer_load_dwordx4 v[60:63], v2, s[8:11], s21 offen offset:3072 sc1
    s_barrier
L_A_go1:
    buffer_load_dwordx4 v[64:67], v2, s[8:11], s22 offen offset:0 sc1
    buffer_load_dwordx4 v[68:71], v2, s[8:11], s22 offen offset:1024 sc1
    buffer_load_dwordx4 v[72:75], v2, s[8:11], s22 offen offset:2048 sc1
    s_waitcnt vmcnt(6) lgkmcnt(2)
    v_smfmac_f32_16x16x64_bf16 v[112:115], v[48:51], a[64:71], v3
    buffer_load_dwordx4 v[76:79], v2, s[8:11], s22 offen offset:3072 sc1
    v_smfmac_f32_16x16x64_bf16 v[124:127], v[48:51], v[96:103], v3
    ds_read_b128 v[16:19], v6 offset:49152
    v_smfmac_f32_16x16x64_bf16 v[116:119], v[48:51], a[72:79], v3
    ds_read_b128 v[20:23], v6 offset:50176
    v_smfmac_f32_16x16x64_bf16 v[120:123], v[48:51], v[160:167], v3
    s_waitcnt vmcnt(6) lgkmcnt(2)
    v_smfmac_f32_16x16x64_bf16 v[112:115], v[52:55], a[80:87], v3
    buffer_load_dwordx4 v[80:83], v2, s[8:11], s23 offen offset:0 sc1
    v_smfmac_f32_16x16x64_bf16 v[124:127], v[52:55], v[104:111], v3
    ds_read_b128 v[96:99], v6 offset:57344
    v_smfmac_f32_16x16x64_bf16 v[116:119], v[52:55], a[88:95], v3
    ds_read_b128 v[100:103], v6 offset:58368
    v_max_u32 v15, v48, v52
    v_smfmac_f32_16x16x64_bf16 v[120:123], v[52:55], v[168:175], v3
    s_waitcnt vmcnt(6) lgkmcnt(2)
    v_smfmac_f32_16x16x64_bf16 v[112:115], v[56:59], a[96:103], v3
    buffer_load_dwordx4 v[84:87], v2, s[8:11], s23 offen offset:1024 sc1
    v_smfmac_f32_16x16x64_bf16 v[124:127], v[56:59], v[16:23], v3
    ds_read_b128 v[104:107], v7 offset:0
    v_smfmac_f32_16x16x64_bf16 v[116:119], v[56:59], a[104:111], v3
    ds_read_b128 v[108:111], v7 offset:1024
    v_smfmac_f32_16x16x64_bf16 v[120:123], v[56:59], v[176:183], v3
    s_waitcnt vmcnt(6) lgkmcnt(2)
    v_smfmac_f32_16x16x64_bf16 v[112:115], v[60:63], a[112:119], v3
    buffer_load_dwordx4 v[88:91], v2, s[8:11], s23 offen offset:2048 sc1
    v_smfmac_f32_16x16x64_bf16 v[124:127], v[60:63], v[96:103], v3
    ds_read_b128 v[16:19], v7 offset:8192
    v_smfmac_f32_16x16x64_bf16 v[116:119], v[60:63], a[120:127], v3
    ds_read_b128 v[20:23], v7 offset:9216
    v_max3_u32 v15, v15, v56, v60
    v_smfmac_f32_16x16x64_bf16 v[120:123], v[60:63], v[184:191], v3
    s_waitcnt vmcnt(6) lgkmcnt(2)
    v_smfmac_f32_16x16x64_bf16 v[112:115], v[64:67], a[128:135], v3
    buffer_load_dwordx4 v[92:95], v2, s[8:11], s23 offen offset:3072 sc1
    v_smfmac_f32_16x16x64_bf16 v[124:127], v[64:67], v[104:111], v3
    ds_read_b128 v[96:99], v7 offset:16384
    v_smfmac_f32_16x16x64_bf16 v[116:119], v[64:67], a[136:143], v3
    ds_read_b128 v[100:103], v7 offset:17408
    v_smfmac_f32_16x16x64_bf16 v[120:123], v[64:67], v[192:199], v3
    s_waitcnt vmcnt(6) lgkmcnt(2)
    v_smfmac_f32_16x16x64_bf16 v[112:115], v[68:71], a[144:151], v3
    buffer_load_dwordx4 v[32:35], v2, s[8:11], s20 offen offset:0 sc1
    v_smfmac_f32_16x16x64_bf16 v[124:127], v[68:71], v[16:23], v3
    ds_read_b128 v[104:107], v7 offset:24576
    v_smfmac_f32_16x16x64_bf16 v[116:119], v[68:71], a[152:159], v3
    ds_read_b128 v[108:111], v7 offset:25600
    v_max3_u32 v15, v15, v64, v68
    v_smfmac_f32_16x16x64_bf16 v[120:123], v[68:71], v[200:207], v3
    s_waitcnt vmcnt(6) lgkmcnt(2)
    v_smfmac_f32_16x16x64_bf16 v[112:115], v[72:75], a[160:167], v3
    buffer_load_dwordx4 v[36:39], v2, s[8:11], s20 offen offset:1024 sc1
    v_smfmac_f32_16x16x64_bf16 v[124:127], v[72:75], v[96:103], v3
    ds_read_b128 v[16:19], v7 offset:32768
    v_smfmac_f32_16x16x64_bf16 v[116:119], v[72:75], a[168:175], v3
    ds_read_b128 v[20:23], v7 offset:33792
    v_smfmac_f32_16x16x64_bf16 v[120:123], v[72:75], v[208:215], v3
    s_waitcnt vmcnt(6) lgkmcnt(2)
    v_smfmac_f32_16x16x64_bf16 v[112:115], v[76:79], a[176:183], v3
    buffer_load_dwordx4 v[40:43], v2, s[8:11], s20 offen offset:2048 sc1
    v_smfmac_f32_16x16x64_bf16 v[124:127], v[76:79], v[104:111], v3
    ds_read_b128 v[96:99], v7 offset:40960
    v_smfmac_f32_16x16x64_bf16 v[116:119], v[76:79], a[184:191], v3
    ds_read_b128 v[100:103], v7 offset:41984
    v_max3_u32 v15, v15, v72, v76
    v_smfmac_f32_16x16x64_bf16 v[120:123], v[76:79], v[216:223], v3
    s_waitcnt vmcnt(6) lgkmcnt(2)
    v_smfmac_f32_16x16x64_bf16 v[112:115], v[80:83], a[192:199], v3
    buffer_load_dwordx4 v[44:47], v2, s[8:11], s20 offen offset:3072 sc1
    v_smfmac_f32_16x16x64_bf16 v[124:127], v[80:83], v[16:23], v3
    ds_read_b128 v[104:107], v7 offset:49152
    v_smfmac_f32_16x16x64_bf16 v[116:119], v[80:83], a[200:207], v3
    ds_read_b128 v[108:111], v7 offset:50176
    v_smfmac_f32_16x16x64_bf16 v[120:123], v[80:83], v[224:231], v3
    s_waitcnt vmcnt(6) lgkmcnt(2)
    v_smfmac_f32_16x16x64_bf16 v[112:115], v[84:87], a[208:215], v3
    v_smfmac_f32_16x16x64_bf16 v[124:127], v[84:87], v[96:103], v3
    ds_read_b128 v[16:19], v7 offset:57344
    v_smfmac_f32_16x16x64_bf16 v[116:119], v[84:87], a[216:223], v3
    ds_read_b128 v[20:23], v7 offset:58368
    v_max3_u32 v15, v15, v80, v84
    v_smfmac_f32_16x16x64_bf16 v[120:123], v[84:87], v[232:239], v3
    s_waitcnt vmcnt(5) lgkmcnt(2)
    v_smfmac_f32_16x16x64_bf16 v[112:115], v[88:91], a[224:231], v3
    v_smfmac_f32_16x16x64_bf16 v[124:127], v[88:91], v[104:111], v3
    ds_read_b128 v[96:99], v6 offset:0
    v_smfmac_f32_16x16x64_bf16 v[116:119], v[88:91], a[232:239], v3
    ds_read_b128 v[100:103], v6 offset:1024
    v_smfmac_f32_16x16x64_bf16 v[120:123], v[88:91], v[240:247], v3
    s_waitcnt vmcnt(4) lgkmcnt(2)
    v_smfmac_f32_16x16x64_bf16 v[112:115], v[92:95], a[240:247], v3
    v_smfmac_f32_16x16x64_bf16 v[124:127], v[92:95], v[16:23], v3
    ds_read_b128 v[104:107], v6 offset:8192
    v_smfmac_f32_16x16x64_bf16 v[116:119], v[92:95], a[248:255], v3
    ds_read_b128 v[108:111], v6 offset:9216
    v_max3_u32 v15, v15, v88, v92
    v_smfmac_f32_16x16x64_bf16 v[120:123], v[92:95], v[248:255], v3
    s_waitcnt vmcnt(3) lgkmcnt(2)
    v_smfmac_f32_16x16x64_bf16 v[112:115], v[32:35], a[0:7], v3
    v_smfmac_f32_16x16x64_bf16 v[124:127], v[32:35], v[96:103], v3
    ds_read_b128 v[16:19], v6 offset:16384
    v_smfmac_f32_16x16x64_bf16 v[116:119], v[32:35], a[8:15], v3
    ds_read_b128 v[20:23], v6 offset:17408
    v_smfmac_f32_16x16x64_bf16 v[120:123], v[32:35], v[128:135], v3
    s_waitcnt vmcnt(2) lgkmcnt(2)
    v_smfmac_f32_16x16x64_bf16 v[112:115], v[36:39], a[16:23], v3
    v_smfmac_f32_16x16x64_bf16 v[124:127], v[36:39], v[104:111], v3
    ds_read_b128 v[96:99], v6 offset:24576
    v_smfmac_f32_16x16x64_bf16 v[116:119], v[36:39], a[24:31], v3
    ds_read_b128 v[100:103], v6 offset:25600
    v_max3_u32 v15, v15, v32, v36
    v_smfmac_f32_16x16x64_bf16 v[120:123], v[36:39], v[136:143], v3
    s_waitcnt vmcnt(1) lgkmcnt(2)
    v_smfmac_f32_16x16x64_bf16 v[112:115], v[40:43], a[32:39], v3
    v_smfmac_f32_16x16x64_bf16 v[124:127], v[40:43], v[16:23], v3
    v_smfmac_f32_16x16x64_bf16 v[116:119], v[40:43], a[40:47], v3
    v_smfmac_f32_16x16x64_bf16 v[120:123], v[40:43], v[144:151], v3
    s_waitcnt vmcnt(0) lgkmcnt(0)
    v_smfmac_f32_16x16x64_bf16 v[112:115], v[44:47], a[48:55], v3
    v_max3_u32 v15, v15, v40, v44
    v_smfmac_f32_16x16x64_bf16 v[120:123], v[44:47], v[152:159], v3
    v_cmp_eq_u32 vcc, -1, v15
    v_smfmac_f32_16x16x64_bf16 v[116:119], v[44:47], a[56:63], v3
    v_smfmac_f32_16x16x64_bf16 v[124:127], v[44:47], v[96:103], v3
    s_branch L_A_g1
L_A_pre2:
    buffer_load_dwordx4 v[64:67], v2, s[8:11], s22 offen offset:0 sc1
    buffer_load_dwordx4 v[68:71], v2, s[8:11], s22 offen offset:1024 sc1
    buffer_load_dwordx4 v[72:75], v2, s[8:11], s22 offen offset:2048 sc1
    buffer_load_dwordx4 v[76:79], v2, s[8:11], s22 offen offset:3072 sc1
    s_barrier
L_A_go2:
    buffer_load_dwordx4 v[80:83], v2, s[8:11], s23 offen offset:0 sc1
    buffer_load_dwordx4 v[84:87], v2, s[8:11], s23 offen offset:1024 sc1
    buffer_load_dwordx4 v[88:91], v2, s[8:11], s23 offen offset:2048 sc1
    s_waitcnt vmcnt(6) lgkmcnt(2)
    v_smfmac_f32_16x16x64_bf16 v[112:115], v[64:67], a[128:135], v3
    buffer_load_dwordx4 v[92:95], v2, s[8:11], s23 offen offset:3072 sc1
    v_smfmac_f32_16x16x64_bf16 v[124:127], v[64:67], v[96:103], v3
    ds_read_b128 v[16:19], v7 offset:16384
    v_smfmac_f32_16x16x64_bf16 v[116:119], v[64:67], a[136:143], v3
    ds_read_b128 v[20:23], v7 offset:17408
    v_smfmac_f32_16x16x64_bf16 v[120:123], v[64:67], v[192:199], v3
    s_waitcnt vmcnt(6) lgkmcnt(2)
    v_smfmac_f32_16x16x64_bf16 v[112:115], v[68:71], a[144:151], v3
    buffer_load_dwordx4 v[32:35], v2, s[8:11], s20 offen offset:0 sc1
    v_smfmac_f32_16x16x64_bf16 v[124:127], v[68:71], v[104:111], v3
    ds_read_b128 v[96:99], v7 offset:24576
    v_smfmac_f32_16x16x64_bf16 v[116:119], v[68:71], a[152:159], v3
    ds_read_b128 v[100:103], v7 offset:25600
    v_max_u32 v15, v64, v68
    v_smfmac_f32_16x16x64_bf16 v[120:123], v[68:71], v[200:207], v3
    s_waitcnt vmcnt(6) lgkmcnt(2)
    v_smfmac_f32_16x16x64_bf16 v[112:115], v[72:75], a[160:167], v3
    buffer_load_dwordx4 v[36:39], v2, s[8:11], s20 offen offset:1024 sc1
    v_smfmac_f32_16x16x64_bf16 v[124:127], v[72:75], v[16:23], v3
    ds_read_b128 v[104:107], v7 offset:32768
    v_smfmac_f32_16x16x64_bf16 v[116:119], v[72:75], a[168:175], v3
    ds_read_b128 v[108:111], v7 offset:33792
    v_smfmac_f32_16x16x64_bf16 v[120:123], v[72:75], v[208:215], v3
    s_waitcnt vmcnt(6) lgkmcnt(2)
    v_smfmac_f32_16x16x64_bf16 v[112:115], v[76:79], a[176:183], v3
    buffer_load_dwordx4 v[40:43], v2, s[8:11], s20 offen offset:2048 sc1
    v_smfmac_f32_16x16x64_bf16 v[124:127], v[76:79], v[96:103], v3
    ds_read_b128 v[16:19], v7 offset:40960
    v_smfmac_f32_16x16x64_bf16 v[116:119], v[76:79], a[184:191], v3
    ds_read_b128 v[20:23], v7 offset:41984
    v_max3_u32 v15, v15, v72, v76
    v_smfmac_f32_16x16x64_bf16 v[120:123], v[76:79], v[216:223], v3
    s_waitcnt vmcnt(6) lgkmcnt(2)
    v_smfmac_f32_16x16x64_bf16 v[112:115], v[80:83], a[192:199], v3
    buffer_load_dwordx4 v[44:47], v2, s[8:11], s20 offen offset:3072 sc1
    v_smfmac_f32_16x16x64_bf16 v[124:127], v[80:83], v[104:111], v3
    ds_read_b128 v[96:99], v7 offset:49152
    v_smfmac_f32_16x16x64_bf16 v[116:119], v[80:83], a[200:207], v3
    ds_read_b128 v[100:103], v7 offset:50176
    v_smfmac_f32_16x16x64_bf16 v[120:123], v[80:83], v[224:231], v3
    s_waitcnt vmcnt(6) lgkmcnt(2)
    v_smfmac_f32_16x16x64_bf16 v[112:115], v[84:87], a[208:215], v3
    buffer_load_dwordx4 v[48:51], v2, s[8:11], s21 offen offset:0 sc1
    v_smfmac_f32_16x16x64_bf16 v[124:127], v[84:87], v[16:23], v3
    ds_read_b128 v[104:107], v7 offset:57344
    v_smfmac_f32_16x16x64_bf16 v[116:119], v[84:87], a[216:223], v3
    ds_read_b128 v[108:111], v7 offset:58368
    v_max3_u32 v15, v15, v80, v84
    v_smfmac_f32_16x16x64_bf16 v[120:123], v[84:87], v[232:239], v3
    s_waitcnt vmcnt(6) lgkmcnt(2)
    v_smfmac_f32_16x16x64_bf16 v[112:115], v[88:91], a[224:231], v3
    buffer_load_dwordx4 v[52:55], v2, s[8:11], s21 offen offset:1024 sc1
    v_smfmac_f32_16x16x64_bf16 v[124:127], v[88:91], v[96:103], v3
    ds_read_b128 v[16:19], v6 offset:0
    v_smfmac_f32_16x16x64_bf16 v[116:119], v[88:91], a[232:239], v3
    ds_read_b128 v[20:23], v6 offset:1024
    v_smfmac_f32_16x16x64_bf16 v[120:123], v[88:91], v[240:247], v3
    s_waitcnt vmcnt(6) lgkmcnt(2)
    v_smfmac_f32_16x16x64_bf16 v[112:115], v[92:95], a[240:247], v3
    buffer_load_dwordx4 v[56:59], v2, s[8:11], s21 offen offset:2048 sc1
    v_smfmac_f32_16x16x64_bf16 v[124:127], v[92:95], v[104:111], v3
    ds_read_b128 v[96:99], v6 offset:8192
    v_smfmac_f32_16x16x64_bf16 v[116:119], v[92:95], a[248:255], v3
    ds_read_b128 v[100:103], v6 offset:9216
    v_max3_u32 v15, v15, v88, v92
    v_smfmac_f32_16x16x64_bf16 v[120:123], v[92:95], v[248:255], v3
    s_waitcnt vmcnt(6) lgkmcnt(2)
    v_smfmac_f32_16x16x64_bf16 v[112:115], v[32:35], a[0:7], v3
    buffer_load_dwordx4 v[60:63], v2, s[8:11], s21 offen offset:3072 sc1
    v_smfmac_f32_16x16x64_bf16 v[124:127], v[32:35], v[16:23], v3
    ds_read_b128 v[104:107], v6 offset:16384
    v_smfmac_f32_16x16x64_bf16 v[116:119], v[32:35], a[8:15], v3
    ds_read_b128 v[108:111], v6 offset:17408
    v_smfmac_f32_16x16x64_bf16 v[120:123], v[32:35], v[128:135], v3
    s_waitcnt vmcnt(6) lgkmcnt(2)
    v_smfmac_f32_16x16x64_bf16 v[112:115], v[36:39], a[16:23], v3
    v_smfmac_f32_16x16x64_bf16 v[124:127], v[36:39], v[96:103], v3
    ds_read_b128 v[16:19], v6 offset:24576
    v_smfmac_f32_16x16x64_bf16 v[116:119], v[36:39], a[24:31], v3
    ds_read_b128 v[20:23], v6 offset:25600
    v_max3_u32 v15, v15, v32, v36
    v_smfmac_f32_16x16x64_bf16 v[120:123], v[36:39], v[136:143], v3
    s_waitcnt vmcnt(5) lgkmcnt(2)
    v_smfmac_f32_16x16x64_bf16 v[112:115], v[40:43], a[32:39], v3
    v_smfmac_f32_16x16x64_bf16 v[124:127], v[40:43], v[104:111], v3
    ds_read_b128 v[96:99], v6 offset:32768
    v_smfmac_f32_16x16x64_bf16 v[116:119], v[40:43], a[40:47], v3
    ds_read_b128 v[100:103], v6 offset:33792
    v_smfmac_f32_16x16x64_bf16 v[120:123], v[40:43], v[144:151], v3
    s_waitcnt vmcnt(4) lgkmcnt(2)
    v_smfmac_f32_16x16x64_bf16 v[112:115], v[44:47], a[48:55], v3
    v_smfmac_f32_16x16x64_bf16 v[124:127], v[44:47], v[16:23], v3
    ds_read_b128 v[104:107], v6 offset:40960
    v_smfmac_f32_16x16x64_bf16 v[116:119], v[44:47], a[56:63], v3
    ds_read_b128 v[108:111], v6 offset:41984
    v_max3_u32 v15, v15, v40, v44
    v_smfmac_f32_16x16x64_bf16 v[120:123], v[44:47], v[152:159], v3
    s_waitcnt vmcnt(3) lgkmcnt(2)
    v_smfmac_f32_16x16x64_bf16 v[112:115], v[48:51], a[64:71], v3
    v_smfmac_f32_16x16x64_bf16 v[124:127], v[48:51], v[96:103], v3
    ds_read_b128 v[16:19], v6 offset:49152
    v_smfmac_f32_16x16x64_bf16 v[116:119], v[48:51], a[72:79], v3
    ds_read_b128 v[20:23], v6 offset:50176
    v_smfmac_f32_16x16x64_bf16 v[120:123], v[48:51], v[160:167], v3
    s_waitcnt vmcnt(2) lgkmcnt(2)
    v_smfmac_f32_16x16x64_bf16 v[112:115], v[52:55], a[80:87], v3
    v_smfmac_f32_16x16x64_bf16 v[124:127], v[52:55], v[104:111], v3
    ds_read_b128 v[96:99], v6 offset:57344
    v_smfmac_f32_16x16x64_bf16 v[116:119], v[52:55], a[88:95], v3
    ds_read_b128 v[100:103], v6 offset:58368
    v_max3_u32 v15, v15, v48, v52
    v_smfmac_f32_16x16x64_bf16 v[120:123], v[52:55], v[168:175], v3
    s_waitcnt vmcnt(1) lgkmcnt(2)
    v_smfmac_f32_16x16x64_bf16 v[112:115], v[56:59], a[96:103], v3
    v_smfmac_f32_16x16x64_bf16 v[124:127], v[56:59], v[16:23], v3
    v_smfmac_f32_16x16x64_bf16 v[116:119], v[56:59], a[104:111], v3
    v_smfmac_f32_16x16x64_bf16 v[120:123], v[56:59], v[176:183], v3
    s_waitcnt vmcnt(0) lgkmcnt(0)
    v_smfmac_f32_16x16x64_bf16 v[112:115], v[60:63], a[112:119], v3
    v_max3_u32 v15, v15, v56, v60
    v_smfmac_f32_16x16x64_bf16 v[120:123], v[60:63], v[184:191], v3
    v_cmp_eq_u32 vcc, -1, v15
    v_smfmac_f32_16x16x64_bf16 v[116:119], v[60:63], a[120:127], v3
    v_smfmac_f32_16x16x64_bf16 v[124:127], v[60:63], v[96:103], v3
    s_branch L_A_g1
L_A_pre3:
    buffer_load_dwordx4 v[80:83], v2, s[8:11], s23 offen offset:0 sc1
    buffer_load_dwordx4 v[84:87], v2, s[8:11], s23 offen offset:1024 sc1
    buffer_load_dwordx4 v[88:91], v2, s[8:11], s23 offen offset:2048 sc1
    buffer_load_dwordx4 v[92:95], v2, s[8:11], s23 offen offset:3072 sc1
    s_barrier
L_A_go3:
    buffer_load_dwordx4 v[32:35], v2, s[8:11], s20 offen offset:0 sc1
    buffer_load_dwordx4 v[36:39], v2, s[8:11], s20 offen offset:1024 sc1
    buffer_load_dwordx4 v[40:43], v2, s[8:11], s20 offen offset:2048 sc1
    s_waitcnt vmcnt(6) lgkmcnt(2)
    v_smfmac_f32_16x16x64_bf16 v[112:115], v[80:83], a[192:199], v3
    buffer_load_dwordx4 v[44:47], v2, s[8:11], s20 offen offset:3072 sc1
    v_smfmac_f32_16x16x64_bf16 v[124:127], v[80:83], v[96:103], v3
    ds_read_b128 v[16:19], v7 offset:49152
    v_smfmac_f32_16x16x64_bf16 v[116:119], v[80:83], a[200:207], v3
    ds_read_b128 v[20:23], v7 offset:50176
    v_smfmac_f32_16x16x64_bf16 v[120:123], v[80:83], v[224:231], v3
    s_waitcnt vmcnt(6) lgkmcnt(2)
    v_smfmac_f32_16x16x64_bf16 v[112:115], v[84:87], a[208:215], v3
    buffer_load_dwordx4 v[48:51], v2, s[8:11], s21 offen offset:0 sc1
    v_smfmac_f32_16x16x64_bf16 v[124:127], v[84:87], v[104:111], v3
    ds_read_b128 v[96:99], v7 offset:57344
    v_smfmac_f32_16x16x64_bf16 v[116:119], v[84:87], a[216:223], v3
    ds_read_b128 v[100:103], v7 offset:58368
    v_max_u32 v15, v80, v84
    v_smfmac_f32_16x16x64_bf16 v[120:123], v[84:87], v[232:239], v3
    s_waitcnt vmcnt(6) lgkmcnt(2)
    v_smfmac_f32_16x16x64_bf16 v[112:115], v[88:91], a[224:231], v3
    buffer_load_dwordx4 v[52:55], v2, s[8:11], s21 offen offset:1024 sc1
    v_smfmac_f32_16x16x64_bf16 v[124:127], v[88:91], v[16:23], v3
    ds_read_b128 v[104:107], v6 offset:0
    v_smfmac_f32_16x16x64_bf16 v[116:119], v[88:91], a[232:239], v3
    ds_read_b128 v[108:111], v6 offset:1024
    v_smfmac_f32_16x16x64_bf16 v[120:123], v[88:91], v[240:247], v3
    s_waitcnt vmcnt(6) lgkmcnt(2)
    v_smfmac_f32_16x16x64_bf16 v[112:115], v[92:95], a[240:247], v3
    buffer_load_dwordx4 v[56:59], v2, s[8:11], s21 offen offset:2048 sc1
    v_smfmac_f32_16x16x64_bf16 v[124:127], v[92:95], v[96:103], v3
    ds_read_b128 v[16:19], v6 offset:8192
    v_smfmac_f32_16x16x64_bf16 v[116:119], v[92:95], a[248:255], v3
    ds_read_b128 v[20:23], v6 offset:9216
    v_max3_u32 v15, v15, v88, v92
    v_smfmac_f32_16x16x64_bf16 v[120:123], v[92:95], v[248:255], v3
    s_waitcnt vmcnt(6) lgkmcnt(2)
    v_smfmac_f32_16x16x64_bf16 v[112:115], v[32:35], a[0:7], v3
    buffer_load_dwordx4 v[60:63], v2, s[8:11], s21 offen offset:3072 sc1
    v_smfmac_f32_16x16x64_bf16 v[124:127], v[32:35], v[104:111], v3
    ds_read_b128 v[96:99], v6 offset:16384
    v_smfmac_f32_16x16x64_bf16 v[116:119], v[32:35], a[8:15], v3
    ds_read_b128 v[100:103], v6 offset:17408
    v_smfmac_f32_16x16x64_bf16 v[120:123], v[32:35], v[128:135], v3
    s_waitcnt vmcnt(6) lgkmcnt(2)
    v_smfmac_f32_16x16x64_bf16 v[112:115], v[36:39], a[16:23], v3
    buffer_load_dwordx4 v[64:67], v2, s[8:11], s22 offen offset:0 sc1
    v_smfmac_f32_16x16x64_bf16 v[124:127], v[36:39], v[16:23], v3
    ds_read_b128 v[104:107], v6 offset:24576
    v_smfmac_f32_16x16x64_bf16 v[116:119], v[36:39], a[24:31], v3
    ds_read_b128 v[108:111], v6 offset:25600
    v_max3_u32 v15, v15, v32, v36
    v_smfmac_f32_16x16x64_bf16 v[120:123], v[36:39], v[136:143], v3
    s_waitcnt vmcnt(6) lgkmcnt(2)
    v_smfmac_f32_16x16x64_bf16 v[112:115], v[40:43], a[32:39], v3
    buffer_load_dwordx4 v[68:71], v2, s[8:11], s22 offen offset:1024 sc1
    v_smfmac_f32_16x16x64_bf16 v[124:127], v[40:43], v[96:103], v3
    ds_read_b128 v[16:19], v6 offset:32768
    v_smfmac_f32_16x16x64_bf16 v[116:119], v[40:43], a[40:47], v3
    ds_read_b128 v[20:23], v6 offset:33792
    v_smfmac_f32_16x16x64_bf16 v[120:123], v[40:43], v[144:151], v3
    s_waitcnt vmcnt(6) lgkmcnt(2)
    v_smfmac_f32_16x16x64_bf16 v[112:115], v[44:47], a[48:55], v3
    buffer_load_dwordx4 v[72:75], v2, s[8:11], s22 offen offset:2048 sc1
    v_smfmac_f32_16x16x64_bf16 v[124:127], v[44:47], v[104:111], v3
    ds_read_b128 v[96:99], v6 offset:40960
    v_smfmac_f32_16x16x64_bf16 v[116:119], v[44:47], a[56:63], v3
    ds_read_b128 v[100:103], v6 offset:41984
    v_max3_u32 v15, v15, v40, v44
    v_smfmac_f32_16x16x64_bf16 v[120:123], v[44:47], v[152:159], v3
    s_waitcnt vmcnt(6) lgkmcnt(2)
    v_smfmac_f32_16x16x64_bf16 v[112:115], v[48:51], a[64:71], v3
    buffer_load_dwordx4 v[76:79], v2, s[8:11], s22 offen offset:3072 sc1
    v_smfmac_f32_16x16x64_bf16 v[124:127], v[48:51], v[16:23], v3
    ds_read_b128 v[104:107], v6 offset:49152
    v_smfmac_f32_16x16x64_bf16 v[116:119], v[48:51], a[72:79], v3
    ds_read_b128 v[108:111], v6 offset:50176
    v_smfmac_f32_16x16x64_bf16 v[120:123], v[48:51], v[160:167], v3
    s_waitcnt vmcnt(6) lgkmcnt(2)
    v_smfmac_f32_16x16x64_bf16 v[112:115], v[52:55], a[80:87], v3
    v_smfmac_f32_16x16x64_bf16 v[124:127], v[52:55], v[96:103], v3
    ds_read_b128 v[16:19], v6 offset:57344
    v_smfmac_f32_16x16x64_bf16 v[116:119], v[52:55], a[88:95], v3
    ds_read_b128 v[20:23], v6 offset:58368
    v_max3_u32 v15, v15, v48, v52
    v_smfmac_f32_16x16x64_bf16 v[120:123], v[52:55], v[168:175], v3
    s_waitcnt vmcnt(5) lgkmcnt(2)
    v_smfmac_f32_16x16x64_bf16 v[112:115], v[56:59], a[96:103], v3
    v_smfmac_f32_16x16x64_bf16 v[124:127], v[56:59], v[104:111], v3
    ds_read_b128 v[96:99], v7 offset:0
    v_smfmac_f32_16x16x64_bf16 v[116:119], v[56:59], a[104:111], v3
    ds_read_b128 v[100:103], v7 offset:1024
    v_smfmac_f32_16x16x64_bf16 v[120:123], v[56:59], v[176:183], v3
    s_waitcnt vmcnt(4) lgkmcnt(2)
    v_smfmac_f32_16x16x64_bf16 v[112:115], v[60:63], a[112:119], v3
    v_smfmac_f32_16x16x64_bf16 v[124:127], v[60:63], v[16:23], v3
    ds_read_b128 v[104:107], v7 offset:8192
    v_smfmac_f32_16x16x64_bf16 v[116:119], v[60:63], a[120:127], v3
    ds_read_b128 v[108:111], v7 offset:9216
    v_max3_u32 v15, v15, v56, v60
    v_smfmac_f32_16x16x64_bf16 v[120:123], v[60:63], v[184:191], v3
    s_waitcnt vmcnt(3) lgkmcnt(2)
    v_smfmac_f32_16x16x64_bf16 v[112:115], v[64:67], a[128:135], v3
    v_smfmac_f32_16x16x64_bf16 v[124:127], v[64:67], v[96:103], v3
    ds_read_b128 v[16:19], v7 offset:16384
    v_smfmac_f32_16x16x64_bf16 v[116:119], v[64:67], a[136:143], v3
    ds_read_b128 v[20:23], v7 offset:17408
    v_smfmac_f32_16x16x64_bf16 v[120:123], v[64:67], v[192:199], v3
    s_waitcnt vmcnt(2) lgkmcnt(2)
    v_smfmac_f32_16x16x64_bf16 v[112:115], v[68:71], a[144:151], v3
    v_smfmac_f32_16x16x64_bf16 v[124:127], v[68:71], v[104:111], v3
    ds_read_b128 v[96:99], v7 offset:24576
    v_smfmac_f32_16x16x64_bf16 v[116:119], v[68:71], a[152:159], v3
    ds_read_b128 v[100:103], v7 offset:25600
    v_max3_u32 v15, v15, v64, v68
    v_smfmac_f32_16x16x64_bf16 v[120:123], v[68:71], v[200:207], v3
    s_waitcnt vmcnt(1) lgkmcnt(2)
    v_smfmac_f32_16x16x64_bf16 v[112:115], v[72:75], a[160:167], v3
    v_smfmac_f32_16x16x64_bf16 v[124:127], v[72:75], v[16:23], v3
    v_smfmac_f32_16x16x64_bf16 v[116:119], v[72:75], a[168:175], v3
    v_smfmac_f32_16x16x64_bf16 v[120:123], v[72:75], v[208:215], v3
    s_waitcnt vmcnt(0) lgkmcnt(0)
    v_smfmac_f32_16x16x64_bf16 v[112:115], v[76:79], a[176:183], v3
    v_max3_u32 v15, v15, v72, v76
    v_smfmac_f32_16x16x64_bf16 v[120:123], v[76:79], v[216:223], v3
    v_cmp_eq_u32 vcc, -1, v15
    v_smfmac_f32_16x16x64_bf16 v[116:119], v[76:79], a[184:191], v3
    v_smfmac_f32_16x16x64_bf16 v[124:127], v[76:79], v[96:103], v3
L_A_g1:
    s_cbranch_vccnz L_A_redo
    ds_read_b128 v[48:51], v1 offset:0
    ds_read_b128 v[52:55], v1 offset:1024
    ds_read_b128 v[56:59], v1 offset:8192
    ds_read_b128 v[60:63], v1 offset:9216
    s_nop 0
    v_cvt_pk_bf16_f32 v72, v112, v113
    v_cvt_pk_bf16_f32 v73, v114, v115
    v_cvt_pk_bf16_f32 v74, v120, v121
    v_cvt_pk_bf16_f32 v75, v122, v123
    v_cvt_pk_bf16_f32 v76, v116, v117
    v_cvt_pk_bf16_f32 v77, v118, v119
    v_mfma_f32_16x16x32_bf16 v[112:115], v[72:75], v[24:27], 0
    v_cvt_pk_bf16_f32 v78, v124, v125
    v_cvt_pk_bf16_f32 v79, v126, v127
    s_lshl_b32 s21, s26, 11
    s_add_u32 s20, s39, s21
    v_mfma_f32_16x16x32_bf16 v[116:119], v[76:79], v[24:27], 0
    s_add_u32 s24, s20, 106168320
    s_lshl_b32 s20, s19, 5
    s_add_u32 s20, s20, s26
    v_cvt_pk_bf16_f32 v68, v112, v113
    v_cvt_pk_bf16_f32 v69, v114, v115
    s_lshl_b32 s20, s20, 12
    s_add_u32 s20, s20, 94371840
    s_waitcnt lgkmcnt(0)
    v_cvt_pk_bf16_f32 v70, v116, v117
    v_cvt_pk_bf16_f32 v71, v118, v119
    v_mov_b32 v65, 0
    v_mov_b32 v67, 0
    v_mfma_f32_16x16x32_bf16 v[72:75], v[48:51], v[68:71], 0
    v_mfma_f32_16x16x32_bf16 v[76:79], v[52:55], v[68:71], 0
    v_mfma_f32_16x16x32_bf16 v[80:83], v[68:71], v[68:71], 0
    s_cmp_eq_u32 s19, 63
    s_cbranch_scc1 L_A_last
    s_nop 1
    s_add_u32 s29, s25, 106430464
    s_nop 0
    ds_write_b128 v13, v[72:75]
    ds_write_b128 v13, v[76:79] offset:1024
    ds_write_b128 v13, v[80:83] offset:2048
    s_waitcnt lgkmcnt(0)
    s_barrier
    ds_read_b128 v[84:87], v14 offset:0
    ds_read_b128 v[88:91], v14 offset:3072
    ds_read2st64_b32 v[104:105], v0 offset0:0 offset1:12
    ds_read_b128 v[92:95], v14 offset:6144
    ds_read_b128 v[96:99], v14 offset:9216
    ds_read2st64_b32 v[106:107], v0 offset0:24 offset1:36
    buffer_load_dword v64, v10, s[8:11], s24 offen sc1
    buffer_load_dword v66, v10, s[8:11], s24 offen offset:1024 sc1
    s_mov_b64 exec, s[36:37]
    buffer_store_dwordx4 v[68:71], v12, s[8:11], s20 offen sc1
    s_mov_b64 exec, -1
    s_waitcnt lgkmcnt(3)
    v_pk_add_f32 v[84:85], v[84:85], v[88:89]
    v_pk_add_f32 v[86:87], v[86:87], v[90:91]
    v_add_f32 v104, v104, v105
    s_waitcnt lgkmcnt(0)
    v_pk_add_f32 v[92:93], v[92:93], v[96:97]
    v_pk_add_f32 v[94:95], v[94:95], v[98:99]
    v_add_f32 v106, v106, v107
    v_pk_add_f32 v[84:85], v[84:85], v[92:93]
    v_pk_add_f32 v[86:87], v[86:87], v[94:95]
    v_add_f32 v104, v104, v106
    v_max3_f32 v88, v84, v85, v86
    v_max3_f32 v88, v88, v87, v104
    s_nop 1
    v_max_f32_dpp v88, v88, v88 row_ror:8 row_mask:0xf bank_mask:0xf
    v_mov_b32 v89, v88
    s_nop 0
    v_mov_b32 v97, 0
    v_permlane16_swap_b32 v88, v89
    v_max_f32 v88, v88, v89
    v_mov_b32 v89, v88
    s_nop 1
    v_permlane32_swap_b32 v88, v89
    v_max_f32 v88, v88, v89
    v_mul_f32 v88, s38, v88
    v_fma_f32 v84, v84, s38, -v88
    v_fma_f32 v85, v85, s38, -v88
    v_fma_f32 v86, v86, s38, -v88
    v_fma_f32 v87, v87, s38, -v88
    v_fma_f32 v104, v104, s38, -v88
    v_exp_f32 v104, v104
    v_exp_f32 v84, v84
    v_exp_f32 v85, v85
    v_exp_f32 v86, v86
    v_exp_f32 v87, v87
    v_mov_b32_dpp v105, v104 row_ror:8 row_mask:0xf bank_mask:0xf
    v_cvt_pk_bf16_f32 v92, v84, v85
    v_cvt_pk_bf16_f32 v93, v86, v87
    v_add_f32 v88, v84, v85
    v_mov_b32_dpp v94, v92 row_ror:8 row_mask:0xf bank_mask:0xf
    v_mov_b32_dpp v95, v93 row_ror:8 row_mask:0xf bank_mask:0xf
    v_cvt_pk_bf16_f32 v96, v104, v105
    v_add_f32 v86, v86, v87
    v_mfma_f32_16x16x32_bf16 v[72:75], v[56:59], v[92:95], 0
    s_waitcnt vmcnt(1)
    v_max_u32 v106, v64, v66
    v_cmp_eq_u32 vcc, -1, v106
    v_add_f32 v88, v88, v104
    v_mfma_f32_16x16x32_bf16 v[76:79], v[60:63], v[92:95], 0
    v_add_f32 v88, v88, v86
    s_cbranch_vccnz L_A_vmfix
L_A_vmok:
    v_mfma_f32_16x16x16_bf16 v[72:75], v[64:65], v[96:97], v[72:75]
    v_add_f32_dpp v88, v88, v88 row_ror:8 row_mask:0xf bank_mask:0xf
    v_mfma_f32_16x16x16_bf16 v[76:79], v[66:67], v[96:97], v[76:79]
    v_mov_b32 v89, v88
    s_cmp_lg_u32 s18, 0
    s_nop 0
    v_permlane16_swap_b32 v88, v89
    v_add_f32 v88, v88, v89
    v_mov_b32 v89, v88
    s_cbranch_scc1 L_A_slowpub
    s_nop 0
    v_permlane32_swap_b32 v88, v89
    v_add_f32 v88, v88, v89
    v_rcp_f32 v88, v88
    s_mov_b64 exec, s[34:35]
    v_pk_mul_f32 v[72:73], v[72:73], v[88:89] op_sel_hi:[1,0]
    v_pk_mul_f32 v[74:75], v[74:75], v[88:89] op_sel_hi:[1,0]
    v_pk_mul_f32 v[76:77], v[76:77], v[88:89] op_sel_hi:[1,0]
    v_pk_mul_f32 v[78:79], v[78:79], v[88:89] op_sel_hi:[1,0]
    v_cvt_pk_bf16_f32 v80, v72, v73
    v_cvt_pk_bf16_f32 v81, v74, v75
    v_cvt_pk_bf16_f32 v82, v76, v77
    v_cvt_pk_bf16_f32 v83, v78, v79
    buffer_store_dwordx4 v[80:83], v11, s[8:11], s29 offen
    s_branch L_A_pubd
L_A_slowpub:
    s_nop 0
    v_permlane32_swap_b32 v88, v89
    v_add_f32 v88, v88, v89
    v_rcp_f32 v88, v88
    s_mov_b64 exec, s[34:35]
    v_pk_mul_f32 v[72:73], v[72:73], v[88:89] op_sel_hi:[1,0]
    v_pk_mul_f32 v[74:75], v[74:75], v[88:89] op_sel_hi:[1,0]
    v_pk_mul_f32 v[76:77], v[76:77], v[88:89] op_sel_hi:[1,0]
    v_pk_mul_f32 v[78:79], v[78:79], v[88:89] op_sel_hi:[1,0]
    v_cvt_pk_bf16_f32 v80, v72, v73
    v_cvt_pk_bf16_f32 v81, v74, v75
    v_cvt_pk_bf16_f32 v82, v76, v77
    v_cvt_pk_bf16_f32 v83, v78, v79
    buffer_store_dwordx4 v[80:83], v11, s[8:11], s29 offen sc1
L_A_pubd:
    v_mov_b32 v72, -1
    v_mov_b32 v73, -1
    v_mov_b32 v74, -1
    v_mov_b32 v75, -1
    s_add_u32 s21, s25, 196608
    s_and_b32 s21, s21, 262143
    s_add_u32 s21, s21, 106430464
    s_cmp_lg_u32 s18, 0
    s_cbranch_scc1 ls_28
    buffer_store_dwordx4 v[72:75], v11, s[8:11], s21 offen
    s_branch ls_29
ls_28:
    buffer_store_dwordx4 v[72:75], v11, s[8:11], s21 offen sc1
ls_29:
    s_mov_b64 exec, -1
    s_waitcnt vmcnt(0)
    s_barrier
    s_cmp_lg_u32 s3, 0
    s_cbranch_scc1 Sd_30
    s_lshl_b32 s20, s19, 2
    s_add_u32 s20, s20, s16
    s_lshl_b32 s20, s20, 7
    s_add_u32 s20, s20, 113278976
    v_mov_b32 v60, 2
    s_mov_b64 exec, 1
    buffer_atomic_add v60, off, s[8:11], s20 sc1
    s_mov_b64 exec, -1
Sd_30:
    s_add_u32 s19, s19, 1
    s_and_b32 s20, s19, 7
    s_cbranch_scc1 Kw_31
Kc_33:
    s_lshr_b32 s20, s19, 3
    s_lshl_b32 s20, s20, 10
    s_lshr_b32 s21, s26, 1
    s_lshl_b32 s21, s21, 6
    s_add_u32 s20, s20, s21
    s_add_u32 s20, s20, 113262592
    s_mov_b32 s30, 0
    s_mov_b32 s21, 0xffff
    s_movk_i32 s22, 0x404
Kp_32:
    buffer_load_dword v15, off, s[8:11], s20 sc1
    s_waitcnt vmcnt(0)
    v_and_b32 v15, s21, v15
    v_cmp_ne_u32 vcc, s22, v15
    s_cbranch_vccz Kw_31
    s_sleep 4
    s_add_u32 s30, s30, 1
    s_cmp_lt_u32 s30, 65536
    s_cbranch_scc1 Kp_32
    s_branch L_abort
Kw_31:
    s_lshl_b32 s20, s19, 5
    s_add_u32 s20, s20, s26
    s_lshl_b32 s20, s20, 13
    s_add_u32 s21, s20, 38797312
    s_add_u32 s20, s20, 22020096
    s_add_u32 m0, s27, 143360
    s_nop 0
    buffer_load_dwordx4 v8, s[8:11], s20 offen sc1 lds
    s_add_u32 m0, s27, 151552
    s_nop 0
    buffer_load_dwordx4 v8, s[8:11], s21 offen sc1 lds
    s_add_u32 s20, s20, 4096
    s_add_u32 s21, s21, 4096
    s_add_u32 m0, s27, 144384
    s_nop 0
    buffer_load_dwordx4 v8, s[8:11], s20 offen sc1 lds
    s_add_u32 m0, s27, 152576
    s_nop 0
    buffer_load_dwordx4 v8, s[8:11], s21 offen sc1 lds
    s_branch L_A_step
L_A_vmfix:
    buffer_load_dword v64, v10, s[8:11], s24 offen sc1
    buffer_load_dword v66, v10, s[8:11], s24 offen offset:1024 sc1
    s_waitcnt vmcnt(0)
    v_max_u32 v89, v64, v66
    v_cmp_eq_u32 vcc, -1, v89
    s_cbranch_vccz L_A_vmok
    s_add_u32 s30, s30, 1
    s_cmp_lt_u32 s30, 65536
    s_cbranch_scc1 L_A_vmfix
    s_branch L_abort
L_A_last:
    s_mov_b64 exec, s[36:37]
    buffer_store_dwordx4 v[68:71], v12, s[8:11], s20 offen sc1
    s_mov_b64 exec, -1
    s_waitcnt vmcnt(0)
    s_barrier
    s_cmp_lg_u32 s3, 0
    s_cbranch_scc1 Sd_34
    s_lshl_b32 s20, s19, 2
    s_add_u32 s20, s20, s16
    s_lshl_b32 s20, s20, 7
    s_add_u32 s20, s20, 113278976
    v_mov_b32 v60, 2
    s_mov_b64 exec, 1
    buffer_atomic_add v60, off, s[8:11], s20 sc1
    s_mov_b64 exec, -1
Sd_34:
    s_branch L_retire
L_vr:
    s_sub_u32 s17, s17, 8
    s_lshl_b32 s26, s16, 3
    s_lshr_b32 s20, s17, 1
    s_add_u32 s26, s26, s20
    s_lshl_b32 s27, s3, 15
    v_lshrrev_b32 v2, 4, v1
    v_bfe_u32 v3, v1, 2, 2
    v_and_b32 v5, 3, v1
    v_lshlrev_b32 v5, 3, v5
    v_add_u32 v5, s27, v5
    v_and_b32 v6, 1, v2
    v_lshrrev_b32 v7, 1, v3
    v_lshl_or_b32 v8, v6, 1, v7
    v_lshl_add_u32 v4, v2, 3, v3
    v_lshl_add_u32 v9, v4, 7, v5
    v_lshrrev_b32 v4, 1, v2
    v_lshlrev_b32 v4, 3, v4
    v_lshl_add_u32 v4, v6, 6, v4
    v_lshl_add_u32 v4, v7, 2, v4
    v_and_b32 v10, 1, v3
    v_add_u32 v4, v4, v10
    v_lshl_add_u32 v10, v4, 7, v5
    v_xor_b32 v4, 0, v8
    v_lshlrev_b32 v4, 5, v4
    v_add_u32 v32, v9, v4
    v_add_u32 v36, v10, v4
    v_xor_b32 v4, 1, v8
    v_lshlrev_b32 v4, 5, v4
    v_add_u32 v33, v9, v4
    v_add_u32 v37, v10, v4
    v_xor_b32 v4, 2, v8
    v_lshlrev_b32 v4, 5, v4
    v_add_u32 v34, v9, v4
    v_add_u32 v38, v10, v4
    v_xor_b32 v4, 3, v8
    v_lshlrev_b32 v4, 5, v4
    v_add_u32 v35, v9, v4
    v_add_u32 v39, v10, v4
    v_lshrrev_b32 v11, 3, v1
    v_and_b32 v12, 7, v1
    v_bfe_u32 v4, v1, 4, 1
    v_lshlrev_b32 v4, 1, v4
    v_xor_b32 v12, v12, v4
    v_lshlrev_b32 v11, 13, v11
    v_lshlrev_b32 v12, 4, v12
    v_add_u32 v40, v11, v12
    v_xor_b32 v12, 64, v12
    v_add_u32 v41, v11, v12
    v_lshrrev_b32 v11, 3, v1
    v_and_b32 v12, 7, v1
    v_bfe_u32 v4, v1, 5, 1
    v_lshlrev_b32 v4, 1, v4
    v_xor_b32 v12, v12, v4
    v_lshlrev_b32 v11, 11, v11
    v_lshlrev_b32 v12, 4, v12
    v_add_u32 v42, v11, v12
    v_xor_b32 v12, 64, v12
    v_add_u32 v43, v11, v12
    v_lshrrev_b32 v11, 2, v1
    v_lshlrev_b32 v11, 13, v11
    v_lshrrev_b32 v12, 5, v1
    v_lshlrev_b32 v12, 1, v12
    v_and_b32 v4, 3, v1
    v_xor_b32 v12, v12, v4
    v_lshl_add_u32 v44, v12, 4, v11
    v_lshl_add_u32 v4, v2, 3, v3
    v_lshl_add_u32 v4, v4, 6, v5
    v_lshl_add_u32 v45, v6, 5, v4
    v_xor_b32 v46, 32, v45
    s_mov_b32 s12, s48
    s_and_b32 s13, s49, 0xffff
    s_mov_b32 s14, 8388608
    s_mov_b32 s15, 0x20000
    s_lshl_b32 s22, s26, 8
    s_and_b32 s20, s17, 1
    s_lshl_b32 s20, s20, 7
    s_add_u32 s22, s22, s20
    s_lshl_b32 s20, s3, 21
    s_add_u32 s22, s22, s20
    s_add_u32 s22, s22, 0
    s_add_u32 m0, s27, 0
    s_nop 0
    buffer_load_dwordx4 v40, s[12:15], s22 offen lds
    s_add_u32 s22, s22, 65536
    s_add_u32 m0, s27, 1024
    s_nop 0
    buffer_load_dwordx4 v41, s[12:15], s22 offen lds
    s_add_u32 s22, s22, 65536
    s_add_u32 m0, s27, 2048
    s_nop 0
    buffer_load_dwordx4 v40, s[12:15], s22 offen lds
    s_add_u32 s22, s22, 65536
    s_add_u32 m0, s27, 3072
    s_nop 0
    buffer_load_dwordx4 v41, s[12:15], s22 offen lds
    s_add_u32 s22, s22, 65536
    s_add_u32 m0, s27, 4096
    s_nop 0
    buffer_load_dwordx4 v40, s[12:15], s22 offen lds
    s_add_u32 s22, s22, 65536
    s_add_u32 m0, s27, 5120
    s_nop 0
    buffer_load_dwordx4 v41, s[12:15], s22 offen lds
    s_add_u32 s22, s22, 65536
    s_waitcnt vmcnt(6)
    s_barrier
    s_cmp_lg_u32 s3, 0
    s_cbranch_scc1 Ia_35
    v_mov_b32 v61, s101
    s_lshl_b32 s21, s2, 2
    s_add_u32 s21, s21, 112198656
    s_mov_b64 exec, 1
    buffer_store_dword v61, off, s[8:11], s21 sc1
    s_mov_b64 exec, -1
Ia_35:
    s_add_u32 m0, s27, 6144
    s_nop 0
    buffer_load_dwordx4 v40, s[12:15], s22 offen lds
    s_add_u32 s22, s22, 65536
    s_add_u32 m0, s27, 7168
    s_nop 0
    buffer_load_dwordx4 v41, s[12:15], s22 offen lds
    s_add_u32 s22, s22, 65536
    s_add_u32 m0, s27, 8192
    s_nop 0
    buffer_load_dwordx4 v40, s[12:15], s22 offen lds
    s_add_u32 s22, s22, 65536
    s_add_u32 m0, s27, 9216
    s_nop 0
    buffer_load_dwordx4 v41, s[12:15], s22 offen lds
    s_add_u32 s22, s22, 65536
    s_add_u32 m0, s27, 10240
    s_nop 0
    buffer_load_dwordx4 v40, s[12:15], s22 offen lds
    s_add_u32 s22, s22, 65536
    s_add_u32 m0, s27, 11264
    s_nop 0
    buffer_load_dwordx4 v41, s[12:15], s22 offen lds
    s_add_u32 s22, s22, 65536
    s_add_u32 m0, s27, 12288
    s_nop 0
    buffer_load_dwordx4 v40, s[12:15], s22 offen lds
    s_add_u32 s22, s22, 65536
    s_add_u32 m0, s27, 13312
    s_nop 0
    buffer_load_dwordx4 v41, s[12:15], s22 offen lds
    s_add_u32 s22, s22, 65536
    s_add_u32 m0, s27, 14336
    s_nop 0
    buffer_load_dwordx4 v40, s[12:15], s22 offen lds
    s_add_u32 s22, s22, 65536
    s_add_u32 m0, s27, 15360
    s_nop 0
    buffer_load_dwordx4 v41, s[12:15], s22 offen lds
    s_add_u32 s22, s22, 65536
    s_mov_b32 s12, s48
    s_and_b32 s13, s49, 0xffff
    s_mov_b32 s14, 8388608
    s_mov_b32 s15, 0x20000
    s_lshl_b32 s22, s26, 8
    s_and_b32 s20, s17, 1
    s_lshl_b32 s20, s20, 7
    s_add_u32 s22, s22, s20
    s_lshl_b32 s20, s3, 21
    s_add_u32 s22, s22, s20
    s_add_u32 s22, s22, 1048576
    s_add_u32 m0, s27, 16384
    s_nop 0
    buffer_load_dwordx4 v40, s[12:15], s22 offen lds
    s_add_u32 s22, s22, 65536
    s_add_u32 m0, s27, 17408
    s_nop 0
    buffer_load_dwordx4 v41, s[12:15], s22 offen lds
    s_add_u32 s22, s22, 65536
    s_add_u32 m0, s27, 18432
    s_nop 0
    buffer_load_dwordx4 v40, s[12:15], s22 offen lds
    s_add_u32 s22, s22, 65536
    s_add_u32 m0, s27, 19456
    s_nop 0
    buffer_load_dwordx4 v41, s[12:15], s22 offen lds
    s_add_u32 s22, s22, 65536
    s_add_u32 m0, s27, 20480
    s_nop 0
    buffer_load_dwordx4 v40, s[12:15], s22 offen lds
    s_add_u32 s22, s22, 65536
    s_add_u32 m0, s27, 21504
    s_nop 0
    buffer_load_dwordx4 v41, s[12:15], s22 offen lds
    s_add_u32 s22, s22, 65536
    s_add_u32 m0, s27, 22528
    s_nop 0
    buffer_load_dwordx4 v40, s[12:15], s22 offen lds
    s_add_u32 s22, s22, 65536
    s_add_u32 m0, s27, 23552
    s_nop 0
    buffer_load_dwordx4 v41, s[12:15], s22 offen lds
    s_add_u32 s22, s22, 65536
    s_add_u32 m0, s27, 24576
    s_nop 0
    buffer_load_dwordx4 v40, s[12:15], s22 offen lds
    s_add_u32 s22, s22, 65536
    s_add_u32 m0, s27, 25600
    s_nop 0
    buffer_load_dwordx4 v41, s[12:15], s22 offen lds
    s_add_u32 s22, s22, 65536
    s_add_u32 m0, s27, 26624
    s_nop 0
    buffer_load_dwordx4 v40, s[12:15], s22 offen lds
    s_add_u32 s22, s22, 65536
    s_add_u32 m0, s27, 27648
    s_nop 0
    buffer_load_dwordx4 v41, s[12:15], s22 offen lds
    s_add_u32 s22, s22, 65536
    s_add_u32 m0, s27, 28672
    s_nop 0
    buffer_load_dwordx4 v40, s[12:15], s22 offen lds
    s_add_u32 s22, s22, 65536
    s_add_u32 m0, s27, 29696
    s_nop 0
    buffer_load_dwordx4 v41, s[12:15], s22 offen lds
    s_add_u32 s22, s22, 65536
    s_add_u32 m0, s27, 30720
    s_nop 0
    buffer_load_dwordx4 v40, s[12:15], s22 offen lds
    s_add_u32 s22, s22, 65536
    s_add_u32 m0, s27, 31744
    s_nop 0
    buffer_load_dwordx4 v41, s[12:15], s22 offen lds
    s_add_u32 s22, s22, 65536
    s_waitcnt vmcnt(16)
    ds_read_b64_tr_b16 a[0:1], v32 offset:0
    ds_read_b64_tr_b16 a[2:3], v32 offset:512
    ds_read_b64_tr_b16 a[4:5], v32 offset:4096
    ds_read_b64_tr_b16 a[6:7], v32 offset:4608
    ds_read_b64_tr_b16 a[8:9], v33 offset:0
    ds_read_b64_tr_b16 a[10:11], v33 offset:512
    ds_read_b64_tr_b16 a[12:13], v33 offset:4096
    ds_read_b64_tr_b16 a[14:15], v33 offset:4608
    ds_read_b64_tr_b16 a[16:17], v34 offset:0
    ds_read_b64_tr_b16 a[18:19], v34 offset:512
    ds_read_b64_tr_b16 a[20:21], v34 offset:4096
    ds_read_b64_tr_b16 a[22:23], v34 offset:4608
    ds_read_b64_tr_b16 a[24:25], v35 offset:0
    ds_read_b64_tr_b16 a[26:27], v35 offset:512
    ds_read_b64_tr_b16 a[28:29], v35 offset:4096
    ds_read_b64_tr_b16 a[30:31], v35 offset:4608
    s_waitcnt lgkmcnt(0)
    ds_read_b64_tr_b16 a[32:33], v32 offset:8192
    ds_read_b64_tr_b16 a[34:35], v32 offset:8704
    ds_read_b64_tr_b16 a[36:37], v32 offset:12288
    ds_read_b64_tr_b16 a[38:39], v32 offset:12800
    ds_read_b64_tr_b16 a[40:41], v33 offset:8192
    ds_read_b64_tr_b16 a[42:43], v33 offset:8704
    ds_read_b64_tr_b16 a[44:45], v33 offset:12288
    ds_read_b64_tr_b16 a[46:47], v33 offset:12800
    ds_read_b64_tr_b16 a[48:49], v34 offset:8192
    ds_read_b64_tr_b16 a[50:51], v34 offset:8704
    ds_read_b64_tr_b16 a[52:53], v34 offset:12288
    ds_read_b64_tr_b16 a[54:55], v34 offset:12800
    ds_read_b64_tr_b16 a[56:57], v35 offset:8192
    ds_read_b64_tr_b16 a[58:59], v35 offset:8704
    ds_read_b64_tr_b16 a[60:61], v35 offset:12288
    ds_read_b64_tr_b16 a[62:63], v35 offset:12800
    s_waitcnt lgkmcnt(0)
    s_mov_b32 s12, s50
    s_and_b32 s13, s51, 0xffff
    s_mov_b32 s14, 8388608
    s_mov_b32 s15, 0x20000
    s_lshl_b32 s22, s16, 21
    s_lshl_b32 s20, s3, 19
    s_add_u32 s22, s22, s20
    s_lshl_b32 s20, s17, 7
    s_add_u32 s22, s22, s20
    s_add_u32 s22, s22, 0
    s_add_u32 m0, s27, 0
    s_nop 0
    buffer_load_dwordx4 v42, s[12:15], s22 offen lds
    s_add_u32 s22, s22, 16384
    s_add_u32 m0, s27, 1024
    s_nop 0
    buffer_load_dwordx4 v42, s[12:15], s22 offen lds
    s_add_u32 s22, s22, 16384
    s_add_u32 m0, s27, 2048
    s_nop 0
    buffer_load_dwordx4 v42, s[12:15], s22 offen lds
    s_add_u32 s22, s22, 16384
    s_add_u32 m0, s27, 3072
    s_nop 0
    buffer_load_dwordx4 v42, s[12:15], s22 offen lds
    s_add_u32 s22, s22, 16384
    s_add_u32 m0, s27, 4096
    s_nop 0
    buffer_load_dwordx4 v42, s[12:15], s22 offen lds
    s_add_u32 s22, s22, 16384
    s_add_u32 m0, s27, 5120
    s_nop 0
    buffer_load_dwordx4 v42, s[12:15], s22 offen lds
    s_add_u32 s22, s22, 16384
    s_add_u32 m0, s27, 6144
    s_nop 0
    buffer_load_dwordx4 v42, s[12:15], s22 offen lds
    s_add_u32 s22, s22, 16384
    s_add_u32 m0, s27, 7168
    s_nop 0
    buffer_load_dwordx4 v42, s[12:15], s22 offen lds
    s_add_u32 s22, s22, 16384
    s_add_u32 m0, s27, 8192
    s_nop 0
    buffer_load_dwordx4 v43, s[12:15], s22 offen lds
    s_add_u32 s22, s22, 16384
    s_add_u32 m0, s27, 9216
    s_nop 0
    buffer_load_dwordx4 v43, s[12:15], s22 offen lds
    s_add_u32 s22, s22, 16384
    s_add_u32 m0, s27, 10240
    s_nop 0
    buffer_load_dwordx4 v43, s[12:15], s22 offen lds
    s_add_u32 s22, s22, 16384
    s_add_u32 m0, s27, 11264
    s_nop 0
    buffer_load_dwordx4 v43, s[12:15], s22 offen lds
    s_add_u32 s22, s22, 16384
    s_add_u32 m0, s27, 12288
    s_nop 0
    buffer_load_dwordx4 v43, s[12:15], s22 offen lds
    s_add_u32 s22, s22, 16384
    s_add_u32 m0, s27, 13312
    s_nop 0
    buffer_load_dwordx4 v43, s[12:15], s22 offen lds
    s_add_u32 s22, s22, 16384
    s_add_u32 m0, s27, 14336
    s_nop 0
    buffer_load_dwordx4 v43, s[12:15], s22 offen lds
    s_add_u32 s22, s22, 16384
    s_add_u32 m0, s27, 15360
    s_nop 0
    buffer_load_dwordx4 v43, s[12:15], s22 offen lds
    s_add_u32 s22, s22, 16384
    s_waitcnt vmcnt(16)
    ds_read_b64_tr_b16 a[64:65], v32 offset:16384
    ds_read_b64_tr_b16 a[66:67], v32 offset:16896
    ds_read_b64_tr_b16 a[68:69], v32 offset:20480
    ds_read_b64_tr_b16 a[70:71], v32 offset:20992
    ds_read_b64_tr_b16 a[72:73], v33 offset:16384
    ds_read_b64_tr_b16 a[74:75], v33 offset:16896
    ds_read_b64_tr_b16 a[76:77], v33 offset:20480
    ds_read_b64_tr_b16 a[78:79], v33 offset:20992
    ds_read_b64_tr_b16 a[80:81], v34 offset:16384
    ds_read_b64_tr_b16 a[82:83], v34 offset:16896
    ds_read_b64_tr_b16 a[84:85], v34 offset:20480
    ds_read_b64_tr_b16 a[86:87], v34 offset:20992
    ds_read_b64_tr_b16 a[88:89], v35 offset:16384
    ds_read_b64_tr_b16 a[90:91], v35 offset:16896
    ds_read_b64_tr_b16 a[92:93], v35 offset:20480
    ds_read_b64_tr_b16 a[94:95], v35 offset:20992
    s_waitcnt lgkmcnt(0)
    ds_read_b64_tr_b16 a[96:97], v32 offset:24576
    ds_read_b64_tr_b16 a[98:99], v32 offset:25088
    ds_read_b64_tr_b16 a[100:101], v32 offset:28672
    ds_read_b64_tr_b16 a[102:103], v32 offset:29184
    ds_read_b64_tr_b16 a[104:105], v33 offset:24576
    ds_read_b64_tr_b16 a[106:107], v33 offset:25088
    ds_read_b64_tr_b16 a[108:109], v33 offset:28672
    ds_read_b64_tr_b16 a[110:111], v33 offset:29184
    ds_read_b64_tr_b16 a[112:113], v34 offset:24576
    ds_read_b64_tr_b16 a[114:115], v34 offset:25088
    ds_read_b64_tr_b16 a[116:117], v34 offset:28672
    ds_read_b64_tr_b16 a[118:119], v34 offset:29184
    ds_read_b64_tr_b16 a[120:121], v35 offset:24576
    ds_read_b64_tr_b16 a[122:123], v35 offset:25088
    ds_read_b64_tr_b16 a[124:125], v35 offset:28672
    ds_read_b64_tr_b16 a[126:127], v35 offset:29184
    s_waitcnt lgkmcnt(0)
    s_mov_b32 s12, s50
    s_and_b32 s13, s51, 0xffff
    s_mov_b32 s14, 8388608
    s_mov_b32 s15, 0x20000
    s_lshl_b32 s22, s16, 21
    s_lshl_b32 s20, s3, 19
    s_add_u32 s22, s22, s20
    s_lshl_b32 s20, s17, 7
    s_add_u32 s22, s22, s20
    s_add_u32 s22, s22, 262144
    s_add_u32 m0, s27, 16384
    s_nop 0
    buffer_load_dwordx4 v42, s[12:15], s22 offen lds
    s_add_u32 s22, s22, 16384
    s_add_u32 m0, s27, 17408
    s_nop 0
    buffer_load_dwordx4 v42, s[12:15], s22 offen lds
    s_add_u32 s22, s22, 16384
    s_add_u32 m0, s27, 18432
    s_nop 0
    buffer_load_dwordx4 v42, s[12:15], s22 offen lds
    s_add_u32 s22, s22, 16384
    s_add_u32 m0, s27, 19456
    s_nop 0
    buffer_load_dwordx4 v42, s[12:15], s22 offen lds
    s_add_u32 s22, s22, 16384
    s_add_u32 m0, s27, 20480
    s_nop 0
    buffer_load_dwordx4 v42, s[12:15], s22 offen lds
    s_add_u32 s22, s22, 16384
    s_add_u32 m0, s27, 21504
    s_nop 0
    buffer_load_dwordx4 v42, s[12:15], s22 offen lds
    s_add_u32 s22, s22, 16384
    s_add_u32 m0, s27, 22528
    s_nop 0
    buffer_load_dwordx4 v42, s[12:15], s22 offen lds
    s_add_u32 s22, s22, 16384
    s_add_u32 m0, s27, 23552
    s_nop 0
    buffer_load_dwordx4 v42, s[12:15], s22 offen lds
    s_add_u32 s22, s22, 16384
    s_add_u32 m0, s27, 24576
    s_nop 0
    buffer_load_dwordx4 v43, s[12:15], s22 offen lds
    s_add_u32 s22, s22, 16384
    s_add_u32 m0, s27, 25600
    s_nop 0
    buffer_load_dwordx4 v43, s[12:15], s22 offen lds
    s_add_u32 s22, s22, 16384
    s_add_u32 m0, s27, 26624
    s_nop 0
    buffer_load_dwordx4 v43, s[12:15], s22 offen lds
    s_add_u32 s22, s22, 16384
    s_add_u32 m0, s27, 27648
    s_nop 0
    buffer_load_dwordx4 v43, s[12:15], s22 offen lds
    s_add_u32 s22, s22, 16384
    s_add_u32 m0, s27, 28672
    s_nop 0
    buffer_load_dwordx4 v43, s[12:15], s22 offen lds
    s_add_u32 s22, s22, 16384
    s_add_u32 m0, s27, 29696
    s_nop 0
    buffer_load_dwordx4 v43, s[12:15], s22 offen lds
    s_add_u32 s22, s22, 16384
    s_add_u32 m0, s27, 30720
    s_nop 0
    buffer_load_dwordx4 v43, s[12:15], s22 offen lds
    s_add_u32 s22, s22, 16384
    s_add_u32 m0, s27, 31744
    s_nop 0
    buffer_load_dwordx4 v43, s[12:15], s22 offen lds
    s_add_u32 s22, s22, 16384
    s_waitcnt vmcnt(16)
    ds_read_b64_tr_b16 a[128:129], v36 offset:0
    ds_read_b64_tr_b16 a[130:131], v36 offset:256
    ds_read_b64_tr_b16 a[132:133], v36 offset:2048
    ds_read_b64_tr_b16 a[134:135], v36 offset:2304
    ds_read_b64_tr_b16 a[136:137], v37 offset:0
    ds_read_b64_tr_b16 a[138:139], v37 offset:256
    ds_read_b64_tr_b16 a[140:141], v37 offset:2048
    ds_read_b64_tr_b16 a[142:143], v37 offset:2304
    ds_read_b64_tr_b16 a[144:145], v38 offset:0
    ds_read_b64_tr_b16 a[146:147], v38 offset:256
    ds_read_b64_tr_b16 a[148:149], v38 offset:2048
    ds_read_b64_tr_b16 a[150:151], v38 offset:2304
    ds_read_b64_tr_b16 a[152:153], v39 offset:0
    ds_read_b64_tr_b16 a[154:155], v39 offset:256
    ds_read_b64_tr_b16 a[156:157], v39 offset:2048
    ds_read_b64_tr_b16 a[158:159], v39 offset:2304
    s_waitcnt lgkmcnt(0)
    ds_read_b64_tr_b16 a[160:161], v36 offset:4096
    ds_read_b64_tr_b16 a[162:163], v36 offset:4352
    ds_read_b64_tr_b16 a[164:165], v36 offset:6144
    ds_read_b64_tr_b16 a[166:167], v36 offset:6400
    ds_read_b64_tr_b16 a[168:169], v37 offset:4096
    ds_read_b64_tr_b16 a[170:171], v37 offset:4352
    ds_read_b64_tr_b16 a[172:173], v37 offset:6144
    ds_read_b64_tr_b16 a[174:175], v37 offset:6400
    ds_read_b64_tr_b16 a[176:177], v38 offset:4096
    ds_read_b64_tr_b16 a[178:179], v38 offset:4352
    ds_read_b64_tr_b16 a[180:181], v38 offset:6144
    ds_read_b64_tr_b16 a[182:183], v38 offset:6400
    ds_read_b64_tr_b16 a[184:185], v39 offset:4096
    ds_read_b64_tr_b16 a[186:187], v39 offset:4352
    ds_read_b64_tr_b16 a[188:189], v39 offset:6144
    ds_read_b64_tr_b16 a[190:191], v39 offset:6400
    s_waitcnt lgkmcnt(0)
    s_waitcnt vmcnt(0)
    ds_read_b64_tr_b16 a[192:193], v36 offset:16384
    ds_read_b64_tr_b16 a[194:195], v36 offset:16640
    ds_read_b64_tr_b16 a[196:197], v36 offset:18432
    ds_read_b64_tr_b16 a[198:199], v36 offset:18688
    ds_read_b64_tr_b16 a[200:201], v37 offset:16384
    ds_read_b64_tr_b16 a[202:203], v37 offset:16640
    ds_read_b64_tr_b16 a[204:205], v37 offset:18432
    ds_read_b64_tr_b16 a[206:207], v37 offset:18688
    ds_read_b64_tr_b16 a[208:209], v38 offset:16384
    ds_read_b64_tr_b16 a[210:211], v38 offset:16640
    ds_read_b64_tr_b16 a[212:213], v38 offset:18432
    ds_read_b64_tr_b16 a[214:215], v38 offset:18688
    ds_read_b64_tr_b16 a[216:217], v39 offset:16384
    ds_read_b64_tr_b16 a[218:219], v39 offset:16640
    ds_read_b64_tr_b16 a[220:221], v39 offset:18432
    ds_read_b64_tr_b16 a[222:223], v39 offset:18688
    s_waitcnt lgkmcnt(0)
    ds_read_b64_tr_b16 a[224:225], v36 offset:20480
    ds_read_b64_tr_b16 a[226:227], v36 offset:20736
    ds_read_b64_tr_b16 a[228:229], v36 offset:22528
    ds_read_b64_tr_b16 a[230:231], v36 offset:22784
    ds_read_b64_tr_b16 a[232:233], v37 offset:20480
    ds_read_b64_tr_b16 a[234:235], v37 offset:20736
    ds_read_b64_tr_b16 a[236:237], v37 offset:22528
    ds_read_b64_tr_b16 a[238:239], v37 offset:22784
    ds_read_b64_tr_b16 a[240:241], v38 offset:20480
    ds_read_b64_tr_b16 a[242:243], v38 offset:20736
    ds_read_b64_tr_b16 a[244:245], v38 offset:22528
    ds_read_b64_tr_b16 a[246:247], v38 offset:22784
    ds_read_b64_tr_b16 a[248:249], v39 offset:20480
    ds_read_b64_tr_b16 a[250:251], v39 offset:20736
    ds_read_b64_tr_b16 a[252:253], v39 offset:22528
    ds_read_b64_tr_b16 a[254:255], v39 offset:22784
    s_waitcnt lgkmcnt(0)
    s_barrier
    v_bfe_u32 v3, v1, 3, 1
    v_mov_b32 v15, 0x44444444
    v_mul_u32_u24 v3, 0xaaaa, v3
    v_lshl_or_b32 v3, v3, 16, v3
    v_add_u32 v3, v15, v3
    v_lshlrev_b32 v4, 4, v1
    s_lshl_b32 s20, s3, 12
    v_add_u32 v5, s20, v4
    v_add_u32 v2, s20, v4
    s_and_b32 s21, s3, 1
    s_lshl_b32 s22, s21, 10
    v_lshrrev_b32 v14, 5, v1
    v_add_u32 v6, s22, v4
    v_and_b32 v15, 15, v1
    v_lshl_add_u32 v15, v14, 4, v15
    v_lshlrev_b32 v15, 4, v15
    v_bfe_u32 v14, v1, 4, 1
    v_lshl_add_u32 v9, v14, 3, v15
    s_lshl_b32 s22, s21, 9
    s_and_b32 s23, s17, 1
    s_lshl_b32 s23, s23, 10
    s_add_u32 s22, s22, s23
    v_add_u32 v9, s22, v9
    s_mul_i32 s22, s3, 2368
    s_add_u32 s22, s22, 16384
    v_lshrrev_b32 v14, 5, v1
    v_mul_u32_u24 v7, 288, v14
    v_bfe_u32 v14, v1, 3, 1
    v_mul_u32_u24 v14, 1184, v14
    v_add_u32 v7, v7, v14
    v_bfe_u32 v14, v1, 1, 1
    v_mul_u32_u24 v14, 144, v14
    v_add_u32 v7, v7, v14
    v_bfe_u32 v14, v1, 4, 1
    v_lshl_add_u32 v7, v14, 6, v7
    v_bfe_u32 v14, v1, 2, 1
    v_lshl_add_u32 v7, v14, 3, v7
    v_and_b32 v14, 1, v1
    v_lshl_add_u32 v7, v14, 2, v7
    v_add_u32 v7, s22, v7
    s_mul_i32 s22, s21, 1184
    s_add_u32 s22, s22, 16384
    v_lshrrev_b32 v14, 4, v1
    v_mul_u32_u24 v8, 288, v14
    v_bfe_u32 v14, v1, 3, 1
    v_mul_u32_u24 v14, 144, v14
    v_add_u32 v8, v8, v14
    v_and_b32 v14, 7, v1
    v_lshl_add_u32 v8, v14, 4, v8
    v_add_u32 v12, 16384, v8
    v_add_u32 v8, s22, v8
    s_lshl_b32 s22, s17, 14
    s_add_u32 s23, s16, 1
    s_and_b32 s23, s23, 3
    s_lshl_b32 s23, s23, 11
    s_add_u32 s23, s23, s22
    v_add_u32 v16, s23, v4
    s_add_u32 s23, s16, 2
    s_and_b32 s23, s23, 3
    s_lshl_b32 s23, s23, 11
    s_add_u32 s23, s23, s22
    v_add_u32 v17, s23, v4
    s_add_u32 s23, s16, 3
    s_and_b32 s23, s23, 3
    s_lshl_b32 s23, s23, 11
    s_add_u32 s23, s23, s22
    v_add_u32 v18, s23, v4
    s_lshl_b32 s23, s21, 10
    s_add_u32 s22, s22, s23
    s_lshl_b32 s23, s16, 11
    s_add_u32 s22, s22, s23
    v_add_u32 v10, s22, v4
    s_lshl_b32 s22, s17, 10
    v_add_u32 v13, s22, v4
    s_mul_i32 s22, s3, 1152
    s_add_u32 s22, s22, 40960
    v_bfe_u32 v14, v1, 4, 1
    v_mul_u32_u24 v19, 576, v14
    v_and_b32 v14, 15, v1
    v_lshl_add_u32 v19, v14, 2, v19
    v_lshrrev_b32 v14, 5, v1
    v_lshl_add_u32 v19, v14, 6, v19
    v_add_u32 v19, s22, v19
    v_and_b32 v14, 7, v1
    v_mul_u32_u24 v20, 144, v14
    v_lshrrev_b32 v14, 3, v1
    v_lshl_add_u32 v20, v14, 4, v20
    v_add_u32 v20, 40960, v20
    s_and_b32 s22, s17, 1
    s_lshl_b32 s22, s22, 9
    s_lshl_b32 s23, s26, 10
    s_add_u32 s22, s22, s23
    v_lshlrev_b32 v21, 3, v1
    v_add_u32 v21, s22, v21
    v_mov_b32 v96, -1
    v_mov_b32 v97, -1
    v_mov_b32 v98, -1
    v_mov_b32 v99, -1
    v_and_b32 v23, 7, v1
    v_lshlrev_b32 v23, 9, v23
    s_lshl_b32 s22, s3, 12
    v_add_u32 v23, s22, v23
    s_mov_b32 s20, s64
    s_and_b32 s21, s65, 0xffff
    s_mov_b32 s22, 256
    s_mov_b32 s23, 0x20000
    s_mov_b32 s30, 0
    s_mov_b32 s24, 192
Ip_36:
    buffer_load_dword v14, off, s[20:23], s24 sc1
    s_waitcnt vmcnt(0)
    v_cmp_ne_u32 vcc, s101, v14
    s_cbranch_vccz Ig_37
    s_sleep 4
    s_add_u32 s30, s30, 1
    s_cmp_lt_u32 s30, 65536
    s_cbranch_scc1 Ip_36
    s_branch L_abort
Ig_37:
    s_or_b32 s22, s16, s17
    s_or_b32 s22, s22, s3
    s_cmp_lg_u32 s22, 0
    s_cbranch_scc1 Cal_38
    s_mov_b32 s34, 0x100
    s_mov_b32 s23, 104857600
    s_memtime s[36:37]
    s_waitcnt lgkmcnt(0)
    buffer_load_dword v14, off, s[8:11], s23 sc1
    s_waitcnt vmcnt(0)
    s_memtime s[38:39]
    s_waitcnt lgkmcnt(0)
    s_sub_u32 s36, s38, s36
    s_mov_b32 s20, s36
    s_mov_b32 s23, 104875008
    s_memtime s[36:37]
    s_waitcnt lgkmcnt(0)
    buffer_load_dword v14, off, s[8:11], s23 sc1
    s_waitcnt vmcnt(0)
    s_memtime s[38:39]
    s_waitcnt lgkmcnt(0)
    s_sub_u32 s36, s38, s36
    s_min_u32 s20, s20, s36
    s_mov_b32 s23, 104892416
    s_memtime s[36:37]
    s_waitcnt lgkmcnt(0)
    buffer_load_dword v14, off, s[8:11], s23 sc1
    s_waitcnt vmcnt(0)
    s_memtime s[38:39]
    s_waitcnt lgkmcnt(0)
    s_sub_u32 s36, s38, s36
    s_min_u32 s20, s20, s36
    s_mov_b32 s23, 104909824
    s_memtime s[36:37]
    s_waitcnt lgkmcnt(0)
    buffer_load_dword v14, off, s[8:11], s23 sc1
    s_waitcnt vmcnt(0)
    s_memtime s[38:39]
    s_waitcnt lgkmcnt(0)
    s_sub_u32 s36, s38, s36
    s_min_u32 s20, s20, s36
    s_mov_b32 s23, 104865792
    s_memtime s[36:37]
    s_waitcnt lgkmcnt(0)
    buffer_load_dword v14, off, s[8:11], s23 sc1
    s_waitcnt vmcnt(0)
    s_memtime s[38:39]
    s_waitcnt lgkmcnt(0)
    s_sub_u32 s36, s38, s36
    s_mov_b32 s21, s36
    s_mov_b32 s23, 104883200
    s_memtime s[36:37]
    s_waitcnt lgkmcnt(0)
    buffer_load_dword v14, off, s[8:11], s23 sc1
    s_waitcnt vmcnt(0)
    s_memtime s[38:39]
    s_waitcnt lgkmcnt(0)
    s_sub_u32 s36, s38, s36
    s_min_u32 s21, s21, s36
    s_mov_b32 s23, 104900608
    s_memtime s[36:37]
    s_waitcnt lgkmcnt(0)
    buffer_load_dword v14, off, s[8:11], s23 sc1
    s_waitcnt vmcnt(0)
    s_memtime s[38:39]
    s_waitcnt lgkmcnt(0)
    s_sub_u32 s36, s38, s36
    s_min_u32 s21, s21, s36
    s_mov_b32 s23, 104918016
    s_memtime s[36:37]
    s_waitcnt lgkmcnt(0)
    buffer_load_dword v14, off, s[8:11], s23 sc1
    s_waitcnt vmcnt(0)
    s_memtime s[38:39]
    s_waitcnt lgkmcnt(0)
    s_sub_u32 s36, s38, s36
    s_min_u32 s21, s21, s36
    s_cmp_lt_u32 s21, s20
    s_cselect_b32 s36, 1, 0
    s_or_b32 s34, s34, s36
    v_mov_b32 v14, s34
    s_mov_b32 s23, 113246208
    buffer_store_dword v14, off, s[8:11], s23 sc1
Cal_38:
    s_mov_b32 s30, 0
    s_mov_b32 s23, 113246208
Cal_39:
    buffer_load_dword v14, off, s[8:11], s23 sc1
    s_waitcnt vmcnt(0)
    v_readfirstlane_b32 s34, v14
    s_nop 3
    s_cmp_lg_u32 s34, 0
    s_cbranch_scc1 Cal_40
    s_sleep 8
    s_add_u32 s30, s30, 1
    s_cmp_lt_u32 s30, 65536
    s_cbranch_scc1 Cal_39
    s_branch L_abort
Cal_40:
    s_bfe_u32 s22, s34, 0x10000
    s_lshl_b32 s22, s22, 13
    s_add_u32 s52, s22, 104857600
    s_lshl_b32 s28, s16, 4
    s_add_u32 s28, s28, s17
    s_add_u32 s28, s28, 32
    s_mov_b32 s19, 0
L_VR_step:
    s_mov_b32 s30, 0
    s_and_b32 s35, s19, 3
    s_lshl_b32 s39, s35, 16
    s_lshl_b32 s21, s16, 14
    s_add_u32 s25, s39, s21
    s_add_u32 s20, s25, 105906176
    s_lshl_b32 s21, s26, 11
    s_add_u32 s24, s39, s21
    s_add_u32 s24, s24, 106168320
    s_lshl_b32 s21, s19, 5
    s_add_u32 s21, s21, s26
    s_lshl_b32 s21, s21, 12
    s_add_u32 s21, s21, 94373888
    s_lshl_b32 s29, s35, 15
    s_add_u32 s29, s29, 106692608
    v_mov_b32 v48, 0
    v_mov_b32 v49, 0
    v_mov_b32 v50, 0
    v_mov_b32 v51, 0
    v_mov_b32 v52, 0
    v_mov_b32 v53, 0
    v_mov_b32 v54, 0
    v_mov_b32 v55, 0
    v_mov_b32 v56, 0
    v_mov_b32 v57, 0
    v_mov_b32 v58, 0
    v_mov_b32 v59, 0
    v_mov_b32 v60, 0
    v_mov_b32 v61, 0
    v_mov_b32 v62, 0
    v_mov_b32 v63, 0
    buffer_load_dwordx4 v[32:35], v2, s[8:11], s20 offen offset:0 sc1
    buffer_load_dwordx4 v[36:39], v2, s[8:11], s20 offen offset:1024 sc1
    s_sleep 2
    buffer_load_dwordx4 v[40:43], v2, s[8:11], s20 offen offset:2048 sc1
    buffer_load_dwordx4 v[44:47], v2, s[8:11], s20 offen offset:3072 sc1
VRp_41:
    s_waitcnt vmcnt(2)
    v_max_u32 v15, v32, v36
    v_cmp_eq_u32 vcc, -1, v15
    s_cbranch_vccz VRf_42
    buffer_load_dwordx4 v[32:35], v2, s[8:11], s20 offen offset:0 sc1
    buffer_load_dwordx4 v[36:39], v2, s[8:11], s20 offen offset:1024 sc1
    s_waitcnt vmcnt(2)
    v_max_u32 v15, v40, v44
    v_cmp_eq_u32 vcc, -1, v15
    s_cbranch_vccz VRf_43
    buffer_load_dwordx4 v[40:43], v2, s[8:11], s20 offen offset:2048 sc1
    buffer_load_dwordx4 v[44:47], v2, s[8:11], s20 offen offset:3072 sc1
    s_add_u32 s30, s30, 1
    s_cmp_lt_u32 s30, 65536
    s_cbranch_scc1 VRp_41
    s_branch L_abort
VRf_42:
    v_smfmac_f32_16x16x64_bf16 v[48:51], v[32:35], a[0:7], v3
    v_smfmac_f32_16x16x64_bf16 v[52:55], v[32:35], a[8:15], v3
    v_smfmac_f32_16x16x64_bf16 v[56:59], v[32:35], a[16:23], v3
    v_smfmac_f32_16x16x64_bf16 v[60:63], v[32:35], a[24:31], v3
    v_smfmac_f32_16x16x64_bf16 v[48:51], v[36:39], a[32:39], v3
    v_smfmac_f32_16x16x64_bf16 v[52:55], v[36:39], a[40:47], v3
    v_smfmac_f32_16x16x64_bf16 v[56:59], v[36:39], a[48:55], v3
    v_smfmac_f32_16x16x64_bf16 v[60:63], v[36:39], a[56:63], v3
    s_waitcnt vmcnt(0)
    v_max_u32 v15, v40, v44
    v_cmp_eq_u32 vcc, -1, v15
    s_cbranch_vccz VRg_45
    buffer_load_dwordx4 v[40:43], v2, s[8:11], s20 offen offset:2048 sc1
    buffer_load_dwordx4 v[44:47], v2, s[8:11], s20 offen offset:3072 sc1
VRq_46:
    s_waitcnt vmcnt(0)
    v_max_u32 v15, v40, v44
    v_cmp_eq_u32 vcc, -1, v15
    s_cbranch_vccz VRg_45
    buffer_load_dwordx4 v[40:43], v2, s[8:11], s20 offen offset:2048 sc1
    buffer_load_dwordx4 v[44:47], v2, s[8:11], s20 offen offset:3072 sc1
    s_add_u32 s30, s30, 1
    s_cmp_lt_u32 s30, 65536
    s_cbranch_scc1 VRq_46
    s_branch L_abort
VRg_45:
    v_smfmac_f32_16x16x64_bf16 v[48:51], v[40:43], a[64:71], v3
    v_smfmac_f32_16x16x64_bf16 v[52:55], v[40:43], a[72:79], v3
    v_smfmac_f32_16x16x64_bf16 v[56:59], v[40:43], a[80:87], v3
    v_smfmac_f32_16x16x64_bf16 v[60:63], v[40:43], a[88:95], v3
    v_smfmac_f32_16x16x64_bf16 v[48:51], v[44:47], a[96:103], v3
    v_smfmac_f32_16x16x64_bf16 v[52:55], v[44:47], a[104:111], v3
    v_smfmac_f32_16x16x64_bf16 v[56:59], v[44:47], a[112:119], v3
    v_smfmac_f32_16x16x64_bf16 v[60:63], v[44:47], a[120:127], v3
    s_branch VRe_44
VRf_43:
    v_smfmac_f32_16x16x64_bf16 v[48:51], v[40:43], a[64:71], v3
    v_smfmac_f32_16x16x64_bf16 v[52:55], v[40:43], a[72:79], v3
    v_smfmac_f32_16x16x64_bf16 v[56:59], v[40:43], a[80:87], v3
    v_smfmac_f32_16x16x64_bf16 v[60:63], v[40:43], a[88:95], v3
    v_smfmac_f32_16x16x64_bf16 v[48:51], v[44:47], a[96:103], v3
    v_smfmac_f32_16x16x64_bf16 v[52:55], v[44:47], a[104:111], v3
    v_smfmac_f32_16x16x64_bf16 v[56:59], v[44:47], a[112:119], v3
    v_smfmac_f32_16x16x64_bf16 v[60:63], v[44:47], a[120:127], v3
    s_waitcnt vmcnt(0)
    v_max_u32 v15, v32, v36
    v_cmp_eq_u32 vcc, -1, v15
    s_cbranch_vccz VRg_47
    buffer_load_dwordx4 v[32:35], v2, s[8:11], s20 offen offset:0 sc1
    buffer_load_dwordx4 v[36:39], v2, s[8:11], s20 offen offset:1024 sc1
VRq_48:
    s_waitcnt vmcnt(0)
    v_max_u32 v15, v32, v36
    v_cmp_eq_u32 vcc, -1, v15
    s_cbranch_vccz VRg_47
    buffer_load_dwordx4 v[32:35], v2, s[8:11], s20 offen offset:0 sc1
    buffer_load_dwordx4 v[36:39], v2, s[8:11], s20 offen offset:1024 sc1
    s_add_u32 s30, s30, 1
    s_cmp_lt_u32 s30, 65536
    s_cbranch_scc1 VRq_48
    s_branch L_abort
VRg_47:
    v_smfmac_f32_16x16x64_bf16 v[48:51], v[32:35], a[0:7], v3
    v_smfmac_f32_16x16x64_bf16 v[52:55], v[32:35], a[8:15], v3
    v_smfmac_f32_16x16x64_bf16 v[56:59], v[32:35], a[16:23], v3
    v_smfmac_f32_16x16x64_bf16 v[60:63], v[32:35], a[24:31], v3
    v_smfmac_f32_16x16x64_bf16 v[48:51], v[36:39], a[32:39], v3
    v_smfmac_f32_16x16x64_bf16 v[52:55], v[36:39], a[40:47], v3
    v_smfmac_f32_16x16x64_bf16 v[56:59], v[36:39], a[48:55], v3
    v_smfmac_f32_16x16x64_bf16 v[60:63], v[36:39], a[56:63], v3
VRe_44:
    s_mov_b32 s20, s24
    s_nop 4
    v_permlane32_swap_b32 v48, v52
    v_permlane32_swap_b32 v49, v53
    v_permlane32_swap_b32 v50, v54
    v_permlane32_swap_b32 v51, v55
    v_pk_add_f32 v[48:49], v[48:49], v[52:53]
    v_pk_add_f32 v[50:51], v[50:51], v[54:55]
    ds_write_b128 v5, v[48:51] offset:0
    v_permlane32_swap_b32 v56, v60
    v_permlane32_swap_b32 v57, v61
    v_permlane32_swap_b32 v58, v62
    v_permlane32_swap_b32 v59, v63
    v_pk_add_f32 v[56:57], v[56:57], v[60:61]
    v_pk_add_f32 v[58:59], v[58:59], v[62:63]
    ds_write_b128 v5, v[56:59] offset:1024
    s_waitcnt lgkmcnt(0)
    s_barrier
    ds_read_b128 v[64:67], v6 offset:0
    ds_read_b128 v[68:71], v6 offset:4096
    ds_read_b128 v[72:75], v6 offset:8192
    ds_read_b128 v[76:79], v6 offset:12288
    s_waitcnt lgkmcnt(2)
    v_pk_add_f32 v[64:65], v[64:65], v[68:69]
    v_pk_add_f32 v[66:67], v[66:67], v[70:71]
    s_waitcnt lgkmcnt(0)
    v_pk_add_f32 v[72:73], v[72:73], v[76:77]
    v_pk_add_f32 v[74:75], v[74:75], v[78:79]
    v_pk_add_f32 v[64:65], v[64:65], v[72:73]
    v_pk_add_f32 v[66:67], v[66:67], v[74:75]
    v_cvt_pk_bf16_f32 v64, v64, v65
    v_cvt_pk_bf16_f32 v65, v66, v67
    s_cmp_ge_u32 s3, 2
    s_cbranch_scc1 VRk_49
    s_cmp_lg_u32 s18, 0
    s_cbranch_scc1 ls_51
    buffer_store_dwordx2 v[64:65], v9, s[8:11], s20 offen
    s_branch ls_52
ls_51:
    buffer_store_dwordx2 v[64:65], v9, s[8:11], s20 offen sc1
ls_52:
    s_branch VRe_50
VRk_49:
    buffer_store_dwordx2 v[64:65], v9, s[8:11], s21 offen sc1
VRe_50:
    s_cmp_eq_u32 s19, 63
    s_cbranch_scc1 L_VR_last
    s_add_u32 s22, s35, 2
    s_and_b32 s22, s22, 3
    s_lshl_b32 s22, s22, 18
    s_cmp_lt_u32 s19, 2
    s_cbranch_scc1 VRq_53
    s_cmp_ge_u32 s3, 2
    s_cbranch_scc1 VRq_54
    s_add_u32 s23, s22, s52
    buffer_store_dwordx4 v[96:99], v10, s[8:11], s23 offen sc1
VRq_54:
VRq_53:
    s_cmp_eq_u32 s19, 0
    s_cbranch_scc1 VRq_55
    s_cmp_lg_u32 s3, 3
    s_cbranch_scc1 VRq_56
    s_branch VRq_55
VRq_56:
    s_cmp_eq_u32 s3, 2
    s_cbranch_scc1 VRq_57
    s_sub_u32 s22, s20, 106168320
    s_add_u32 s22, s22, 196608
    s_and_b32 s22, s22, 262143
    s_add_u32 s22, s22, 106168320
    s_cmp_lg_u32 s18, 0
    s_cbranch_scc1 ls_58
    buffer_store_dwordx2 v[96:97], v9, s[8:11], s22 offen
    s_branch ls_59
ls_58:
    buffer_store_dwordx2 v[96:97], v9, s[8:11], s22 offen sc1
ls_59:
    s_branch VRq_55
VRq_57:
    s_add_u32 s22, s25, 196608
    s_and_b32 s22, s22, 262143
    s_add_u32 s22, s22, 105906176
    s_cmp_lg_u32 s18, 0
    s_cbranch_scc1 ls_60
    buffer_store_dwordx4 v[96:99], v13, s[8:11], s22 offen
    s_branch ls_61
ls_60:
    buffer_store_dwordx4 v[96:99], v13, s[8:11], s22 offen sc1
ls_61:
VRq_55:
    s_add_u32 s20, s25, 106430464
    s_lshl_b32 s21, s35, 18
    s_add_u32 s84, s21, s52
    s_add_u32 s22, s25, 65536
    s_and_b32 s22, s22, 262143
    s_add_u32 s22, s22, 105906176
    v_mov_b32 v48, 0
    v_mov_b32 v49, 0
    v_mov_b32 v50, 0
    v_mov_b32 v51, 0
    v_mov_b32 v52, 0
    v_mov_b32 v53, 0
    v_mov_b32 v54, 0
    v_mov_b32 v55, 0
    v_mov_b32 v56, 0
    v_mov_b32 v57, 0
    v_mov_b32 v58, 0
    v_mov_b32 v59, 0
    v_mov_b32 v60, 0
    v_mov_b32 v61, 0
    v_mov_b32 v62, 0
    v_mov_b32 v63, 0
    buffer_load_dwordx4 v[32:35], v2, s[8:11], s20 offen offset:0 sc1
    buffer_load_dwordx4 v[36:39], v2, s[8:11], s20 offen offset:1024 sc1
    s_sleep 2
    buffer_load_dwordx4 v[40:43], v2, s[8:11], s20 offen offset:2048 sc1
    buffer_load_dwordx4 v[44:47], v2, s[8:11], s20 offen offset:3072 sc1
VRp_62:
    s_waitcnt vmcnt(2)
    v_max_u32 v15, v32, v36
    v_cmp_eq_u32 vcc, -1, v15
    s_cbranch_vccz VRf_63
    buffer_load_dwordx4 v[32:35], v2, s[8:11], s20 offen offset:0 sc1
    buffer_load_dwordx4 v[36:39], v2, s[8:11], s20 offen offset:1024 sc1
    s_waitcnt vmcnt(2)
    v_max_u32 v15, v40, v44
    v_cmp_eq_u32 vcc, -1, v15
    s_cbranch_vccz VRf_64
    buffer_load_dwordx4 v[40:43], v2, s[8:11], s20 offen offset:2048 sc1
    buffer_load_dwordx4 v[44:47], v2, s[8:11], s20 offen offset:3072 sc1
    s_add_u32 s30, s30, 1
    s_cmp_lt_u32 s30, 65536
    s_cbranch_scc1 VRp_62
    s_branch L_abort
VRf_63:
    v_smfmac_f32_16x16x64_bf16 v[48:51], v[32:35], a[128:135], v3
    v_smfmac_f32_16x16x64_bf16 v[52:55], v[32:35], a[136:143], v3
    v_smfmac_f32_16x16x64_bf16 v[56:59], v[32:35], a[144:151], v3
    v_smfmac_f32_16x16x64_bf16 v[60:63], v[32:35], a[152:159], v3
    v_smfmac_f32_16x16x64_bf16 v[48:51], v[36:39], a[160:167], v3
    v_smfmac_f32_16x16x64_bf16 v[52:55], v[36:39], a[168:175], v3
    v_smfmac_f32_16x16x64_bf16 v[56:59], v[36:39], a[176:183], v3
    v_smfmac_f32_16x16x64_bf16 v[60:63], v[36:39], a[184:191], v3
    s_waitcnt vmcnt(0)
    v_max_u32 v15, v40, v44
    v_cmp_eq_u32 vcc, -1, v15
    s_cbranch_vccz VRg_66
    buffer_load_dwordx4 v[40:43], v2, s[8:11], s20 offen offset:2048 sc1
    buffer_load_dwordx4 v[44:47], v2, s[8:11], s20 offen offset:3072 sc1
VRq_67:
    s_waitcnt vmcnt(0)
    v_max_u32 v15, v40, v44
    v_cmp_eq_u32 vcc, -1, v15
    s_cbranch_vccz VRg_66
    buffer_load_dwordx4 v[40:43], v2, s[8:11], s20 offen offset:2048 sc1
    buffer_load_dwordx4 v[44:47], v2, s[8:11], s20 offen offset:3072 sc1
    s_add_u32 s30, s30, 1
    s_cmp_lt_u32 s30, 65536
    s_cbranch_scc1 VRq_67
    s_branch L_abort
VRg_66:
    v_smfmac_f32_16x16x64_bf16 v[48:51], v[40:43], a[192:199], v3
    v_smfmac_f32_16x16x64_bf16 v[48:51], v[44:47], a[224:231], v3
    v_smfmac_f32_16x16x64_bf16 v[52:55], v[40:43], a[200:207], v3
    v_smfmac_f32_16x16x64_bf16 v[52:55], v[44:47], a[232:239], v3
    v_smfmac_f32_16x16x64_bf16 v[56:59], v[40:43], a[208:215], v3
    s_nop 1
    v_smfmac_f32_16x16x64_bf16 v[56:59], v[44:47], a[240:247], v3
    s_nop 1
    v_smfmac_f32_16x16x64_bf16 v[60:63], v[40:43], a[216:223], v3
    s_nop 0
    v_permlane32_swap_b32 v48, v52
    v_permlane32_swap_b32 v49, v53
    v_smfmac_f32_16x16x64_bf16 v[60:63], v[44:47], a[248:255], v3
    v_permlane32_swap_b32 v50, v54
    v_permlane32_swap_b32 v51, v55
    v_pk_add_f32 v[48:49], v[48:49], v[52:53]
    v_pk_add_f32 v[50:51], v[50:51], v[54:55]
    ds_write2_b32 v7, v48, v49 offset0:0 offset1:4
    ds_write2_b32 v7, v50, v51 offset0:8 offset1:12
    s_nop 1
    v_permlane32_swap_b32 v56, v60
    v_permlane32_swap_b32 v57, v61
    v_permlane32_swap_b32 v58, v62
    v_permlane32_swap_b32 v59, v63
    v_pk_add_f32 v[56:57], v[56:57], v[60:61]
    v_pk_add_f32 v[58:59], v[58:59], v[62:63]
    ds_write2_b32 v7, v56, v57 offset0:144 offset1:148
    ds_write2_b32 v7, v58, v59 offset0:152 offset1:156
    s_branch VRe_65
VRf_64:
    v_smfmac_f32_16x16x64_bf16 v[48:51], v[40:43], a[192:199], v3
    v_smfmac_f32_16x16x64_bf16 v[52:55], v[40:43], a[200:207], v3
    v_smfmac_f32_16x16x64_bf16 v[56:59], v[40:43], a[208:215], v3
    v_smfmac_f32_16x16x64_bf16 v[60:63], v[40:43], a[216:223], v3
    v_smfmac_f32_16x16x64_bf16 v[48:51], v[44:47], a[224:231], v3
    v_smfmac_f32_16x16x64_bf16 v[52:55], v[44:47], a[232:239], v3
    v_smfmac_f32_16x16x64_bf16 v[56:59], v[44:47], a[240:247], v3
    v_smfmac_f32_16x16x64_bf16 v[60:63], v[44:47], a[248:255], v3
    s_waitcnt vmcnt(0)
    v_max_u32 v15, v32, v36
    v_cmp_eq_u32 vcc, -1, v15
    s_cbranch_vccz VRg_68
    buffer_load_dwordx4 v[32:35], v2, s[8:11], s20 offen offset:0 sc1
    buffer_load_dwordx4 v[36:39], v2, s[8:11], s20 offen offset:1024 sc1
VRq_69:
    s_waitcnt vmcnt(0)
    v_max_u32 v15, v32, v36
    v_cmp_eq_u32 vcc, -1, v15
    s_cbranch_vccz VRg_68
    buffer_load_dwordx4 v[32:35], v2, s[8:11], s20 offen offset:0 sc1
    buffer_load_dwordx4 v[36:39], v2, s[8:11], s20 offen offset:1024 sc1
    s_add_u32 s30, s30, 1
    s_cmp_lt_u32 s30, 65536
    s_cbranch_scc1 VRq_69
    s_branch L_abort
VRg_68:
    v_smfmac_f32_16x16x64_bf16 v[48:51], v[32:35], a[128:135], v3
    v_smfmac_f32_16x16x64_bf16 v[48:51], v[36:39], a[160:167], v3
    v_smfmac_f32_16x16x64_bf16 v[52:55], v[32:35], a[136:143], v3
    v_smfmac_f32_16x16x64_bf16 v[52:55], v[36:39], a[168:175], v3
    v_smfmac_f32_16x16x64_bf16 v[56:59], v[32:35], a[144:151], v3
    s_nop 1
    v_smfmac_f32_16x16x64_bf16 v[56:59], v[36:39], a[176:183], v3
    s_nop 1
    v_smfmac_f32_16x16x64_bf16 v[60:63], v[32:35], a[152:159], v3
    s_nop 0
    v_permlane32_swap_b32 v48, v52
    v_permlane32_swap_b32 v49, v53
    v_smfmac_f32_16x16x64_bf16 v[60:63], v[36:39], a[184:191], v3
    v_permlane32_swap_b32 v50, v54
    v_permlane32_swap_b32 v51, v55
    v_pk_add_f32 v[48:49], v[48:49], v[52:53]
    v_pk_add_f32 v[50:51], v[50:51], v[54:55]
    ds_write2_b32 v7, v48, v49 offset0:0 offset1:4
    ds_write2_b32 v7, v50, v51 offset0:8 offset1:12
    s_nop 1
    v_permlane32_swap_b32 v56, v60
    v_permlane32_swap_b32 v57, v61
    v_permlane32_swap_b32 v58, v62
    v_permlane32_swap_b32 v59, v63
    v_pk_add_f32 v[56:57], v[56:57], v[60:61]
    v_pk_add_f32 v[58:59], v[58:59], v[62:63]
    ds_write2_b32 v7, v56, v57 offset0:144 offset1:148
    ds_write2_b32 v7, v58, v59 offset0:152 offset1:156
VRe_65:
    s_cmp_ge_u32 s3, 2
    s_waitcnt lgkmcnt(0)
    s_barrier
    s_cbranch_scc1 Xpo_71
    ds_read_b128 v[64:67], v8 offset:0
    ds_read_b128 v[68:71], v8 offset:2368
    ds_read_b128 v[72:75], v8 offset:4736
    ds_read_b128 v[76:79], v8 offset:7104
    s_waitcnt lgkmcnt(2)
    v_pk_add_f32 v[64:65], v[64:65], v[68:69]
    v_pk_add_f32 v[66:67], v[66:67], v[70:71]
    s_waitcnt lgkmcnt(0)
    v_pk_add_f32 v[72:73], v[72:73], v[76:77]
    v_pk_add_f32 v[74:75], v[74:75], v[78:79]
    v_pk_add_f32 v[64:65], v[64:65], v[72:73]
    v_pk_add_f32 v[66:67], v[66:67], v[74:75]
    buffer_store_dwordx4 v[64:67], v10, s[8:11], s84 offen sc1
    s_branch Xe_70
Xpo_71:
    s_cmp_lg_u32 s3, 3
    s_cbranch_scc1 X3_72
    s_lshl_b32 s20, s19, 2
    s_add_u32 s20, s20, s16
    s_lshl_b32 s20, s20, 7
    s_add_u32 s20, s20, 113278976
    v_mov_b32 v61, 2
    s_mov_b64 exec, 1
    buffer_atomic_add v61, off, s[8:11], s20 sc1
    s_mov_b64 exec, -1
Sd_73:
    s_branch Xe_70
X3_72:
    ds_read_b128 v[64:67], v12 offset:0
    ds_read_b128 v[68:71], v12 offset:2368
    ds_read_b128 v[72:75], v12 offset:4736
    ds_read_b128 v[76:79], v12 offset:7104
    ds_read_b128 v[80:83], v12 offset:1184
    ds_read_b128 v[84:87], v12 offset:3552
    ds_read_b128 v[88:91], v12 offset:5920
    ds_read_b128 v[92:95], v12 offset:8288
    s_waitcnt lgkmcnt(4)
    v_pk_add_f32 v[64:65], v[64:65], v[68:69]
    v_pk_add_f32 v[66:67], v[66:67], v[70:71]
    v_pk_add_f32 v[72:73], v[72:73], v[76:77]
    v_pk_add_f32 v[74:75], v[74:75], v[78:79]
    v_pk_add_f32 v[64:65], v[64:65], v[72:73]
    v_pk_add_f32 v[66:67], v[66:67], v[74:75]
    s_waitcnt lgkmcnt(0)
    v_pk_add_f32 v[80:81], v[80:81], v[84:85]
    v_pk_add_f32 v[82:83], v[82:83], v[86:87]
    v_pk_add_f32 v[88:89], v[88:89], v[92:93]
    v_pk_add_f32 v[90:91], v[90:91], v[94:95]
    v_pk_add_f32 v[68:69], v[80:81], v[88:89]
    v_pk_add_f32 v[70:71], v[82:83], v[90:91]
    s_sleep 6
Xp_75:
    buffer_load_dwordx4 v[108:111], v17, s[8:11], s84 offen offset:0 sc1
    buffer_load_dwordx4 v[112:115], v17, s[8:11], s84 offen offset:1024 sc1
    buffer_load_dwordx4 v[100:103], v16, s[8:11], s84 offen offset:0 sc1
    buffer_load_dwordx4 v[104:107], v16, s[8:11], s84 offen offset:1024 sc1
    buffer_load_dwordx4 v[116:119], v18, s[8:11], s84 offen offset:0 sc1
    buffer_load_dwordx4 v[120:123], v18, s[8:11], s84 offen offset:1024 sc1
    s_waitcnt vmcnt(4)
    v_pk_add_f32 v[80:81], v[64:65], v[108:109]
    v_pk_add_f32 v[82:83], v[66:67], v[110:111]
    v_pk_add_f32 v[84:85], v[68:69], v[112:113]
    v_pk_add_f32 v[86:87], v[70:71], v[114:115]
    s_waitcnt vmcnt(2)
    v_max3_u32 v15, v100, v104, v108
    v_max_u32 v15, v15, v112
    s_cmp_lg_u32 s18, 0
    s_waitcnt vmcnt(0)
    v_max3_u32 v15, v15, v116, v120
    v_cmp_eq_u32 vcc, -1, v15
    v_pk_add_f32 v[72:73], v[100:101], v[116:117]
    v_pk_add_f32 v[74:75], v[102:103], v[118:119]
    v_pk_add_f32 v[76:77], v[104:105], v[120:121]
    v_pk_add_f32 v[78:79], v[106:107], v[122:123]
    v_pk_add_f32 v[80:81], v[80:81], v[72:73]
    v_pk_add_f32 v[82:83], v[82:83], v[74:75]
    v_pk_add_f32 v[84:85], v[84:85], v[76:77]
    v_pk_add_f32 v[86:87], v[86:87], v[78:79]
    v_cvt_pk_bf16_f32 v80, v80, v81
    v_cvt_pk_bf16_f32 v81, v82, v83
    v_cvt_pk_bf16_f32 v82, v84, v85
    v_cvt_pk_bf16_f32 v83, v86, v87
    s_cbranch_vccz Xg_76
    s_add_u32 s30, s30, 1
    s_cmp_lt_u32 s30, 65536
    s_cbranch_scc1 Xp_75
    s_branch L_abort
Xg_76:
    s_cbranch_scc1 Xs_77
    buffer_store_dwordx4 v[80:83], v13, s[8:11], s22 offen
    s_branch Xe_70
Xs_77:
    buffer_store_dwordx4 v[80:83], v13, s[8:11], s22 offen sc1
Xe_70:
    s_add_u32 s19, s19, 1
    s_branch L_VR_step
L_VR_last:
    s_waitcnt vmcnt(0)
    s_barrier
    s_cmp_lg_u32 s3, 0
    s_cbranch_scc1 Sd_78
    s_lshl_b32 s20, s19, 2
    s_add_u32 s20, s20, s16
    s_lshl_b32 s20, s20, 7
    s_add_u32 s20, s20, 113278976
    v_mov_b32 v60, 2
    s_mov_b64 exec, 1
    buffer_atomic_add v60, off, s[8:11], s20 sc1
    s_mov_b64 exec, -1
Sd_78:
L_retire:
    s_setprio 0
    s_mov_b32 s96, 2
    s_load_dwordx8 s[40:47], s[0:1], 0
    s_load_dwordx4 s[48:51], s[0:1], 32
    s_load_dwordx8 s[56:63], s[0:1], 64
    s_load_dwordx4 s[64:67], s[0:1], 96
    v_mbcnt_lo_u32_b32 v1, -1, 0
    v_mbcnt_hi_u32_b32 v1, -1, v1
    s_waitcnt vmcnt(0) lgkmcnt(0)
    s_barrier
    s_mov_b32 s92, s66
    s_and_b32 s93, s67, 0xffff
    s_mov_b32 s94, 268435456
    s_mov_b32 s95, 0x20000
    s_branch L_worker
L_abort:
    s_mov_b64 exec, -1
    v_mov_b32 v4, 0x1fff
    v_mov_b32 v5, 159744
    ds_write_b32 v5, v4
    s_waitcnt lgkmcnt(0)
    s_endpgm
L_worker0:
    s_mov_b32 s92, s66
    s_and_b32 s93, s67, 0xffff
    s_mov_b32 s94, 268435456
    s_mov_b32 s95, 0x20000
    s_waitcnt vmcnt(0)
    s_barrier
    s_cmp_lg_u32 s3, 0
    s_cbranch_scc1 Ia_79
    v_mov_b32 v61, s101
    s_lshl_b32 s21, s2, 2
    s_add_u32 s21, s21, 112198656
    s_mov_b64 exec, 1
    buffer_store_dword v61, off, s[92:95], s21 sc1
    s_mov_b64 exec, -1
Ia_79:
    s_cmp_eq_u32 s3, 0
    s_cbranch_scc1 Ws_84
    s_cmp_lg_u32 s98, 5
    s_cbranch_scc1 Ws_85
    v_lshrrev_b32 v2, 4, v1
    v_lshlrev_b32 v2, 13, v2
    v_and_b32 v3, 15, v1
    v_lshl_add_u32 v2, v3, 4, v2
    s_mov_b32 m0, 160768
    s_branch Ws_80
Ws_85:
    s_sub_u32 s19, s33, 128
    s_mul_i32 s19, s19, 3
    s_add_u32 s19, s19, s3
    s_sub_u32 s19, s19, 1
    v_lshlrev_b32 v2, 4, v1
    s_mov_b32 s84, s46
    s_and_b32 s85, s47, 0xffff
    s_mov_b32 s86, 8388608
    s_mov_b32 s87, 0x20000
    s_mul_i32 s79, s19, 21504
    s_add_u32 s79, s79, 131072
    s_mov_b32 m0, 160768
    s_nop 0
    buffer_load_dwordx4 v2, s[84:87], s79 offen lds
    s_add_u32 s79, s79, 1024
    buffer_load_dwordx4 v2, s[84:87], s79 offen lds
    s_add_u32 s79, s79, 1024
    buffer_load_dwordx4 v2, s[84:87], s79 offen lds
    s_add_u32 s79, s79, 1024
    buffer_load_dwordx4 v2, s[84:87], s79 offen lds
    s_add_u32 s79, s79, 1024
    buffer_load_dwordx4 v2, s[84:87], s79 offen lds
    s_add_u32 s79, s79, 1024
    buffer_load_dwordx4 v2, s[84:87], s79 offen lds
    s_add_u32 s79, s79, 1024
    buffer_load_dwordx4 v2, s[84:87], s79 offen lds
    s_add_u32 s79, s79, 1024
    buffer_load_dwordx4 v2, s[84:87], s79 offen lds
    s_add_u32 s79, s79, 1024
    buffer_load_dwordx4 v2, s[84:87], s79 offen lds
    s_add_u32 s79, s79, 1024
    buffer_load_dwordx4 v2, s[84:87], s79 offen lds
    s_add_u32 s79, s79, 1024
    buffer_load_dwordx4 v2, s[84:87], s79 offen lds
    s_add_u32 s79, s79, 1024
    buffer_load_dwordx4 v2, s[84:87], s79 offen lds
    s_add_u32 s79, s79, 1024
    buffer_load_dwordx4 v2, s[84:87], s79 offen lds
    s_add_u32 s79, s79, 1024
    buffer_load_dwordx4 v2, s[84:87], s79 offen lds
    s_add_u32 s79, s79, 1024
    buffer_load_dwordx4 v2, s[84:87], s79 offen lds
    s_add_u32 s79, s79, 1024
    buffer_load_dwordx4 v2, s[84:87], s79 offen lds
    s_add_u32 s79, s79, 1024
    buffer_load_dwordx4 v2, s[84:87], s79 offen lds
    s_add_u32 s79, s79, 1024
    buffer_load_dwordx4 v2, s[84:87], s79 offen lds
    s_add_u32 s79, s79, 1024
    buffer_load_dwordx4 v2, s[84:87], s79 offen lds
    s_add_u32 s79, s79, 1024
    buffer_load_dwordx4 v2, s[84:87], s79 offen lds
    s_add_u32 s79, s79, 1024
    buffer_load_dwordx4 v2, s[84:87], s79 offen lds
    s_branch Ws_80
Ws_84:
    s_cmp_lg_u32 s33, 255
    s_cbranch_scc1 Ws_81
    v_lshlrev_b32 v3, 2, v1
    s_mov_b32 s26, 112198656
    s_mov_b32 s30, 0
Ws_82:
    buffer_load_dword v8, v3, s[92:95], s26 offen offset:0 sc1
    buffer_load_dword v9, v3, s[92:95], s26 offen offset:256 sc1
    buffer_load_dword v10, v3, s[92:95], s26 offen offset:512 sc1
    buffer_load_dword v11, v3, s[92:95], s26 offen offset:768 sc1
    s_waitcnt vmcnt(0)
    v_xor_b32 v8, s101, v8
    v_xor_b32 v9, s101, v9
    v_xor_b32 v10, s101, v10
    v_xor_b32 v11, s101, v11
    v_or_b32 v5, v8, v9
    v_or3_b32 v5, v5, v10, v11
    v_cmp_ne_u32 vcc, 0, v5
    s_cbranch_vccz Ws_83
    s_sleep 2
    s_add_u32 s30, s30, 1
    s_cmp_lt_u32 s30, 65536
    s_cbranch_scc1 Ws_82
    s_branch L_abort
Ws_83:
    s_mov_b32 s20, s64
    s_and_b32 s21, s65, 0xffff
    s_mov_b32 s22, 256
    s_mov_b32 s23, 0x20000
    v_mov_b32 v5, s101
    s_mov_b32 s24, 192
    buffer_store_dword v5, off, s[20:23], s24 sc1
    s_branch Ws_80
Ws_81:
    s_cmp_eq_u32 s98, 5
    s_cbranch_scc1 Ws_86
    v_and_b32 v3, 7, v1
    s_and_b32 s26, s34, 3
    s_mul_i32 s26, s26, 7
    v_add_u32 v3, s26, v3
    v_and_b32 v4, 3, v3
    v_lshrrev_b32 v3, 2, v3
    v_lshl_add_u32 v3, v3, 3, v4
    v_add_u32 v3, 4, v3
    v_lshlrev_b32 v3, 2, v3
    s_mov_b32 s26, 112198656
    s_mov_b32 s30, 0
Ws_87:
    s_sleep 6
    buffer_load_dword v8, v3, s[92:95], s26 offen sc1
    s_waitcnt vmcnt(0)
    v_cmp_ne_u32 vcc, s101, v8
    s_cbranch_vccz Ws_80
    s_add_u32 s30, s30, 1
    s_cmp_lt_u32 s30, 65536
    s_cbranch_scc1 Ws_87
    s_branch L_abort
Ws_86:
    s_mov_b32 s20, s64
    s_and_b32 s21, s65, 0xffff
    s_mov_b32 s22, 256
    s_mov_b32 s23, 0x20000
    s_mov_b32 s30, 0
    s_mov_b32 s24, 192
Ip_88:
    buffer_load_dword v14, off, s[20:23], s24 sc1
    s_waitcnt vmcnt(0)
    v_cmp_ne_u32 vcc, s101, v14
    s_cbranch_vccz Ig_89
    s_sleep 4
    s_add_u32 s30, s30, 1
    s_cmp_lt_u32 s30, 65536
    s_cbranch_scc1 Ip_88
    s_branch L_abort
Ig_89:
    s_branch Ws_80
    s_mov_b32 s26, 113253120
    s_mov_b32 s30, 0
Ws_90:
    s_sleep 16
    buffer_load_dword v8, off, s[92:95], s26 sc1
    s_waitcnt vmcnt(0)
    v_cmp_gt_u32 vcc, 0, v8
    s_cbranch_vccz Ws_80
    s_add_u32 s30, s30, 1
    s_cmp_lt_u32 s30, 65536
    s_cbranch_scc1 Ws_90
    s_branch L_abort
Ws_80:
    s_barrier
L_worker:
    s_mov_b32 s39, 0
    s_mov_b32 s69, 0
    s_mov_b32 s82, 0
    s_cmp_eq_u32 s96, 2
    s_cbranch_scc1 Ft_91
    s_cmp_lg_u32 s3, 0
    s_cbranch_scc1 Ft_91
    s_sub_u32 s25, s34, s83
    s_add_u32 s25, s25, s83
    s_cmp_eq_u32 s98, 5
    s_cbranch_scc1 N_93
    s_cmp_eq_u32 s98, 4
    s_cbranch_scc1 N_92
    s_lshr_b32 s22, s25, 5
    s_and_b32 s25, s25, 31
    s_lshl_b32 s22, s22, 2
    s_add_u32 s22, s22, s98
    s_lshl_b32 s22, s22, 5
    s_add_u32 s25, s25, s22
N_92:
    s_cmp_lt_u32 s25, 768
    s_cselect_b32 s25, s25, 96
    s_cbranch_scc1 N_93_e
N_93:
    s_add_u32 s25, s25, 768
    s_cmp_lt_u32 s25, 864
N_93_e:
    v_mov_b32 v14, s25
    v_mov_b32 v15, 159744
    ds_write_b32 v15, v14
    s_mov_b32 s39, 1
Ft_91:
L_next:
    s_cmp_lg_u32 s3, 0
    s_cbranch_scc1 N_94
    s_cmp_lg_u32 s39, 0
    s_mov_b32 s39, 0
    s_cbranch_scc1 N_94
    s_cmp_eq_u32 s96, 2
    s_cbranch_scc1 N_97
N_96:
    v_mov_b32 v4, 1
    s_mov_b64 exec, 1
    buffer_atomic_add v4, off, s[92:95], s97 sc0 sc1
    s_mov_b64 exec, -1
    s_waitcnt vmcnt(0)
    v_readfirstlane_b32 s25, v4
    s_nop 3
    s_add_u32 s25, s25, s83
    s_cmp_eq_u32 s98, 5
    s_cbranch_scc1 N_99
    s_cmp_eq_u32 s98, 4
    s_cbranch_scc1 N_98
    s_lshr_b32 s22, s25, 5
    s_and_b32 s25, s25, 31
    s_lshl_b32 s22, s22, 2
    s_add_u32 s22, s22, s98
    s_lshl_b32 s22, s22, 5
    s_add_u32 s25, s25, s22
N_98:
    s_cmp_lt_u32 s25, 768
    s_cselect_b32 s25, s25, 96
    s_cbranch_scc1 N_99_e
N_99:
    s_add_u32 s25, s25, 768
    s_cmp_lt_u32 s25, 864
N_99_e:
    s_cbranch_scc1 N_95
    s_mov_b32 s96, 2
N_97:
    s_mov_b32 s20, 113247488
    v_mov_b32 v4, 1
    s_mov_b64 exec, 1
    buffer_atomic_add v4, off, s[92:95], s20 sc0 sc1
    s_mov_b64 exec, -1
    s_waitcnt vmcnt(0)
    v_readfirstlane_b32 s25, v4
    s_nop 3
    s_min_u32 s25, s25, 0xfff
    s_add_u32 s25, s25, 0x1000
N_95:
    v_mov_b32 v14, s25
    v_mov_b32 v15, 159744
    ds_write_b32 v15, v14
N_94:
    s_waitcnt lgkmcnt(0)
    s_barrier
    v_mov_b32 v5, 159744
    ds_read_b32 v4, v5
    s_waitcnt lgkmcnt(0)
    v_readfirstlane_b32 s99, v4
    s_nop 3
    s_cmp_ge_u32 s99, 0x1000
    s_cbranch_scc1 L_qa
    s_lshr_b32 s20, s99, 3
    s_and_b32 s21, s99, 7
    s_cmp_ge_u32 s20, 4
    s_cbranch_scc1 D_100
    s_sub_u32 s20, s20, 0
    s_lshr_b32 s38, s20, 3
    s_add_u32 s38, s38, 1
    s_and_b32 s37, s20, 7
    s_lshl_b32 s37, s37, 1
    s_lshr_b32 s22, s21, 2
    s_add_u32 s37, s37, s22
    s_and_b32 s36, s21, 3
    s_branch L_KS
D_100:
    s_cmp_ge_u32 s20, 8
    s_cbranch_scc1 D_101
    s_sub_u32 s20, s20, 0
    s_lshr_b32 s38, s20, 3
    s_add_u32 s38, s38, 1
    s_and_b32 s37, s20, 7
    s_lshl_b32 s37, s37, 1
    s_lshr_b32 s22, s21, 2
    s_add_u32 s37, s37, s22
    s_and_b32 s36, s21, 3
    s_branch L_KS
D_101:
    s_cmp_ge_u32 s20, 12
    s_cbranch_scc1 D_102
    s_sub_u32 s20, s20, 0
    s_lshr_b32 s38, s20, 3
    s_add_u32 s38, s38, 1
    s_and_b32 s37, s20, 7
    s_lshl_b32 s37, s37, 1
    s_lshr_b32 s22, s21, 2
    s_add_u32 s37, s37, s22
    s_and_b32 s36, s21, 3
    s_branch L_KS
D_102:
    s_cmp_ge_u32 s20, 16
    s_cbranch_scc1 D_103
    s_sub_u32 s20, s20, 0
    s_lshr_b32 s38, s20, 3
    s_add_u32 s38, s38, 1
    s_and_b32 s37, s20, 7
    s_lshl_b32 s37, s37, 1
    s_lshr_b32 s22, s21, 2
    s_add_u32 s37, s37, s22
    s_and_b32 s36, s21, 3
    s_branch L_KS
D_103:
    s_cmp_ge_u32 s20, 20
    s_cbranch_scc1 D_104
    s_sub_u32 s20, s20, 4
    s_and_b32 s36, s21, 3
    s_add_u32 s36, s36, 2
    s_lshr_b32 s21, s21, 2
    s_lshl_b32 s37, s20, 1
    s_add_u32 s37, s37, s21
    s_lshr_b32 s38, s37, 4
    s_add_u32 s38, s38, 1
    s_and_b32 s37, s37, 15
    s_branch L_QKV2
D_104:
    s_cmp_ge_u32 s20, 24
    s_cbranch_scc1 D_105
    s_sub_u32 s20, s20, 12
    s_and_b32 s36, s21, 3
    s_add_u32 s36, s36, 2
    s_lshr_b32 s21, s21, 2
    s_lshl_b32 s37, s20, 1
    s_add_u32 s37, s37, s21
    s_lshr_b32 s38, s37, 4
    s_add_u32 s38, s38, 1
    s_and_b32 s37, s37, 15
    s_branch L_QKV2
D_105:
    s_cmp_ge_u32 s20, 28
    s_cbranch_scc1 D_106
    s_sub_u32 s20, s20, 20
    s_and_b32 s36, s21, 3
    s_add_u32 s36, s36, 2
    s_lshr_b32 s21, s21, 2
    s_lshl_b32 s37, s20, 1
    s_add_u32 s37, s37, s21
    s_lshr_b32 s38, s37, 4
    s_add_u32 s38, s38, 1
    s_and_b32 s37, s37, 15
    s_branch L_QKV2
D_106:
    s_cmp_ge_u32 s20, 32
    s_cbranch_scc1 D_107
    s_sub_u32 s20, s20, 28
    s_and_b32 s36, s21, 3
    s_add_u32 s36, s36, 2
    s_lshr_b32 s21, s21, 2
    s_lshl_b32 s37, s20, 1
    s_add_u32 s37, s37, s21
    s_lshr_b32 s38, s37, 4
    s_add_u32 s38, s38, 1
    s_and_b32 s37, s37, 15
    s_branch L_QKV2
D_107:
    s_cmp_ge_u32 s20, 36
    s_cbranch_scc1 D_108
    s_sub_u32 s20, s20, 24
    s_and_b32 s36, s21, 3
    s_add_u32 s36, s36, 4
    s_lshr_b32 s21, s21, 2
    s_lshl_b32 s37, s20, 1
    s_add_u32 s37, s37, s21
    s_branch L_GU2
D_108:
    s_cmp_ge_u32 s20, 40
    s_cbranch_scc1 D_109
    s_sub_u32 s20, s20, 36
    s_and_b32 s36, s21, 3
    s_add_u32 s36, s36, 4
    s_lshr_b32 s21, s21, 2
    s_lshl_b32 s37, s20, 1
    s_add_u32 s37, s37, s21
    s_branch L_GU2
D_109:
    s_cmp_ge_u32 s20, 44
    s_cbranch_scc1 D_110
    s_sub_u32 s20, s20, 36
    s_and_b32 s36, s21, 3
    s_add_u32 s36, s36, 4
    s_lshr_b32 s21, s21, 2
    s_lshl_b32 s37, s20, 1
    s_add_u32 s37, s37, s21
    s_branch L_GU2
D_110:
    s_cmp_ge_u32 s20, 48
    s_cbranch_scc1 D_111
    s_sub_u32 s20, s20, 20
    s_mov_b32 s36, s21
    s_mov_b32 s37, s20
    s_branch L_GU2
D_111:
    s_cmp_ge_u32 s20, 52
    s_cbranch_scc1 D_112
    s_sub_u32 s20, s20, 48
    s_mov_b32 s36, 0
    s_mov_b32 s38, 0
    s_branch L_QKV
D_112:
    s_cmp_ge_u32 s20, 56
    s_cbranch_scc1 D_113
    s_sub_u32 s20, s20, 44
    s_and_b32 s36, s21, 3
    s_add_u32 s36, s36, 0
    s_lshr_b32 s21, s21, 2
    s_lshl_b32 s37, s20, 1
    s_add_u32 s37, s37, s21
    s_branch L_GU2
D_113:
    s_cmp_ge_u32 s20, 60
    s_cbranch_scc1 D_114
    s_sub_u32 s20, s20, 56
    s_mov_b32 s36, 6
    s_and_b32 s38, s20, 1
    s_add_u32 s38, s38, 1
    s_lshr_b32 s20, s20, 1
    s_branch L_QKV
D_114:
    s_cmp_ge_u32 s20, 64
    s_cbranch_scc1 D_115
    s_sub_u32 s20, s20, 60
    s_mov_b32 s36, 2
    s_mov_b32 s38, 0
    s_branch L_QKV
D_115:
    s_cmp_ge_u32 s20, 68
    s_cbranch_scc1 D_116
    s_sub_u32 s20, s20, 64
    s_and_b32 s36, s21, 3
    s_add_u32 s36, s36, 0
    s_lshr_b32 s21, s21, 2
    s_lshl_b32 s37, s20, 1
    s_add_u32 s37, s37, s21
    s_branch L_GU2
D_116:
    s_cmp_ge_u32 s20, 72
    s_cbranch_scc1 D_117
    s_sub_u32 s20, s20, 64
    s_and_b32 s36, s21, 3
    s_add_u32 s36, s36, 0
    s_lshr_b32 s21, s21, 2
    s_lshl_b32 s37, s20, 1
    s_add_u32 s37, s37, s21
    s_branch L_GU2
D_117:
    s_cmp_ge_u32 s20, 76
    s_cbranch_scc1 D_118
    s_sub_u32 s20, s20, 68
    s_mov_b32 s36, 6
    s_and_b32 s38, s20, 1
    s_add_u32 s38, s38, 1
    s_lshr_b32 s20, s20, 1
    s_branch L_QKV
D_118:
    s_cmp_ge_u32 s20, 80
    s_cbranch_scc1 D_119
    s_sub_u32 s20, s20, 72
    s_mov_b32 s36, s20
    s_mov_b32 s37, s21
    s_branch L_DN
D_119:
    s_cmp_ge_u32 s20, 84
    s_cbranch_scc1 D_120
    s_sub_u32 s20, s20, 80
    s_mov_b32 s36, s20
    s_mov_b32 s37, s21
    s_branch L_W2
D_120:
    s_cmp_ge_u32 s20, 88
    s_cbranch_scc1 D_121
    s_sub_u32 s20, s20, 84
    s_lshl_b32 s37, s20, 3
    s_add_u32 s37, s37, s21
    s_branch L_WR
D_121:
    s_cmp_ge_u32 s20, 92
    s_cbranch_scc1 D_122
    s_sub_u32 s20, s20, 88
    s_mov_b32 s36, s20
    s_mov_b32 s37, s21
    s_branch L_DN
D_122:
    s_cmp_ge_u32 s20, 96
    s_cbranch_scc1 D_123
    s_sub_u32 s20, s20, 84
    s_mov_b32 s36, s20
    s_mov_b32 s37, s21
    s_branch L_W1
D_123:
    s_cmp_ge_u32 s20, 100
    s_cbranch_scc1 D_124
    s_sub_u32 s20, s20, 96
    s_and_b32 s38, s20, 1
    s_add_u32 s38, s38, 1
    s_lshr_b32 s37, s20, 1
    s_lshl_b32 s37, s37, 3
    s_add_u32 s37, s37, s21
    s_mov_b32 s36, 1
    s_branch L_QKV2
D_124:
    s_cmp_ge_u32 s20, 104
    s_cbranch_scc1 D_125
    s_sub_u32 s20, s20, 100
    s_mov_b32 s36, 6
    s_mov_b32 s38, 0
    s_branch L_QKV
D_125:
    s_cmp_ge_u32 s20, 108
    s_cbranch_scc1 D_126
    s_sub_u32 s20, s20, 104
    s_mov_b32 s36, 4
    s_mov_b32 s38, 0
    s_branch L_QKV
D_126:
    s_branch L_abort
L_QA:
    s_cmp_eq_u32 s98, 4
    s_cselect_b32 s96, 1, 2
    s_barrier
    s_branch L_next
L_QKV:
    s_and_b32 s22, s21, 1
    s_add_u32 s36, s36, s22
    s_lshr_b32 s21, s21, 1
    s_lshl_b32 s37, s20, 2
    s_add_u32 s37, s37, s21
L_QKV2:
    s_mov_b32 s8, s66
    s_and_b32 s9, s67, 0xffff
    s_mov_b32 s10, 4456448
    s_mov_b32 s11, 0x20000
    s_cmp_eq_u32 s38, 1
    s_cselect_b32 s34, s46, s44
    s_cselect_b32 s35, s47, s45
    s_cmp_eq_u32 s38, 2
    s_cselect_b32 s34, s48, s34
    s_cselect_b32 s35, s49, s35
    s_mov_b32 s12, s34
    s_and_b32 s13, s35, 0xffff
    s_mov_b32 s14, 8388608
    s_mov_b32 s15, 0x20000
    v_lshrrev_b32 v3, 4, v1
    v_and_b32 v4, 7, v1
    v_xor_b32 v3, v3, v4
    v_lshrrev_b32 v2, 3, v1
    s_lshl_b32 s21, s3, 6
    v_add_u32 v2, s21, v2
    s_mov_b32 s22, 2176
    v_mul_lo_u32 v2, v2, s22
    v_lshlrev_b32 v3, 4, v3
    v_xor_b32 v4, 64, v3
    v_add_u32 v3, v2, v3
    v_add_u32 v4, v2, v4
    v_add_u32 v16, 0, v3
    v_add_u32 v17, 17408, v4
    v_add_u32 v18, 34816, v3
    v_add_u32 v19, 52224, v4
    v_add_u32 v20, 69632, v3
    v_add_u32 v21, 87040, v4
    v_add_u32 v22, 104448, v3
    v_add_u32 v23, 121856, v4
    v_lshrrev_b32 v2, 4, v1
    v_and_b32 v3, 15, v1
    v_lshlrev_b32 v4, 1, v2
    v_xor_b32 v3, v3, v4
    s_and_b32 s21, s3, 1
    s_lshl_b32 s21, s21, 5
    v_add_u32 v2, s21, v2
    s_mov_b32 s22, 8192
    v_mul_lo_u32 v2, v2, s22
    s_lshr_b32 s23, s3, 1
    s_lshl_b32 s23, s23, 7
    v_add_u32 v2, s23, v2
    v_lshrrev_b32 v4, 3, v3
    v_lshlrev_b32 v4, 8, v4
    v_and_b32 v3, 7, v3
    v_lshl_add_u32 v3, v3, 4, v4
    v_xor_b32 v4, 256, v3
    v_add_u32 v3, v2, v3
    v_add_u32 v4, v2, v4
    v_add_u32 v24, 0, v3
    v_add_u32 v25, 32768, v3
    v_add_u32 v26, 65536, v4
    v_add_u32 v27, 98304, v4
    v_add_u32 v28, 131072, v3
    v_add_u32 v29, 163840, v3
    v_add_u32 v30, 196608, v4
    v_add_u32 v31, 229376, v4
    s_lshl_b32 s18, s3, 13
    s_add_u32 s19, s18, 32768
    v_and_b32 v2, 15, v1
    v_lshrrev_b32 v3, 1, v2
    v_lshrrev_b32 v4, 4, v1
    v_xor_b32 v3, v3, v4
    s_lshr_b32 s21, s3, 1
    s_lshl_b32 s21, s21, 7
    v_add_u32 v2, s21, v2
    v_lshlrev_b32 v2, 7, v2
    v_lshl_add_u32 v32, v3, 4, v2
    v_xor_b32 v33, 64, v32
    v_bfe_u32 v3, v1, 2, 2
    v_lshl_add_u32 v2, v4, 3, v3
    v_lshlrev_b32 v2, 8, v2
    v_and_b32 v5, 3, v1
    v_lshl_add_u32 v2, v5, 3, v2
    v_add_u32 v2, 32768, v2
    v_and_b32 v4, 1, v4
    v_lshl_or_b32 v3, v4, 2, v3
    s_and_b32 s21, s3, 1
    s_lshl_b32 s21, s21, 2
    v_xor_b32 v3, s21, v3
    v_xor_b32 v4, 0, v3
    v_lshl_add_u32 v34, v4, 5, v2
    v_xor_b32 v4, 1, v3
    v_lshl_add_u32 v35, v4, 5, v2
    v_xor_b32 v4, 2, v3
    v_lshl_add_u32 v36, v4, 5, v2
    v_xor_b32 v4, 3, v3
    v_lshl_add_u32 v37, v4, 5, v2
    v_add_u32 v38, 65536, v32
    v_add_u32 v39, 65536, v33
    v_add_u32 v40, 65536, v34
    v_add_u32 v41, 65536, v35
    v_add_u32 v42, 65536, v36
    v_add_u32 v43, 65536, v37
    s_mul_i32 s16, s36, 557056
    s_lshl_b32 s17, s37, 9
    s_add_u32 m0, s18, 0
    s_nop 0
    buffer_load_dwordx4 v16, s[8:11], s16 offen sc1 lds
    s_add_u32 m0, s19, 0
    s_nop 0
    buffer_load_dwordx4 v24, s[12:15], s17 offen  lds
    s_add_u32 m0, s18, 1024
    s_nop 0
    buffer_load_dwordx4 v17, s[8:11], s16 offen sc1 lds
    s_add_u32 m0, s19, 1024
    s_nop 0
    buffer_load_dwordx4 v25, s[12:15], s17 offen  lds
    s_add_u32 m0, s18, 2048
    s_nop 0
    buffer_load_dwordx4 v18, s[8:11], s16 offen sc1 lds
    s_add_u32 m0, s19, 2048
    s_nop 0
    buffer_load_dwordx4 v26, s[12:15], s17 offen  lds
    s_add_u32 m0, s18, 3072
    s_nop 0
    buffer_load_dwordx4 v19, s[8:11], s16 offen sc1 lds
    s_add_u32 m0, s19, 3072
    s_nop 0
    buffer_load_dwordx4 v27, s[12:15], s17 offen  lds
    s_add_u32 m0, s18, 4096
    s_nop 0
    buffer_load_dwordx4 v20, s[8:11], s16 offen sc1 lds
    s_add_u32 m0, s19, 4096
    s_nop 0
    buffer_load_dwordx4 v28, s[12:15], s17 offen  lds
    s_add_u32 m0, s18, 5120
    s_nop 0
    buffer_load_dwordx4 v21, s[8:11], s16 offen sc1 lds
    s_add_u32 m0, s19, 5120
    s_nop 0
    buffer_load_dwordx4 v29, s[12:15], s17 offen  lds
    s_add_u32 m0, s18, 6144
    s_nop 0
    buffer_load_dwordx4 v22, s[8:11], s16 offen sc1 lds
    s_add_u32 m0, s19, 6144
    s_nop 0
    buffer_load_dwordx4 v30, s[12:15], s17 offen  lds
    s_add_u32 m0, s18, 7168
    s_nop 0
    buffer_load_dwordx4 v23, s[8:11], s16 offen sc1 lds
    s_add_u32 m0, s19, 7168
    s_nop 0
    buffer_load_dwordx4 v31, s[12:15], s17 offen  lds
    s_add_u32 s16, s16, 128
    s_add_u32 s17, s17, 524288
    s_add_u32 m0, s18, 65536
    s_nop 0
    buffer_load_dwordx4 v16, s[8:11], s16 offen sc1 lds
    s_add_u32 m0, s19, 65536
    s_nop 0
    buffer_load_dwordx4 v24, s[12:15], s17 offen  lds
    s_add_u32 m0, s18, 66560
    s_nop 0
    buffer_load_dwordx4 v17, s[8:11], s16 offen sc1 lds
    s_add_u32 m0, s19, 66560
    s_nop 0
    buffer_load_dwordx4 v25, s[12:15], s17 offen  lds
    s_add_u32 m0, s18, 67584
    s_nop 0
    buffer_load_dwordx4 v18, s[8:11], s16 offen sc1 lds
    s_add_u32 m0, s19, 67584
    s_nop 0
    buffer_load_dwordx4 v26, s[12:15], s17 offen  lds
    s_add_u32 m0, s18, 68608
    s_nop 0
    buffer_load_dwordx4 v19, s[8:11], s16 offen sc1 lds
    s_add_u32 m0, s19, 68608
    s_nop 0
    buffer_load_dwordx4 v27, s[12:15], s17 offen  lds
    s_add_u32 m0, s18, 69632
    s_nop 0
    buffer_load_dwordx4 v20, s[8:11], s16 offen sc1 lds
    s_add_u32 m0, s19, 69632
    s_nop 0
    buffer_load_dwordx4 v28, s[12:15], s17 offen  lds
    s_add_u32 m0, s18, 70656
    s_nop 0
    buffer_load_dwordx4 v21, s[8:11], s16 offen sc1 lds
    s_add_u32 m0, s19, 70656
    s_nop 0
    buffer_load_dwordx4 v29, s[12:15], s17 offen  lds
    s_add_u32 m0, s18, 71680
    s_nop 0
    buffer_load_dwordx4 v22, s[8:11], s16 offen sc1 lds
    s_add_u32 m0, s19, 71680
    s_nop 0
    buffer_load_dwordx4 v30, s[12:15], s17 offen  lds
    s_add_u32 m0, s18, 72704
    s_nop 0
    buffer_load_dwordx4 v23, s[8:11], s16 offen sc1 lds
    s_add_u32 m0, s19, 72704
    s_nop 0
    buffer_load_dwordx4 v31, s[12:15], s17 offen  lds
    s_add_u32 s16, s16, 128
    s_add_u32 s17, s17, 524288
    s_call_b64 s[4:5], L_epi
    s_mov_b32 s24, s56
    s_and_b32 s25, s57, 0xffff
    s_mov_b32 s26, 7340032
    s_mov_b32 s27, 0x20000
    s_mov_b32 s28, s58
    s_and_b32 s29, s59, 0xffff
    s_mov_b32 s30, 7340032
    s_mov_b32 s31, 0x20000
    s_mov_b32 s84, s60
    s_and_b32 s85, s61, 0xffff
    s_mov_b32 s86, 7340032
    s_mov_b32 s87, 0x20000
    s_sub_u32 s79, s99, 128
    s_cmp_lt_u32 s79, 128
    s_cselect_b32 s26, s26, 0
    s_cselect_b32 s30, s30, 0
    s_cselect_b32 s86, s86, 0
    s_cselect_b32 s79, s79, 0
    s_lshl_b32 s79, s79, 2
    s_add_u32 s79, s79, s3
    s_mul_i32 s79, s79, 14336
    v_lshlrev_b32 v13, 4, v1
    s_cmp_eq_u32 s38, 2
    s_cbranch_scc1 L_V
    s_waitcnt vmcnt(16)
    s_barrier
    ds_read_b64_tr_b16 v[96:97], v34 offset:0
    ds_read_b64_tr_b16 v[98:99], v34 offset:1024
    ds_read_b128 v[64:67], v32 offset:0
    ds_read_b128 v[68:71], v32 offset:2048
    ds_read_b128 v[72:75], v32 offset:4096
    ds_read_b128 v[76:79], v32 offset:6144
    ds_read_b128 v[80:83], v32 offset:8192
    ds_read_b128 v[84:87], v32 offset:10240
    ds_read_b128 v[88:91], v32 offset:12288
    ds_read_b128 v[92:95], v32 offset:14336
    ds_read_b64_tr_b16 v[100:101], v35 offset:0
    ds_read_b64_tr_b16 v[102:103], v35 offset:1024
    ds_read_b64_tr_b16 v[104:105], v36 offset:0
    ds_read_b64_tr_b16 v[106:107], v36 offset:1024
    ds_read_b64_tr_b16 v[108:109], v37 offset:0
    ds_read_b64_tr_b16 v[110:111], v37 offset:1024
    ds_read_b64_tr_b16 v[112:113], v34 offset:16384
    ds_read_b64_tr_b16 v[114:115], v34 offset:17408
    ds_read_b64_tr_b16 v[116:117], v35 offset:16384
    ds_read_b64_tr_b16 v[118:119], v35 offset:17408
    ds_read_b64_tr_b16 v[120:121], v36 offset:16384
    ds_read_b64_tr_b16 v[122:123], v36 offset:17408
    ds_read_b64_tr_b16 v[124:125], v37 offset:16384
    ds_read_b64_tr_b16 v[126:127], v37 offset:17408
    s_cmp_eq_u32 s69, 0
    s_cbranch_scc1 Hf_127
    s_mov_b32 s21, s69
    s_mov_b32 s69, 0
    s_cmp_lg_u32 s3, 0
    s_cbranch_scc1 Hf_127
    v_mov_b32 v14, s21
    s_mov_b64 exec, 1
    buffer_atomic_add v14, off, s[92:95], s68 sc1
    s_mov_b64 exec, -1
Hf_127:
    s_waitcnt lgkmcnt(0)
    v_mfma_f32_16x16x32_bf16 a[0:3], v[96:99], v[64:67], 0
    ds_read_b64_tr_b16 v[160:161], v34 offset:8192
    v_mfma_f32_16x16x32_bf16 a[32:35], v[96:99], v[68:71], 0
    v_mfma_f32_16x16x32_bf16 a[64:67], v[96:99], v[72:75], 0
    ds_read_b64_tr_b16 v[162:163], v34 offset:9216
    v_mfma_f32_16x16x32_bf16 a[96:99], v[96:99], v[76:79], 0
    v_mfma_f32_16x16x32_bf16 a[128:131], v[96:99], v[80:83], 0
    ds_read_b128 v[128:131], v33 offset:0
    v_mfma_f32_16x16x32_bf16 a[160:163], v[96:99], v[84:87], 0
    v_mfma_f32_16x16x32_bf16 a[192:195], v[96:99], v[88:91], 0
    ds_read_b128 v[132:135], v33 offset:2048
    v_mfma_f32_16x16x32_bf16 a[224:227], v[96:99], v[92:95], 0
    v_mfma_f32_16x16x32_bf16 a[4:7], v[100:103], v[64:67], 0
    ds_read_b128 v[136:139], v33 offset:4096
    v_mfma_f32_16x16x32_bf16 a[36:39], v[100:103], v[68:71], 0
    v_mfma_f32_16x16x32_bf16 a[68:71], v[100:103], v[72:75], 0
    ds_read_b128 v[140:143], v33 offset:6144
    v_mfma_f32_16x16x32_bf16 a[100:103], v[100:103], v[76:79], 0
    v_mfma_f32_16x16x32_bf16 a[132:135], v[100:103], v[80:83], 0
    ds_read_b128 v[144:147], v33 offset:8192
    v_mfma_f32_16x16x32_bf16 a[164:167], v[100:103], v[84:87], 0
    v_mfma_f32_16x16x32_bf16 a[196:199], v[100:103], v[88:91], 0
    ds_read_b128 v[148:151], v33 offset:10240
    v_mfma_f32_16x16x32_bf16 a[228:231], v[100:103], v[92:95], 0
    v_mfma_f32_16x16x32_bf16 a[8:11], v[104:107], v[64:67], 0
    ds_read_b128 v[152:155], v33 offset:12288
    v_mfma_f32_16x16x32_bf16 a[40:43], v[104:107], v[68:71], 0
    v_mfma_f32_16x16x32_bf16 a[72:75], v[104:107], v[72:75], 0
    ds_read_b128 v[156:159], v33 offset:14336
    v_mfma_f32_16x16x32_bf16 a[104:107], v[104:107], v[76:79], 0
    v_mfma_f32_16x16x32_bf16 a[136:139], v[104:107], v[80:83], 0
    ds_read_b64_tr_b16 v[164:165], v35 offset:8192
    v_mfma_f32_16x16x32_bf16 a[168:171], v[104:107], v[84:87], 0
    v_mfma_f32_16x16x32_bf16 a[200:203], v[104:107], v[88:91], 0
    ds_read_b64_tr_b16 v[166:167], v35 offset:9216
    v_mfma_f32_16x16x32_bf16 a[232:235], v[104:107], v[92:95], 0
    v_mfma_f32_16x16x32_bf16 a[12:15], v[108:111], v[64:67], 0
    ds_read_b64_tr_b16 v[168:169], v36 offset:8192
    v_mfma_f32_16x16x32_bf16 a[44:47], v[108:111], v[68:71], 0
    v_mfma_f32_16x16x32_bf16 a[76:79], v[108:111], v[72:75], 0
    ds_read_b64_tr_b16 v[170:171], v36 offset:9216
    v_mfma_f32_16x16x32_bf16 a[108:111], v[108:111], v[76:79], 0
    v_mfma_f32_16x16x32_bf16 a[140:143], v[108:111], v[80:83], 0
    ds_read_b64_tr_b16 v[172:173], v37 offset:8192
    v_mfma_f32_16x16x32_bf16 a[172:175], v[108:111], v[84:87], 0
    v_mfma_f32_16x16x32_bf16 a[204:207], v[108:111], v[88:91], 0
    ds_read_b64_tr_b16 v[174:175], v37 offset:9216
    v_mfma_f32_16x16x32_bf16 a[236:239], v[108:111], v[92:95], 0
    v_mfma_f32_16x16x32_bf16 a[16:19], v[112:115], v[64:67], 0
    ds_read_b64_tr_b16 v[176:177], v34 offset:24576
    v_mfma_f32_16x16x32_bf16 a[48:51], v[112:115], v[68:71], 0
    v_mfma_f32_16x16x32_bf16 a[80:83], v[112:115], v[72:75], 0
    ds_read_b64_tr_b16 v[178:179], v34 offset:25600
    v_mfma_f32_16x16x32_bf16 a[112:115], v[112:115], v[76:79], 0
    v_mfma_f32_16x16x32_bf16 a[144:147], v[112:115], v[80:83], 0
    ds_read_b64_tr_b16 v[180:181], v35 offset:24576
    v_mfma_f32_16x16x32_bf16 a[176:179], v[112:115], v[84:87], 0
    v_mfma_f32_16x16x32_bf16 a[208:211], v[112:115], v[88:91], 0
    ds_read_b64_tr_b16 v[182:183], v35 offset:25600
    v_mfma_f32_16x16x32_bf16 a[240:243], v[112:115], v[92:95], 0
    v_mfma_f32_16x16x32_bf16 a[20:23], v[116:119], v[64:67], 0
    ds_read_b64_tr_b16 v[184:185], v36 offset:24576
    v_mfma_f32_16x16x32_bf16 a[52:55], v[116:119], v[68:71], 0
    v_mfma_f32_16x16x32_bf16 a[84:87], v[116:119], v[72:75], 0
    ds_read_b64_tr_b16 v[186:187], v36 offset:25600
    v_mfma_f32_16x16x32_bf16 a[116:119], v[116:119], v[76:79], 0
    v_mfma_f32_16x16x32_bf16 a[148:151], v[116:119], v[80:83], 0
    ds_read_b64_tr_b16 v[188:189], v37 offset:24576
    v_mfma_f32_16x16x32_bf16 a[180:183], v[116:119], v[84:87], 0
    v_mfma_f32_16x16x32_bf16 a[212:215], v[116:119], v[88:91], 0
    ds_read_b64_tr_b16 v[190:191], v37 offset:25600
    v_mfma_f32_16x16x32_bf16 a[244:247], v[116:119], v[92:95], 0
    v_mfma_f32_16x16x32_bf16 a[24:27], v[120:123], v[64:67], 0
    v_mfma_f32_16x16x32_bf16 a[56:59], v[120:123], v[68:71], 0
    v_mfma_f32_16x16x32_bf16 a[88:91], v[120:123], v[72:75], 0
    v_mfma_f32_16x16x32_bf16 a[120:123], v[120:123], v[76:79], 0
    v_mfma_f32_16x16x32_bf16 a[152:155], v[120:123], v[80:83], 0
    v_mfma_f32_16x16x32_bf16 a[184:187], v[120:123], v[84:87], 0
    v_mfma_f32_16x16x32_bf16 a[216:219], v[120:123], v[88:91], 0
    v_mfma_f32_16x16x32_bf16 a[248:251], v[120:123], v[92:95], 0
    s_waitcnt vmcnt(0) lgkmcnt(0)
    s_barrier
    v_mfma_f32_16x16x32_bf16 a[28:31], v[124:127], v[64:67], 0
    v_mfma_f32_16x16x32_bf16 a[60:63], v[124:127], v[68:71], 0
    v_mfma_f32_16x16x32_bf16 a[92:95], v[124:127], v[72:75], 0
    v_mfma_f32_16x16x32_bf16 a[124:127], v[124:127], v[76:79], 0
    v_mfma_f32_16x16x32_bf16 a[156:159], v[124:127], v[80:83], 0
    v_mfma_f32_16x16x32_bf16 a[188:191], v[124:127], v[84:87], 0
    v_mfma_f32_16x16x32_bf16 a[220:223], v[124:127], v[88:91], 0
    v_mfma_f32_16x16x32_bf16 a[252:255], v[124:127], v[92:95], 0
    s_mov_b32 s20, 7
Gqk_128:
    s_waitcnt lgkmcnt(0)
    v_mfma_f32_16x16x32_bf16 a[0:3], v[160:163], v[128:131], a[0:3]
    s_add_u32 m0, s18, 0
    v_mfma_f32_16x16x32_bf16 a[32:35], v[160:163], v[132:135], a[32:35]
    buffer_load_dwordx4 v16, s[8:11], s16 offen sc1 lds
    v_mfma_f32_16x16x32_bf16 a[64:67], v[160:163], v[136:139], a[64:67]
    ds_read_b64_tr_b16 v[96:97], v40 offset:0
    v_mfma_f32_16x16x32_bf16 a[96:99], v[160:163], v[140:143], a[96:99]
    ds_read_b64_tr_b16 v[98:99], v40 offset:1024
    v_mfma_f32_16x16x32_bf16 a[128:131], v[160:163], v[144:147], a[128:131]
    s_add_u32 m0, s19, 0
    v_mfma_f32_16x16x32_bf16 a[160:163], v[160:163], v[148:151], a[160:163]
    buffer_load_dwordx4 v24, s[12:15], s17 offen  lds
    v_mfma_f32_16x16x32_bf16 a[192:195], v[160:163], v[152:155], a[192:195]
    ds_read_b128 v[64:67], v38 offset:0
    v_mfma_f32_16x16x32_bf16 a[224:227], v[160:163], v[156:159], a[224:227]
    ds_read_b128 v[68:71], v38 offset:2048
    v_mfma_f32_16x16x32_bf16 a[4:7], v[164:167], v[128:131], a[4:7]
    s_add_u32 m0, s18, 1024
    v_mfma_f32_16x16x32_bf16 a[36:39], v[164:167], v[132:135], a[36:39]
    buffer_load_dwordx4 v17, s[8:11], s16 offen sc1 lds
    v_mfma_f32_16x16x32_bf16 a[68:71], v[164:167], v[136:139], a[68:71]
    ds_read_b128 v[72:75], v38 offset:4096
    v_mfma_f32_16x16x32_bf16 a[100:103], v[164:167], v[140:143], a[100:103]
    ds_read_b128 v[76:79], v38 offset:6144
    v_mfma_f32_16x16x32_bf16 a[132:135], v[164:167], v[144:147], a[132:135]
    s_add_u32 m0, s19, 1024
    v_mfma_f32_16x16x32_bf16 a[164:167], v[164:167], v[148:151], a[164:167]
    buffer_load_dwordx4 v25, s[12:15], s17 offen  lds
    v_mfma_f32_16x16x32_bf16 a[196:199], v[164:167], v[152:155], a[196:199]
    ds_read_b128 v[80:83], v38 offset:8192
    v_mfma_f32_16x16x32_bf16 a[228:231], v[164:167], v[156:159], a[228:231]
    ds_read_b128 v[84:87], v38 offset:10240
    v_mfma_f32_16x16x32_bf16 a[8:11], v[168:171], v[128:131], a[8:11]
    s_add_u32 m0, s18, 2048
    v_mfma_f32_16x16x32_bf16 a[40:43], v[168:171], v[132:135], a[40:43]
    buffer_load_dwordx4 v18, s[8:11], s16 offen sc1 lds
    v_mfma_f32_16x16x32_bf16 a[72:75], v[168:171], v[136:139], a[72:75]
    ds_read_b128 v[88:91], v38 offset:12288
    v_mfma_f32_16x16x32_bf16 a[104:107], v[168:171], v[140:143], a[104:107]
    ds_read_b128 v[92:95], v38 offset:14336
    v_mfma_f32_16x16x32_bf16 a[136:139], v[168:171], v[144:147], a[136:139]
    s_add_u32 m0, s19, 2048
    v_mfma_f32_16x16x32_bf16 a[168:171], v[168:171], v[148:151], a[168:171]
    buffer_load_dwordx4 v26, s[12:15], s17 offen  lds
    v_mfma_f32_16x16x32_bf16 a[200:203], v[168:171], v[152:155], a[200:203]
    ds_read_b64_tr_b16 v[100:101], v41 offset:0
    v_mfma_f32_16x16x32_bf16 a[232:235], v[168:171], v[156:159], a[232:235]
    ds_read_b64_tr_b16 v[102:103], v41 offset:1024
    v_mfma_f32_16x16x32_bf16 a[12:15], v[172:175], v[128:131], a[12:15]
    s_add_u32 m0, s18, 3072
    v_mfma_f32_16x16x32_bf16 a[44:47], v[172:175], v[132:135], a[44:47]
    buffer_load_dwordx4 v19, s[8:11], s16 offen sc1 lds
    v_mfma_f32_16x16x32_bf16 a[76:79], v[172:175], v[136:139], a[76:79]
    ds_read_b64_tr_b16 v[104:105], v42 offset:0
    v_mfma_f32_16x16x32_bf16 a[108:111], v[172:175], v[140:143], a[108:111]
    ds_read_b64_tr_b16 v[106:107], v42 offset:1024
    v_mfma_f32_16x16x32_bf16 a[140:143], v[172:175], v[144:147], a[140:143]
    s_add_u32 m0, s19, 3072
    v_mfma_f32_16x16x32_bf16 a[172:175], v[172:175], v[148:151], a[172:175]
    buffer_load_dwordx4 v27, s[12:15], s17 offen  lds
    v_mfma_f32_16x16x32_bf16 a[204:207], v[172:175], v[152:155], a[204:207]
    ds_read_b64_tr_b16 v[108:109], v43 offset:0
    v_mfma_f32_16x16x32_bf16 a[236:239], v[172:175], v[156:159], a[236:239]
    ds_read_b64_tr_b16 v[110:111], v43 offset:1024
    v_mfma_f32_16x16x32_bf16 a[16:19], v[176:179], v[128:131], a[16:19]
    s_add_u32 m0, s18, 4096
    v_mfma_f32_16x16x32_bf16 a[48:51], v[176:179], v[132:135], a[48:51]
    buffer_load_dwordx4 v20, s[8:11], s16 offen sc1 lds
    v_mfma_f32_16x16x32_bf16 a[80:83], v[176:179], v[136:139], a[80:83]
    ds_read_b64_tr_b16 v[112:113], v40 offset:16384
    v_mfma_f32_16x16x32_bf16 a[112:115], v[176:179], v[140:143], a[112:115]
    ds_read_b64_tr_b16 v[114:115], v40 offset:17408
    v_mfma_f32_16x16x32_bf16 a[144:147], v[176:179], v[144:147], a[144:147]
    s_add_u32 m0, s19, 4096
    v_mfma_f32_16x16x32_bf16 a[176:179], v[176:179], v[148:151], a[176:179]
    buffer_load_dwordx4 v28, s[12:15], s17 offen  lds
    v_mfma_f32_16x16x32_bf16 a[208:211], v[176:179], v[152:155], a[208:211]
    ds_read_b64_tr_b16 v[116:117], v41 offset:16384
    v_mfma_f32_16x16x32_bf16 a[240:243], v[176:179], v[156:159], a[240:243]
    ds_read_b64_tr_b16 v[118:119], v41 offset:17408
    v_mfma_f32_16x16x32_bf16 a[20:23], v[180:183], v[128:131], a[20:23]
    s_add_u32 m0, s18, 5120
    v_mfma_f32_16x16x32_bf16 a[52:55], v[180:183], v[132:135], a[52:55]
    buffer_load_dwordx4 v21, s[8:11], s16 offen sc1 lds
    v_mfma_f32_16x16x32_bf16 a[84:87], v[180:183], v[136:139], a[84:87]
    ds_read_b64_tr_b16 v[120:121], v42 offset:16384
    v_mfma_f32_16x16x32_bf16 a[116:119], v[180:183], v[140:143], a[116:119]
    ds_read_b64_tr_b16 v[122:123], v42 offset:17408
    v_mfma_f32_16x16x32_bf16 a[148:151], v[180:183], v[144:147], a[148:151]
    s_add_u32 m0, s19, 5120
    v_mfma_f32_16x16x32_bf16 a[180:183], v[180:183], v[148:151], a[180:183]
    buffer_load_dwordx4 v29, s[12:15], s17 offen  lds
    v_mfma_f32_16x16x32_bf16 a[212:215], v[180:183], v[152:155], a[212:215]
    ds_read_b64_tr_b16 v[124:125], v43 offset:16384
    v_mfma_f32_16x16x32_bf16 a[244:247], v[180:183], v[156:159], a[244:247]
    ds_read_b64_tr_b16 v[126:127], v43 offset:17408
    v_mfma_f32_16x16x32_bf16 a[24:27], v[184:187], v[128:131], a[24:27]
    s_add_u32 m0, s18, 6144
    v_mfma_f32_16x16x32_bf16 a[56:59], v[184:187], v[132:135], a[56:59]
    buffer_load_dwordx4 v22, s[8:11], s16 offen sc1 lds
    v_mfma_f32_16x16x32_bf16 a[88:91], v[184:187], v[136:139], a[88:91]
    v_mfma_f32_16x16x32_bf16 a[120:123], v[184:187], v[140:143], a[120:123]
    v_mfma_f32_16x16x32_bf16 a[152:155], v[184:187], v[144:147], a[152:155]
    s_add_u32 m0, s19, 6144
    v_mfma_f32_16x16x32_bf16 a[184:187], v[184:187], v[148:151], a[184:187]
    buffer_load_dwordx4 v30, s[12:15], s17 offen  lds
    v_mfma_f32_16x16x32_bf16 a[216:219], v[184:187], v[152:155], a[216:219]
    v_mfma_f32_16x16x32_bf16 a[248:251], v[184:187], v[156:159], a[248:251]
    v_mfma_f32_16x16x32_bf16 a[28:31], v[188:191], v[128:131], a[28:31]
    s_add_u32 m0, s18, 7168
    v_mfma_f32_16x16x32_bf16 a[60:63], v[188:191], v[132:135], a[60:63]
    buffer_load_dwordx4 v23, s[8:11], s16 offen sc1 lds
    v_mfma_f32_16x16x32_bf16 a[92:95], v[188:191], v[136:139], a[92:95]
    v_mfma_f32_16x16x32_bf16 a[124:127], v[188:191], v[140:143], a[124:127]
    v_mfma_f32_16x16x32_bf16 a[156:159], v[188:191], v[144:147], a[156:159]
    s_add_u32 m0, s19, 7168
    v_mfma_f32_16x16x32_bf16 a[188:191], v[188:191], v[148:151], a[188:191]
    buffer_load_dwordx4 v31, s[12:15], s17 offen  lds
    v_mfma_f32_16x16x32_bf16 a[220:223], v[188:191], v[152:155], a[220:223]
    v_mfma_f32_16x16x32_bf16 a[252:255], v[188:191], v[156:159], a[252:255]
    s_waitcnt lgkmcnt(0)
    s_add_u32 s16, s16, 128
    s_add_u32 s17, s17, 524288
    v_mfma_f32_16x16x32_bf16 a[0:3], v[96:99], v[64:67], a[0:3]
    ds_read_b64_tr_b16 v[160:161], v40 offset:8192
    s_mov_b32 m0, 160768
    v_mfma_f32_16x16x32_bf16 a[32:35], v[96:99], v[68:71], a[32:35]
    buffer_load_dwordx4 v13, s[24:27], s79 offen lds
    v_mfma_f32_16x16x32_bf16 a[64:67], v[96:99], v[72:75], a[64:67]
    ds_read_b64_tr_b16 v[162:163], v40 offset:9216
    v_mfma_f32_16x16x32_bf16 a[96:99], v[96:99], v[76:79], a[96:99]
    v_mfma_f32_16x16x32_bf16 a[128:131], v[96:99], v[80:83], a[128:131]
    ds_read_b128 v[128:131], v39 offset:0
    s_mov_b32 m0, 160768
    v_mfma_f32_16x16x32_bf16 a[160:163], v[96:99], v[84:87], a[160:163]
    buffer_load_dwordx4 v13, s[28:31], s79 offen lds
    v_mfma_f32_16x16x32_bf16 a[192:195], v[96:99], v[88:91], a[192:195]
    ds_read_b128 v[132:135], v39 offset:2048
    v_mfma_f32_16x16x32_bf16 a[224:227], v[96:99], v[92:95], a[224:227]
    v_mfma_f32_16x16x32_bf16 a[4:7], v[100:103], v[64:67], a[4:7]
    ds_read_b128 v[136:139], v39 offset:4096
    s_mov_b32 m0, 160768
    v_mfma_f32_16x16x32_bf16 a[36:39], v[100:103], v[68:71], a[36:39]
    buffer_load_dwordx4 v13, s[84:87], s79 offen lds
    v_mfma_f32_16x16x32_bf16 a[68:71], v[100:103], v[72:75], a[68:71]
    ds_read_b128 v[140:143], v39 offset:6144
    v_mfma_f32_16x16x32_bf16 a[100:103], v[100:103], v[76:79], a[100:103]
    v_mfma_f32_16x16x32_bf16 a[132:135], v[100:103], v[80:83], a[132:135]
    ds_read_b128 v[144:147], v39 offset:8192
    v_mfma_f32_16x16x32_bf16 a[164:167], v[100:103], v[84:87], a[164:167]
    v_mfma_f32_16x16x32_bf16 a[196:199], v[100:103], v[88:91], a[196:199]
    ds_read_b128 v[148:151], v39 offset:10240
    v_mfma_f32_16x16x32_bf16 a[228:231], v[100:103], v[92:95], a[228:231]
    v_mfma_f32_16x16x32_bf16 a[8:11], v[104:107], v[64:67], a[8:11]
    ds_read_b128 v[152:155], v39 offset:12288
    v_mfma_f32_16x16x32_bf16 a[40:43], v[104:107], v[68:71], a[40:43]
    v_mfma_f32_16x16x32_bf16 a[72:75], v[104:107], v[72:75], a[72:75]
    ds_read_b128 v[156:159], v39 offset:14336
    v_mfma_f32_16x16x32_bf16 a[104:107], v[104:107], v[76:79], a[104:107]
    v_mfma_f32_16x16x32_bf16 a[136:139], v[104:107], v[80:83], a[136:139]
    ds_read_b64_tr_b16 v[164:165], v41 offset:8192
    v_mfma_f32_16x16x32_bf16 a[168:171], v[104:107], v[84:87], a[168:171]
    v_mfma_f32_16x16x32_bf16 a[200:203], v[104:107], v[88:91], a[200:203]
    ds_read_b64_tr_b16 v[166:167], v41 offset:9216
    v_mfma_f32_16x16x32_bf16 a[232:235], v[104:107], v[92:95], a[232:235]
    v_mfma_f32_16x16x32_bf16 a[12:15], v[108:111], v[64:67], a[12:15]
    ds_read_b64_tr_b16 v[168:169], v42 offset:8192
    v_mfma_f32_16x16x32_bf16 a[44:47], v[108:111], v[68:71], a[44:47]
    v_mfma_f32_16x16x32_bf16 a[76:79], v[108:111], v[72:75], a[76:79]
    ds_read_b64_tr_b16 v[170:171], v42 offset:9216
    v_mfma_f32_16x16x32_bf16 a[108:111], v[108:111], v[76:79], a[108:111]
    v_mfma_f32_16x16x32_bf16 a[140:143], v[108:111], v[80:83], a[140:143]
    ds_read_b64_tr_b16 v[172:173], v43 offset:8192
    v_mfma_f32_16x16x32_bf16 a[172:175], v[108:111], v[84:87], a[172:175]
    v_mfma_f32_16x16x32_bf16 a[204:207], v[108:111], v[88:91], a[204:207]
    ds_read_b64_tr_b16 v[174:175], v43 offset:9216
    v_mfma_f32_16x16x32_bf16 a[236:239], v[108:111], v[92:95], a[236:239]
    v_mfma_f32_16x16x32_bf16 a[16:19], v[112:115], v[64:67], a[16:19]
    ds_read_b64_tr_b16 v[176:177], v40 offset:24576
    v_mfma_f32_16x16x32_bf16 a[48:51], v[112:115], v[68:71], a[48:51]
    v_mfma_f32_16x16x32_bf16 a[80:83], v[112:115], v[72:75], a[80:83]
    ds_read_b64_tr_b16 v[178:179], v40 offset:25600
    v_mfma_f32_16x16x32_bf16 a[112:115], v[112:115], v[76:79], a[112:115]
    v_mfma_f32_16x16x32_bf16 a[144:147], v[112:115], v[80:83], a[144:147]
    ds_read_b64_tr_b16 v[180:181], v41 offset:24576
    v_mfma_f32_16x16x32_bf16 a[176:179], v[112:115], v[84:87], a[176:179]
    v_mfma_f32_16x16x32_bf16 a[208:211], v[112:115], v[88:91], a[208:211]
    ds_read_b64_tr_b16 v[182:183], v41 offset:25600
    v_mfma_f32_16x16x32_bf16 a[240:243], v[112:115], v[92:95], a[240:243]
    v_mfma_f32_16x16x32_bf16 a[20:23], v[116:119], v[64:67], a[20:23]
    ds_read_b64_tr_b16 v[184:185], v42 offset:24576
    v_mfma_f32_16x16x32_bf16 a[52:55], v[116:119], v[68:71], a[52:55]
    v_mfma_f32_16x16x32_bf16 a[84:87], v[116:119], v[72:75], a[84:87]
    ds_read_b64_tr_b16 v[186:187], v42 offset:25600
    v_mfma_f32_16x16x32_bf16 a[116:119], v[116:119], v[76:79], a[116:119]
    v_mfma_f32_16x16x32_bf16 a[148:151], v[116:119], v[80:83], a[148:151]
    ds_read_b64_tr_b16 v[188:189], v43 offset:24576
    v_mfma_f32_16x16x32_bf16 a[180:183], v[116:119], v[84:87], a[180:183]
    v_mfma_f32_16x16x32_bf16 a[212:215], v[116:119], v[88:91], a[212:215]
    ds_read_b64_tr_b16 v[190:191], v43 offset:25600
    v_mfma_f32_16x16x32_bf16 a[244:247], v[116:119], v[92:95], a[244:247]
    v_mfma_f32_16x16x32_bf16 a[24:27], v[120:123], v[64:67], a[24:27]
    v_mfma_f32_16x16x32_bf16 a[56:59], v[120:123], v[68:71], a[56:59]
    v_mfma_f32_16x16x32_bf16 a[88:91], v[120:123], v[72:75], a[88:91]
    v_mfma_f32_16x16x32_bf16 a[120:123], v[120:123], v[76:79], a[120:123]
    v_mfma_f32_16x16x32_bf16 a[152:155], v[120:123], v[80:83], a[152:155]
    v_mfma_f32_16x16x32_bf16 a[184:187], v[120:123], v[84:87], a[184:187]
    v_mfma_f32_16x16x32_bf16 a[216:219], v[120:123], v[88:91], a[216:219]
    v_mfma_f32_16x16x32_bf16 a[248:251], v[120:123], v[92:95], a[248:251]
    s_waitcnt vmcnt(3) lgkmcnt(0)
    s_barrier
    v_mfma_f32_16x16x32_bf16 a[28:31], v[124:127], v[64:67], a[28:31]
    v_mfma_f32_16x16x32_bf16 a[60:63], v[124:127], v[68:71], a[60:63]
    v_mfma_f32_16x16x32_bf16 a[92:95], v[124:127], v[72:75], a[92:95]
    v_mfma_f32_16x16x32_bf16 a[124:127], v[124:127], v[76:79], a[124:127]
    v_mfma_f32_16x16x32_bf16 a[156:159], v[124:127], v[80:83], a[156:159]
    v_mfma_f32_16x16x32_bf16 a[188:191], v[124:127], v[84:87], a[188:191]
    v_mfma_f32_16x16x32_bf16 a[220:223], v[124:127], v[88:91], a[220:223]
    v_mfma_f32_16x16x32_bf16 a[252:255], v[124:127], v[92:95], a[252:255]
    s_add_u32 s79, s79, 1024
    s_waitcnt lgkmcnt(0)
    v_mfma_f32_16x16x32_bf16 a[0:3], v[160:163], v[128:131], a[0:3]
    s_add_u32 m0, s18, 65536
    v_mfma_f32_16x16x32_bf16 a[32:35], v[160:163], v[132:135], a[32:35]
    buffer_load_dwordx4 v16, s[8:11], s16 offen sc1 lds
    v_mfma_f32_16x16x32_bf16 a[64:67], v[160:163], v[136:139], a[64:67]
    ds_read_b64_tr_b16 v[96:97], v34 offset:0
    v_mfma_f32_16x16x32_bf16 a[96:99], v[160:163], v[140:143], a[96:99]
    ds_read_b64_tr_b16 v[98:99], v34 offset:1024
    v_mfma_f32_16x16x32_bf16 a[128:131], v[160:163], v[144:147], a[128:131]
    s_add_u32 m0, s19, 65536
    v_mfma_f32_16x16x32_bf16 a[160:163], v[160:163], v[148:151], a[160:163]
    buffer_load_dwordx4 v24, s[12:15], s17 offen  lds
    v_mfma_f32_16x16x32_bf16 a[192:195], v[160:163], v[152:155], a[192:195]
    ds_read_b128 v[64:67], v32 offset:0
    v_mfma_f32_16x16x32_bf16 a[224:227], v[160:163], v[156:159], a[224:227]
    ds_read_b128 v[68:71], v32 offset:2048
    v_mfma_f32_16x16x32_bf16 a[4:7], v[164:167], v[128:131], a[4:7]
    s_add_u32 m0, s18, 66560
    v_mfma_f32_16x16x32_bf16 a[36:39], v[164:167], v[132:135], a[36:39]
    buffer_load_dwordx4 v17, s[8:11], s16 offen sc1 lds
    v_mfma_f32_16x16x32_bf16 a[68:71], v[164:167], v[136:139], a[68:71]
    ds_read_b128 v[72:75], v32 offset:4096
    v_mfma_f32_16x16x32_bf16 a[100:103], v[164:167], v[140:143], a[100:103]
    ds_read_b128 v[76:79], v32 offset:6144
    v_mfma_f32_16x16x32_bf16 a[132:135], v[164:167], v[144:147], a[132:135]
    s_add_u32 m0, s19, 66560
    v_mfma_f32_16x16x32_bf16 a[164:167], v[164:167], v[148:151], a[164:167]
    buffer_load_dwordx4 v25, s[12:15], s17 offen  lds
    v_mfma_f32_16x16x32_bf16 a[196:199], v[164:167], v[152:155], a[196:199]
    ds_read_b128 v[80:83], v32 offset:8192
    v_mfma_f32_16x16x32_bf16 a[228:231], v[164:167], v[156:159], a[228:231]
    ds_read_b128 v[84:87], v32 offset:10240
    v_mfma_f32_16x16x32_bf16 a[8:11], v[168:171], v[128:131], a[8:11]
    s_add_u32 m0, s18, 67584
    v_mfma_f32_16x16x32_bf16 a[40:43], v[168:171], v[132:135], a[40:43]
    buffer_load_dwordx4 v18, s[8:11], s16 offen sc1 lds
    v_mfma_f32_16x16x32_bf16 a[72:75], v[168:171], v[136:139], a[72:75]
    ds_read_b128 v[88:91], v32 offset:12288
    v_mfma_f32_16x16x32_bf16 a[104:107], v[168:171], v[140:143], a[104:107]
    ds_read_b128 v[92:95], v32 offset:14336
    v_mfma_f32_16x16x32_bf16 a[136:139], v[168:171], v[144:147], a[136:139]
    s_add_u32 m0, s19, 67584
    v_mfma_f32_16x16x32_bf16 a[168:171], v[168:171], v[148:151], a[168:171]
    buffer_load_dwordx4 v26, s[12:15], s17 offen  lds
    v_mfma_f32_16x16x32_bf16 a[200:203], v[168:171], v[152:155], a[200:203]
    ds_read_b64_tr_b16 v[100:101], v35 offset:0
    v_mfma_f32_16x16x32_bf16 a[232:235], v[168:171], v[156:159], a[232:235]
    ds_read_b64_tr_b16 v[102:103], v35 offset:1024
    v_mfma_f32_16x16x32_bf16 a[12:15], v[172:175], v[128:131], a[12:15]
    s_add_u32 m0, s18, 68608
    v_mfma_f32_16x16x32_bf16 a[44:47], v[172:175], v[132:135], a[44:47]
    buffer_load_dwordx4 v19, s[8:11], s16 offen sc1 lds
    v_mfma_f32_16x16x32_bf16 a[76:79], v[172:175], v[136:139], a[76:79]
    ds_read_b64_tr_b16 v[104:105], v36 offset:0
    v_mfma_f32_16x16x32_bf16 a[108:111], v[172:175], v[140:143], a[108:111]
    ds_read_b64_tr_b16 v[106:107], v36 offset:1024
    v_mfma_f32_16x16x32_bf16 a[140:143], v[172:175], v[144:147], a[140:143]
    s_add_u32 m0, s19, 68608
    v_mfma_f32_16x16x32_bf16 a[172:175], v[172:175], v[148:151], a[172:175]
    buffer_load_dwordx4 v27, s[12:15], s17 offen  lds
    v_mfma_f32_16x16x32_bf16 a[204:207], v[172:175], v[152:155], a[204:207]
    ds_read_b64_tr_b16 v[108:109], v37 offset:0
    v_mfma_f32_16x16x32_bf16 a[236:239], v[172:175], v[156:159], a[236:239]
    ds_read_b64_tr_b16 v[110:111], v37 offset:1024
    v_mfma_f32_16x16x32_bf16 a[16:19], v[176:179], v[128:131], a[16:19]
    s_add_u32 m0, s18, 69632
    v_mfma_f32_16x16x32_bf16 a[48:51], v[176:179], v[132:135], a[48:51]
    buffer_load_dwordx4 v20, s[8:11], s16 offen sc1 lds
    v_mfma_f32_16x16x32_bf16 a[80:83], v[176:179], v[136:139], a[80:83]
    ds_read_b64_tr_b16 v[112:113], v34 offset:16384
    v_mfma_f32_16x16x32_bf16 a[112:115], v[176:179], v[140:143], a[112:115]
    ds_read_b64_tr_b16 v[114:115], v34 offset:17408
    v_mfma_f32_16x16x32_bf16 a[144:147], v[176:179], v[144:147], a[144:147]
    s_add_u32 m0, s19, 69632
    v_mfma_f32_16x16x32_bf16 a[176:179], v[176:179], v[148:151], a[176:179]
    buffer_load_dwordx4 v28, s[12:15], s17 offen  lds
    v_mfma_f32_16x16x32_bf16 a[208:211], v[176:179], v[152:155], a[208:211]
    ds_read_b64_tr_b16 v[116:117], v35 offset:16384
    v_mfma_f32_16x16x32_bf16 a[240:243], v[176:179], v[156:159], a[240:243]
    ds_read_b64_tr_b16 v[118:119], v35 offset:17408
    v_mfma_f32_16x16x32_bf16 a[20:23], v[180:183], v[128:131], a[20:23]
    s_add_u32 m0, s18, 70656
    v_mfma_f32_16x16x32_bf16 a[52:55], v[180:183], v[132:135], a[52:55]
    buffer_load_dwordx4 v21, s[8:11], s16 offen sc1 lds
    v_mfma_f32_16x16x32_bf16 a[84:87], v[180:183], v[136:139], a[84:87]
    ds_read_b64_tr_b16 v[120:121], v36 offset:16384
    v_mfma_f32_16x16x32_bf16 a[116:119], v[180:183], v[140:143], a[116:119]
    ds_read_b64_tr_b16 v[122:123], v36 offset:17408
    v_mfma_f32_16x16x32_bf16 a[148:151], v[180:183], v[144:147], a[148:151]
    s_add_u32 m0, s19, 70656
    v_mfma_f32_16x16x32_bf16 a[180:183], v[180:183], v[148:151], a[180:183]
    buffer_load_dwordx4 v29, s[12:15], s17 offen  lds
    v_mfma_f32_16x16x32_bf16 a[212:215], v[180:183], v[152:155], a[212:215]
    ds_read_b64_tr_b16 v[124:125], v37 offset:16384
    v_mfma_f32_16x16x32_bf16 a[244:247], v[180:183], v[156:159], a[244:247]
    ds_read_b64_tr_b16 v[126:127], v37 offset:17408
    v_mfma_f32_16x16x32_bf16 a[24:27], v[184:187], v[128:131], a[24:27]
    s_add_u32 m0, s18, 71680
    v_mfma_f32_16x16x32_bf16 a[56:59], v[184:187], v[132:135], a[56:59]
    buffer_load_dwordx4 v22, s[8:11], s16 offen sc1 lds
    v_mfma_f32_16x16x32_bf16 a[88:91], v[184:187], v[136:139], a[88:91]
    v_mfma_f32_16x16x32_bf16 a[120:123], v[184:187], v[140:143], a[120:123]
    v_mfma_f32_16x16x32_bf16 a[152:155], v[184:187], v[144:147], a[152:155]
    s_add_u32 m0, s19, 71680
    v_mfma_f32_16x16x32_bf16 a[184:187], v[184:187], v[148:151], a[184:187]
    buffer_load_dwordx4 v30, s[12:15], s17 offen  lds
    v_mfma_f32_16x16x32_bf16 a[216:219], v[184:187], v[152:155], a[216:219]
    v_mfma_f32_16x16x32_bf16 a[248:251], v[184:187], v[156:159], a[248:251]
    v_mfma_f32_16x16x32_bf16 a[28:31], v[188:191], v[128:131], a[28:31]
    s_add_u32 m0, s18, 72704
    v_mfma_f32_16x16x32_bf16 a[60:63], v[188:191], v[132:135], a[60:63]
    buffer_load_dwordx4 v23, s[8:11], s16 offen sc1 lds
    v_mfma_f32_16x16x32_bf16 a[92:95], v[188:191], v[136:139], a[92:95]
    v_mfma_f32_16x16x32_bf16 a[124:127], v[188:191], v[140:143], a[124:127]
    v_mfma_f32_16x16x32_bf16 a[156:159], v[188:191], v[144:147], a[156:159]
    s_add_u32 m0, s19, 72704
    v_mfma_f32_16x16x32_bf16 a[188:191], v[188:191], v[148:151], a[188:191]
    buffer_load_dwordx4 v31, s[12:15], s17 offen  lds
    v_mfma_f32_16x16x32_bf16 a[220:223], v[188:191], v[152:155], a[220:223]
    v_mfma_f32_16x16x32_bf16 a[252:255], v[188:191], v[156:159], a[252:255]
    s_waitcnt lgkmcnt(0)
    s_add_u32 s16, s16, 128
    s_add_u32 s17, s17, 524288
    v_mfma_f32_16x16x32_bf16 a[0:3], v[96:99], v[64:67], a[0:3]
    ds_read_b64_tr_b16 v[160:161], v34 offset:8192
    s_mov_b32 m0, 160768
    v_mfma_f32_16x16x32_bf16 a[32:35], v[96:99], v[68:71], a[32:35]
    buffer_load_dwordx4 v13, s[24:27], s79 offen lds
    v_mfma_f32_16x16x32_bf16 a[64:67], v[96:99], v[72:75], a[64:67]
    ds_read_b64_tr_b16 v[162:163], v34 offset:9216
    v_mfma_f32_16x16x32_bf16 a[96:99], v[96:99], v[76:79], a[96:99]
    v_mfma_f32_16x16x32_bf16 a[128:131], v[96:99], v[80:83], a[128:131]
    ds_read_b128 v[128:131], v33 offset:0
    s_mov_b32 m0, 160768
    v_mfma_f32_16x16x32_bf16 a[160:163], v[96:99], v[84:87], a[160:163]
    buffer_load_dwordx4 v13, s[28:31], s79 offen lds
    v_mfma_f32_16x16x32_bf16 a[192:195], v[96:99], v[88:91], a[192:195]
    ds_read_b128 v[132:135], v33 offset:2048
    v_mfma_f32_16x16x32_bf16 a[224:227], v[96:99], v[92:95], a[224:227]
    v_mfma_f32_16x16x32_bf16 a[4:7], v[100:103], v[64:67], a[4:7]
    ds_read_b128 v[136:139], v33 offset:4096
    s_mov_b32 m0, 160768
    v_mfma_f32_16x16x32_bf16 a[36:39], v[100:103], v[68:71], a[36:39]
    buffer_load_dwordx4 v13, s[84:87], s79 offen lds
    v_mfma_f32_16x16x32_bf16 a[68:71], v[100:103], v[72:75], a[68:71]
    ds_read_b128 v[140:143], v33 offset:6144
    v_mfma_f32_16x16x32_bf16 a[100:103], v[100:103], v[76:79], a[100:103]
    v_mfma_f32_16x16x32_bf16 a[132:135], v[100:103], v[80:83], a[132:135]
    ds_read_b128 v[144:147], v33 offset:8192
    v_mfma_f32_16x16x32_bf16 a[164:167], v[100:103], v[84:87], a[164:167]
    v_mfma_f32_16x16x32_bf16 a[196:199], v[100:103], v[88:91], a[196:199]
    ds_read_b128 v[148:151], v33 offset:10240
    v_mfma_f32_16x16x32_bf16 a[228:231], v[100:103], v[92:95], a[228:231]
    v_mfma_f32_16x16x32_bf16 a[8:11], v[104:107], v[64:67], a[8:11]
    ds_read_b128 v[152:155], v33 offset:12288
    v_mfma_f32_16x16x32_bf16 a[40:43], v[104:107], v[68:71], a[40:43]
    v_mfma_f32_16x16x32_bf16 a[72:75], v[104:107], v[72:75], a[72:75]
    ds_read_b128 v[156:159], v33 offset:14336
    v_mfma_f32_16x16x32_bf16 a[104:107], v[104:107], v[76:79], a[104:107]
    v_mfma_f32_16x16x32_bf16 a[136:139], v[104:107], v[80:83], a[136:139]
    ds_read_b64_tr_b16 v[164:165], v35 offset:8192
    v_mfma_f32_16x16x32_bf16 a[168:171], v[104:107], v[84:87], a[168:171]
    v_mfma_f32_16x16x32_bf16 a[200:203], v[104:107], v[88:91], a[200:203]
    ds_read_b64_tr_b16 v[166:167], v35 offset:9216
    v_mfma_f32_16x16x32_bf16 a[232:235], v[104:107], v[92:95], a[232:235]
    v_mfma_f32_16x16x32_bf16 a[12:15], v[108:111], v[64:67], a[12:15]
    ds_read_b64_tr_b16 v[168:169], v36 offset:8192
    v_mfma_f32_16x16x32_bf16 a[44:47], v[108:111], v[68:71], a[44:47]
    v_mfma_f32_16x16x32_bf16 a[76:79], v[108:111], v[72:75], a[76:79]
    ds_read_b64_tr_b16 v[170:171], v36 offset:9216
    v_mfma_f32_16x16x32_bf16 a[108:111], v[108:111], v[76:79], a[108:111]
    v_mfma_f32_16x16x32_bf16 a[140:143], v[108:111], v[80:83], a[140:143]
    ds_read_b64_tr_b16 v[172:173], v37 offset:8192
    v_mfma_f32_16x16x32_bf16 a[172:175], v[108:111], v[84:87], a[172:175]
    v_mfma_f32_16x16x32_bf16 a[204:207], v[108:111], v[88:91], a[204:207]
    ds_read_b64_tr_b16 v[174:175], v37 offset:9216
    v_mfma_f32_16x16x32_bf16 a[236:239], v[108:111], v[92:95], a[236:239]
    v_mfma_f32_16x16x32_bf16 a[16:19], v[112:115], v[64:67], a[16:19]
    ds_read_b64_tr_b16 v[176:177], v34 offset:24576
    v_mfma_f32_16x16x32_bf16 a[48:51], v[112:115], v[68:71], a[48:51]
    v_mfma_f32_16x16x32_bf16 a[80:83], v[112:115], v[72:75], a[80:83]
    ds_read_b64_tr_b16 v[178:179], v34 offset:25600
    v_mfma_f32_16x16x32_bf16 a[112:115], v[112:115], v[76:79], a[112:115]
    v_mfma_f32_16x16x32_bf16 a[144:147], v[112:115], v[80:83], a[144:147]
    ds_read_b64_tr_b16 v[180:181], v35 offset:24576
    v_mfma_f32_16x16x32_bf16 a[176:179], v[112:115], v[84:87], a[176:179]
    v_mfma_f32_16x16x32_bf16 a[208:211], v[112:115], v[88:91], a[208:211]
    ds_read_b64_tr_b16 v[182:183], v35 offset:25600
    v_mfma_f32_16x16x32_bf16 a[240:243], v[112:115], v[92:95], a[240:243]
    v_mfma_f32_16x16x32_bf16 a[20:23], v[116:119], v[64:67], a[20:23]
    ds_read_b64_tr_b16 v[184:185], v36 offset:24576
    v_mfma_f32_16x16x32_bf16 a[52:55], v[116:119], v[68:71], a[52:55]
    v_mfma_f32_16x16x32_bf16 a[84:87], v[116:119], v[72:75], a[84:87]
    ds_read_b64_tr_b16 v[186:187], v36 offset:25600
    v_mfma_f32_16x16x32_bf16 a[116:119], v[116:119], v[76:79], a[116:119]
    v_mfma_f32_16x16x32_bf16 a[148:151], v[116:119], v[80:83], a[148:151]
    ds_read_b64_tr_b16 v[188:189], v37 offset:24576
    v_mfma_f32_16x16x32_bf16 a[180:183], v[116:119], v[84:87], a[180:183]
    v_mfma_f32_16x16x32_bf16 a[212:215], v[116:119], v[88:91], a[212:215]
    ds_read_b64_tr_b16 v[190:191], v37 offset:25600
    v_mfma_f32_16x16x32_bf16 a[244:247], v[116:119], v[92:95], a[244:247]
    v_mfma_f32_16x16x32_bf16 a[24:27], v[120:123], v[64:67], a[24:27]
    v_mfma_f32_16x16x32_bf16 a[56:59], v[120:123], v[68:71], a[56:59]
    v_mfma_f32_16x16x32_bf16 a[88:91], v[120:123], v[72:75], a[88:91]
    v_mfma_f32_16x16x32_bf16 a[120:123], v[120:123], v[76:79], a[120:123]
    v_mfma_f32_16x16x32_bf16 a[152:155], v[120:123], v[80:83], a[152:155]
    v_mfma_f32_16x16x32_bf16 a[184:187], v[120:123], v[84:87], a[184:187]
    v_mfma_f32_16x16x32_bf16 a[216:219], v[120:123], v[88:91], a[216:219]
    v_mfma_f32_16x16x32_bf16 a[248:251], v[120:123], v[92:95], a[248:251]
    s_waitcnt vmcnt(3) lgkmcnt(0)
    s_barrier
    v_mfma_f32_16x16x32_bf16 a[28:31], v[124:127], v[64:67], a[28:31]
    v_mfma_f32_16x16x32_bf16 a[60:63], v[124:127], v[68:71], a[60:63]
    v_mfma_f32_16x16x32_bf16 a[92:95], v[124:127], v[72:75], a[92:95]
    v_mfma_f32_16x16x32_bf16 a[124:127], v[124:127], v[76:79], a[124:127]
    v_mfma_f32_16x16x32_bf16 a[156:159], v[124:127], v[80:83], a[156:159]
    v_mfma_f32_16x16x32_bf16 a[188:191], v[124:127], v[84:87], a[188:191]
    v_mfma_f32_16x16x32_bf16 a[220:223], v[124:127], v[88:91], a[220:223]
    v_mfma_f32_16x16x32_bf16 a[252:255], v[124:127], v[92:95], a[252:255]
    s_add_u32 s79, s79, 1024
    s_sub_u32 s20, s20, 1
    s_cmp_lg_u32 s20, 0
    s_cbranch_scc1 Gqk_128
    s_cmp_lg_u32 s3, 0
    s_cbranch_scc1 Ht_129
    v_mov_b32 v14, 1
    s_mov_b64 exec, 1
    buffer_atomic_add v14, off, s[92:95], s97 sc0 sc1
    s_mov_b64 exec, -1
Ht_129:
    s_waitcnt lgkmcnt(0)
    v_mfma_f32_16x16x32_bf16 a[0:3], v[160:163], v[128:131], a[0:3]
    ds_read_b64_tr_b16 v[96:97], v40 offset:0
    v_mfma_f32_16x16x32_bf16 a[32:35], v[160:163], v[132:135], a[32:35]
    v_mfma_f32_16x16x32_bf16 a[64:67], v[160:163], v[136:139], a[64:67]
    ds_read_b64_tr_b16 v[98:99], v40 offset:1024
    v_mfma_f32_16x16x32_bf16 a[96:99], v[160:163], v[140:143], a[96:99]
    v_mfma_f32_16x16x32_bf16 a[128:131], v[160:163], v[144:147], a[128:131]
    ds_read_b128 v[64:67], v38 offset:0
    v_mfma_f32_16x16x32_bf16 a[160:163], v[160:163], v[148:151], a[160:163]
    v_mfma_f32_16x16x32_bf16 a[192:195], v[160:163], v[152:155], a[192:195]
    ds_read_b128 v[68:71], v38 offset:2048
    v_mfma_f32_16x16x32_bf16 a[224:227], v[160:163], v[156:159], a[224:227]
    v_mfma_f32_16x16x32_bf16 a[4:7], v[164:167], v[128:131], a[4:7]
    ds_read_b128 v[72:75], v38 offset:4096
    v_mfma_f32_16x16x32_bf16 a[36:39], v[164:167], v[132:135], a[36:39]
    v_mfma_f32_16x16x32_bf16 a[68:71], v[164:167], v[136:139], a[68:71]
    ds_read_b128 v[76:79], v38 offset:6144
    v_mfma_f32_16x16x32_bf16 a[100:103], v[164:167], v[140:143], a[100:103]
    v_mfma_f32_16x16x32_bf16 a[132:135], v[164:167], v[144:147], a[132:135]
    ds_read_b128 v[80:83], v38 offset:8192
    v_mfma_f32_16x16x32_bf16 a[164:167], v[164:167], v[148:151], a[164:167]
    v_mfma_f32_16x16x32_bf16 a[196:199], v[164:167], v[152:155], a[196:199]
    ds_read_b128 v[84:87], v38 offset:10240
    v_mfma_f32_16x16x32_bf16 a[228:231], v[164:167], v[156:159], a[228:231]
    v_mfma_f32_16x16x32_bf16 a[8:11], v[168:171], v[128:131], a[8:11]
    ds_read_b128 v[88:91], v38 offset:12288
    v_mfma_f32_16x16x32_bf16 a[40:43], v[168:171], v[132:135], a[40:43]
    v_mfma_f32_16x16x32_bf16 a[72:75], v[168:171], v[136:139], a[72:75]
    ds_read_b128 v[92:95], v38 offset:14336
    v_mfma_f32_16x16x32_bf16 a[104:107], v[168:171], v[140:143], a[104:107]
    v_mfma_f32_16x16x32_bf16 a[136:139], v[168:171], v[144:147], a[136:139]
    ds_read_b64_tr_b16 v[100:101], v41 offset:0
    v_mfma_f32_16x16x32_bf16 a[168:171], v[168:171], v[148:151], a[168:171]
    v_mfma_f32_16x16x32_bf16 a[200:203], v[168:171], v[152:155], a[200:203]
    ds_read_b64_tr_b16 v[102:103], v41 offset:1024
    v_mfma_f32_16x16x32_bf16 a[232:235], v[168:171], v[156:159], a[232:235]
    v_mfma_f32_16x16x32_bf16 a[12:15], v[172:175], v[128:131], a[12:15]
    ds_read_b64_tr_b16 v[104:105], v42 offset:0
    v_mfma_f32_16x16x32_bf16 a[44:47], v[172:175], v[132:135], a[44:47]
    v_mfma_f32_16x16x32_bf16 a[76:79], v[172:175], v[136:139], a[76:79]
    ds_read_b64_tr_b16 v[106:107], v42 offset:1024
    v_mfma_f32_16x16x32_bf16 a[108:111], v[172:175], v[140:143], a[108:111]
    v_mfma_f32_16x16x32_bf16 a[140:143], v[172:175], v[144:147], a[140:143]
    ds_read_b64_tr_b16 v[108:109], v43 offset:0
    v_mfma_f32_16x16x32_bf16 a[172:175], v[172:175], v[148:151], a[172:175]
    v_mfma_f32_16x16x32_bf16 a[204:207], v[172:175], v[152:155], a[204:207]
    ds_read_b64_tr_b16 v[110:111], v43 offset:1024
    v_mfma_f32_16x16x32_bf16 a[236:239], v[172:175], v[156:159], a[236:239]
    v_mfma_f32_16x16x32_bf16 a[16:19], v[176:179], v[128:131], a[16:19]
    ds_read_b64_tr_b16 v[112:113], v40 offset:16384
    v_mfma_f32_16x16x32_bf16 a[48:51], v[176:179], v[132:135], a[48:51]
    v_mfma_f32_16x16x32_bf16 a[80:83], v[176:179], v[136:139], a[80:83]
    ds_read_b64_tr_b16 v[114:115], v40 offset:17408
    v_mfma_f32_16x16x32_bf16 a[112:115], v[176:179], v[140:143], a[112:115]
    v_mfma_f32_16x16x32_bf16 a[144:147], v[176:179], v[144:147], a[144:147]
    ds_read_b64_tr_b16 v[116:117], v41 offset:16384
    v_mfma_f32_16x16x32_bf16 a[176:179], v[176:179], v[148:151], a[176:179]
    v_mfma_f32_16x16x32_bf16 a[208:211], v[176:179], v[152:155], a[208:211]
    ds_read_b64_tr_b16 v[118:119], v41 offset:17408
    v_mfma_f32_16x16x32_bf16 a[240:243], v[176:179], v[156:159], a[240:243]
    v_mfma_f32_16x16x32_bf16 a[20:23], v[180:183], v[128:131], a[20:23]
    ds_read_b64_tr_b16 v[120:121], v42 offset:16384
    v_mfma_f32_16x16x32_bf16 a[52:55], v[180:183], v[132:135], a[52:55]
    v_mfma_f32_16x16x32_bf16 a[84:87], v[180:183], v[136:139], a[84:87]
    ds_read_b64_tr_b16 v[122:123], v42 offset:17408
    v_mfma_f32_16x16x32_bf16 a[116:119], v[180:183], v[140:143], a[116:119]
    v_mfma_f32_16x16x32_bf16 a[148:151], v[180:183], v[144:147], a[148:151]
    ds_read_b64_tr_b16 v[124:125], v43 offset:16384
    v_mfma_f32_16x16x32_bf16 a[180:183], v[180:183], v[148:151], a[180:183]
    v_mfma_f32_16x16x32_bf16 a[212:215], v[180:183], v[152:155], a[212:215]
    ds_read_b64_tr_b16 v[126:127], v43 offset:17408
    v_mfma_f32_16x16x32_bf16 a[244:247], v[180:183], v[156:159], a[244:247]
    v_mfma_f32_16x16x32_bf16 a[24:27], v[184:187], v[128:131], a[24:27]
    v_mfma_f32_16x16x32_bf16 a[56:59], v[184:187], v[132:135], a[56:59]
    v_mfma_f32_16x16x32_bf16 a[88:91], v[184:187], v[136:139], a[88:91]
    v_mfma_f32_16x16x32_bf16 a[120:123], v[184:187], v[140:143], a[120:123]
    v_mfma_f32_16x16x32_bf16 a[152:155], v[184:187], v[144:147], a[152:155]
    v_mfma_f32_16x16x32_bf16 a[184:187], v[184:187], v[148:151], a[184:187]
    v_mfma_f32_16x16x32_bf16 a[216:219], v[184:187], v[152:155], a[216:219]
    v_mfma_f32_16x16x32_bf16 a[248:251], v[184:187], v[156:159], a[248:251]
    v_mfma_f32_16x16x32_bf16 a[28:31], v[188:191], v[128:131], a[28:31]
    v_mfma_f32_16x16x32_bf16 a[60:63], v[188:191], v[132:135], a[60:63]
    v_mfma_f32_16x16x32_bf16 a[92:95], v[188:191], v[136:139], a[92:95]
    v_mfma_f32_16x16x32_bf16 a[124:127], v[188:191], v[140:143], a[124:127]
    v_mfma_f32_16x16x32_bf16 a[156:159], v[188:191], v[144:147], a[156:159]
    v_mfma_f32_16x16x32_bf16 a[188:191], v[188:191], v[148:151], a[188:191]
    v_mfma_f32_16x16x32_bf16 a[220:223], v[188:191], v[152:155], a[220:223]
    v_mfma_f32_16x16x32_bf16 a[252:255], v[188:191], v[156:159], a[252:255]
    s_waitcnt lgkmcnt(0)
    v_mfma_f32_16x16x32_bf16 a[0:3], v[96:99], v[64:67], a[0:3]
    ds_read_b64_tr_b16 v[160:161], v40 offset:8192
    v_mfma_f32_16x16x32_bf16 a[32:35], v[96:99], v[68:71], a[32:35]
    v_mfma_f32_16x16x32_bf16 a[64:67], v[96:99], v[72:75], a[64:67]
    ds_read_b64_tr_b16 v[162:163], v40 offset:9216
    v_mfma_f32_16x16x32_bf16 a[96:99], v[96:99], v[76:79], a[96:99]
    v_mfma_f32_16x16x32_bf16 a[128:131], v[96:99], v[80:83], a[128:131]
    ds_read_b128 v[128:131], v39 offset:0
    v_mfma_f32_16x16x32_bf16 a[160:163], v[96:99], v[84:87], a[160:163]
    v_mfma_f32_16x16x32_bf16 a[192:195], v[96:99], v[88:91], a[192:195]
    ds_read_b128 v[132:135], v39 offset:2048
    v_mfma_f32_16x16x32_bf16 a[224:227], v[96:99], v[92:95], a[224:227]
    v_mfma_f32_16x16x32_bf16 a[4:7], v[100:103], v[64:67], a[4:7]
    ds_read_b128 v[136:139], v39 offset:4096
    v_mfma_f32_16x16x32_bf16 a[36:39], v[100:103], v[68:71], a[36:39]
    v_mfma_f32_16x16x32_bf16 a[68:71], v[100:103], v[72:75], a[68:71]
    ds_read_b128 v[140:143], v39 offset:6144
    v_mfma_f32_16x16x32_bf16 a[100:103], v[100:103], v[76:79], a[100:103]
    v_mfma_f32_16x16x32_bf16 a[132:135], v[100:103], v[80:83], a[132:135]
    ds_read_b128 v[144:147], v39 offset:8192
    v_mfma_f32_16x16x32_bf16 a[164:167], v[100:103], v[84:87], a[164:167]
    v_mfma_f32_16x16x32_bf16 a[196:199], v[100:103], v[88:91], a[196:199]
    ds_read_b128 v[148:151], v39 offset:10240
    v_mfma_f32_16x16x32_bf16 a[228:231], v[100:103], v[92:95], a[228:231]
    v_mfma_f32_16x16x32_bf16 a[8:11], v[104:107], v[64:67], a[8:11]
    ds_read_b128 v[152:155], v39 offset:12288
    v_mfma_f32_16x16x32_bf16 a[40:43], v[104:107], v[68:71], a[40:43]
    v_mfma_f32_16x16x32_bf16 a[72:75], v[104:107], v[72:75], a[72:75]
    ds_read_b128 v[156:159], v39 offset:14336
    v_mfma_f32_16x16x32_bf16 a[104:107], v[104:107], v[76:79], a[104:107]
    v_mfma_f32_16x16x32_bf16 a[136:139], v[104:107], v[80:83], a[136:139]
    ds_read_b64_tr_b16 v[164:165], v41 offset:8192
    v_mfma_f32_16x16x32_bf16 a[168:171], v[104:107], v[84:87], a[168:171]
    v_mfma_f32_16x16x32_bf16 a[200:203], v[104:107], v[88:91], a[200:203]
    ds_read_b64_tr_b16 v[166:167], v41 offset:9216
    v_mfma_f32_16x16x32_bf16 a[232:235], v[104:107], v[92:95], a[232:235]
    v_mfma_f32_16x16x32_bf16 a[12:15], v[108:111], v[64:67], a[12:15]
    ds_read_b64_tr_b16 v[168:169], v42 offset:8192
    v_mfma_f32_16x16x32_bf16 a[44:47], v[108:111], v[68:71], a[44:47]
    v_mfma_f32_16x16x32_bf16 a[76:79], v[108:111], v[72:75], a[76:79]
    ds_read_b64_tr_b16 v[170:171], v42 offset:9216
    v_mfma_f32_16x16x32_bf16 a[108:111], v[108:111], v[76:79], a[108:111]
    v_mfma_f32_16x16x32_bf16 a[140:143], v[108:111], v[80:83], a[140:143]
    ds_read_b64_tr_b16 v[172:173], v43 offset:8192
    v_mfma_f32_16x16x32_bf16 a[172:175], v[108:111], v[84:87], a[172:175]
    v_mfma_f32_16x16x32_bf16 a[204:207], v[108:111], v[88:91], a[204:207]
    ds_read_b64_tr_b16 v[174:175], v43 offset:9216
    v_mfma_f32_16x16x32_bf16 a[236:239], v[108:111], v[92:95], a[236:239]
    v_mfma_f32_16x16x32_bf16 a[16:19], v[112:115], v[64:67], a[16:19]
    ds_read_b64_tr_b16 v[176:177], v40 offset:24576
    v_mfma_f32_16x16x32_bf16 a[48:51], v[112:115], v[68:71], a[48:51]
    v_mfma_f32_16x16x32_bf16 a[80:83], v[112:115], v[72:75], a[80:83]
    ds_read_b64_tr_b16 v[178:179], v40 offset:25600
    v_mfma_f32_16x16x32_bf16 a[112:115], v[112:115], v[76:79], a[112:115]
    v_mfma_f32_16x16x32_bf16 a[144:147], v[112:115], v[80:83], a[144:147]
    ds_read_b64_tr_b16 v[180:181], v41 offset:24576
    v_mfma_f32_16x16x32_bf16 a[176:179], v[112:115], v[84:87], a[176:179]
    v_mfma_f32_16x16x32_bf16 a[208:211], v[112:115], v[88:91], a[208:211]
    ds_read_b64_tr_b16 v[182:183], v41 offset:25600
    v_mfma_f32_16x16x32_bf16 a[240:243], v[112:115], v[92:95], a[240:243]
    v_mfma_f32_16x16x32_bf16 a[20:23], v[116:119], v[64:67], a[20:23]
    ds_read_b64_tr_b16 v[184:185], v42 offset:24576
    v_mfma_f32_16x16x32_bf16 a[52:55], v[116:119], v[68:71], a[52:55]
    v_mfma_f32_16x16x32_bf16 a[84:87], v[116:119], v[72:75], a[84:87]
    ds_read_b64_tr_b16 v[186:187], v42 offset:25600
    v_mfma_f32_16x16x32_bf16 a[116:119], v[116:119], v[76:79], a[116:119]
    v_mfma_f32_16x16x32_bf16 a[148:151], v[116:119], v[80:83], a[148:151]
    ds_read_b64_tr_b16 v[188:189], v43 offset:24576
    v_mfma_f32_16x16x32_bf16 a[180:183], v[116:119], v[84:87], a[180:183]
    v_mfma_f32_16x16x32_bf16 a[212:215], v[116:119], v[88:91], a[212:215]
    ds_read_b64_tr_b16 v[190:191], v43 offset:25600
    v_mfma_f32_16x16x32_bf16 a[244:247], v[116:119], v[92:95], a[244:247]
    v_mfma_f32_16x16x32_bf16 a[24:27], v[120:123], v[64:67], a[24:27]
    v_mfma_f32_16x16x32_bf16 a[56:59], v[120:123], v[68:71], a[56:59]
    v_mfma_f32_16x16x32_bf16 a[88:91], v[120:123], v[72:75], a[88:91]
    v_mfma_f32_16x16x32_bf16 a[120:123], v[120:123], v[76:79], a[120:123]
    v_mfma_f32_16x16x32_bf16 a[152:155], v[120:123], v[80:83], a[152:155]
    v_mfma_f32_16x16x32_bf16 a[184:187], v[120:123], v[84:87], a[184:187]
    v_mfma_f32_16x16x32_bf16 a[216:219], v[120:123], v[88:91], a[216:219]
    v_mfma_f32_16x16x32_bf16 a[248:251], v[120:123], v[92:95], a[248:251]
    s_waitcnt lgkmcnt(0)
    s_barrier
    v_mfma_f32_16x16x32_bf16 a[28:31], v[124:127], v[64:67], a[28:31]
    v_mfma_f32_16x16x32_bf16 a[60:63], v[124:127], v[68:71], a[60:63]
    v_mfma_f32_16x16x32_bf16 a[92:95], v[124:127], v[72:75], a[92:95]
    v_mfma_f32_16x16x32_bf16 a[124:127], v[124:127], v[76:79], a[124:127]
    v_mfma_f32_16x16x32_bf16 a[156:159], v[124:127], v[80:83], a[156:159]
    v_mfma_f32_16x16x32_bf16 a[188:191], v[124:127], v[84:87], a[188:191]
    v_mfma_f32_16x16x32_bf16 a[220:223], v[124:127], v[88:91], a[220:223]
    v_mfma_f32_16x16x32_bf16 a[252:255], v[124:127], v[92:95], a[252:255]
    s_waitcnt lgkmcnt(0)
    v_mfma_f32_16x16x32_bf16 a[0:3], v[160:163], v[128:131], a[0:3]
    v_mfma_f32_16x16x32_bf16 a[32:35], v[160:163], v[132:135], a[32:35]
    v_mfma_f32_16x16x32_bf16 a[64:67], v[160:163], v[136:139], a[64:67]
    v_mfma_f32_16x16x32_bf16 a[96:99], v[160:163], v[140:143], a[96:99]
    v_mfma_f32_16x16x32_bf16 a[128:131], v[160:163], v[144:147], a[128:131]
    v_mfma_f32_16x16x32_bf16 a[160:163], v[160:163], v[148:151], a[160:163]
    v_mfma_f32_16x16x32_bf16 a[192:195], v[160:163], v[152:155], a[192:195]
    v_mfma_f32_16x16x32_bf16 a[224:227], v[160:163], v[156:159], a[224:227]
    v_mfma_f32_16x16x32_bf16 a[4:7], v[164:167], v[128:131], a[4:7]
    v_mfma_f32_16x16x32_bf16 a[36:39], v[164:167], v[132:135], a[36:39]
    v_mfma_f32_16x16x32_bf16 a[68:71], v[164:167], v[136:139], a[68:71]
    v_mfma_f32_16x16x32_bf16 a[100:103], v[164:167], v[140:143], a[100:103]
    v_mfma_f32_16x16x32_bf16 a[132:135], v[164:167], v[144:147], a[132:135]
    v_mfma_f32_16x16x32_bf16 a[164:167], v[164:167], v[148:151], a[164:167]
    v_mfma_f32_16x16x32_bf16 a[196:199], v[164:167], v[152:155], a[196:199]
    v_mfma_f32_16x16x32_bf16 a[228:231], v[164:167], v[156:159], a[228:231]
    v_mfma_f32_16x16x32_bf16 a[8:11], v[168:171], v[128:131], a[8:11]
    v_mfma_f32_16x16x32_bf16 a[40:43], v[168:171], v[132:135], a[40:43]
    v_mfma_f32_16x16x32_bf16 a[72:75], v[168:171], v[136:139], a[72:75]
    v_mfma_f32_16x16x32_bf16 a[104:107], v[168:171], v[140:143], a[104:107]
    v_mfma_f32_16x16x32_bf16 a[136:139], v[168:171], v[144:147], a[136:139]
    v_mfma_f32_16x16x32_bf16 a[168:171], v[168:171], v[148:151], a[168:171]
    v_mfma_f32_16x16x32_bf16 a[200:203], v[168:171], v[152:155], a[200:203]
    v_mfma_f32_16x16x32_bf16 a[232:235], v[168:171], v[156:159], a[232:235]
    v_mfma_f32_16x16x32_bf16 a[12:15], v[172:175], v[128:131], a[12:15]
    v_mfma_f32_16x16x32_bf16 a[44:47], v[172:175], v[132:135], a[44:47]
    v_mfma_f32_16x16x32_bf16 a[76:79], v[172:175], v[136:139], a[76:79]
    v_mfma_f32_16x16x32_bf16 a[108:111], v[172:175], v[140:143], a[108:111]
    v_mfma_f32_16x16x32_bf16 a[140:143], v[172:175], v[144:147], a[140:143]
    v_mfma_f32_16x16x32_bf16 a[172:175], v[172:175], v[148:151], a[172:175]
    v_mfma_f32_16x16x32_bf16 a[204:207], v[172:175], v[152:155], a[204:207]
    v_mfma_f32_16x16x32_bf16 a[236:239], v[172:175], v[156:159], a[236:239]
    v_mfma_f32_16x16x32_bf16 a[16:19], v[176:179], v[128:131], a[16:19]
    v_mfma_f32_16x16x32_bf16 a[48:51], v[176:179], v[132:135], a[48:51]
    v_mfma_f32_16x16x32_bf16 a[80:83], v[176:179], v[136:139], a[80:83]
    v_mfma_f32_16x16x32_bf16 a[112:115], v[176:179], v[140:143], a[112:115]
    v_mfma_f32_16x16x32_bf16 a[144:147], v[176:179], v[144:147], a[144:147]
    v_mfma_f32_16x16x32_bf16 a[176:179], v[176:179], v[148:151], a[176:179]
    v_mfma_f32_16x16x32_bf16 a[208:211], v[176:179], v[152:155], a[208:211]
    v_mfma_f32_16x16x32_bf16 a[240:243], v[176:179], v[156:159], a[240:243]
    v_mfma_f32_16x16x32_bf16 a[20:23], v[180:183], v[128:131], a[20:23]
    v_mfma_f32_16x16x32_bf16 a[52:55], v[180:183], v[132:135], a[52:55]
    v_mfma_f32_16x16x32_bf16 a[84:87], v[180:183], v[136:139], a[84:87]
    v_mfma_f32_16x16x32_bf16 a[116:119], v[180:183], v[140:143], a[116:119]
    v_mfma_f32_16x16x32_bf16 a[148:151], v[180:183], v[144:147], a[148:151]
    v_mfma_f32_16x16x32_bf16 a[180:183], v[180:183], v[148:151], a[180:183]
    v_mfma_f32_16x16x32_bf16 a[212:215], v[180:183], v[152:155], a[212:215]
    v_mfma_f32_16x16x32_bf16 a[244:247], v[180:183], v[156:159], a[244:247]
    v_mfma_f32_16x16x32_bf16 a[24:27], v[184:187], v[128:131], a[24:27]
    v_mfma_f32_16x16x32_bf16 a[56:59], v[184:187], v[132:135], a[56:59]
    v_mfma_f32_16x16x32_bf16 a[88:91], v[184:187], v[136:139], a[88:91]
    v_mfma_f32_16x16x32_bf16 a[120:123], v[184:187], v[140:143], a[120:123]
    v_mfma_f32_16x16x32_bf16 a[152:155], v[184:187], v[144:147], a[152:155]
    v_mfma_f32_16x16x32_bf16 a[184:187], v[184:187], v[148:151], a[184:187]
    v_mfma_f32_16x16x32_bf16 a[216:219], v[184:187], v[152:155], a[216:219]
    v_mfma_f32_16x16x32_bf16 a[248:251], v[184:187], v[156:159], a[248:251]
    v_mfma_f32_16x16x32_bf16 a[28:31], v[188:191], v[128:131], a[28:31]
    v_mfma_f32_16x16x32_bf16 a[60:63], v[188:191], v[132:135], a[60:63]
    v_mfma_f32_16x16x32_bf16 a[92:95], v[188:191], v[136:139], a[92:95]
    v_mfma_f32_16x16x32_bf16 a[124:127], v[188:191], v[140:143], a[124:127]
    v_mfma_f32_16x16x32_bf16 a[156:159], v[188:191], v[144:147], a[156:159]
    v_mfma_f32_16x16x32_bf16 a[188:191], v[188:191], v[148:151], a[188:191]
    v_mfma_f32_16x16x32_bf16 a[220:223], v[188:191], v[152:155], a[220:223]
    v_mfma_f32_16x16x32_bf16 a[252:255], v[188:191], v[156:159], a[252:255]
    s_mov_b32 s82, 1
    s_branch L_QKVfin
L_V:
    s_waitcnt vmcnt(16)
    s_barrier
    ds_read_b64_tr_b16 v[96:97], v34 offset:0
    ds_read_b64_tr_b16 v[98:99], v34 offset:1024
    ds_read_b128 v[64:67], v32 offset:0
    ds_read_b128 v[68:71], v32 offset:2048
    ds_read_b128 v[72:75], v32 offset:4096
    ds_read_b128 v[76:79], v32 offset:6144
    ds_read_b128 v[80:83], v32 offset:8192
    ds_read_b128 v[84:87], v32 offset:10240
    ds_read_b128 v[88:91], v32 offset:12288
    ds_read_b128 v[92:95], v32 offset:14336
    ds_read_b64_tr_b16 v[100:101], v35 offset:0
    ds_read_b64_tr_b16 v[102:103], v35 offset:1024
    ds_read_b64_tr_b16 v[104:105], v36 offset:0
    ds_read_b64_tr_b16 v[106:107], v36 offset:1024
    ds_read_b64_tr_b16 v[108:109], v37 offset:0
    ds_read_b64_tr_b16 v[110:111], v37 offset:1024
    ds_read_b64_tr_b16 v[112:113], v34 offset:16384
    ds_read_b64_tr_b16 v[114:115], v34 offset:17408
    ds_read_b64_tr_b16 v[116:117], v35 offset:16384
    ds_read_b64_tr_b16 v[118:119], v35 offset:17408
    ds_read_b64_tr_b16 v[120:121], v36 offset:16384
    ds_read_b64_tr_b16 v[122:123], v36 offset:17408
    ds_read_b64_tr_b16 v[124:125], v37 offset:16384
    ds_read_b64_tr_b16 v[126:127], v37 offset:17408
    s_cmp_eq_u32 s69, 0
    s_cbranch_scc1 Hf_130
    s_mov_b32 s21, s69
    s_mov_b32 s69, 0
    s_cmp_lg_u32 s3, 0
    s_cbranch_scc1 Hf_130
    v_mov_b32 v14, s21
    s_mov_b64 exec, 1
    buffer_atomic_add v14, off, s[92:95], s68 sc1
    s_mov_b64 exec, -1
Hf_130:
    s_waitcnt lgkmcnt(0)
    v_mfma_f32_16x16x32_bf16 a[0:3], v[64:67], v[96:99], 0
    ds_read_b64_tr_b16 v[160:161], v34 offset:8192
    v_mfma_f32_16x16x32_bf16 a[32:35], v[68:71], v[96:99], 0
    v_mfma_f32_16x16x32_bf16 a[64:67], v[72:75], v[96:99], 0
    ds_read_b64_tr_b16 v[162:163], v34 offset:9216
    v_mfma_f32_16x16x32_bf16 a[96:99], v[76:79], v[96:99], 0
    v_mfma_f32_16x16x32_bf16 a[128:131], v[80:83], v[96:99], 0
    ds_read_b128 v[128:131], v33 offset:0
    v_mfma_f32_16x16x32_bf16 a[160:163], v[84:87], v[96:99], 0
    v_mfma_f32_16x16x32_bf16 a[192:195], v[88:91], v[96:99], 0
    ds_read_b128 v[132:135], v33 offset:2048
    v_mfma_f32_16x16x32_bf16 a[224:227], v[92:95], v[96:99], 0
    v_mfma_f32_16x16x32_bf16 a[4:7], v[64:67], v[100:103], 0
    ds_read_b128 v[136:139], v33 offset:4096
    v_mfma_f32_16x16x32_bf16 a[36:39], v[68:71], v[100:103], 0
    v_mfma_f32_16x16x32_bf16 a[68:71], v[72:75], v[100:103], 0
    ds_read_b128 v[140:143], v33 offset:6144
    v_mfma_f32_16x16x32_bf16 a[100:103], v[76:79], v[100:103], 0
    v_mfma_f32_16x16x32_bf16 a[132:135], v[80:83], v[100:103], 0
    ds_read_b128 v[144:147], v33 offset:8192
    v_mfma_f32_16x16x32_bf16 a[164:167], v[84:87], v[100:103], 0
    v_mfma_f32_16x16x32_bf16 a[196:199], v[88:91], v[100:103], 0
    ds_read_b128 v[148:151], v33 offset:10240
    v_mfma_f32_16x16x32_bf16 a[228:231], v[92:95], v[100:103], 0
    v_mfma_f32_16x16x32_bf16 a[8:11], v[64:67], v[104:107], 0
    ds_read_b128 v[152:155], v33 offset:12288
    v_mfma_f32_16x16x32_bf16 a[40:43], v[68:71], v[104:107], 0
    v_mfma_f32_16x16x32_bf16 a[72:75], v[72:75], v[104:107], 0
    ds_read_b128 v[156:159], v33 offset:14336
    v_mfma_f32_16x16x32_bf16 a[104:107], v[76:79], v[104:107], 0
    v_mfma_f32_16x16x32_bf16 a[136:139], v[80:83], v[104:107], 0
    ds_read_b64_tr_b16 v[164:165], v35 offset:8192
    v_mfma_f32_16x16x32_bf16 a[168:171], v[84:87], v[104:107], 0
    v_mfma_f32_16x16x32_bf16 a[200:203], v[88:91], v[104:107], 0
    ds_read_b64_tr_b16 v[166:167], v35 offset:9216
    v_mfma_f32_16x16x32_bf16 a[232:235], v[92:95], v[104:107], 0
    v_mfma_f32_16x16x32_bf16 a[12:15], v[64:67], v[108:111], 0
    ds_read_b64_tr_b16 v[168:169], v36 offset:8192
    v_mfma_f32_16x16x32_bf16 a[44:47], v[68:71], v[108:111], 0
    v_mfma_f32_16x16x32_bf16 a[76:79], v[72:75], v[108:111], 0
    ds_read_b64_tr_b16 v[170:171], v36 offset:9216
    v_mfma_f32_16x16x32_bf16 a[108:111], v[76:79], v[108:111], 0
    v_mfma_f32_16x16x32_bf16 a[140:143], v[80:83], v[108:111], 0
    ds_read_b64_tr_b16 v[172:173], v37 offset:8192
    v_mfma_f32_16x16x32_bf16 a[172:175], v[84:87], v[108:111], 0
    v_mfma_f32_16x16x32_bf16 a[204:207], v[88:91], v[108:111], 0
    ds_read_b64_tr_b16 v[174:175], v37 offset:9216
    v_mfma_f32_16x16x32_bf16 a[236:239], v[92:95], v[108:111], 0
    v_mfma_f32_16x16x32_bf16 a[16:19], v[64:67], v[112:115], 0
    ds_read_b64_tr_b16 v[176:177], v34 offset:24576
    v_mfma_f32_16x16x32_bf16 a[48:51], v[68:71], v[112:115], 0
    v_mfma_f32_16x16x32_bf16 a[80:83], v[72:75], v[112:115], 0
    ds_read_b64_tr_b16 v[178:179], v34 offset:25600
    v_mfma_f32_16x16x32_bf16 a[112:115], v[76:79], v[112:115], 0
    v_mfma_f32_16x16x32_bf16 a[144:147], v[80:83], v[112:115], 0
    ds_read_b64_tr_b16 v[180:181], v35 offset:24576
    v_mfma_f32_16x16x32_bf16 a[176:179], v[84:87], v[112:115], 0
    v_mfma_f32_16x16x32_bf16 a[208:211], v[88:91], v[112:115], 0
    ds_read_b64_tr_b16 v[182:183], v35 offset:25600
    v_mfma_f32_16x16x32_bf16 a[240:243], v[92:95], v[112:115], 0
    v_mfma_f32_16x16x32_bf16 a[20:23], v[64:67], v[116:119], 0
    ds_read_b64_tr_b16 v[184:185], v36 offset:24576
    v_mfma_f32_16x16x32_bf16 a[52:55], v[68:71], v[116:119], 0
    v_mfma_f32_16x16x32_bf16 a[84:87], v[72:75], v[116:119], 0
    ds_read_b64_tr_b16 v[186:187], v36 offset:25600
    v_mfma_f32_16x16x32_bf16 a[116:119], v[76:79], v[116:119], 0
    v_mfma_f32_16x16x32_bf16 a[148:151], v[80:83], v[116:119], 0
    ds_read_b64_tr_b16 v[188:189], v37 offset:24576
    v_mfma_f32_16x16x32_bf16 a[180:183], v[84:87], v[116:119], 0
    v_mfma_f32_16x16x32_bf16 a[212:215], v[88:91], v[116:119], 0
    ds_read_b64_tr_b16 v[190:191], v37 offset:25600
    v_mfma_f32_16x16x32_bf16 a[244:247], v[92:95], v[116:119], 0
    v_mfma_f32_16x16x32_bf16 a[24:27], v[64:67], v[120:123], 0
    v_mfma_f32_16x16x32_bf16 a[56:59], v[68:71], v[120:123], 0
    v_mfma_f32_16x16x32_bf16 a[88:91], v[72:75], v[120:123], 0
    v_mfma_f32_16x16x32_bf16 a[120:123], v[76:79], v[120:123], 0
    v_mfma_f32_16x16x32_bf16 a[152:155], v[80:83], v[120:123], 0
    v_mfma_f32_16x16x32_bf16 a[184:187], v[84:87], v[120:123], 0
    v_mfma_f32_16x16x32_bf16 a[216:219], v[88:91], v[120:123], 0
    v_mfma_f32_16x16x32_bf16 a[248:251], v[92:95], v[120:123], 0
    s_waitcnt vmcnt(0) lgkmcnt(0)
    s_barrier
    v_mfma_f32_16x16x32_bf16 a[28:31], v[64:67], v[124:127], 0
    v_mfma_f32_16x16x32_bf16 a[60:63], v[68:71], v[124:127], 0
    v_mfma_f32_16x16x32_bf16 a[92:95], v[72:75], v[124:127], 0
    v_mfma_f32_16x16x32_bf16 a[124:127], v[76:79], v[124:127], 0
    v_mfma_f32_16x16x32_bf16 a[156:159], v[80:83], v[124:127], 0
    v_mfma_f32_16x16x32_bf16 a[188:191], v[84:87], v[124:127], 0
    v_mfma_f32_16x16x32_bf16 a[220:223], v[88:91], v[124:127], 0
    v_mfma_f32_16x16x32_bf16 a[252:255], v[92:95], v[124:127], 0
    s_mov_b32 s20, 7
Gv_131:
    s_waitcnt lgkmcnt(0)
    v_mfma_f32_16x16x32_bf16 a[0:3], v[128:131], v[160:163], a[0:3]
    s_add_u32 m0, s18, 0
    v_mfma_f32_16x16x32_bf16 a[32:35], v[132:135], v[160:163], a[32:35]
    buffer_load_dwordx4 v16, s[8:11], s16 offen sc1 lds
    v_mfma_f32_16x16x32_bf16 a[64:67], v[136:139], v[160:163], a[64:67]
    ds_read_b64_tr_b16 v[96:97], v40 offset:0
    v_mfma_f32_16x16x32_bf16 a[96:99], v[140:143], v[160:163], a[96:99]
    ds_read_b64_tr_b16 v[98:99], v40 offset:1024
    v_mfma_f32_16x16x32_bf16 a[128:131], v[144:147], v[160:163], a[128:131]
    s_add_u32 m0, s19, 0
    v_mfma_f32_16x16x32_bf16 a[160:163], v[148:151], v[160:163], a[160:163]
    buffer_load_dwordx4 v24, s[12:15], s17 offen  lds
    v_mfma_f32_16x16x32_bf16 a[192:195], v[152:155], v[160:163], a[192:195]
    ds_read_b128 v[64:67], v38 offset:0
    v_mfma_f32_16x16x32_bf16 a[224:227], v[156:159], v[160:163], a[224:227]
    ds_read_b128 v[68:71], v38 offset:2048
    v_mfma_f32_16x16x32_bf16 a[4:7], v[128:131], v[164:167], a[4:7]
    s_add_u32 m0, s18, 1024
    v_mfma_f32_16x16x32_bf16 a[36:39], v[132:135], v[164:167], a[36:39]
    buffer_load_dwordx4 v17, s[8:11], s16 offen sc1 lds
    v_mfma_f32_16x16x32_bf16 a[68:71], v[136:139], v[164:167], a[68:71]
    ds_read_b128 v[72:75], v38 offset:4096
    v_mfma_f32_16x16x32_bf16 a[100:103], v[140:143], v[164:167], a[100:103]
    ds_read_b128 v[76:79], v38 offset:6144
    v_mfma_f32_16x16x32_bf16 a[132:135], v[144:147], v[164:167], a[132:135]
    s_add_u32 m0, s19, 1024
    v_mfma_f32_16x16x32_bf16 a[164:167], v[148:151], v[164:167], a[164:167]
    buffer_load_dwordx4 v25, s[12:15], s17 offen  lds
    v_mfma_f32_16x16x32_bf16 a[196:199], v[152:155], v[164:167], a[196:199]
    ds_read_b128 v[80:83], v38 offset:8192
    v_mfma_f32_16x16x32_bf16 a[228:231], v[156:159], v[164:167], a[228:231]
    ds_read_b128 v[84:87], v38 offset:10240
    v_mfma_f32_16x16x32_bf16 a[8:11], v[128:131], v[168:171], a[8:11]
    s_add_u32 m0, s18, 2048
    v_mfma_f32_16x16x32_bf16 a[40:43], v[132:135], v[168:171], a[40:43]
    buffer_load_dwordx4 v18, s[8:11], s16 offen sc1 lds
    v_mfma_f32_16x16x32_bf16 a[72:75], v[136:139], v[168:171], a[72:75]
    ds_read_b128 v[88:91], v38 offset:12288
    v_mfma_f32_16x16x32_bf16 a[104:107], v[140:143], v[168:171], a[104:107]
    ds_read_b128 v[92:95], v38 offset:14336
    v_mfma_f32_16x16x32_bf16 a[136:139], v[144:147], v[168:171], a[136:139]
    s_add_u32 m0, s19, 2048
    v_mfma_f32_16x16x32_bf16 a[168:171], v[148:151], v[168:171], a[168:171]
    buffer_load_dwordx4 v26, s[12:15], s17 offen  lds
    v_mfma_f32_16x16x32_bf16 a[200:203], v[152:155], v[168:171], a[200:203]
    ds_read_b64_tr_b16 v[100:101], v41 offset:0
    v_mfma_f32_16x16x32_bf16 a[232:235], v[156:159], v[168:171], a[232:235]
    ds_read_b64_tr_b16 v[102:103], v41 offset:1024
    v_mfma_f32_16x16x32_bf16 a[12:15], v[128:131], v[172:175], a[12:15]
    s_add_u32 m0, s18, 3072
    v_mfma_f32_16x16x32_bf16 a[44:47], v[132:135], v[172:175], a[44:47]
    buffer_load_dwordx4 v19, s[8:11], s16 offen sc1 lds
    v_mfma_f32_16x16x32_bf16 a[76:79], v[136:139], v[172:175], a[76:79]
    ds_read_b64_tr_b16 v[104:105], v42 offset:0
    v_mfma_f32_16x16x32_bf16 a[108:111], v[140:143], v[172:175], a[108:111]
    ds_read_b64_tr_b16 v[106:107], v42 offset:1024
    v_mfma_f32_16x16x32_bf16 a[140:143], v[144:147], v[172:175], a[140:143]
    s_add_u32 m0, s19, 3072
    v_mfma_f32_16x16x32_bf16 a[172:175], v[148:151], v[172:175], a[172:175]
    buffer_load_dwordx4 v27, s[12:15], s17 offen  lds
    v_mfma_f32_16x16x32_bf16 a[204:207], v[152:155], v[172:175], a[204:207]
    ds_read_b64_tr_b16 v[108:109], v43 offset:0
    v_mfma_f32_16x16x32_bf16 a[236:239], v[156:159], v[172:175], a[236:239]
    ds_read_b64_tr_b16 v[110:111], v43 offset:1024
    v_mfma_f32_16x16x32_bf16 a[16:19], v[128:131], v[176:179], a[16:19]
    s_add_u32 m0, s18, 4096
    v_mfma_f32_16x16x32_bf16 a[48:51], v[132:135], v[176:179], a[48:51]
    buffer_load_dwordx4 v20, s[8:11], s16 offen sc1 lds
    v_mfma_f32_16x16x32_bf16 a[80:83], v[136:139], v[176:179], a[80:83]
    ds_read_b64_tr_b16 v[112:113], v40 offset:16384
    v_mfma_f32_16x16x32_bf16 a[112:115], v[140:143], v[176:179], a[112:115]
    ds_read_b64_tr_b16 v[114:115], v40 offset:17408
    v_mfma_f32_16x16x32_bf16 a[144:147], v[144:147], v[176:179], a[144:147]
    s_add_u32 m0, s19, 4096
    v_mfma_f32_16x16x32_bf16 a[176:179], v[148:151], v[176:179], a[176:179]
    buffer_load_dwordx4 v28, s[12:15], s17 offen  lds
    v_mfma_f32_16x16x32_bf16 a[208:211], v[152:155], v[176:179], a[208:211]
    ds_read_b64_tr_b16 v[116:117], v41 offset:16384
    v_mfma_f32_16x16x32_bf16 a[240:243], v[156:159], v[176:179], a[240:243]
    ds_read_b64_tr_b16 v[118:119], v41 offset:17408
    v_mfma_f32_16x16x32_bf16 a[20:23], v[128:131], v[180:183], a[20:23]
    s_add_u32 m0, s18, 5120
    v_mfma_f32_16x16x32_bf16 a[52:55], v[132:135], v[180:183], a[52:55]
    buffer_load_dwordx4 v21, s[8:11], s16 offen sc1 lds
    v_mfma_f32_16x16x32_bf16 a[84:87], v[136:139], v[180:183], a[84:87]
    ds_read_b64_tr_b16 v[120:121], v42 offset:16384
    v_mfma_f32_16x16x32_bf16 a[116:119], v[140:143], v[180:183], a[116:119]
    ds_read_b64_tr_b16 v[122:123], v42 offset:17408
    v_mfma_f32_16x16x32_bf16 a[148:151], v[144:147], v[180:183], a[148:151]
    s_add_u32 m0, s19, 5120
    v_mfma_f32_16x16x32_bf16 a[180:183], v[148:151], v[180:183], a[180:183]
    buffer_load_dwordx4 v29, s[12:15], s17 offen  lds
    v_mfma_f32_16x16x32_bf16 a[212:215], v[152:155], v[180:183], a[212:215]
    ds_read_b64_tr_b16 v[124:125], v43 offset:16384
    v_mfma_f32_16x16x32_bf16 a[244:247], v[156:159], v[180:183], a[244:247]
    ds_read_b64_tr_b16 v[126:127], v43 offset:17408
    v_mfma_f32_16x16x32_bf16 a[24:27], v[128:131], v[184:187], a[24:27]
    s_add_u32 m0, s18, 6144
    v_mfma_f32_16x16x32_bf16 a[56:59], v[132:135], v[184:187], a[56:59]
    buffer_load_dwordx4 v22, s[8:11], s16 offen sc1 lds
    v_mfma_f32_16x16x32_bf16 a[88:91], v[136:139], v[184:187], a[88:91]
    v_mfma_f32_16x16x32_bf16 a[120:123], v[140:143], v[184:187], a[120:123]
    v_mfma_f32_16x16x32_bf16 a[152:155], v[144:147], v[184:187], a[152:155]
    s_add_u32 m0, s19, 6144
    v_mfma_f32_16x16x32_bf16 a[184:187], v[148:151], v[184:187], a[184:187]
    buffer_load_dwordx4 v30, s[12:15], s17 offen  lds
    v_mfma_f32_16x16x32_bf16 a[216:219], v[152:155], v[184:187], a[216:219]
    v_mfma_f32_16x16x32_bf16 a[248:251], v[156:159], v[184:187], a[248:251]
    v_mfma_f32_16x16x32_bf16 a[28:31], v[128:131], v[188:191], a[28:31]
    s_add_u32 m0, s18, 7168
    v_mfma_f32_16x16x32_bf16 a[60:63], v[132:135], v[188:191], a[60:63]
    buffer_load_dwordx4 v23, s[8:11], s16 offen sc1 lds
    v_mfma_f32_16x16x32_bf16 a[92:95], v[136:139], v[188:191], a[92:95]
    v_mfma_f32_16x16x32_bf16 a[124:127], v[140:143], v[188:191], a[124:127]
    v_mfma_f32_16x16x32_bf16 a[156:159], v[144:147], v[188:191], a[156:159]
    s_add_u32 m0, s19, 7168
    v_mfma_f32_16x16x32_bf16 a[188:191], v[148:151], v[188:191], a[188:191]
    buffer_load_dwordx4 v31, s[12:15], s17 offen  lds
    v_mfma_f32_16x16x32_bf16 a[220:223], v[152:155], v[188:191], a[220:223]
    v_mfma_f32_16x16x32_bf16 a[252:255], v[156:159], v[188:191], a[252:255]
    s_waitcnt lgkmcnt(0)
    s_add_u32 s16, s16, 128
    s_add_u32 s17, s17, 524288
    v_mfma_f32_16x16x32_bf16 a[0:3], v[64:67], v[96:99], a[0:3]
    ds_read_b64_tr_b16 v[160:161], v40 offset:8192
    s_mov_b32 m0, 160768
    v_mfma_f32_16x16x32_bf16 a[32:35], v[68:71], v[96:99], a[32:35]
    buffer_load_dwordx4 v13, s[24:27], s79 offen lds
    v_mfma_f32_16x16x32_bf16 a[64:67], v[72:75], v[96:99], a[64:67]
    ds_read_b64_tr_b16 v[162:163], v40 offset:9216
    v_mfma_f32_16x16x32_bf16 a[96:99], v[76:79], v[96:99], a[96:99]
    v_mfma_f32_16x16x32_bf16 a[128:131], v[80:83], v[96:99], a[128:131]
    ds_read_b128 v[128:131], v39 offset:0
    s_mov_b32 m0, 160768
    v_mfma_f32_16x16x32_bf16 a[160:163], v[84:87], v[96:99], a[160:163]
    buffer_load_dwordx4 v13, s[28:31], s79 offen lds
    v_mfma_f32_16x16x32_bf16 a[192:195], v[88:91], v[96:99], a[192:195]
    ds_read_b128 v[132:135], v39 offset:2048
    v_mfma_f32_16x16x32_bf16 a[224:227], v[92:95], v[96:99], a[224:227]
    v_mfma_f32_16x16x32_bf16 a[4:7], v[64:67], v[100:103], a[4:7]
    ds_read_b128 v[136:139], v39 offset:4096
    s_mov_b32 m0, 160768
    v_mfma_f32_16x16x32_bf16 a[36:39], v[68:71], v[100:103], a[36:39]
    buffer_load_dwordx4 v13, s[84:87], s79 offen lds
    v_mfma_f32_16x16x32_bf16 a[68:71], v[72:75], v[100:103], a[68:71]
    ds_read_b128 v[140:143], v39 offset:6144
    v_mfma_f32_16x16x32_bf16 a[100:103], v[76:79], v[100:103], a[100:103]
    v_mfma_f32_16x16x32_bf16 a[132:135], v[80:83], v[100:103], a[132:135]
    ds_read_b128 v[144:147], v39 offset:8192
    v_mfma_f32_16x16x32_bf16 a[164:167], v[84:87], v[100:103], a[164:167]
    v_mfma_f32_16x16x32_bf16 a[196:199], v[88:91], v[100:103], a[196:199]
    ds_read_b128 v[148:151], v39 offset:10240
    v_mfma_f32_16x16x32_bf16 a[228:231], v[92:95], v[100:103], a[228:231]
    v_mfma_f32_16x16x32_bf16 a[8:11], v[64:67], v[104:107], a[8:11]
    ds_read_b128 v[152:155], v39 offset:12288
    v_mfma_f32_16x16x32_bf16 a[40:43], v[68:71], v[104:107], a[40:43]
    v_mfma_f32_16x16x32_bf16 a[72:75], v[72:75], v[104:107], a[72:75]
    ds_read_b128 v[156:159], v39 offset:14336
    v_mfma_f32_16x16x32_bf16 a[104:107], v[76:79], v[104:107], a[104:107]
    v_mfma_f32_16x16x32_bf16 a[136:139], v[80:83], v[104:107], a[136:139]
    ds_read_b64_tr_b16 v[164:165], v41 offset:8192
    v_mfma_f32_16x16x32_bf16 a[168:171], v[84:87], v[104:107], a[168:171]
    v_mfma_f32_16x16x32_bf16 a[200:203], v[88:91], v[104:107], a[200:203]
    ds_read_b64_tr_b16 v[166:167], v41 offset:9216
    v_mfma_f32_16x16x32_bf16 a[232:235], v[92:95], v[104:107], a[232:235]
    v_mfma_f32_16x16x32_bf16 a[12:15], v[64:67], v[108:111], a[12:15]
    ds_read_b64_tr_b16 v[168:169], v42 offset:8192
    v_mfma_f32_16x16x32_bf16 a[44:47], v[68:71], v[108:111], a[44:47]
    v_mfma_f32_16x16x32_bf16 a[76:79], v[72:75], v[108:111], a[76:79]
    ds_read_b64_tr_b16 v[170:171], v42 offset:9216
    v_mfma_f32_16x16x32_bf16 a[108:111], v[76:79], v[108:111], a[108:111]
    v_mfma_f32_16x16x32_bf16 a[140:143], v[80:83], v[108:111], a[140:143]
    ds_read_b64_tr_b16 v[172:173], v43 offset:8192
    v_mfma_f32_16x16x32_bf16 a[172:175], v[84:87], v[108:111], a[172:175]
    v_mfma_f32_16x16x32_bf16 a[204:207], v[88:91], v[108:111], a[204:207]
    ds_read_b64_tr_b16 v[174:175], v43 offset:9216
    v_mfma_f32_16x16x32_bf16 a[236:239], v[92:95], v[108:111], a[236:239]
    v_mfma_f32_16x16x32_bf16 a[16:19], v[64:67], v[112:115], a[16:19]
    ds_read_b64_tr_b16 v[176:177], v40 offset:24576
    v_mfma_f32_16x16x32_bf16 a[48:51], v[68:71], v[112:115], a[48:51]
    v_mfma_f32_16x16x32_bf16 a[80:83], v[72:75], v[112:115], a[80:83]
    ds_read_b64_tr_b16 v[178:179], v40 offset:25600
    v_mfma_f32_16x16x32_bf16 a[112:115], v[76:79], v[112:115], a[112:115]
    v_mfma_f32_16x16x32_bf16 a[144:147], v[80:83], v[112:115], a[144:147]
    ds_read_b64_tr_b16 v[180:181], v41 offset:24576
    v_mfma_f32_16x16x32_bf16 a[176:179], v[84:87], v[112:115], a[176:179]
    v_mfma_f32_16x16x32_bf16 a[208:211], v[88:91], v[112:115], a[208:211]
    ds_read_b64_tr_b16 v[182:183], v41 offset:25600
    v_mfma_f32_16x16x32_bf16 a[240:243], v[92:95], v[112:115], a[240:243]
    v_mfma_f32_16x16x32_bf16 a[20:23], v[64:67], v[116:119], a[20:23]
    ds_read_b64_tr_b16 v[184:185], v42 offset:24576
    v_mfma_f32_16x16x32_bf16 a[52:55], v[68:71], v[116:119], a[52:55]
    v_mfma_f32_16x16x32_bf16 a[84:87], v[72:75], v[116:119], a[84:87]
    ds_read_b64_tr_b16 v[186:187], v42 offset:25600
    v_mfma_f32_16x16x32_bf16 a[116:119], v[76:79], v[116:119], a[116:119]
    v_mfma_f32_16x16x32_bf16 a[148:151], v[80:83], v[116:119], a[148:151]
    ds_read_b64_tr_b16 v[188:189], v43 offset:24576
    v_mfma_f32_16x16x32_bf16 a[180:183], v[84:87], v[116:119], a[180:183]
    v_mfma_f32_16x16x32_bf16 a[212:215], v[88:91], v[116:119], a[212:215]
    ds_read_b64_tr_b16 v[190:191], v43 offset:25600
    v_mfma_f32_16x16x32_bf16 a[244:247], v[92:95], v[116:119], a[244:247]
    v_mfma_f32_16x16x32_bf16 a[24:27], v[64:67], v[120:123], a[24:27]
    v_mfma_f32_16x16x32_bf16 a[56:59], v[68:71], v[120:123], a[56:59]
    v_mfma_f32_16x16x32_bf16 a[88:91], v[72:75], v[120:123], a[88:91]
    v_mfma_f32_16x16x32_bf16 a[120:123], v[76:79], v[120:123], a[120:123]
    v_mfma_f32_16x16x32_bf16 a[152:155], v[80:83], v[120:123], a[152:155]
    v_mfma_f32_16x16x32_bf16 a[184:187], v[84:87], v[120:123], a[184:187]
    v_mfma_f32_16x16x32_bf16 a[216:219], v[88:91], v[120:123], a[216:219]
    v_mfma_f32_16x16x32_bf16 a[248:251], v[92:95], v[120:123], a[248:251]
    s_waitcnt vmcnt(3) lgkmcnt(0)
    s_barrier
    v_mfma_f32_16x16x32_bf16 a[28:31], v[64:67], v[124:127], a[28:31]
    v_mfma_f32_16x16x32_bf16 a[60:63], v[68:71], v[124:127], a[60:63]
    v_mfma_f32_16x16x32_bf16 a[92:95], v[72:75], v[124:127], a[92:95]
    v_mfma_f32_16x16x32_bf16 a[124:127], v[76:79], v[124:127], a[124:127]
    v_mfma_f32_16x16x32_bf16 a[156:159], v[80:83], v[124:127], a[156:159]
    v_mfma_f32_16x16x32_bf16 a[188:191], v[84:87], v[124:127], a[188:191]
    v_mfma_f32_16x16x32_bf16 a[220:223], v[88:91], v[124:127], a[220:223]
    v_mfma_f32_16x16x32_bf16 a[252:255], v[92:95], v[124:127], a[252:255]
    s_add_u32 s79, s79, 1024
    s_waitcnt lgkmcnt(0)
    v_mfma_f32_16x16x32_bf16 a[0:3], v[128:131], v[160:163], a[0:3]
    s_add_u32 m0, s18, 65536
    v_mfma_f32_16x16x32_bf16 a[32:35], v[132:135], v[160:163], a[32:35]
    buffer_load_dwordx4 v16, s[8:11], s16 offen sc1 lds
    v_mfma_f32_16x16x32_bf16 a[64:67], v[136:139], v[160:163], a[64:67]
    ds_read_b64_tr_b16 v[96:97], v34 offset:0
    v_mfma_f32_16x16x32_bf16 a[96:99], v[140:143], v[160:163], a[96:99]
    ds_read_b64_tr_b16 v[98:99], v34 offset:1024
    v_mfma_f32_16x16x32_bf16 a[128:131], v[144:147], v[160:163], a[128:131]
    s_add_u32 m0, s19, 65536
    v_mfma_f32_16x16x32_bf16 a[160:163], v[148:151], v[160:163], a[160:163]
    buffer_load_dwordx4 v24, s[12:15], s17 offen  lds
    v_mfma_f32_16x16x32_bf16 a[192:195], v[152:155], v[160:163], a[192:195]
    ds_read_b128 v[64:67], v32 offset:0
    v_mfma_f32_16x16x32_bf16 a[224:227], v[156:159], v[160:163], a[224:227]
    ds_read_b128 v[68:71], v32 offset:2048
    v_mfma_f32_16x16x32_bf16 a[4:7], v[128:131], v[164:167], a[4:7]
    s_add_u32 m0, s18, 66560
    v_mfma_f32_16x16x32_bf16 a[36:39], v[132:135], v[164:167], a[36:39]
    buffer_load_dwordx4 v17, s[8:11], s16 offen sc1 lds
    v_mfma_f32_16x16x32_bf16 a[68:71], v[136:139], v[164:167], a[68:71]
    ds_read_b128 v[72:75], v32 offset:4096
    v_mfma_f32_16x16x32_bf16 a[100:103], v[140:143], v[164:167], a[100:103]
    ds_read_b128 v[76:79], v32 offset:6144
    v_mfma_f32_16x16x32_bf16 a[132:135], v[144:147], v[164:167], a[132:135]
    s_add_u32 m0, s19, 66560
    v_mfma_f32_16x16x32_bf16 a[164:167], v[148:151], v[164:167], a[164:167]
    buffer_load_dwordx4 v25, s[12:15], s17 offen  lds
    v_mfma_f32_16x16x32_bf16 a[196:199], v[152:155], v[164:167], a[196:199]
    ds_read_b128 v[80:83], v32 offset:8192
    v_mfma_f32_16x16x32_bf16 a[228:231], v[156:159], v[164:167], a[228:231]
    ds_read_b128 v[84:87], v32 offset:10240
    v_mfma_f32_16x16x32_bf16 a[8:11], v[128:131], v[168:171], a[8:11]
    s_add_u32 m0, s18, 67584
    v_mfma_f32_16x16x32_bf16 a[40:43], v[132:135], v[168:171], a[40:43]
    buffer_load_dwordx4 v18, s[8:11], s16 offen sc1 lds
    v_mfma_f32_16x16x32_bf16 a[72:75], v[136:139], v[168:171], a[72:75]
    ds_read_b128 v[88:91], v32 offset:12288
    v_mfma_f32_16x16x32_bf16 a[104:107], v[140:143], v[168:171], a[104:107]
    ds_read_b128 v[92:95], v32 offset:14336
    v_mfma_f32_16x16x32_bf16 a[136:139], v[144:147], v[168:171], a[136:139]
    s_add_u32 m0, s19, 67584
    v_mfma_f32_16x16x32_bf16 a[168:171], v[148:151], v[168:171], a[168:171]
    buffer_load_dwordx4 v26, s[12:15], s17 offen  lds
    v_mfma_f32_16x16x32_bf16 a[200:203], v[152:155], v[168:171], a[200:203]
    ds_read_b64_tr_b16 v[100:101], v35 offset:0
    v_mfma_f32_16x16x32_bf16 a[232:235], v[156:159], v[168:171], a[232:235]
    ds_read_b64_tr_b16 v[102:103], v35 offset:1024
    v_mfma_f32_16x16x32_bf16 a[12:15], v[128:131], v[172:175], a[12:15]
    s_add_u32 m0, s18, 68608
    v_mfma_f32_16x16x32_bf16 a[44:47], v[132:135], v[172:175], a[44:47]
    buffer_load_dwordx4 v19, s[8:11], s16 offen sc1 lds
    v_mfma_f32_16x16x32_bf16 a[76:79], v[136:139], v[172:175], a[76:79]
    ds_read_b64_tr_b16 v[104:105], v36 offset:0
    v_mfma_f32_16x16x32_bf16 a[108:111], v[140:143], v[172:175], a[108:111]
    ds_read_b64_tr_b16 v[106:107], v36 offset:1024
    v_mfma_f32_16x16x32_bf16 a[140:143], v[144:147], v[172:175], a[140:143]
    s_add_u32 m0, s19, 68608
    v_mfma_f32_16x16x32_bf16 a[172:175], v[148:151], v[172:175], a[172:175]
    buffer_load_dwordx4 v27, s[12:15], s17 offen  lds
    v_mfma_f32_16x16x32_bf16 a[204:207], v[152:155], v[172:175], a[204:207]
    ds_read_b64_tr_b16 v[108:109], v37 offset:0
    v_mfma_f32_16x16x32_bf16 a[236:239], v[156:159], v[172:175], a[236:239]
    ds_read_b64_tr_b16 v[110:111], v37 offset:1024
    v_mfma_f32_16x16x32_bf16 a[16:19], v[128:131], v[176:179], a[16:19]
    s_add_u32 m0, s18, 69632
    v_mfma_f32_16x16x32_bf16 a[48:51], v[132:135], v[176:179], a[48:51]
    buffer_load_dwordx4 v20, s[8:11], s16 offen sc1 lds
    v_mfma_f32_16x16x32_bf16 a[80:83], v[136:139], v[176:179], a[80:83]
    ds_read_b64_tr_b16 v[112:113], v34 offset:16384
    v_mfma_f32_16x16x32_bf16 a[112:115], v[140:143], v[176:179], a[112:115]
    ds_read_b64_tr_b16 v[114:115], v34 offset:17408
    v_mfma_f32_16x16x32_bf16 a[144:147], v[144:147], v[176:179], a[144:147]
    s_add_u32 m0, s19, 69632
    v_mfma_f32_16x16x32_bf16 a[176:179], v[148:151], v[176:179], a[176:179]
    buffer_load_dwordx4 v28, s[12:15], s17 offen  lds
    v_mfma_f32_16x16x32_bf16 a[208:211], v[152:155], v[176:179], a[208:211]
    ds_read_b64_tr_b16 v[116:117], v35 offset:16384
    v_mfma_f32_16x16x32_bf16 a[240:243], v[156:159], v[176:179], a[240:243]
    ds_read_b64_tr_b16 v[118:119], v35 offset:17408
    v_mfma_f32_16x16x32_bf16 a[20:23], v[128:131], v[180:183], a[20:23]
    s_add_u32 m0, s18, 70656
    v_mfma_f32_16x16x32_bf16 a[52:55], v[132:135], v[180:183], a[52:55]
    buffer_load_dwordx4 v21, s[8:11], s16 offen sc1 lds
    v_mfma_f32_16x16x32_bf16 a[84:87], v[136:139], v[180:183], a[84:87]
    ds_read_b64_tr_b16 v[120:121], v36 offset:16384
    v_mfma_f32_16x16x32_bf16 a[116:119], v[140:143], v[180:183], a[116:119]
    ds_read_b64_tr_b16 v[122:123], v36 offset:17408
    v_mfma_f32_16x16x32_bf16 a[148:151], v[144:147], v[180:183], a[148:151]
    s_add_u32 m0, s19, 70656
    v_mfma_f32_16x16x32_bf16 a[180:183], v[148:151], v[180:183], a[180:183]
    buffer_load_dwordx4 v29, s[12:15], s17 offen  lds
    v_mfma_f32_16x16x32_bf16 a[212:215], v[152:155], v[180:183], a[212:215]
    ds_read_b64_tr_b16 v[124:125], v37 offset:16384
    v_mfma_f32_16x16x32_bf16 a[244:247], v[156:159], v[180:183], a[244:247]
    ds_read_b64_tr_b16 v[126:127], v37 offset:17408
    v_mfma_f32_16x16x32_bf16 a[24:27], v[128:131], v[184:187], a[24:27]
    s_add_u32 m0, s18, 71680
    v_mfma_f32_16x16x32_bf16 a[56:59], v[132:135], v[184:187], a[56:59]
    buffer_load_dwordx4 v22, s[8:11], s16 offen sc1 lds
    v_mfma_f32_16x16x32_bf16 a[88:91], v[136:139], v[184:187], a[88:91]
    v_mfma_f32_16x16x32_bf16 a[120:123], v[140:143], v[184:187], a[120:123]
    v_mfma_f32_16x16x32_bf16 a[152:155], v[144:147], v[184:187], a[152:155]
    s_add_u32 m0, s19, 71680
    v_mfma_f32_16x16x32_bf16 a[184:187], v[148:151], v[184:187], a[184:187]
    buffer_load_dwordx4 v30, s[12:15], s17 offen  lds
    v_mfma_f32_16x16x32_bf16 a[216:219], v[152:155], v[184:187], a[216:219]
    v_mfma_f32_16x16x32_bf16 a[248:251], v[156:159], v[184:187], a[248:251]
    v_mfma_f32_16x16x32_bf16 a[28:31], v[128:131], v[188:191], a[28:31]
    s_add_u32 m0, s18, 72704
    v_mfma_f32_16x16x32_bf16 a[60:63], v[132:135], v[188:191], a[60:63]
    buffer_load_dwordx4 v23, s[8:11], s16 offen sc1 lds
    v_mfma_f32_16x16x32_bf16 a[92:95], v[136:139], v[188:191], a[92:95]
    v_mfma_f32_16x16x32_bf16 a[124:127], v[140:143], v[188:191], a[124:127]
    v_mfma_f32_16x16x32_bf16 a[156:159], v[144:147], v[188:191], a[156:159]
    s_add_u32 m0, s19, 72704
    v_mfma_f32_16x16x32_bf16 a[188:191], v[148:151], v[188:191], a[188:191]
    buffer_load_dwordx4 v31, s[12:15], s17 offen  lds
    v_mfma_f32_16x16x32_bf16 a[220:223], v[152:155], v[188:191], a[220:223]
    v_mfma_f32_16x16x32_bf16 a[252:255], v[156:159], v[188:191], a[252:255]
    s_waitcnt lgkmcnt(0)
    s_add_u32 s16, s16, 128
    s_add_u32 s17, s17, 524288
    v_mfma_f32_16x16x32_bf16 a[0:3], v[64:67], v[96:99], a[0:3]
    ds_read_b64_tr_b16 v[160:161], v34 offset:8192
    s_mov_b32 m0, 160768
    v_mfma_f32_16x16x32_bf16 a[32:35], v[68:71], v[96:99], a[32:35]
    buffer_load_dwordx4 v13, s[24:27], s79 offen lds
    v_mfma_f32_16x16x32_bf16 a[64:67], v[72:75], v[96:99], a[64:67]
    ds_read_b64_tr_b16 v[162:163], v34 offset:9216
    v_mfma_f32_16x16x32_bf16 a[96:99], v[76:79], v[96:99], a[96:99]
    v_mfma_f32_16x16x32_bf16 a[128:131], v[80:83], v[96:99], a[128:131]
    ds_read_b128 v[128:131], v33 offset:0
    s_mov_b32 m0, 160768
    v_mfma_f32_16x16x32_bf16 a[160:163], v[84:87], v[96:99], a[160:163]
    buffer_load_dwordx4 v13, s[28:31], s79 offen lds
    v_mfma_f32_16x16x32_bf16 a[192:195], v[88:91], v[96:99], a[192:195]
    ds_read_b128 v[132:135], v33 offset:2048
    v_mfma_f32_16x16x32_bf16 a[224:227], v[92:95], v[96:99], a[224:227]
    v_mfma_f32_16x16x32_bf16 a[4:7], v[64:67], v[100:103], a[4:7]
    ds_read_b128 v[136:139], v33 offset:4096
    s_mov_b32 m0, 160768
    v_mfma_f32_16x16x32_bf16 a[36:39], v[68:71], v[100:103], a[36:39]
    buffer_load_dwordx4 v13, s[84:87], s79 offen lds
    v_mfma_f32_16x16x32_bf16 a[68:71], v[72:75], v[100:103], a[68:71]
    ds_read_b128 v[140:143], v33 offset:6144
    v_mfma_f32_16x16x32_bf16 a[100:103], v[76:79], v[100:103], a[100:103]
    v_mfma_f32_16x16x32_bf16 a[132:135], v[80:83], v[100:103], a[132:135]
    ds_read_b128 v[144:147], v33 offset:8192
    v_mfma_f32_16x16x32_bf16 a[164:167], v[84:87], v[100:103], a[164:167]
    v_mfma_f32_16x16x32_bf16 a[196:199], v[88:91], v[100:103], a[196:199]
    ds_read_b128 v[148:151], v33 offset:10240
    v_mfma_f32_16x16x32_bf16 a[228:231], v[92:95], v[100:103], a[228:231]
    v_mfma_f32_16x16x32_bf16 a[8:11], v[64:67], v[104:107], a[8:11]
    ds_read_b128 v[152:155], v33 offset:12288
    v_mfma_f32_16x16x32_bf16 a[40:43], v[68:71], v[104:107], a[40:43]
    v_mfma_f32_16x16x32_bf16 a[72:75], v[72:75], v[104:107], a[72:75]
    ds_read_b128 v[156:159], v33 offset:14336
    v_mfma_f32_16x16x32_bf16 a[104:107], v[76:79], v[104:107], a[104:107]
    v_mfma_f32_16x16x32_bf16 a[136:139], v[80:83], v[104:107], a[136:139]
    ds_read_b64_tr_b16 v[164:165], v35 offset:8192
    v_mfma_f32_16x16x32_bf16 a[168:171], v[84:87], v[104:107], a[168:171]
    v_mfma_f32_16x16x32_bf16 a[200:203], v[88:91], v[104:107], a[200:203]
    ds_read_b64_tr_b16 v[166:167], v35 offset:9216
    v_mfma_f32_16x16x32_bf16 a[232:235], v[92:95], v[104:107], a[232:235]
    v_mfma_f32_16x16x32_bf16 a[12:15], v[64:67], v[108:111], a[12:15]
    ds_read_b64_tr_b16 v[168:169], v36 offset:8192
    v_mfma_f32_16x16x32_bf16 a[44:47], v[68:71], v[108:111], a[44:47]
    v_mfma_f32_16x16x32_bf16 a[76:79], v[72:75], v[108:111], a[76:79]
    ds_read_b64_tr_b16 v[170:171], v36 offset:9216
    v_mfma_f32_16x16x32_bf16 a[108:111], v[76:79], v[108:111], a[108:111]
    v_mfma_f32_16x16x32_bf16 a[140:143], v[80:83], v[108:111], a[140:143]
    ds_read_b64_tr_b16 v[172:173], v37 offset:8192
    v_mfma_f32_16x16x32_bf16 a[172:175], v[84:87], v[108:111], a[172:175]
    v_mfma_f32_16x16x32_bf16 a[204:207], v[88:91], v[108:111], a[204:207]
    ds_read_b64_tr_b16 v[174:175], v37 offset:9216
    v_mfma_f32_16x16x32_bf16 a[236:239], v[92:95], v[108:111], a[236:239]
    v_mfma_f32_16x16x32_bf16 a[16:19], v[64:67], v[112:115], a[16:19]
    ds_read_b64_tr_b16 v[176:177], v34 offset:24576
    v_mfma_f32_16x16x32_bf16 a[48:51], v[68:71], v[112:115], a[48:51]
    v_mfma_f32_16x16x32_bf16 a[80:83], v[72:75], v[112:115], a[80:83]
    ds_read_b64_tr_b16 v[178:179], v34 offset:25600
    v_mfma_f32_16x16x32_bf16 a[112:115], v[76:79], v[112:115], a[112:115]
    v_mfma_f32_16x16x32_bf16 a[144:147], v[80:83], v[112:115], a[144:147]
    ds_read_b64_tr_b16 v[180:181], v35 offset:24576
    v_mfma_f32_16x16x32_bf16 a[176:179], v[84:87], v[112:115], a[176:179]
    v_mfma_f32_16x16x32_bf16 a[208:211], v[88:91], v[112:115], a[208:211]
    ds_read_b64_tr_b16 v[182:183], v35 offset:25600
    v_mfma_f32_16x16x32_bf16 a[240:243], v[92:95], v[112:115], a[240:243]
    v_mfma_f32_16x16x32_bf16 a[20:23], v[64:67], v[116:119], a[20:23]
    ds_read_b64_tr_b16 v[184:185], v36 offset:24576
    v_mfma_f32_16x16x32_bf16 a[52:55], v[68:71], v[116:119], a[52:55]
    v_mfma_f32_16x16x32_bf16 a[84:87], v[72:75], v[116:119], a[84:87]
    ds_read_b64_tr_b16 v[186:187], v36 offset:25600
    v_mfma_f32_16x16x32_bf16 a[116:119], v[76:79], v[116:119], a[116:119]
    v_mfma_f32_16x16x32_bf16 a[148:151], v[80:83], v[116:119], a[148:151]
    ds_read_b64_tr_b16 v[188:189], v37 offset:24576
    v_mfma_f32_16x16x32_bf16 a[180:183], v[84:87], v[116:119], a[180:183]
    v_mfma_f32_16x16x32_bf16 a[212:215], v[88:91], v[116:119], a[212:215]
    ds_read_b64_tr_b16 v[190:191], v37 offset:25600
    v_mfma_f32_16x16x32_bf16 a[244:247], v[92:95], v[116:119], a[244:247]
    v_mfma_f32_16x16x32_bf16 a[24:27], v[64:67], v[120:123], a[24:27]
    v_mfma_f32_16x16x32_bf16 a[56:59], v[68:71], v[120:123], a[56:59]
    v_mfma_f32_16x16x32_bf16 a[88:91], v[72:75], v[120:123], a[88:91]
    v_mfma_f32_16x16x32_bf16 a[120:123], v[76:79], v[120:123], a[120:123]
    v_mfma_f32_16x16x32_bf16 a[152:155], v[80:83], v[120:123], a[152:155]
    v_mfma_f32_16x16x32_bf16 a[184:187], v[84:87], v[120:123], a[184:187]
    v_mfma_f32_16x16x32_bf16 a[216:219], v[88:91], v[120:123], a[216:219]
    v_mfma_f32_16x16x32_bf16 a[248:251], v[92:95], v[120:123], a[248:251]
    s_waitcnt vmcnt(3) lgkmcnt(0)
    s_barrier
    v_mfma_f32_16x16x32_bf16 a[28:31], v[64:67], v[124:127], a[28:31]
    v_mfma_f32_16x16x32_bf16 a[60:63], v[68:71], v[124:127], a[60:63]
    v_mfma_f32_16x16x32_bf16 a[92:95], v[72:75], v[124:127], a[92:95]
    v_mfma_f32_16x16x32_bf16 a[124:127], v[76:79], v[124:127], a[124:127]
    v_mfma_f32_16x16x32_bf16 a[156:159], v[80:83], v[124:127], a[156:159]
    v_mfma_f32_16x16x32_bf16 a[188:191], v[84:87], v[124:127], a[188:191]
    v_mfma_f32_16x16x32_bf16 a[220:223], v[88:91], v[124:127], a[220:223]
    v_mfma_f32_16x16x32_bf16 a[252:255], v[92:95], v[124:127], a[252:255]
    s_add_u32 s79, s79, 1024
    s_sub_u32 s20, s20, 1
    s_cmp_lg_u32 s20, 0
    s_cbranch_scc1 Gv_131
    s_cmp_lg_u32 s3, 0
    s_cbranch_scc1 Ht_132
    v_mov_b32 v14, 1
    s_mov_b64 exec, 1
    buffer_atomic_add v14, off, s[92:95], s97 sc0 sc1
    s_mov_b64 exec, -1
Ht_132:
    s_waitcnt lgkmcnt(0)
    v_mfma_f32_16x16x32_bf16 a[0:3], v[128:131], v[160:163], a[0:3]
    ds_read_b64_tr_b16 v[96:97], v40 offset:0
    v_mfma_f32_16x16x32_bf16 a[32:35], v[132:135], v[160:163], a[32:35]
    v_mfma_f32_16x16x32_bf16 a[64:67], v[136:139], v[160:163], a[64:67]
    ds_read_b64_tr_b16 v[98:99], v40 offset:1024
    v_mfma_f32_16x16x32_bf16 a[96:99], v[140:143], v[160:163], a[96:99]
    v_mfma_f32_16x16x32_bf16 a[128:131], v[144:147], v[160:163], a[128:131]
    ds_read_b128 v[64:67], v38 offset:0
    v_mfma_f32_16x16x32_bf16 a[160:163], v[148:151], v[160:163], a[160:163]
    v_mfma_f32_16x16x32_bf16 a[192:195], v[152:155], v[160:163], a[192:195]
    ds_read_b128 v[68:71], v38 offset:2048
    v_mfma_f32_16x16x32_bf16 a[224:227], v[156:159], v[160:163], a[224:227]
    v_mfma_f32_16x16x32_bf16 a[4:7], v[128:131], v[164:167], a[4:7]
    ds_read_b128 v[72:75], v38 offset:4096
    v_mfma_f32_16x16x32_bf16 a[36:39], v[132:135], v[164:167], a[36:39]
    v_mfma_f32_16x16x32_bf16 a[68:71], v[136:139], v[164:167], a[68:71]
    ds_read_b128 v[76:79], v38 offset:6144
    v_mfma_f32_16x16x32_bf16 a[100:103], v[140:143], v[164:167], a[100:103]
    v_mfma_f32_16x16x32_bf16 a[132:135], v[144:147], v[164:167], a[132:135]
    ds_read_b128 v[80:83], v38 offset:8192
    v_mfma_f32_16x16x32_bf16 a[164:167], v[148:151], v[164:167], a[164:167]
    v_mfma_f32_16x16x32_bf16 a[196:199], v[152:155], v[164:167], a[196:199]
    ds_read_b128 v[84:87], v38 offset:10240
    v_mfma_f32_16x16x32_bf16 a[228:231], v[156:159], v[164:167], a[228:231]
    v_mfma_f32_16x16x32_bf16 a[8:11], v[128:131], v[168:171], a[8:11]
    ds_read_b128 v[88:91], v38 offset:12288
    v_mfma_f32_16x16x32_bf16 a[40:43], v[132:135], v[168:171], a[40:43]
    v_mfma_f32_16x16x32_bf16 a[72:75], v[136:139], v[168:171], a[72:75]
    ds_read_b128 v[92:95], v38 offset:14336
    v_mfma_f32_16x16x32_bf16 a[104:107], v[140:143], v[168:171], a[104:107]
    v_mfma_f32_16x16x32_bf16 a[136:139], v[144:147], v[168:171], a[136:139]
    ds_read_b64_tr_b16 v[100:101], v41 offset:0
    v_mfma_f32_16x16x32_bf16 a[168:171], v[148:151], v[168:171], a[168:171]
    v_mfma_f32_16x16x32_bf16 a[200:203], v[152:155], v[168:171], a[200:203]
    ds_read_b64_tr_b16 v[102:103], v41 offset:1024
    v_mfma_f32_16x16x32_bf16 a[232:235], v[156:159], v[168:171], a[232:235]
    v_mfma_f32_16x16x32_bf16 a[12:15], v[128:131], v[172:175], a[12:15]
    ds_read_b64_tr_b16 v[104:105], v42 offset:0
    v_mfma_f32_16x16x32_bf16 a[44:47], v[132:135], v[172:175], a[44:47]
    v_mfma_f32_16x16x32_bf16 a[76:79], v[136:139], v[172:175], a[76:79]
    ds_read_b64_tr_b16 v[106:107], v42 offset:1024
    v_mfma_f32_16x16x32_bf16 a[108:111], v[140:143], v[172:175], a[108:111]
    v_mfma_f32_16x16x32_bf16 a[140:143], v[144:147], v[172:175], a[140:143]
    ds_read_b64_tr_b16 v[108:109], v43 offset:0
    v_mfma_f32_16x16x32_bf16 a[172:175], v[148:151], v[172:175], a[172:175]
    v_mfma_f32_16x16x32_bf16 a[204:207], v[152:155], v[172:175], a[204:207]
    ds_read_b64_tr_b16 v[110:111], v43 offset:1024
    v_mfma_f32_16x16x32_bf16 a[236:239], v[156:159], v[172:175], a[236:239]
    v_mfma_f32_16x16x32_bf16 a[16:19], v[128:131], v[176:179], a[16:19]
    ds_read_b64_tr_b16 v[112:113], v40 offset:16384
    v_mfma_f32_16x16x32_bf16 a[48:51], v[132:135], v[176:179], a[48:51]
    v_mfma_f32_16x16x32_bf16 a[80:83], v[136:139], v[176:179], a[80:83]
    ds_read_b64_tr_b16 v[114:115], v40 offset:17408
    v_mfma_f32_16x16x32_bf16 a[112:115], v[140:143], v[176:179], a[112:115]
    v_mfma_f32_16x16x32_bf16 a[144:147], v[144:147], v[176:179], a[144:147]
    ds_read_b64_tr_b16 v[116:117], v41 offset:16384
    v_mfma_f32_16x16x32_bf16 a[176:179], v[148:151], v[176:179], a[176:179]
    v_mfma_f32_16x16x32_bf16 a[208:211], v[152:155], v[176:179], a[208:211]
    ds_read_b64_tr_b16 v[118:119], v41 offset:17408
    v_mfma_f32_16x16x32_bf16 a[240:243], v[156:159], v[176:179], a[240:243]
    v_mfma_f32_16x16x32_bf16 a[20:23], v[128:131], v[180:183], a[20:23]
    ds_read_b64_tr_b16 v[120:121], v42 offset:16384
    v_mfma_f32_16x16x32_bf16 a[52:55], v[132:135], v[180:183], a[52:55]
    v_mfma_f32_16x16x32_bf16 a[84:87], v[136:139], v[180:183], a[84:87]
    ds_read_b64_tr_b16 v[122:123], v42 offset:17408
    v_mfma_f32_16x16x32_bf16 a[116:119], v[140:143], v[180:183], a[116:119]
    v_mfma_f32_16x16x32_bf16 a[148:151], v[144:147], v[180:183], a[148:151]
    ds_read_b64_tr_b16 v[124:125], v43 offset:16384
    v_mfma_f32_16x16x32_bf16 a[180:183], v[148:151], v[180:183], a[180:183]
    v_mfma_f32_16x16x32_bf16 a[212:215], v[152:155], v[180:183], a[212:215]
    ds_read_b64_tr_b16 v[126:127], v43 offset:17408
    v_mfma_f32_16x16x32_bf16 a[244:247], v[156:159], v[180:183], a[244:247]
    v_mfma_f32_16x16x32_bf16 a[24:27], v[128:131], v[184:187], a[24:27]
    v_mfma_f32_16x16x32_bf16 a[56:59], v[132:135], v[184:187], a[56:59]
    v_mfma_f32_16x16x32_bf16 a[88:91], v[136:139], v[184:187], a[88:91]
    v_mfma_f32_16x16x32_bf16 a[120:123], v[140:143], v[184:187], a[120:123]
    v_mfma_f32_16x16x32_bf16 a[152:155], v[144:147], v[184:187], a[152:155]
    v_mfma_f32_16x16x32_bf16 a[184:187], v[148:151], v[184:187], a[184:187]
    v_mfma_f32_16x16x32_bf16 a[216:219], v[152:155], v[184:187], a[216:219]
    v_mfma_f32_16x16x32_bf16 a[248:251], v[156:159], v[184:187], a[248:251]
    v_mfma_f32_16x16x32_bf16 a[28:31], v[128:131], v[188:191], a[28:31]
    v_mfma_f32_16x16x32_bf16 a[60:63], v[132:135], v[188:191], a[60:63]
    v_mfma_f32_16x16x32_bf16 a[92:95], v[136:139], v[188:191], a[92:95]
    v_mfma_f32_16x16x32_bf16 a[124:127], v[140:143], v[188:191], a[124:127]
    v_mfma_f32_16x16x32_bf16 a[156:159], v[144:147], v[188:191], a[156:159]
    v_mfma_f32_16x16x32_bf16 a[188:191], v[148:151], v[188:191], a[188:191]
    v_mfma_f32_16x16x32_bf16 a[220:223], v[152:155], v[188:191], a[220:223]
    v_mfma_f32_16x16x32_bf16 a[252:255], v[156:159], v[188:191], a[252:255]
    s_waitcnt lgkmcnt(0)
    v_mfma_f32_16x16x32_bf16 a[0:3], v[64:67], v[96:99], a[0:3]
    ds_read_b64_tr_b16 v[160:161], v40 offset:8192
    v_mfma_f32_16x16x32_bf16 a[32:35], v[68:71], v[96:99], a[32:35]
    v_mfma_f32_16x16x32_bf16 a[64:67], v[72:75], v[96:99], a[64:67]
    ds_read_b64_tr_b16 v[162:163], v40 offset:9216
    v_mfma_f32_16x16x32_bf16 a[96:99], v[76:79], v[96:99], a[96:99]
    v_mfma_f32_16x16x32_bf16 a[128:131], v[80:83], v[96:99], a[128:131]
    ds_read_b128 v[128:131], v39 offset:0
    v_mfma_f32_16x16x32_bf16 a[160:163], v[84:87], v[96:99], a[160:163]
    v_mfma_f32_16x16x32_bf16 a[192:195], v[88:91], v[96:99], a[192:195]
    ds_read_b128 v[132:135], v39 offset:2048
    v_mfma_f32_16x16x32_bf16 a[224:227], v[92:95], v[96:99], a[224:227]
    v_mfma_f32_16x16x32_bf16 a[4:7], v[64:67], v[100:103], a[4:7]
    ds_read_b128 v[136:139], v39 offset:4096
    v_mfma_f32_16x16x32_bf16 a[36:39], v[68:71], v[100:103], a[36:39]
    v_mfma_f32_16x16x32_bf16 a[68:71], v[72:75], v[100:103], a[68:71]
    ds_read_b128 v[140:143], v39 offset:6144
    v_mfma_f32_16x16x32_bf16 a[100:103], v[76:79], v[100:103], a[100:103]
    v_mfma_f32_16x16x32_bf16 a[132:135], v[80:83], v[100:103], a[132:135]
    ds_read_b128 v[144:147], v39 offset:8192
    v_mfma_f32_16x16x32_bf16 a[164:167], v[84:87], v[100:103], a[164:167]
    v_mfma_f32_16x16x32_bf16 a[196:199], v[88:91], v[100:103], a[196:199]
    ds_read_b128 v[148:151], v39 offset:10240
    v_mfma_f32_16x16x32_bf16 a[228:231], v[92:95], v[100:103], a[228:231]
    v_mfma_f32_16x16x32_bf16 a[8:11], v[64:67], v[104:107], a[8:11]
    ds_read_b128 v[152:155], v39 offset:12288
    v_mfma_f32_16x16x32_bf16 a[40:43], v[68:71], v[104:107], a[40:43]
    v_mfma_f32_16x16x32_bf16 a[72:75], v[72:75], v[104:107], a[72:75]
    ds_read_b128 v[156:159], v39 offset:14336
    v_mfma_f32_16x16x32_bf16 a[104:107], v[76:79], v[104:107], a[104:107]
    v_mfma_f32_16x16x32_bf16 a[136:139], v[80:83], v[104:107], a[136:139]
    ds_read_b64_tr_b16 v[164:165], v41 offset:8192
    v_mfma_f32_16x16x32_bf16 a[168:171], v[84:87], v[104:107], a[168:171]
    v_mfma_f32_16x16x32_bf16 a[200:203], v[88:91], v[104:107], a[200:203]
    ds_read_b64_tr_b16 v[166:167], v41 offset:9216
    v_mfma_f32_16x16x32_bf16 a[232:235], v[92:95], v[104:107], a[232:235]
    v_mfma_f32_16x16x32_bf16 a[12:15], v[64:67], v[108:111], a[12:15]
    ds_read_b64_tr_b16 v[168:169], v42 offset:8192
    v_mfma_f32_16x16x32_bf16 a[44:47], v[68:71], v[108:111], a[44:47]
    v_mfma_f32_16x16x32_bf16 a[76:79], v[72:75], v[108:111], a[76:79]
    ds_read_b64_tr_b16 v[170:171], v42 offset:9216
    v_mfma_f32_16x16x32_bf16 a[108:111], v[76:79], v[108:111], a[108:111]
    v_mfma_f32_16x16x32_bf16 a[140:143], v[80:83], v[108:111], a[140:143]
    ds_read_b64_tr_b16 v[172:173], v43 offset:8192
    v_mfma_f32_16x16x32_bf16 a[172:175], v[84:87], v[108:111], a[172:175]
    v_mfma_f32_16x16x32_bf16 a[204:207], v[88:91], v[108:111], a[204:207]
    ds_read_b64_tr_b16 v[174:175], v43 offset:9216
    v_mfma_f32_16x16x32_bf16 a[236:239], v[92:95], v[108:111], a[236:239]
    v_mfma_f32_16x16x32_bf16 a[16:19], v[64:67], v[112:115], a[16:19]
    ds_read_b64_tr_b16 v[176:177], v40 offset:24576
    v_mfma_f32_16x16x32_bf16 a[48:51], v[68:71], v[112:115], a[48:51]
    v_mfma_f32_16x16x32_bf16 a[80:83], v[72:75], v[112:115], a[80:83]
    ds_read_b64_tr_b16 v[178:179], v40 offset:25600
    v_mfma_f32_16x16x32_bf16 a[112:115], v[76:79], v[112:115], a[112:115]
    v_mfma_f32_16x16x32_bf16 a[144:147], v[80:83], v[112:115], a[144:147]
    ds_read_b64_tr_b16 v[180:181], v41 offset:24576
    v_mfma_f32_16x16x32_bf16 a[176:179], v[84:87], v[112:115], a[176:179]
    v_mfma_f32_16x16x32_bf16 a[208:211], v[88:91], v[112:115], a[208:211]
    ds_read_b64_tr_b16 v[182:183], v41 offset:25600
    v_mfma_f32_16x16x32_bf16 a[240:243], v[92:95], v[112:115], a[240:243]
    v_mfma_f32_16x16x32_bf16 a[20:23], v[64:67], v[116:119], a[20:23]
    ds_read_b64_tr_b16 v[184:185], v42 offset:24576
    v_mfma_f32_16x16x32_bf16 a[52:55], v[68:71], v[116:119], a[52:55]
    v_mfma_f32_16x16x32_bf16 a[84:87], v[72:75], v[116:119], a[84:87]
    ds_read_b64_tr_b16 v[186:187], v42 offset:25600
    v_mfma_f32_16x16x32_bf16 a[116:119], v[76:79], v[116:119], a[116:119]
    v_mfma_f32_16x16x32_bf16 a[148:151], v[80:83], v[116:119], a[148:151]
    ds_read_b64_tr_b16 v[188:189], v43 offset:24576
    v_mfma_f32_16x16x32_bf16 a[180:183], v[84:87], v[116:119], a[180:183]
    v_mfma_f32_16x16x32_bf16 a[212:215], v[88:91], v[116:119], a[212:215]
    ds_read_b64_tr_b16 v[190:191], v43 offset:25600
    v_mfma_f32_16x16x32_bf16 a[244:247], v[92:95], v[116:119], a[244:247]
    v_mfma_f32_16x16x32_bf16 a[24:27], v[64:67], v[120:123], a[24:27]
    v_mfma_f32_16x16x32_bf16 a[56:59], v[68:71], v[120:123], a[56:59]
    v_mfma_f32_16x16x32_bf16 a[88:91], v[72:75], v[120:123], a[88:91]
    v_mfma_f32_16x16x32_bf16 a[120:123], v[76:79], v[120:123], a[120:123]
    v_mfma_f32_16x16x32_bf16 a[152:155], v[80:83], v[120:123], a[152:155]
    v_mfma_f32_16x16x32_bf16 a[184:187], v[84:87], v[120:123], a[184:187]
    v_mfma_f32_16x16x32_bf16 a[216:219], v[88:91], v[120:123], a[216:219]
    v_mfma_f32_16x16x32_bf16 a[248:251], v[92:95], v[120:123], a[248:251]
    s_waitcnt lgkmcnt(0)
    s_barrier
    v_mfma_f32_16x16x32_bf16 a[28:31], v[64:67], v[124:127], a[28:31]
    v_mfma_f32_16x16x32_bf16 a[60:63], v[68:71], v[124:127], a[60:63]
    v_mfma_f32_16x16x32_bf16 a[92:95], v[72:75], v[124:127], a[92:95]
    v_mfma_f32_16x16x32_bf16 a[124:127], v[76:79], v[124:127], a[124:127]
    v_mfma_f32_16x16x32_bf16 a[156:159], v[80:83], v[124:127], a[156:159]
    v_mfma_f32_16x16x32_bf16 a[188:191], v[84:87], v[124:127], a[188:191]
    v_mfma_f32_16x16x32_bf16 a[220:223], v[88:91], v[124:127], a[220:223]
    v_mfma_f32_16x16x32_bf16 a[252:255], v[92:95], v[124:127], a[252:255]
    s_waitcnt lgkmcnt(0)
    v_mfma_f32_16x16x32_bf16 a[0:3], v[128:131], v[160:163], a[0:3]
    v_mfma_f32_16x16x32_bf16 a[32:35], v[132:135], v[160:163], a[32:35]
    v_mfma_f32_16x16x32_bf16 a[64:67], v[136:139], v[160:163], a[64:67]
    v_mfma_f32_16x16x32_bf16 a[96:99], v[140:143], v[160:163], a[96:99]
    v_mfma_f32_16x16x32_bf16 a[128:131], v[144:147], v[160:163], a[128:131]
    v_mfma_f32_16x16x32_bf16 a[160:163], v[148:151], v[160:163], a[160:163]
    v_mfma_f32_16x16x32_bf16 a[192:195], v[152:155], v[160:163], a[192:195]
    v_mfma_f32_16x16x32_bf16 a[224:227], v[156:159], v[160:163], a[224:227]
    v_mfma_f32_16x16x32_bf16 a[4:7], v[128:131], v[164:167], a[4:7]
    v_mfma_f32_16x16x32_bf16 a[36:39], v[132:135], v[164:167], a[36:39]
    v_mfma_f32_16x16x32_bf16 a[68:71], v[136:139], v[164:167], a[68:71]
    v_mfma_f32_16x16x32_bf16 a[100:103], v[140:143], v[164:167], a[100:103]
    v_mfma_f32_16x16x32_bf16 a[132:135], v[144:147], v[164:167], a[132:135]
    v_mfma_f32_16x16x32_bf16 a[164:167], v[148:151], v[164:167], a[164:167]
    v_mfma_f32_16x16x32_bf16 a[196:199], v[152:155], v[164:167], a[196:199]
    v_mfma_f32_16x16x32_bf16 a[228:231], v[156:159], v[164:167], a[228:231]
    v_mfma_f32_16x16x32_bf16 a[8:11], v[128:131], v[168:171], a[8:11]
    v_mfma_f32_16x16x32_bf16 a[40:43], v[132:135], v[168:171], a[40:43]
    v_mfma_f32_16x16x32_bf16 a[72:75], v[136:139], v[168:171], a[72:75]
    v_mfma_f32_16x16x32_bf16 a[104:107], v[140:143], v[168:171], a[104:107]
    v_mfma_f32_16x16x32_bf16 a[136:139], v[144:147], v[168:171], a[136:139]
    v_mfma_f32_16x16x32_bf16 a[168:171], v[148:151], v[168:171], a[168:171]
    v_mfma_f32_16x16x32_bf16 a[200:203], v[152:155], v[168:171], a[200:203]
    v_mfma_f32_16x16x32_bf16 a[232:235], v[156:159], v[168:171], a[232:235]
    v_mfma_f32_16x16x32_bf16 a[12:15], v[128:131], v[172:175], a[12:15]
    v_mfma_f32_16x16x32_bf16 a[44:47], v[132:135], v[172:175], a[44:47]
    v_mfma_f32_16x16x32_bf16 a[76:79], v[136:139], v[172:175], a[76:79]
    v_mfma_f32_16x16x32_bf16 a[108:111], v[140:143], v[172:175], a[108:111]
    v_mfma_f32_16x16x32_bf16 a[140:143], v[144:147], v[172:175], a[140:143]
    v_mfma_f32_16x16x32_bf16 a[172:175], v[148:151], v[172:175], a[172:175]
    v_mfma_f32_16x16x32_bf16 a[204:207], v[152:155], v[172:175], a[204:207]
    v_mfma_f32_16x16x32_bf16 a[236:239], v[156:159], v[172:175], a[236:239]
    v_mfma_f32_16x16x32_bf16 a[16:19], v[128:131], v[176:179], a[16:19]
    v_mfma_f32_16x16x32_bf16 a[48:51], v[132:135], v[176:179], a[48:51]
    v_mfma_f32_16x16x32_bf16 a[80:83], v[136:139], v[176:179], a[80:83]
    v_mfma_f32_16x16x32_bf16 a[112:115], v[140:143], v[176:179], a[112:115]
    v_mfma_f32_16x16x32_bf16 a[144:147], v[144:147], v[176:179], a[144:147]
    v_mfma_f32_16x16x32_bf16 a[176:179], v[148:151], v[176:179], a[176:179]
    v_mfma_f32_16x16x32_bf16 a[208:211], v[152:155], v[176:179], a[208:211]
    v_mfma_f32_16x16x32_bf16 a[240:243], v[156:159], v[176:179], a[240:243]
    v_mfma_f32_16x16x32_bf16 a[20:23], v[128:131], v[180:183], a[20:23]
    v_mfma_f32_16x16x32_bf16 a[52:55], v[132:135], v[180:183], a[52:55]
    v_mfma_f32_16x16x32_bf16 a[84:87], v[136:139], v[180:183], a[84:87]
    v_mfma_f32_16x16x32_bf16 a[116:119], v[140:143], v[180:183], a[116:119]
    v_mfma_f32_16x16x32_bf16 a[148:151], v[144:147], v[180:183], a[148:151]
    v_mfma_f32_16x16x32_bf16 a[180:183], v[148:151], v[180:183], a[180:183]
    v_mfma_f32_16x16x32_bf16 a[212:215], v[152:155], v[180:183], a[212:215]
    v_mfma_f32_16x16x32_bf16 a[244:247], v[156:159], v[180:183], a[244:247]
    v_mfma_f32_16x16x32_bf16 a[24:27], v[128:131], v[184:187], a[24:27]
    v_mfma_f32_16x16x32_bf16 a[56:59], v[132:135], v[184:187], a[56:59]
    v_mfma_f32_16x16x32_bf16 a[88:91], v[136:139], v[184:187], a[88:91]
    v_mfma_f32_16x16x32_bf16 a[120:123], v[140:143], v[184:187], a[120:123]
    v_mfma_f32_16x16x32_bf16 a[152:155], v[144:147], v[184:187], a[152:155]
    v_mfma_f32_16x16x32_bf16 a[184:187], v[148:151], v[184:187], a[184:187]
    v_mfma_f32_16x16x32_bf16 a[216:219], v[152:155], v[184:187], a[216:219]
    v_mfma_f32_16x16x32_bf16 a[248:251], v[156:159], v[184:187], a[248:251]
    v_mfma_f32_16x16x32_bf16 a[28:31], v[128:131], v[188:191], a[28:31]
    v_mfma_f32_16x16x32_bf16 a[60:63], v[132:135], v[188:191], a[60:63]
    v_mfma_f32_16x16x32_bf16 a[92:95], v[136:139], v[188:191], a[92:95]
    v_mfma_f32_16x16x32_bf16 a[124:127], v[140:143], v[188:191], a[124:127]
    v_mfma_f32_16x16x32_bf16 a[156:159], v[144:147], v[188:191], a[156:159]
    v_mfma_f32_16x16x32_bf16 a[188:191], v[148:151], v[188:191], a[188:191]
    v_mfma_f32_16x16x32_bf16 a[220:223], v[152:155], v[188:191], a[220:223]
    v_mfma_f32_16x16x32_bf16 a[252:255], v[156:159], v[188:191], a[252:255]
    s_mov_b32 s82, 2
L_QKVfin:
    s_cmp_lg_u32 s3, 0
    s_cbranch_scc1 Am_133
    s_waitcnt vmcnt(0)
    v_readfirstlane_b32 s25, v14
    s_nop 3
    s_add_u32 s25, s25, s83
    s_cmp_eq_u32 s98, 5
    s_cbranch_scc1 N_135
    s_cmp_eq_u32 s98, 4
    s_cbranch_scc1 N_134
    s_lshr_b32 s22, s25, 5
    s_and_b32 s25, s25, 31
    s_lshl_b32 s22, s22, 2
    s_add_u32 s22, s22, s98
    s_lshl_b32 s22, s22, 5
    s_add_u32 s25, s25, s22
N_134:
    s_cmp_lt_u32 s25, 768
    s_cselect_b32 s25, s25, 96
    s_cbranch_scc1 N_135_e
N_135:
    s_add_u32 s25, s25, 768
    s_cmp_lt_u32 s25, 864
N_135_e:
    s_cselect_b32 s39, 1, 0
    s_cselect_b32 s96, 1, 2
    v_mov_b32 v14, s25
    v_mov_b32 v15, 159744
    ds_write_b32 v15, v14
Am_133:
    s_lshl_b32 s32, s36, 21
    s_lshl_b32 s33, s37, 14
    s_add_u32 s32, s32, s33
    s_lshl_b32 s33, s38, 24
    s_add_u32 s32, s32, s33
    s_add_u32 s78, s32, 5242880
    s_lshl_b32 s32, s36, 10
    s_lshl_b32 s33, s37, 6
    s_add_u32 s32, s32, s33
    s_add_u32 s32, s32, 113262592
    s_add_u32 s33, s38, 2
    s_cmp_ge_u32 s33, 3
    s_cselect_b32 s34, 3, 0
    s_sub_u32 s33, s33, s34
    s_lshl_b32 s33, s33, 3
    s_lshl_b32 s69, 4, s33
    s_mov_b32 s68, s32
    s_call_b64 s[4:5], L_epi
    s_branch L_next
L_KS:
    s_mov_b32 s8, s66
    s_and_b32 s9, s67, 0xffff
    s_mov_b32 s10, 4456448
    s_mov_b32 s11, 0x20000
    s_cmp_eq_u32 s38, 2
    s_cselect_b32 s34, s48, s46
    s_cselect_b32 s35, s49, s47
    s_mov_b32 s12, s34
    s_and_b32 s13, s35, 0xffff
    s_mov_b32 s14, 8388608
    s_mov_b32 s15, 0x20000
    v_lshrrev_b32 v3, 4, v1
    v_and_b32 v4, 7, v1
    v_xor_b32 v3, v3, v4
    v_lshrrev_b32 v2, 3, v1
    s_mul_i32 s21, s3, 16
    v_add_u32 v2, s21, v2
    s_mov_b32 s22, 2176
    v_mul_lo_u32 v2, v2, s22
    v_lshlrev_b32 v3, 4, v3
    v_xor_b32 v4, 64, v3
    v_add_u32 v3, v2, v3
    v_add_u32 v4, v2, v4
    v_add_u32 v16, 0, v3
    v_add_u32 v17, 17408, v4
    v_lshrrev_b32 v2, 4, v1
    v_and_b32 v3, 15, v1
    v_lshlrev_b32 v4, 2, v2
    v_xor_b32 v3, v3, v4
    s_and_b32 s21, s3, 1
    s_lshl_b32 s21, s21, 5
    v_add_u32 v2, s21, v2
    s_mov_b32 s22, 8192
    v_mul_lo_u32 v2, v2, s22
    s_lshr_b32 s23, s3, 1
    v_lshrrev_b32 v4, 3, v3
    v_lshlrev_b32 v4, 8, v4
    v_and_b32 v3, 7, v3
    v_lshlrev_b32 v3, 4, v3
    v_add_u32 v3, v3, v4
    s_lshl_b32 s23, s23, 7
    v_add_u32 v3, s23, v3
    v_add_u32 v2, v2, v3
    v_add_u32 v24, 0, v2
    v_add_u32 v25, 32768, v2
    v_add_u32 v26, 65536, v2
    v_add_u32 v27, 98304, v2
    v_add_u32 v28, 131072, v2
    v_add_u32 v29, 163840, v2
    v_add_u32 v30, 196608, v2
    v_add_u32 v31, 229376, v2
    s_mul_i32 s18, s3, 2048
    s_mul_i32 s19, s3, 8192
    s_add_u32 s19, s19, 8192
    s_lshr_b32 s21, s3, 1
    s_mul_i32 s21, s21, 32
    v_and_b32 v2, 31, v1
    v_lshrrev_b32 v3, 1, v2
    v_and_b32 v3, 7, v3
    v_lshrrev_b32 v4, 5, v1
    v_xor_b32 v3, v3, v4
    v_add_u32 v2, s21, v2
    v_lshlrev_b32 v2, 7, v2
    v_xor_b32 v4, 0, v3
    v_lshlrev_b32 v4, 4, v4
    v_add_u32 v32, v2, v4
    v_xor_b32 v4, 2, v3
    v_lshlrev_b32 v4, 4, v4
    v_add_u32 v33, v2, v4
    v_xor_b32 v4, 4, v3
    v_lshlrev_b32 v4, 4, v4
    v_add_u32 v34, v2, v4
    v_xor_b32 v4, 6, v3
    v_lshlrev_b32 v4, 4, v4
    v_add_u32 v35, v2, v4
    v_lshrrev_b32 v2, 5, v1
    v_lshlrev_b32 v2, 3, v2
    v_bfe_u32 v3, v1, 2, 2
    v_add_u32 v2, v2, v3
    v_mul_u32_u24 v2, 256, v2
    v_bfe_u32 v4, v1, 4, 1
    v_lshlrev_b32 v4, 5, v4
    v_add_u32 v2, v2, v4
    v_and_b32 v4, 3, v1
    v_lshlrev_b32 v4, 3, v4
    v_add_u32 v2, v2, v4
    v_add_u32 v2, 8192, v2
    s_and_b32 s21, s3, 1
    s_lshl_b32 s21, s21, 1
    v_xor_b32 v4, s21, v3
    v_lshlrev_b32 v4, 6, v4
    v_add_u32 v36, v2, v4
    v_xor_b32 v4, s21, v3
    v_xor_b32 v4, 1, v4
    v_lshlrev_b32 v4, 6, v4
    v_add_u32 v37, v2, v4
    v_add_u32 v38, 40960, v32
    v_add_u32 v39, 40960, v33
    v_add_u32 v40, 40960, v34
    v_add_u32 v41, 40960, v35
    v_add_u32 v42, 40960, v36
    v_add_u32 v43, 40960, v37
    v_add_u32 v44, 81920, v32
    v_add_u32 v45, 81920, v33
    v_add_u32 v46, 81920, v34
    v_add_u32 v47, 81920, v35
    v_add_u32 v48, 81920, v36
    v_add_u32 v49, 81920, v37
    s_mul_i32 s16, s36, 139264
    s_lshl_b32 s17, s37, 9
    s_lshl_b32 s32, s36, 19
    s_lshl_b32 s33, s37, 14
    s_add_u32 s32, s32, s33
    s_lshl_b32 s33, s38, 24
    s_add_u32 s32, s32, s33
    s_add_u32 s32, s32, 5242880
    s_add_u32 m0, s18, 0
    s_nop 0
    buffer_load_dwordx4 v16, s[8:11], s16 offen sc1 lds
    s_add_u32 m0, s19, 0
    s_nop 0
    buffer_load_dwordx4 v24, s[12:15], s17 offen  lds
    s_add_u32 m0, s18, 1024
    s_nop 0
    buffer_load_dwordx4 v17, s[8:11], s16 offen sc1 lds
    s_add_u32 m0, s19, 1024
    s_nop 0
    buffer_load_dwordx4 v25, s[12:15], s17 offen  lds
    s_add_u32 m0, s19, 2048
    s_nop 0
    buffer_load_dwordx4 v26, s[12:15], s17 offen  lds
    s_add_u32 m0, s19, 3072
    s_nop 0
    buffer_load_dwordx4 v27, s[12:15], s17 offen  lds
    s_add_u32 m0, s19, 4096
    s_nop 0
    buffer_load_dwordx4 v28, s[12:15], s17 offen  lds
    s_add_u32 m0, s19, 5120
    s_nop 0
    buffer_load_dwordx4 v29, s[12:15], s17 offen  lds
    s_add_u32 m0, s19, 6144
    s_nop 0
    buffer_load_dwordx4 v30, s[12:15], s17 offen  lds
    s_add_u32 m0, s19, 7168
    s_nop 0
    buffer_load_dwordx4 v31, s[12:15], s17 offen  lds
    s_add_u32 s16, s16, 128
    s_add_u32 s17, s17, 524288
    s_add_u32 m0, s18, 40960
    s_nop 0
    buffer_load_dwordx4 v16, s[8:11], s16 offen sc1 lds
    s_add_u32 m0, s19, 40960
    s_nop 0
    buffer_load_dwordx4 v24, s[12:15], s17 offen  lds
    s_add_u32 m0, s18, 41984
    s_nop 0
    buffer_load_dwordx4 v17, s[8:11], s16 offen sc1 lds
    s_add_u32 m0, s19, 41984
    s_nop 0
    buffer_load_dwordx4 v25, s[12:15], s17 offen  lds
    s_add_u32 m0, s19, 43008
    s_nop 0
    buffer_load_dwordx4 v26, s[12:15], s17 offen  lds
    s_add_u32 m0, s19, 44032
    s_nop 0
    buffer_load_dwordx4 v27, s[12:15], s17 offen  lds
    s_add_u32 m0, s19, 45056
    s_nop 0
    buffer_load_dwordx4 v28, s[12:15], s17 offen  lds
    s_add_u32 m0, s19, 46080
    s_nop 0
    buffer_load_dwordx4 v29, s[12:15], s17 offen  lds
    s_add_u32 m0, s19, 47104
    s_nop 0
    buffer_load_dwordx4 v30, s[12:15], s17 offen  lds
    s_add_u32 m0, s19, 48128
    s_nop 0
    buffer_load_dwordx4 v31, s[12:15], s17 offen  lds
    s_add_u32 s16, s16, 128
    s_add_u32 s17, s17, 524288
    s_add_u32 m0, s18, 81920
    s_nop 0
    buffer_load_dwordx4 v16, s[8:11], s16 offen sc1 lds
    s_add_u32 m0, s19, 81920
    s_nop 0
    buffer_load_dwordx4 v24, s[12:15], s17 offen  lds
    s_add_u32 m0, s18, 82944
    s_nop 0
    buffer_load_dwordx4 v17, s[8:11], s16 offen sc1 lds
    s_add_u32 m0, s19, 82944
    s_nop 0
    buffer_load_dwordx4 v25, s[12:15], s17 offen  lds
    s_add_u32 m0, s19, 83968
    s_nop 0
    buffer_load_dwordx4 v26, s[12:15], s17 offen  lds
    s_add_u32 m0, s19, 84992
    s_nop 0
    buffer_load_dwordx4 v27, s[12:15], s17 offen  lds
    s_add_u32 m0, s19, 86016
    s_nop 0
    buffer_load_dwordx4 v28, s[12:15], s17 offen  lds
    s_add_u32 m0, s19, 87040
    s_nop 0
    buffer_load_dwordx4 v29, s[12:15], s17 offen  lds
    s_add_u32 m0, s19, 88064
    s_nop 0
    buffer_load_dwordx4 v30, s[12:15], s17 offen  lds
    s_add_u32 m0, s19, 89088
    s_nop 0
    buffer_load_dwordx4 v31, s[12:15], s17 offen  lds
    s_add_u32 s16, s16, 128
    s_add_u32 s17, s17, 524288
    s_cmp_eq_u32 s38, 2
    s_cbranch_scc1 L_VS
    s_waitcnt vmcnt(20)
    s_barrier
    ds_read_b64_tr_b16 v[80:81], v36 offset:0
    ds_read_b64_tr_b16 v[82:83], v36 offset:1024
    ds_read_b128 v[64:67], v32 offset:0
    ds_read_b64_tr_b16 v[84:85], v37 offset:0
    ds_read_b64_tr_b16 v[86:87], v37 offset:1024
    ds_read_b64_tr_b16 v[88:89], v36 offset:16384
    ds_read_b64_tr_b16 v[90:91], v36 offset:17408
    ds_read_b64_tr_b16 v[92:93], v37 offset:16384
    ds_read_b64_tr_b16 v[94:95], v37 offset:17408
    s_waitcnt lgkmcnt(0)
    v_mfma_f32_32x32x16_bf16 a[0:15], v[80:83], v[64:67], 0
    ds_read_b64_tr_b16 v[112:113], v36 offset:4096
    ds_read_b64_tr_b16 v[114:115], v36 offset:5120
    ds_read_b128 v[96:99], v33 offset:0
    v_mfma_f32_32x32x16_bf16 a[16:31], v[84:87], v[64:67], 0
    ds_read_b64_tr_b16 v[116:117], v37 offset:4096
    ds_read_b64_tr_b16 v[118:119], v37 offset:5120
    v_mfma_f32_32x32x16_bf16 a[32:47], v[88:91], v[64:67], 0
    ds_read_b64_tr_b16 v[120:121], v36 offset:20480
    ds_read_b64_tr_b16 v[122:123], v36 offset:21504
    v_mfma_f32_32x32x16_bf16 a[48:63], v[92:95], v[64:67], 0
    ds_read_b64_tr_b16 v[124:125], v37 offset:20480
    ds_read_b64_tr_b16 v[126:127], v37 offset:21504
    s_waitcnt lgkmcnt(0)
    v_mfma_f32_32x32x16_bf16 a[0:15], v[112:115], v[96:99], a[0:15]
    ds_read_b64_tr_b16 v[80:81], v36 offset:8192
    ds_read_b64_tr_b16 v[82:83], v36 offset:9216
    ds_read_b128 v[64:67], v34 offset:0
    v_mfma_f32_32x32x16_bf16 a[16:31], v[116:119], v[96:99], a[16:31]
    ds_read_b64_tr_b16 v[84:85], v37 offset:8192
    ds_read_b64_tr_b16 v[86:87], v37 offset:9216
    v_mfma_f32_32x32x16_bf16 a[32:47], v[120:123], v[96:99], a[32:47]
    ds_read_b64_tr_b16 v[88:89], v36 offset:24576
    ds_read_b64_tr_b16 v[90:91], v36 offset:25600
    v_mfma_f32_32x32x16_bf16 a[48:63], v[124:127], v[96:99], a[48:63]
    ds_read_b64_tr_b16 v[92:93], v37 offset:24576
    ds_read_b64_tr_b16 v[94:95], v37 offset:25600
    s_waitcnt lgkmcnt(0)
    v_mfma_f32_32x32x16_bf16 a[0:15], v[80:83], v[64:67], a[0:15]
    ds_read_b64_tr_b16 v[112:113], v36 offset:12288
    ds_read_b64_tr_b16 v[114:115], v36 offset:13312
    ds_read_b128 v[96:99], v35 offset:0
    ds_read_b64_tr_b16 v[116:117], v37 offset:12288
    ds_read_b64_tr_b16 v[118:119], v37 offset:13312
    v_mfma_f32_32x32x16_bf16 a[16:31], v[84:87], v[64:67], a[16:31]
    ds_read_b64_tr_b16 v[120:121], v36 offset:28672
    ds_read_b64_tr_b16 v[122:123], v36 offset:29696
    ds_read_b64_tr_b16 v[124:125], v37 offset:28672
    ds_read_b64_tr_b16 v[126:127], v37 offset:29696
    v_mfma_f32_32x32x16_bf16 a[32:47], v[88:91], v[64:67], a[32:47]
    s_waitcnt vmcnt(10) lgkmcnt(0)
    s_barrier
    v_mfma_f32_32x32x16_bf16 a[48:63], v[92:95], v[64:67], a[48:63]
    s_mov_b32 s20, 4
Gks_136:
    s_waitcnt lgkmcnt(0)
    v_mfma_f32_32x32x16_bf16 a[0:15], v[112:115], v[96:99], a[0:15]
    s_add_u32 m0, s18, 0
    ds_read_b64_tr_b16 v[80:81], v42 offset:0
    buffer_load_dwordx4 v16, s[8:11], s16 offen sc1 lds
    ds_read_b64_tr_b16 v[82:83], v42 offset:1024
    ds_read_b128 v[64:67], v38 offset:0
    s_add_u32 m0, s19, 0
    v_mfma_f32_32x32x16_bf16 a[16:31], v[116:119], v[96:99], a[16:31]
    buffer_load_dwordx4 v24, s[12:15], s17 offen  lds
    ds_read_b64_tr_b16 v[84:85], v43 offset:0
    ds_read_b64_tr_b16 v[86:87], v43 offset:1024
    s_add_u32 m0, s18, 1024
    v_mfma_f32_32x32x16_bf16 a[32:47], v[120:123], v[96:99], a[32:47]
    buffer_load_dwordx4 v17, s[8:11], s16 offen sc1 lds
    ds_read_b64_tr_b16 v[88:89], v42 offset:16384
    ds_read_b64_tr_b16 v[90:91], v42 offset:17408
    s_add_u32 m0, s19, 1024
    v_mfma_f32_32x32x16_bf16 a[48:63], v[124:127], v[96:99], a[48:63]
    buffer_load_dwordx4 v25, s[12:15], s17 offen  lds
    ds_read_b64_tr_b16 v[92:93], v43 offset:16384
    ds_read_b64_tr_b16 v[94:95], v43 offset:17408
    s_waitcnt lgkmcnt(0)
    v_mfma_f32_32x32x16_bf16 a[0:15], v[80:83], v[64:67], a[0:15]
    s_add_u32 m0, s19, 2048
    ds_read_b64_tr_b16 v[112:113], v42 offset:4096
    buffer_load_dwordx4 v26, s[12:15], s17 offen  lds
    ds_read_b64_tr_b16 v[114:115], v42 offset:5120
    ds_read_b128 v[96:99], v39 offset:0
    s_add_u32 m0, s19, 3072
    v_mfma_f32_32x32x16_bf16 a[16:31], v[84:87], v[64:67], a[16:31]
    buffer_load_dwordx4 v27, s[12:15], s17 offen  lds
    ds_read_b64_tr_b16 v[116:117], v43 offset:4096
    ds_read_b64_tr_b16 v[118:119], v43 offset:5120
    s_add_u32 m0, s19, 4096
    v_mfma_f32_32x32x16_bf16 a[32:47], v[88:91], v[64:67], a[32:47]
    buffer_load_dwordx4 v28, s[12:15], s17 offen  lds
    ds_read_b64_tr_b16 v[120:121], v42 offset:20480
    ds_read_b64_tr_b16 v[122:123], v42 offset:21504
    s_add_u32 m0, s19, 5120
    v_mfma_f32_32x32x16_bf16 a[48:63], v[92:95], v[64:67], a[48:63]
    buffer_load_dwordx4 v29, s[12:15], s17 offen  lds
    ds_read_b64_tr_b16 v[124:125], v43 offset:20480
    ds_read_b64_tr_b16 v[126:127], v43 offset:21504
    s_waitcnt lgkmcnt(0)
    v_mfma_f32_32x32x16_bf16 a[0:15], v[112:115], v[96:99], a[0:15]
    ds_read_b64_tr_b16 v[80:81], v42 offset:8192
    ds_read_b64_tr_b16 v[82:83], v42 offset:9216
    ds_read_b128 v[64:67], v40 offset:0
    s_add_u32 m0, s19, 6144
    v_mfma_f32_32x32x16_bf16 a[16:31], v[116:119], v[96:99], a[16:31]
    buffer_load_dwordx4 v30, s[12:15], s17 offen  lds
    ds_read_b64_tr_b16 v[84:85], v43 offset:8192
    ds_read_b64_tr_b16 v[86:87], v43 offset:9216
    v_mfma_f32_32x32x16_bf16 a[32:47], v[120:123], v[96:99], a[32:47]
    ds_read_b64_tr_b16 v[88:89], v42 offset:24576
    ds_read_b64_tr_b16 v[90:91], v42 offset:25600
    s_add_u32 m0, s19, 7168
    v_mfma_f32_32x32x16_bf16 a[48:63], v[124:127], v[96:99], a[48:63]
    buffer_load_dwordx4 v31, s[12:15], s17 offen  lds
    ds_read_b64_tr_b16 v[92:93], v43 offset:24576
    ds_read_b64_tr_b16 v[94:95], v43 offset:25600
    s_waitcnt lgkmcnt(0)
    s_add_u32 s16, s16, 128
    s_add_u32 s17, s17, 524288
    v_mfma_f32_32x32x16_bf16 a[0:15], v[80:83], v[64:67], a[0:15]
    ds_read_b64_tr_b16 v[112:113], v42 offset:12288
    ds_read_b64_tr_b16 v[114:115], v42 offset:13312
    ds_read_b128 v[96:99], v41 offset:0
    ds_read_b64_tr_b16 v[116:117], v43 offset:12288
    ds_read_b64_tr_b16 v[118:119], v43 offset:13312
    v_mfma_f32_32x32x16_bf16 a[16:31], v[84:87], v[64:67], a[16:31]
    ds_read_b64_tr_b16 v[120:121], v42 offset:28672
    ds_read_b64_tr_b16 v[122:123], v42 offset:29696
    ds_read_b64_tr_b16 v[124:125], v43 offset:28672
    ds_read_b64_tr_b16 v[126:127], v43 offset:29696
    v_mfma_f32_32x32x16_bf16 a[32:47], v[88:91], v[64:67], a[32:47]
    s_waitcnt vmcnt(10) lgkmcnt(0)
    s_barrier
    v_mfma_f32_32x32x16_bf16 a[48:63], v[92:95], v[64:67], a[48:63]
    s_waitcnt lgkmcnt(0)
    v_mfma_f32_32x32x16_bf16 a[0:15], v[112:115], v[96:99], a[0:15]
    s_add_u32 m0, s18, 40960
    ds_read_b64_tr_b16 v[80:81], v48 offset:0
    buffer_load_dwordx4 v16, s[8:11], s16 offen sc1 lds
    ds_read_b64_tr_b16 v[82:83], v48 offset:1024
    ds_read_b128 v[64:67], v44 offset:0
    s_add_u32 m0, s19, 40960
    v_mfma_f32_32x32x16_bf16 a[16:31], v[116:119], v[96:99], a[16:31]
    buffer_load_dwordx4 v24, s[12:15], s17 offen  lds
    ds_read_b64_tr_b16 v[84:85], v49 offset:0
    ds_read_b64_tr_b16 v[86:87], v49 offset:1024
    s_add_u32 m0, s18, 41984
    v_mfma_f32_32x32x16_bf16 a[32:47], v[120:123], v[96:99], a[32:47]
    buffer_load_dwordx4 v17, s[8:11], s16 offen sc1 lds
    ds_read_b64_tr_b16 v[88:89], v48 offset:16384
    ds_read_b64_tr_b16 v[90:91], v48 offset:17408
    s_add_u32 m0, s19, 41984
    v_mfma_f32_32x32x16_bf16 a[48:63], v[124:127], v[96:99], a[48:63]
    buffer_load_dwordx4 v25, s[12:15], s17 offen  lds
    ds_read_b64_tr_b16 v[92:93], v49 offset:16384
    ds_read_b64_tr_b16 v[94:95], v49 offset:17408
    s_waitcnt lgkmcnt(0)
    v_mfma_f32_32x32x16_bf16 a[0:15], v[80:83], v[64:67], a[0:15]
    s_add_u32 m0, s19, 43008
    ds_read_b64_tr_b16 v[112:113], v48 offset:4096
    buffer_load_dwordx4 v26, s[12:15], s17 offen  lds
    ds_read_b64_tr_b16 v[114:115], v48 offset:5120
    ds_read_b128 v[96:99], v45 offset:0
    s_add_u32 m0, s19, 44032
    v_mfma_f32_32x32x16_bf16 a[16:31], v[84:87], v[64:67], a[16:31]
    buffer_load_dwordx4 v27, s[12:15], s17 offen  lds
    ds_read_b64_tr_b16 v[116:117], v49 offset:4096
    ds_read_b64_tr_b16 v[118:119], v49 offset:5120
    s_add_u32 m0, s19, 45056
    v_mfma_f32_32x32x16_bf16 a[32:47], v[88:91], v[64:67], a[32:47]
    buffer_load_dwordx4 v28, s[12:15], s17 offen  lds
    ds_read_b64_tr_b16 v[120:121], v48 offset:20480
    ds_read_b64_tr_b16 v[122:123], v48 offset:21504
    s_add_u32 m0, s19, 46080
    v_mfma_f32_32x32x16_bf16 a[48:63], v[92:95], v[64:67], a[48:63]
    buffer_load_dwordx4 v29, s[12:15], s17 offen  lds
    ds_read_b64_tr_b16 v[124:125], v49 offset:20480
    ds_read_b64_tr_b16 v[126:127], v49 offset:21504
    s_waitcnt lgkmcnt(0)
    v_mfma_f32_32x32x16_bf16 a[0:15], v[112:115], v[96:99], a[0:15]
    ds_read_b64_tr_b16 v[80:81], v48 offset:8192
    ds_read_b64_tr_b16 v[82:83], v48 offset:9216
    ds_read_b128 v[64:67], v46 offset:0
    s_add_u32 m0, s19, 47104
    v_mfma_f32_32x32x16_bf16 a[16:31], v[116:119], v[96:99], a[16:31]
    buffer_load_dwordx4 v30, s[12:15], s17 offen  lds
    ds_read_b64_tr_b16 v[84:85], v49 offset:8192
    ds_read_b64_tr_b16 v[86:87], v49 offset:9216
    v_mfma_f32_32x32x16_bf16 a[32:47], v[120:123], v[96:99], a[32:47]
    ds_read_b64_tr_b16 v[88:89], v48 offset:24576
    ds_read_b64_tr_b16 v[90:91], v48 offset:25600
    s_add_u32 m0, s19, 48128
    v_mfma_f32_32x32x16_bf16 a[48:63], v[124:127], v[96:99], a[48:63]
    buffer_load_dwordx4 v31, s[12:15], s17 offen  lds
    ds_read_b64_tr_b16 v[92:93], v49 offset:24576
    ds_read_b64_tr_b16 v[94:95], v49 offset:25600
    s_waitcnt lgkmcnt(0)
    s_add_u32 s16, s16, 128
    s_add_u32 s17, s17, 524288
    v_mfma_f32_32x32x16_bf16 a[0:15], v[80:83], v[64:67], a[0:15]
    ds_read_b64_tr_b16 v[112:113], v48 offset:12288
    ds_read_b64_tr_b16 v[114:115], v48 offset:13312
    ds_read_b128 v[96:99], v47 offset:0
    ds_read_b64_tr_b16 v[116:117], v49 offset:12288
    ds_read_b64_tr_b16 v[118:119], v49 offset:13312
    v_mfma_f32_32x32x16_bf16 a[16:31], v[84:87], v[64:67], a[16:31]
    ds_read_b64_tr_b16 v[120:121], v48 offset:28672
    ds_read_b64_tr_b16 v[122:123], v48 offset:29696
    ds_read_b64_tr_b16 v[124:125], v49 offset:28672
    ds_read_b64_tr_b16 v[126:127], v49 offset:29696
    v_mfma_f32_32x32x16_bf16 a[32:47], v[88:91], v[64:67], a[32:47]
    s_waitcnt vmcnt(10) lgkmcnt(0)
    s_barrier
    v_mfma_f32_32x32x16_bf16 a[48:63], v[92:95], v[64:67], a[48:63]
    s_waitcnt lgkmcnt(0)
    v_mfma_f32_32x32x16_bf16 a[0:15], v[112:115], v[96:99], a[0:15]
    s_add_u32 m0, s18, 81920
    ds_read_b64_tr_b16 v[80:81], v36 offset:0
    buffer_load_dwordx4 v16, s[8:11], s16 offen sc1 lds
    ds_read_b64_tr_b16 v[82:83], v36 offset:1024
    ds_read_b128 v[64:67], v32 offset:0
    s_add_u32 m0, s19, 81920
    v_mfma_f32_32x32x16_bf16 a[16:31], v[116:119], v[96:99], a[16:31]
    buffer_load_dwordx4 v24, s[12:15], s17 offen  lds
    ds_read_b64_tr_b16 v[84:85], v37 offset:0
    ds_read_b64_tr_b16 v[86:87], v37 offset:1024
    s_add_u32 m0, s18, 82944
    v_mfma_f32_32x32x16_bf16 a[32:47], v[120:123], v[96:99], a[32:47]
    buffer_load_dwordx4 v17, s[8:11], s16 offen sc1 lds
    ds_read_b64_tr_b16 v[88:89], v36 offset:16384
    ds_read_b64_tr_b16 v[90:91], v36 offset:17408
    s_add_u32 m0, s19, 82944
    v_mfma_f32_32x32x16_bf16 a[48:63], v[124:127], v[96:99], a[48:63]
    buffer_load_dwordx4 v25, s[12:15], s17 offen  lds
    ds_read_b64_tr_b16 v[92:93], v37 offset:16384
    ds_read_b64_tr_b16 v[94:95], v37 offset:17408
    s_waitcnt lgkmcnt(0)
    v_mfma_f32_32x32x16_bf16 a[0:15], v[80:83], v[64:67], a[0:15]
    s_add_u32 m0, s19, 83968
    ds_read_b64_tr_b16 v[112:113], v36 offset:4096
    buffer_load_dwordx4 v26, s[12:15], s17 offen  lds
    ds_read_b64_tr_b16 v[114:115], v36 offset:5120
    ds_read_b128 v[96:99], v33 offset:0
    s_add_u32 m0, s19, 84992
    v_mfma_f32_32x32x16_bf16 a[16:31], v[84:87], v[64:67], a[16:31]
    buffer_load_dwordx4 v27, s[12:15], s17 offen  lds
    ds_read_b64_tr_b16 v[116:117], v37 offset:4096
    ds_read_b64_tr_b16 v[118:119], v37 offset:5120
    s_add_u32 m0, s19, 86016
    v_mfma_f32_32x32x16_bf16 a[32:47], v[88:91], v[64:67], a[32:47]
    buffer_load_dwordx4 v28, s[12:15], s17 offen  lds
    ds_read_b64_tr_b16 v[120:121], v36 offset:20480
    ds_read_b64_tr_b16 v[122:123], v36 offset:21504
    s_add_u32 m0, s19, 87040
    v_mfma_f32_32x32x16_bf16 a[48:63], v[92:95], v[64:67], a[48:63]
    buffer_load_dwordx4 v29, s[12:15], s17 offen  lds
    ds_read_b64_tr_b16 v[124:125], v37 offset:20480
    ds_read_b64_tr_b16 v[126:127], v37 offset:21504
    s_waitcnt lgkmcnt(0)
    v_mfma_f32_32x32x16_bf16 a[0:15], v[112:115], v[96:99], a[0:15]
    ds_read_b64_tr_b16 v[80:81], v36 offset:8192
    ds_read_b64_tr_b16 v[82:83], v36 offset:9216
    ds_read_b128 v[64:67], v34 offset:0
    s_add_u32 m0, s19, 88064
    v_mfma_f32_32x32x16_bf16 a[16:31], v[116:119], v[96:99], a[16:31]
    buffer_load_dwordx4 v30, s[12:15], s17 offen  lds
    ds_read_b64_tr_b16 v[84:85], v37 offset:8192
    ds_read_b64_tr_b16 v[86:87], v37 offset:9216
    v_mfma_f32_32x32x16_bf16 a[32:47], v[120:123], v[96:99], a[32:47]
    ds_read_b64_tr_b16 v[88:89], v36 offset:24576
    ds_read_b64_tr_b16 v[90:91], v36 offset:25600
    s_add_u32 m0, s19, 89088
    v_mfma_f32_32x32x16_bf16 a[48:63], v[124:127], v[96:99], a[48:63]
    buffer_load_dwordx4 v31, s[12:15], s17 offen  lds
    ds_read_b64_tr_b16 v[92:93], v37 offset:24576
    ds_read_b64_tr_b16 v[94:95], v37 offset:25600
    s_waitcnt lgkmcnt(0)
    s_add_u32 s16, s16, 128
    s_add_u32 s17, s17, 524288
    v_mfma_f32_32x32x16_bf16 a[0:15], v[80:83], v[64:67], a[0:15]
    ds_read_b64_tr_b16 v[112:113], v36 offset:12288
    ds_read_b64_tr_b16 v[114:115], v36 offset:13312
    ds_read_b128 v[96:99], v35 offset:0
    ds_read_b64_tr_b16 v[116:117], v37 offset:12288
    ds_read_b64_tr_b16 v[118:119], v37 offset:13312
    v_mfma_f32_32x32x16_bf16 a[16:31], v[84:87], v[64:67], a[16:31]
    ds_read_b64_tr_b16 v[120:121], v36 offset:28672
    ds_read_b64_tr_b16 v[122:123], v36 offset:29696
    ds_read_b64_tr_b16 v[124:125], v37 offset:28672
    ds_read_b64_tr_b16 v[126:127], v37 offset:29696
    v_mfma_f32_32x32x16_bf16 a[32:47], v[88:91], v[64:67], a[32:47]
    s_waitcnt vmcnt(10) lgkmcnt(0)
    s_barrier
    v_mfma_f32_32x32x16_bf16 a[48:63], v[92:95], v[64:67], a[48:63]
    s_sub_u32 s20, s20, 1
    s_cmp_lg_u32 s20, 0
    s_cbranch_scc1 Gks_136
GEks_137:
    s_waitcnt lgkmcnt(0)
    v_mfma_f32_32x32x16_bf16 a[0:15], v[112:115], v[96:99], a[0:15]
    s_add_u32 m0, s18, 0
    ds_read_b64_tr_b16 v[80:81], v42 offset:0
    buffer_load_dwordx4 v16, s[8:11], s16 offen sc1 lds
    ds_read_b64_tr_b16 v[82:83], v42 offset:1024
    ds_read_b128 v[64:67], v38 offset:0
    s_add_u32 m0, s19, 0
    v_mfma_f32_32x32x16_bf16 a[16:31], v[116:119], v[96:99], a[16:31]
    buffer_load_dwordx4 v24, s[12:15], s17 offen  lds
    ds_read_b64_tr_b16 v[84:85], v43 offset:0
    ds_read_b64_tr_b16 v[86:87], v43 offset:1024
    s_add_u32 m0, s18, 1024
    v_mfma_f32_32x32x16_bf16 a[32:47], v[120:123], v[96:99], a[32:47]
    buffer_load_dwordx4 v17, s[8:11], s16 offen sc1 lds
    ds_read_b64_tr_b16 v[88:89], v42 offset:16384
    ds_read_b64_tr_b16 v[90:91], v42 offset:17408
    s_add_u32 m0, s19, 1024
    v_mfma_f32_32x32x16_bf16 a[48:63], v[124:127], v[96:99], a[48:63]
    buffer_load_dwordx4 v25, s[12:15], s17 offen  lds
    ds_read_b64_tr_b16 v[92:93], v43 offset:16384
    ds_read_b64_tr_b16 v[94:95], v43 offset:17408
    s_waitcnt lgkmcnt(0)
    v_mfma_f32_32x32x16_bf16 a[0:15], v[80:83], v[64:67], a[0:15]
    s_add_u32 m0, s19, 2048
    ds_read_b64_tr_b16 v[112:113], v42 offset:4096
    buffer_load_dwordx4 v26, s[12:15], s17 offen  lds
    ds_read_b64_tr_b16 v[114:115], v42 offset:5120
    ds_read_b128 v[96:99], v39 offset:0
    s_add_u32 m0, s19, 3072
    v_mfma_f32_32x32x16_bf16 a[16:31], v[84:87], v[64:67], a[16:31]
    buffer_load_dwordx4 v27, s[12:15], s17 offen  lds
    ds_read_b64_tr_b16 v[116:117], v43 offset:4096
    ds_read_b64_tr_b16 v[118:119], v43 offset:5120
    s_add_u32 m0, s19, 4096
    v_mfma_f32_32x32x16_bf16 a[32:47], v[88:91], v[64:67], a[32:47]
    buffer_load_dwordx4 v28, s[12:15], s17 offen  lds
    ds_read_b64_tr_b16 v[120:121], v42 offset:20480
    ds_read_b64_tr_b16 v[122:123], v42 offset:21504
    s_add_u32 m0, s19, 5120
    v_mfma_f32_32x32x16_bf16 a[48:63], v[92:95], v[64:67], a[48:63]
    buffer_load_dwordx4 v29, s[12:15], s17 offen  lds
    ds_read_b64_tr_b16 v[124:125], v43 offset:20480
    ds_read_b64_tr_b16 v[126:127], v43 offset:21504
    s_waitcnt lgkmcnt(0)
    v_mfma_f32_32x32x16_bf16 a[0:15], v[112:115], v[96:99], a[0:15]
    ds_read_b64_tr_b16 v[80:81], v42 offset:8192
    ds_read_b64_tr_b16 v[82:83], v42 offset:9216
    ds_read_b128 v[64:67], v40 offset:0
    s_add_u32 m0, s19, 6144
    v_mfma_f32_32x32x16_bf16 a[16:31], v[116:119], v[96:99], a[16:31]
    buffer_load_dwordx4 v30, s[12:15], s17 offen  lds
    ds_read_b64_tr_b16 v[84:85], v43 offset:8192
    ds_read_b64_tr_b16 v[86:87], v43 offset:9216
    v_mfma_f32_32x32x16_bf16 a[32:47], v[120:123], v[96:99], a[32:47]
    ds_read_b64_tr_b16 v[88:89], v42 offset:24576
    ds_read_b64_tr_b16 v[90:91], v42 offset:25600
    s_add_u32 m0, s19, 7168
    v_mfma_f32_32x32x16_bf16 a[48:63], v[124:127], v[96:99], a[48:63]
    buffer_load_dwordx4 v31, s[12:15], s17 offen  lds
    ds_read_b64_tr_b16 v[92:93], v43 offset:24576
    ds_read_b64_tr_b16 v[94:95], v43 offset:25600
    s_waitcnt lgkmcnt(0)
    s_add_u32 s16, s16, 128
    s_add_u32 s17, s17, 524288
    v_mfma_f32_32x32x16_bf16 a[0:15], v[80:83], v[64:67], a[0:15]
    ds_read_b64_tr_b16 v[112:113], v42 offset:12288
    ds_read_b64_tr_b16 v[114:115], v42 offset:13312
    ds_read_b128 v[96:99], v41 offset:0
    ds_read_b64_tr_b16 v[116:117], v43 offset:12288
    ds_read_b64_tr_b16 v[118:119], v43 offset:13312
    v_mfma_f32_32x32x16_bf16 a[16:31], v[84:87], v[64:67], a[16:31]
    ds_read_b64_tr_b16 v[120:121], v42 offset:28672
    ds_read_b64_tr_b16 v[122:123], v42 offset:29696
    ds_read_b64_tr_b16 v[124:125], v43 offset:28672
    ds_read_b64_tr_b16 v[126:127], v43 offset:29696
    v_mfma_f32_32x32x16_bf16 a[32:47], v[88:91], v[64:67], a[32:47]
    s_waitcnt vmcnt(10) lgkmcnt(0)
    s_barrier
    v_mfma_f32_32x32x16_bf16 a[48:63], v[92:95], v[64:67], a[48:63]
    s_waitcnt lgkmcnt(0)
    v_mfma_f32_32x32x16_bf16 a[0:15], v[112:115], v[96:99], a[0:15]
    ds_read_b64_tr_b16 v[80:81], v48 offset:0
    ds_read_b64_tr_b16 v[82:83], v48 offset:1024
    ds_read_b128 v[64:67], v44 offset:0
    v_mfma_f32_32x32x16_bf16 a[16:31], v[116:119], v[96:99], a[16:31]
    ds_read_b64_tr_b16 v[84:85], v49 offset:0
    ds_read_b64_tr_b16 v[86:87], v49 offset:1024
    v_mfma_f32_32x32x16_bf16 a[32:47], v[120:123], v[96:99], a[32:47]
    ds_read_b64_tr_b16 v[88:89], v48 offset:16384
    ds_read_b64_tr_b16 v[90:91], v48 offset:17408
    v_mfma_f32_32x32x16_bf16 a[48:63], v[124:127], v[96:99], a[48:63]
    ds_read_b64_tr_b16 v[92:93], v49 offset:16384
    ds_read_b64_tr_b16 v[94:95], v49 offset:17408
    s_waitcnt lgkmcnt(0)
    v_mfma_f32_32x32x16_bf16 a[0:15], v[80:83], v[64:67], a[0:15]
    ds_read_b64_tr_b16 v[112:113], v48 offset:4096
    ds_read_b64_tr_b16 v[114:115], v48 offset:5120
    ds_read_b128 v[96:99], v45 offset:0
    v_mfma_f32_32x32x16_bf16 a[16:31], v[84:87], v[64:67], a[16:31]
    ds_read_b64_tr_b16 v[116:117], v49 offset:4096
    ds_read_b64_tr_b16 v[118:119], v49 offset:5120
    v_mfma_f32_32x32x16_bf16 a[32:47], v[88:91], v[64:67], a[32:47]
    ds_read_b64_tr_b16 v[120:121], v48 offset:20480
    ds_read_b64_tr_b16 v[122:123], v48 offset:21504
    v_mfma_f32_32x32x16_bf16 a[48:63], v[92:95], v[64:67], a[48:63]
    ds_read_b64_tr_b16 v[124:125], v49 offset:20480
    ds_read_b64_tr_b16 v[126:127], v49 offset:21504
    s_waitcnt lgkmcnt(0)
    v_mfma_f32_32x32x16_bf16 a[0:15], v[112:115], v[96:99], a[0:15]
    ds_read_b64_tr_b16 v[80:81], v48 offset:8192
    ds_read_b64_tr_b16 v[82:83], v48 offset:9216
    ds_read_b128 v[64:67], v46 offset:0
    v_mfma_f32_32x32x16_bf16 a[16:31], v[116:119], v[96:99], a[16:31]
    ds_read_b64_tr_b16 v[84:85], v49 offset:8192
    ds_read_b64_tr_b16 v[86:87], v49 offset:9216
    v_mfma_f32_32x32x16_bf16 a[32:47], v[120:123], v[96:99], a[32:47]
    ds_read_b64_tr_b16 v[88:89], v48 offset:24576
    ds_read_b64_tr_b16 v[90:91], v48 offset:25600
    v_mfma_f32_32x32x16_bf16 a[48:63], v[124:127], v[96:99], a[48:63]
    ds_read_b64_tr_b16 v[92:93], v49 offset:24576
    ds_read_b64_tr_b16 v[94:95], v49 offset:25600
    s_waitcnt lgkmcnt(0)
    v_mfma_f32_32x32x16_bf16 a[0:15], v[80:83], v[64:67], a[0:15]
    ds_read_b64_tr_b16 v[112:113], v48 offset:12288
    ds_read_b64_tr_b16 v[114:115], v48 offset:13312
    ds_read_b128 v[96:99], v47 offset:0
    ds_read_b64_tr_b16 v[116:117], v49 offset:12288
    ds_read_b64_tr_b16 v[118:119], v49 offset:13312
    v_mfma_f32_32x32x16_bf16 a[16:31], v[84:87], v[64:67], a[16:31]
    ds_read_b64_tr_b16 v[120:121], v48 offset:28672
    ds_read_b64_tr_b16 v[122:123], v48 offset:29696
    ds_read_b64_tr_b16 v[124:125], v49 offset:28672
    ds_read_b64_tr_b16 v[126:127], v49 offset:29696
    v_mfma_f32_32x32x16_bf16 a[32:47], v[88:91], v[64:67], a[32:47]
    s_waitcnt vmcnt(0) lgkmcnt(0)
    s_barrier
    v_mfma_f32_32x32x16_bf16 a[48:63], v[92:95], v[64:67], a[48:63]
    s_cmp_lg_u32 s3, 0
    s_cbranch_scc1 Ht_138
    s_mov_b32 s25, s20
    s_mov_b32 s20, s64
    s_and_b32 s21, s65, 0xffff
    s_mov_b32 s22, 256
    s_mov_b32 s23, 0x20000
    s_mov_b32 s30, 0
    s_mov_b32 s24, 192
Ip_139:
    buffer_load_dword v14, off, s[20:23], s24 sc1
    s_waitcnt vmcnt(0)
    v_cmp_ne_u32 vcc, s101, v14
    s_cbranch_vccz Ig_140
    s_sleep 4
    s_add_u32 s30, s30, 1
    s_cmp_lt_u32 s30, 65536
    s_cbranch_scc1 Ip_139
    s_branch L_abort
Ig_140:
    s_mov_b32 s20, s25
Ht_138:
    s_cmp_lg_u32 s3, 0
    s_cbranch_scc1 Ht_141
    v_mov_b32 v14, 1
    s_mov_b64 exec, 1
    buffer_atomic_add v14, off, s[92:95], s97 sc0 sc1
    s_mov_b64 exec, -1
Ht_141:
    s_waitcnt lgkmcnt(0)
    v_mfma_f32_32x32x16_bf16 a[0:15], v[112:115], v[96:99], a[0:15]
    ds_read_b64_tr_b16 v[80:81], v36 offset:0
    ds_read_b64_tr_b16 v[82:83], v36 offset:1024
    ds_read_b128 v[64:67], v32 offset:0
    v_mfma_f32_32x32x16_bf16 a[16:31], v[116:119], v[96:99], a[16:31]
    ds_read_b64_tr_b16 v[84:85], v37 offset:0
    ds_read_b64_tr_b16 v[86:87], v37 offset:1024
    v_mfma_f32_32x32x16_bf16 a[32:47], v[120:123], v[96:99], a[32:47]
    ds_read_b64_tr_b16 v[88:89], v36 offset:16384
    ds_read_b64_tr_b16 v[90:91], v36 offset:17408
    v_mfma_f32_32x32x16_bf16 a[48:63], v[124:127], v[96:99], a[48:63]
    ds_read_b64_tr_b16 v[92:93], v37 offset:16384
    ds_read_b64_tr_b16 v[94:95], v37 offset:17408
    s_waitcnt lgkmcnt(0)
    v_mfma_f32_32x32x16_bf16 a[0:15], v[80:83], v[64:67], a[0:15]
    ds_read_b64_tr_b16 v[112:113], v36 offset:4096
    ds_read_b64_tr_b16 v[114:115], v36 offset:5120
    ds_read_b128 v[96:99], v33 offset:0
    v_mfma_f32_32x32x16_bf16 a[16:31], v[84:87], v[64:67], a[16:31]
    ds_read_b64_tr_b16 v[116:117], v37 offset:4096
    ds_read_b64_tr_b16 v[118:119], v37 offset:5120
    v_mfma_f32_32x32x16_bf16 a[32:47], v[88:91], v[64:67], a[32:47]
    ds_read_b64_tr_b16 v[120:121], v36 offset:20480
    ds_read_b64_tr_b16 v[122:123], v36 offset:21504
    v_mfma_f32_32x32x16_bf16 a[48:63], v[92:95], v[64:67], a[48:63]
    ds_read_b64_tr_b16 v[124:125], v37 offset:20480
    ds_read_b64_tr_b16 v[126:127], v37 offset:21504
    s_waitcnt lgkmcnt(0)
    v_mfma_f32_32x32x16_bf16 a[0:15], v[112:115], v[96:99], a[0:15]
    ds_read_b64_tr_b16 v[80:81], v36 offset:8192
    ds_read_b64_tr_b16 v[82:83], v36 offset:9216
    ds_read_b128 v[64:67], v34 offset:0
    v_mfma_f32_32x32x16_bf16 a[16:31], v[116:119], v[96:99], a[16:31]
    ds_read_b64_tr_b16 v[84:85], v37 offset:8192
    ds_read_b64_tr_b16 v[86:87], v37 offset:9216
    v_mfma_f32_32x32x16_bf16 a[32:47], v[120:123], v[96:99], a[32:47]
    ds_read_b64_tr_b16 v[88:89], v36 offset:24576
    ds_read_b64_tr_b16 v[90:91], v36 offset:25600
    v_mfma_f32_32x32x16_bf16 a[48:63], v[124:127], v[96:99], a[48:63]
    ds_read_b64_tr_b16 v[92:93], v37 offset:24576
    ds_read_b64_tr_b16 v[94:95], v37 offset:25600
    s_waitcnt lgkmcnt(0)
    v_mfma_f32_32x32x16_bf16 a[0:15], v[80:83], v[64:67], a[0:15]
    ds_read_b64_tr_b16 v[112:113], v36 offset:12288
    ds_read_b64_tr_b16 v[114:115], v36 offset:13312
    ds_read_b128 v[96:99], v35 offset:0
    ds_read_b64_tr_b16 v[116:117], v37 offset:12288
    ds_read_b64_tr_b16 v[118:119], v37 offset:13312
    v_mfma_f32_32x32x16_bf16 a[16:31], v[84:87], v[64:67], a[16:31]
    ds_read_b64_tr_b16 v[120:121], v36 offset:28672
    ds_read_b64_tr_b16 v[122:123], v36 offset:29696
    ds_read_b64_tr_b16 v[124:125], v37 offset:28672
    ds_read_b64_tr_b16 v[126:127], v37 offset:29696
    v_mfma_f32_32x32x16_bf16 a[32:47], v[88:91], v[64:67], a[32:47]
    s_waitcnt lgkmcnt(0)
    s_barrier
    v_mfma_f32_32x32x16_bf16 a[48:63], v[92:95], v[64:67], a[48:63]
    s_waitcnt lgkmcnt(0)
    v_mfma_f32_32x32x16_bf16 a[0:15], v[112:115], v[96:99], a[0:15]
    v_mfma_f32_32x32x16_bf16 a[16:31], v[116:119], v[96:99], a[16:31]
    v_mfma_f32_32x32x16_bf16 a[32:47], v[120:123], v[96:99], a[32:47]
    v_mfma_f32_32x32x16_bf16 a[48:63], v[124:127], v[96:99], a[48:63]
    s_cmp_lg_u32 s3, 0
    s_cbranch_scc1 Am_142
    s_waitcnt vmcnt(0)
    v_readfirstlane_b32 s25, v14
    s_nop 3
    s_add_u32 s25, s25, s83
    s_cmp_eq_u32 s98, 5
    s_cbranch_scc1 N_144
    s_cmp_eq_u32 s98, 4
    s_cbranch_scc1 N_143
    s_lshr_b32 s22, s25, 5
    s_and_b32 s25, s25, 31
    s_lshl_b32 s22, s22, 2
    s_add_u32 s22, s22, s98
    s_lshl_b32 s22, s22, 5
    s_add_u32 s25, s25, s22
N_143:
    s_cmp_lt_u32 s25, 768
    s_cselect_b32 s25, s25, 96
    s_cbranch_scc1 N_144_e
N_144:
    s_add_u32 s25, s25, 768
    s_cmp_lt_u32 s25, 864
N_144_e:
    s_cselect_b32 s39, 1, 0
    s_cselect_b32 s96, 1, 2
    v_mov_b32 v14, s25
    v_mov_b32 v15, 159744
    ds_write_b32 v15, v14
Am_142:
    s_nop 15
    v_bfe_u32 v2, v1, 4, 1
    v_lshlrev_b32 v2, 12, v2
    v_and_b32 v3, 15, v1
    v_lshl_add_u32 v2, v3, 4, v2
    v_lshrrev_b32 v3, 5, v1
    v_lshl_add_u32 v2, v3, 8, v2
    s_lshr_b32 s21, s3, 1
    s_mul_i32 s21, s21, 262144
    s_and_b32 s22, s3, 1
    s_lshl_b32 s22, s22, 13
    s_add_u32 s21, s21, s22
    s_add_u32 s21, s21, s32
    v_accvgpr_read_b32 v132, a0
    v_accvgpr_read_b32 v133, a1
    v_accvgpr_read_b32 v134, a2
    v_accvgpr_read_b32 v135, a3
    v_accvgpr_read_b32 v136, a32
    v_accvgpr_read_b32 v137, a33
    v_accvgpr_read_b32 v138, a34
    v_accvgpr_read_b32 v139, a35
    v_cvt_pk_bf16_f32 v128, v132, v133
    v_cvt_pk_bf16_f32 v129, v134, v135
    v_cvt_pk_bf16_f32 v130, v136, v137
    v_cvt_pk_bf16_f32 v131, v138, v139
    buffer_store_dwordx4 v[128:131], v2, s[92:95], s21 offen offset:0 sc1
    v_accvgpr_read_b32 v144, a4
    v_accvgpr_read_b32 v145, a5
    v_accvgpr_read_b32 v146, a6
    v_accvgpr_read_b32 v147, a7
    v_accvgpr_read_b32 v148, a36
    v_accvgpr_read_b32 v149, a37
    v_accvgpr_read_b32 v150, a38
    v_accvgpr_read_b32 v151, a39
    v_cvt_pk_bf16_f32 v140, v144, v145
    v_cvt_pk_bf16_f32 v141, v146, v147
    v_cvt_pk_bf16_f32 v142, v148, v149
    v_cvt_pk_bf16_f32 v143, v150, v151
    buffer_store_dwordx4 v[140:143], v2, s[92:95], s21 offen offset:512 sc1
    v_accvgpr_read_b32 v156, a8
    v_accvgpr_read_b32 v157, a9
    v_accvgpr_read_b32 v158, a10
    v_accvgpr_read_b32 v159, a11
    v_accvgpr_read_b32 v160, a40
    v_accvgpr_read_b32 v161, a41
    v_accvgpr_read_b32 v162, a42
    v_accvgpr_read_b32 v163, a43
    v_cvt_pk_bf16_f32 v152, v156, v157
    v_cvt_pk_bf16_f32 v153, v158, v159
    v_cvt_pk_bf16_f32 v154, v160, v161
    v_cvt_pk_bf16_f32 v155, v162, v163
    buffer_store_dwordx4 v[152:155], v2, s[92:95], s21 offen offset:1024 sc1
    v_accvgpr_read_b32 v168, a12
    v_accvgpr_read_b32 v169, a13
    v_accvgpr_read_b32 v170, a14
    v_accvgpr_read_b32 v171, a15
    v_accvgpr_read_b32 v172, a44
    v_accvgpr_read_b32 v173, a45
    v_accvgpr_read_b32 v174, a46
    v_accvgpr_read_b32 v175, a47
    v_cvt_pk_bf16_f32 v164, v168, v169
    v_cvt_pk_bf16_f32 v165, v170, v171
    v_cvt_pk_bf16_f32 v166, v172, v173
    v_cvt_pk_bf16_f32 v167, v174, v175
    buffer_store_dwordx4 v[164:167], v2, s[92:95], s21 offen offset:1536 sc1
    v_accvgpr_read_b32 v132, a16
    v_accvgpr_read_b32 v133, a17
    v_accvgpr_read_b32 v134, a18
    v_accvgpr_read_b32 v135, a19
    v_accvgpr_read_b32 v136, a48
    v_accvgpr_read_b32 v137, a49
    v_accvgpr_read_b32 v138, a50
    v_accvgpr_read_b32 v139, a51
    v_cvt_pk_bf16_f32 v128, v132, v133
    v_cvt_pk_bf16_f32 v129, v134, v135
    v_cvt_pk_bf16_f32 v130, v136, v137
    v_cvt_pk_bf16_f32 v131, v138, v139
    buffer_store_dwordx4 v[128:131], v2, s[92:95], s21 offen offset:2048 sc1
    v_accvgpr_read_b32 v144, a20
    v_accvgpr_read_b32 v145, a21
    v_accvgpr_read_b32 v146, a22
    v_accvgpr_read_b32 v147, a23
    v_accvgpr_read_b32 v148, a52
    v_accvgpr_read_b32 v149, a53
    v_accvgpr_read_b32 v150, a54
    v_accvgpr_read_b32 v151, a55
    v_cvt_pk_bf16_f32 v140, v144, v145
    v_cvt_pk_bf16_f32 v141, v146, v147
    v_cvt_pk_bf16_f32 v142, v148, v149
    v_cvt_pk_bf16_f32 v143, v150, v151
    buffer_store_dwordx4 v[140:143], v2, s[92:95], s21 offen offset:2560 sc1
    v_accvgpr_read_b32 v156, a24
    v_accvgpr_read_b32 v157, a25
    v_accvgpr_read_b32 v158, a26
    v_accvgpr_read_b32 v159, a27
    v_accvgpr_read_b32 v160, a56
    v_accvgpr_read_b32 v161, a57
    v_accvgpr_read_b32 v162, a58
    v_accvgpr_read_b32 v163, a59
    v_cvt_pk_bf16_f32 v152, v156, v157
    v_cvt_pk_bf16_f32 v153, v158, v159
    v_cvt_pk_bf16_f32 v154, v160, v161
    v_cvt_pk_bf16_f32 v155, v162, v163
    buffer_store_dwordx4 v[152:155], v2, s[92:95], s21 offen offset:3072 sc1
    v_accvgpr_read_b32 v168, a28
    v_accvgpr_read_b32 v169, a29
    v_accvgpr_read_b32 v170, a30
    v_accvgpr_read_b32 v171, a31
    v_accvgpr_read_b32 v172, a60
    v_accvgpr_read_b32 v173, a61
    v_accvgpr_read_b32 v174, a62
    v_accvgpr_read_b32 v175, a63
    v_cvt_pk_bf16_f32 v164, v168, v169
    v_cvt_pk_bf16_f32 v165, v170, v171
    v_cvt_pk_bf16_f32 v166, v172, v173
    v_cvt_pk_bf16_f32 v167, v174, v175
    buffer_store_dwordx4 v[164:167], v2, s[92:95], s21 offen offset:3584 sc1
    s_branch L_KSfin
L_VS:
    s_waitcnt vmcnt(20)
    s_barrier
    ds_read_b64_tr_b16 v[80:81], v36 offset:0
    ds_read_b64_tr_b16 v[82:83], v36 offset:1024
    ds_read_b128 v[64:67], v32 offset:0
    ds_read_b64_tr_b16 v[84:85], v37 offset:0
    ds_read_b64_tr_b16 v[86:87], v37 offset:1024
    ds_read_b64_tr_b16 v[88:89], v36 offset:16384
    ds_read_b64_tr_b16 v[90:91], v36 offset:17408
    ds_read_b64_tr_b16 v[92:93], v37 offset:16384
    ds_read_b64_tr_b16 v[94:95], v37 offset:17408
    s_waitcnt lgkmcnt(0)
    v_mfma_f32_32x32x16_bf16 a[0:15], v[64:67], v[80:83], 0
    ds_read_b64_tr_b16 v[112:113], v36 offset:4096
    ds_read_b64_tr_b16 v[114:115], v36 offset:5120
    ds_read_b128 v[96:99], v33 offset:0
    v_mfma_f32_32x32x16_bf16 a[16:31], v[64:67], v[84:87], 0
    ds_read_b64_tr_b16 v[116:117], v37 offset:4096
    ds_read_b64_tr_b16 v[118:119], v37 offset:5120
    v_mfma_f32_32x32x16_bf16 a[32:47], v[64:67], v[88:91], 0
    ds_read_b64_tr_b16 v[120:121], v36 offset:20480
    ds_read_b64_tr_b16 v[122:123], v36 offset:21504
    v_mfma_f32_32x32x16_bf16 a[48:63], v[64:67], v[92:95], 0
    ds_read_b64_tr_b16 v[124:125], v37 offset:20480
    ds_read_b64_tr_b16 v[126:127], v37 offset:21504
    s_waitcnt lgkmcnt(0)
    v_mfma_f32_32x32x16_bf16 a[0:15], v[96:99], v[112:115], a[0:15]
    ds_read_b64_tr_b16 v[80:81], v36 offset:8192
    ds_read_b64_tr_b16 v[82:83], v36 offset:9216
    ds_read_b128 v[64:67], v34 offset:0
    v_mfma_f32_32x32x16_bf16 a[16:31], v[96:99], v[116:119], a[16:31]
    ds_read_b64_tr_b16 v[84:85], v37 offset:8192
    ds_read_b64_tr_b16 v[86:87], v37 offset:9216
    v_mfma_f32_32x32x16_bf16 a[32:47], v[96:99], v[120:123], a[32:47]
    ds_read_b64_tr_b16 v[88:89], v36 offset:24576
    ds_read_b64_tr_b16 v[90:91], v36 offset:25600
    v_mfma_f32_32x32x16_bf16 a[48:63], v[96:99], v[124:127], a[48:63]
    ds_read_b64_tr_b16 v[92:93], v37 offset:24576
    ds_read_b64_tr_b16 v[94:95], v37 offset:25600
    s_waitcnt lgkmcnt(0)
    v_mfma_f32_32x32x16_bf16 a[0:15], v[64:67], v[80:83], a[0:15]
    ds_read_b64_tr_b16 v[112:113], v36 offset:12288
    ds_read_b64_tr_b16 v[114:115], v36 offset:13312
    ds_read_b128 v[96:99], v35 offset:0
    ds_read_b64_tr_b16 v[116:117], v37 offset:12288
    ds_read_b64_tr_b16 v[118:119], v37 offset:13312
    v_mfma_f32_32x32x16_bf16 a[16:31], v[64:67], v[84:87], a[16:31]
    ds_read_b64_tr_b16 v[120:121], v36 offset:28672
    ds_read_b64_tr_b16 v[122:123], v36 offset:29696
    ds_read_b64_tr_b16 v[124:125], v37 offset:28672
    ds_read_b64_tr_b16 v[126:127], v37 offset:29696
    v_mfma_f32_32x32x16_bf16 a[32:47], v[64:67], v[88:91], a[32:47]
    s_waitcnt vmcnt(10) lgkmcnt(0)
    s_barrier
    v_mfma_f32_32x32x16_bf16 a[48:63], v[64:67], v[92:95], a[48:63]
    s_mov_b32 s20, 4
Gvs_145:
    s_waitcnt lgkmcnt(0)
    v_mfma_f32_32x32x16_bf16 a[0:15], v[96:99], v[112:115], a[0:15]
    s_add_u32 m0, s18, 0
    ds_read_b64_tr_b16 v[80:81], v42 offset:0
    buffer_load_dwordx4 v16, s[8:11], s16 offen sc1 lds
    ds_read_b64_tr_b16 v[82:83], v42 offset:1024
    ds_read_b128 v[64:67], v38 offset:0
    s_add_u32 m0, s19, 0
    v_mfma_f32_32x32x16_bf16 a[16:31], v[96:99], v[116:119], a[16:31]
    buffer_load_dwordx4 v24, s[12:15], s17 offen  lds
    ds_read_b64_tr_b16 v[84:85], v43 offset:0
    ds_read_b64_tr_b16 v[86:87], v43 offset:1024
    s_add_u32 m0, s18, 1024
    v_mfma_f32_32x32x16_bf16 a[32:47], v[96:99], v[120:123], a[32:47]
    buffer_load_dwordx4 v17, s[8:11], s16 offen sc1 lds
    ds_read_b64_tr_b16 v[88:89], v42 offset:16384
    ds_read_b64_tr_b16 v[90:91], v42 offset:17408
    s_add_u32 m0, s19, 1024
    v_mfma_f32_32x32x16_bf16 a[48:63], v[96:99], v[124:127], a[48:63]
    buffer_load_dwordx4 v25, s[12:15], s17 offen  lds
    ds_read_b64_tr_b16 v[92:93], v43 offset:16384
    ds_read_b64_tr_b16 v[94:95], v43 offset:17408
    s_waitcnt lgkmcnt(0)
    v_mfma_f32_32x32x16_bf16 a[0:15], v[64:67], v[80:83], a[0:15]
    s_add_u32 m0, s19, 2048
    ds_read_b64_tr_b16 v[112:113], v42 offset:4096
    buffer_load_dwordx4 v26, s[12:15], s17 offen  lds
    ds_read_b64_tr_b16 v[114:115], v42 offset:5120
    ds_read_b128 v[96:99], v39 offset:0
    s_add_u32 m0, s19, 3072
    v_mfma_f32_32x32x16_bf16 a[16:31], v[64:67], v[84:87], a[16:31]
    buffer_load_dwordx4 v27, s[12:15], s17 offen  lds
    ds_read_b64_tr_b16 v[116:117], v43 offset:4096
    ds_read_b64_tr_b16 v[118:119], v43 offset:5120
    s_add_u32 m0, s19, 4096
    v_mfma_f32_32x32x16_bf16 a[32:47], v[64:67], v[88:91], a[32:47]
    buffer_load_dwordx4 v28, s[12:15], s17 offen  lds
    ds_read_b64_tr_b16 v[120:121], v42 offset:20480
    ds_read_b64_tr_b16 v[122:123], v42 offset:21504
    s_add_u32 m0, s19, 5120
    v_mfma_f32_32x32x16_bf16 a[48:63], v[64:67], v[92:95], a[48:63]
    buffer_load_dwordx4 v29, s[12:15], s17 offen  lds
    ds_read_b64_tr_b16 v[124:125], v43 offset:20480
    ds_read_b64_tr_b16 v[126:127], v43 offset:21504
    s_waitcnt lgkmcnt(0)
    v_mfma_f32_32x32x16_bf16 a[0:15], v[96:99], v[112:115], a[0:15]
    ds_read_b64_tr_b16 v[80:81], v42 offset:8192
    ds_read_b64_tr_b16 v[82:83], v42 offset:9216
    ds_read_b128 v[64:67], v40 offset:0
    s_add_u32 m0, s19, 6144
    v_mfma_f32_32x32x16_bf16 a[16:31], v[96:99], v[116:119], a[16:31]
    buffer_load_dwordx4 v30, s[12:15], s17 offen  lds
    ds_read_b64_tr_b16 v[84:85], v43 offset:8192
    ds_read_b64_tr_b16 v[86:87], v43 offset:9216
    v_mfma_f32_32x32x16_bf16 a[32:47], v[96:99], v[120:123], a[32:47]
    ds_read_b64_tr_b16 v[88:89], v42 offset:24576
    ds_read_b64_tr_b16 v[90:91], v42 offset:25600
    s_add_u32 m0, s19, 7168
    v_mfma_f32_32x32x16_bf16 a[48:63], v[96:99], v[124:127], a[48:63]
    buffer_load_dwordx4 v31, s[12:15], s17 offen  lds
    ds_read_b64_tr_b16 v[92:93], v43 offset:24576
    ds_read_b64_tr_b16 v[94:95], v43 offset:25600
    s_waitcnt lgkmcnt(0)
    s_add_u32 s16, s16, 128
    s_add_u32 s17, s17, 524288
    v_mfma_f32_32x32x16_bf16 a[0:15], v[64:67], v[80:83], a[0:15]
    ds_read_b64_tr_b16 v[112:113], v42 offset:12288
    ds_read_b64_tr_b16 v[114:115], v42 offset:13312
    ds_read_b128 v[96:99], v41 offset:0
    ds_read_b64_tr_b16 v[116:117], v43 offset:12288
    ds_read_b64_tr_b16 v[118:119], v43 offset:13312
    v_mfma_f32_32x32x16_bf16 a[16:31], v[64:67], v[84:87], a[16:31]
    ds_read_b64_tr_b16 v[120:121], v42 offset:28672
    ds_read_b64_tr_b16 v[122:123], v42 offset:29696
    ds_read_b64_tr_b16 v[124:125], v43 offset:28672
    ds_read_b64_tr_b16 v[126:127], v43 offset:29696
    v_mfma_f32_32x32x16_bf16 a[32:47], v[64:67], v[88:91], a[32:47]
    s_waitcnt vmcnt(10) lgkmcnt(0)
    s_barrier
    v_mfma_f32_32x32x16_bf16 a[48:63], v[64:67], v[92:95], a[48:63]
    s_waitcnt lgkmcnt(0)
    v_mfma_f32_32x32x16_bf16 a[0:15], v[96:99], v[112:115], a[0:15]
    s_add_u32 m0, s18, 40960
    ds_read_b64_tr_b16 v[80:81], v48 offset:0
    buffer_load_dwordx4 v16, s[8:11], s16 offen sc1 lds
    ds_read_b64_tr_b16 v[82:83], v48 offset:1024
    ds_read_b128 v[64:67], v44 offset:0
    s_add_u32 m0, s19, 40960
    v_mfma_f32_32x32x16_bf16 a[16:31], v[96:99], v[116:119], a[16:31]
    buffer_load_dwordx4 v24, s[12:15], s17 offen  lds
    ds_read_b64_tr_b16 v[84:85], v49 offset:0
    ds_read_b64_tr_b16 v[86:87], v49 offset:1024
    s_add_u32 m0, s18, 41984
    v_mfma_f32_32x32x16_bf16 a[32:47], v[96:99], v[120:123], a[32:47]
    buffer_load_dwordx4 v17, s[8:11], s16 offen sc1 lds
    ds_read_b64_tr_b16 v[88:89], v48 offset:16384
    ds_read_b64_tr_b16 v[90:91], v48 offset:17408
    s_add_u32 m0, s19, 41984
    v_mfma_f32_32x32x16_bf16 a[48:63], v[96:99], v[124:127], a[48:63]
    buffer_load_dwordx4 v25, s[12:15], s17 offen  lds
    ds_read_b64_tr_b16 v[92:93], v49 offset:16384
    ds_read_b64_tr_b16 v[94:95], v49 offset:17408
    s_waitcnt lgkmcnt(0)
    v_mfma_f32_32x32x16_bf16 a[0:15], v[64:67], v[80:83], a[0:15]
    s_add_u32 m0, s19, 43008
    ds_read_b64_tr_b16 v[112:113], v48 offset:4096
    buffer_load_dwordx4 v26, s[12:15], s17 offen  lds
    ds_read_b64_tr_b16 v[114:115], v48 offset:5120
    ds_read_b128 v[96:99], v45 offset:0
    s_add_u32 m0, s19, 44032
    v_mfma_f32_32x32x16_bf16 a[16:31], v[64:67], v[84:87], a[16:31]
    buffer_load_dwordx4 v27, s[12:15], s17 offen  lds
    ds_read_b64_tr_b16 v[116:117], v49 offset:4096
    ds_read_b64_tr_b16 v[118:119], v49 offset:5120
    s_add_u32 m0, s19, 45056
    v_mfma_f32_32x32x16_bf16 a[32:47], v[64:67], v[88:91], a[32:47]
    buffer_load_dwordx4 v28, s[12:15], s17 offen  lds
    ds_read_b64_tr_b16 v[120:121], v48 offset:20480
    ds_read_b64_tr_b16 v[122:123], v48 offset:21504
    s_add_u32 m0, s19, 46080
    v_mfma_f32_32x32x16_bf16 a[48:63], v[64:67], v[92:95], a[48:63]
    buffer_load_dwordx4 v29, s[12:15], s17 offen  lds
    ds_read_b64_tr_b16 v[124:125], v49 offset:20480
    ds_read_b64_tr_b16 v[126:127], v49 offset:21504
    s_waitcnt lgkmcnt(0)
    v_mfma_f32_32x32x16_bf16 a[0:15], v[96:99], v[112:115], a[0:15]
    ds_read_b64_tr_b16 v[80:81], v48 offset:8192
    ds_read_b64_tr_b16 v[82:83], v48 offset:9216
    ds_read_b128 v[64:67], v46 offset:0
    s_add_u32 m0, s19, 47104
    v_mfma_f32_32x32x16_bf16 a[16:31], v[96:99], v[116:119], a[16:31]
    buffer_load_dwordx4 v30, s[12:15], s17 offen  lds
    ds_read_b64_tr_b16 v[84:85], v49 offset:8192
    ds_read_b64_tr_b16 v[86:87], v49 offset:9216
    v_mfma_f32_32x32x16_bf16 a[32:47], v[96:99], v[120:123], a[32:47]
    ds_read_b64_tr_b16 v[88:89], v48 offset:24576
    ds_read_b64_tr_b16 v[90:91], v48 offset:25600
    s_add_u32 m0, s19, 48128
    v_mfma_f32_32x32x16_bf16 a[48:63], v[96:99], v[124:127], a[48:63]
    buffer_load_dwordx4 v31, s[12:15], s17 offen  lds
    ds_read_b64_tr_b16 v[92:93], v49 offset:24576
    ds_read_b64_tr_b16 v[94:95], v49 offset:25600
    s_waitcnt lgkmcnt(0)
    s_add_u32 s16, s16, 128
    s_add_u32 s17, s17, 524288
    v_mfma_f32_32x32x16_bf16 a[0:15], v[64:67], v[80:83], a[0:15]
    ds_read_b64_tr_b16 v[112:113], v48 offset:12288
    ds_read_b64_tr_b16 v[114:115], v48 offset:13312
    ds_read_b128 v[96:99], v47 offset:0
    ds_read_b64_tr_b16 v[116:117], v49 offset:12288
    ds_read_b64_tr_b16 v[118:119], v49 offset:13312
    v_mfma_f32_32x32x16_bf16 a[16:31], v[64:67], v[84:87], a[16:31]
    ds_read_b64_tr_b16 v[120:121], v48 offset:28672
    ds_read_b64_tr_b16 v[122:123], v48 offset:29696
    ds_read_b64_tr_b16 v[124:125], v49 offset:28672
    ds_read_b64_tr_b16 v[126:127], v49 offset:29696
    v_mfma_f32_32x32x16_bf16 a[32:47], v[64:67], v[88:91], a[32:47]
    s_waitcnt vmcnt(10) lgkmcnt(0)
    s_barrier
    v_mfma_f32_32x32x16_bf16 a[48:63], v[64:67], v[92:95], a[48:63]
    s_waitcnt lgkmcnt(0)
    v_mfma_f32_32x32x16_bf16 a[0:15], v[96:99], v[112:115], a[0:15]
    s_add_u32 m0, s18, 81920
    ds_read_b64_tr_b16 v[80:81], v36 offset:0
    buffer_load_dwordx4 v16, s[8:11], s16 offen sc1 lds
    ds_read_b64_tr_b16 v[82:83], v36 offset:1024
    ds_read_b128 v[64:67], v32 offset:0
    s_add_u32 m0, s19, 81920
    v_mfma_f32_32x32x16_bf16 a[16:31], v[96:99], v[116:119], a[16:31]
    buffer_load_dwordx4 v24, s[12:15], s17 offen  lds
    ds_read_b64_tr_b16 v[84:85], v37 offset:0
    ds_read_b64_tr_b16 v[86:87], v37 offset:1024
    s_add_u32 m0, s18, 82944
    v_mfma_f32_32x32x16_bf16 a[32:47], v[96:99], v[120:123], a[32:47]
    buffer_load_dwordx4 v17, s[8:11], s16 offen sc1 lds
    ds_read_b64_tr_b16 v[88:89], v36 offset:16384
    ds_read_b64_tr_b16 v[90:91], v36 offset:17408
    s_add_u32 m0, s19, 82944
    v_mfma_f32_32x32x16_bf16 a[48:63], v[96:99], v[124:127], a[48:63]
    buffer_load_dwordx4 v25, s[12:15], s17 offen  lds
    ds_read_b64_tr_b16 v[92:93], v37 offset:16384
    ds_read_b64_tr_b16 v[94:95], v37 offset:17408
    s_waitcnt lgkmcnt(0)
    v_mfma_f32_32x32x16_bf16 a[0:15], v[64:67], v[80:83], a[0:15]
    s_add_u32 m0, s19, 83968
    ds_read_b64_tr_b16 v[112:113], v36 offset:4096
    buffer_load_dwordx4 v26, s[12:15], s17 offen  lds
    ds_read_b64_tr_b16 v[114:115], v36 offset:5120
    ds_read_b128 v[96:99], v33 offset:0
    s_add_u32 m0, s19, 84992
    v_mfma_f32_32x32x16_bf16 a[16:31], v[64:67], v[84:87], a[16:31]
    buffer_load_dwordx4 v27, s[12:15], s17 offen  lds
    ds_read_b64_tr_b16 v[116:117], v37 offset:4096
    ds_read_b64_tr_b16 v[118:119], v37 offset:5120
    s_add_u32 m0, s19, 86016
    v_mfma_f32_32x32x16_bf16 a[32:47], v[64:67], v[88:91], a[32:47]
    buffer_load_dwordx4 v28, s[12:15], s17 offen  lds
    ds_read_b64_tr_b16 v[120:121], v36 offset:20480
    ds_read_b64_tr_b16 v[122:123], v36 offset:21504
    s_add_u32 m0, s19, 87040
    v_mfma_f32_32x32x16_bf16 a[48:63], v[64:67], v[92:95], a[48:63]
    buffer_load_dwordx4 v29, s[12:15], s17 offen  lds
    ds_read_b64_tr_b16 v[124:125], v37 offset:20480
    ds_read_b64_tr_b16 v[126:127], v37 offset:21504
    s_waitcnt lgkmcnt(0)
    v_mfma_f32_32x32x16_bf16 a[0:15], v[96:99], v[112:115], a[0:15]
    ds_read_b64_tr_b16 v[80:81], v36 offset:8192
    ds_read_b64_tr_b16 v[82:83], v36 offset:9216
    ds_read_b128 v[64:67], v34 offset:0
    s_add_u32 m0, s19, 88064
    v_mfma_f32_32x32x16_bf16 a[16:31], v[96:99], v[116:119], a[16:31]
    buffer_load_dwordx4 v30, s[12:15], s17 offen  lds
    ds_read_b64_tr_b16 v[84:85], v37 offset:8192
    ds_read_b64_tr_b16 v[86:87], v37 offset:9216
    v_mfma_f32_32x32x16_bf16 a[32:47], v[96:99], v[120:123], a[32:47]
    ds_read_b64_tr_b16 v[88:89], v36 offset:24576
    ds_read_b64_tr_b16 v[90:91], v36 offset:25600
    s_add_u32 m0, s19, 89088
    v_mfma_f32_32x32x16_bf16 a[48:63], v[96:99], v[124:127], a[48:63]
    buffer_load_dwordx4 v31, s[12:15], s17 offen  lds
    ds_read_b64_tr_b16 v[92:93], v37 offset:24576
    ds_read_b64_tr_b16 v[94:95], v37 offset:25600
    s_waitcnt lgkmcnt(0)
    s_add_u32 s16, s16, 128
    s_add_u32 s17, s17, 524288
    v_mfma_f32_32x32x16_bf16 a[0:15], v[64:67], v[80:83], a[0:15]
    ds_read_b64_tr_b16 v[112:113], v36 offset:12288
    ds_read_b64_tr_b16 v[114:115], v36 offset:13312
    ds_read_b128 v[96:99], v35 offset:0
    ds_read_b64_tr_b16 v[116:117], v37 offset:12288
    ds_read_b64_tr_b16 v[118:119], v37 offset:13312
    v_mfma_f32_32x32x16_bf16 a[16:31], v[64:67], v[84:87], a[16:31]
    ds_read_b64_tr_b16 v[120:121], v36 offset:28672
    ds_read_b64_tr_b16 v[122:123], v36 offset:29696
    ds_read_b64_tr_b16 v[124:125], v37 offset:28672
    ds_read_b64_tr_b16 v[126:127], v37 offset:29696
    v_mfma_f32_32x32x16_bf16 a[32:47], v[64:67], v[88:91], a[32:47]
    s_waitcnt vmcnt(10) lgkmcnt(0)
    s_barrier
    v_mfma_f32_32x32x16_bf16 a[48:63], v[64:67], v[92:95], a[48:63]
    s_sub_u32 s20, s20, 1
    s_cmp_lg_u32 s20, 0
    s_cbranch_scc1 Gvs_145
GEvs_146:
    s_waitcnt lgkmcnt(0)
    v_mfma_f32_32x32x16_bf16 a[0:15], v[96:99], v[112:115], a[0:15]
    s_add_u32 m0, s18, 0
    ds_read_b64_tr_b16 v[80:81], v42 offset:0
    buffer_load_dwordx4 v16, s[8:11], s16 offen sc1 lds
    ds_read_b64_tr_b16 v[82:83], v42 offset:1024
    ds_read_b128 v[64:67], v38 offset:0
    s_add_u32 m0, s19, 0
    v_mfma_f32_32x32x16_bf16 a[16:31], v[96:99], v[116:119], a[16:31]
    buffer_load_dwordx4 v24, s[12:15], s17 offen  lds
    ds_read_b64_tr_b16 v[84:85], v43 offset:0
    ds_read_b64_tr_b16 v[86:87], v43 offset:1024
    s_add_u32 m0, s18, 1024
    v_mfma_f32_32x32x16_bf16 a[32:47], v[96:99], v[120:123], a[32:47]
    buffer_load_dwordx4 v17, s[8:11], s16 offen sc1 lds
    ds_read_b64_tr_b16 v[88:89], v42 offset:16384
    ds_read_b64_tr_b16 v[90:91], v42 offset:17408
    s_add_u32 m0, s19, 1024
    v_mfma_f32_32x32x16_bf16 a[48:63], v[96:99], v[124:127], a[48:63]
    buffer_load_dwordx4 v25, s[12:15], s17 offen  lds
    ds_read_b64_tr_b16 v[92:93], v43 offset:16384
    ds_read_b64_tr_b16 v[94:95], v43 offset:17408
    s_waitcnt lgkmcnt(0)
    v_mfma_f32_32x32x16_bf16 a[0:15], v[64:67], v[80:83], a[0:15]
    s_add_u32 m0, s19, 2048
    ds_read_b64_tr_b16 v[112:113], v42 offset:4096
    buffer_load_dwordx4 v26, s[12:15], s17 offen  lds
    ds_read_b64_tr_b16 v[114:115], v42 offset:5120
    ds_read_b128 v[96:99], v39 offset:0
    s_add_u32 m0, s19, 3072
    v_mfma_f32_32x32x16_bf16 a[16:31], v[64:67], v[84:87], a[16:31]
    buffer_load_dwordx4 v27, s[12:15], s17 offen  lds
    ds_read_b64_tr_b16 v[116:117], v43 offset:4096
    ds_read_b64_tr_b16 v[118:119], v43 offset:5120
    s_add_u32 m0, s19, 4096
    v_mfma_f32_32x32x16_bf16 a[32:47], v[64:67], v[88:91], a[32:47]
    buffer_load_dwordx4 v28, s[12:15], s17 offen  lds
    ds_read_b64_tr_b16 v[120:121], v42 offset:20480
    ds_read_b64_tr_b16 v[122:123], v42 offset:21504
    s_add_u32 m0, s19, 5120
    v_mfma_f32_32x32x16_bf16 a[48:63], v[64:67], v[92:95], a[48:63]
    buffer_load_dwordx4 v29, s[12:15], s17 offen  lds
    ds_read_b64_tr_b16 v[124:125], v43 offset:20480
    ds_read_b64_tr_b16 v[126:127], v43 offset:21504
    s_waitcnt lgkmcnt(0)
    v_mfma_f32_32x32x16_bf16 a[0:15], v[96:99], v[112:115], a[0:15]
    ds_read_b64_tr_b16 v[80:81], v42 offset:8192
    ds_read_b64_tr_b16 v[82:83], v42 offset:9216
    ds_read_b128 v[64:67], v40 offset:0
    s_add_u32 m0, s19, 6144
    v_mfma_f32_32x32x16_bf16 a[16:31], v[96:99], v[116:119], a[16:31]
    buffer_load_dwordx4 v30, s[12:15], s17 offen  lds
    ds_read_b64_tr_b16 v[84:85], v43 offset:8192
    ds_read_b64_tr_b16 v[86:87], v43 offset:9216
    v_mfma_f32_32x32x16_bf16 a[32:47], v[96:99], v[120:123], a[32:47]
    ds_read_b64_tr_b16 v[88:89], v42 offset:24576
    ds_read_b64_tr_b16 v[90:91], v42 offset:25600
    s_add_u32 m0, s19, 7168
    v_mfma_f32_32x32x16_bf16 a[48:63], v[96:99], v[124:127], a[48:63]
    buffer_load_dwordx4 v31, s[12:15], s17 offen  lds
    ds_read_b64_tr_b16 v[92:93], v43 offset:24576
    ds_read_b64_tr_b16 v[94:95], v43 offset:25600
    s_waitcnt lgkmcnt(0)
    s_add_u32 s16, s16, 128
    s_add_u32 s17, s17, 524288
    v_mfma_f32_32x32x16_bf16 a[0:15], v[64:67], v[80:83], a[0:15]
    ds_read_b64_tr_b16 v[112:113], v42 offset:12288
    ds_read_b64_tr_b16 v[114:115], v42 offset:13312
    ds_read_b128 v[96:99], v41 offset:0
    ds_read_b64_tr_b16 v[116:117], v43 offset:12288
    ds_read_b64_tr_b16 v[118:119], v43 offset:13312
    v_mfma_f32_32x32x16_bf16 a[16:31], v[64:67], v[84:87], a[16:31]
    ds_read_b64_tr_b16 v[120:121], v42 offset:28672
    ds_read_b64_tr_b16 v[122:123], v42 offset:29696
    ds_read_b64_tr_b16 v[124:125], v43 offset:28672
    ds_read_b64_tr_b16 v[126:127], v43 offset:29696
    v_mfma_f32_32x32x16_bf16 a[32:47], v[64:67], v[88:91], a[32:47]
    s_waitcnt vmcnt(10) lgkmcnt(0)
    s_barrier
    v_mfma_f32_32x32x16_bf16 a[48:63], v[64:67], v[92:95], a[48:63]
    s_waitcnt lgkmcnt(0)
    v_mfma_f32_32x32x16_bf16 a[0:15], v[96:99], v[112:115], a[0:15]
    ds_read_b64_tr_b16 v[80:81], v48 offset:0
    ds_read_b64_tr_b16 v[82:83], v48 offset:1024
    ds_read_b128 v[64:67], v44 offset:0
    v_mfma_f32_32x32x16_bf16 a[16:31], v[96:99], v[116:119], a[16:31]
    ds_read_b64_tr_b16 v[84:85], v49 offset:0
    ds_read_b64_tr_b16 v[86:87], v49 offset:1024
    v_mfma_f32_32x32x16_bf16 a[32:47], v[96:99], v[120:123], a[32:47]
    ds_read_b64_tr_b16 v[88:89], v48 offset:16384
    ds_read_b64_tr_b16 v[90:91], v48 offset:17408
    v_mfma_f32_32x32x16_bf16 a[48:63], v[96:99], v[124:127], a[48:63]
    ds_read_b64_tr_b16 v[92:93], v49 offset:16384
    ds_read_b64_tr_b16 v[94:95], v49 offset:17408
    s_waitcnt lgkmcnt(0)
    v_mfma_f32_32x32x16_bf16 a[0:15], v[64:67], v[80:83], a[0:15]
    ds_read_b64_tr_b16 v[112:113], v48 offset:4096
    ds_read_b64_tr_b16 v[114:115], v48 offset:5120
    ds_read_b128 v[96:99], v45 offset:0
    v_mfma_f32_32x32x16_bf16 a[16:31], v[64:67], v[84:87], a[16:31]
    ds_read_b64_tr_b16 v[116:117], v49 offset:4096
    ds_read_b64_tr_b16 v[118:119], v49 offset:5120
    v_mfma_f32_32x32x16_bf16 a[32:47], v[64:67], v[88:91], a[32:47]
    ds_read_b64_tr_b16 v[120:121], v48 offset:20480
    ds_read_b64_tr_b16 v[122:123], v48 offset:21504
    v_mfma_f32_32x32x16_bf16 a[48:63], v[64:67], v[92:95], a[48:63]
    ds_read_b64_tr_b16 v[124:125], v49 offset:20480
    ds_read_b64_tr_b16 v[126:127], v49 offset:21504
    s_waitcnt lgkmcnt(0)
    v_mfma_f32_32x32x16_bf16 a[0:15], v[96:99], v[112:115], a[0:15]
    ds_read_b64_tr_b16 v[80:81], v48 offset:8192
    ds_read_b64_tr_b16 v[82:83], v48 offset:9216
    ds_read_b128 v[64:67], v46 offset:0
    v_mfma_f32_32x32x16_bf16 a[16:31], v[96:99], v[116:119], a[16:31]
    ds_read_b64_tr_b16 v[84:85], v49 offset:8192
    ds_read_b64_tr_b16 v[86:87], v49 offset:9216
    v_mfma_f32_32x32x16_bf16 a[32:47], v[96:99], v[120:123], a[32:47]
    ds_read_b64_tr_b16 v[88:89], v48 offset:24576
    ds_read_b64_tr_b16 v[90:91], v48 offset:25600
    v_mfma_f32_32x32x16_bf16 a[48:63], v[96:99], v[124:127], a[48:63]
    ds_read_b64_tr_b16 v[92:93], v49 offset:24576
    ds_read_b64_tr_b16 v[94:95], v49 offset:25600
    s_waitcnt lgkmcnt(0)
    v_mfma_f32_32x32x16_bf16 a[0:15], v[64:67], v[80:83], a[0:15]
    ds_read_b64_tr_b16 v[112:113], v48 offset:12288
    ds_read_b64_tr_b16 v[114:115], v48 offset:13312
    ds_read_b128 v[96:99], v47 offset:0
    ds_read_b64_tr_b16 v[116:117], v49 offset:12288
    ds_read_b64_tr_b16 v[118:119], v49 offset:13312
    v_mfma_f32_32x32x16_bf16 a[16:31], v[64:67], v[84:87], a[16:31]
    ds_read_b64_tr_b16 v[120:121], v48 offset:28672
    ds_read_b64_tr_b16 v[122:123], v48 offset:29696
    ds_read_b64_tr_b16 v[124:125], v49 offset:28672
    ds_read_b64_tr_b16 v[126:127], v49 offset:29696
    v_mfma_f32_32x32x16_bf16 a[32:47], v[64:67], v[88:91], a[32:47]
    s_waitcnt vmcnt(0) lgkmcnt(0)
    s_barrier
    v_mfma_f32_32x32x16_bf16 a[48:63], v[64:67], v[92:95], a[48:63]
    s_cmp_lg_u32 s3, 0
    s_cbranch_scc1 Ht_147
    s_mov_b32 s25, s20
    s_mov_b32 s20, s64
    s_and_b32 s21, s65, 0xffff
    s_mov_b32 s22, 256
    s_mov_b32 s23, 0x20000
    s_mov_b32 s30, 0
    s_mov_b32 s24, 192
Ip_148:
    buffer_load_dword v14, off, s[20:23], s24 sc1
    s_waitcnt vmcnt(0)
    v_cmp_ne_u32 vcc, s101, v14
    s_cbranch_vccz Ig_149
    s_sleep 4
    s_add_u32 s30, s30, 1
    s_cmp_lt_u32 s30, 65536
    s_cbranch_scc1 Ip_148
    s_branch L_abort
Ig_149:
    s_mov_b32 s20, s25
Ht_147:
    s_cmp_lg_u32 s3, 0
    s_cbranch_scc1 Ht_150
    v_mov_b32 v14, 1
    s_mov_b64 exec, 1
    buffer_atomic_add v14, off, s[92:95], s97 sc0 sc1
    s_mov_b64 exec, -1
Ht_150:
    s_waitcnt lgkmcnt(0)
    v_mfma_f32_32x32x16_bf16 a[0:15], v[96:99], v[112:115], a[0:15]
    ds_read_b64_tr_b16 v[80:81], v36 offset:0
    ds_read_b64_tr_b16 v[82:83], v36 offset:1024
    ds_read_b128 v[64:67], v32 offset:0
    v_mfma_f32_32x32x16_bf16 a[16:31], v[96:99], v[116:119], a[16:31]
    ds_read_b64_tr_b16 v[84:85], v37 offset:0
    ds_read_b64_tr_b16 v[86:87], v37 offset:1024
    v_mfma_f32_32x32x16_bf16 a[32:47], v[96:99], v[120:123], a[32:47]
    ds_read_b64_tr_b16 v[88:89], v36 offset:16384
    ds_read_b64_tr_b16 v[90:91], v36 offset:17408
    v_mfma_f32_32x32x16_bf16 a[48:63], v[96:99], v[124:127], a[48:63]
    ds_read_b64_tr_b16 v[92:93], v37 offset:16384
    ds_read_b64_tr_b16 v[94:95], v37 offset:17408
    s_waitcnt lgkmcnt(0)
    v_mfma_f32_32x32x16_bf16 a[0:15], v[64:67], v[80:83], a[0:15]
    ds_read_b64_tr_b16 v[112:113], v36 offset:4096
    ds_read_b64_tr_b16 v[114:115], v36 offset:5120
    ds_read_b128 v[96:99], v33 offset:0
    v_mfma_f32_32x32x16_bf16 a[16:31], v[64:67], v[84:87], a[16:31]
    ds_read_b64_tr_b16 v[116:117], v37 offset:4096
    ds_read_b64_tr_b16 v[118:119], v37 offset:5120
    v_mfma_f32_32x32x16_bf16 a[32:47], v[64:67], v[88:91], a[32:47]
    ds_read_b64_tr_b16 v[120:121], v36 offset:20480
    ds_read_b64_tr_b16 v[122:123], v36 offset:21504
    v_mfma_f32_32x32x16_bf16 a[48:63], v[64:67], v[92:95], a[48:63]
    ds_read_b64_tr_b16 v[124:125], v37 offset:20480
    ds_read_b64_tr_b16 v[126:127], v37 offset:21504
    s_waitcnt lgkmcnt(0)
    v_mfma_f32_32x32x16_bf16 a[0:15], v[96:99], v[112:115], a[0:15]
    ds_read_b64_tr_b16 v[80:81], v36 offset:8192
    ds_read_b64_tr_b16 v[82:83], v36 offset:9216
    ds_read_b128 v[64:67], v34 offset:0
    v_mfma_f32_32x32x16_bf16 a[16:31], v[96:99], v[116:119], a[16:31]
    ds_read_b64_tr_b16 v[84:85], v37 offset:8192
    ds_read_b64_tr_b16 v[86:87], v37 offset:9216
    v_mfma_f32_32x32x16_bf16 a[32:47], v[96:99], v[120:123], a[32:47]
    ds_read_b64_tr_b16 v[88:89], v36 offset:24576
    ds_read_b64_tr_b16 v[90:91], v36 offset:25600
    v_mfma_f32_32x32x16_bf16 a[48:63], v[96:99], v[124:127], a[48:63]
    ds_read_b64_tr_b16 v[92:93], v37 offset:24576
    ds_read_b64_tr_b16 v[94:95], v37 offset:25600
    s_waitcnt lgkmcnt(0)
    v_mfma_f32_32x32x16_bf16 a[0:15], v[64:67], v[80:83], a[0:15]
    ds_read_b64_tr_b16 v[112:113], v36 offset:12288
    ds_read_b64_tr_b16 v[114:115], v36 offset:13312
    ds_read_b128 v[96:99], v35 offset:0
    ds_read_b64_tr_b16 v[116:117], v37 offset:12288
    ds_read_b64_tr_b16 v[118:119], v37 offset:13312
    v_mfma_f32_32x32x16_bf16 a[16:31], v[64:67], v[84:87], a[16:31]
    ds_read_b64_tr_b16 v[120:121], v36 offset:28672
    ds_read_b64_tr_b16 v[122:123], v36 offset:29696
    ds_read_b64_tr_b16 v[124:125], v37 offset:28672
    ds_read_b64_tr_b16 v[126:127], v37 offset:29696
    v_mfma_f32_32x32x16_bf16 a[32:47], v[64:67], v[88:91], a[32:47]
    s_waitcnt lgkmcnt(0)
    s_barrier
    v_mfma_f32_32x32x16_bf16 a[48:63], v[64:67], v[92:95], a[48:63]
    s_waitcnt lgkmcnt(0)
    v_mfma_f32_32x32x16_bf16 a[0:15], v[96:99], v[112:115], a[0:15]
    v_mfma_f32_32x32x16_bf16 a[16:31], v[96:99], v[116:119], a[16:31]
    v_mfma_f32_32x32x16_bf16 a[32:47], v[96:99], v[120:123], a[32:47]
    v_mfma_f32_32x32x16_bf16 a[48:63], v[96:99], v[124:127], a[48:63]
    s_cmp_lg_u32 s3, 0
    s_cbranch_scc1 Am_151
    s_waitcnt vmcnt(0)
    v_readfirstlane_b32 s25, v14
    s_nop 3
    s_add_u32 s25, s25, s83
    s_cmp_eq_u32 s98, 5
    s_cbranch_scc1 N_153
    s_cmp_eq_u32 s98, 4
    s_cbranch_scc1 N_152
    s_lshr_b32 s22, s25, 5
    s_and_b32 s25, s25, 31
    s_lshl_b32 s22, s22, 2
    s_add_u32 s22, s22, s98
    s_lshl_b32 s22, s22, 5
    s_add_u32 s25, s25, s22
N_152:
    s_cmp_lt_u32 s25, 768
    s_cselect_b32 s25, s25, 96
    s_cbranch_scc1 N_153_e
N_153:
    s_add_u32 s25, s25, 768
    s_cmp_lt_u32 s25, 864
N_153_e:
    s_cselect_b32 s39, 1, 0
    s_cselect_b32 s96, 1, 2
    v_mov_b32 v14, s25
    v_mov_b32 v15, 159744
    ds_write_b32 v15, v14
Am_151:
    s_nop 15
    v_bfe_u32 v2, v1, 4, 1
    v_lshlrev_b32 v2, 10, v2
    v_and_b32 v3, 15, v1
    v_lshl_add_u32 v2, v3, 4, v2
    v_lshrrev_b32 v3, 5, v1
    v_lshl_add_u32 v2, v3, 8, v2
    v_add_u32 v3, 4096, v2
    s_lshr_b32 s21, s3, 1
    s_mul_i32 s21, s21, 262144
    s_and_b32 s22, s3, 1
    s_lshl_b32 s22, s22, 13
    s_add_u32 s21, s21, s22
    s_add_u32 s21, s21, s32
    v_accvgpr_read_b32 v132, a0
    v_accvgpr_read_b32 v133, a1
    v_accvgpr_read_b32 v134, a2
    v_accvgpr_read_b32 v135, a3
    v_accvgpr_read_b32 v136, a8
    v_accvgpr_read_b32 v137, a9
    v_accvgpr_read_b32 v138, a10
    v_accvgpr_read_b32 v139, a11
    v_cvt_pk_bf16_f32 v128, v132, v133
    v_cvt_pk_bf16_f32 v129, v134, v135
    v_cvt_pk_bf16_f32 v130, v136, v137
    v_cvt_pk_bf16_f32 v131, v138, v139
    buffer_store_dwordx4 v[128:131], v2, s[92:95], s21 offen offset:0 sc1
    v_accvgpr_read_b32 v144, a4
    v_accvgpr_read_b32 v145, a5
    v_accvgpr_read_b32 v146, a6
    v_accvgpr_read_b32 v147, a7
    v_accvgpr_read_b32 v148, a12
    v_accvgpr_read_b32 v149, a13
    v_accvgpr_read_b32 v150, a14
    v_accvgpr_read_b32 v151, a15
    v_cvt_pk_bf16_f32 v140, v144, v145
    v_cvt_pk_bf16_f32 v141, v146, v147
    v_cvt_pk_bf16_f32 v142, v148, v149
    v_cvt_pk_bf16_f32 v143, v150, v151
    buffer_store_dwordx4 v[140:143], v2, s[92:95], s21 offen offset:512 sc1
    v_accvgpr_read_b32 v156, a16
    v_accvgpr_read_b32 v157, a17
    v_accvgpr_read_b32 v158, a18
    v_accvgpr_read_b32 v159, a19
    v_accvgpr_read_b32 v160, a24
    v_accvgpr_read_b32 v161, a25
    v_accvgpr_read_b32 v162, a26
    v_accvgpr_read_b32 v163, a27
    v_cvt_pk_bf16_f32 v152, v156, v157
    v_cvt_pk_bf16_f32 v153, v158, v159
    v_cvt_pk_bf16_f32 v154, v160, v161
    v_cvt_pk_bf16_f32 v155, v162, v163
    buffer_store_dwordx4 v[152:155], v2, s[92:95], s21 offen offset:2048 sc1
    v_accvgpr_read_b32 v168, a20
    v_accvgpr_read_b32 v169, a21
    v_accvgpr_read_b32 v170, a22
    v_accvgpr_read_b32 v171, a23
    v_accvgpr_read_b32 v172, a28
    v_accvgpr_read_b32 v173, a29
    v_accvgpr_read_b32 v174, a30
    v_accvgpr_read_b32 v175, a31
    v_cvt_pk_bf16_f32 v164, v168, v169
    v_cvt_pk_bf16_f32 v165, v170, v171
    v_cvt_pk_bf16_f32 v166, v172, v173
    v_cvt_pk_bf16_f32 v167, v174, v175
    buffer_store_dwordx4 v[164:167], v2, s[92:95], s21 offen offset:2560 sc1
    v_accvgpr_read_b32 v132, a32
    v_accvgpr_read_b32 v133, a33
    v_accvgpr_read_b32 v134, a34
    v_accvgpr_read_b32 v135, a35
    v_accvgpr_read_b32 v136, a40
    v_accvgpr_read_b32 v137, a41
    v_accvgpr_read_b32 v138, a42
    v_accvgpr_read_b32 v139, a43
    v_cvt_pk_bf16_f32 v128, v132, v133
    v_cvt_pk_bf16_f32 v129, v134, v135
    v_cvt_pk_bf16_f32 v130, v136, v137
    v_cvt_pk_bf16_f32 v131, v138, v139
    buffer_store_dwordx4 v[128:131], v3, s[92:95], s21 offen offset:0 sc1
    v_accvgpr_read_b32 v144, a36
    v_accvgpr_read_b32 v145, a37
    v_accvgpr_read_b32 v146, a38
    v_accvgpr_read_b32 v147, a39
    v_accvgpr_read_b32 v148, a44
    v_accvgpr_read_b32 v149, a45
    v_accvgpr_read_b32 v150, a46
    v_accvgpr_read_b32 v151, a47
    v_cvt_pk_bf16_f32 v140, v144, v145
    v_cvt_pk_bf16_f32 v141, v146, v147
    v_cvt_pk_bf16_f32 v142, v148, v149
    v_cvt_pk_bf16_f32 v143, v150, v151
    buffer_store_dwordx4 v[140:143], v3, s[92:95], s21 offen offset:512 sc1
    v_accvgpr_read_b32 v156, a48
    v_accvgpr_read_b32 v157, a49
    v_accvgpr_read_b32 v158, a50
    v_accvgpr_read_b32 v159, a51
    v_accvgpr_read_b32 v160, a56
    v_accvgpr_read_b32 v161, a57
    v_accvgpr_read_b32 v162, a58
    v_accvgpr_read_b32 v163, a59
    v_cvt_pk_bf16_f32 v152, v156, v157
    v_cvt_pk_bf16_f32 v153, v158, v159
    v_cvt_pk_bf16_f32 v154, v160, v161
    v_cvt_pk_bf16_f32 v155, v162, v163
    buffer_store_dwordx4 v[152:155], v3, s[92:95], s21 offen offset:2048 sc1
    v_accvgpr_read_b32 v168, a52
    v_accvgpr_read_b32 v169, a53
    v_accvgpr_read_b32 v170, a54
    v_accvgpr_read_b32 v171, a55
    v_accvgpr_read_b32 v172, a60
    v_accvgpr_read_b32 v173, a61
    v_accvgpr_read_b32 v174, a62
    v_accvgpr_read_b32 v175, a63
    v_cvt_pk_bf16_f32 v164, v168, v169
    v_cvt_pk_bf16_f32 v165, v170, v171
    v_cvt_pk_bf16_f32 v166, v172, v173
    v_cvt_pk_bf16_f32 v167, v174, v175
    buffer_store_dwordx4 v[164:167], v3, s[92:95], s21 offen offset:2560 sc1
L_KSfin:
    s_lshl_b32 s32, s37, 6
    s_add_u32 s32, s32, 113262592
    s_sub_u32 s33, s38, 1
    s_lshl_b32 s33, s33, 3
    s_lshl_b32 s33, 1, s33
    s_waitcnt vmcnt(0)
    s_barrier
    s_cmp_lg_u32 s3, 0
    s_cbranch_scc1 Fin_154
    v_mov_b32 v4, s33
    s_mov_b64 exec, 1
    buffer_atomic_add v4, off, s[92:95], s32 sc1
    s_mov_b64 exec, -1
Fin_154:
    s_branch L_next
L_GU:
    s_and_b32 s22, s21, 1
    s_add_u32 s36, s36, s22
    s_lshr_b32 s21, s21, 1
    s_lshl_b32 s37, s20, 2
    s_add_u32 s37, s37, s21
L_GU2:
    s_mov_b32 s8, s66
    s_and_b32 s9, s67, 0xffff
    s_mov_b32 s10, 4456448
    s_mov_b32 s11, 0x20000
    s_cmp_ge_u32 s3, 2
    s_cselect_b32 s34, s58, s56
    s_cselect_b32 s35, s59, s57
    s_mov_b32 s12, s34
    s_and_b32 s13, s35, 0xffff
    s_mov_b32 s14, 7340032
    s_mov_b32 s15, 0x20000
    v_lshrrev_b32 v3, 4, v1
    v_and_b32 v4, 7, v1
    v_xor_b32 v3, v3, v4
    v_lshrrev_b32 v2, 3, v1
    s_lshl_b32 s21, s3, 6
    v_add_u32 v2, s21, v2
    s_mov_b32 s22, 2176
    v_mul_lo_u32 v2, v2, s22
    v_lshlrev_b32 v3, 4, v3
    v_xor_b32 v4, 64, v3
    v_add_u32 v3, v2, v3
    v_add_u32 v4, v2, v4
    v_add_u32 v16, 0, v3
    v_add_u32 v17, 17408, v4
    v_add_u32 v18, 34816, v3
    v_add_u32 v19, 52224, v4
    v_add_u32 v20, 69632, v3
    v_add_u32 v21, 87040, v4
    v_add_u32 v22, 104448, v3
    v_add_u32 v23, 121856, v4
    v_lshrrev_b32 v2, 4, v1
    v_and_b32 v3, 15, v1
    v_lshlrev_b32 v4, 1, v2
    v_xor_b32 v3, v3, v4
    s_and_b32 s21, s3, 1
    s_lshl_b32 s21, s21, 5
    v_add_u32 v2, s21, v2
    s_mov_b32 s22, 7168
    v_mul_lo_u32 v2, v2, s22
    v_lshlrev_b32 v3, 4, v3
    v_xor_b32 v4, 128, v3
    v_add_u32 v3, v2, v3
    v_add_u32 v4, v2, v4
    v_add_u32 v24, 0, v3
    v_add_u32 v25, 28672, v3
    v_add_u32 v26, 57344, v4
    v_add_u32 v27, 86016, v4
    v_add_u32 v28, 114688, v3
    v_add_u32 v29, 143360, v3
    v_add_u32 v30, 172032, v4
    v_add_u32 v31, 200704, v4
    s_lshl_b32 s18, s3, 13
    s_add_u32 s19, s18, 32768
    v_and_b32 v2, 15, v1
    v_lshrrev_b32 v3, 1, v2
    v_lshrrev_b32 v4, 4, v1
    v_xor_b32 v3, v3, v4
    s_lshr_b32 s21, s3, 1
    s_lshl_b32 s21, s21, 7
    v_add_u32 v2, s21, v2
    v_lshlrev_b32 v2, 7, v2
    v_lshl_add_u32 v32, v3, 4, v2
    v_xor_b32 v33, 64, v32
    v_bfe_u32 v3, v1, 2, 2
    v_lshl_add_u32 v2, v4, 3, v3
    v_lshlrev_b32 v2, 8, v2
    v_and_b32 v5, 3, v1
    v_lshl_add_u32 v2, v5, 3, v2
    v_add_u32 v2, 32768, v2
    v_and_b32 v4, 1, v4
    v_lshl_or_b32 v3, v4, 2, v3
    s_and_b32 s21, s3, 1
    s_lshl_b32 s21, s21, 2
    v_xor_b32 v3, s21, v3
    v_xor_b32 v4, 0, v3
    v_lshl_add_u32 v34, v4, 5, v2
    v_xor_b32 v4, 1, v3
    v_lshl_add_u32 v35, v4, 5, v2
    v_xor_b32 v4, 2, v3
    v_lshl_add_u32 v36, v4, 5, v2
    v_xor_b32 v4, 3, v3
    v_lshl_add_u32 v37, v4, 5, v2
    v_add_u32 v38, 65536, v32
    v_add_u32 v39, 65536, v33
    v_add_u32 v40, 65536, v34
    v_add_u32 v41, 65536, v35
    v_add_u32 v42, 65536, v36
    v_add_u32 v43, 65536, v37
    s_mul_i32 s16, s36, 557056
    s_lshl_b32 s17, s37, 8
    s_add_u32 m0, s18, 0
    s_nop 0
    buffer_load_dwordx4 v16, s[8:11], s16 offen sc1 lds
    s_add_u32 m0, s19, 0
    s_nop 0
    buffer_load_dwordx4 v24, s[12:15], s17 offen  lds
    s_add_u32 m0, s18, 1024
    s_nop 0
    buffer_load_dwordx4 v17, s[8:11], s16 offen sc1 lds
    s_add_u32 m0, s19, 1024
    s_nop 0
    buffer_load_dwordx4 v25, s[12:15], s17 offen  lds
    s_add_u32 m0, s18, 2048
    s_nop 0
    buffer_load_dwordx4 v18, s[8:11], s16 offen sc1 lds
    s_add_u32 m0, s19, 2048
    s_nop 0
    buffer_load_dwordx4 v26, s[12:15], s17 offen  lds
    s_add_u32 m0, s18, 3072
    s_nop 0
    buffer_load_dwordx4 v19, s[8:11], s16 offen sc1 lds
    s_add_u32 m0, s19, 3072
    s_nop 0
    buffer_load_dwordx4 v27, s[12:15], s17 offen  lds
    s_add_u32 m0, s18, 4096
    s_nop 0
    buffer_load_dwordx4 v20, s[8:11], s16 offen sc1 lds
    s_add_u32 m0, s19, 4096
    s_nop 0
    buffer_load_dwordx4 v28, s[12:15], s17 offen  lds
    s_add_u32 m0, s18, 5120
    s_nop 0
    buffer_load_dwordx4 v21, s[8:11], s16 offen sc1 lds
    s_add_u32 m0, s19, 5120
    s_nop 0
    buffer_load_dwordx4 v29, s[12:15], s17 offen  lds
    s_add_u32 m0, s18, 6144
    s_nop 0
    buffer_load_dwordx4 v22, s[8:11], s16 offen sc1 lds
    s_add_u32 m0, s19, 6144
    s_nop 0
    buffer_load_dwordx4 v30, s[12:15], s17 offen  lds
    s_add_u32 m0, s18, 7168
    s_nop 0
    buffer_load_dwordx4 v23, s[8:11], s16 offen sc1 lds
    s_add_u32 m0, s19, 7168
    s_nop 0
    buffer_load_dwordx4 v31, s[12:15], s17 offen  lds
    s_add_u32 s16, s16, 128
    s_add_u32 s17, s17, 458752
    s_add_u32 m0, s18, 65536
    s_nop 0
    buffer_load_dwordx4 v16, s[8:11], s16 offen sc1 lds
    s_add_u32 m0, s19, 65536
    s_nop 0
    buffer_load_dwordx4 v24, s[12:15], s17 offen  lds
    s_add_u32 m0, s18, 66560
    s_nop 0
    buffer_load_dwordx4 v17, s[8:11], s16 offen sc1 lds
    s_add_u32 m0, s19, 66560
    s_nop 0
    buffer_load_dwordx4 v25, s[12:15], s17 offen  lds
    s_add_u32 m0, s18, 67584
    s_nop 0
    buffer_load_dwordx4 v18, s[8:11], s16 offen sc1 lds
    s_add_u32 m0, s19, 67584
    s_nop 0
    buffer_load_dwordx4 v26, s[12:15], s17 offen  lds
    s_add_u32 m0, s18, 68608
    s_nop 0
    buffer_load_dwordx4 v19, s[8:11], s16 offen sc1 lds
    s_add_u32 m0, s19, 68608
    s_nop 0
    buffer_load_dwordx4 v27, s[12:15], s17 offen  lds
    s_add_u32 m0, s18, 69632
    s_nop 0
    buffer_load_dwordx4 v20, s[8:11], s16 offen sc1 lds
    s_add_u32 m0, s19, 69632
    s_nop 0
    buffer_load_dwordx4 v28, s[12:15], s17 offen  lds
    s_add_u32 m0, s18, 70656
    s_nop 0
    buffer_load_dwordx4 v21, s[8:11], s16 offen sc1 lds
    s_add_u32 m0, s19, 70656
    s_nop 0
    buffer_load_dwordx4 v29, s[12:15], s17 offen  lds
    s_add_u32 m0, s18, 71680
    s_nop 0
    buffer_load_dwordx4 v22, s[8:11], s16 offen sc1 lds
    s_add_u32 m0, s19, 71680
    s_nop 0
    buffer_load_dwordx4 v30, s[12:15], s17 offen  lds
    s_add_u32 m0, s18, 72704
    s_nop 0
    buffer_load_dwordx4 v23, s[8:11], s16 offen sc1 lds
    s_add_u32 m0, s19, 72704
    s_nop 0
    buffer_load_dwordx4 v31, s[12:15], s17 offen  lds
    s_add_u32 s16, s16, 128
    s_add_u32 s17, s17, 458752
    s_call_b64 s[4:5], L_epi
    s_waitcnt vmcnt(16)
    s_barrier
    ds_read_b64_tr_b16 v[96:97], v34 offset:0
    ds_read_b64_tr_b16 v[98:99], v34 offset:1024
    ds_read_b128 v[64:67], v32 offset:0
    ds_read_b128 v[68:71], v32 offset:2048
    ds_read_b128 v[72:75], v32 offset:4096
    ds_read_b128 v[76:79], v32 offset:6144
    ds_read_b128 v[80:83], v32 offset:8192
    ds_read_b128 v[84:87], v32 offset:10240
    ds_read_b128 v[88:91], v32 offset:12288
    ds_read_b128 v[92:95], v32 offset:14336
    ds_read_b64_tr_b16 v[100:101], v35 offset:0
    ds_read_b64_tr_b16 v[102:103], v35 offset:1024
    ds_read_b64_tr_b16 v[104:105], v36 offset:0
    ds_read_b64_tr_b16 v[106:107], v36 offset:1024
    ds_read_b64_tr_b16 v[108:109], v37 offset:0
    ds_read_b64_tr_b16 v[110:111], v37 offset:1024
    ds_read_b64_tr_b16 v[112:113], v34 offset:16384
    ds_read_b64_tr_b16 v[114:115], v34 offset:17408
    ds_read_b64_tr_b16 v[116:117], v35 offset:16384
    ds_read_b64_tr_b16 v[118:119], v35 offset:17408
    ds_read_b64_tr_b16 v[120:121], v36 offset:16384
    ds_read_b64_tr_b16 v[122:123], v36 offset:17408
    ds_read_b64_tr_b16 v[124:125], v37 offset:16384
    ds_read_b64_tr_b16 v[126:127], v37 offset:17408
    s_cmp_eq_u32 s69, 0
    s_cbranch_scc1 Hf_155
    s_mov_b32 s21, s69
    s_mov_b32 s69, 0
    s_cmp_lg_u32 s3, 0
    s_cbranch_scc1 Hf_155
    v_mov_b32 v14, s21
    s_mov_b64 exec, 1
    buffer_atomic_add v14, off, s[92:95], s68 sc1
    s_mov_b64 exec, -1
Hf_155:
    s_waitcnt lgkmcnt(0)
    v_mfma_f32_16x16x32_bf16 a[0:3], v[96:99], v[64:67], 0
    ds_read_b64_tr_b16 v[160:161], v34 offset:8192
    v_mfma_f32_16x16x32_bf16 a[32:35], v[96:99], v[68:71], 0
    v_mfma_f32_16x16x32_bf16 a[64:67], v[96:99], v[72:75], 0
    ds_read_b64_tr_b16 v[162:163], v34 offset:9216
    v_mfma_f32_16x16x32_bf16 a[96:99], v[96:99], v[76:79], 0
    v_mfma_f32_16x16x32_bf16 a[128:131], v[96:99], v[80:83], 0
    ds_read_b128 v[128:131], v33 offset:0
    v_mfma_f32_16x16x32_bf16 a[160:163], v[96:99], v[84:87], 0
    v_mfma_f32_16x16x32_bf16 a[192:195], v[96:99], v[88:91], 0
    ds_read_b128 v[132:135], v33 offset:2048
    v_mfma_f32_16x16x32_bf16 a[224:227], v[96:99], v[92:95], 0
    v_mfma_f32_16x16x32_bf16 a[4:7], v[100:103], v[64:67], 0
    ds_read_b128 v[136:139], v33 offset:4096
    v_mfma_f32_16x16x32_bf16 a[36:39], v[100:103], v[68:71], 0
    v_mfma_f32_16x16x32_bf16 a[68:71], v[100:103], v[72:75], 0
    ds_read_b128 v[140:143], v33 offset:6144
    v_mfma_f32_16x16x32_bf16 a[100:103], v[100:103], v[76:79], 0
    v_mfma_f32_16x16x32_bf16 a[132:135], v[100:103], v[80:83], 0
    ds_read_b128 v[144:147], v33 offset:8192
    v_mfma_f32_16x16x32_bf16 a[164:167], v[100:103], v[84:87], 0
    v_mfma_f32_16x16x32_bf16 a[196:199], v[100:103], v[88:91], 0
    ds_read_b128 v[148:151], v33 offset:10240
    v_mfma_f32_16x16x32_bf16 a[228:231], v[100:103], v[92:95], 0
    v_mfma_f32_16x16x32_bf16 a[8:11], v[104:107], v[64:67], 0
    ds_read_b128 v[152:155], v33 offset:12288
    v_mfma_f32_16x16x32_bf16 a[40:43], v[104:107], v[68:71], 0
    v_mfma_f32_16x16x32_bf16 a[72:75], v[104:107], v[72:75], 0
    ds_read_b128 v[156:159], v33 offset:14336
    v_mfma_f32_16x16x32_bf16 a[104:107], v[104:107], v[76:79], 0
    v_mfma_f32_16x16x32_bf16 a[136:139], v[104:107], v[80:83], 0
    ds_read_b64_tr_b16 v[164:165], v35 offset:8192
    v_mfma_f32_16x16x32_bf16 a[168:171], v[104:107], v[84:87], 0
    v_mfma_f32_16x16x32_bf16 a[200:203], v[104:107], v[88:91], 0
    ds_read_b64_tr_b16 v[166:167], v35 offset:9216
    v_mfma_f32_16x16x32_bf16 a[232:235], v[104:107], v[92:95], 0
    v_mfma_f32_16x16x32_bf16 a[12:15], v[108:111], v[64:67], 0
    ds_read_b64_tr_b16 v[168:169], v36 offset:8192
    v_mfma_f32_16x16x32_bf16 a[44:47], v[108:111], v[68:71], 0
    v_mfma_f32_16x16x32_bf16 a[76:79], v[108:111], v[72:75], 0
    ds_read_b64_tr_b16 v[170:171], v36 offset:9216
    v_mfma_f32_16x16x32_bf16 a[108:111], v[108:111], v[76:79], 0
    v_mfma_f32_16x16x32_bf16 a[140:143], v[108:111], v[80:83], 0
    ds_read_b64_tr_b16 v[172:173], v37 offset:8192
    v_mfma_f32_16x16x32_bf16 a[172:175], v[108:111], v[84:87], 0
    v_mfma_f32_16x16x32_bf16 a[204:207], v[108:111], v[88:91], 0
    ds_read_b64_tr_b16 v[174:175], v37 offset:9216
    v_mfma_f32_16x16x32_bf16 a[236:239], v[108:111], v[92:95], 0
    v_mfma_f32_16x16x32_bf16 a[16:19], v[112:115], v[64:67], 0
    ds_read_b64_tr_b16 v[176:177], v34 offset:24576
    v_mfma_f32_16x16x32_bf16 a[48:51], v[112:115], v[68:71], 0
    v_mfma_f32_16x16x32_bf16 a[80:83], v[112:115], v[72:75], 0
    ds_read_b64_tr_b16 v[178:179], v34 offset:25600
    v_mfma_f32_16x16x32_bf16 a[112:115], v[112:115], v[76:79], 0
    v_mfma_f32_16x16x32_bf16 a[144:147], v[112:115], v[80:83], 0
    ds_read_b64_tr_b16 v[180:181], v35 offset:24576
    v_mfma_f32_16x16x32_bf16 a[176:179], v[112:115], v[84:87], 0
    v_mfma_f32_16x16x32_bf16 a[208:211], v[112:115], v[88:91], 0
    ds_read_b64_tr_b16 v[182:183], v35 offset:25600
    v_mfma_f32_16x16x32_bf16 a[240:243], v[112:115], v[92:95], 0
    v_mfma_f32_16x16x32_bf16 a[20:23], v[116:119], v[64:67], 0
    ds_read_b64_tr_b16 v[184:185], v36 offset:24576
    v_mfma_f32_16x16x32_bf16 a[52:55], v[116:119], v[68:71], 0
    v_mfma_f32_16x16x32_bf16 a[84:87], v[116:119], v[72:75], 0
    ds_read_b64_tr_b16 v[186:187], v36 offset:25600
    v_mfma_f32_16x16x32_bf16 a[116:119], v[116:119], v[76:79], 0
    v_mfma_f32_16x16x32_bf16 a[148:151], v[116:119], v[80:83], 0
    ds_read_b64_tr_b16 v[188:189], v37 offset:24576
    v_mfma_f32_16x16x32_bf16 a[180:183], v[116:119], v[84:87], 0
    v_mfma_f32_16x16x32_bf16 a[212:215], v[116:119], v[88:91], 0
    ds_read_b64_tr_b16 v[190:191], v37 offset:25600
    v_mfma_f32_16x16x32_bf16 a[244:247], v[116:119], v[92:95], 0
    v_mfma_f32_16x16x32_bf16 a[24:27], v[120:123], v[64:67], 0
    v_mfma_f32_16x16x32_bf16 a[56:59], v[120:123], v[68:71], 0
    v_mfma_f32_16x16x32_bf16 a[88:91], v[120:123], v[72:75], 0
    v_mfma_f32_16x16x32_bf16 a[120:123], v[120:123], v[76:79], 0
    v_mfma_f32_16x16x32_bf16 a[152:155], v[120:123], v[80:83], 0
    v_mfma_f32_16x16x32_bf16 a[184:187], v[120:123], v[84:87], 0
    v_mfma_f32_16x16x32_bf16 a[216:219], v[120:123], v[88:91], 0
    v_mfma_f32_16x16x32_bf16 a[248:251], v[120:123], v[92:95], 0
    s_waitcnt vmcnt(0) lgkmcnt(0)
    s_barrier
    v_mfma_f32_16x16x32_bf16 a[28:31], v[124:127], v[64:67], 0
    v_mfma_f32_16x16x32_bf16 a[60:63], v[124:127], v[68:71], 0
    v_mfma_f32_16x16x32_bf16 a[92:95], v[124:127], v[72:75], 0
    v_mfma_f32_16x16x32_bf16 a[124:127], v[124:127], v[76:79], 0
    v_mfma_f32_16x16x32_bf16 a[156:159], v[124:127], v[80:83], 0
    v_mfma_f32_16x16x32_bf16 a[188:191], v[124:127], v[84:87], 0
    v_mfma_f32_16x16x32_bf16 a[220:223], v[124:127], v[88:91], 0
    v_mfma_f32_16x16x32_bf16 a[252:255], v[124:127], v[92:95], 0
    s_mov_b32 s20, 7
Ggu_156:
    s_waitcnt lgkmcnt(0)
    v_mfma_f32_16x16x32_bf16 a[0:3], v[160:163], v[128:131], a[0:3]
    s_add_u32 m0, s18, 0
    v_mfma_f32_16x16x32_bf16 a[32:35], v[160:163], v[132:135], a[32:35]
    buffer_load_dwordx4 v16, s[8:11], s16 offen sc1 lds
    v_mfma_f32_16x16x32_bf16 a[64:67], v[160:163], v[136:139], a[64:67]
    ds_read_b64_tr_b16 v[96:97], v40 offset:0
    v_mfma_f32_16x16x32_bf16 a[96:99], v[160:163], v[140:143], a[96:99]
    ds_read_b64_tr_b16 v[98:99], v40 offset:1024
    v_mfma_f32_16x16x32_bf16 a[128:131], v[160:163], v[144:147], a[128:131]
    s_add_u32 m0, s19, 0
    v_mfma_f32_16x16x32_bf16 a[160:163], v[160:163], v[148:151], a[160:163]
    buffer_load_dwordx4 v24, s[12:15], s17 offen  lds
    v_mfma_f32_16x16x32_bf16 a[192:195], v[160:163], v[152:155], a[192:195]
    ds_read_b128 v[64:67], v38 offset:0
    v_mfma_f32_16x16x32_bf16 a[224:227], v[160:163], v[156:159], a[224:227]
    ds_read_b128 v[68:71], v38 offset:2048
    v_mfma_f32_16x16x32_bf16 a[4:7], v[164:167], v[128:131], a[4:7]
    s_add_u32 m0, s18, 1024
    v_mfma_f32_16x16x32_bf16 a[36:39], v[164:167], v[132:135], a[36:39]
    buffer_load_dwordx4 v17, s[8:11], s16 offen sc1 lds
    v_mfma_f32_16x16x32_bf16 a[68:71], v[164:167], v[136:139], a[68:71]
    ds_read_b128 v[72:75], v38 offset:4096
    v_mfma_f32_16x16x32_bf16 a[100:103], v[164:167], v[140:143], a[100:103]
    ds_read_b128 v[76:79], v38 offset:6144
    v_mfma_f32_16x16x32_bf16 a[132:135], v[164:167], v[144:147], a[132:135]
    s_add_u32 m0, s19, 1024
    v_mfma_f32_16x16x32_bf16 a[164:167], v[164:167], v[148:151], a[164:167]
    buffer_load_dwordx4 v25, s[12:15], s17 offen  lds
    v_mfma_f32_16x16x32_bf16 a[196:199], v[164:167], v[152:155], a[196:199]
    ds_read_b128 v[80:83], v38 offset:8192
    v_mfma_f32_16x16x32_bf16 a[228:231], v[164:167], v[156:159], a[228:231]
    ds_read_b128 v[84:87], v38 offset:10240
    v_mfma_f32_16x16x32_bf16 a[8:11], v[168:171], v[128:131], a[8:11]
    s_add_u32 m0, s18, 2048
    v_mfma_f32_16x16x32_bf16 a[40:43], v[168:171], v[132:135], a[40:43]
    buffer_load_dwordx4 v18, s[8:11], s16 offen sc1 lds
    v_mfma_f32_16x16x32_bf16 a[72:75], v[168:171], v[136:139], a[72:75]
    ds_read_b128 v[88:91], v38 offset:12288
    v_mfma_f32_16x16x32_bf16 a[104:107], v[168:171], v[140:143], a[104:107]
    ds_read_b128 v[92:95], v38 offset:14336
    v_mfma_f32_16x16x32_bf16 a[136:139], v[168:171], v[144:147], a[136:139]
    s_add_u32 m0, s19, 2048
    v_mfma_f32_16x16x32_bf16 a[168:171], v[168:171], v[148:151], a[168:171]
    buffer_load_dwordx4 v26, s[12:15], s17 offen  lds
    v_mfma_f32_16x16x32_bf16 a[200:203], v[168:171], v[152:155], a[200:203]
    ds_read_b64_tr_b16 v[100:101], v41 offset:0
    v_mfma_f32_16x16x32_bf16 a[232:235], v[168:171], v[156:159], a[232:235]
    ds_read_b64_tr_b16 v[102:103], v41 offset:1024
    v_mfma_f32_16x16x32_bf16 a[12:15], v[172:175], v[128:131], a[12:15]
    s_add_u32 m0, s18, 3072
    v_mfma_f32_16x16x32_bf16 a[44:47], v[172:175], v[132:135], a[44:47]
    buffer_load_dwordx4 v19, s[8:11], s16 offen sc1 lds
    v_mfma_f32_16x16x32_bf16 a[76:79], v[172:175], v[136:139], a[76:79]
    ds_read_b64_tr_b16 v[104:105], v42 offset:0
    v_mfma_f32_16x16x32_bf16 a[108:111], v[172:175], v[140:143], a[108:111]
    ds_read_b64_tr_b16 v[106:107], v42 offset:1024
    v_mfma_f32_16x16x32_bf16 a[140:143], v[172:175], v[144:147], a[140:143]
    s_add_u32 m0, s19, 3072
    v_mfma_f32_16x16x32_bf16 a[172:175], v[172:175], v[148:151], a[172:175]
    buffer_load_dwordx4 v27, s[12:15], s17 offen  lds
    v_mfma_f32_16x16x32_bf16 a[204:207], v[172:175], v[152:155], a[204:207]
    ds_read_b64_tr_b16 v[108:109], v43 offset:0
    v_mfma_f32_16x16x32_bf16 a[236:239], v[172:175], v[156:159], a[236:239]
    ds_read_b64_tr_b16 v[110:111], v43 offset:1024
    v_mfma_f32_16x16x32_bf16 a[16:19], v[176:179], v[128:131], a[16:19]
    s_add_u32 m0, s18, 4096
    v_mfma_f32_16x16x32_bf16 a[48:51], v[176:179], v[132:135], a[48:51]
    buffer_load_dwordx4 v20, s[8:11], s16 offen sc1 lds
    v_mfma_f32_16x16x32_bf16 a[80:83], v[176:179], v[136:139], a[80:83]
    ds_read_b64_tr_b16 v[112:113], v40 offset:16384
    v_mfma_f32_16x16x32_bf16 a[112:115], v[176:179], v[140:143], a[112:115]
    ds_read_b64_tr_b16 v[114:115], v40 offset:17408
    v_mfma_f32_16x16x32_bf16 a[144:147], v[176:179], v[144:147], a[144:147]
    s_add_u32 m0, s19, 4096
    v_mfma_f32_16x16x32_bf16 a[176:179], v[176:179], v[148:151], a[176:179]
    buffer_load_dwordx4 v28, s[12:15], s17 offen  lds
    v_mfma_f32_16x16x32_bf16 a[208:211], v[176:179], v[152:155], a[208:211]
    ds_read_b64_tr_b16 v[116:117], v41 offset:16384
    v_mfma_f32_16x16x32_bf16 a[240:243], v[176:179], v[156:159], a[240:243]
    ds_read_b64_tr_b16 v[118:119], v41 offset:17408
    v_mfma_f32_16x16x32_bf16 a[20:23], v[180:183], v[128:131], a[20:23]
    s_add_u32 m0, s18, 5120
    v_mfma_f32_16x16x32_bf16 a[52:55], v[180:183], v[132:135], a[52:55]
    buffer_load_dwordx4 v21, s[8:11], s16 offen sc1 lds
    v_mfma_f32_16x16x32_bf16 a[84:87], v[180:183], v[136:139], a[84:87]
    ds_read_b64_tr_b16 v[120:121], v42 offset:16384
    v_mfma_f32_16x16x32_bf16 a[116:119], v[180:183], v[140:143], a[116:119]
    ds_read_b64_tr_b16 v[122:123], v42 offset:17408
    v_mfma_f32_16x16x32_bf16 a[148:151], v[180:183], v[144:147], a[148:151]
    s_add_u32 m0, s19, 5120
    v_mfma_f32_16x16x32_bf16 a[180:183], v[180:183], v[148:151], a[180:183]
    buffer_load_dwordx4 v29, s[12:15], s17 offen  lds
    v_mfma_f32_16x16x32_bf16 a[212:215], v[180:183], v[152:155], a[212:215]
    ds_read_b64_tr_b16 v[124:125], v43 offset:16384
    v_mfma_f32_16x16x32_bf16 a[244:247], v[180:183], v[156:159], a[244:247]
    ds_read_b64_tr_b16 v[126:127], v43 offset:17408
    v_mfma_f32_16x16x32_bf16 a[24:27], v[184:187], v[128:131], a[24:27]
    s_add_u32 m0, s18, 6144
    v_mfma_f32_16x16x32_bf16 a[56:59], v[184:187], v[132:135], a[56:59]
    buffer_load_dwordx4 v22, s[8:11], s16 offen sc1 lds
    v_mfma_f32_16x16x32_bf16 a[88:91], v[184:187], v[136:139], a[88:91]
    v_mfma_f32_16x16x32_bf16 a[120:123], v[184:187], v[140:143], a[120:123]
    v_mfma_f32_16x16x32_bf16 a[152:155], v[184:187], v[144:147], a[152:155]
    s_add_u32 m0, s19, 6144
    v_mfma_f32_16x16x32_bf16 a[184:187], v[184:187], v[148:151], a[184:187]
    buffer_load_dwordx4 v30, s[12:15], s17 offen  lds
    v_mfma_f32_16x16x32_bf16 a[216:219], v[184:187], v[152:155], a[216:219]
    v_mfma_f32_16x16x32_bf16 a[248:251], v[184:187], v[156:159], a[248:251]
    v_mfma_f32_16x16x32_bf16 a[28:31], v[188:191], v[128:131], a[28:31]
    s_add_u32 m0, s18, 7168
    v_mfma_f32_16x16x32_bf16 a[60:63], v[188:191], v[132:135], a[60:63]
    buffer_load_dwordx4 v23, s[8:11], s16 offen sc1 lds
    v_mfma_f32_16x16x32_bf16 a[92:95], v[188:191], v[136:139], a[92:95]
    v_mfma_f32_16x16x32_bf16 a[124:127], v[188:191], v[140:143], a[124:127]
    v_mfma_f32_16x16x32_bf16 a[156:159], v[188:191], v[144:147], a[156:159]
    s_add_u32 m0, s19, 7168
    v_mfma_f32_16x16x32_bf16 a[188:191], v[188:191], v[148:151], a[188:191]
    buffer_load_dwordx4 v31, s[12:15], s17 offen  lds
    v_mfma_f32_16x16x32_bf16 a[220:223], v[188:191], v[152:155], a[220:223]
    v_mfma_f32_16x16x32_bf16 a[252:255], v[188:191], v[156:159], a[252:255]
    s_waitcnt lgkmcnt(0)
    s_add_u32 s16, s16, 128
    s_add_u32 s17, s17, 458752
    v_mfma_f32_16x16x32_bf16 a[0:3], v[96:99], v[64:67], a[0:3]
    ds_read_b64_tr_b16 v[160:161], v40 offset:8192
    v_mfma_f32_16x16x32_bf16 a[32:35], v[96:99], v[68:71], a[32:35]
    v_mfma_f32_16x16x32_bf16 a[64:67], v[96:99], v[72:75], a[64:67]
    ds_read_b64_tr_b16 v[162:163], v40 offset:9216
    v_mfma_f32_16x16x32_bf16 a[96:99], v[96:99], v[76:79], a[96:99]
    v_mfma_f32_16x16x32_bf16 a[128:131], v[96:99], v[80:83], a[128:131]
    ds_read_b128 v[128:131], v39 offset:0
    v_mfma_f32_16x16x32_bf16 a[160:163], v[96:99], v[84:87], a[160:163]
    v_mfma_f32_16x16x32_bf16 a[192:195], v[96:99], v[88:91], a[192:195]
    ds_read_b128 v[132:135], v39 offset:2048
    v_mfma_f32_16x16x32_bf16 a[224:227], v[96:99], v[92:95], a[224:227]
    v_mfma_f32_16x16x32_bf16 a[4:7], v[100:103], v[64:67], a[4:7]
    ds_read_b128 v[136:139], v39 offset:4096
    v_mfma_f32_16x16x32_bf16 a[36:39], v[100:103], v[68:71], a[36:39]
    v_mfma_f32_16x16x32_bf16 a[68:71], v[100:103], v[72:75], a[68:71]
    ds_read_b128 v[140:143], v39 offset:6144
    v_mfma_f32_16x16x32_bf16 a[100:103], v[100:103], v[76:79], a[100:103]
    v_mfma_f32_16x16x32_bf16 a[132:135], v[100:103], v[80:83], a[132:135]
    ds_read_b128 v[144:147], v39 offset:8192
    v_mfma_f32_16x16x32_bf16 a[164:167], v[100:103], v[84:87], a[164:167]
    v_mfma_f32_16x16x32_bf16 a[196:199], v[100:103], v[88:91], a[196:199]
    ds_read_b128 v[148:151], v39 offset:10240
    v_mfma_f32_16x16x32_bf16 a[228:231], v[100:103], v[92:95], a[228:231]
    v_mfma_f32_16x16x32_bf16 a[8:11], v[104:107], v[64:67], a[8:11]
    ds_read_b128 v[152:155], v39 offset:12288
    v_mfma_f32_16x16x32_bf16 a[40:43], v[104:107], v[68:71], a[40:43]
    v_mfma_f32_16x16x32_bf16 a[72:75], v[104:107], v[72:75], a[72:75]
    ds_read_b128 v[156:159], v39 offset:14336
    v_mfma_f32_16x16x32_bf16 a[104:107], v[104:107], v[76:79], a[104:107]
    v_mfma_f32_16x16x32_bf16 a[136:139], v[104:107], v[80:83], a[136:139]
    ds_read_b64_tr_b16 v[164:165], v41 offset:8192
    v_mfma_f32_16x16x32_bf16 a[168:171], v[104:107], v[84:87], a[168:171]
    v_mfma_f32_16x16x32_bf16 a[200:203], v[104:107], v[88:91], a[200:203]
    ds_read_b64_tr_b16 v[166:167], v41 offset:9216
    v_mfma_f32_16x16x32_bf16 a[232:235], v[104:107], v[92:95], a[232:235]
    v_mfma_f32_16x16x32_bf16 a[12:15], v[108:111], v[64:67], a[12:15]
    ds_read_b64_tr_b16 v[168:169], v42 offset:8192
    v_mfma_f32_16x16x32_bf16 a[44:47], v[108:111], v[68:71], a[44:47]
    v_mfma_f32_16x16x32_bf16 a[76:79], v[108:111], v[72:75], a[76:79]
    ds_read_b64_tr_b16 v[170:171], v42 offset:9216
    v_mfma_f32_16x16x32_bf16 a[108:111], v[108:111], v[76:79], a[108:111]
    v_mfma_f32_16x16x32_bf16 a[140:143], v[108:111], v[80:83], a[140:143]
    ds_read_b64_tr_b16 v[172:173], v43 offset:8192
    v_mfma_f32_16x16x32_bf16 a[172:175], v[108:111], v[84:87], a[172:175]
    v_mfma_f32_16x16x32_bf16 a[204:207], v[108:111], v[88:91], a[204:207]
    ds_read_b64_tr_b16 v[174:175], v43 offset:9216
    v_mfma_f32_16x16x32_bf16 a[236:239], v[108:111], v[92:95], a[236:239]
    v_mfma_f32_16x16x32_bf16 a[16:19], v[112:115], v[64:67], a[16:19]
    ds_read_b64_tr_b16 v[176:177], v40 offset:24576
    v_mfma_f32_16x16x32_bf16 a[48:51], v[112:115], v[68:71], a[48:51]
    v_mfma_f32_16x16x32_bf16 a[80:83], v[112:115], v[72:75], a[80:83]
    ds_read_b64_tr_b16 v[178:179], v40 offset:25600
    v_mfma_f32_16x16x32_bf16 a[112:115], v[112:115], v[76:79], a[112:115]
    v_mfma_f32_16x16x32_bf16 a[144:147], v[112:115], v[80:83], a[144:147]
    ds_read_b64_tr_b16 v[180:181], v41 offset:24576
    v_mfma_f32_16x16x32_bf16 a[176:179], v[112:115], v[84:87], a[176:179]
    v_mfma_f32_16x16x32_bf16 a[208:211], v[112:115], v[88:91], a[208:211]
    ds_read_b64_tr_b16 v[182:183], v41 offset:25600
    v_mfma_f32_16x16x32_bf16 a[240:243], v[112:115], v[92:95], a[240:243]
    v_mfma_f32_16x16x32_bf16 a[20:23], v[116:119], v[64:67], a[20:23]
    ds_read_b64_tr_b16 v[184:185], v42 offset:24576
    v_mfma_f32_16x16x32_bf16 a[52:55], v[116:119], v[68:71], a[52:55]
    v_mfma_f32_16x16x32_bf16 a[84:87], v[116:119], v[72:75], a[84:87]
    ds_read_b64_tr_b16 v[186:187], v42 offset:25600
    v_mfma_f32_16x16x32_bf16 a[116:119], v[116:119], v[76:79], a[116:119]
    v_mfma_f32_16x16x32_bf16 a[148:151], v[116:119], v[80:83], a[148:151]
    ds_read_b64_tr_b16 v[188:189], v43 offset:24576
    v_mfma_f32_16x16x32_bf16 a[180:183], v[116:119], v[84:87], a[180:183]
    v_mfma_f32_16x16x32_bf16 a[212:215], v[116:119], v[88:91], a[212:215]
    ds_read_b64_tr_b16 v[190:191], v43 offset:25600
    v_mfma_f32_16x16x32_bf16 a[244:247], v[116:119], v[92:95], a[244:247]
    v_mfma_f32_16x16x32_bf16 a[24:27], v[120:123], v[64:67], a[24:27]
    v_mfma_f32_16x16x32_bf16 a[56:59], v[120:123], v[68:71], a[56:59]
    v_mfma_f32_16x16x32_bf16 a[88:91], v[120:123], v[72:75], a[88:91]
    v_mfma_f32_16x16x32_bf16 a[120:123], v[120:123], v[76:79], a[120:123]
    v_mfma_f32_16x16x32_bf16 a[152:155], v[120:123], v[80:83], a[152:155]
    v_mfma_f32_16x16x32_bf16 a[184:187], v[120:123], v[84:87], a[184:187]
    v_mfma_f32_16x16x32_bf16 a[216:219], v[120:123], v[88:91], a[216:219]
    v_mfma_f32_16x16x32_bf16 a[248:251], v[120:123], v[92:95], a[248:251]
    s_waitcnt vmcnt(0) lgkmcnt(0)
    s_barrier
    v_mfma_f32_16x16x32_bf16 a[28:31], v[124:127], v[64:67], a[28:31]
    v_mfma_f32_16x16x32_bf16 a[60:63], v[124:127], v[68:71], a[60:63]
    v_mfma_f32_16x16x32_bf16 a[92:95], v[124:127], v[72:75], a[92:95]
    v_mfma_f32_16x16x32_bf16 a[124:127], v[124:127], v[76:79], a[124:127]
    v_mfma_f32_16x16x32_bf16 a[156:159], v[124:127], v[80:83], a[156:159]
    v_mfma_f32_16x16x32_bf16 a[188:191], v[124:127], v[84:87], a[188:191]
    v_mfma_f32_16x16x32_bf16 a[220:223], v[124:127], v[88:91], a[220:223]
    v_mfma_f32_16x16x32_bf16 a[252:255], v[124:127], v[92:95], a[252:255]
    s_waitcnt lgkmcnt(0)
    v_mfma_f32_16x16x32_bf16 a[0:3], v[160:163], v[128:131], a[0:3]
    s_add_u32 m0, s18, 65536
    v_mfma_f32_16x16x32_bf16 a[32:35], v[160:163], v[132:135], a[32:35]
    buffer_load_dwordx4 v16, s[8:11], s16 offen sc1 lds
    v_mfma_f32_16x16x32_bf16 a[64:67], v[160:163], v[136:139], a[64:67]
    ds_read_b64_tr_b16 v[96:97], v34 offset:0
    v_mfma_f32_16x16x32_bf16 a[96:99], v[160:163], v[140:143], a[96:99]
    ds_read_b64_tr_b16 v[98:99], v34 offset:1024
    v_mfma_f32_16x16x32_bf16 a[128:131], v[160:163], v[144:147], a[128:131]
    s_add_u32 m0, s19, 65536
    v_mfma_f32_16x16x32_bf16 a[160:163], v[160:163], v[148:151], a[160:163]
    buffer_load_dwordx4 v24, s[12:15], s17 offen  lds
    v_mfma_f32_16x16x32_bf16 a[192:195], v[160:163], v[152:155], a[192:195]
    ds_read_b128 v[64:67], v32 offset:0
    v_mfma_f32_16x16x32_bf16 a[224:227], v[160:163], v[156:159], a[224:227]
    ds_read_b128 v[68:71], v32 offset:2048
    v_mfma_f32_16x16x32_bf16 a[4:7], v[164:167], v[128:131], a[4:7]
    s_add_u32 m0, s18, 66560
    v_mfma_f32_16x16x32_bf16 a[36:39], v[164:167], v[132:135], a[36:39]
    buffer_load_dwordx4 v17, s[8:11], s16 offen sc1 lds
    v_mfma_f32_16x16x32_bf16 a[68:71], v[164:167], v[136:139], a[68:71]
    ds_read_b128 v[72:75], v32 offset:4096
    v_mfma_f32_16x16x32_bf16 a[100:103], v[164:167], v[140:143], a[100:103]
    ds_read_b128 v[76:79], v32 offset:6144
    v_mfma_f32_16x16x32_bf16 a[132:135], v[164:167], v[144:147], a[132:135]
    s_add_u32 m0, s19, 66560
    v_mfma_f32_16x16x32_bf16 a[164:167], v[164:167], v[148:151], a[164:167]
    buffer_load_dwordx4 v25, s[12:15], s17 offen  lds
    v_mfma_f32_16x16x32_bf16 a[196:199], v[164:167], v[152:155], a[196:199]
    ds_read_b128 v[80:83], v32 offset:8192
    v_mfma_f32_16x16x32_bf16 a[228:231], v[164:167], v[156:159], a[228:231]
    ds_read_b128 v[84:87], v32 offset:10240
    v_mfma_f32_16x16x32_bf16 a[8:11], v[168:171], v[128:131], a[8:11]
    s_add_u32 m0, s18, 67584
    v_mfma_f32_16x16x32_bf16 a[40:43], v[168:171], v[132:135], a[40:43]
    buffer_load_dwordx4 v18, s[8:11], s16 offen sc1 lds
    v_mfma_f32_16x16x32_bf16 a[72:75], v[168:171], v[136:139], a[72:75]
    ds_read_b128 v[88:91], v32 offset:12288
    v_mfma_f32_16x16x32_bf16 a[104:107], v[168:171], v[140:143], a[104:107]
    ds_read_b128 v[92:95], v32 offset:14336
    v_mfma_f32_16x16x32_bf16 a[136:139], v[168:171], v[144:147], a[136:139]
    s_add_u32 m0, s19, 67584
    v_mfma_f32_16x16x32_bf16 a[168:171], v[168:171], v[148:151], a[168:171]
    buffer_load_dwordx4 v26, s[12:15], s17 offen  lds
    v_mfma_f32_16x16x32_bf16 a[200:203], v[168:171], v[152:155], a[200:203]
    ds_read_b64_tr_b16 v[100:101], v35 offset:0
    v_mfma_f32_16x16x32_bf16 a[232:235], v[168:171], v[156:159], a[232:235]
    ds_read_b64_tr_b16 v[102:103], v35 offset:1024
    v_mfma_f32_16x16x32_bf16 a[12:15], v[172:175], v[128:131], a[12:15]
    s_add_u32 m0, s18, 68608
    v_mfma_f32_16x16x32_bf16 a[44:47], v[172:175], v[132:135], a[44:47]
    buffer_load_dwordx4 v19, s[8:11], s16 offen sc1 lds
    v_mfma_f32_16x16x32_bf16 a[76:79], v[172:175], v[136:139], a[76:79]
    ds_read_b64_tr_b16 v[104:105], v36 offset:0
    v_mfma_f32_16x16x32_bf16 a[108:111], v[172:175], v[140:143], a[108:111]
    ds_read_b64_tr_b16 v[106:107], v36 offset:1024
    v_mfma_f32_16x16x32_bf16 a[140:143], v[172:175], v[144:147], a[140:143]
    s_add_u32 m0, s19, 68608
    v_mfma_f32_16x16x32_bf16 a[172:175], v[172:175], v[148:151], a[172:175]
    buffer_load_dwordx4 v27, s[12:15], s17 offen  lds
    v_mfma_f32_16x16x32_bf16 a[204:207], v[172:175], v[152:155], a[204:207]
    ds_read_b64_tr_b16 v[108:109], v37 offset:0
    v_mfma_f32_16x16x32_bf16 a[236:239], v[172:175], v[156:159], a[236:239]
    ds_read_b64_tr_b16 v[110:111], v37 offset:1024
    v_mfma_f32_16x16x32_bf16 a[16:19], v[176:179], v[128:131], a[16:19]
    s_add_u32 m0, s18, 69632
    v_mfma_f32_16x16x32_bf16 a[48:51], v[176:179], v[132:135], a[48:51]
    buffer_load_dwordx4 v20, s[8:11], s16 offen sc1 lds
    v_mfma_f32_16x16x32_bf16 a[80:83], v[176:179], v[136:139], a[80:83]
    ds_read_b64_tr_b16 v[112:113], v34 offset:16384
    v_mfma_f32_16x16x32_bf16 a[112:115], v[176:179], v[140:143], a[112:115]
    ds_read_b64_tr_b16 v[114:115], v34 offset:17408
    v_mfma_f32_16x16x32_bf16 a[144:147], v[176:179], v[144:147], a[144:147]
    s_add_u32 m0, s19, 69632
    v_mfma_f32_16x16x32_bf16 a[176:179], v[176:179], v[148:151], a[176:179]
    buffer_load_dwordx4 v28, s[12:15], s17 offen  lds
    v_mfma_f32_16x16x32_bf16 a[208:211], v[176:179], v[152:155], a[208:211]
    ds_read_b64_tr_b16 v[116:117], v35 offset:16384
    v_mfma_f32_16x16x32_bf16 a[240:243], v[176:179], v[156:159], a[240:243]
    ds_read_b64_tr_b16 v[118:119], v35 offset:17408
    v_mfma_f32_16x16x32_bf16 a[20:23], v[180:183], v[128:131], a[20:23]
    s_add_u32 m0, s18, 70656
    v_mfma_f32_16x16x32_bf16 a[52:55], v[180:183], v[132:135], a[52:55]
    buffer_load_dwordx4 v21, s[8:11], s16 offen sc1 lds
    v_mfma_f32_16x16x32_bf16 a[84:87], v[180:183], v[136:139], a[84:87]
    ds_read_b64_tr_b16 v[120:121], v36 offset:16384
    v_mfma_f32_16x16x32_bf16 a[116:119], v[180:183], v[140:143], a[116:119]
    ds_read_b64_tr_b16 v[122:123], v36 offset:17408
    v_mfma_f32_16x16x32_bf16 a[148:151], v[180:183], v[144:147], a[148:151]
    s_add_u32 m0, s19, 70656
    v_mfma_f32_16x16x32_bf16 a[180:183], v[180:183], v[148:151], a[180:183]
    buffer_load_dwordx4 v29, s[12:15], s17 offen  lds
    v_mfma_f32_16x16x32_bf16 a[212:215], v[180:183], v[152:155], a[212:215]
    ds_read_b64_tr_b16 v[124:125], v37 offset:16384
    v_mfma_f32_16x16x32_bf16 a[244:247], v[180:183], v[156:159], a[244:247]
    ds_read_b64_tr_b16 v[126:127], v37 offset:17408
    v_mfma_f32_16x16x32_bf16 a[24:27], v[184:187], v[128:131], a[24:27]
    s_add_u32 m0, s18, 71680
    v_mfma_f32_16x16x32_bf16 a[56:59], v[184:187], v[132:135], a[56:59]
    buffer_load_dwordx4 v22, s[8:11], s16 offen sc1 lds
    v_mfma_f32_16x16x32_bf16 a[88:91], v[184:187], v[136:139], a[88:91]
    v_mfma_f32_16x16x32_bf16 a[120:123], v[184:187], v[140:143], a[120:123]
    v_mfma_f32_16x16x32_bf16 a[152:155], v[184:187], v[144:147], a[152:155]
    s_add_u32 m0, s19, 71680
    v_mfma_f32_16x16x32_bf16 a[184:187], v[184:187], v[148:151], a[184:187]
    buffer_load_dwordx4 v30, s[12:15], s17 offen  lds
    v_mfma_f32_16x16x32_bf16 a[216:219], v[184:187], v[152:155], a[216:219]
    v_mfma_f32_16x16x32_bf16 a[248:251], v[184:187], v[156:159], a[248:251]
    v_mfma_f32_16x16x32_bf16 a[28:31], v[188:191], v[128:131], a[28:31]
    s_add_u32 m0, s18, 72704
    v_mfma_f32_16x16x32_bf16 a[60:63], v[188:191], v[132:135], a[60:63]
    buffer_load_dwordx4 v23, s[8:11], s16 offen sc1 lds
    v_mfma_f32_16x16x32_bf16 a[92:95], v[188:191], v[136:139], a[92:95]
    v_mfma_f32_16x16x32_bf16 a[124:127], v[188:191], v[140:143], a[124:127]
    v_mfma_f32_16x16x32_bf16 a[156:159], v[188:191], v[144:147], a[156:159]
    s_add_u32 m0, s19, 72704
    v_mfma_f32_16x16x32_bf16 a[188:191], v[188:191], v[148:151], a[188:191]
    buffer_load_dwordx4 v31, s[12:15], s17 offen  lds
    v_mfma_f32_16x16x32_bf16 a[220:223], v[188:191], v[152:155], a[220:223]
    v_mfma_f32_16x16x32_bf16 a[252:255], v[188:191], v[156:159], a[252:255]
    s_waitcnt lgkmcnt(0)
    s_add_u32 s16, s16, 128
    s_add_u32 s17, s17, 458752
    v_mfma_f32_16x16x32_bf16 a[0:3], v[96:99], v[64:67], a[0:3]
    ds_read_b64_tr_b16 v[160:161], v34 offset:8192
    v_mfma_f32_16x16x32_bf16 a[32:35], v[96:99], v[68:71], a[32:35]
    v_mfma_f32_16x16x32_bf16 a[64:67], v[96:99], v[72:75], a[64:67]
    ds_read_b64_tr_b16 v[162:163], v34 offset:9216
    v_mfma_f32_16x16x32_bf16 a[96:99], v[96:99], v[76:79], a[96:99]
    v_mfma_f32_16x16x32_bf16 a[128:131], v[96:99], v[80:83], a[128:131]
    ds_read_b128 v[128:131], v33 offset:0
    v_mfma_f32_16x16x32_bf16 a[160:163], v[96:99], v[84:87], a[160:163]
    v_mfma_f32_16x16x32_bf16 a[192:195], v[96:99], v[88:91], a[192:195]
    ds_read_b128 v[132:135], v33 offset:2048
    v_mfma_f32_16x16x32_bf16 a[224:227], v[96:99], v[92:95], a[224:227]
    v_mfma_f32_16x16x32_bf16 a[4:7], v[100:103], v[64:67], a[4:7]
    ds_read_b128 v[136:139], v33 offset:4096
    v_mfma_f32_16x16x32_bf16 a[36:39], v[100:103], v[68:71], a[36:39]
    v_mfma_f32_16x16x32_bf16 a[68:71], v[100:103], v[72:75], a[68:71]
    ds_read_b128 v[140:143], v33 offset:6144
    v_mfma_f32_16x16x32_bf16 a[100:103], v[100:103], v[76:79], a[100:103]
    v_mfma_f32_16x16x32_bf16 a[132:135], v[100:103], v[80:83], a[132:135]
    ds_read_b128 v[144:147], v33 offset:8192
    v_mfma_f32_16x16x32_bf16 a[164:167], v[100:103], v[84:87], a[164:167]
    v_mfma_f32_16x16x32_bf16 a[196:199], v[100:103], v[88:91], a[196:199]
    ds_read_b128 v[148:151], v33 offset:10240
    v_mfma_f32_16x16x32_bf16 a[228:231], v[100:103], v[92:95], a[228:231]
    v_mfma_f32_16x16x32_bf16 a[8:11], v[104:107], v[64:67], a[8:11]
    ds_read_b128 v[152:155], v33 offset:12288
    v_mfma_f32_16x16x32_bf16 a[40:43], v[104:107], v[68:71], a[40:43]
    v_mfma_f32_16x16x32_bf16 a[72:75], v[104:107], v[72:75], a[72:75]
    ds_read_b128 v[156:159], v33 offset:14336
    v_mfma_f32_16x16x32_bf16 a[104:107], v[104:107], v[76:79], a[104:107]
    v_mfma_f32_16x16x32_bf16 a[136:139], v[104:107], v[80:83], a[136:139]
    ds_read_b64_tr_b16 v[164:165], v35 offset:8192
    v_mfma_f32_16x16x32_bf16 a[168:171], v[104:107], v[84:87], a[168:171]
    v_mfma_f32_16x16x32_bf16 a[200:203], v[104:107], v[88:91], a[200:203]
    ds_read_b64_tr_b16 v[166:167], v35 offset:9216
    v_mfma_f32_16x16x32_bf16 a[232:235], v[104:107], v[92:95], a[232:235]
    v_mfma_f32_16x16x32_bf16 a[12:15], v[108:111], v[64:67], a[12:15]
    ds_read_b64_tr_b16 v[168:169], v36 offset:8192
    v_mfma_f32_16x16x32_bf16 a[44:47], v[108:111], v[68:71], a[44:47]
    v_mfma_f32_16x16x32_bf16 a[76:79], v[108:111], v[72:75], a[76:79]
    ds_read_b64_tr_b16 v[170:171], v36 offset:9216
    v_mfma_f32_16x16x32_bf16 a[108:111], v[108:111], v[76:79], a[108:111]
    v_mfma_f32_16x16x32_bf16 a[140:143], v[108:111], v[80:83], a[140:143]
    ds_read_b64_tr_b16 v[172:173], v37 offset:8192
    v_mfma_f32_16x16x32_bf16 a[172:175], v[108:111], v[84:87], a[172:175]
    v_mfma_f32_16x16x32_bf16 a[204:207], v[108:111], v[88:91], a[204:207]
    ds_read_b64_tr_b16 v[174:175], v37 offset:9216
    v_mfma_f32_16x16x32_bf16 a[236:239], v[108:111], v[92:95], a[236:239]
    v_mfma_f32_16x16x32_bf16 a[16:19], v[112:115], v[64:67], a[16:19]
    ds_read_b64_tr_b16 v[176:177], v34 offset:24576
    v_mfma_f32_16x16x32_bf16 a[48:51], v[112:115], v[68:71], a[48:51]
    v_mfma_f32_16x16x32_bf16 a[80:83], v[112:115], v[72:75], a[80:83]
    ds_read_b64_tr_b16 v[178:179], v34 offset:25600
    v_mfma_f32_16x16x32_bf16 a[112:115], v[112:115], v[76:79], a[112:115]
    v_mfma_f32_16x16x32_bf16 a[144:147], v[112:115], v[80:83], a[144:147]
    ds_read_b64_tr_b16 v[180:181], v35 offset:24576
    v_mfma_f32_16x16x32_bf16 a[176:179], v[112:115], v[84:87], a[176:179]
    v_mfma_f32_16x16x32_bf16 a[208:211], v[112:115], v[88:91], a[208:211]
    ds_read_b64_tr_b16 v[182:183], v35 offset:25600
    v_mfma_f32_16x16x32_bf16 a[240:243], v[112:115], v[92:95], a[240:243]
    v_mfma_f32_16x16x32_bf16 a[20:23], v[116:119], v[64:67], a[20:23]
    ds_read_b64_tr_b16 v[184:185], v36 offset:24576
    v_mfma_f32_16x16x32_bf16 a[52:55], v[116:119], v[68:71], a[52:55]
    v_mfma_f32_16x16x32_bf16 a[84:87], v[116:119], v[72:75], a[84:87]
    ds_read_b64_tr_b16 v[186:187], v36 offset:25600
    v_mfma_f32_16x16x32_bf16 a[116:119], v[116:119], v[76:79], a[116:119]
    v_mfma_f32_16x16x32_bf16 a[148:151], v[116:119], v[80:83], a[148:151]
    ds_read_b64_tr_b16 v[188:189], v37 offset:24576
    v_mfma_f32_16x16x32_bf16 a[180:183], v[116:119], v[84:87], a[180:183]
    v_mfma_f32_16x16x32_bf16 a[212:215], v[116:119], v[88:91], a[212:215]
    ds_read_b64_tr_b16 v[190:191], v37 offset:25600
    v_mfma_f32_16x16x32_bf16 a[244:247], v[116:119], v[92:95], a[244:247]
    v_mfma_f32_16x16x32_bf16 a[24:27], v[120:123], v[64:67], a[24:27]
    v_mfma_f32_16x16x32_bf16 a[56:59], v[120:123], v[68:71], a[56:59]
    v_mfma_f32_16x16x32_bf16 a[88:91], v[120:123], v[72:75], a[88:91]
    v_mfma_f32_16x16x32_bf16 a[120:123], v[120:123], v[76:79], a[120:123]
    v_mfma_f32_16x16x32_bf16 a[152:155], v[120:123], v[80:83], a[152:155]
    v_mfma_f32_16x16x32_bf16 a[184:187], v[120:123], v[84:87], a[184:187]
    v_mfma_f32_16x16x32_bf16 a[216:219], v[120:123], v[88:91], a[216:219]
    v_mfma_f32_16x16x32_bf16 a[248:251], v[120:123], v[92:95], a[248:251]
    s_waitcnt vmcnt(0) lgkmcnt(0)
    s_barrier
    v_mfma_f32_16x16x32_bf16 a[28:31], v[124:127], v[64:67], a[28:31]
    v_mfma_f32_16x16x32_bf16 a[60:63], v[124:127], v[68:71], a[60:63]
    v_mfma_f32_16x16x32_bf16 a[92:95], v[124:127], v[72:75], a[92:95]
    v_mfma_f32_16x16x32_bf16 a[124:127], v[124:127], v[76:79], a[124:127]
    v_mfma_f32_16x16x32_bf16 a[156:159], v[124:127], v[80:83], a[156:159]
    v_mfma_f32_16x16x32_bf16 a[188:191], v[124:127], v[84:87], a[188:191]
    v_mfma_f32_16x16x32_bf16 a[220:223], v[124:127], v[88:91], a[220:223]
    v_mfma_f32_16x16x32_bf16 a[252:255], v[124:127], v[92:95], a[252:255]
    s_sub_u32 s20, s20, 1
    s_cmp_lg_u32 s20, 0
    s_cbranch_scc1 Ggu_156
    s_cmp_lg_u32 s3, 0
    s_cbranch_scc1 Ht_157
    v_mov_b32 v14, 1
    s_mov_b64 exec, 1
    buffer_atomic_add v14, off, s[92:95], s97 sc0 sc1
    s_mov_b64 exec, -1
Ht_157:
    s_waitcnt lgkmcnt(0)
    v_mfma_f32_16x16x32_bf16 a[0:3], v[160:163], v[128:131], a[0:3]
    ds_read_b64_tr_b16 v[96:97], v40 offset:0
    v_mfma_f32_16x16x32_bf16 a[32:35], v[160:163], v[132:135], a[32:35]
    v_mfma_f32_16x16x32_bf16 a[64:67], v[160:163], v[136:139], a[64:67]
    ds_read_b64_tr_b16 v[98:99], v40 offset:1024
    v_mfma_f32_16x16x32_bf16 a[96:99], v[160:163], v[140:143], a[96:99]
    v_mfma_f32_16x16x32_bf16 a[128:131], v[160:163], v[144:147], a[128:131]
    ds_read_b128 v[64:67], v38 offset:0
    v_mfma_f32_16x16x32_bf16 a[160:163], v[160:163], v[148:151], a[160:163]
    v_mfma_f32_16x16x32_bf16 a[192:195], v[160:163], v[152:155], a[192:195]
    ds_read_b128 v[68:71], v38 offset:2048
    v_mfma_f32_16x16x32_bf16 a[224:227], v[160:163], v[156:159], a[224:227]
    v_mfma_f32_16x16x32_bf16 a[4:7], v[164:167], v[128:131], a[4:7]
    ds_read_b128 v[72:75], v38 offset:4096
    v_mfma_f32_16x16x32_bf16 a[36:39], v[164:167], v[132:135], a[36:39]
    v_mfma_f32_16x16x32_bf16 a[68:71], v[164:167], v[136:139], a[68:71]
    ds_read_b128 v[76:79], v38 offset:6144
    v_mfma_f32_16x16x32_bf16 a[100:103], v[164:167], v[140:143], a[100:103]
    v_mfma_f32_16x16x32_bf16 a[132:135], v[164:167], v[144:147], a[132:135]
    ds_read_b128 v[80:83], v38 offset:8192
    v_mfma_f32_16x16x32_bf16 a[164:167], v[164:167], v[148:151], a[164:167]
    v_mfma_f32_16x16x32_bf16 a[196:199], v[164:167], v[152:155], a[196:199]
    ds_read_b128 v[84:87], v38 offset:10240
    v_mfma_f32_16x16x32_bf16 a[228:231], v[164:167], v[156:159], a[228:231]
    v_mfma_f32_16x16x32_bf16 a[8:11], v[168:171], v[128:131], a[8:11]
    ds_read_b128 v[88:91], v38 offset:12288
    v_mfma_f32_16x16x32_bf16 a[40:43], v[168:171], v[132:135], a[40:43]
    v_mfma_f32_16x16x32_bf16 a[72:75], v[168:171], v[136:139], a[72:75]
    ds_read_b128 v[92:95], v38 offset:14336
    v_mfma_f32_16x16x32_bf16 a[104:107], v[168:171], v[140:143], a[104:107]
    v_mfma_f32_16x16x32_bf16 a[136:139], v[168:171], v[144:147], a[136:139]
    ds_read_b64_tr_b16 v[100:101], v41 offset:0
    v_mfma_f32_16x16x32_bf16 a[168:171], v[168:171], v[148:151], a[168:171]
    v_mfma_f32_16x16x32_bf16 a[200:203], v[168:171], v[152:155], a[200:203]
    ds_read_b64_tr_b16 v[102:103], v41 offset:1024
    v_mfma_f32_16x16x32_bf16 a[232:235], v[168:171], v[156:159], a[232:235]
    v_mfma_f32_16x16x32_bf16 a[12:15], v[172:175], v[128:131], a[12:15]
    ds_read_b64_tr_b16 v[104:105], v42 offset:0
    v_mfma_f32_16x16x32_bf16 a[44:47], v[172:175], v[132:135], a[44:47]
    v_mfma_f32_16x16x32_bf16 a[76:79], v[172:175], v[136:139], a[76:79]
    ds_read_b64_tr_b16 v[106:107], v42 offset:1024
    v_mfma_f32_16x16x32_bf16 a[108:111], v[172:175], v[140:143], a[108:111]
    v_mfma_f32_16x16x32_bf16 a[140:143], v[172:175], v[144:147], a[140:143]
    ds_read_b64_tr_b16 v[108:109], v43 offset:0
    v_mfma_f32_16x16x32_bf16 a[172:175], v[172:175], v[148:151], a[172:175]
    v_mfma_f32_16x16x32_bf16 a[204:207], v[172:175], v[152:155], a[204:207]
    ds_read_b64_tr_b16 v[110:111], v43 offset:1024
    v_mfma_f32_16x16x32_bf16 a[236:239], v[172:175], v[156:159], a[236:239]
    v_mfma_f32_16x16x32_bf16 a[16:19], v[176:179], v[128:131], a[16:19]
    ds_read_b64_tr_b16 v[112:113], v40 offset:16384
    v_mfma_f32_16x16x32_bf16 a[48:51], v[176:179], v[132:135], a[48:51]
    v_mfma_f32_16x16x32_bf16 a[80:83], v[176:179], v[136:139], a[80:83]
    ds_read_b64_tr_b16 v[114:115], v40 offset:17408
    v_mfma_f32_16x16x32_bf16 a[112:115], v[176:179], v[140:143], a[112:115]
    v_mfma_f32_16x16x32_bf16 a[144:147], v[176:179], v[144:147], a[144:147]
    ds_read_b64_tr_b16 v[116:117], v41 offset:16384
    v_mfma_f32_16x16x32_bf16 a[176:179], v[176:179], v[148:151], a[176:179]
    v_mfma_f32_16x16x32_bf16 a[208:211], v[176:179], v[152:155], a[208:211]
    ds_read_b64_tr_b16 v[118:119], v41 offset:17408
    v_mfma_f32_16x16x32_bf16 a[240:243], v[176:179], v[156:159], a[240:243]
    v_mfma_f32_16x16x32_bf16 a[20:23], v[180:183], v[128:131], a[20:23]
    ds_read_b64_tr_b16 v[120:121], v42 offset:16384
    v_mfma_f32_16x16x32_bf16 a[52:55], v[180:183], v[132:135], a[52:55]
    v_mfma_f32_16x16x32_bf16 a[84:87], v[180:183], v[136:139], a[84:87]
    ds_read_b64_tr_b16 v[122:123], v42 offset:17408
    v_mfma_f32_16x16x32_bf16 a[116:119], v[180:183], v[140:143], a[116:119]
    v_mfma_f32_16x16x32_bf16 a[148:151], v[180:183], v[144:147], a[148:151]
    ds_read_b64_tr_b16 v[124:125], v43 offset:16384
    v_mfma_f32_16x16x32_bf16 a[180:183], v[180:183], v[148:151], a[180:183]
    v_mfma_f32_16x16x32_bf16 a[212:215], v[180:183], v[152:155], a[212:215]
    ds_read_b64_tr_b16 v[126:127], v43 offset:17408
    v_mfma_f32_16x16x32_bf16 a[244:247], v[180:183], v[156:159], a[244:247]
    v_mfma_f32_16x16x32_bf16 a[24:27], v[184:187], v[128:131], a[24:27]
    v_mfma_f32_16x16x32_bf16 a[56:59], v[184:187], v[132:135], a[56:59]
    v_mfma_f32_16x16x32_bf16 a[88:91], v[184:187], v[136:139], a[88:91]
    v_mfma_f32_16x16x32_bf16 a[120:123], v[184:187], v[140:143], a[120:123]
    v_mfma_f32_16x16x32_bf16 a[152:155], v[184:187], v[144:147], a[152:155]
    v_mfma_f32_16x16x32_bf16 a[184:187], v[184:187], v[148:151], a[184:187]
    v_mfma_f32_16x16x32_bf16 a[216:219], v[184:187], v[152:155], a[216:219]
    v_mfma_f32_16x16x32_bf16 a[248:251], v[184:187], v[156:159], a[248:251]
    v_mfma_f32_16x16x32_bf16 a[28:31], v[188:191], v[128:131], a[28:31]
    v_mfma_f32_16x16x32_bf16 a[60:63], v[188:191], v[132:135], a[60:63]
    v_mfma_f32_16x16x32_bf16 a[92:95], v[188:191], v[136:139], a[92:95]
    v_mfma_f32_16x16x32_bf16 a[124:127], v[188:191], v[140:143], a[124:127]
    v_mfma_f32_16x16x32_bf16 a[156:159], v[188:191], v[144:147], a[156:159]
    v_mfma_f32_16x16x32_bf16 a[188:191], v[188:191], v[148:151], a[188:191]
    v_mfma_f32_16x16x32_bf16 a[220:223], v[188:191], v[152:155], a[220:223]
    v_mfma_f32_16x16x32_bf16 a[252:255], v[188:191], v[156:159], a[252:255]
    s_waitcnt lgkmcnt(0)
    v_mfma_f32_16x16x32_bf16 a[0:3], v[96:99], v[64:67], a[0:3]
    ds_read_b64_tr_b16 v[160:161], v40 offset:8192
    v_mfma_f32_16x16x32_bf16 a[32:35], v[96:99], v[68:71], a[32:35]
    v_mfma_f32_16x16x32_bf16 a[64:67], v[96:99], v[72:75], a[64:67]
    ds_read_b64_tr_b16 v[162:163], v40 offset:9216
    v_mfma_f32_16x16x32_bf16 a[96:99], v[96:99], v[76:79], a[96:99]
    v_mfma_f32_16x16x32_bf16 a[128:131], v[96:99], v[80:83], a[128:131]
    ds_read_b128 v[128:131], v39 offset:0
    v_mfma_f32_16x16x32_bf16 a[160:163], v[96:99], v[84:87], a[160:163]
    v_mfma_f32_16x16x32_bf16 a[192:195], v[96:99], v[88:91], a[192:195]
    ds_read_b128 v[132:135], v39 offset:2048
    v_mfma_f32_16x16x32_bf16 a[224:227], v[96:99], v[92:95], a[224:227]
    v_mfma_f32_16x16x32_bf16 a[4:7], v[100:103], v[64:67], a[4:7]
    ds_read_b128 v[136:139], v39 offset:4096
    v_mfma_f32_16x16x32_bf16 a[36:39], v[100:103], v[68:71], a[36:39]
    v_mfma_f32_16x16x32_bf16 a[68:71], v[100:103], v[72:75], a[68:71]
    ds_read_b128 v[140:143], v39 offset:6144
    v_mfma_f32_16x16x32_bf16 a[100:103], v[100:103], v[76:79], a[100:103]
    v_mfma_f32_16x16x32_bf16 a[132:135], v[100:103], v[80:83], a[132:135]
    ds_read_b128 v[144:147], v39 offset:8192
    v_mfma_f32_16x16x32_bf16 a[164:167], v[100:103], v[84:87], a[164:167]
    v_mfma_f32_16x16x32_bf16 a[196:199], v[100:103], v[88:91], a[196:199]
    ds_read_b128 v[148:151], v39 offset:10240
    v_mfma_f32_16x16x32_bf16 a[228:231], v[100:103], v[92:95], a[228:231]
    v_mfma_f32_16x16x32_bf16 a[8:11], v[104:107], v[64:67], a[8:11]
    ds_read_b128 v[152:155], v39 offset:12288
    v_mfma_f32_16x16x32_bf16 a[40:43], v[104:107], v[68:71], a[40:43]
    v_mfma_f32_16x16x32_bf16 a[72:75], v[104:107], v[72:75], a[72:75]
    ds_read_b128 v[156:159], v39 offset:14336
    v_mfma_f32_16x16x32_bf16 a[104:107], v[104:107], v[76:79], a[104:107]
    v_mfma_f32_16x16x32_bf16 a[136:139], v[104:107], v[80:83], a[136:139]
    ds_read_b64_tr_b16 v[164:165], v41 offset:8192
    v_mfma_f32_16x16x32_bf16 a[168:171], v[104:107], v[84:87], a[168:171]
    v_mfma_f32_16x16x32_bf16 a[200:203], v[104:107], v[88:91], a[200:203]
    ds_read_b64_tr_b16 v[166:167], v41 offset:9216
    v_mfma_f32_16x16x32_bf16 a[232:235], v[104:107], v[92:95], a[232:235]
    v_mfma_f32_16x16x32_bf16 a[12:15], v[108:111], v[64:67], a[12:15]
    ds_read_b64_tr_b16 v[168:169], v42 offset:8192
    v_mfma_f32_16x16x32_bf16 a[44:47], v[108:111], v[68:71], a[44:47]
    v_mfma_f32_16x16x32_bf16 a[76:79], v[108:111], v[72:75], a[76:79]
    ds_read_b64_tr_b16 v[170:171], v42 offset:9216
    v_mfma_f32_16x16x32_bf16 a[108:111], v[108:111], v[76:79], a[108:111]
    v_mfma_f32_16x16x32_bf16 a[140:143], v[108:111], v[80:83], a[140:143]
    ds_read_b64_tr_b16 v[172:173], v43 offset:8192
    v_mfma_f32_16x16x32_bf16 a[172:175], v[108:111], v[84:87], a[172:175]
    v_mfma_f32_16x16x32_bf16 a[204:207], v[108:111], v[88:91], a[204:207]
    ds_read_b64_tr_b16 v[174:175], v43 offset:9216
    v_mfma_f32_16x16x32_bf16 a[236:239], v[108:111], v[92:95], a[236:239]
    v_mfma_f32_16x16x32_bf16 a[16:19], v[112:115], v[64:67], a[16:19]
    ds_read_b64_tr_b16 v[176:177], v40 offset:24576
    v_mfma_f32_16x16x32_bf16 a[48:51], v[112:115], v[68:71], a[48:51]
    v_mfma_f32_16x16x32_bf16 a[80:83], v[112:115], v[72:75], a[80:83]
    ds_read_b64_tr_b16 v[178:179], v40 offset:25600
    v_mfma_f32_16x16x32_bf16 a[112:115], v[112:115], v[76:79], a[112:115]
    v_mfma_f32_16x16x32_bf16 a[144:147], v[112:115], v[80:83], a[144:147]
    ds_read_b64_tr_b16 v[180:181], v41 offset:24576
    v_mfma_f32_16x16x32_bf16 a[176:179], v[112:115], v[84:87], a[176:179]
    v_mfma_f32_16x16x32_bf16 a[208:211], v[112:115], v[88:91], a[208:211]
    ds_read_b64_tr_b16 v[182:183], v41 offset:25600
    v_mfma_f32_16x16x32_bf16 a[240:243], v[112:115], v[92:95], a[240:243]
    v_mfma_f32_16x16x32_bf16 a[20:23], v[116:119], v[64:67], a[20:23]
    ds_read_b64_tr_b16 v[184:185], v42 offset:24576
    v_mfma_f32_16x16x32_bf16 a[52:55], v[116:119], v[68:71], a[52:55]
    v_mfma_f32_16x16x32_bf16 a[84:87], v[116:119], v[72:75], a[84:87]
    ds_read_b64_tr_b16 v[186:187], v42 offset:25600
    v_mfma_f32_16x16x32_bf16 a[116:119], v[116:119], v[76:79], a[116:119]
    v_mfma_f32_16x16x32_bf16 a[148:151], v[116:119], v[80:83], a[148:151]
    ds_read_b64_tr_b16 v[188:189], v43 offset:24576
    v_mfma_f32_16x16x32_bf16 a[180:183], v[116:119], v[84:87], a[180:183]
    v_mfma_f32_16x16x32_bf16 a[212:215], v[116:119], v[88:91], a[212:215]
    ds_read_b64_tr_b16 v[190:191], v43 offset:25600
    v_mfma_f32_16x16x32_bf16 a[244:247], v[116:119], v[92:95], a[244:247]
    v_mfma_f32_16x16x32_bf16 a[24:27], v[120:123], v[64:67], a[24:27]
    v_mfma_f32_16x16x32_bf16 a[56:59], v[120:123], v[68:71], a[56:59]
    v_mfma_f32_16x16x32_bf16 a[88:91], v[120:123], v[72:75], a[88:91]
    v_mfma_f32_16x16x32_bf16 a[120:123], v[120:123], v[76:79], a[120:123]
    v_mfma_f32_16x16x32_bf16 a[152:155], v[120:123], v[80:83], a[152:155]
    v_mfma_f32_16x16x32_bf16 a[184:187], v[120:123], v[84:87], a[184:187]
    v_mfma_f32_16x16x32_bf16 a[216:219], v[120:123], v[88:91], a[216:219]
    v_mfma_f32_16x16x32_bf16 a[248:251], v[120:123], v[92:95], a[248:251]
    s_waitcnt lgkmcnt(0)
    s_barrier
    v_mfma_f32_16x16x32_bf16 a[28:31], v[124:127], v[64:67], a[28:31]
    v_mfma_f32_16x16x32_bf16 a[60:63], v[124:127], v[68:71], a[60:63]
    v_mfma_f32_16x16x32_bf16 a[92:95], v[124:127], v[72:75], a[92:95]
    v_mfma_f32_16x16x32_bf16 a[124:127], v[124:127], v[76:79], a[124:127]
    v_mfma_f32_16x16x32_bf16 a[156:159], v[124:127], v[80:83], a[156:159]
    v_mfma_f32_16x16x32_bf16 a[188:191], v[124:127], v[84:87], a[188:191]
    v_mfma_f32_16x16x32_bf16 a[220:223], v[124:127], v[88:91], a[220:223]
    v_mfma_f32_16x16x32_bf16 a[252:255], v[124:127], v[92:95], a[252:255]
    s_waitcnt lgkmcnt(0)
    v_mfma_f32_16x16x32_bf16 a[0:3], v[160:163], v[128:131], a[0:3]
    v_mfma_f32_16x16x32_bf16 a[32:35], v[160:163], v[132:135], a[32:35]
    v_mfma_f32_16x16x32_bf16 a[64:67], v[160:163], v[136:139], a[64:67]
    v_mfma_f32_16x16x32_bf16 a[96:99], v[160:163], v[140:143], a[96:99]
    v_mfma_f32_16x16x32_bf16 a[128:131], v[160:163], v[144:147], a[128:131]
    v_mfma_f32_16x16x32_bf16 a[160:163], v[160:163], v[148:151], a[160:163]
    v_mfma_f32_16x16x32_bf16 a[192:195], v[160:163], v[152:155], a[192:195]
    v_mfma_f32_16x16x32_bf16 a[224:227], v[160:163], v[156:159], a[224:227]
    v_mfma_f32_16x16x32_bf16 a[4:7], v[164:167], v[128:131], a[4:7]
    v_mfma_f32_16x16x32_bf16 a[36:39], v[164:167], v[132:135], a[36:39]
    v_mfma_f32_16x16x32_bf16 a[68:71], v[164:167], v[136:139], a[68:71]
    v_mfma_f32_16x16x32_bf16 a[100:103], v[164:167], v[140:143], a[100:103]
    v_mfma_f32_16x16x32_bf16 a[132:135], v[164:167], v[144:147], a[132:135]
    v_mfma_f32_16x16x32_bf16 a[164:167], v[164:167], v[148:151], a[164:167]
    v_mfma_f32_16x16x32_bf16 a[196:199], v[164:167], v[152:155], a[196:199]
    v_mfma_f32_16x16x32_bf16 a[228:231], v[164:167], v[156:159], a[228:231]
    v_mfma_f32_16x16x32_bf16 a[8:11], v[168:171], v[128:131], a[8:11]
    v_mfma_f32_16x16x32_bf16 a[40:43], v[168:171], v[132:135], a[40:43]
    v_mfma_f32_16x16x32_bf16 a[72:75], v[168:171], v[136:139], a[72:75]
    v_mfma_f32_16x16x32_bf16 a[104:107], v[168:171], v[140:143], a[104:107]
    v_mfma_f32_16x16x32_bf16 a[136:139], v[168:171], v[144:147], a[136:139]
    v_mfma_f32_16x16x32_bf16 a[168:171], v[168:171], v[148:151], a[168:171]
    v_mfma_f32_16x16x32_bf16 a[200:203], v[168:171], v[152:155], a[200:203]
    v_mfma_f32_16x16x32_bf16 a[232:235], v[168:171], v[156:159], a[232:235]
    v_mfma_f32_16x16x32_bf16 a[12:15], v[172:175], v[128:131], a[12:15]
    v_mfma_f32_16x16x32_bf16 a[44:47], v[172:175], v[132:135], a[44:47]
    v_mfma_f32_16x16x32_bf16 a[76:79], v[172:175], v[136:139], a[76:79]
    v_mfma_f32_16x16x32_bf16 a[108:111], v[172:175], v[140:143], a[108:111]
    v_mfma_f32_16x16x32_bf16 a[140:143], v[172:175], v[144:147], a[140:143]
    v_mfma_f32_16x16x32_bf16 a[172:175], v[172:175], v[148:151], a[172:175]
    v_mfma_f32_16x16x32_bf16 a[204:207], v[172:175], v[152:155], a[204:207]
    v_mfma_f32_16x16x32_bf16 a[236:239], v[172:175], v[156:159], a[236:239]
    v_mfma_f32_16x16x32_bf16 a[16:19], v[176:179], v[128:131], a[16:19]
    v_mfma_f32_16x16x32_bf16 a[48:51], v[176:179], v[132:135], a[48:51]
    v_mfma_f32_16x16x32_bf16 a[80:83], v[176:179], v[136:139], a[80:83]
    v_mfma_f32_16x16x32_bf16 a[112:115], v[176:179], v[140:143], a[112:115]
    v_mfma_f32_16x16x32_bf16 a[144:147], v[176:179], v[144:147], a[144:147]
    v_mfma_f32_16x16x32_bf16 a[176:179], v[176:179], v[148:151], a[176:179]
    v_mfma_f32_16x16x32_bf16 a[208:211], v[176:179], v[152:155], a[208:211]
    v_mfma_f32_16x16x32_bf16 a[240:243], v[176:179], v[156:159], a[240:243]
    v_mfma_f32_16x16x32_bf16 a[20:23], v[180:183], v[128:131], a[20:23]
    v_mfma_f32_16x16x32_bf16 a[52:55], v[180:183], v[132:135], a[52:55]
    v_mfma_f32_16x16x32_bf16 a[84:87], v[180:183], v[136:139], a[84:87]
    v_mfma_f32_16x16x32_bf16 a[116:119], v[180:183], v[140:143], a[116:119]
    v_mfma_f32_16x16x32_bf16 a[148:151], v[180:183], v[144:147], a[148:151]
    v_mfma_f32_16x16x32_bf16 a[180:183], v[180:183], v[148:151], a[180:183]
    v_mfma_f32_16x16x32_bf16 a[212:215], v[180:183], v[152:155], a[212:215]
    v_mfma_f32_16x16x32_bf16 a[244:247], v[180:183], v[156:159], a[244:247]
    v_mfma_f32_16x16x32_bf16 a[24:27], v[184:187], v[128:131], a[24:27]
    v_mfma_f32_16x16x32_bf16 a[56:59], v[184:187], v[132:135], a[56:59]
    v_mfma_f32_16x16x32_bf16 a[88:91], v[184:187], v[136:139], a[88:91]
    v_mfma_f32_16x16x32_bf16 a[120:123], v[184:187], v[140:143], a[120:123]
    v_mfma_f32_16x16x32_bf16 a[152:155], v[184:187], v[144:147], a[152:155]
    v_mfma_f32_16x16x32_bf16 a[184:187], v[184:187], v[148:151], a[184:187]
    v_mfma_f32_16x16x32_bf16 a[216:219], v[184:187], v[152:155], a[216:219]
    v_mfma_f32_16x16x32_bf16 a[248:251], v[184:187], v[156:159], a[248:251]
    v_mfma_f32_16x16x32_bf16 a[28:31], v[188:191], v[128:131], a[28:31]
    v_mfma_f32_16x16x32_bf16 a[60:63], v[188:191], v[132:135], a[60:63]
    v_mfma_f32_16x16x32_bf16 a[92:95], v[188:191], v[136:139], a[92:95]
    v_mfma_f32_16x16x32_bf16 a[124:127], v[188:191], v[140:143], a[124:127]
    v_mfma_f32_16x16x32_bf16 a[156:159], v[188:191], v[144:147], a[156:159]
    v_mfma_f32_16x16x32_bf16 a[188:191], v[188:191], v[148:151], a[188:191]
    v_mfma_f32_16x16x32_bf16 a[220:223], v[188:191], v[152:155], a[220:223]
    v_mfma_f32_16x16x32_bf16 a[252:255], v[188:191], v[156:159], a[252:255]
    s_cmp_lg_u32 s3, 0
    s_cbranch_scc1 Am_158
    s_waitcnt vmcnt(0)
    v_readfirstlane_b32 s25, v14
    s_nop 3
    s_add_u32 s25, s25, s83
    s_cmp_eq_u32 s98, 5
    s_cbranch_scc1 N_160
    s_cmp_eq_u32 s98, 4
    s_cbranch_scc1 N_159
    s_lshr_b32 s22, s25, 5
    s_and_b32 s25, s25, 31
    s_lshl_b32 s22, s22, 2
    s_add_u32 s22, s22, s98
    s_lshl_b32 s22, s22, 5
    s_add_u32 s25, s25, s22
N_159:
    s_cmp_lt_u32 s25, 768
    s_cselect_b32 s25, s25, 96
    s_cbranch_scc1 N_160_e
N_160:
    s_add_u32 s25, s25, 768
    s_cmp_lt_u32 s25, 864
N_160_e:
    s_cselect_b32 s39, 1, 0
    s_cselect_b32 s96, 1, 2
    v_mov_b32 v14, s25
    v_mov_b32 v15, 159744
    ds_write_b32 v15, v14
Am_158:
    s_mul_i32 s32, s36, 1867776
    s_lshl_b32 s33, s37, 10
    s_add_u32 s32, s32, s33
    s_add_u32 s78, s32, 55574528
    s_mov_b32 s82, 3
    s_lshl_b32 s68, s36, 7
    s_add_u32 s68, s68, 113247616
    s_mov_b32 s69, 1
    s_call_b64 s[4:5], L_epi
    s_branch L_next
L_epi:
    s_cmp_eq_u32 s82, 0
    s_cbranch_scc1 L_epi_ret
    s_cmp_eq_u32 s82, 2
    s_cbranch_scc1 L_epi2
    s_cmp_eq_u32 s82, 3
    s_cbranch_scc1 L_epi3
    s_nop 7
    v_lshlrev_b32 v2, 4, v1
    v_add_u32 v3, 4096, v2
    s_lshr_b32 s21, s3, 1
    s_mul_i32 s21, s21, 1048576
    s_and_b32 s22, s3, 1
    s_lshl_b32 s22, s22, 13
    s_add_u32 s21, s21, s22
    s_add_u32 s21, s21, s78
    v_accvgpr_read_b32 v132, a0
    v_accvgpr_read_b32 v133, a1
    v_accvgpr_read_b32 v134, a2
    v_accvgpr_read_b32 v135, a3
    v_accvgpr_read_b32 v136, a16
    v_accvgpr_read_b32 v137, a17
    v_accvgpr_read_b32 v138, a18
    v_accvgpr_read_b32 v139, a19
    v_cvt_pk_bf16_f32 v128, v132, v133
    v_cvt_pk_bf16_f32 v129, v134, v135
    v_cvt_pk_bf16_f32 v130, v136, v137
    v_cvt_pk_bf16_f32 v131, v138, v139
    buffer_store_dwordx4 v[128:131], v2, s[92:95], s21 offen offset:0 sc1
    v_accvgpr_read_b32 v144, a4
    v_accvgpr_read_b32 v145, a5
    v_accvgpr_read_b32 v146, a6
    v_accvgpr_read_b32 v147, a7
    v_accvgpr_read_b32 v148, a20
    v_accvgpr_read_b32 v149, a21
    v_accvgpr_read_b32 v150, a22
    v_accvgpr_read_b32 v151, a23
    v_cvt_pk_bf16_f32 v140, v144, v145
    v_cvt_pk_bf16_f32 v141, v146, v147
    v_cvt_pk_bf16_f32 v142, v148, v149
    v_cvt_pk_bf16_f32 v143, v150, v151
    buffer_store_dwordx4 v[140:143], v2, s[92:95], s21 offen offset:1024 sc1
    v_accvgpr_read_b32 v156, a8
    v_accvgpr_read_b32 v157, a9
    v_accvgpr_read_b32 v158, a10
    v_accvgpr_read_b32 v159, a11
    v_accvgpr_read_b32 v160, a24
    v_accvgpr_read_b32 v161, a25
    v_accvgpr_read_b32 v162, a26
    v_accvgpr_read_b32 v163, a27
    v_cvt_pk_bf16_f32 v152, v156, v157
    v_cvt_pk_bf16_f32 v153, v158, v159
    v_cvt_pk_bf16_f32 v154, v160, v161
    v_cvt_pk_bf16_f32 v155, v162, v163
    buffer_store_dwordx4 v[152:155], v2, s[92:95], s21 offen offset:2048 sc1
    v_accvgpr_read_b32 v168, a12
    v_accvgpr_read_b32 v169, a13
    v_accvgpr_read_b32 v170, a14
    v_accvgpr_read_b32 v171, a15
    v_accvgpr_read_b32 v172, a28
    v_accvgpr_read_b32 v173, a29
    v_accvgpr_read_b32 v174, a30
    v_accvgpr_read_b32 v175, a31
    v_cvt_pk_bf16_f32 v164, v168, v169
    v_cvt_pk_bf16_f32 v165, v170, v171
    v_cvt_pk_bf16_f32 v166, v172, v173
    v_cvt_pk_bf16_f32 v167, v174, v175
    buffer_store_dwordx4 v[164:167], v2, s[92:95], s21 offen offset:3072 sc1
    v_accvgpr_read_b32 v132, a32
    v_accvgpr_read_b32 v133, a33
    v_accvgpr_read_b32 v134, a34
    v_accvgpr_read_b32 v135, a35
    v_accvgpr_read_b32 v136, a48
    v_accvgpr_read_b32 v137, a49
    v_accvgpr_read_b32 v138, a50
    v_accvgpr_read_b32 v139, a51
    v_cvt_pk_bf16_f32 v128, v132, v133
    v_cvt_pk_bf16_f32 v129, v134, v135
    v_cvt_pk_bf16_f32 v130, v136, v137
    v_cvt_pk_bf16_f32 v131, v138, v139
    buffer_store_dwordx4 v[128:131], v3, s[92:95], s21 offen offset:0 sc1
    v_accvgpr_read_b32 v144, a36
    v_accvgpr_read_b32 v145, a37
    v_accvgpr_read_b32 v146, a38
    v_accvgpr_read_b32 v147, a39
    v_accvgpr_read_b32 v148, a52
    v_accvgpr_read_b32 v149, a53
    v_accvgpr_read_b32 v150, a54
    v_accvgpr_read_b32 v151, a55
    v_cvt_pk_bf16_f32 v140, v144, v145
    v_cvt_pk_bf16_f32 v141, v146, v147
    v_cvt_pk_bf16_f32 v142, v148, v149
    v_cvt_pk_bf16_f32 v143, v150, v151
    buffer_store_dwordx4 v[140:143], v3, s[92:95], s21 offen offset:1024 sc1
    v_accvgpr_read_b32 v156, a40
    v_accvgpr_read_b32 v157, a41
    v_accvgpr_read_b32 v158, a42
    v_accvgpr_read_b32 v159, a43
    v_accvgpr_read_b32 v160, a56
    v_accvgpr_read_b32 v161, a57
    v_accvgpr_read_b32 v162, a58
    v_accvgpr_read_b32 v163, a59
    v_cvt_pk_bf16_f32 v152, v156, v157
    v_cvt_pk_bf16_f32 v153, v158, v159
    v_cvt_pk_bf16_f32 v154, v160, v161
    v_cvt_pk_bf16_f32 v155, v162, v163
    buffer_store_dwordx4 v[152:155], v3, s[92:95], s21 offen offset:2048 sc1
    v_accvgpr_read_b32 v168, a44
    v_accvgpr_read_b32 v169, a45
    v_accvgpr_read_b32 v170, a46
    v_accvgpr_read_b32 v171, a47
    v_accvgpr_read_b32 v172, a60
    v_accvgpr_read_b32 v173, a61
    v_accvgpr_read_b32 v174, a62
    v_accvgpr_read_b32 v175, a63
    v_cvt_pk_bf16_f32 v164, v168, v169
    v_cvt_pk_bf16_f32 v165, v170, v171
    v_cvt_pk_bf16_f32 v166, v172, v173
    v_cvt_pk_bf16_f32 v167, v174, v175
    buffer_store_dwordx4 v[164:167], v3, s[92:95], s21 offen offset:3072 sc1
    s_add_u32 s21, s21, 262144
    v_accvgpr_read_b32 v132, a64
    v_accvgpr_read_b32 v133, a65
    v_accvgpr_read_b32 v134, a66
    v_accvgpr_read_b32 v135, a67
    v_accvgpr_read_b32 v136, a80
    v_accvgpr_read_b32 v137, a81
    v_accvgpr_read_b32 v138, a82
    v_accvgpr_read_b32 v139, a83
    v_cvt_pk_bf16_f32 v128, v132, v133
    v_cvt_pk_bf16_f32 v129, v134, v135
    v_cvt_pk_bf16_f32 v130, v136, v137
    v_cvt_pk_bf16_f32 v131, v138, v139
    buffer_store_dwordx4 v[128:131], v2, s[92:95], s21 offen offset:0 sc1
    v_accvgpr_read_b32 v144, a68
    v_accvgpr_read_b32 v145, a69
    v_accvgpr_read_b32 v146, a70
    v_accvgpr_read_b32 v147, a71
    v_accvgpr_read_b32 v148, a84
    v_accvgpr_read_b32 v149, a85
    v_accvgpr_read_b32 v150, a86
    v_accvgpr_read_b32 v151, a87
    v_cvt_pk_bf16_f32 v140, v144, v145
    v_cvt_pk_bf16_f32 v141, v146, v147
    v_cvt_pk_bf16_f32 v142, v148, v149
    v_cvt_pk_bf16_f32 v143, v150, v151
    buffer_store_dwordx4 v[140:143], v2, s[92:95], s21 offen offset:1024 sc1
    v_accvgpr_read_b32 v156, a72
    v_accvgpr_read_b32 v157, a73
    v_accvgpr_read_b32 v158, a74
    v_accvgpr_read_b32 v159, a75
    v_accvgpr_read_b32 v160, a88
    v_accvgpr_read_b32 v161, a89
    v_accvgpr_read_b32 v162, a90
    v_accvgpr_read_b32 v163, a91
    v_cvt_pk_bf16_f32 v152, v156, v157
    v_cvt_pk_bf16_f32 v153, v158, v159
    v_cvt_pk_bf16_f32 v154, v160, v161
    v_cvt_pk_bf16_f32 v155, v162, v163
    buffer_store_dwordx4 v[152:155], v2, s[92:95], s21 offen offset:2048 sc1
    v_accvgpr_read_b32 v168, a76
    v_accvgpr_read_b32 v169, a77
    v_accvgpr_read_b32 v170, a78
    v_accvgpr_read_b32 v171, a79
    v_accvgpr_read_b32 v172, a92
    v_accvgpr_read_b32 v173, a93
    v_accvgpr_read_b32 v174, a94
    v_accvgpr_read_b32 v175, a95
    v_cvt_pk_bf16_f32 v164, v168, v169
    v_cvt_pk_bf16_f32 v165, v170, v171
    v_cvt_pk_bf16_f32 v166, v172, v173
    v_cvt_pk_bf16_f32 v167, v174, v175
    buffer_store_dwordx4 v[164:167], v2, s[92:95], s21 offen offset:3072 sc1
    v_accvgpr_read_b32 v132, a96
    v_accvgpr_read_b32 v133, a97
    v_accvgpr_read_b32 v134, a98
    v_accvgpr_read_b32 v135, a99
    v_accvgpr_read_b32 v136, a112
    v_accvgpr_read_b32 v137, a113
    v_accvgpr_read_b32 v138, a114
    v_accvgpr_read_b32 v139, a115
    v_cvt_pk_bf16_f32 v128, v132, v133
    v_cvt_pk_bf16_f32 v129, v134, v135
    v_cvt_pk_bf16_f32 v130, v136, v137
    v_cvt_pk_bf16_f32 v131, v138, v139
    buffer_store_dwordx4 v[128:131], v3, s[92:95], s21 offen offset:0 sc1
    v_accvgpr_read_b32 v144, a100
    v_accvgpr_read_b32 v145, a101
    v_accvgpr_read_b32 v146, a102
    v_accvgpr_read_b32 v147, a103
    v_accvgpr_read_b32 v148, a116
    v_accvgpr_read_b32 v149, a117
    v_accvgpr_read_b32 v150, a118
    v_accvgpr_read_b32 v151, a119
    v_cvt_pk_bf16_f32 v140, v144, v145
    v_cvt_pk_bf16_f32 v141, v146, v147
    v_cvt_pk_bf16_f32 v142, v148, v149
    v_cvt_pk_bf16_f32 v143, v150, v151
    buffer_store_dwordx4 v[140:143], v3, s[92:95], s21 offen offset:1024 sc1
    v_accvgpr_read_b32 v156, a104
    v_accvgpr_read_b32 v157, a105
    v_accvgpr_read_b32 v158, a106
    v_accvgpr_read_b32 v159, a107
    v_accvgpr_read_b32 v160, a120
    v_accvgpr_read_b32 v161, a121
    v_accvgpr_read_b32 v162, a122
    v_accvgpr_read_b32 v163, a123
    v_cvt_pk_bf16_f32 v152, v156, v157
    v_cvt_pk_bf16_f32 v153, v158, v159
    v_cvt_pk_bf16_f32 v154, v160, v161
    v_cvt_pk_bf16_f32 v155, v162, v163
    buffer_store_dwordx4 v[152:155], v3, s[92:95], s21 offen offset:2048 sc1
    v_accvgpr_read_b32 v168, a108
    v_accvgpr_read_b32 v169, a109
    v_accvgpr_read_b32 v170, a110
    v_accvgpr_read_b32 v171, a111
    v_accvgpr_read_b32 v172, a124
    v_accvgpr_read_b32 v173, a125
    v_accvgpr_read_b32 v174, a126
    v_accvgpr_read_b32 v175, a127
    v_cvt_pk_bf16_f32 v164, v168, v169
    v_cvt_pk_bf16_f32 v165, v170, v171
    v_cvt_pk_bf16_f32 v166, v172, v173
    v_cvt_pk_bf16_f32 v167, v174, v175
    buffer_store_dwordx4 v[164:167], v3, s[92:95], s21 offen offset:3072 sc1
    s_add_u32 s21, s21, 262144
    v_accvgpr_read_b32 v132, a128
    v_accvgpr_read_b32 v133, a129
    v_accvgpr_read_b32 v134, a130
    v_accvgpr_read_b32 v135, a131
    v_accvgpr_read_b32 v136, a144
    v_accvgpr_read_b32 v137, a145
    v_accvgpr_read_b32 v138, a146
    v_accvgpr_read_b32 v139, a147
    v_cvt_pk_bf16_f32 v128, v132, v133
    v_cvt_pk_bf16_f32 v129, v134, v135
    v_cvt_pk_bf16_f32 v130, v136, v137
    v_cvt_pk_bf16_f32 v131, v138, v139
    buffer_store_dwordx4 v[128:131], v2, s[92:95], s21 offen offset:0 sc1
    v_accvgpr_read_b32 v144, a132
    v_accvgpr_read_b32 v145, a133
    v_accvgpr_read_b32 v146, a134
    v_accvgpr_read_b32 v147, a135
    v_accvgpr_read_b32 v148, a148
    v_accvgpr_read_b32 v149, a149
    v_accvgpr_read_b32 v150, a150
    v_accvgpr_read_b32 v151, a151
    v_cvt_pk_bf16_f32 v140, v144, v145
    v_cvt_pk_bf16_f32 v141, v146, v147
    v_cvt_pk_bf16_f32 v142, v148, v149
    v_cvt_pk_bf16_f32 v143, v150, v151
    buffer_store_dwordx4 v[140:143], v2, s[92:95], s21 offen offset:1024 sc1
    v_accvgpr_read_b32 v156, a136
    v_accvgpr_read_b32 v157, a137
    v_accvgpr_read_b32 v158, a138
    v_accvgpr_read_b32 v159, a139
    v_accvgpr_read_b32 v160, a152
    v_accvgpr_read_b32 v161, a153
    v_accvgpr_read_b32 v162, a154
    v_accvgpr_read_b32 v163, a155
    v_cvt_pk_bf16_f32 v152, v156, v157
    v_cvt_pk_bf16_f32 v153, v158, v159
    v_cvt_pk_bf16_f32 v154, v160, v161
    v_cvt_pk_bf16_f32 v155, v162, v163
    buffer_store_dwordx4 v[152:155], v2, s[92:95], s21 offen offset:2048 sc1
    v_accvgpr_read_b32 v168, a140
    v_accvgpr_read_b32 v169, a141
    v_accvgpr_read_b32 v170, a142
    v_accvgpr_read_b32 v171, a143
    v_accvgpr_read_b32 v172, a156
    v_accvgpr_read_b32 v173, a157
    v_accvgpr_read_b32 v174, a158
    v_accvgpr_read_b32 v175, a159
    v_cvt_pk_bf16_f32 v164, v168, v169
    v_cvt_pk_bf16_f32 v165, v170, v171
    v_cvt_pk_bf16_f32 v166, v172, v173
    v_cvt_pk_bf16_f32 v167, v174, v175
    buffer_store_dwordx4 v[164:167], v2, s[92:95], s21 offen offset:3072 sc1
    v_accvgpr_read_b32 v132, a160
    v_accvgpr_read_b32 v133, a161
    v_accvgpr_read_b32 v134, a162
    v_accvgpr_read_b32 v135, a163
    v_accvgpr_read_b32 v136, a176
    v_accvgpr_read_b32 v137, a177
    v_accvgpr_read_b32 v138, a178
    v_accvgpr_read_b32 v139, a179
    v_cvt_pk_bf16_f32 v128, v132, v133
    v_cvt_pk_bf16_f32 v129, v134, v135
    v_cvt_pk_bf16_f32 v130, v136, v137
    v_cvt_pk_bf16_f32 v131, v138, v139
    buffer_store_dwordx4 v[128:131], v3, s[92:95], s21 offen offset:0 sc1
    v_accvgpr_read_b32 v144, a164
    v_accvgpr_read_b32 v145, a165
    v_accvgpr_read_b32 v146, a166
    v_accvgpr_read_b32 v147, a167
    v_accvgpr_read_b32 v148, a180
    v_accvgpr_read_b32 v149, a181
    v_accvgpr_read_b32 v150, a182
    v_accvgpr_read_b32 v151, a183
    v_cvt_pk_bf16_f32 v140, v144, v145
    v_cvt_pk_bf16_f32 v141, v146, v147
    v_cvt_pk_bf16_f32 v142, v148, v149
    v_cvt_pk_bf16_f32 v143, v150, v151
    buffer_store_dwordx4 v[140:143], v3, s[92:95], s21 offen offset:1024 sc1
    v_accvgpr_read_b32 v156, a168
    v_accvgpr_read_b32 v157, a169
    v_accvgpr_read_b32 v158, a170
    v_accvgpr_read_b32 v159, a171
    v_accvgpr_read_b32 v160, a184
    v_accvgpr_read_b32 v161, a185
    v_accvgpr_read_b32 v162, a186
    v_accvgpr_read_b32 v163, a187
    v_cvt_pk_bf16_f32 v152, v156, v157
    v_cvt_pk_bf16_f32 v153, v158, v159
    v_cvt_pk_bf16_f32 v154, v160, v161
    v_cvt_pk_bf16_f32 v155, v162, v163
    buffer_store_dwordx4 v[152:155], v3, s[92:95], s21 offen offset:2048 sc1
    v_accvgpr_read_b32 v168, a172
    v_accvgpr_read_b32 v169, a173
    v_accvgpr_read_b32 v170, a174
    v_accvgpr_read_b32 v171, a175
    v_accvgpr_read_b32 v172, a188
    v_accvgpr_read_b32 v173, a189
    v_accvgpr_read_b32 v174, a190
    v_accvgpr_read_b32 v175, a191
    v_cvt_pk_bf16_f32 v164, v168, v169
    v_cvt_pk_bf16_f32 v165, v170, v171
    v_cvt_pk_bf16_f32 v166, v172, v173
    v_cvt_pk_bf16_f32 v167, v174, v175
    buffer_store_dwordx4 v[164:167], v3, s[92:95], s21 offen offset:3072 sc1
    s_add_u32 s21, s21, 262144
    v_accvgpr_read_b32 v132, a192
    v_accvgpr_read_b32 v133, a193
    v_accvgpr_read_b32 v134, a194
    v_accvgpr_read_b32 v135, a195
    v_accvgpr_read_b32 v136, a208
    v_accvgpr_read_b32 v137, a209
    v_accvgpr_read_b32 v138, a210
    v_accvgpr_read_b32 v139, a211
    v_cvt_pk_bf16_f32 v128, v132, v133
    v_cvt_pk_bf16_f32 v129, v134, v135
    v_cvt_pk_bf16_f32 v130, v136, v137
    v_cvt_pk_bf16_f32 v131, v138, v139
    buffer_store_dwordx4 v[128:131], v2, s[92:95], s21 offen offset:0 sc1
    v_accvgpr_read_b32 v144, a196
    v_accvgpr_read_b32 v145, a197
    v_accvgpr_read_b32 v146, a198
    v_accvgpr_read_b32 v147, a199
    v_accvgpr_read_b32 v148, a212
    v_accvgpr_read_b32 v149, a213
    v_accvgpr_read_b32 v150, a214
    v_accvgpr_read_b32 v151, a215
    v_cvt_pk_bf16_f32 v140, v144, v145
    v_cvt_pk_bf16_f32 v141, v146, v147
    v_cvt_pk_bf16_f32 v142, v148, v149
    v_cvt_pk_bf16_f32 v143, v150, v151
    buffer_store_dwordx4 v[140:143], v2, s[92:95], s21 offen offset:1024 sc1
    v_accvgpr_read_b32 v156, a200
    v_accvgpr_read_b32 v157, a201
    v_accvgpr_read_b32 v158, a202
    v_accvgpr_read_b32 v159, a203
    v_accvgpr_read_b32 v160, a216
    v_accvgpr_read_b32 v161, a217
    v_accvgpr_read_b32 v162, a218
    v_accvgpr_read_b32 v163, a219
    v_cvt_pk_bf16_f32 v152, v156, v157
    v_cvt_pk_bf16_f32 v153, v158, v159
    v_cvt_pk_bf16_f32 v154, v160, v161
    v_cvt_pk_bf16_f32 v155, v162, v163
    buffer_store_dwordx4 v[152:155], v2, s[92:95], s21 offen offset:2048 sc1
    v_accvgpr_read_b32 v168, a204
    v_accvgpr_read_b32 v169, a205
    v_accvgpr_read_b32 v170, a206
    v_accvgpr_read_b32 v171, a207
    v_accvgpr_read_b32 v172, a220
    v_accvgpr_read_b32 v173, a221
    v_accvgpr_read_b32 v174, a222
    v_accvgpr_read_b32 v175, a223
    v_cvt_pk_bf16_f32 v164, v168, v169
    v_cvt_pk_bf16_f32 v165, v170, v171
    v_cvt_pk_bf16_f32 v166, v172, v173
    v_cvt_pk_bf16_f32 v167, v174, v175
    buffer_store_dwordx4 v[164:167], v2, s[92:95], s21 offen offset:3072 sc1
    v_accvgpr_read_b32 v132, a224
    v_accvgpr_read_b32 v133, a225
    v_accvgpr_read_b32 v134, a226
    v_accvgpr_read_b32 v135, a227
    v_accvgpr_read_b32 v136, a240
    v_accvgpr_read_b32 v137, a241
    v_accvgpr_read_b32 v138, a242
    v_accvgpr_read_b32 v139, a243
    v_cvt_pk_bf16_f32 v128, v132, v133
    v_cvt_pk_bf16_f32 v129, v134, v135
    v_cvt_pk_bf16_f32 v130, v136, v137
    v_cvt_pk_bf16_f32 v131, v138, v139
    buffer_store_dwordx4 v[128:131], v3, s[92:95], s21 offen offset:0 sc1
    v_accvgpr_read_b32 v144, a228
    v_accvgpr_read_b32 v145, a229
    v_accvgpr_read_b32 v146, a230
    v_accvgpr_read_b32 v147, a231
    v_accvgpr_read_b32 v148, a244
    v_accvgpr_read_b32 v149, a245
    v_accvgpr_read_b32 v150, a246
    v_accvgpr_read_b32 v151, a247
    v_cvt_pk_bf16_f32 v140, v144, v145
    v_cvt_pk_bf16_f32 v141, v146, v147
    v_cvt_pk_bf16_f32 v142, v148, v149
    v_cvt_pk_bf16_f32 v143, v150, v151
    buffer_store_dwordx4 v[140:143], v3, s[92:95], s21 offen offset:1024 sc1
    v_accvgpr_read_b32 v156, a232
    v_accvgpr_read_b32 v157, a233
    v_accvgpr_read_b32 v158, a234
    v_accvgpr_read_b32 v159, a235
    v_accvgpr_read_b32 v160, a248
    v_accvgpr_read_b32 v161, a249
    v_accvgpr_read_b32 v162, a250
    v_accvgpr_read_b32 v163, a251
    v_cvt_pk_bf16_f32 v152, v156, v157
    v_cvt_pk_bf16_f32 v153, v158, v159
    v_cvt_pk_bf16_f32 v154, v160, v161
    v_cvt_pk_bf16_f32 v155, v162, v163
    buffer_store_dwordx4 v[152:155], v3, s[92:95], s21 offen offset:2048 sc1
    v_accvgpr_read_b32 v168, a236
    v_accvgpr_read_b32 v169, a237
    v_accvgpr_read_b32 v170, a238
    v_accvgpr_read_b32 v171, a239
    v_accvgpr_read_b32 v172, a252
    v_accvgpr_read_b32 v173, a253
    v_accvgpr_read_b32 v174, a254
    v_accvgpr_read_b32 v175, a255
    v_cvt_pk_bf16_f32 v164, v168, v169
    v_cvt_pk_bf16_f32 v165, v170, v171
    v_cvt_pk_bf16_f32 v166, v172, v173
    v_cvt_pk_bf16_f32 v167, v174, v175
    buffer_store_dwordx4 v[164:167], v3, s[92:95], s21 offen offset:3072 sc1
    s_branch L_epi_end
L_epi2:
    s_nop 7
    v_lshlrev_b32 v2, 4, v1
    v_add_u32 v3, 4096, v2
    s_lshr_b32 s21, s3, 1
    s_mul_i32 s21, s21, 1048576
    s_and_b32 s22, s3, 1
    s_lshl_b32 s22, s22, 13
    s_add_u32 s21, s21, s22
    s_add_u32 s21, s21, s78
    v_accvgpr_read_b32 v132, a0
    v_accvgpr_read_b32 v133, a1
    v_accvgpr_read_b32 v134, a2
    v_accvgpr_read_b32 v135, a3
    v_accvgpr_read_b32 v136, a32
    v_accvgpr_read_b32 v137, a33
    v_accvgpr_read_b32 v138, a34
    v_accvgpr_read_b32 v139, a35
    v_cvt_pk_bf16_f32 v128, v132, v133
    v_cvt_pk_bf16_f32 v129, v134, v135
    v_cvt_pk_bf16_f32 v130, v136, v137
    v_cvt_pk_bf16_f32 v131, v138, v139
    buffer_store_dwordx4 v[128:131], v2, s[92:95], s21 offen offset:0 sc1
    v_accvgpr_read_b32 v144, a4
    v_accvgpr_read_b32 v145, a5
    v_accvgpr_read_b32 v146, a6
    v_accvgpr_read_b32 v147, a7
    v_accvgpr_read_b32 v148, a36
    v_accvgpr_read_b32 v149, a37
    v_accvgpr_read_b32 v150, a38
    v_accvgpr_read_b32 v151, a39
    v_cvt_pk_bf16_f32 v140, v144, v145
    v_cvt_pk_bf16_f32 v141, v146, v147
    v_cvt_pk_bf16_f32 v142, v148, v149
    v_cvt_pk_bf16_f32 v143, v150, v151
    buffer_store_dwordx4 v[140:143], v2, s[92:95], s21 offen offset:1024 sc1
    v_accvgpr_read_b32 v156, a8
    v_accvgpr_read_b32 v157, a9
    v_accvgpr_read_b32 v158, a10
    v_accvgpr_read_b32 v159, a11
    v_accvgpr_read_b32 v160, a40
    v_accvgpr_read_b32 v161, a41
    v_accvgpr_read_b32 v162, a42
    v_accvgpr_read_b32 v163, a43
    v_cvt_pk_bf16_f32 v152, v156, v157
    v_cvt_pk_bf16_f32 v153, v158, v159
    v_cvt_pk_bf16_f32 v154, v160, v161
    v_cvt_pk_bf16_f32 v155, v162, v163
    buffer_store_dwordx4 v[152:155], v2, s[92:95], s21 offen offset:2048 sc1
    v_accvgpr_read_b32 v168, a12
    v_accvgpr_read_b32 v169, a13
    v_accvgpr_read_b32 v170, a14
    v_accvgpr_read_b32 v171, a15
    v_accvgpr_read_b32 v172, a44
    v_accvgpr_read_b32 v173, a45
    v_accvgpr_read_b32 v174, a46
    v_accvgpr_read_b32 v175, a47
    v_cvt_pk_bf16_f32 v164, v168, v169
    v_cvt_pk_bf16_f32 v165, v170, v171
    v_cvt_pk_bf16_f32 v166, v172, v173
    v_cvt_pk_bf16_f32 v167, v174, v175
    buffer_store_dwordx4 v[164:167], v2, s[92:95], s21 offen offset:3072 sc1
    v_accvgpr_read_b32 v132, a16
    v_accvgpr_read_b32 v133, a17
    v_accvgpr_read_b32 v134, a18
    v_accvgpr_read_b32 v135, a19
    v_accvgpr_read_b32 v136, a48
    v_accvgpr_read_b32 v137, a49
    v_accvgpr_read_b32 v138, a50
    v_accvgpr_read_b32 v139, a51
    v_cvt_pk_bf16_f32 v128, v132, v133
    v_cvt_pk_bf16_f32 v129, v134, v135
    v_cvt_pk_bf16_f32 v130, v136, v137
    v_cvt_pk_bf16_f32 v131, v138, v139
    buffer_store_dwordx4 v[128:131], v3, s[92:95], s21 offen offset:0 sc1
    v_accvgpr_read_b32 v144, a20
    v_accvgpr_read_b32 v145, a21
    v_accvgpr_read_b32 v146, a22
    v_accvgpr_read_b32 v147, a23
    v_accvgpr_read_b32 v148, a52
    v_accvgpr_read_b32 v149, a53
    v_accvgpr_read_b32 v150, a54
    v_accvgpr_read_b32 v151, a55
    v_cvt_pk_bf16_f32 v140, v144, v145
    v_cvt_pk_bf16_f32 v141, v146, v147
    v_cvt_pk_bf16_f32 v142, v148, v149
    v_cvt_pk_bf16_f32 v143, v150, v151
    buffer_store_dwordx4 v[140:143], v3, s[92:95], s21 offen offset:1024 sc1
    v_accvgpr_read_b32 v156, a24
    v_accvgpr_read_b32 v157, a25
    v_accvgpr_read_b32 v158, a26
    v_accvgpr_read_b32 v159, a27
    v_accvgpr_read_b32 v160, a56
    v_accvgpr_read_b32 v161, a57
    v_accvgpr_read_b32 v162, a58
    v_accvgpr_read_b32 v163, a59
    v_cvt_pk_bf16_f32 v152, v156, v157
    v_cvt_pk_bf16_f32 v153, v158, v159
    v_cvt_pk_bf16_f32 v154, v160, v161
    v_cvt_pk_bf16_f32 v155, v162, v163
    buffer_store_dwordx4 v[152:155], v3, s[92:95], s21 offen offset:2048 sc1
    v_accvgpr_read_b32 v168, a28
    v_accvgpr_read_b32 v169, a29
    v_accvgpr_read_b32 v170, a30
    v_accvgpr_read_b32 v171, a31
    v_accvgpr_read_b32 v172, a60
    v_accvgpr_read_b32 v173, a61
    v_accvgpr_read_b32 v174, a62
    v_accvgpr_read_b32 v175, a63
    v_cvt_pk_bf16_f32 v164, v168, v169
    v_cvt_pk_bf16_f32 v165, v170, v171
    v_cvt_pk_bf16_f32 v166, v172, v173
    v_cvt_pk_bf16_f32 v167, v174, v175
    buffer_store_dwordx4 v[164:167], v3, s[92:95], s21 offen offset:3072 sc1
    s_add_u32 s21, s21, 262144
    v_accvgpr_read_b32 v132, a64
    v_accvgpr_read_b32 v133, a65
    v_accvgpr_read_b32 v134, a66
    v_accvgpr_read_b32 v135, a67
    v_accvgpr_read_b32 v136, a96
    v_accvgpr_read_b32 v137, a97
    v_accvgpr_read_b32 v138, a98
    v_accvgpr_read_b32 v139, a99
    v_cvt_pk_bf16_f32 v128, v132, v133
    v_cvt_pk_bf16_f32 v129, v134, v135
    v_cvt_pk_bf16_f32 v130, v136, v137
    v_cvt_pk_bf16_f32 v131, v138, v139
    buffer_store_dwordx4 v[128:131], v2, s[92:95], s21 offen offset:0 sc1
    v_accvgpr_read_b32 v144, a68
    v_accvgpr_read_b32 v145, a69
    v_accvgpr_read_b32 v146, a70
    v_accvgpr_read_b32 v147, a71
    v_accvgpr_read_b32 v148, a100
    v_accvgpr_read_b32 v149, a101
    v_accvgpr_read_b32 v150, a102
    v_accvgpr_read_b32 v151, a103
    v_cvt_pk_bf16_f32 v140, v144, v145
    v_cvt_pk_bf16_f32 v141, v146, v147
    v_cvt_pk_bf16_f32 v142, v148, v149
    v_cvt_pk_bf16_f32 v143, v150, v151
    buffer_store_dwordx4 v[140:143], v2, s[92:95], s21 offen offset:1024 sc1
    v_accvgpr_read_b32 v156, a72
    v_accvgpr_read_b32 v157, a73
    v_accvgpr_read_b32 v158, a74
    v_accvgpr_read_b32 v159, a75
    v_accvgpr_read_b32 v160, a104
    v_accvgpr_read_b32 v161, a105
    v_accvgpr_read_b32 v162, a106
    v_accvgpr_read_b32 v163, a107
    v_cvt_pk_bf16_f32 v152, v156, v157
    v_cvt_pk_bf16_f32 v153, v158, v159
    v_cvt_pk_bf16_f32 v154, v160, v161
    v_cvt_pk_bf16_f32 v155, v162, v163
    buffer_store_dwordx4 v[152:155], v2, s[92:95], s21 offen offset:2048 sc1
    v_accvgpr_read_b32 v168, a76
    v_accvgpr_read_b32 v169, a77
    v_accvgpr_read_b32 v170, a78
    v_accvgpr_read_b32 v171, a79
    v_accvgpr_read_b32 v172, a108
    v_accvgpr_read_b32 v173, a109
    v_accvgpr_read_b32 v174, a110
    v_accvgpr_read_b32 v175, a111
    v_cvt_pk_bf16_f32 v164, v168, v169
    v_cvt_pk_bf16_f32 v165, v170, v171
    v_cvt_pk_bf16_f32 v166, v172, v173
    v_cvt_pk_bf16_f32 v167, v174, v175
    buffer_store_dwordx4 v[164:167], v2, s[92:95], s21 offen offset:3072 sc1
    v_accvgpr_read_b32 v132, a80
    v_accvgpr_read_b32 v133, a81
    v_accvgpr_read_b32 v134, a82
    v_accvgpr_read_b32 v135, a83
    v_accvgpr_read_b32 v136, a112
    v_accvgpr_read_b32 v137, a113
    v_accvgpr_read_b32 v138, a114
    v_accvgpr_read_b32 v139, a115
    v_cvt_pk_bf16_f32 v128, v132, v133
    v_cvt_pk_bf16_f32 v129, v134, v135
    v_cvt_pk_bf16_f32 v130, v136, v137
    v_cvt_pk_bf16_f32 v131, v138, v139
    buffer_store_dwordx4 v[128:131], v3, s[92:95], s21 offen offset:0 sc1
    v_accvgpr_read_b32 v144, a84
    v_accvgpr_read_b32 v145, a85
    v_accvgpr_read_b32 v146, a86
    v_accvgpr_read_b32 v147, a87
    v_accvgpr_read_b32 v148, a116
    v_accvgpr_read_b32 v149, a117
    v_accvgpr_read_b32 v150, a118
    v_accvgpr_read_b32 v151, a119
    v_cvt_pk_bf16_f32 v140, v144, v145
    v_cvt_pk_bf16_f32 v141, v146, v147
    v_cvt_pk_bf16_f32 v142, v148, v149
    v_cvt_pk_bf16_f32 v143, v150, v151
    buffer_store_dwordx4 v[140:143], v3, s[92:95], s21 offen offset:1024 sc1
    v_accvgpr_read_b32 v156, a88
    v_accvgpr_read_b32 v157, a89
    v_accvgpr_read_b32 v158, a90
    v_accvgpr_read_b32 v159, a91
    v_accvgpr_read_b32 v160, a120
    v_accvgpr_read_b32 v161, a121
    v_accvgpr_read_b32 v162, a122
    v_accvgpr_read_b32 v163, a123
    v_cvt_pk_bf16_f32 v152, v156, v157
    v_cvt_pk_bf16_f32 v153, v158, v159
    v_cvt_pk_bf16_f32 v154, v160, v161
    v_cvt_pk_bf16_f32 v155, v162, v163
    buffer_store_dwordx4 v[152:155], v3, s[92:95], s21 offen offset:2048 sc1
    v_accvgpr_read_b32 v168, a92
    v_accvgpr_read_b32 v169, a93
    v_accvgpr_read_b32 v170, a94
    v_accvgpr_read_b32 v171, a95
    v_accvgpr_read_b32 v172, a124
    v_accvgpr_read_b32 v173, a125
    v_accvgpr_read_b32 v174, a126
    v_accvgpr_read_b32 v175, a127
    v_cvt_pk_bf16_f32 v164, v168, v169
    v_cvt_pk_bf16_f32 v165, v170, v171
    v_cvt_pk_bf16_f32 v166, v172, v173
    v_cvt_pk_bf16_f32 v167, v174, v175
    buffer_store_dwordx4 v[164:167], v3, s[92:95], s21 offen offset:3072 sc1
    s_add_u32 s21, s21, 262144
    v_accvgpr_read_b32 v132, a128
    v_accvgpr_read_b32 v133, a129
    v_accvgpr_read_b32 v134, a130
    v_accvgpr_read_b32 v135, a131
    v_accvgpr_read_b32 v136, a160
    v_accvgpr_read_b32 v137, a161
    v_accvgpr_read_b32 v138, a162
    v_accvgpr_read_b32 v139, a163
    v_cvt_pk_bf16_f32 v128, v132, v133
    v_cvt_pk_bf16_f32 v129, v134, v135
    v_cvt_pk_bf16_f32 v130, v136, v137
    v_cvt_pk_bf16_f32 v131, v138, v139
    buffer_store_dwordx4 v[128:131], v2, s[92:95], s21 offen offset:0 sc1
    v_accvgpr_read_b32 v144, a132
    v_accvgpr_read_b32 v145, a133
    v_accvgpr_read_b32 v146, a134
    v_accvgpr_read_b32 v147, a135
    v_accvgpr_read_b32 v148, a164
    v_accvgpr_read_b32 v149, a165
    v_accvgpr_read_b32 v150, a166
    v_accvgpr_read_b32 v151, a167
    v_cvt_pk_bf16_f32 v140, v144, v145
    v_cvt_pk_bf16_f32 v141, v146, v147
    v_cvt_pk_bf16_f32 v142, v148, v149
    v_cvt_pk_bf16_f32 v143, v150, v151
    buffer_store_dwordx4 v[140:143], v2, s[92:95], s21 offen offset:1024 sc1
    v_accvgpr_read_b32 v156, a136
    v_accvgpr_read_b32 v157, a137
    v_accvgpr_read_b32 v158, a138
    v_accvgpr_read_b32 v159, a139
    v_accvgpr_read_b32 v160, a168
    v_accvgpr_read_b32 v161, a169
    v_accvgpr_read_b32 v162, a170
    v_accvgpr_read_b32 v163, a171
    v_cvt_pk_bf16_f32 v152, v156, v157
    v_cvt_pk_bf16_f32 v153, v158, v159
    v_cvt_pk_bf16_f32 v154, v160, v161
    v_cvt_pk_bf16_f32 v155, v162, v163
    buffer_store_dwordx4 v[152:155], v2, s[92:95], s21 offen offset:2048 sc1
    v_accvgpr_read_b32 v168, a140
    v_accvgpr_read_b32 v169, a141
    v_accvgpr_read_b32 v170, a142
    v_accvgpr_read_b32 v171, a143
    v_accvgpr_read_b32 v172, a172
    v_accvgpr_read_b32 v173, a173
    v_accvgpr_read_b32 v174, a174
    v_accvgpr_read_b32 v175, a175
    v_cvt_pk_bf16_f32 v164, v168, v169
    v_cvt_pk_bf16_f32 v165, v170, v171
    v_cvt_pk_bf16_f32 v166, v172, v173
    v_cvt_pk_bf16_f32 v167, v174, v175
    buffer_store_dwordx4 v[164:167], v2, s[92:95], s21 offen offset:3072 sc1
    v_accvgpr_read_b32 v132, a144
    v_accvgpr_read_b32 v133, a145
    v_accvgpr_read_b32 v134, a146
    v_accvgpr_read_b32 v135, a147
    v_accvgpr_read_b32 v136, a176
    v_accvgpr_read_b32 v137, a177
    v_accvgpr_read_b32 v138, a178
    v_accvgpr_read_b32 v139, a179
    v_cvt_pk_bf16_f32 v128, v132, v133
    v_cvt_pk_bf16_f32 v129, v134, v135
    v_cvt_pk_bf16_f32 v130, v136, v137
    v_cvt_pk_bf16_f32 v131, v138, v139
    buffer_store_dwordx4 v[128:131], v3, s[92:95], s21 offen offset:0 sc1
    v_accvgpr_read_b32 v144, a148
    v_accvgpr_read_b32 v145, a149
    v_accvgpr_read_b32 v146, a150
    v_accvgpr_read_b32 v147, a151
    v_accvgpr_read_b32 v148, a180
    v_accvgpr_read_b32 v149, a181
    v_accvgpr_read_b32 v150, a182
    v_accvgpr_read_b32 v151, a183
    v_cvt_pk_bf16_f32 v140, v144, v145
    v_cvt_pk_bf16_f32 v141, v146, v147
    v_cvt_pk_bf16_f32 v142, v148, v149
    v_cvt_pk_bf16_f32 v143, v150, v151
    buffer_store_dwordx4 v[140:143], v3, s[92:95], s21 offen offset:1024 sc1
    v_accvgpr_read_b32 v156, a152
    v_accvgpr_read_b32 v157, a153
    v_accvgpr_read_b32 v158, a154
    v_accvgpr_read_b32 v159, a155
    v_accvgpr_read_b32 v160, a184
    v_accvgpr_read_b32 v161, a185
    v_accvgpr_read_b32 v162, a186
    v_accvgpr_read_b32 v163, a187
    v_cvt_pk_bf16_f32 v152, v156, v157
    v_cvt_pk_bf16_f32 v153, v158, v159
    v_cvt_pk_bf16_f32 v154, v160, v161
    v_cvt_pk_bf16_f32 v155, v162, v163
    buffer_store_dwordx4 v[152:155], v3, s[92:95], s21 offen offset:2048 sc1
    v_accvgpr_read_b32 v168, a156
    v_accvgpr_read_b32 v169, a157
    v_accvgpr_read_b32 v170, a158
    v_accvgpr_read_b32 v171, a159
    v_accvgpr_read_b32 v172, a188
    v_accvgpr_read_b32 v173, a189
    v_accvgpr_read_b32 v174, a190
    v_accvgpr_read_b32 v175, a191
    v_cvt_pk_bf16_f32 v164, v168, v169
    v_cvt_pk_bf16_f32 v165, v170, v171
    v_cvt_pk_bf16_f32 v166, v172, v173
    v_cvt_pk_bf16_f32 v167, v174, v175
    buffer_store_dwordx4 v[164:167], v3, s[92:95], s21 offen offset:3072 sc1
    s_add_u32 s21, s21, 262144
    v_accvgpr_read_b32 v132, a192
    v_accvgpr_read_b32 v133, a193
    v_accvgpr_read_b32 v134, a194
    v_accvgpr_read_b32 v135, a195
    v_accvgpr_read_b32 v136, a224
    v_accvgpr_read_b32 v137, a225
    v_accvgpr_read_b32 v138, a226
    v_accvgpr_read_b32 v139, a227
    v_cvt_pk_bf16_f32 v128, v132, v133
    v_cvt_pk_bf16_f32 v129, v134, v135
    v_cvt_pk_bf16_f32 v130, v136, v137
    v_cvt_pk_bf16_f32 v131, v138, v139
    buffer_store_dwordx4 v[128:131], v2, s[92:95], s21 offen offset:0 sc1
    v_accvgpr_read_b32 v144, a196
    v_accvgpr_read_b32 v145, a197
    v_accvgpr_read_b32 v146, a198
    v_accvgpr_read_b32 v147, a199
    v_accvgpr_read_b32 v148, a228
    v_accvgpr_read_b32 v149, a229
    v_accvgpr_read_b32 v150, a230
    v_accvgpr_read_b32 v151, a231
    v_cvt_pk_bf16_f32 v140, v144, v145
    v_cvt_pk_bf16_f32 v141, v146, v147
    v_cvt_pk_bf16_f32 v142, v148, v149
    v_cvt_pk_bf16_f32 v143, v150, v151
    buffer_store_dwordx4 v[140:143], v2, s[92:95], s21 offen offset:1024 sc1
    v_accvgpr_read_b32 v156, a200
    v_accvgpr_read_b32 v157, a201
    v_accvgpr_read_b32 v158, a202
    v_accvgpr_read_b32 v159, a203
    v_accvgpr_read_b32 v160, a232
    v_accvgpr_read_b32 v161, a233
    v_accvgpr_read_b32 v162, a234
    v_accvgpr_read_b32 v163, a235
    v_cvt_pk_bf16_f32 v152, v156, v157
    v_cvt_pk_bf16_f32 v153, v158, v159
    v_cvt_pk_bf16_f32 v154, v160, v161
    v_cvt_pk_bf16_f32 v155, v162, v163
    buffer_store_dwordx4 v[152:155], v2, s[92:95], s21 offen offset:2048 sc1
    v_accvgpr_read_b32 v168, a204
    v_accvgpr_read_b32 v169, a205
    v_accvgpr_read_b32 v170, a206
    v_accvgpr_read_b32 v171, a207
    v_accvgpr_read_b32 v172, a236
    v_accvgpr_read_b32 v173, a237
    v_accvgpr_read_b32 v174, a238
    v_accvgpr_read_b32 v175, a239
    v_cvt_pk_bf16_f32 v164, v168, v169
    v_cvt_pk_bf16_f32 v165, v170, v171
    v_cvt_pk_bf16_f32 v166, v172, v173
    v_cvt_pk_bf16_f32 v167, v174, v175
    buffer_store_dwordx4 v[164:167], v2, s[92:95], s21 offen offset:3072 sc1
    v_accvgpr_read_b32 v132, a208
    v_accvgpr_read_b32 v133, a209
    v_accvgpr_read_b32 v134, a210
    v_accvgpr_read_b32 v135, a211
    v_accvgpr_read_b32 v136, a240
    v_accvgpr_read_b32 v137, a241
    v_accvgpr_read_b32 v138, a242
    v_accvgpr_read_b32 v139, a243
    v_cvt_pk_bf16_f32 v128, v132, v133
    v_cvt_pk_bf16_f32 v129, v134, v135
    v_cvt_pk_bf16_f32 v130, v136, v137
    v_cvt_pk_bf16_f32 v131, v138, v139
    buffer_store_dwordx4 v[128:131], v3, s[92:95], s21 offen offset:0 sc1
    v_accvgpr_read_b32 v144, a212
    v_accvgpr_read_b32 v145, a213
    v_accvgpr_read_b32 v146, a214
    v_accvgpr_read_b32 v147, a215
    v_accvgpr_read_b32 v148, a244
    v_accvgpr_read_b32 v149, a245
    v_accvgpr_read_b32 v150, a246
    v_accvgpr_read_b32 v151, a247
    v_cvt_pk_bf16_f32 v140, v144, v145
    v_cvt_pk_bf16_f32 v141, v146, v147
    v_cvt_pk_bf16_f32 v142, v148, v149
    v_cvt_pk_bf16_f32 v143, v150, v151
    buffer_store_dwordx4 v[140:143], v3, s[92:95], s21 offen offset:1024 sc1
    v_accvgpr_read_b32 v156, a216
    v_accvgpr_read_b32 v157, a217
    v_accvgpr_read_b32 v158, a218
    v_accvgpr_read_b32 v159, a219
    v_accvgpr_read_b32 v160, a248
    v_accvgpr_read_b32 v161, a249
    v_accvgpr_read_b32 v162, a250
    v_accvgpr_read_b32 v163, a251
    v_cvt_pk_bf16_f32 v152, v156, v157
    v_cvt_pk_bf16_f32 v153, v158, v159
    v_cvt_pk_bf16_f32 v154, v160, v161
    v_cvt_pk_bf16_f32 v155, v162, v163
    buffer_store_dwordx4 v[152:155], v3, s[92:95], s21 offen offset:2048 sc1
    v_accvgpr_read_b32 v168, a220
    v_accvgpr_read_b32 v169, a221
    v_accvgpr_read_b32 v170, a222
    v_accvgpr_read_b32 v171, a223
    v_accvgpr_read_b32 v172, a252
    v_accvgpr_read_b32 v173, a253
    v_accvgpr_read_b32 v174, a254
    v_accvgpr_read_b32 v175, a255
    v_cvt_pk_bf16_f32 v164, v168, v169
    v_cvt_pk_bf16_f32 v165, v170, v171
    v_cvt_pk_bf16_f32 v166, v172, v173
    v_cvt_pk_bf16_f32 v167, v174, v175
    buffer_store_dwordx4 v[164:167], v3, s[92:95], s21 offen offset:3072 sc1
    s_branch L_epi_end
L_epi3:
    s_nop 7
    v_bfe_u32 v2, v1, 2, 2
    s_mov_b32 s22, 29184
    v_mul_lo_u32 v2, v2, s22
    v_lshrrev_b32 v3, 5, v1
    v_lshl_add_u32 v2, v3, 7, v2
    v_and_b32 v3, 3, v1
    v_lshl_add_u32 v2, v3, 5, v2
    v_bfe_u32 v3, v1, 4, 1
    v_lshl_add_u32 v2, v3, 4, v2
    s_lshr_b32 s21, s3, 1
    s_mul_i32 s21, s21, 933888
    s_and_b32 s22, s3, 1
    s_lshl_b32 s22, s22, 9
    s_add_u32 s21, s21, s22
    s_add_u32 s21, s21, s78
    v_mov_b32 v4, 0xc0135761
    v_mov_b32 v5, 0xc0135761
    v_mov_b32 v6, 0xbdd2d3e8
    v_mov_b32 v7, 0xbdd2d3e8
    v_mov_b32 v8, 1.0
    v_mov_b32 v9, 1.0
    v_accvgpr_read_b32 v128, a0
    v_accvgpr_read_b32 v129, a1
    v_accvgpr_read_b32 v130, a2
    v_accvgpr_read_b32 v131, a3
    v_accvgpr_read_b32 v132, a4
    v_accvgpr_read_b32 v133, a5
    v_accvgpr_read_b32 v134, a6
    v_accvgpr_read_b32 v135, a7
    v_accvgpr_read_b32 v136, a16
    v_accvgpr_read_b32 v137, a17
    v_accvgpr_read_b32 v138, a18
    v_accvgpr_read_b32 v139, a19
    v_accvgpr_read_b32 v140, a20
    v_accvgpr_read_b32 v141, a21
    v_accvgpr_read_b32 v142, a22
    v_accvgpr_read_b32 v143, a23
    v_pk_mul_f32 v[144:145], v[128:129], v[128:129]
    v_pk_mul_f32 v[146:147], v[130:131], v[130:131]
    v_pk_mul_f32 v[148:149], v[132:133], v[132:133]
    v_pk_mul_f32 v[150:151], v[134:135], v[134:135]
    v_pk_fma_f32 v[144:145], v[144:145], v[6:7], v[4:5]
    v_pk_fma_f32 v[146:147], v[146:147], v[6:7], v[4:5]
    v_pk_fma_f32 v[148:149], v[148:149], v[6:7], v[4:5]
    v_pk_fma_f32 v[150:151], v[150:151], v[6:7], v[4:5]
    v_pk_mul_f32 v[144:145], v[144:145], v[128:129]
    v_pk_mul_f32 v[146:147], v[146:147], v[130:131]
    v_pk_mul_f32 v[148:149], v[148:149], v[132:133]
    v_pk_mul_f32 v[150:151], v[150:151], v[134:135]
    v_exp_f32 v144, v144
    v_exp_f32 v145, v145
    v_exp_f32 v146, v146
    v_exp_f32 v147, v147
    v_exp_f32 v148, v148
    v_exp_f32 v149, v149
    v_exp_f32 v150, v150
    v_exp_f32 v151, v151
    v_pk_mul_f32 v[128:129], v[128:129], v[136:137]
    v_pk_mul_f32 v[130:131], v[130:131], v[138:139]
    v_pk_mul_f32 v[132:133], v[132:133], v[140:141]
    v_pk_mul_f32 v[134:135], v[134:135], v[142:143]
    v_pk_add_f32 v[144:145], v[144:145], v[8:9]
    v_pk_add_f32 v[146:147], v[146:147], v[8:9]
    v_pk_add_f32 v[148:149], v[148:149], v[8:9]
    v_pk_add_f32 v[150:151], v[150:151], v[8:9]
    v_rcp_f32 v144, v144
    v_rcp_f32 v145, v145
    v_rcp_f32 v146, v146
    v_rcp_f32 v147, v147
    v_rcp_f32 v148, v148
    v_rcp_f32 v149, v149
    v_rcp_f32 v150, v150
    v_rcp_f32 v151, v151
    s_nop 0
    v_pk_mul_f32 v[128:129], v[128:129], v[144:145]
    v_pk_mul_f32 v[130:131], v[130:131], v[146:147]
    v_pk_mul_f32 v[132:133], v[132:133], v[148:149]
    v_pk_mul_f32 v[134:135], v[134:135], v[150:151]
    v_cvt_pk_bf16_f32 v160, v128, v129
    v_cvt_pk_bf16_f32 v161, v130, v131
    v_cvt_pk_bf16_f32 v162, v132, v133
    v_cvt_pk_bf16_f32 v163, v134, v135
    buffer_store_dwordx4 v[160:163], v2, s[92:95], s21 offen offset:0 sc1
    v_accvgpr_read_b32 v168, a8
    v_accvgpr_read_b32 v169, a9
    v_accvgpr_read_b32 v170, a10
    v_accvgpr_read_b32 v171, a11
    v_accvgpr_read_b32 v172, a12
    v_accvgpr_read_b32 v173, a13
    v_accvgpr_read_b32 v174, a14
    v_accvgpr_read_b32 v175, a15
    v_accvgpr_read_b32 v176, a24
    v_accvgpr_read_b32 v177, a25
    v_accvgpr_read_b32 v178, a26
    v_accvgpr_read_b32 v179, a27
    v_accvgpr_read_b32 v180, a28
    v_accvgpr_read_b32 v181, a29
    v_accvgpr_read_b32 v182, a30
    v_accvgpr_read_b32 v183, a31
    v_pk_mul_f32 v[184:185], v[168:169], v[168:169]
    v_pk_mul_f32 v[186:187], v[170:171], v[170:171]
    v_pk_mul_f32 v[188:189], v[172:173], v[172:173]
    v_pk_mul_f32 v[190:191], v[174:175], v[174:175]
    v_pk_fma_f32 v[184:185], v[184:185], v[6:7], v[4:5]
    v_pk_fma_f32 v[186:187], v[186:187], v[6:7], v[4:5]
    v_pk_fma_f32 v[188:189], v[188:189], v[6:7], v[4:5]
    v_pk_fma_f32 v[190:191], v[190:191], v[6:7], v[4:5]
    v_pk_mul_f32 v[184:185], v[184:185], v[168:169]
    v_pk_mul_f32 v[186:187], v[186:187], v[170:171]
    v_pk_mul_f32 v[188:189], v[188:189], v[172:173]
    v_pk_mul_f32 v[190:191], v[190:191], v[174:175]
    v_exp_f32 v184, v184
    v_exp_f32 v185, v185
    v_exp_f32 v186, v186
    v_exp_f32 v187, v187
    v_exp_f32 v188, v188
    v_exp_f32 v189, v189
    v_exp_f32 v190, v190
    v_exp_f32 v191, v191
    v_pk_mul_f32 v[168:169], v[168:169], v[176:177]
    v_pk_mul_f32 v[170:171], v[170:171], v[178:179]
    v_pk_mul_f32 v[172:173], v[172:173], v[180:181]
    v_pk_mul_f32 v[174:175], v[174:175], v[182:183]
    v_pk_add_f32 v[184:185], v[184:185], v[8:9]
    v_pk_add_f32 v[186:187], v[186:187], v[8:9]
    v_pk_add_f32 v[188:189], v[188:189], v[8:9]
    v_pk_add_f32 v[190:191], v[190:191], v[8:9]
    v_rcp_f32 v184, v184
    v_rcp_f32 v185, v185
    v_rcp_f32 v186, v186
    v_rcp_f32 v187, v187
    v_rcp_f32 v188, v188
    v_rcp_f32 v189, v189
    v_rcp_f32 v190, v190
    v_rcp_f32 v191, v191
    s_nop 0
    v_pk_mul_f32 v[168:169], v[168:169], v[184:185]
    v_pk_mul_f32 v[170:171], v[170:171], v[186:187]
    v_pk_mul_f32 v[172:173], v[172:173], v[188:189]
    v_pk_mul_f32 v[174:175], v[174:175], v[190:191]
    v_cvt_pk_bf16_f32 v200, v168, v169
    v_cvt_pk_bf16_f32 v201, v170, v171
    v_cvt_pk_bf16_f32 v202, v172, v173
    v_cvt_pk_bf16_f32 v203, v174, v175
    buffer_store_dwordx4 v[200:203], v2, s[92:95], s21 offen offset:256 sc1
    s_add_u32 s21, s21, 116736
    v_accvgpr_read_b32 v128, a32
    v_accvgpr_read_b32 v129, a33
    v_accvgpr_read_b32 v130, a34
    v_accvgpr_read_b32 v131, a35
    v_accvgpr_read_b32 v132, a36
    v_accvgpr_read_b32 v133, a37
    v_accvgpr_read_b32 v134, a38
    v_accvgpr_read_b32 v135, a39
    v_accvgpr_read_b32 v136, a48
    v_accvgpr_read_b32 v137, a49
    v_accvgpr_read_b32 v138, a50
    v_accvgpr_read_b32 v139, a51
    v_accvgpr_read_b32 v140, a52
    v_accvgpr_read_b32 v141, a53
    v_accvgpr_read_b32 v142, a54
    v_accvgpr_read_b32 v143, a55
    v_pk_mul_f32 v[144:145], v[128:129], v[128:129]
    v_pk_mul_f32 v[146:147], v[130:131], v[130:131]
    v_pk_mul_f32 v[148:149], v[132:133], v[132:133]
    v_pk_mul_f32 v[150:151], v[134:135], v[134:135]
    v_pk_fma_f32 v[144:145], v[144:145], v[6:7], v[4:5]
    v_pk_fma_f32 v[146:147], v[146:147], v[6:7], v[4:5]
    v_pk_fma_f32 v[148:149], v[148:149], v[6:7], v[4:5]
    v_pk_fma_f32 v[150:151], v[150:151], v[6:7], v[4:5]
    v_pk_mul_f32 v[144:145], v[144:145], v[128:129]
    v_pk_mul_f32 v[146:147], v[146:147], v[130:131]
    v_pk_mul_f32 v[148:149], v[148:149], v[132:133]
    v_pk_mul_f32 v[150:151], v[150:151], v[134:135]
    v_exp_f32 v144, v144
    v_exp_f32 v145, v145
    v_exp_f32 v146, v146
    v_exp_f32 v147, v147
    v_exp_f32 v148, v148
    v_exp_f32 v149, v149
    v_exp_f32 v150, v150
    v_exp_f32 v151, v151
    v_pk_mul_f32 v[128:129], v[128:129], v[136:137]
    v_pk_mul_f32 v[130:131], v[130:131], v[138:139]
    v_pk_mul_f32 v[132:133], v[132:133], v[140:141]
    v_pk_mul_f32 v[134:135], v[134:135], v[142:143]
    v_pk_add_f32 v[144:145], v[144:145], v[8:9]
    v_pk_add_f32 v[146:147], v[146:147], v[8:9]
    v_pk_add_f32 v[148:149], v[148:149], v[8:9]
    v_pk_add_f32 v[150:151], v[150:151], v[8:9]
    v_rcp_f32 v144, v144
    v_rcp_f32 v145, v145
    v_rcp_f32 v146, v146
    v_rcp_f32 v147, v147
    v_rcp_f32 v148, v148
    v_rcp_f32 v149, v149
    v_rcp_f32 v150, v150
    v_rcp_f32 v151, v151
    s_nop 0
    v_pk_mul_f32 v[128:129], v[128:129], v[144:145]
    v_pk_mul_f32 v[130:131], v[130:131], v[146:147]
    v_pk_mul_f32 v[132:133], v[132:133], v[148:149]
    v_pk_mul_f32 v[134:135], v[134:135], v[150:151]
    v_cvt_pk_bf16_f32 v160, v128, v129
    v_cvt_pk_bf16_f32 v161, v130, v131
    v_cvt_pk_bf16_f32 v162, v132, v133
    v_cvt_pk_bf16_f32 v163, v134, v135
    buffer_store_dwordx4 v[160:163], v2, s[92:95], s21 offen offset:0 sc1
    v_accvgpr_read_b32 v168, a40
    v_accvgpr_read_b32 v169, a41
    v_accvgpr_read_b32 v170, a42
    v_accvgpr_read_b32 v171, a43
    v_accvgpr_read_b32 v172, a44
    v_accvgpr_read_b32 v173, a45
    v_accvgpr_read_b32 v174, a46
    v_accvgpr_read_b32 v175, a47
    v_accvgpr_read_b32 v176, a56
    v_accvgpr_read_b32 v177, a57
    v_accvgpr_read_b32 v178, a58
    v_accvgpr_read_b32 v179, a59
    v_accvgpr_read_b32 v180, a60
    v_accvgpr_read_b32 v181, a61
    v_accvgpr_read_b32 v182, a62
    v_accvgpr_read_b32 v183, a63
    v_pk_mul_f32 v[184:185], v[168:169], v[168:169]
    v_pk_mul_f32 v[186:187], v[170:171], v[170:171]
    v_pk_mul_f32 v[188:189], v[172:173], v[172:173]
    v_pk_mul_f32 v[190:191], v[174:175], v[174:175]
    v_pk_fma_f32 v[184:185], v[184:185], v[6:7], v[4:5]
    v_pk_fma_f32 v[186:187], v[186:187], v[6:7], v[4:5]
    v_pk_fma_f32 v[188:189], v[188:189], v[6:7], v[4:5]
    v_pk_fma_f32 v[190:191], v[190:191], v[6:7], v[4:5]
    v_pk_mul_f32 v[184:185], v[184:185], v[168:169]
    v_pk_mul_f32 v[186:187], v[186:187], v[170:171]
    v_pk_mul_f32 v[188:189], v[188:189], v[172:173]
    v_pk_mul_f32 v[190:191], v[190:191], v[174:175]
    v_exp_f32 v184, v184
    v_exp_f32 v185, v185
    v_exp_f32 v186, v186
    v_exp_f32 v187, v187
    v_exp_f32 v188, v188
    v_exp_f32 v189, v189
    v_exp_f32 v190, v190
    v_exp_f32 v191, v191
    v_pk_mul_f32 v[168:169], v[168:169], v[176:177]
    v_pk_mul_f32 v[170:171], v[170:171], v[178:179]
    v_pk_mul_f32 v[172:173], v[172:173], v[180:181]
    v_pk_mul_f32 v[174:175], v[174:175], v[182:183]
    v_pk_add_f32 v[184:185], v[184:185], v[8:9]
    v_pk_add_f32 v[186:187], v[186:187], v[8:9]
    v_pk_add_f32 v[188:189], v[188:189], v[8:9]
    v_pk_add_f32 v[190:191], v[190:191], v[8:9]
    v_rcp_f32 v184, v184
    v_rcp_f32 v185, v185
    v_rcp_f32 v186, v186
    v_rcp_f32 v187, v187
    v_rcp_f32 v188, v188
    v_rcp_f32 v189, v189
    v_rcp_f32 v190, v190
    v_rcp_f32 v191, v191
    s_nop 0
    v_pk_mul_f32 v[168:169], v[168:169], v[184:185]
    v_pk_mul_f32 v[170:171], v[170:171], v[186:187]
    v_pk_mul_f32 v[172:173], v[172:173], v[188:189]
    v_pk_mul_f32 v[174:175], v[174:175], v[190:191]
    v_cvt_pk_bf16_f32 v200, v168, v169
    v_cvt_pk_bf16_f32 v201, v170, v171
    v_cvt_pk_bf16_f32 v202, v172, v173
    v_cvt_pk_bf16_f32 v203, v174, v175
    buffer_store_dwordx4 v[200:203], v2, s[92:95], s21 offen offset:256 sc1
    s_add_u32 s21, s21, 116736
    v_accvgpr_read_b32 v128, a64
    v_accvgpr_read_b32 v129, a65
    v_accvgpr_read_b32 v130, a66
    v_accvgpr_read_b32 v131, a67
    v_accvgpr_read_b32 v132, a68
    v_accvgpr_read_b32 v133, a69
    v_accvgpr_read_b32 v134, a70
    v_accvgpr_read_b32 v135, a71
    v_accvgpr_read_b32 v136, a80
    v_accvgpr_read_b32 v137, a81
    v_accvgpr_read_b32 v138, a82
    v_accvgpr_read_b32 v139, a83
    v_accvgpr_read_b32 v140, a84
    v_accvgpr_read_b32 v141, a85
    v_accvgpr_read_b32 v142, a86
    v_accvgpr_read_b32 v143, a87
    v_pk_mul_f32 v[144:145], v[128:129], v[128:129]
    v_pk_mul_f32 v[146:147], v[130:131], v[130:131]
    v_pk_mul_f32 v[148:149], v[132:133], v[132:133]
    v_pk_mul_f32 v[150:151], v[134:135], v[134:135]
    v_pk_fma_f32 v[144:145], v[144:145], v[6:7], v[4:5]
    v_pk_fma_f32 v[146:147], v[146:147], v[6:7], v[4:5]
    v_pk_fma_f32 v[148:149], v[148:149], v[6:7], v[4:5]
    v_pk_fma_f32 v[150:151], v[150:151], v[6:7], v[4:5]
    v_pk_mul_f32 v[144:145], v[144:145], v[128:129]
    v_pk_mul_f32 v[146:147], v[146:147], v[130:131]
    v_pk_mul_f32 v[148:149], v[148:149], v[132:133]
    v_pk_mul_f32 v[150:151], v[150:151], v[134:135]
    v_exp_f32 v144, v144
    v_exp_f32 v145, v145
    v_exp_f32 v146, v146
    v_exp_f32 v147, v147
    v_exp_f32 v148, v148
    v_exp_f32 v149, v149
    v_exp_f32 v150, v150
    v_exp_f32 v151, v151
    v_pk_mul_f32 v[128:129], v[128:129], v[136:137]
    v_pk_mul_f32 v[130:131], v[130:131], v[138:139]
    v_pk_mul_f32 v[132:133], v[132:133], v[140:141]
    v_pk_mul_f32 v[134:135], v[134:135], v[142:143]
    v_pk_add_f32 v[144:145], v[144:145], v[8:9]
    v_pk_add_f32 v[146:147], v[146:147], v[8:9]
    v_pk_add_f32 v[148:149], v[148:149], v[8:9]
    v_pk_add_f32 v[150:151], v[150:151], v[8:9]
    v_rcp_f32 v144, v144
    v_rcp_f32 v145, v145
    v_rcp_f32 v146, v146
    v_rcp_f32 v147, v147
    v_rcp_f32 v148, v148
    v_rcp_f32 v149, v149
    v_rcp_f32 v150, v150
    v_rcp_f32 v151, v151
    s_nop 0
    v_pk_mul_f32 v[128:129], v[128:129], v[144:145]
    v_pk_mul_f32 v[130:131], v[130:131], v[146:147]
    v_pk_mul_f32 v[132:133], v[132:133], v[148:149]
    v_pk_mul_f32 v[134:135], v[134:135], v[150:151]
    v_cvt_pk_bf16_f32 v160, v128, v129
    v_cvt_pk_bf16_f32 v161, v130, v131
    v_cvt_pk_bf16_f32 v162, v132, v133
    v_cvt_pk_bf16_f32 v163, v134, v135
    buffer_store_dwordx4 v[160:163], v2, s[92:95], s21 offen offset:0 sc1
    v_accvgpr_read_b32 v168, a72
    v_accvgpr_read_b32 v169, a73
    v_accvgpr_read_b32 v170, a74
    v_accvgpr_read_b32 v171, a75
    v_accvgpr_read_b32 v172, a76
    v_accvgpr_read_b32 v173, a77
    v_accvgpr_read_b32 v174, a78
    v_accvgpr_read_b32 v175, a79
    v_accvgpr_read_b32 v176, a88
    v_accvgpr_read_b32 v177, a89
    v_accvgpr_read_b32 v178, a90
    v_accvgpr_read_b32 v179, a91
    v_accvgpr_read_b32 v180, a92
    v_accvgpr_read_b32 v181, a93
    v_accvgpr_read_b32 v182, a94
    v_accvgpr_read_b32 v183, a95
    v_pk_mul_f32 v[184:185], v[168:169], v[168:169]
    v_pk_mul_f32 v[186:187], v[170:171], v[170:171]
    v_pk_mul_f32 v[188:189], v[172:173], v[172:173]
    v_pk_mul_f32 v[190:191], v[174:175], v[174:175]
    v_pk_fma_f32 v[184:185], v[184:185], v[6:7], v[4:5]
    v_pk_fma_f32 v[186:187], v[186:187], v[6:7], v[4:5]
    v_pk_fma_f32 v[188:189], v[188:189], v[6:7], v[4:5]
    v_pk_fma_f32 v[190:191], v[190:191], v[6:7], v[4:5]
    v_pk_mul_f32 v[184:185], v[184:185], v[168:169]
    v_pk_mul_f32 v[186:187], v[186:187], v[170:171]
    v_pk_mul_f32 v[188:189], v[188:189], v[172:173]
    v_pk_mul_f32 v[190:191], v[190:191], v[174:175]
    v_exp_f32 v184, v184
    v_exp_f32 v185, v185
    v_exp_f32 v186, v186
    v_exp_f32 v187, v187
    v_exp_f32 v188, v188
    v_exp_f32 v189, v189
    v_exp_f32 v190, v190
    v_exp_f32 v191, v191
    v_pk_mul_f32 v[168:169], v[168:169], v[176:177]
    v_pk_mul_f32 v[170:171], v[170:171], v[178:179]
    v_pk_mul_f32 v[172:173], v[172:173], v[180:181]
    v_pk_mul_f32 v[174:175], v[174:175], v[182:183]
    v_pk_add_f32 v[184:185], v[184:185], v[8:9]
    v_pk_add_f32 v[186:187], v[186:187], v[8:9]
    v_pk_add_f32 v[188:189], v[188:189], v[8:9]
    v_pk_add_f32 v[190:191], v[190:191], v[8:9]
    v_rcp_f32 v184, v184
    v_rcp_f32 v185, v185
    v_rcp_f32 v186, v186
    v_rcp_f32 v187, v187
    v_rcp_f32 v188, v188
    v_rcp_f32 v189, v189
    v_rcp_f32 v190, v190
    v_rcp_f32 v191, v191
    s_nop 0
    v_pk_mul_f32 v[168:169], v[168:169], v[184:185]
    v_pk_mul_f32 v[170:171], v[170:171], v[186:187]
    v_pk_mul_f32 v[172:173], v[172:173], v[188:189]
    v_pk_mul_f32 v[174:175], v[174:175], v[190:191]
    v_cvt_pk_bf16_f32 v200, v168, v169
    v_cvt_pk_bf16_f32 v201, v170, v171
    v_cvt_pk_bf16_f32 v202, v172, v173
    v_cvt_pk_bf16_f32 v203, v174, v175
    buffer_store_dwordx4 v[200:203], v2, s[92:95], s21 offen offset:256 sc1
    s_add_u32 s21, s21, 116736
    v_accvgpr_read_b32 v128, a96
    v_accvgpr_read_b32 v129, a97
    v_accvgpr_read_b32 v130, a98
    v_accvgpr_read_b32 v131, a99
    v_accvgpr_read_b32 v132, a100
    v_accvgpr_read_b32 v133, a101
    v_accvgpr_read_b32 v134, a102
    v_accvgpr_read_b32 v135, a103
    v_accvgpr_read_b32 v136, a112
    v_accvgpr_read_b32 v137, a113
    v_accvgpr_read_b32 v138, a114
    v_accvgpr_read_b32 v139, a115
    v_accvgpr_read_b32 v140, a116
    v_accvgpr_read_b32 v141, a117
    v_accvgpr_read_b32 v142, a118
    v_accvgpr_read_b32 v143, a119
    v_pk_mul_f32 v[144:145], v[128:129], v[128:129]
    v_pk_mul_f32 v[146:147], v[130:131], v[130:131]
    v_pk_mul_f32 v[148:149], v[132:133], v[132:133]
    v_pk_mul_f32 v[150:151], v[134:135], v[134:135]
    v_pk_fma_f32 v[144:145], v[144:145], v[6:7], v[4:5]
    v_pk_fma_f32 v[146:147], v[146:147], v[6:7], v[4:5]
    v_pk_fma_f32 v[148:149], v[148:149], v[6:7], v[4:5]
    v_pk_fma_f32 v[150:151], v[150:151], v[6:7], v[4:5]
    v_pk_mul_f32 v[144:145], v[144:145], v[128:129]
    v_pk_mul_f32 v[146:147], v[146:147], v[130:131]
    v_pk_mul_f32 v[148:149], v[148:149], v[132:133]
    v_pk_mul_f32 v[150:151], v[150:151], v[134:135]
    v_exp_f32 v144, v144
    v_exp_f32 v145, v145
    v_exp_f32 v146, v146
    v_exp_f32 v147, v147
    v_exp_f32 v148, v148
    v_exp_f32 v149, v149
    v_exp_f32 v150, v150
    v_exp_f32 v151, v151
    v_pk_mul_f32 v[128:129], v[128:129], v[136:137]
    v_pk_mul_f32 v[130:131], v[130:131], v[138:139]
    v_pk_mul_f32 v[132:133], v[132:133], v[140:141]
    v_pk_mul_f32 v[134:135], v[134:135], v[142:143]
    v_pk_add_f32 v[144:145], v[144:145], v[8:9]
    v_pk_add_f32 v[146:147], v[146:147], v[8:9]
    v_pk_add_f32 v[148:149], v[148:149], v[8:9]
    v_pk_add_f32 v[150:151], v[150:151], v[8:9]
    v_rcp_f32 v144, v144
    v_rcp_f32 v145, v145
    v_rcp_f32 v146, v146
    v_rcp_f32 v147, v147
    v_rcp_f32 v148, v148
    v_rcp_f32 v149, v149
    v_rcp_f32 v150, v150
    v_rcp_f32 v151, v151
    s_nop 0
    v_pk_mul_f32 v[128:129], v[128:129], v[144:145]
    v_pk_mul_f32 v[130:131], v[130:131], v[146:147]
    v_pk_mul_f32 v[132:133], v[132:133], v[148:149]
    v_pk_mul_f32 v[134:135], v[134:135], v[150:151]
    v_cvt_pk_bf16_f32 v160, v128, v129
    v_cvt_pk_bf16_f32 v161, v130, v131
    v_cvt_pk_bf16_f32 v162, v132, v133
    v_cvt_pk_bf16_f32 v163, v134, v135
    buffer_store_dwordx4 v[160:163], v2, s[92:95], s21 offen offset:0 sc1
    v_accvgpr_read_b32 v168, a104
    v_accvgpr_read_b32 v169, a105
    v_accvgpr_read_b32 v170, a106
    v_accvgpr_read_b32 v171, a107
    v_accvgpr_read_b32 v172, a108
    v_accvgpr_read_b32 v173, a109
    v_accvgpr_read_b32 v174, a110
    v_accvgpr_read_b32 v175, a111
    v_accvgpr_read_b32 v176, a120
    v_accvgpr_read_b32 v177, a121
    v_accvgpr_read_b32 v178, a122
    v_accvgpr_read_b32 v179, a123
    v_accvgpr_read_b32 v180, a124
    v_accvgpr_read_b32 v181, a125
    v_accvgpr_read_b32 v182, a126
    v_accvgpr_read_b32 v183, a127
    v_pk_mul_f32 v[184:185], v[168:169], v[168:169]
    v_pk_mul_f32 v[186:187], v[170:171], v[170:171]
    v_pk_mul_f32 v[188:189], v[172:173], v[172:173]
    v_pk_mul_f32 v[190:191], v[174:175], v[174:175]
    v_pk_fma_f32 v[184:185], v[184:185], v[6:7], v[4:5]
    v_pk_fma_f32 v[186:187], v[186:187], v[6:7], v[4:5]
    v_pk_fma_f32 v[188:189], v[188:189], v[6:7], v[4:5]
    v_pk_fma_f32 v[190:191], v[190:191], v[6:7], v[4:5]
    v_pk_mul_f32 v[184:185], v[184:185], v[168:169]
    v_pk_mul_f32 v[186:187], v[186:187], v[170:171]
    v_pk_mul_f32 v[188:189], v[188:189], v[172:173]
    v_pk_mul_f32 v[190:191], v[190:191], v[174:175]
    v_exp_f32 v184, v184
    v_exp_f32 v185, v185
    v_exp_f32 v186, v186
    v_exp_f32 v187, v187
    v_exp_f32 v188, v188
    v_exp_f32 v189, v189
    v_exp_f32 v190, v190
    v_exp_f32 v191, v191
    v_pk_mul_f32 v[168:169], v[168:169], v[176:177]
    v_pk_mul_f32 v[170:171], v[170:171], v[178:179]
    v_pk_mul_f32 v[172:173], v[172:173], v[180:181]
    v_pk_mul_f32 v[174:175], v[174:175], v[182:183]
    v_pk_add_f32 v[184:185], v[184:185], v[8:9]
    v_pk_add_f32 v[186:187], v[186:187], v[8:9]
    v_pk_add_f32 v[188:189], v[188:189], v[8:9]
    v_pk_add_f32 v[190:191], v[190:191], v[8:9]
    v_rcp_f32 v184, v184
    v_rcp_f32 v185, v185
    v_rcp_f32 v186, v186
    v_rcp_f32 v187, v187
    v_rcp_f32 v188, v188
    v_rcp_f32 v189, v189
    v_rcp_f32 v190, v190
    v_rcp_f32 v191, v191
    s_nop 0
    v_pk_mul_f32 v[168:169], v[168:169], v[184:185]
    v_pk_mul_f32 v[170:171], v[170:171], v[186:187]
    v_pk_mul_f32 v[172:173], v[172:173], v[188:189]
    v_pk_mul_f32 v[174:175], v[174:175], v[190:191]
    v_cvt_pk_bf16_f32 v200, v168, v169
    v_cvt_pk_bf16_f32 v201, v170, v171
    v_cvt_pk_bf16_f32 v202, v172, v173
    v_cvt_pk_bf16_f32 v203, v174, v175
    buffer_store_dwordx4 v[200:203], v2, s[92:95], s21 offen offset:256 sc1
    s_add_u32 s21, s21, 116736
    v_accvgpr_read_b32 v128, a128
    v_accvgpr_read_b32 v129, a129
    v_accvgpr_read_b32 v130, a130
    v_accvgpr_read_b32 v131, a131
    v_accvgpr_read_b32 v132, a132
    v_accvgpr_read_b32 v133, a133
    v_accvgpr_read_b32 v134, a134
    v_accvgpr_read_b32 v135, a135
    v_accvgpr_read_b32 v136, a144
    v_accvgpr_read_b32 v137, a145
    v_accvgpr_read_b32 v138, a146
    v_accvgpr_read_b32 v139, a147
    v_accvgpr_read_b32 v140, a148
    v_accvgpr_read_b32 v141, a149
    v_accvgpr_read_b32 v142, a150
    v_accvgpr_read_b32 v143, a151
    v_pk_mul_f32 v[144:145], v[128:129], v[128:129]
    v_pk_mul_f32 v[146:147], v[130:131], v[130:131]
    v_pk_mul_f32 v[148:149], v[132:133], v[132:133]
    v_pk_mul_f32 v[150:151], v[134:135], v[134:135]
    v_pk_fma_f32 v[144:145], v[144:145], v[6:7], v[4:5]
    v_pk_fma_f32 v[146:147], v[146:147], v[6:7], v[4:5]
    v_pk_fma_f32 v[148:149], v[148:149], v[6:7], v[4:5]
    v_pk_fma_f32 v[150:151], v[150:151], v[6:7], v[4:5]
    v_pk_mul_f32 v[144:145], v[144:145], v[128:129]
    v_pk_mul_f32 v[146:147], v[146:147], v[130:131]
    v_pk_mul_f32 v[148:149], v[148:149], v[132:133]
    v_pk_mul_f32 v[150:151], v[150:151], v[134:135]
    v_exp_f32 v144, v144
    v_exp_f32 v145, v145
    v_exp_f32 v146, v146
    v_exp_f32 v147, v147
    v_exp_f32 v148, v148
    v_exp_f32 v149, v149
    v_exp_f32 v150, v150
    v_exp_f32 v151, v151
    v_pk_mul_f32 v[128:129], v[128:129], v[136:137]
    v_pk_mul_f32 v[130:131], v[130:131], v[138:139]
    v_pk_mul_f32 v[132:133], v[132:133], v[140:141]
    v_pk_mul_f32 v[134:135], v[134:135], v[142:143]
    v_pk_add_f32 v[144:145], v[144:145], v[8:9]
    v_pk_add_f32 v[146:147], v[146:147], v[8:9]
    v_pk_add_f32 v[148:149], v[148:149], v[8:9]
    v_pk_add_f32 v[150:151], v[150:151], v[8:9]
    v_rcp_f32 v144, v144
    v_rcp_f32 v145, v145
    v_rcp_f32 v146, v146
    v_rcp_f32 v147, v147
    v_rcp_f32 v148, v148
    v_rcp_f32 v149, v149
    v_rcp_f32 v150, v150
    v_rcp_f32 v151, v151
    s_nop 0
    v_pk_mul_f32 v[128:129], v[128:129], v[144:145]
    v_pk_mul_f32 v[130:131], v[130:131], v[146:147]
    v_pk_mul_f32 v[132:133], v[132:133], v[148:149]
    v_pk_mul_f32 v[134:135], v[134:135], v[150:151]
    v_cvt_pk_bf16_f32 v160, v128, v129
    v_cvt_pk_bf16_f32 v161, v130, v131
    v_cvt_pk_bf16_f32 v162, v132, v133
    v_cvt_pk_bf16_f32 v163, v134, v135
    buffer_store_dwordx4 v[160:163], v2, s[92:95], s21 offen offset:0 sc1
    v_accvgpr_read_b32 v168, a136
    v_accvgpr_read_b32 v169, a137
    v_accvgpr_read_b32 v170, a138
    v_accvgpr_read_b32 v171, a139
    v_accvgpr_read_b32 v172, a140
    v_accvgpr_read_b32 v173, a141
    v_accvgpr_read_b32 v174, a142
    v_accvgpr_read_b32 v175, a143
    v_accvgpr_read_b32 v176, a152
    v_accvgpr_read_b32 v177, a153
    v_accvgpr_read_b32 v178, a154
    v_accvgpr_read_b32 v179, a155
    v_accvgpr_read_b32 v180, a156
    v_accvgpr_read_b32 v181, a157
    v_accvgpr_read_b32 v182, a158
    v_accvgpr_read_b32 v183, a159
    v_pk_mul_f32 v[184:185], v[168:169], v[168:169]
    v_pk_mul_f32 v[186:187], v[170:171], v[170:171]
    v_pk_mul_f32 v[188:189], v[172:173], v[172:173]
    v_pk_mul_f32 v[190:191], v[174:175], v[174:175]
    v_pk_fma_f32 v[184:185], v[184:185], v[6:7], v[4:5]
    v_pk_fma_f32 v[186:187], v[186:187], v[6:7], v[4:5]
    v_pk_fma_f32 v[188:189], v[188:189], v[6:7], v[4:5]
    v_pk_fma_f32 v[190:191], v[190:191], v[6:7], v[4:5]
    v_pk_mul_f32 v[184:185], v[184:185], v[168:169]
    v_pk_mul_f32 v[186:187], v[186:187], v[170:171]
    v_pk_mul_f32 v[188:189], v[188:189], v[172:173]
    v_pk_mul_f32 v[190:191], v[190:191], v[174:175]
    v_exp_f32 v184, v184
    v_exp_f32 v185, v185
    v_exp_f32 v186, v186
    v_exp_f32 v187, v187
    v_exp_f32 v188, v188
    v_exp_f32 v189, v189
    v_exp_f32 v190, v190
    v_exp_f32 v191, v191
    v_pk_mul_f32 v[168:169], v[168:169], v[176:177]
    v_pk_mul_f32 v[170:171], v[170:171], v[178:179]
    v_pk_mul_f32 v[172:173], v[172:173], v[180:181]
    v_pk_mul_f32 v[174:175], v[174:175], v[182:183]
    v_pk_add_f32 v[184:185], v[184:185], v[8:9]
    v_pk_add_f32 v[186:187], v[186:187], v[8:9]
    v_pk_add_f32 v[188:189], v[188:189], v[8:9]
    v_pk_add_f32 v[190:191], v[190:191], v[8:9]
    v_rcp_f32 v184, v184
    v_rcp_f32 v185, v185
    v_rcp_f32 v186, v186
    v_rcp_f32 v187, v187
    v_rcp_f32 v188, v188
    v_rcp_f32 v189, v189
    v_rcp_f32 v190, v190
    v_rcp_f32 v191, v191
    s_nop 0
    v_pk_mul_f32 v[168:169], v[168:169], v[184:185]
    v_pk_mul_f32 v[170:171], v[170:171], v[186:187]
    v_pk_mul_f32 v[172:173], v[172:173], v[188:189]
    v_pk_mul_f32 v[174:175], v[174:175], v[190:191]
    v_cvt_pk_bf16_f32 v200, v168, v169
    v_cvt_pk_bf16_f32 v201, v170, v171
    v_cvt_pk_bf16_f32 v202, v172, v173
    v_cvt_pk_bf16_f32 v203, v174, v175
    buffer_store_dwordx4 v[200:203], v2, s[92:95], s21 offen offset:256 sc1
    s_add_u32 s21, s21, 116736
    v_accvgpr_read_b32 v128, a160
    v_accvgpr_read_b32 v129, a161
    v_accvgpr_read_b32 v130, a162
    v_accvgpr_read_b32 v131, a163
    v_accvgpr_read_b32 v132, a164
    v_accvgpr_read_b32 v133, a165
    v_accvgpr_read_b32 v134, a166
    v_accvgpr_read_b32 v135, a167
    v_accvgpr_read_b32 v136, a176
    v_accvgpr_read_b32 v137, a177
    v_accvgpr_read_b32 v138, a178
    v_accvgpr_read_b32 v139, a179
    v_accvgpr_read_b32 v140, a180
    v_accvgpr_read_b32 v141, a181
    v_accvgpr_read_b32 v142, a182
    v_accvgpr_read_b32 v143, a183
    v_pk_mul_f32 v[144:145], v[128:129], v[128:129]
    v_pk_mul_f32 v[146:147], v[130:131], v[130:131]
    v_pk_mul_f32 v[148:149], v[132:133], v[132:133]
    v_pk_mul_f32 v[150:151], v[134:135], v[134:135]
    v_pk_fma_f32 v[144:145], v[144:145], v[6:7], v[4:5]
    v_pk_fma_f32 v[146:147], v[146:147], v[6:7], v[4:5]
    v_pk_fma_f32 v[148:149], v[148:149], v[6:7], v[4:5]
    v_pk_fma_f32 v[150:151], v[150:151], v[6:7], v[4:5]
    v_pk_mul_f32 v[144:145], v[144:145], v[128:129]
    v_pk_mul_f32 v[146:147], v[146:147], v[130:131]
    v_pk_mul_f32 v[148:149], v[148:149], v[132:133]
    v_pk_mul_f32 v[150:151], v[150:151], v[134:135]
    v_exp_f32 v144, v144
    v_exp_f32 v145, v145
    v_exp_f32 v146, v146
    v_exp_f32 v147, v147
    v_exp_f32 v148, v148
    v_exp_f32 v149, v149
    v_exp_f32 v150, v150
    v_exp_f32 v151, v151
    v_pk_mul_f32 v[128:129], v[128:129], v[136:137]
    v_pk_mul_f32 v[130:131], v[130:131], v[138:139]
    v_pk_mul_f32 v[132:133], v[132:133], v[140:141]
    v_pk_mul_f32 v[134:135], v[134:135], v[142:143]
    v_pk_add_f32 v[144:145], v[144:145], v[8:9]
    v_pk_add_f32 v[146:147], v[146:147], v[8:9]
    v_pk_add_f32 v[148:149], v[148:149], v[8:9]
    v_pk_add_f32 v[150:151], v[150:151], v[8:9]
    v_rcp_f32 v144, v144
    v_rcp_f32 v145, v145
    v_rcp_f32 v146, v146
    v_rcp_f32 v147, v147
    v_rcp_f32 v148, v148
    v_rcp_f32 v149, v149
    v_rcp_f32 v150, v150
    v_rcp_f32 v151, v151
    s_nop 0
    v_pk_mul_f32 v[128:129], v[128:129], v[144:145]
    v_pk_mul_f32 v[130:131], v[130:131], v[146:147]
    v_pk_mul_f32 v[132:133], v[132:133], v[148:149]
    v_pk_mul_f32 v[134:135], v[134:135], v[150:151]
    v_cvt_pk_bf16_f32 v160, v128, v129
    v_cvt_pk_bf16_f32 v161, v130, v131
    v_cvt_pk_bf16_f32 v162, v132, v133
    v_cvt_pk_bf16_f32 v163, v134, v135
    buffer_store_dwordx4 v[160:163], v2, s[92:95], s21 offen offset:0 sc1
    v_accvgpr_read_b32 v168, a168
    v_accvgpr_read_b32 v169, a169
    v_accvgpr_read_b32 v170, a170
    v_accvgpr_read_b32 v171, a171
    v_accvgpr_read_b32 v172, a172
    v_accvgpr_read_b32 v173, a173
    v_accvgpr_read_b32 v174, a174
    v_accvgpr_read_b32 v175, a175
    v_accvgpr_read_b32 v176, a184
    v_accvgpr_read_b32 v177, a185
    v_accvgpr_read_b32 v178, a186
    v_accvgpr_read_b32 v179, a187
    v_accvgpr_read_b32 v180, a188
    v_accvgpr_read_b32 v181, a189
    v_accvgpr_read_b32 v182, a190
    v_accvgpr_read_b32 v183, a191
    v_pk_mul_f32 v[184:185], v[168:169], v[168:169]
    v_pk_mul_f32 v[186:187], v[170:171], v[170:171]
    v_pk_mul_f32 v[188:189], v[172:173], v[172:173]
    v_pk_mul_f32 v[190:191], v[174:175], v[174:175]
    v_pk_fma_f32 v[184:185], v[184:185], v[6:7], v[4:5]
    v_pk_fma_f32 v[186:187], v[186:187], v[6:7], v[4:5]
    v_pk_fma_f32 v[188:189], v[188:189], v[6:7], v[4:5]
    v_pk_fma_f32 v[190:191], v[190:191], v[6:7], v[4:5]
    v_pk_mul_f32 v[184:185], v[184:185], v[168:169]
    v_pk_mul_f32 v[186:187], v[186:187], v[170:171]
    v_pk_mul_f32 v[188:189], v[188:189], v[172:173]
    v_pk_mul_f32 v[190:191], v[190:191], v[174:175]
    v_exp_f32 v184, v184
    v_exp_f32 v185, v185
    v_exp_f32 v186, v186
    v_exp_f32 v187, v187
    v_exp_f32 v188, v188
    v_exp_f32 v189, v189
    v_exp_f32 v190, v190
    v_exp_f32 v191, v191
    v_pk_mul_f32 v[168:169], v[168:169], v[176:177]
    v_pk_mul_f32 v[170:171], v[170:171], v[178:179]
    v_pk_mul_f32 v[172:173], v[172:173], v[180:181]
    v_pk_mul_f32 v[174:175], v[174:175], v[182:183]
    v_pk_add_f32 v[184:185], v[184:185], v[8:9]
    v_pk_add_f32 v[186:187], v[186:187], v[8:9]
    v_pk_add_f32 v[188:189], v[188:189], v[8:9]
    v_pk_add_f32 v[190:191], v[190:191], v[8:9]
    v_rcp_f32 v184, v184
    v_rcp_f32 v185, v185
    v_rcp_f32 v186, v186
    v_rcp_f32 v187, v187
    v_rcp_f32 v188, v188
    v_rcp_f32 v189, v189
    v_rcp_f32 v190, v190
    v_rcp_f32 v191, v191
    s_nop 0
    v_pk_mul_f32 v[168:169], v[168:169], v[184:185]
    v_pk_mul_f32 v[170:171], v[170:171], v[186:187]
    v_pk_mul_f32 v[172:173], v[172:173], v[188:189]
    v_pk_mul_f32 v[174:175], v[174:175], v[190:191]
    v_cvt_pk_bf16_f32 v200, v168, v169
    v_cvt_pk_bf16_f32 v201, v170, v171
    v_cvt_pk_bf16_f32 v202, v172, v173
    v_cvt_pk_bf16_f32 v203, v174, v175
    buffer_store_dwordx4 v[200:203], v2, s[92:95], s21 offen offset:256 sc1
    s_add_u32 s21, s21, 116736
    v_accvgpr_read_b32 v128, a192
    v_accvgpr_read_b32 v129, a193
    v_accvgpr_read_b32 v130, a194
    v_accvgpr_read_b32 v131, a195
    v_accvgpr_read_b32 v132, a196
    v_accvgpr_read_b32 v133, a197
    v_accvgpr_read_b32 v134, a198
    v_accvgpr_read_b32 v135, a199
    v_accvgpr_read_b32 v136, a208
    v_accvgpr_read_b32 v137, a209
    v_accvgpr_read_b32 v138, a210
    v_accvgpr_read_b32 v139, a211
    v_accvgpr_read_b32 v140, a212
    v_accvgpr_read_b32 v141, a213
    v_accvgpr_read_b32 v142, a214
    v_accvgpr_read_b32 v143, a215
    v_pk_mul_f32 v[144:145], v[128:129], v[128:129]
    v_pk_mul_f32 v[146:147], v[130:131], v[130:131]
    v_pk_mul_f32 v[148:149], v[132:133], v[132:133]
    v_pk_mul_f32 v[150:151], v[134:135], v[134:135]
    v_pk_fma_f32 v[144:145], v[144:145], v[6:7], v[4:5]
    v_pk_fma_f32 v[146:147], v[146:147], v[6:7], v[4:5]
    v_pk_fma_f32 v[148:149], v[148:149], v[6:7], v[4:5]
    v_pk_fma_f32 v[150:151], v[150:151], v[6:7], v[4:5]
    v_pk_mul_f32 v[144:145], v[144:145], v[128:129]
    v_pk_mul_f32 v[146:147], v[146:147], v[130:131]
    v_pk_mul_f32 v[148:149], v[148:149], v[132:133]
    v_pk_mul_f32 v[150:151], v[150:151], v[134:135]
    v_exp_f32 v144, v144
    v_exp_f32 v145, v145
    v_exp_f32 v146, v146
    v_exp_f32 v147, v147
    v_exp_f32 v148, v148
    v_exp_f32 v149, v149
    v_exp_f32 v150, v150
    v_exp_f32 v151, v151
    v_pk_mul_f32 v[128:129], v[128:129], v[136:137]
    v_pk_mul_f32 v[130:131], v[130:131], v[138:139]
    v_pk_mul_f32 v[132:133], v[132:133], v[140:141]
    v_pk_mul_f32 v[134:135], v[134:135], v[142:143]
    v_pk_add_f32 v[144:145], v[144:145], v[8:9]
    v_pk_add_f32 v[146:147], v[146:147], v[8:9]
    v_pk_add_f32 v[148:149], v[148:149], v[8:9]
    v_pk_add_f32 v[150:151], v[150:151], v[8:9]
    v_rcp_f32 v144, v144
    v_rcp_f32 v145, v145
    v_rcp_f32 v146, v146
    v_rcp_f32 v147, v147
    v_rcp_f32 v148, v148
    v_rcp_f32 v149, v149
    v_rcp_f32 v150, v150
    v_rcp_f32 v151, v151
    s_nop 0
    v_pk_mul_f32 v[128:129], v[128:129], v[144:145]
    v_pk_mul_f32 v[130:131], v[130:131], v[146:147]
    v_pk_mul_f32 v[132:133], v[132:133], v[148:149]
    v_pk_mul_f32 v[134:135], v[134:135], v[150:151]
    v_cvt_pk_bf16_f32 v160, v128, v129
    v_cvt_pk_bf16_f32 v161, v130, v131
    v_cvt_pk_bf16_f32 v162, v132, v133
    v_cvt_pk_bf16_f32 v163, v134, v135
    buffer_store_dwordx4 v[160:163], v2, s[92:95], s21 offen offset:0 sc1
    v_accvgpr_read_b32 v168, a200
    v_accvgpr_read_b32 v169, a201
    v_accvgpr_read_b32 v170, a202
    v_accvgpr_read_b32 v171, a203
    v_accvgpr_read_b32 v172, a204
    v_accvgpr_read_b32 v173, a205
    v_accvgpr_read_b32 v174, a206
    v_accvgpr_read_b32 v175, a207
    v_accvgpr_read_b32 v176, a216
    v_accvgpr_read_b32 v177, a217
    v_accvgpr_read_b32 v178, a218
    v_accvgpr_read_b32 v179, a219
    v_accvgpr_read_b32 v180, a220
    v_accvgpr_read_b32 v181, a221
    v_accvgpr_read_b32 v182, a222
    v_accvgpr_read_b32 v183, a223
    v_pk_mul_f32 v[184:185], v[168:169], v[168:169]
    v_pk_mul_f32 v[186:187], v[170:171], v[170:171]
    v_pk_mul_f32 v[188:189], v[172:173], v[172:173]
    v_pk_mul_f32 v[190:191], v[174:175], v[174:175]
    v_pk_fma_f32 v[184:185], v[184:185], v[6:7], v[4:5]
    v_pk_fma_f32 v[186:187], v[186:187], v[6:7], v[4:5]
    v_pk_fma_f32 v[188:189], v[188:189], v[6:7], v[4:5]
    v_pk_fma_f32 v[190:191], v[190:191], v[6:7], v[4:5]
    v_pk_mul_f32 v[184:185], v[184:185], v[168:169]
    v_pk_mul_f32 v[186:187], v[186:187], v[170:171]
    v_pk_mul_f32 v[188:189], v[188:189], v[172:173]
    v_pk_mul_f32 v[190:191], v[190:191], v[174:175]
    v_exp_f32 v184, v184
    v_exp_f32 v185, v185
    v_exp_f32 v186, v186
    v_exp_f32 v187, v187
    v_exp_f32 v188, v188
    v_exp_f32 v189, v189
    v_exp_f32 v190, v190
    v_exp_f32 v191, v191
    v_pk_mul_f32 v[168:169], v[168:169], v[176:177]
    v_pk_mul_f32 v[170:171], v[170:171], v[178:179]
    v_pk_mul_f32 v[172:173], v[172:173], v[180:181]
    v_pk_mul_f32 v[174:175], v[174:175], v[182:183]
    v_pk_add_f32 v[184:185], v[184:185], v[8:9]
    v_pk_add_f32 v[186:187], v[186:187], v[8:9]
    v_pk_add_f32 v[188:189], v[188:189], v[8:9]
    v_pk_add_f32 v[190:191], v[190:191], v[8:9]
    v_rcp_f32 v184, v184
    v_rcp_f32 v185, v185
    v_rcp_f32 v186, v186
    v_rcp_f32 v187, v187
    v_rcp_f32 v188, v188
    v_rcp_f32 v189, v189
    v_rcp_f32 v190, v190
    v_rcp_f32 v191, v191
    s_nop 0
    v_pk_mul_f32 v[168:169], v[168:169], v[184:185]
    v_pk_mul_f32 v[170:171], v[170:171], v[186:187]
    v_pk_mul_f32 v[172:173], v[172:173], v[188:189]
    v_pk_mul_f32 v[174:175], v[174:175], v[190:191]
    v_cvt_pk_bf16_f32 v200, v168, v169
    v_cvt_pk_bf16_f32 v201, v170, v171
    v_cvt_pk_bf16_f32 v202, v172, v173
    v_cvt_pk_bf16_f32 v203, v174, v175
    buffer_store_dwordx4 v[200:203], v2, s[92:95], s21 offen offset:256 sc1
    s_add_u32 s21, s21, 116736
    v_accvgpr_read_b32 v128, a224
    v_accvgpr_read_b32 v129, a225
    v_accvgpr_read_b32 v130, a226
    v_accvgpr_read_b32 v131, a227
    v_accvgpr_read_b32 v132, a228
    v_accvgpr_read_b32 v133, a229
    v_accvgpr_read_b32 v134, a230
    v_accvgpr_read_b32 v135, a231
    v_accvgpr_read_b32 v136, a240
    v_accvgpr_read_b32 v137, a241
    v_accvgpr_read_b32 v138, a242
    v_accvgpr_read_b32 v139, a243
    v_accvgpr_read_b32 v140, a244
    v_accvgpr_read_b32 v141, a245
    v_accvgpr_read_b32 v142, a246
    v_accvgpr_read_b32 v143, a247
    v_pk_mul_f32 v[144:145], v[128:129], v[128:129]
    v_pk_mul_f32 v[146:147], v[130:131], v[130:131]
    v_pk_mul_f32 v[148:149], v[132:133], v[132:133]
    v_pk_mul_f32 v[150:151], v[134:135], v[134:135]
    v_pk_fma_f32 v[144:145], v[144:145], v[6:7], v[4:5]
    v_pk_fma_f32 v[146:147], v[146:147], v[6:7], v[4:5]
    v_pk_fma_f32 v[148:149], v[148:149], v[6:7], v[4:5]
    v_pk_fma_f32 v[150:151], v[150:151], v[6:7], v[4:5]
    v_pk_mul_f32 v[144:145], v[144:145], v[128:129]
    v_pk_mul_f32 v[146:147], v[146:147], v[130:131]
    v_pk_mul_f32 v[148:149], v[148:149], v[132:133]
    v_pk_mul_f32 v[150:151], v[150:151], v[134:135]
    v_exp_f32 v144, v144
    v_exp_f32 v145, v145
    v_exp_f32 v146, v146
    v_exp_f32 v147, v147
    v_exp_f32 v148, v148
    v_exp_f32 v149, v149
    v_exp_f32 v150, v150
    v_exp_f32 v151, v151
    v_pk_mul_f32 v[128:129], v[128:129], v[136:137]
    v_pk_mul_f32 v[130:131], v[130:131], v[138:139]
    v_pk_mul_f32 v[132:133], v[132:133], v[140:141]
    v_pk_mul_f32 v[134:135], v[134:135], v[142:143]
    v_pk_add_f32 v[144:145], v[144:145], v[8:9]
    v_pk_add_f32 v[146:147], v[146:147], v[8:9]
    v_pk_add_f32 v[148:149], v[148:149], v[8:9]
    v_pk_add_f32 v[150:151], v[150:151], v[8:9]
    v_rcp_f32 v144, v144
    v_rcp_f32 v145, v145
    v_rcp_f32 v146, v146
    v_rcp_f32 v147, v147
    v_rcp_f32 v148, v148
    v_rcp_f32 v149, v149
    v_rcp_f32 v150, v150
    v_rcp_f32 v151, v151
    s_nop 0
    v_pk_mul_f32 v[128:129], v[128:129], v[144:145]
    v_pk_mul_f32 v[130:131], v[130:131], v[146:147]
    v_pk_mul_f32 v[132:133], v[132:133], v[148:149]
    v_pk_mul_f32 v[134:135], v[134:135], v[150:151]
    v_cvt_pk_bf16_f32 v160, v128, v129
    v_cvt_pk_bf16_f32 v161, v130, v131
    v_cvt_pk_bf16_f32 v162, v132, v133
    v_cvt_pk_bf16_f32 v163, v134, v135
    buffer_store_dwordx4 v[160:163], v2, s[92:95], s21 offen offset:0 sc1
    v_accvgpr_read_b32 v168, a232
    v_accvgpr_read_b32 v169, a233
    v_accvgpr_read_b32 v170, a234
    v_accvgpr_read_b32 v171, a235
    v_accvgpr_read_b32 v172, a236
    v_accvgpr_read_b32 v173, a237
    v_accvgpr_read_b32 v174, a238
    v_accvgpr_read_b32 v175, a239
    v_accvgpr_read_b32 v176, a248
    v_accvgpr_read_b32 v177, a249
    v_accvgpr_read_b32 v178, a250
    v_accvgpr_read_b32 v179, a251
    v_accvgpr_read_b32 v180, a252
    v_accvgpr_read_b32 v181, a253
    v_accvgpr_read_b32 v182, a254
    v_accvgpr_read_b32 v183, a255
    v_pk_mul_f32 v[184:185], v[168:169], v[168:169]
    v_pk_mul_f32 v[186:187], v[170:171], v[170:171]
    v_pk_mul_f32 v[188:189], v[172:173], v[172:173]
    v_pk_mul_f32 v[190:191], v[174:175], v[174:175]
    v_pk_fma_f32 v[184:185], v[184:185], v[6:7], v[4:5]
    v_pk_fma_f32 v[186:187], v[186:187], v[6:7], v[4:5]
    v_pk_fma_f32 v[188:189], v[188:189], v[6:7], v[4:5]
    v_pk_fma_f32 v[190:191], v[190:191], v[6:7], v[4:5]
    v_pk_mul_f32 v[184:185], v[184:185], v[168:169]
    v_pk_mul_f32 v[186:187], v[186:187], v[170:171]
    v_pk_mul_f32 v[188:189], v[188:189], v[172:173]
    v_pk_mul_f32 v[190:191], v[190:191], v[174:175]
    v_exp_f32 v184, v184
    v_exp_f32 v185, v185
    v_exp_f32 v186, v186
    v_exp_f32 v187, v187
    v_exp_f32 v188, v188
    v_exp_f32 v189, v189
    v_exp_f32 v190, v190
    v_exp_f32 v191, v191
    v_pk_mul_f32 v[168:169], v[168:169], v[176:177]
    v_pk_mul_f32 v[170:171], v[170:171], v[178:179]
    v_pk_mul_f32 v[172:173], v[172:173], v[180:181]
    v_pk_mul_f32 v[174:175], v[174:175], v[182:183]
    v_pk_add_f32 v[184:185], v[184:185], v[8:9]
    v_pk_add_f32 v[186:187], v[186:187], v[8:9]
    v_pk_add_f32 v[188:189], v[188:189], v[8:9]
    v_pk_add_f32 v[190:191], v[190:191], v[8:9]
    v_rcp_f32 v184, v184
    v_rcp_f32 v185, v185
    v_rcp_f32 v186, v186
    v_rcp_f32 v187, v187
    v_rcp_f32 v188, v188
    v_rcp_f32 v189, v189
    v_rcp_f32 v190, v190
    v_rcp_f32 v191, v191
    s_nop 0
    v_pk_mul_f32 v[168:169], v[168:169], v[184:185]
    v_pk_mul_f32 v[170:171], v[170:171], v[186:187]
    v_pk_mul_f32 v[172:173], v[172:173], v[188:189]
    v_pk_mul_f32 v[174:175], v[174:175], v[190:191]
    v_cvt_pk_bf16_f32 v200, v168, v169
    v_cvt_pk_bf16_f32 v201, v170, v171
    v_cvt_pk_bf16_f32 v202, v172, v173
    v_cvt_pk_bf16_f32 v203, v174, v175
    buffer_store_dwordx4 v[200:203], v2, s[92:95], s21 offen offset:256 sc1
L_epi_end:
    s_mov_b32 s82, 0
L_epi_ret:
    s_setpc_b64 s[4:5]
L_DN:
    s_call_b64 s[4:5], L_epi
    s_cmp_eq_u32 s69, 0
    s_cbranch_scc1 Fl_161
    s_waitcnt vmcnt(0)
    s_barrier
    s_cmp_lg_u32 s3, 0
    s_cbranch_scc1 Fin_163
    v_mov_b32 v4, s69
    s_mov_b64 exec, 1
    buffer_atomic_add v4, off, s[92:95], s68 sc1
    s_mov_b64 exec, -1
Fin_163:
    s_mov_b32 s69, 0
Fl_161:
    s_lshl_b32 s32, s36, 7
    s_add_u32 s32, s32, 113247616
    s_cmp_lg_u32 s3, 0
    s_cbranch_scc1 Wf_164
    v_mov_b32 v5, 0
    s_mov_b32 s30, 0
    s_mov_b32 s21, 0x1c
Wp_165:
    buffer_load_dword v4, v5, s[92:95], s32 offen sc1
    s_waitcnt vmcnt(0)
    v_cmp_ne_u32 vcc, s21, v4
    s_cbranch_vccz Wf_164
    s_sleep 8
    s_add_u32 s30, s30, 1
    s_cmp_lt_u32 s30, 65536
    s_cbranch_scc1 Wp_165
    s_branch L_abort
Wf_164:
    s_barrier
    s_add_u32 s8, s66, 55574528
    s_addc_u32 s9, s67, 0
    s_and_b32 s9, s9, 0xffff
    s_mov_b32 s10, 14942208
    s_mov_b32 s11, 0x20000
    s_mov_b32 s12, s60
    s_and_b32 s13, s61, 0xffff
    s_mov_b32 s14, 7340032
    s_mov_b32 s15, 0x20000
    v_lshrrev_b32 v2, 5, v1
    v_and_b32 v3, 31, v1
    v_lshlrev_b32 v3, 4, v3
    v_lshlrev_b32 v4, 7, v2
    v_xor_b32 v3, v3, v4
    s_mul_i32 s21, s3, 16
    v_add_u32 v2, s21, v2
    s_mov_b32 s22, 29184
    v_mul_lo_u32 v2, v2, s22
    v_add_u32 v3, v2, v3
    v_add_u32 v16, 0, v3
    v_add_u32 v17, 58368, v3
    v_add_u32 v18, 116736, v3
    v_add_u32 v19, 175104, v3
    v_add_u32 v20, 233472, v3
    v_add_u32 v21, 291840, v3
    v_add_u32 v22, 350208, v3
    v_add_u32 v23, 408576, v3
    v_lshrrev_b32 v2, 3, v1
    v_and_b32 v3, 7, v1
    v_bfe_u32 v4, v1, 4, 1
    v_lshlrev_b32 v4, 1, v4
    v_xor_b32 v3, v3, v4
    v_lshrrev_b32 v4, 2, v2
    v_lshlrev_b32 v4, 4, v4
    v_and_b32 v2, 3, v2
    v_add_u32 v2, v2, v4
    s_and_b32 s21, s3, 1
    s_lshl_b32 s21, s21, 5
    v_add_u32 v2, s21, v2
    s_mov_b32 s22, 2048
    v_mul_lo_u32 v2, v2, s22
    s_lshr_b32 s23, s3, 1
    s_lshl_b32 s23, s23, 7
    v_add_u32 v2, s23, v2
    v_lshlrev_b32 v3, 4, v3
    v_xor_b32 v4, 64, v3
    v_add_u32 v3, v2, v3
    v_add_u32 v4, v2, v4
    v_add_u32 v24, 0, v3
    v_add_u32 v25, 8192, v4
    v_add_u32 v26, 16384, v3
    v_add_u32 v27, 24576, v4
    s_mul_i32 s18, s3, 8192
    s_lshl_b32 s19, s3, 12
    s_add_u32 s19, s19, 32768
    s_lshr_b32 s21, s3, 1
    s_mul_i32 s21, s21, 16384
    v_bfe_u32 v2, v1, 2, 2
    v_lshlrev_b32 v2, 9, v2
    v_add_u32 v2, s21, v2
    v_and_b32 v3, 3, v1
    v_lshl_add_u32 v2, v3, 5, v2
    v_bfe_u32 v3, v1, 4, 1
    v_lshl_add_u32 v2, v3, 4, v2
    v_lshrrev_b32 v4, 5, v1
    v_bfe_u32 v5, v1, 2, 1
    v_xor_b32 v4, v4, v5
    v_lshl_add_u32 v32, v4, 7, v2
    v_lshrrev_b32 v4, 4, v1
    v_bfe_u32 v5, v1, 2, 2
    v_lshl_add_u32 v2, v4, 3, v5
    v_lshlrev_b32 v2, 7, v2
    v_and_b32 v4, 3, v1
    v_lshl_add_u32 v2, v4, 3, v2
    v_add_u32 v2, 32768, v2
    v_lshrrev_b32 v5, 1, v5
    v_lshl_or_b32 v3, v3, 1, v5
    s_and_b32 s21, s3, 1
    s_lshl_b32 s21, s21, 1
    v_xor_b32 v3, s21, v3
    v_lshl_add_u32 v33, v3, 5, v2
    v_xor_b32 v34, 32, v33
    v_add_u32 v38, 49152, v32
    v_add_u32 v39, 49152, v33
    v_add_u32 v40, 49152, v34
    v_add_u32 v44, 98304, v32
    v_add_u32 v45, 98304, v33
    v_add_u32 v46, 98304, v34
    s_mul_i32 s16, s36, 1867776
    s_lshl_b32 s17, s37, 8
    s_add_u32 m0, s18, 0
    s_nop 0
    buffer_load_dwordx4 v16, s[8:11], s16 offen sc1 lds
    s_add_u32 m0, s19, 0
    s_nop 0
    buffer_load_dwordx4 v24, s[12:15], s17 offen  lds
    s_add_u32 m0, s18, 1024
    s_nop 0
    buffer_load_dwordx4 v17, s[8:11], s16 offen sc1 lds
    s_add_u32 m0, s19, 1024
    s_nop 0
    buffer_load_dwordx4 v25, s[12:15], s17 offen  lds
    s_add_u32 m0, s18, 2048
    s_nop 0
    buffer_load_dwordx4 v18, s[8:11], s16 offen sc1 lds
    s_add_u32 m0, s19, 2048
    s_nop 0
    buffer_load_dwordx4 v26, s[12:15], s17 offen  lds
    s_add_u32 m0, s18, 3072
    s_nop 0
    buffer_load_dwordx4 v19, s[8:11], s16 offen sc1 lds
    s_add_u32 m0, s19, 3072
    s_nop 0
    buffer_load_dwordx4 v27, s[12:15], s17 offen  lds
    s_add_u32 m0, s18, 4096
    s_nop 0
    buffer_load_dwordx4 v20, s[8:11], s16 offen sc1 lds
    s_add_u32 m0, s18, 5120
    s_nop 0
    buffer_load_dwordx4 v21, s[8:11], s16 offen sc1 lds
    s_add_u32 m0, s18, 6144
    s_nop 0
    buffer_load_dwordx4 v22, s[8:11], s16 offen sc1 lds
    s_add_u32 m0, s18, 7168
    s_nop 0
    buffer_load_dwordx4 v23, s[8:11], s16 offen sc1 lds
    s_add_u32 s16, s16, 512
    s_add_u32 s17, s17, 131072
    s_add_u32 m0, s18, 49152
    s_nop 0
    buffer_load_dwordx4 v16, s[8:11], s16 offen sc1 lds
    s_add_u32 m0, s19, 49152
    s_nop 0
    buffer_load_dwordx4 v24, s[12:15], s17 offen  lds
    s_add_u32 m0, s18, 50176
    s_nop 0
    buffer_load_dwordx4 v17, s[8:11], s16 offen sc1 lds
    s_add_u32 m0, s19, 50176
    s_nop 0
    buffer_load_dwordx4 v25, s[12:15], s17 offen  lds
    s_add_u32 m0, s18, 51200
    s_nop 0
    buffer_load_dwordx4 v18, s[8:11], s16 offen sc1 lds
    s_add_u32 m0, s19, 51200
    s_nop 0
    buffer_load_dwordx4 v26, s[12:15], s17 offen  lds
    s_add_u32 m0, s18, 52224
    s_nop 0
    buffer_load_dwordx4 v19, s[8:11], s16 offen sc1 lds
    s_add_u32 m0, s19, 52224
    s_nop 0
    buffer_load_dwordx4 v27, s[12:15], s17 offen  lds
    s_add_u32 m0, s18, 53248
    s_nop 0
    buffer_load_dwordx4 v20, s[8:11], s16 offen sc1 lds
    s_add_u32 m0, s18, 54272
    s_nop 0
    buffer_load_dwordx4 v21, s[8:11], s16 offen sc1 lds
    s_add_u32 m0, s18, 55296
    s_nop 0
    buffer_load_dwordx4 v22, s[8:11], s16 offen sc1 lds
    s_add_u32 m0, s18, 56320
    s_nop 0
    buffer_load_dwordx4 v23, s[8:11], s16 offen sc1 lds
    s_add_u32 s16, s16, 512
    s_add_u32 s17, s17, 131072
    s_add_u32 m0, s18, 98304
    s_nop 0
    buffer_load_dwordx4 v16, s[8:11], s16 offen sc1 lds
    s_add_u32 m0, s19, 98304
    s_nop 0
    buffer_load_dwordx4 v24, s[12:15], s17 offen  lds
    s_add_u32 m0, s18, 99328
    s_nop 0
    buffer_load_dwordx4 v17, s[8:11], s16 offen sc1 lds
    s_add_u32 m0, s19, 99328
    s_nop 0
    buffer_load_dwordx4 v25, s[12:15], s17 offen  lds
    s_add_u32 m0, s18, 100352
    s_nop 0
    buffer_load_dwordx4 v18, s[8:11], s16 offen sc1 lds
    s_add_u32 m0, s19, 100352
    s_nop 0
    buffer_load_dwordx4 v26, s[12:15], s17 offen  lds
    s_add_u32 m0, s18, 101376
    s_nop 0
    buffer_load_dwordx4 v19, s[8:11], s16 offen sc1 lds
    s_add_u32 m0, s19, 101376
    s_nop 0
    buffer_load_dwordx4 v27, s[12:15], s17 offen  lds
    s_add_u32 m0, s18, 102400
    s_nop 0
    buffer_load_dwordx4 v20, s[8:11], s16 offen sc1 lds
    s_add_u32 m0, s18, 103424
    s_nop 0
    buffer_load_dwordx4 v21, s[8:11], s16 offen sc1 lds
    s_add_u32 m0, s18, 104448
    s_nop 0
    buffer_load_dwordx4 v22, s[8:11], s16 offen sc1 lds
    s_add_u32 m0, s18, 105472
    s_nop 0
    buffer_load_dwordx4 v23, s[8:11], s16 offen sc1 lds
    s_add_u32 s16, s16, 512
    s_add_u32 s17, s17, 131072
    s_waitcnt vmcnt(24)
    s_barrier
    ds_read_b64_tr_b16 v[96:97], v33 offset:0
    ds_read_b64_tr_b16 v[98:99], v33 offset:512
    ds_read_b128 v[64:67], v32 offset:0
    ds_read_b128 v[68:71], v32 offset:2048
    ds_read_b128 v[72:75], v32 offset:4096
    ds_read_b128 v[76:79], v32 offset:6144
    ds_read_b128 v[80:83], v32 offset:8192
    ds_read_b128 v[84:87], v32 offset:10240
    ds_read_b128 v[88:91], v32 offset:12288
    ds_read_b128 v[92:95], v32 offset:14336
    ds_read_b64_tr_b16 v[100:101], v34 offset:0
    ds_read_b64_tr_b16 v[102:103], v34 offset:512
    ds_read_b64_tr_b16 v[104:105], v33 offset:8192
    ds_read_b64_tr_b16 v[106:107], v33 offset:8704
    ds_read_b64_tr_b16 v[108:109], v34 offset:8192
    ds_read_b64_tr_b16 v[110:111], v34 offset:8704
    s_waitcnt lgkmcnt(0)
    v_mfma_f32_16x16x32_bf16 a[0:3], v[96:99], v[64:67], 0
    ds_read_b64_tr_b16 v[160:161], v33 offset:4096
    v_mfma_f32_16x16x32_bf16 a[16:19], v[96:99], v[68:71], 0
    v_mfma_f32_16x16x32_bf16 a[32:35], v[96:99], v[72:75], 0
    ds_read_b64_tr_b16 v[162:163], v33 offset:4608
    v_mfma_f32_16x16x32_bf16 a[48:51], v[96:99], v[76:79], 0
    ds_read_b128 v[128:131], v32 offset:256
    v_mfma_f32_16x16x32_bf16 a[64:67], v[96:99], v[80:83], 0
    ds_read_b128 v[132:135], v32 offset:2304
    v_mfma_f32_16x16x32_bf16 a[80:83], v[96:99], v[84:87], 0
    v_mfma_f32_16x16x32_bf16 a[96:99], v[96:99], v[88:91], 0
    ds_read_b128 v[136:139], v32 offset:4352
    v_mfma_f32_16x16x32_bf16 a[112:115], v[96:99], v[92:95], 0
    ds_read_b128 v[140:143], v32 offset:6400
    v_mfma_f32_16x16x32_bf16 a[4:7], v[100:103], v[64:67], 0
    ds_read_b128 v[144:147], v32 offset:8448
    v_mfma_f32_16x16x32_bf16 a[20:23], v[100:103], v[68:71], 0
    v_mfma_f32_16x16x32_bf16 a[36:39], v[100:103], v[72:75], 0
    ds_read_b128 v[148:151], v32 offset:10496
    v_mfma_f32_16x16x32_bf16 a[52:55], v[100:103], v[76:79], 0
    ds_read_b128 v[152:155], v32 offset:12544
    v_mfma_f32_16x16x32_bf16 a[68:71], v[100:103], v[80:83], 0
    ds_read_b128 v[156:159], v32 offset:14592
    v_mfma_f32_16x16x32_bf16 a[84:87], v[100:103], v[84:87], 0
    v_mfma_f32_16x16x32_bf16 a[100:103], v[100:103], v[88:91], 0
    ds_read_b64_tr_b16 v[164:165], v34 offset:4096
    v_mfma_f32_16x16x32_bf16 a[116:119], v[100:103], v[92:95], 0
    ds_read_b64_tr_b16 v[166:167], v34 offset:4608
    v_mfma_f32_16x16x32_bf16 a[8:11], v[104:107], v[64:67], 0
    ds_read_b64_tr_b16 v[168:169], v33 offset:12288
    v_mfma_f32_16x16x32_bf16 a[24:27], v[104:107], v[68:71], 0
    v_mfma_f32_16x16x32_bf16 a[40:43], v[104:107], v[72:75], 0
    ds_read_b64_tr_b16 v[170:171], v33 offset:12800
    v_mfma_f32_16x16x32_bf16 a[56:59], v[104:107], v[76:79], 0
    ds_read_b64_tr_b16 v[172:173], v34 offset:12288
    v_mfma_f32_16x16x32_bf16 a[72:75], v[104:107], v[80:83], 0
    ds_read_b64_tr_b16 v[174:175], v34 offset:12800
    v_mfma_f32_16x16x32_bf16 a[88:91], v[104:107], v[84:87], 0
    v_mfma_f32_16x16x32_bf16 a[104:107], v[104:107], v[88:91], 0
    v_mfma_f32_16x16x32_bf16 a[120:123], v[104:107], v[92:95], 0
    v_mfma_f32_16x16x32_bf16 a[12:15], v[108:111], v[64:67], 0
    v_mfma_f32_16x16x32_bf16 a[28:31], v[108:111], v[68:71], 0
    v_mfma_f32_16x16x32_bf16 a[44:47], v[108:111], v[72:75], 0
    v_mfma_f32_16x16x32_bf16 a[60:63], v[108:111], v[76:79], 0
    s_waitcnt vmcnt(12) lgkmcnt(0)
    s_barrier
    v_mfma_f32_16x16x32_bf16 a[76:79], v[108:111], v[80:83], 0
    v_mfma_f32_16x16x32_bf16 a[92:95], v[108:111], v[84:87], 0
    v_mfma_f32_16x16x32_bf16 a[108:111], v[108:111], v[88:91], 0
    v_mfma_f32_16x16x32_bf16 a[124:127], v[108:111], v[92:95], 0
    s_mov_b32 s20, 17
Gdn_166:
    s_waitcnt lgkmcnt(0)
    v_mfma_f32_16x16x32_bf16 a[0:3], v[160:163], v[128:131], a[0:3]
    s_add_u32 m0, s18, 0
    ds_read_b64_tr_b16 v[96:97], v39 offset:0
    v_mfma_f32_16x16x32_bf16 a[16:19], v[160:163], v[132:135], a[16:19]
    buffer_load_dwordx4 v16, s[8:11], s16 offen sc1 lds
    v_mfma_f32_16x16x32_bf16 a[32:35], v[160:163], v[136:139], a[32:35]
    ds_read_b64_tr_b16 v[98:99], v39 offset:512
    v_mfma_f32_16x16x32_bf16 a[48:51], v[160:163], v[140:143], a[48:51]
    ds_read_b128 v[64:67], v38 offset:0
    v_mfma_f32_16x16x32_bf16 a[64:67], v[160:163], v[144:147], a[64:67]
    s_add_u32 m0, s19, 0
    ds_read_b128 v[68:71], v38 offset:2048
    v_mfma_f32_16x16x32_bf16 a[80:83], v[160:163], v[148:151], a[80:83]
    buffer_load_dwordx4 v24, s[12:15], s17 offen  lds
    v_mfma_f32_16x16x32_bf16 a[96:99], v[160:163], v[152:155], a[96:99]
    ds_read_b128 v[72:75], v38 offset:4096
    v_mfma_f32_16x16x32_bf16 a[112:115], v[160:163], v[156:159], a[112:115]
    ds_read_b128 v[76:79], v38 offset:6144
    v_mfma_f32_16x16x32_bf16 a[4:7], v[164:167], v[128:131], a[4:7]
    s_add_u32 m0, s18, 1024
    ds_read_b128 v[80:83], v38 offset:8192
    v_mfma_f32_16x16x32_bf16 a[20:23], v[164:167], v[132:135], a[20:23]
    buffer_load_dwordx4 v17, s[8:11], s16 offen sc1 lds
    v_mfma_f32_16x16x32_bf16 a[36:39], v[164:167], v[136:139], a[36:39]
    ds_read_b128 v[84:87], v38 offset:10240
    v_mfma_f32_16x16x32_bf16 a[52:55], v[164:167], v[140:143], a[52:55]
    v_mfma_f32_16x16x32_bf16 a[68:71], v[164:167], v[144:147], a[68:71]
    s_add_u32 m0, s19, 1024
    ds_read_b128 v[88:91], v38 offset:12288
    v_mfma_f32_16x16x32_bf16 a[84:87], v[164:167], v[148:151], a[84:87]
    buffer_load_dwordx4 v25, s[12:15], s17 offen  lds
    v_mfma_f32_16x16x32_bf16 a[100:103], v[164:167], v[152:155], a[100:103]
    ds_read_b128 v[92:95], v38 offset:14336
    v_mfma_f32_16x16x32_bf16 a[116:119], v[164:167], v[156:159], a[116:119]
    ds_read_b64_tr_b16 v[100:101], v40 offset:0
    v_mfma_f32_16x16x32_bf16 a[8:11], v[168:171], v[128:131], a[8:11]
    s_add_u32 m0, s18, 2048
    ds_read_b64_tr_b16 v[102:103], v40 offset:512
    v_mfma_f32_16x16x32_bf16 a[24:27], v[168:171], v[132:135], a[24:27]
    buffer_load_dwordx4 v18, s[8:11], s16 offen sc1 lds
    v_mfma_f32_16x16x32_bf16 a[40:43], v[168:171], v[136:139], a[40:43]
    ds_read_b64_tr_b16 v[104:105], v39 offset:8192
    v_mfma_f32_16x16x32_bf16 a[56:59], v[168:171], v[140:143], a[56:59]
    ds_read_b64_tr_b16 v[106:107], v39 offset:8704
    v_mfma_f32_16x16x32_bf16 a[72:75], v[168:171], v[144:147], a[72:75]
    s_add_u32 m0, s19, 2048
    ds_read_b64_tr_b16 v[108:109], v40 offset:8192
    v_mfma_f32_16x16x32_bf16 a[88:91], v[168:171], v[148:151], a[88:91]
    buffer_load_dwordx4 v26, s[12:15], s17 offen  lds
    v_mfma_f32_16x16x32_bf16 a[104:107], v[168:171], v[152:155], a[104:107]
    ds_read_b64_tr_b16 v[110:111], v40 offset:8704
    v_mfma_f32_16x16x32_bf16 a[120:123], v[168:171], v[156:159], a[120:123]
    v_mfma_f32_16x16x32_bf16 a[12:15], v[172:175], v[128:131], a[12:15]
    s_add_u32 m0, s18, 3072
    v_mfma_f32_16x16x32_bf16 a[28:31], v[172:175], v[132:135], a[28:31]
    buffer_load_dwordx4 v19, s[8:11], s16 offen sc1 lds
    v_mfma_f32_16x16x32_bf16 a[44:47], v[172:175], v[136:139], a[44:47]
    v_mfma_f32_16x16x32_bf16 a[60:63], v[172:175], v[140:143], a[60:63]
    v_mfma_f32_16x16x32_bf16 a[76:79], v[172:175], v[144:147], a[76:79]
    s_add_u32 m0, s19, 3072
    v_mfma_f32_16x16x32_bf16 a[92:95], v[172:175], v[148:151], a[92:95]
    buffer_load_dwordx4 v27, s[12:15], s17 offen  lds
    v_mfma_f32_16x16x32_bf16 a[108:111], v[172:175], v[152:155], a[108:111]
    v_mfma_f32_16x16x32_bf16 a[124:127], v[172:175], v[156:159], a[124:127]
    s_waitcnt lgkmcnt(0)
    v_mfma_f32_16x16x32_bf16 a[0:3], v[96:99], v[64:67], a[0:3]
    s_add_u32 m0, s18, 4096
    ds_read_b64_tr_b16 v[160:161], v39 offset:4096
    v_mfma_f32_16x16x32_bf16 a[16:19], v[96:99], v[68:71], a[16:19]
    buffer_load_dwordx4 v20, s[8:11], s16 offen sc1 lds
    v_mfma_f32_16x16x32_bf16 a[32:35], v[96:99], v[72:75], a[32:35]
    ds_read_b64_tr_b16 v[162:163], v39 offset:4608
    v_mfma_f32_16x16x32_bf16 a[48:51], v[96:99], v[76:79], a[48:51]
    ds_read_b128 v[128:131], v38 offset:256
    v_mfma_f32_16x16x32_bf16 a[64:67], v[96:99], v[80:83], a[64:67]
    s_add_u32 m0, s18, 5120
    ds_read_b128 v[132:135], v38 offset:2304
    v_mfma_f32_16x16x32_bf16 a[80:83], v[96:99], v[84:87], a[80:83]
    buffer_load_dwordx4 v21, s[8:11], s16 offen sc1 lds
    v_mfma_f32_16x16x32_bf16 a[96:99], v[96:99], v[88:91], a[96:99]
    ds_read_b128 v[136:139], v38 offset:4352
    v_mfma_f32_16x16x32_bf16 a[112:115], v[96:99], v[92:95], a[112:115]
    ds_read_b128 v[140:143], v38 offset:6400
    v_mfma_f32_16x16x32_bf16 a[4:7], v[100:103], v[64:67], a[4:7]
    s_add_u32 m0, s18, 6144
    ds_read_b128 v[144:147], v38 offset:8448
    v_mfma_f32_16x16x32_bf16 a[20:23], v[100:103], v[68:71], a[20:23]
    buffer_load_dwordx4 v22, s[8:11], s16 offen sc1 lds
    v_mfma_f32_16x16x32_bf16 a[36:39], v[100:103], v[72:75], a[36:39]
    ds_read_b128 v[148:151], v38 offset:10496
    v_mfma_f32_16x16x32_bf16 a[52:55], v[100:103], v[76:79], a[52:55]
    ds_read_b128 v[152:155], v38 offset:12544
    v_mfma_f32_16x16x32_bf16 a[68:71], v[100:103], v[80:83], a[68:71]
    s_add_u32 m0, s18, 7168
    ds_read_b128 v[156:159], v38 offset:14592
    v_mfma_f32_16x16x32_bf16 a[84:87], v[100:103], v[84:87], a[84:87]
    buffer_load_dwordx4 v23, s[8:11], s16 offen sc1 lds
    v_mfma_f32_16x16x32_bf16 a[100:103], v[100:103], v[88:91], a[100:103]
    ds_read_b64_tr_b16 v[164:165], v40 offset:4096
    v_mfma_f32_16x16x32_bf16 a[116:119], v[100:103], v[92:95], a[116:119]
    ds_read_b64_tr_b16 v[166:167], v40 offset:4608
    v_mfma_f32_16x16x32_bf16 a[8:11], v[104:107], v[64:67], a[8:11]
    ds_read_b64_tr_b16 v[168:169], v39 offset:12288
    v_mfma_f32_16x16x32_bf16 a[24:27], v[104:107], v[68:71], a[24:27]
    v_mfma_f32_16x16x32_bf16 a[40:43], v[104:107], v[72:75], a[40:43]
    ds_read_b64_tr_b16 v[170:171], v39 offset:12800
    v_mfma_f32_16x16x32_bf16 a[56:59], v[104:107], v[76:79], a[56:59]
    ds_read_b64_tr_b16 v[172:173], v40 offset:12288
    v_mfma_f32_16x16x32_bf16 a[72:75], v[104:107], v[80:83], a[72:75]
    ds_read_b64_tr_b16 v[174:175], v40 offset:12800
    v_mfma_f32_16x16x32_bf16 a[88:91], v[104:107], v[84:87], a[88:91]
    v_mfma_f32_16x16x32_bf16 a[104:107], v[104:107], v[88:91], a[104:107]
    v_mfma_f32_16x16x32_bf16 a[120:123], v[104:107], v[92:95], a[120:123]
    v_mfma_f32_16x16x32_bf16 a[12:15], v[108:111], v[64:67], a[12:15]
    v_mfma_f32_16x16x32_bf16 a[28:31], v[108:111], v[68:71], a[28:31]
    v_mfma_f32_16x16x32_bf16 a[44:47], v[108:111], v[72:75], a[44:47]
    v_mfma_f32_16x16x32_bf16 a[60:63], v[108:111], v[76:79], a[60:63]
    s_waitcnt vmcnt(12) lgkmcnt(0)
    s_barrier
    v_mfma_f32_16x16x32_bf16 a[76:79], v[108:111], v[80:83], a[76:79]
    v_mfma_f32_16x16x32_bf16 a[92:95], v[108:111], v[84:87], a[92:95]
    v_mfma_f32_16x16x32_bf16 a[108:111], v[108:111], v[88:91], a[108:111]
    v_mfma_f32_16x16x32_bf16 a[124:127], v[108:111], v[92:95], a[124:127]
    s_add_u32 s16, s16, 512
    s_add_u32 s17, s17, 131072
    s_waitcnt lgkmcnt(0)
    v_mfma_f32_16x16x32_bf16 a[0:3], v[160:163], v[128:131], a[0:3]
    s_add_u32 m0, s18, 49152
    ds_read_b64_tr_b16 v[96:97], v45 offset:0
    v_mfma_f32_16x16x32_bf16 a[16:19], v[160:163], v[132:135], a[16:19]
    buffer_load_dwordx4 v16, s[8:11], s16 offen sc1 lds
    v_mfma_f32_16x16x32_bf16 a[32:35], v[160:163], v[136:139], a[32:35]
    ds_read_b64_tr_b16 v[98:99], v45 offset:512
    v_mfma_f32_16x16x32_bf16 a[48:51], v[160:163], v[140:143], a[48:51]
    ds_read_b128 v[64:67], v44 offset:0
    v_mfma_f32_16x16x32_bf16 a[64:67], v[160:163], v[144:147], a[64:67]
    s_add_u32 m0, s19, 49152
    ds_read_b128 v[68:71], v44 offset:2048
    v_mfma_f32_16x16x32_bf16 a[80:83], v[160:163], v[148:151], a[80:83]
    buffer_load_dwordx4 v24, s[12:15], s17 offen  lds
    v_mfma_f32_16x16x32_bf16 a[96:99], v[160:163], v[152:155], a[96:99]
    ds_read_b128 v[72:75], v44 offset:4096
    v_mfma_f32_16x16x32_bf16 a[112:115], v[160:163], v[156:159], a[112:115]
    ds_read_b128 v[76:79], v44 offset:6144
    v_mfma_f32_16x16x32_bf16 a[4:7], v[164:167], v[128:131], a[4:7]
    s_add_u32 m0, s18, 50176
    ds_read_b128 v[80:83], v44 offset:8192
    v_mfma_f32_16x16x32_bf16 a[20:23], v[164:167], v[132:135], a[20:23]
    buffer_load_dwordx4 v17, s[8:11], s16 offen sc1 lds
    v_mfma_f32_16x16x32_bf16 a[36:39], v[164:167], v[136:139], a[36:39]
    ds_read_b128 v[84:87], v44 offset:10240
    v_mfma_f32_16x16x32_bf16 a[52:55], v[164:167], v[140:143], a[52:55]
    v_mfma_f32_16x16x32_bf16 a[68:71], v[164:167], v[144:147], a[68:71]
    s_add_u32 m0, s19, 50176
    ds_read_b128 v[88:91], v44 offset:12288
    v_mfma_f32_16x16x32_bf16 a[84:87], v[164:167], v[148:151], a[84:87]
    buffer_load_dwordx4 v25, s[12:15], s17 offen  lds
    v_mfma_f32_16x16x32_bf16 a[100:103], v[164:167], v[152:155], a[100:103]
    ds_read_b128 v[92:95], v44 offset:14336
    v_mfma_f32_16x16x32_bf16 a[116:119], v[164:167], v[156:159], a[116:119]
    ds_read_b64_tr_b16 v[100:101], v46 offset:0
    v_mfma_f32_16x16x32_bf16 a[8:11], v[168:171], v[128:131], a[8:11]
    s_add_u32 m0, s18, 51200
    ds_read_b64_tr_b16 v[102:103], v46 offset:512
    v_mfma_f32_16x16x32_bf16 a[24:27], v[168:171], v[132:135], a[24:27]
    buffer_load_dwordx4 v18, s[8:11], s16 offen sc1 lds
    v_mfma_f32_16x16x32_bf16 a[40:43], v[168:171], v[136:139], a[40:43]
    ds_read_b64_tr_b16 v[104:105], v45 offset:8192
    v_mfma_f32_16x16x32_bf16 a[56:59], v[168:171], v[140:143], a[56:59]
    ds_read_b64_tr_b16 v[106:107], v45 offset:8704
    v_mfma_f32_16x16x32_bf16 a[72:75], v[168:171], v[144:147], a[72:75]
    s_add_u32 m0, s19, 51200
    ds_read_b64_tr_b16 v[108:109], v46 offset:8192
    v_mfma_f32_16x16x32_bf16 a[88:91], v[168:171], v[148:151], a[88:91]
    buffer_load_dwordx4 v26, s[12:15], s17 offen  lds
    v_mfma_f32_16x16x32_bf16 a[104:107], v[168:171], v[152:155], a[104:107]
    ds_read_b64_tr_b16 v[110:111], v46 offset:8704
    v_mfma_f32_16x16x32_bf16 a[120:123], v[168:171], v[156:159], a[120:123]
    v_mfma_f32_16x16x32_bf16 a[12:15], v[172:175], v[128:131], a[12:15]
    s_add_u32 m0, s18, 52224
    v_mfma_f32_16x16x32_bf16 a[28:31], v[172:175], v[132:135], a[28:31]
    buffer_load_dwordx4 v19, s[8:11], s16 offen sc1 lds
    v_mfma_f32_16x16x32_bf16 a[44:47], v[172:175], v[136:139], a[44:47]
    v_mfma_f32_16x16x32_bf16 a[60:63], v[172:175], v[140:143], a[60:63]
    v_mfma_f32_16x16x32_bf16 a[76:79], v[172:175], v[144:147], a[76:79]
    s_add_u32 m0, s19, 52224
    v_mfma_f32_16x16x32_bf16 a[92:95], v[172:175], v[148:151], a[92:95]
    buffer_load_dwordx4 v27, s[12:15], s17 offen  lds
    v_mfma_f32_16x16x32_bf16 a[108:111], v[172:175], v[152:155], a[108:111]
    v_mfma_f32_16x16x32_bf16 a[124:127], v[172:175], v[156:159], a[124:127]
    s_waitcnt lgkmcnt(0)
    v_mfma_f32_16x16x32_bf16 a[0:3], v[96:99], v[64:67], a[0:3]
    s_add_u32 m0, s18, 53248
    ds_read_b64_tr_b16 v[160:161], v45 offset:4096
    v_mfma_f32_16x16x32_bf16 a[16:19], v[96:99], v[68:71], a[16:19]
    buffer_load_dwordx4 v20, s[8:11], s16 offen sc1 lds
    v_mfma_f32_16x16x32_bf16 a[32:35], v[96:99], v[72:75], a[32:35]
    ds_read_b64_tr_b16 v[162:163], v45 offset:4608
    v_mfma_f32_16x16x32_bf16 a[48:51], v[96:99], v[76:79], a[48:51]
    ds_read_b128 v[128:131], v44 offset:256
    v_mfma_f32_16x16x32_bf16 a[64:67], v[96:99], v[80:83], a[64:67]
    s_add_u32 m0, s18, 54272
    ds_read_b128 v[132:135], v44 offset:2304
    v_mfma_f32_16x16x32_bf16 a[80:83], v[96:99], v[84:87], a[80:83]
    buffer_load_dwordx4 v21, s[8:11], s16 offen sc1 lds
    v_mfma_f32_16x16x32_bf16 a[96:99], v[96:99], v[88:91], a[96:99]
    ds_read_b128 v[136:139], v44 offset:4352
    v_mfma_f32_16x16x32_bf16 a[112:115], v[96:99], v[92:95], a[112:115]
    ds_read_b128 v[140:143], v44 offset:6400
    v_mfma_f32_16x16x32_bf16 a[4:7], v[100:103], v[64:67], a[4:7]
    s_add_u32 m0, s18, 55296
    ds_read_b128 v[144:147], v44 offset:8448
    v_mfma_f32_16x16x32_bf16 a[20:23], v[100:103], v[68:71], a[20:23]
    buffer_load_dwordx4 v22, s[8:11], s16 offen sc1 lds
    v_mfma_f32_16x16x32_bf16 a[36:39], v[100:103], v[72:75], a[36:39]
    ds_read_b128 v[148:151], v44 offset:10496
    v_mfma_f32_16x16x32_bf16 a[52:55], v[100:103], v[76:79], a[52:55]
    ds_read_b128 v[152:155], v44 offset:12544
    v_mfma_f32_16x16x32_bf16 a[68:71], v[100:103], v[80:83], a[68:71]
    s_add_u32 m0, s18, 56320
    ds_read_b128 v[156:159], v44 offset:14592
    v_mfma_f32_16x16x32_bf16 a[84:87], v[100:103], v[84:87], a[84:87]
    buffer_load_dwordx4 v23, s[8:11], s16 offen sc1 lds
    v_mfma_f32_16x16x32_bf16 a[100:103], v[100:103], v[88:91], a[100:103]
    ds_read_b64_tr_b16 v[164:165], v46 offset:4096
    v_mfma_f32_16x16x32_bf16 a[116:119], v[100:103], v[92:95], a[116:119]
    ds_read_b64_tr_b16 v[166:167], v46 offset:4608
    v_mfma_f32_16x16x32_bf16 a[8:11], v[104:107], v[64:67], a[8:11]
    ds_read_b64_tr_b16 v[168:169], v45 offset:12288
    v_mfma_f32_16x16x32_bf16 a[24:27], v[104:107], v[68:71], a[24:27]
    v_mfma_f32_16x16x32_bf16 a[40:43], v[104:107], v[72:75], a[40:43]
    ds_read_b64_tr_b16 v[170:171], v45 offset:12800
    v_mfma_f32_16x16x32_bf16 a[56:59], v[104:107], v[76:79], a[56:59]
    ds_read_b64_tr_b16 v[172:173], v46 offset:12288
    v_mfma_f32_16x16x32_bf16 a[72:75], v[104:107], v[80:83], a[72:75]
    ds_read_b64_tr_b16 v[174:175], v46 offset:12800
    v_mfma_f32_16x16x32_bf16 a[88:91], v[104:107], v[84:87], a[88:91]
    v_mfma_f32_16x16x32_bf16 a[104:107], v[104:107], v[88:91], a[104:107]
    v_mfma_f32_16x16x32_bf16 a[120:123], v[104:107], v[92:95], a[120:123]
    v_mfma_f32_16x16x32_bf16 a[12:15], v[108:111], v[64:67], a[12:15]
    v_mfma_f32_16x16x32_bf16 a[28:31], v[108:111], v[68:71], a[28:31]
    v_mfma_f32_16x16x32_bf16 a[44:47], v[108:111], v[72:75], a[44:47]
    v_mfma_f32_16x16x32_bf16 a[60:63], v[108:111], v[76:79], a[60:63]
    s_waitcnt vmcnt(12) lgkmcnt(0)
    s_barrier
    v_mfma_f32_16x16x32_bf16 a[76:79], v[108:111], v[80:83], a[76:79]
    v_mfma_f32_16x16x32_bf16 a[92:95], v[108:111], v[84:87], a[92:95]
    v_mfma_f32_16x16x32_bf16 a[108:111], v[108:111], v[88:91], a[108:111]
    v_mfma_f32_16x16x32_bf16 a[124:127], v[108:111], v[92:95], a[124:127]
    s_add_u32 s16, s16, 512
    s_add_u32 s17, s17, 131072
    s_waitcnt lgkmcnt(0)
    v_mfma_f32_16x16x32_bf16 a[0:3], v[160:163], v[128:131], a[0:3]
    s_add_u32 m0, s18, 98304
    ds_read_b64_tr_b16 v[96:97], v33 offset:0
    v_mfma_f32_16x16x32_bf16 a[16:19], v[160:163], v[132:135], a[16:19]
    buffer_load_dwordx4 v16, s[8:11], s16 offen sc1 lds
    v_mfma_f32_16x16x32_bf16 a[32:35], v[160:163], v[136:139], a[32:35]
    ds_read_b64_tr_b16 v[98:99], v33 offset:512
    v_mfma_f32_16x16x32_bf16 a[48:51], v[160:163], v[140:143], a[48:51]
    ds_read_b128 v[64:67], v32 offset:0
    v_mfma_f32_16x16x32_bf16 a[64:67], v[160:163], v[144:147], a[64:67]
    s_add_u32 m0, s19, 98304
    ds_read_b128 v[68:71], v32 offset:2048
    v_mfma_f32_16x16x32_bf16 a[80:83], v[160:163], v[148:151], a[80:83]
    buffer_load_dwordx4 v24, s[12:15], s17 offen  lds
    v_mfma_f32_16x16x32_bf16 a[96:99], v[160:163], v[152:155], a[96:99]
    ds_read_b128 v[72:75], v32 offset:4096
    v_mfma_f32_16x16x32_bf16 a[112:115], v[160:163], v[156:159], a[112:115]
    ds_read_b128 v[76:79], v32 offset:6144
    v_mfma_f32_16x16x32_bf16 a[4:7], v[164:167], v[128:131], a[4:7]
    s_add_u32 m0, s18, 99328
    ds_read_b128 v[80:83], v32 offset:8192
    v_mfma_f32_16x16x32_bf16 a[20:23], v[164:167], v[132:135], a[20:23]
    buffer_load_dwordx4 v17, s[8:11], s16 offen sc1 lds
    v_mfma_f32_16x16x32_bf16 a[36:39], v[164:167], v[136:139], a[36:39]
    ds_read_b128 v[84:87], v32 offset:10240
    v_mfma_f32_16x16x32_bf16 a[52:55], v[164:167], v[140:143], a[52:55]
    v_mfma_f32_16x16x32_bf16 a[68:71], v[164:167], v[144:147], a[68:71]
    s_add_u32 m0, s19, 99328
    ds_read_b128 v[88:91], v32 offset:12288
    v_mfma_f32_16x16x32_bf16 a[84:87], v[164:167], v[148:151], a[84:87]
    buffer_load_dwordx4 v25, s[12:15], s17 offen  lds
    v_mfma_f32_16x16x32_bf16 a[100:103], v[164:167], v[152:155], a[100:103]
    ds_read_b128 v[92:95], v32 offset:14336
    v_mfma_f32_16x16x32_bf16 a[116:119], v[164:167], v[156:159], a[116:119]
    ds_read_b64_tr_b16 v[100:101], v34 offset:0
    v_mfma_f32_16x16x32_bf16 a[8:11], v[168:171], v[128:131], a[8:11]
    s_add_u32 m0, s18, 100352
    ds_read_b64_tr_b16 v[102:103], v34 offset:512
    v_mfma_f32_16x16x32_bf16 a[24:27], v[168:171], v[132:135], a[24:27]
    buffer_load_dwordx4 v18, s[8:11], s16 offen sc1 lds
    v_mfma_f32_16x16x32_bf16 a[40:43], v[168:171], v[136:139], a[40:43]
    ds_read_b64_tr_b16 v[104:105], v33 offset:8192
    v_mfma_f32_16x16x32_bf16 a[56:59], v[168:171], v[140:143], a[56:59]
    ds_read_b64_tr_b16 v[106:107], v33 offset:8704
    v_mfma_f32_16x16x32_bf16 a[72:75], v[168:171], v[144:147], a[72:75]
    s_add_u32 m0, s19, 100352
    ds_read_b64_tr_b16 v[108:109], v34 offset:8192
    v_mfma_f32_16x16x32_bf16 a[88:91], v[168:171], v[148:151], a[88:91]
    buffer_load_dwordx4 v26, s[12:15], s17 offen  lds
    v_mfma_f32_16x16x32_bf16 a[104:107], v[168:171], v[152:155], a[104:107]
    ds_read_b64_tr_b16 v[110:111], v34 offset:8704
    v_mfma_f32_16x16x32_bf16 a[120:123], v[168:171], v[156:159], a[120:123]
    v_mfma_f32_16x16x32_bf16 a[12:15], v[172:175], v[128:131], a[12:15]
    s_add_u32 m0, s18, 101376
    v_mfma_f32_16x16x32_bf16 a[28:31], v[172:175], v[132:135], a[28:31]
    buffer_load_dwordx4 v19, s[8:11], s16 offen sc1 lds
    v_mfma_f32_16x16x32_bf16 a[44:47], v[172:175], v[136:139], a[44:47]
    v_mfma_f32_16x16x32_bf16 a[60:63], v[172:175], v[140:143], a[60:63]
    v_mfma_f32_16x16x32_bf16 a[76:79], v[172:175], v[144:147], a[76:79]
    s_add_u32 m0, s19, 101376
    v_mfma_f32_16x16x32_bf16 a[92:95], v[172:175], v[148:151], a[92:95]
    buffer_load_dwordx4 v27, s[12:15], s17 offen  lds
    v_mfma_f32_16x16x32_bf16 a[108:111], v[172:175], v[152:155], a[108:111]
    v_mfma_f32_16x16x32_bf16 a[124:127], v[172:175], v[156:159], a[124:127]
    s_waitcnt lgkmcnt(0)
    v_mfma_f32_16x16x32_bf16 a[0:3], v[96:99], v[64:67], a[0:3]
    s_add_u32 m0, s18, 102400
    ds_read_b64_tr_b16 v[160:161], v33 offset:4096
    v_mfma_f32_16x16x32_bf16 a[16:19], v[96:99], v[68:71], a[16:19]
    buffer_load_dwordx4 v20, s[8:11], s16 offen sc1 lds
    v_mfma_f32_16x16x32_bf16 a[32:35], v[96:99], v[72:75], a[32:35]
    ds_read_b64_tr_b16 v[162:163], v33 offset:4608
    v_mfma_f32_16x16x32_bf16 a[48:51], v[96:99], v[76:79], a[48:51]
    ds_read_b128 v[128:131], v32 offset:256
    v_mfma_f32_16x16x32_bf16 a[64:67], v[96:99], v[80:83], a[64:67]
    s_add_u32 m0, s18, 103424
    ds_read_b128 v[132:135], v32 offset:2304
    v_mfma_f32_16x16x32_bf16 a[80:83], v[96:99], v[84:87], a[80:83]
    buffer_load_dwordx4 v21, s[8:11], s16 offen sc1 lds
    v_mfma_f32_16x16x32_bf16 a[96:99], v[96:99], v[88:91], a[96:99]
    ds_read_b128 v[136:139], v32 offset:4352
    v_mfma_f32_16x16x32_bf16 a[112:115], v[96:99], v[92:95], a[112:115]
    ds_read_b128 v[140:143], v32 offset:6400
    v_mfma_f32_16x16x32_bf16 a[4:7], v[100:103], v[64:67], a[4:7]
    s_add_u32 m0, s18, 104448
    ds_read_b128 v[144:147], v32 offset:8448
    v_mfma_f32_16x16x32_bf16 a[20:23], v[100:103], v[68:71], a[20:23]
    buffer_load_dwordx4 v22, s[8:11], s16 offen sc1 lds
    v_mfma_f32_16x16x32_bf16 a[36:39], v[100:103], v[72:75], a[36:39]
    ds_read_b128 v[148:151], v32 offset:10496
    v_mfma_f32_16x16x32_bf16 a[52:55], v[100:103], v[76:79], a[52:55]
    ds_read_b128 v[152:155], v32 offset:12544
    v_mfma_f32_16x16x32_bf16 a[68:71], v[100:103], v[80:83], a[68:71]
    s_add_u32 m0, s18, 105472
    ds_read_b128 v[156:159], v32 offset:14592
    v_mfma_f32_16x16x32_bf16 a[84:87], v[100:103], v[84:87], a[84:87]
    buffer_load_dwordx4 v23, s[8:11], s16 offen sc1 lds
    v_mfma_f32_16x16x32_bf16 a[100:103], v[100:103], v[88:91], a[100:103]
    ds_read_b64_tr_b16 v[164:165], v34 offset:4096
    v_mfma_f32_16x16x32_bf16 a[116:119], v[100:103], v[92:95], a[116:119]
    ds_read_b64_tr_b16 v[166:167], v34 offset:4608
    v_mfma_f32_16x16x32_bf16 a[8:11], v[104:107], v[64:67], a[8:11]
    ds_read_b64_tr_b16 v[168:169], v33 offset:12288
    v_mfma_f32_16x16x32_bf16 a[24:27], v[104:107], v[68:71], a[24:27]
    v_mfma_f32_16x16x32_bf16 a[40:43], v[104:107], v[72:75], a[40:43]
    ds_read_b64_tr_b16 v[170:171], v33 offset:12800
    v_mfma_f32_16x16x32_bf16 a[56:59], v[104:107], v[76:79], a[56:59]
    ds_read_b64_tr_b16 v[172:173], v34 offset:12288
    v_mfma_f32_16x16x32_bf16 a[72:75], v[104:107], v[80:83], a[72:75]
    ds_read_b64_tr_b16 v[174:175], v34 offset:12800
    v_mfma_f32_16x16x32_bf16 a[88:91], v[104:107], v[84:87], a[88:91]
    v_mfma_f32_16x16x32_bf16 a[104:107], v[104:107], v[88:91], a[104:107]
    v_mfma_f32_16x16x32_bf16 a[120:123], v[104:107], v[92:95], a[120:123]
    v_mfma_f32_16x16x32_bf16 a[12:15], v[108:111], v[64:67], a[12:15]
    v_mfma_f32_16x16x32_bf16 a[28:31], v[108:111], v[68:71], a[28:31]
    v_mfma_f32_16x16x32_bf16 a[44:47], v[108:111], v[72:75], a[44:47]
    v_mfma_f32_16x16x32_bf16 a[60:63], v[108:111], v[76:79], a[60:63]
    s_waitcnt vmcnt(12) lgkmcnt(0)
    s_barrier
    v_mfma_f32_16x16x32_bf16 a[76:79], v[108:111], v[80:83], a[76:79]
    v_mfma_f32_16x16x32_bf16 a[92:95], v[108:111], v[84:87], a[92:95]
    v_mfma_f32_16x16x32_bf16 a[108:111], v[108:111], v[88:91], a[108:111]
    v_mfma_f32_16x16x32_bf16 a[124:127], v[108:111], v[92:95], a[124:127]
    s_add_u32 s16, s16, 512
    s_add_u32 s17, s17, 131072
    s_sub_u32 s20, s20, 1
    s_cmp_lg_u32 s20, 0
    s_cbranch_scc1 Gdn_166
    s_waitcnt lgkmcnt(0)
    v_mfma_f32_16x16x32_bf16 a[0:3], v[160:163], v[128:131], a[0:3]
    s_add_u32 m0, s18, 0
    ds_read_b64_tr_b16 v[96:97], v39 offset:0
    v_mfma_f32_16x16x32_bf16 a[16:19], v[160:163], v[132:135], a[16:19]
    buffer_load_dwordx4 v16, s[8:11], s16 offen sc1 lds
    v_mfma_f32_16x16x32_bf16 a[32:35], v[160:163], v[136:139], a[32:35]
    ds_read_b64_tr_b16 v[98:99], v39 offset:512
    v_mfma_f32_16x16x32_bf16 a[48:51], v[160:163], v[140:143], a[48:51]
    ds_read_b128 v[64:67], v38 offset:0
    v_mfma_f32_16x16x32_bf16 a[64:67], v[160:163], v[144:147], a[64:67]
    s_add_u32 m0, s19, 0
    ds_read_b128 v[68:71], v38 offset:2048
    v_mfma_f32_16x16x32_bf16 a[80:83], v[160:163], v[148:151], a[80:83]
    buffer_load_dwordx4 v24, s[12:15], s17 offen  lds
    v_mfma_f32_16x16x32_bf16 a[96:99], v[160:163], v[152:155], a[96:99]
    ds_read_b128 v[72:75], v38 offset:4096
    v_mfma_f32_16x16x32_bf16 a[112:115], v[160:163], v[156:159], a[112:115]
    ds_read_b128 v[76:79], v38 offset:6144
    v_mfma_f32_16x16x32_bf16 a[4:7], v[164:167], v[128:131], a[4:7]
    s_add_u32 m0, s18, 1024
    ds_read_b128 v[80:83], v38 offset:8192
    v_mfma_f32_16x16x32_bf16 a[20:23], v[164:167], v[132:135], a[20:23]
    buffer_load_dwordx4 v17, s[8:11], s16 offen sc1 lds
    v_mfma_f32_16x16x32_bf16 a[36:39], v[164:167], v[136:139], a[36:39]
    ds_read_b128 v[84:87], v38 offset:10240
    v_mfma_f32_16x16x32_bf16 a[52:55], v[164:167], v[140:143], a[52:55]
    v_mfma_f32_16x16x32_bf16 a[68:71], v[164:167], v[144:147], a[68:71]
    s_add_u32 m0, s19, 1024
    ds_read_b128 v[88:91], v38 offset:12288
    v_mfma_f32_16x16x32_bf16 a[84:87], v[164:167], v[148:151], a[84:87]
    buffer_load_dwordx4 v25, s[12:15], s17 offen  lds
    v_mfma_f32_16x16x32_bf16 a[100:103], v[164:167], v[152:155], a[100:103]
    ds_read_b128 v[92:95], v38 offset:14336
    v_mfma_f32_16x16x32_bf16 a[116:119], v[164:167], v[156:159], a[116:119]
    ds_read_b64_tr_b16 v[100:101], v40 offset:0
    v_mfma_f32_16x16x32_bf16 a[8:11], v[168:171], v[128:131], a[8:11]
    s_add_u32 m0, s18, 2048
    ds_read_b64_tr_b16 v[102:103], v40 offset:512
    v_mfma_f32_16x16x32_bf16 a[24:27], v[168:171], v[132:135], a[24:27]
    buffer_load_dwordx4 v18, s[8:11], s16 offen sc1 lds
    v_mfma_f32_16x16x32_bf16 a[40:43], v[168:171], v[136:139], a[40:43]
    ds_read_b64_tr_b16 v[104:105], v39 offset:8192
    v_mfma_f32_16x16x32_bf16 a[56:59], v[168:171], v[140:143], a[56:59]
    ds_read_b64_tr_b16 v[106:107], v39 offset:8704
    v_mfma_f32_16x16x32_bf16 a[72:75], v[168:171], v[144:147], a[72:75]
    s_add_u32 m0, s19, 2048
    ds_read_b64_tr_b16 v[108:109], v40 offset:8192
    v_mfma_f32_16x16x32_bf16 a[88:91], v[168:171], v[148:151], a[88:91]
    buffer_load_dwordx4 v26, s[12:15], s17 offen  lds
    v_mfma_f32_16x16x32_bf16 a[104:107], v[168:171], v[152:155], a[104:107]
    ds_read_b64_tr_b16 v[110:111], v40 offset:8704
    v_mfma_f32_16x16x32_bf16 a[120:123], v[168:171], v[156:159], a[120:123]
    v_mfma_f32_16x16x32_bf16 a[12:15], v[172:175], v[128:131], a[12:15]
    s_add_u32 m0, s18, 3072
    v_mfma_f32_16x16x32_bf16 a[28:31], v[172:175], v[132:135], a[28:31]
    buffer_load_dwordx4 v19, s[8:11], s16 offen sc1 lds
    v_mfma_f32_16x16x32_bf16 a[44:47], v[172:175], v[136:139], a[44:47]
    v_mfma_f32_16x16x32_bf16 a[60:63], v[172:175], v[140:143], a[60:63]
    v_mfma_f32_16x16x32_bf16 a[76:79], v[172:175], v[144:147], a[76:79]
    s_add_u32 m0, s19, 3072
    v_mfma_f32_16x16x32_bf16 a[92:95], v[172:175], v[148:151], a[92:95]
    buffer_load_dwordx4 v27, s[12:15], s17 offen  lds
    v_mfma_f32_16x16x32_bf16 a[108:111], v[172:175], v[152:155], a[108:111]
    v_mfma_f32_16x16x32_bf16 a[124:127], v[172:175], v[156:159], a[124:127]
    s_waitcnt lgkmcnt(0)
    v_mfma_f32_16x16x32_bf16 a[0:3], v[96:99], v[64:67], a[0:3]
    s_add_u32 m0, s18, 4096
    ds_read_b64_tr_b16 v[160:161], v39 offset:4096
    v_mfma_f32_16x16x32_bf16 a[16:19], v[96:99], v[68:71], a[16:19]
    buffer_load_dwordx4 v20, s[8:11], s16 offen sc1 lds
    v_mfma_f32_16x16x32_bf16 a[32:35], v[96:99], v[72:75], a[32:35]
    ds_read_b64_tr_b16 v[162:163], v39 offset:4608
    v_mfma_f32_16x16x32_bf16 a[48:51], v[96:99], v[76:79], a[48:51]
    ds_read_b128 v[128:131], v38 offset:256
    v_mfma_f32_16x16x32_bf16 a[64:67], v[96:99], v[80:83], a[64:67]
    s_add_u32 m0, s18, 5120
    ds_read_b128 v[132:135], v38 offset:2304
    v_mfma_f32_16x16x32_bf16 a[80:83], v[96:99], v[84:87], a[80:83]
    buffer_load_dwordx4 v21, s[8:11], s16 offen sc1 lds
    v_mfma_f32_16x16x32_bf16 a[96:99], v[96:99], v[88:91], a[96:99]
    ds_read_b128 v[136:139], v38 offset:4352
    v_mfma_f32_16x16x32_bf16 a[112:115], v[96:99], v[92:95], a[112:115]
    ds_read_b128 v[140:143], v38 offset:6400
    v_mfma_f32_16x16x32_bf16 a[4:7], v[100:103], v[64:67], a[4:7]
    s_add_u32 m0, s18, 6144
    ds_read_b128 v[144:147], v38 offset:8448
    v_mfma_f32_16x16x32_bf16 a[20:23], v[100:103], v[68:71], a[20:23]
    buffer_load_dwordx4 v22, s[8:11], s16 offen sc1 lds
    v_mfma_f32_16x16x32_bf16 a[36:39], v[100:103], v[72:75], a[36:39]
    ds_read_b128 v[148:151], v38 offset:10496
    v_mfma_f32_16x16x32_bf16 a[52:55], v[100:103], v[76:79], a[52:55]
    ds_read_b128 v[152:155], v38 offset:12544
    v_mfma_f32_16x16x32_bf16 a[68:71], v[100:103], v[80:83], a[68:71]
    s_add_u32 m0, s18, 7168
    ds_read_b128 v[156:159], v38 offset:14592
    v_mfma_f32_16x16x32_bf16 a[84:87], v[100:103], v[84:87], a[84:87]
    buffer_load_dwordx4 v23, s[8:11], s16 offen sc1 lds
    v_mfma_f32_16x16x32_bf16 a[100:103], v[100:103], v[88:91], a[100:103]
    ds_read_b64_tr_b16 v[164:165], v40 offset:4096
    v_mfma_f32_16x16x32_bf16 a[116:119], v[100:103], v[92:95], a[116:119]
    ds_read_b64_tr_b16 v[166:167], v40 offset:4608
    v_mfma_f32_16x16x32_bf16 a[8:11], v[104:107], v[64:67], a[8:11]
    ds_read_b64_tr_b16 v[168:169], v39 offset:12288
    v_mfma_f32_16x16x32_bf16 a[24:27], v[104:107], v[68:71], a[24:27]
    v_mfma_f32_16x16x32_bf16 a[40:43], v[104:107], v[72:75], a[40:43]
    ds_read_b64_tr_b16 v[170:171], v39 offset:12800
    v_mfma_f32_16x16x32_bf16 a[56:59], v[104:107], v[76:79], a[56:59]
    ds_read_b64_tr_b16 v[172:173], v40 offset:12288
    v_mfma_f32_16x16x32_bf16 a[72:75], v[104:107], v[80:83], a[72:75]
    ds_read_b64_tr_b16 v[174:175], v40 offset:12800
    v_mfma_f32_16x16x32_bf16 a[88:91], v[104:107], v[84:87], a[88:91]
    v_mfma_f32_16x16x32_bf16 a[104:107], v[104:107], v[88:91], a[104:107]
    v_mfma_f32_16x16x32_bf16 a[120:123], v[104:107], v[92:95], a[120:123]
    v_mfma_f32_16x16x32_bf16 a[12:15], v[108:111], v[64:67], a[12:15]
    v_mfma_f32_16x16x32_bf16 a[28:31], v[108:111], v[68:71], a[28:31]
    v_mfma_f32_16x16x32_bf16 a[44:47], v[108:111], v[72:75], a[44:47]
    v_mfma_f32_16x16x32_bf16 a[60:63], v[108:111], v[76:79], a[60:63]
    s_waitcnt vmcnt(12) lgkmcnt(0)
    s_barrier
    v_mfma_f32_16x16x32_bf16 a[76:79], v[108:111], v[80:83], a[76:79]
    v_mfma_f32_16x16x32_bf16 a[92:95], v[108:111], v[84:87], a[92:95]
    v_mfma_f32_16x16x32_bf16 a[108:111], v[108:111], v[88:91], a[108:111]
    v_mfma_f32_16x16x32_bf16 a[124:127], v[108:111], v[92:95], a[124:127]
    s_add_u32 s16, s16, 512
    s_add_u32 s17, s17, 131072
    s_waitcnt lgkmcnt(0)
    v_mfma_f32_16x16x32_bf16 a[0:3], v[160:163], v[128:131], a[0:3]
    s_add_u32 m0, s18, 49152
    ds_read_b64_tr_b16 v[96:97], v45 offset:0
    v_mfma_f32_16x16x32_bf16 a[16:19], v[160:163], v[132:135], a[16:19]
    buffer_load_dwordx4 v16, s[8:11], s16 offen sc1 lds
    v_mfma_f32_16x16x32_bf16 a[32:35], v[160:163], v[136:139], a[32:35]
    ds_read_b64_tr_b16 v[98:99], v45 offset:512
    v_mfma_f32_16x16x32_bf16 a[48:51], v[160:163], v[140:143], a[48:51]
    ds_read_b128 v[64:67], v44 offset:0
    v_mfma_f32_16x16x32_bf16 a[64:67], v[160:163], v[144:147], a[64:67]
    s_add_u32 m0, s19, 49152
    ds_read_b128 v[68:71], v44 offset:2048
    v_mfma_f32_16x16x32_bf16 a[80:83], v[160:163], v[148:151], a[80:83]
    buffer_load_dwordx4 v24, s[12:15], s17 offen  lds
    v_mfma_f32_16x16x32_bf16 a[96:99], v[160:163], v[152:155], a[96:99]
    ds_read_b128 v[72:75], v44 offset:4096
    v_mfma_f32_16x16x32_bf16 a[112:115], v[160:163], v[156:159], a[112:115]
    ds_read_b128 v[76:79], v44 offset:6144
    v_mfma_f32_16x16x32_bf16 a[4:7], v[164:167], v[128:131], a[4:7]
    s_add_u32 m0, s18, 50176
    ds_read_b128 v[80:83], v44 offset:8192
    v_mfma_f32_16x16x32_bf16 a[20:23], v[164:167], v[132:135], a[20:23]
    buffer_load_dwordx4 v17, s[8:11], s16 offen sc1 lds
    v_mfma_f32_16x16x32_bf16 a[36:39], v[164:167], v[136:139], a[36:39]
    ds_read_b128 v[84:87], v44 offset:10240
    v_mfma_f32_16x16x32_bf16 a[52:55], v[164:167], v[140:143], a[52:55]
    v_mfma_f32_16x16x32_bf16 a[68:71], v[164:167], v[144:147], a[68:71]
    s_add_u32 m0, s19, 50176
    ds_read_b128 v[88:91], v44 offset:12288
    v_mfma_f32_16x16x32_bf16 a[84:87], v[164:167], v[148:151], a[84:87]
    buffer_load_dwordx4 v25, s[12:15], s17 offen  lds
    v_mfma_f32_16x16x32_bf16 a[100:103], v[164:167], v[152:155], a[100:103]
    ds_read_b128 v[92:95], v44 offset:14336
    v_mfma_f32_16x16x32_bf16 a[116:119], v[164:167], v[156:159], a[116:119]
    ds_read_b64_tr_b16 v[100:101], v46 offset:0
    v_mfma_f32_16x16x32_bf16 a[8:11], v[168:171], v[128:131], a[8:11]
    s_add_u32 m0, s18, 51200
    ds_read_b64_tr_b16 v[102:103], v46 offset:512
    v_mfma_f32_16x16x32_bf16 a[24:27], v[168:171], v[132:135], a[24:27]
    buffer_load_dwordx4 v18, s[8:11], s16 offen sc1 lds
    v_mfma_f32_16x16x32_bf16 a[40:43], v[168:171], v[136:139], a[40:43]
    ds_read_b64_tr_b16 v[104:105], v45 offset:8192
    v_mfma_f32_16x16x32_bf16 a[56:59], v[168:171], v[140:143], a[56:59]
    ds_read_b64_tr_b16 v[106:107], v45 offset:8704
    v_mfma_f32_16x16x32_bf16 a[72:75], v[168:171], v[144:147], a[72:75]
    s_add_u32 m0, s19, 51200
    ds_read_b64_tr_b16 v[108:109], v46 offset:8192
    v_mfma_f32_16x16x32_bf16 a[88:91], v[168:171], v[148:151], a[88:91]
    buffer_load_dwordx4 v26, s[12:15], s17 offen  lds
    v_mfma_f32_16x16x32_bf16 a[104:107], v[168:171], v[152:155], a[104:107]
    ds_read_b64_tr_b16 v[110:111], v46 offset:8704
    v_mfma_f32_16x16x32_bf16 a[120:123], v[168:171], v[156:159], a[120:123]
    v_mfma_f32_16x16x32_bf16 a[12:15], v[172:175], v[128:131], a[12:15]
    s_add_u32 m0, s18, 52224
    v_mfma_f32_16x16x32_bf16 a[28:31], v[172:175], v[132:135], a[28:31]
    buffer_load_dwordx4 v19, s[8:11], s16 offen sc1 lds
    v_mfma_f32_16x16x32_bf16 a[44:47], v[172:175], v[136:139], a[44:47]
    v_mfma_f32_16x16x32_bf16 a[60:63], v[172:175], v[140:143], a[60:63]
    v_mfma_f32_16x16x32_bf16 a[76:79], v[172:175], v[144:147], a[76:79]
    s_add_u32 m0, s19, 52224
    v_mfma_f32_16x16x32_bf16 a[92:95], v[172:175], v[148:151], a[92:95]
    buffer_load_dwordx4 v27, s[12:15], s17 offen  lds
    v_mfma_f32_16x16x32_bf16 a[108:111], v[172:175], v[152:155], a[108:111]
    v_mfma_f32_16x16x32_bf16 a[124:127], v[172:175], v[156:159], a[124:127]
    s_waitcnt lgkmcnt(0)
    v_mfma_f32_16x16x32_bf16 a[0:3], v[96:99], v[64:67], a[0:3]
    s_add_u32 m0, s18, 53248
    ds_read_b64_tr_b16 v[160:161], v45 offset:4096
    v_mfma_f32_16x16x32_bf16 a[16:19], v[96:99], v[68:71], a[16:19]
    buffer_load_dwordx4 v20, s[8:11], s16 offen sc1 lds
    v_mfma_f32_16x16x32_bf16 a[32:35], v[96:99], v[72:75], a[32:35]
    ds_read_b64_tr_b16 v[162:163], v45 offset:4608
    v_mfma_f32_16x16x32_bf16 a[48:51], v[96:99], v[76:79], a[48:51]
    ds_read_b128 v[128:131], v44 offset:256
    v_mfma_f32_16x16x32_bf16 a[64:67], v[96:99], v[80:83], a[64:67]
    s_add_u32 m0, s18, 54272
    ds_read_b128 v[132:135], v44 offset:2304
    v_mfma_f32_16x16x32_bf16 a[80:83], v[96:99], v[84:87], a[80:83]
    buffer_load_dwordx4 v21, s[8:11], s16 offen sc1 lds
    v_mfma_f32_16x16x32_bf16 a[96:99], v[96:99], v[88:91], a[96:99]
    ds_read_b128 v[136:139], v44 offset:4352
    v_mfma_f32_16x16x32_bf16 a[112:115], v[96:99], v[92:95], a[112:115]
    ds_read_b128 v[140:143], v44 offset:6400
    v_mfma_f32_16x16x32_bf16 a[4:7], v[100:103], v[64:67], a[4:7]
    s_add_u32 m0, s18, 55296
    ds_read_b128 v[144:147], v44 offset:8448
    v_mfma_f32_16x16x32_bf16 a[20:23], v[100:103], v[68:71], a[20:23]
    buffer_load_dwordx4 v22, s[8:11], s16 offen sc1 lds
    v_mfma_f32_16x16x32_bf16 a[36:39], v[100:103], v[72:75], a[36:39]
    ds_read_b128 v[148:151], v44 offset:10496
    v_mfma_f32_16x16x32_bf16 a[52:55], v[100:103], v[76:79], a[52:55]
    ds_read_b128 v[152:155], v44 offset:12544
    v_mfma_f32_16x16x32_bf16 a[68:71], v[100:103], v[80:83], a[68:71]
    s_add_u32 m0, s18, 56320
    ds_read_b128 v[156:159], v44 offset:14592
    v_mfma_f32_16x16x32_bf16 a[84:87], v[100:103], v[84:87], a[84:87]
    buffer_load_dwordx4 v23, s[8:11], s16 offen sc1 lds
    v_mfma_f32_16x16x32_bf16 a[100:103], v[100:103], v[88:91], a[100:103]
    ds_read_b64_tr_b16 v[164:165], v46 offset:4096
    v_mfma_f32_16x16x32_bf16 a[116:119], v[100:103], v[92:95], a[116:119]
    ds_read_b64_tr_b16 v[166:167], v46 offset:4608
    v_mfma_f32_16x16x32_bf16 a[8:11], v[104:107], v[64:67], a[8:11]
    ds_read_b64_tr_b16 v[168:169], v45 offset:12288
    v_mfma_f32_16x16x32_bf16 a[24:27], v[104:107], v[68:71], a[24:27]
    v_mfma_f32_16x16x32_bf16 a[40:43], v[104:107], v[72:75], a[40:43]
    ds_read_b64_tr_b16 v[170:171], v45 offset:12800
    v_mfma_f32_16x16x32_bf16 a[56:59], v[104:107], v[76:79], a[56:59]
    ds_read_b64_tr_b16 v[172:173], v46 offset:12288
    v_mfma_f32_16x16x32_bf16 a[72:75], v[104:107], v[80:83], a[72:75]
    ds_read_b64_tr_b16 v[174:175], v46 offset:12800
    v_mfma_f32_16x16x32_bf16 a[88:91], v[104:107], v[84:87], a[88:91]
    v_mfma_f32_16x16x32_bf16 a[104:107], v[104:107], v[88:91], a[104:107]
    v_mfma_f32_16x16x32_bf16 a[120:123], v[104:107], v[92:95], a[120:123]
    v_mfma_f32_16x16x32_bf16 a[12:15], v[108:111], v[64:67], a[12:15]
    v_mfma_f32_16x16x32_bf16 a[28:31], v[108:111], v[68:71], a[28:31]
    v_mfma_f32_16x16x32_bf16 a[44:47], v[108:111], v[72:75], a[44:47]
    v_mfma_f32_16x16x32_bf16 a[60:63], v[108:111], v[76:79], a[60:63]
    s_waitcnt vmcnt(12) lgkmcnt(0)
    s_barrier
    v_mfma_f32_16x16x32_bf16 a[76:79], v[108:111], v[80:83], a[76:79]
    v_mfma_f32_16x16x32_bf16 a[92:95], v[108:111], v[84:87], a[92:95]
    v_mfma_f32_16x16x32_bf16 a[108:111], v[108:111], v[88:91], a[108:111]
    v_mfma_f32_16x16x32_bf16 a[124:127], v[108:111], v[92:95], a[124:127]
    s_add_u32 s16, s16, 512
    s_add_u32 s17, s17, 131072
    s_waitcnt lgkmcnt(0)
    v_mfma_f32_16x16x32_bf16 a[0:3], v[160:163], v[128:131], a[0:3]
    ds_read_b64_tr_b16 v[96:97], v33 offset:0
    v_mfma_f32_16x16x32_bf16 a[16:19], v[160:163], v[132:135], a[16:19]
    v_mfma_f32_16x16x32_bf16 a[32:35], v[160:163], v[136:139], a[32:35]
    ds_read_b64_tr_b16 v[98:99], v33 offset:512
    v_mfma_f32_16x16x32_bf16 a[48:51], v[160:163], v[140:143], a[48:51]
    ds_read_b128 v[64:67], v32 offset:0
    v_mfma_f32_16x16x32_bf16 a[64:67], v[160:163], v[144:147], a[64:67]
    ds_read_b128 v[68:71], v32 offset:2048
    v_mfma_f32_16x16x32_bf16 a[80:83], v[160:163], v[148:151], a[80:83]
    v_mfma_f32_16x16x32_bf16 a[96:99], v[160:163], v[152:155], a[96:99]
    ds_read_b128 v[72:75], v32 offset:4096
    v_mfma_f32_16x16x32_bf16 a[112:115], v[160:163], v[156:159], a[112:115]
    ds_read_b128 v[76:79], v32 offset:6144
    v_mfma_f32_16x16x32_bf16 a[4:7], v[164:167], v[128:131], a[4:7]
    ds_read_b128 v[80:83], v32 offset:8192
    v_mfma_f32_16x16x32_bf16 a[20:23], v[164:167], v[132:135], a[20:23]
    v_mfma_f32_16x16x32_bf16 a[36:39], v[164:167], v[136:139], a[36:39]
    ds_read_b128 v[84:87], v32 offset:10240
    v_mfma_f32_16x16x32_bf16 a[52:55], v[164:167], v[140:143], a[52:55]
    v_mfma_f32_16x16x32_bf16 a[68:71], v[164:167], v[144:147], a[68:71]
    ds_read_b128 v[88:91], v32 offset:12288
    v_mfma_f32_16x16x32_bf16 a[84:87], v[164:167], v[148:151], a[84:87]
    v_mfma_f32_16x16x32_bf16 a[100:103], v[164:167], v[152:155], a[100:103]
    ds_read_b128 v[92:95], v32 offset:14336
    v_mfma_f32_16x16x32_bf16 a[116:119], v[164:167], v[156:159], a[116:119]
    ds_read_b64_tr_b16 v[100:101], v34 offset:0
    v_mfma_f32_16x16x32_bf16 a[8:11], v[168:171], v[128:131], a[8:11]
    ds_read_b64_tr_b16 v[102:103], v34 offset:512
    v_mfma_f32_16x16x32_bf16 a[24:27], v[168:171], v[132:135], a[24:27]
    v_mfma_f32_16x16x32_bf16 a[40:43], v[168:171], v[136:139], a[40:43]
    ds_read_b64_tr_b16 v[104:105], v33 offset:8192
    v_mfma_f32_16x16x32_bf16 a[56:59], v[168:171], v[140:143], a[56:59]
    ds_read_b64_tr_b16 v[106:107], v33 offset:8704
    v_mfma_f32_16x16x32_bf16 a[72:75], v[168:171], v[144:147], a[72:75]
    ds_read_b64_tr_b16 v[108:109], v34 offset:8192
    v_mfma_f32_16x16x32_bf16 a[88:91], v[168:171], v[148:151], a[88:91]
    v_mfma_f32_16x16x32_bf16 a[104:107], v[168:171], v[152:155], a[104:107]
    ds_read_b64_tr_b16 v[110:111], v34 offset:8704
    v_mfma_f32_16x16x32_bf16 a[120:123], v[168:171], v[156:159], a[120:123]
    v_mfma_f32_16x16x32_bf16 a[12:15], v[172:175], v[128:131], a[12:15]
    v_mfma_f32_16x16x32_bf16 a[28:31], v[172:175], v[132:135], a[28:31]
    v_mfma_f32_16x16x32_bf16 a[44:47], v[172:175], v[136:139], a[44:47]
    v_mfma_f32_16x16x32_bf16 a[60:63], v[172:175], v[140:143], a[60:63]
    v_mfma_f32_16x16x32_bf16 a[76:79], v[172:175], v[144:147], a[76:79]
    v_mfma_f32_16x16x32_bf16 a[92:95], v[172:175], v[148:151], a[92:95]
    v_mfma_f32_16x16x32_bf16 a[108:111], v[172:175], v[152:155], a[108:111]
    v_mfma_f32_16x16x32_bf16 a[124:127], v[172:175], v[156:159], a[124:127]
    s_waitcnt lgkmcnt(0)
    v_mfma_f32_16x16x32_bf16 a[0:3], v[96:99], v[64:67], a[0:3]
    ds_read_b64_tr_b16 v[160:161], v33 offset:4096
    v_mfma_f32_16x16x32_bf16 a[16:19], v[96:99], v[68:71], a[16:19]
    v_mfma_f32_16x16x32_bf16 a[32:35], v[96:99], v[72:75], a[32:35]
    ds_read_b64_tr_b16 v[162:163], v33 offset:4608
    v_mfma_f32_16x16x32_bf16 a[48:51], v[96:99], v[76:79], a[48:51]
    ds_read_b128 v[128:131], v32 offset:256
    v_mfma_f32_16x16x32_bf16 a[64:67], v[96:99], v[80:83], a[64:67]
    ds_read_b128 v[132:135], v32 offset:2304
    v_mfma_f32_16x16x32_bf16 a[80:83], v[96:99], v[84:87], a[80:83]
    v_mfma_f32_16x16x32_bf16 a[96:99], v[96:99], v[88:91], a[96:99]
    ds_read_b128 v[136:139], v32 offset:4352
    v_mfma_f32_16x16x32_bf16 a[112:115], v[96:99], v[92:95], a[112:115]
    ds_read_b128 v[140:143], v32 offset:6400
    v_mfma_f32_16x16x32_bf16 a[4:7], v[100:103], v[64:67], a[4:7]
    ds_read_b128 v[144:147], v32 offset:8448
    v_mfma_f32_16x16x32_bf16 a[20:23], v[100:103], v[68:71], a[20:23]
    v_mfma_f32_16x16x32_bf16 a[36:39], v[100:103], v[72:75], a[36:39]
    ds_read_b128 v[148:151], v32 offset:10496
    v_mfma_f32_16x16x32_bf16 a[52:55], v[100:103], v[76:79], a[52:55]
    ds_read_b128 v[152:155], v32 offset:12544
    v_mfma_f32_16x16x32_bf16 a[68:71], v[100:103], v[80:83], a[68:71]
    ds_read_b128 v[156:159], v32 offset:14592
    v_mfma_f32_16x16x32_bf16 a[84:87], v[100:103], v[84:87], a[84:87]
    v_mfma_f32_16x16x32_bf16 a[100:103], v[100:103], v[88:91], a[100:103]
    ds_read_b64_tr_b16 v[164:165], v34 offset:4096
    v_mfma_f32_16x16x32_bf16 a[116:119], v[100:103], v[92:95], a[116:119]
    ds_read_b64_tr_b16 v[166:167], v34 offset:4608
    v_mfma_f32_16x16x32_bf16 a[8:11], v[104:107], v[64:67], a[8:11]
    ds_read_b64_tr_b16 v[168:169], v33 offset:12288
    v_mfma_f32_16x16x32_bf16 a[24:27], v[104:107], v[68:71], a[24:27]
    v_mfma_f32_16x16x32_bf16 a[40:43], v[104:107], v[72:75], a[40:43]
    ds_read_b64_tr_b16 v[170:171], v33 offset:12800
    v_mfma_f32_16x16x32_bf16 a[56:59], v[104:107], v[76:79], a[56:59]
    ds_read_b64_tr_b16 v[172:173], v34 offset:12288
    v_mfma_f32_16x16x32_bf16 a[72:75], v[104:107], v[80:83], a[72:75]
    ds_read_b64_tr_b16 v[174:175], v34 offset:12800
    v_mfma_f32_16x16x32_bf16 a[88:91], v[104:107], v[84:87], a[88:91]
    v_mfma_f32_16x16x32_bf16 a[104:107], v[104:107], v[88:91], a[104:107]
    v_mfma_f32_16x16x32_bf16 a[120:123], v[104:107], v[92:95], a[120:123]
    v_mfma_f32_16x16x32_bf16 a[12:15], v[108:111], v[64:67], a[12:15]
    v_mfma_f32_16x16x32_bf16 a[28:31], v[108:111], v[68:71], a[28:31]
    v_mfma_f32_16x16x32_bf16 a[44:47], v[108:111], v[72:75], a[44:47]
    v_mfma_f32_16x16x32_bf16 a[60:63], v[108:111], v[76:79], a[60:63]
    s_waitcnt vmcnt(0) lgkmcnt(0)
    s_barrier
    v_mfma_f32_16x16x32_bf16 a[76:79], v[108:111], v[80:83], a[76:79]
    v_mfma_f32_16x16x32_bf16 a[92:95], v[108:111], v[84:87], a[92:95]
    v_mfma_f32_16x16x32_bf16 a[108:111], v[108:111], v[88:91], a[108:111]
    v_mfma_f32_16x16x32_bf16 a[124:127], v[108:111], v[92:95], a[124:127]
    s_cmp_lg_u32 s3, 0
    s_cbranch_scc1 Ht_167
    v_mov_b32 v14, 1
    s_mov_b64 exec, 1
    buffer_atomic_add v14, off, s[92:95], s97 sc0 sc1
    s_mov_b64 exec, -1
Ht_167:
    s_waitcnt lgkmcnt(0)
    v_mfma_f32_16x16x32_bf16 a[0:3], v[160:163], v[128:131], a[0:3]
    ds_read_b64_tr_b16 v[96:97], v39 offset:0
    v_mfma_f32_16x16x32_bf16 a[16:19], v[160:163], v[132:135], a[16:19]
    v_mfma_f32_16x16x32_bf16 a[32:35], v[160:163], v[136:139], a[32:35]
    ds_read_b64_tr_b16 v[98:99], v39 offset:512
    v_mfma_f32_16x16x32_bf16 a[48:51], v[160:163], v[140:143], a[48:51]
    ds_read_b128 v[64:67], v38 offset:0
    v_mfma_f32_16x16x32_bf16 a[64:67], v[160:163], v[144:147], a[64:67]
    ds_read_b128 v[68:71], v38 offset:2048
    v_mfma_f32_16x16x32_bf16 a[80:83], v[160:163], v[148:151], a[80:83]
    v_mfma_f32_16x16x32_bf16 a[96:99], v[160:163], v[152:155], a[96:99]
    ds_read_b128 v[72:75], v38 offset:4096
    v_mfma_f32_16x16x32_bf16 a[112:115], v[160:163], v[156:159], a[112:115]
    ds_read_b128 v[76:79], v38 offset:6144
    v_mfma_f32_16x16x32_bf16 a[4:7], v[164:167], v[128:131], a[4:7]
    ds_read_b128 v[80:83], v38 offset:8192
    v_mfma_f32_16x16x32_bf16 a[20:23], v[164:167], v[132:135], a[20:23]
    v_mfma_f32_16x16x32_bf16 a[36:39], v[164:167], v[136:139], a[36:39]
    ds_read_b128 v[84:87], v38 offset:10240
    v_mfma_f32_16x16x32_bf16 a[52:55], v[164:167], v[140:143], a[52:55]
    v_mfma_f32_16x16x32_bf16 a[68:71], v[164:167], v[144:147], a[68:71]
    ds_read_b128 v[88:91], v38 offset:12288
    v_mfma_f32_16x16x32_bf16 a[84:87], v[164:167], v[148:151], a[84:87]
    v_mfma_f32_16x16x32_bf16 a[100:103], v[164:167], v[152:155], a[100:103]
    ds_read_b128 v[92:95], v38 offset:14336
    v_mfma_f32_16x16x32_bf16 a[116:119], v[164:167], v[156:159], a[116:119]
    ds_read_b64_tr_b16 v[100:101], v40 offset:0
    v_mfma_f32_16x16x32_bf16 a[8:11], v[168:171], v[128:131], a[8:11]
    ds_read_b64_tr_b16 v[102:103], v40 offset:512
    v_mfma_f32_16x16x32_bf16 a[24:27], v[168:171], v[132:135], a[24:27]
    v_mfma_f32_16x16x32_bf16 a[40:43], v[168:171], v[136:139], a[40:43]
    ds_read_b64_tr_b16 v[104:105], v39 offset:8192
    v_mfma_f32_16x16x32_bf16 a[56:59], v[168:171], v[140:143], a[56:59]
    ds_read_b64_tr_b16 v[106:107], v39 offset:8704
    v_mfma_f32_16x16x32_bf16 a[72:75], v[168:171], v[144:147], a[72:75]
    ds_read_b64_tr_b16 v[108:109], v40 offset:8192
    v_mfma_f32_16x16x32_bf16 a[88:91], v[168:171], v[148:151], a[88:91]
    v_mfma_f32_16x16x32_bf16 a[104:107], v[168:171], v[152:155], a[104:107]
    ds_read_b64_tr_b16 v[110:111], v40 offset:8704
    v_mfma_f32_16x16x32_bf16 a[120:123], v[168:171], v[156:159], a[120:123]
    v_mfma_f32_16x16x32_bf16 a[12:15], v[172:175], v[128:131], a[12:15]
    v_mfma_f32_16x16x32_bf16 a[28:31], v[172:175], v[132:135], a[28:31]
    v_mfma_f32_16x16x32_bf16 a[44:47], v[172:175], v[136:139], a[44:47]
    v_mfma_f32_16x16x32_bf16 a[60:63], v[172:175], v[140:143], a[60:63]
    v_mfma_f32_16x16x32_bf16 a[76:79], v[172:175], v[144:147], a[76:79]
    v_mfma_f32_16x16x32_bf16 a[92:95], v[172:175], v[148:151], a[92:95]
    v_mfma_f32_16x16x32_bf16 a[108:111], v[172:175], v[152:155], a[108:111]
    v_mfma_f32_16x16x32_bf16 a[124:127], v[172:175], v[156:159], a[124:127]
    s_waitcnt lgkmcnt(0)
    v_mfma_f32_16x16x32_bf16 a[0:3], v[96:99], v[64:67], a[0:3]
    ds_read_b64_tr_b16 v[160:161], v39 offset:4096
    v_mfma_f32_16x16x32_bf16 a[16:19], v[96:99], v[68:71], a[16:19]
    v_mfma_f32_16x16x32_bf16 a[32:35], v[96:99], v[72:75], a[32:35]
    ds_read_b64_tr_b16 v[162:163], v39 offset:4608
    v_mfma_f32_16x16x32_bf16 a[48:51], v[96:99], v[76:79], a[48:51]
    ds_read_b128 v[128:131], v38 offset:256
    v_mfma_f32_16x16x32_bf16 a[64:67], v[96:99], v[80:83], a[64:67]
    ds_read_b128 v[132:135], v38 offset:2304
    v_mfma_f32_16x16x32_bf16 a[80:83], v[96:99], v[84:87], a[80:83]
    v_mfma_f32_16x16x32_bf16 a[96:99], v[96:99], v[88:91], a[96:99]
    ds_read_b128 v[136:139], v38 offset:4352
    v_mfma_f32_16x16x32_bf16 a[112:115], v[96:99], v[92:95], a[112:115]
    ds_read_b128 v[140:143], v38 offset:6400
    v_mfma_f32_16x16x32_bf16 a[4:7], v[100:103], v[64:67], a[4:7]
    ds_read_b128 v[144:147], v38 offset:8448
    v_mfma_f32_16x16x32_bf16 a[20:23], v[100:103], v[68:71], a[20:23]
    v_mfma_f32_16x16x32_bf16 a[36:39], v[100:103], v[72:75], a[36:39]
    ds_read_b128 v[148:151], v38 offset:10496
    v_mfma_f32_16x16x32_bf16 a[52:55], v[100:103], v[76:79], a[52:55]
    ds_read_b128 v[152:155], v38 offset:12544
    v_mfma_f32_16x16x32_bf16 a[68:71], v[100:103], v[80:83], a[68:71]
    ds_read_b128 v[156:159], v38 offset:14592
    v_mfma_f32_16x16x32_bf16 a[84:87], v[100:103], v[84:87], a[84:87]
    v_mfma_f32_16x16x32_bf16 a[100:103], v[100:103], v[88:91], a[100:103]
    ds_read_b64_tr_b16 v[164:165], v40 offset:4096
    v_mfma_f32_16x16x32_bf16 a[116:119], v[100:103], v[92:95], a[116:119]
    ds_read_b64_tr_b16 v[166:167], v40 offset:4608
    v_mfma_f32_16x16x32_bf16 a[8:11], v[104:107], v[64:67], a[8:11]
    ds_read_b64_tr_b16 v[168:169], v39 offset:12288
    v_mfma_f32_16x16x32_bf16 a[24:27], v[104:107], v[68:71], a[24:27]
    v_mfma_f32_16x16x32_bf16 a[40:43], v[104:107], v[72:75], a[40:43]
    ds_read_b64_tr_b16 v[170:171], v39 offset:12800
    v_mfma_f32_16x16x32_bf16 a[56:59], v[104:107], v[76:79], a[56:59]
    ds_read_b64_tr_b16 v[172:173], v40 offset:12288
    v_mfma_f32_16x16x32_bf16 a[72:75], v[104:107], v[80:83], a[72:75]
    ds_read_b64_tr_b16 v[174:175], v40 offset:12800
    v_mfma_f32_16x16x32_bf16 a[88:91], v[104:107], v[84:87], a[88:91]
    v_mfma_f32_16x16x32_bf16 a[104:107], v[104:107], v[88:91], a[104:107]
    v_mfma_f32_16x16x32_bf16 a[120:123], v[104:107], v[92:95], a[120:123]
    v_mfma_f32_16x16x32_bf16 a[12:15], v[108:111], v[64:67], a[12:15]
    v_mfma_f32_16x16x32_bf16 a[28:31], v[108:111], v[68:71], a[28:31]
    v_mfma_f32_16x16x32_bf16 a[44:47], v[108:111], v[72:75], a[44:47]
    v_mfma_f32_16x16x32_bf16 a[60:63], v[108:111], v[76:79], a[60:63]
    s_waitcnt lgkmcnt(0)
    s_barrier
    v_mfma_f32_16x16x32_bf16 a[76:79], v[108:111], v[80:83], a[76:79]
    v_mfma_f32_16x16x32_bf16 a[92:95], v[108:111], v[84:87], a[92:95]
    v_mfma_f32_16x16x32_bf16 a[108:111], v[108:111], v[88:91], a[108:111]
    v_mfma_f32_16x16x32_bf16 a[124:127], v[108:111], v[92:95], a[124:127]
    s_waitcnt lgkmcnt(0)
    v_mfma_f32_16x16x32_bf16 a[0:3], v[160:163], v[128:131], a[0:3]
    v_mfma_f32_16x16x32_bf16 a[16:19], v[160:163], v[132:135], a[16:19]
    v_mfma_f32_16x16x32_bf16 a[32:35], v[160:163], v[136:139], a[32:35]
    v_mfma_f32_16x16x32_bf16 a[48:51], v[160:163], v[140:143], a[48:51]
    v_mfma_f32_16x16x32_bf16 a[64:67], v[160:163], v[144:147], a[64:67]
    v_mfma_f32_16x16x32_bf16 a[80:83], v[160:163], v[148:151], a[80:83]
    v_mfma_f32_16x16x32_bf16 a[96:99], v[160:163], v[152:155], a[96:99]
    v_mfma_f32_16x16x32_bf16 a[112:115], v[160:163], v[156:159], a[112:115]
    v_mfma_f32_16x16x32_bf16 a[4:7], v[164:167], v[128:131], a[4:7]
    v_mfma_f32_16x16x32_bf16 a[20:23], v[164:167], v[132:135], a[20:23]
    v_mfma_f32_16x16x32_bf16 a[36:39], v[164:167], v[136:139], a[36:39]
    v_mfma_f32_16x16x32_bf16 a[52:55], v[164:167], v[140:143], a[52:55]
    v_mfma_f32_16x16x32_bf16 a[68:71], v[164:167], v[144:147], a[68:71]
    v_mfma_f32_16x16x32_bf16 a[84:87], v[164:167], v[148:151], a[84:87]
    v_mfma_f32_16x16x32_bf16 a[100:103], v[164:167], v[152:155], a[100:103]
    v_mfma_f32_16x16x32_bf16 a[116:119], v[164:167], v[156:159], a[116:119]
    v_mfma_f32_16x16x32_bf16 a[8:11], v[168:171], v[128:131], a[8:11]
    v_mfma_f32_16x16x32_bf16 a[24:27], v[168:171], v[132:135], a[24:27]
    v_mfma_f32_16x16x32_bf16 a[40:43], v[168:171], v[136:139], a[40:43]
    v_mfma_f32_16x16x32_bf16 a[56:59], v[168:171], v[140:143], a[56:59]
    v_mfma_f32_16x16x32_bf16 a[72:75], v[168:171], v[144:147], a[72:75]
    v_mfma_f32_16x16x32_bf16 a[88:91], v[168:171], v[148:151], a[88:91]
    v_mfma_f32_16x16x32_bf16 a[104:107], v[168:171], v[152:155], a[104:107]
    v_mfma_f32_16x16x32_bf16 a[120:123], v[168:171], v[156:159], a[120:123]
    v_mfma_f32_16x16x32_bf16 a[12:15], v[172:175], v[128:131], a[12:15]
    v_mfma_f32_16x16x32_bf16 a[28:31], v[172:175], v[132:135], a[28:31]
    v_mfma_f32_16x16x32_bf16 a[44:47], v[172:175], v[136:139], a[44:47]
    v_mfma_f32_16x16x32_bf16 a[60:63], v[172:175], v[140:143], a[60:63]
    v_mfma_f32_16x16x32_bf16 a[76:79], v[172:175], v[144:147], a[76:79]
    v_mfma_f32_16x16x32_bf16 a[92:95], v[172:175], v[148:151], a[92:95]
    v_mfma_f32_16x16x32_bf16 a[108:111], v[172:175], v[152:155], a[108:111]
    v_mfma_f32_16x16x32_bf16 a[124:127], v[172:175], v[156:159], a[124:127]
    s_cmp_lg_u32 s3, 0
    s_cbranch_scc1 Am_168
    s_waitcnt vmcnt(0)
    v_readfirstlane_b32 s25, v14
    s_nop 3
    s_add_u32 s25, s25, s83
    s_cmp_eq_u32 s98, 5
    s_cbranch_scc1 N_170
    s_cmp_eq_u32 s98, 4
    s_cbranch_scc1 N_169
    s_lshr_b32 s22, s25, 5
    s_and_b32 s25, s25, 31
    s_lshl_b32 s22, s22, 2
    s_add_u32 s22, s22, s98
    s_lshl_b32 s22, s22, 5
    s_add_u32 s25, s25, s22
N_169:
    s_cmp_lt_u32 s25, 768
    s_cselect_b32 s25, s25, 96
    s_cbranch_scc1 N_170_e
N_170:
    s_add_u32 s25, s25, 768
    s_cmp_lt_u32 s25, 864
N_170_e:
    s_cselect_b32 s39, 1, 0
    s_cselect_b32 s96, 1, 2
    v_mov_b32 v14, s25
    v_mov_b32 v15, 159744
    ds_write_b32 v15, v14
Am_168:
    s_add_u32 s28, s66, 89128960
    s_addc_u32 s29, s67, 0
    s_and_b32 s29, s29, 0xffff
    s_mov_b32 s30, 4194304
    s_mov_b32 s31, 0x20000
    s_lshl_b32 s32, s36, 19
    s_lshl_b32 s33, s37, 8
    s_lshr_b32 s21, s3, 1
    s_mul_i32 s21, s21, 262144
    s_add_u32 s21, s21, s32
    s_and_b32 s22, s3, 1
    s_lshl_b32 s22, s22, 6
    s_add_u32 s22, s22, s33
    v_bfe_u32 v3, v1, 4, 1
    v_lshrrev_b32 v4, 5, v1
    v_bfe_u32 v10, v1, 2, 2
    v_lshlrev_b32 v10, 13, v10
    v_lshl_add_u32 v10, v3, 7, v10
    v_lshl_add_u32 v10, v4, 4, v10
    v_and_b32 v5, 3, v1
    v_lshl_add_u32 v10, v5, 5, v10
    v_and_b32 v2, 15, v1
    v_lshlrev_b32 v2, 11, v2
    v_lshl_add_u32 v2, v3, 5, v2
    v_lshl_add_u32 v2, v4, 4, v2
    s_lshl_b32 s23, s22, 2
    s_add_u32 s85, s21, s23
    s_add_u32 s84, s21, s22
    s_nop 7
    v_accvgpr_read_b32 v128, a0
    v_accvgpr_read_b32 v129, a1
    v_accvgpr_read_b32 v130, a2
    v_accvgpr_read_b32 v131, a3
    v_accvgpr_read_b32 v132, a4
    v_accvgpr_read_b32 v133, a5
    v_accvgpr_read_b32 v134, a6
    v_accvgpr_read_b32 v135, a7
    v_cvt_pk_bf16_f32 v136, v128, v129
    v_cvt_pk_bf16_f32 v137, v130, v131
    v_cvt_pk_bf16_f32 v138, v132, v133
    v_cvt_pk_bf16_f32 v139, v134, v135
    s_nop 1
    v_permlane16_swap_b32 v136, v138
    v_permlane16_swap_b32 v137, v139
    s_add_u32 s86, s85, 0
    buffer_store_dwordx4 v[136:139], v10, s[28:31], s86 offen offset:0 sc1
    v_accvgpr_read_b32 v144, a8
    v_accvgpr_read_b32 v145, a9
    v_accvgpr_read_b32 v146, a10
    v_accvgpr_read_b32 v147, a11
    v_accvgpr_read_b32 v148, a12
    v_accvgpr_read_b32 v149, a13
    v_accvgpr_read_b32 v150, a14
    v_accvgpr_read_b32 v151, a15
    v_cvt_pk_bf16_f32 v152, v144, v145
    v_cvt_pk_bf16_f32 v153, v146, v147
    v_cvt_pk_bf16_f32 v154, v148, v149
    v_cvt_pk_bf16_f32 v155, v150, v151
    s_nop 1
    v_permlane16_swap_b32 v152, v154
    v_permlane16_swap_b32 v153, v155
    s_add_u32 s86, s85, 0
    buffer_store_dwordx4 v[152:155], v10, s[28:31], s86 offen offset:512 sc1
    v_accvgpr_read_b32 v128, a16
    v_accvgpr_read_b32 v129, a17
    v_accvgpr_read_b32 v130, a18
    v_accvgpr_read_b32 v131, a19
    v_accvgpr_read_b32 v132, a20
    v_accvgpr_read_b32 v133, a21
    v_accvgpr_read_b32 v134, a22
    v_accvgpr_read_b32 v135, a23
    v_cvt_pk_bf16_f32 v136, v128, v129
    v_cvt_pk_bf16_f32 v137, v130, v131
    v_cvt_pk_bf16_f32 v138, v132, v133
    v_cvt_pk_bf16_f32 v139, v134, v135
    s_nop 1
    v_permlane16_swap_b32 v136, v138
    v_permlane16_swap_b32 v137, v139
    s_add_u32 s86, s85, 32768
    buffer_store_dwordx4 v[136:139], v10, s[28:31], s86 offen offset:0 sc1
    v_accvgpr_read_b32 v144, a24
    v_accvgpr_read_b32 v145, a25
    v_accvgpr_read_b32 v146, a26
    v_accvgpr_read_b32 v147, a27
    v_accvgpr_read_b32 v148, a28
    v_accvgpr_read_b32 v149, a29
    v_accvgpr_read_b32 v150, a30
    v_accvgpr_read_b32 v151, a31
    v_cvt_pk_bf16_f32 v152, v144, v145
    v_cvt_pk_bf16_f32 v153, v146, v147
    v_cvt_pk_bf16_f32 v154, v148, v149
    v_cvt_pk_bf16_f32 v155, v150, v151
    s_nop 1
    v_permlane16_swap_b32 v152, v154
    v_permlane16_swap_b32 v153, v155
    s_add_u32 s86, s85, 32768
    buffer_store_dwordx4 v[152:155], v10, s[28:31], s86 offen offset:512 sc1
    v_accvgpr_read_b32 v128, a32
    v_accvgpr_read_b32 v129, a33
    v_accvgpr_read_b32 v130, a34
    v_accvgpr_read_b32 v131, a35
    v_accvgpr_read_b32 v132, a36
    v_accvgpr_read_b32 v133, a37
    v_accvgpr_read_b32 v134, a38
    v_accvgpr_read_b32 v135, a39
    v_cvt_pk_bf16_f32 v136, v128, v129
    v_cvt_pk_bf16_f32 v137, v130, v131
    v_cvt_pk_bf16_f32 v138, v132, v133
    v_cvt_pk_bf16_f32 v139, v134, v135
    s_nop 1
    v_permlane16_swap_b32 v136, v138
    v_permlane16_swap_b32 v137, v139
    s_add_u32 s86, s85, 65536
    buffer_store_dwordx4 v[136:139], v10, s[28:31], s86 offen offset:0 sc1
    v_accvgpr_read_b32 v144, a40
    v_accvgpr_read_b32 v145, a41
    v_accvgpr_read_b32 v146, a42
    v_accvgpr_read_b32 v147, a43
    v_accvgpr_read_b32 v148, a44
    v_accvgpr_read_b32 v149, a45
    v_accvgpr_read_b32 v150, a46
    v_accvgpr_read_b32 v151, a47
    v_cvt_pk_bf16_f32 v152, v144, v145
    v_cvt_pk_bf16_f32 v153, v146, v147
    v_cvt_pk_bf16_f32 v154, v148, v149
    v_cvt_pk_bf16_f32 v155, v150, v151
    s_nop 1
    v_permlane16_swap_b32 v152, v154
    v_permlane16_swap_b32 v153, v155
    s_add_u32 s86, s85, 65536
    buffer_store_dwordx4 v[152:155], v10, s[28:31], s86 offen offset:512 sc1
    v_accvgpr_read_b32 v128, a48
    v_accvgpr_read_b32 v129, a49
    v_accvgpr_read_b32 v130, a50
    v_accvgpr_read_b32 v131, a51
    v_accvgpr_read_b32 v132, a52
    v_accvgpr_read_b32 v133, a53
    v_accvgpr_read_b32 v134, a54
    v_accvgpr_read_b32 v135, a55
    v_cvt_pk_bf16_f32 v136, v128, v129
    v_cvt_pk_bf16_f32 v137, v130, v131
    v_cvt_pk_bf16_f32 v138, v132, v133
    v_cvt_pk_bf16_f32 v139, v134, v135
    s_nop 1
    v_permlane16_swap_b32 v136, v138
    v_permlane16_swap_b32 v137, v139
    s_add_u32 s86, s85, 98304
    buffer_store_dwordx4 v[136:139], v10, s[28:31], s86 offen offset:0 sc1
    v_accvgpr_read_b32 v144, a56
    v_accvgpr_read_b32 v145, a57
    v_accvgpr_read_b32 v146, a58
    v_accvgpr_read_b32 v147, a59
    v_accvgpr_read_b32 v148, a60
    v_accvgpr_read_b32 v149, a61
    v_accvgpr_read_b32 v150, a62
    v_accvgpr_read_b32 v151, a63
    v_cvt_pk_bf16_f32 v152, v144, v145
    v_cvt_pk_bf16_f32 v153, v146, v147
    v_cvt_pk_bf16_f32 v154, v148, v149
    v_cvt_pk_bf16_f32 v155, v150, v151
    s_nop 1
    v_permlane16_swap_b32 v152, v154
    v_permlane16_swap_b32 v153, v155
    s_add_u32 s86, s85, 98304
    buffer_store_dwordx4 v[152:155], v10, s[28:31], s86 offen offset:512 sc1
    v_accvgpr_read_b32 v128, a64
    v_accvgpr_read_b32 v129, a65
    v_accvgpr_read_b32 v130, a66
    v_accvgpr_read_b32 v131, a67
    v_accvgpr_read_b32 v132, a68
    v_accvgpr_read_b32 v133, a69
    v_accvgpr_read_b32 v134, a70
    v_accvgpr_read_b32 v135, a71
    v_cvt_pk_bf16_f32 v136, v128, v129
    v_cvt_pk_bf16_f32 v137, v130, v131
    v_cvt_pk_bf16_f32 v138, v132, v133
    v_cvt_pk_bf16_f32 v139, v134, v135
    s_nop 1
    v_permlane16_swap_b32 v136, v138
    v_permlane16_swap_b32 v137, v139
    s_add_u32 s86, s85, 131072
    buffer_store_dwordx4 v[136:139], v10, s[28:31], s86 offen offset:0 sc1
    v_accvgpr_read_b32 v144, a72
    v_accvgpr_read_b32 v145, a73
    v_accvgpr_read_b32 v146, a74
    v_accvgpr_read_b32 v147, a75
    v_accvgpr_read_b32 v148, a76
    v_accvgpr_read_b32 v149, a77
    v_accvgpr_read_b32 v150, a78
    v_accvgpr_read_b32 v151, a79
    v_cvt_pk_bf16_f32 v152, v144, v145
    v_cvt_pk_bf16_f32 v153, v146, v147
    v_cvt_pk_bf16_f32 v154, v148, v149
    v_cvt_pk_bf16_f32 v155, v150, v151
    s_nop 1
    v_permlane16_swap_b32 v152, v154
    v_permlane16_swap_b32 v153, v155
    s_add_u32 s86, s85, 131072
    buffer_store_dwordx4 v[152:155], v10, s[28:31], s86 offen offset:512 sc1
    v_accvgpr_read_b32 v128, a80
    v_accvgpr_read_b32 v129, a81
    v_accvgpr_read_b32 v130, a82
    v_accvgpr_read_b32 v131, a83
    v_accvgpr_read_b32 v132, a84
    v_accvgpr_read_b32 v133, a85
    v_accvgpr_read_b32 v134, a86
    v_accvgpr_read_b32 v135, a87
    v_cvt_pk_bf16_f32 v136, v128, v129
    v_cvt_pk_bf16_f32 v137, v130, v131
    v_cvt_pk_bf16_f32 v138, v132, v133
    v_cvt_pk_bf16_f32 v139, v134, v135
    s_nop 1
    v_permlane16_swap_b32 v136, v138
    v_permlane16_swap_b32 v137, v139
    s_add_u32 s86, s85, 163840
    buffer_store_dwordx4 v[136:139], v10, s[28:31], s86 offen offset:0 sc1
    v_accvgpr_read_b32 v144, a88
    v_accvgpr_read_b32 v145, a89
    v_accvgpr_read_b32 v146, a90
    v_accvgpr_read_b32 v147, a91
    v_accvgpr_read_b32 v148, a92
    v_accvgpr_read_b32 v149, a93
    v_accvgpr_read_b32 v150, a94
    v_accvgpr_read_b32 v151, a95
    v_cvt_pk_bf16_f32 v152, v144, v145
    v_cvt_pk_bf16_f32 v153, v146, v147
    v_cvt_pk_bf16_f32 v154, v148, v149
    v_cvt_pk_bf16_f32 v155, v150, v151
    s_nop 1
    v_permlane16_swap_b32 v152, v154
    v_permlane16_swap_b32 v153, v155
    s_add_u32 s86, s85, 163840
    buffer_store_dwordx4 v[152:155], v10, s[28:31], s86 offen offset:512 sc1
    v_accvgpr_read_b32 v128, a96
    v_accvgpr_read_b32 v129, a97
    v_accvgpr_read_b32 v130, a98
    v_accvgpr_read_b32 v131, a99
    v_accvgpr_read_b32 v132, a100
    v_accvgpr_read_b32 v133, a101
    v_accvgpr_read_b32 v134, a102
    v_accvgpr_read_b32 v135, a103
    v_cvt_pk_bf16_f32 v136, v128, v129
    v_cvt_pk_bf16_f32 v137, v130, v131
    v_cvt_pk_bf16_f32 v138, v132, v133
    v_cvt_pk_bf16_f32 v139, v134, v135
    s_nop 1
    v_permlane16_swap_b32 v136, v138
    v_permlane16_swap_b32 v137, v139
    s_add_u32 s86, s85, 196608
    buffer_store_dwordx4 v[136:139], v10, s[28:31], s86 offen offset:0 sc1
    v_accvgpr_read_b32 v144, a104
    v_accvgpr_read_b32 v145, a105
    v_accvgpr_read_b32 v146, a106
    v_accvgpr_read_b32 v147, a107
    v_accvgpr_read_b32 v148, a108
    v_accvgpr_read_b32 v149, a109
    v_accvgpr_read_b32 v150, a110
    v_accvgpr_read_b32 v151, a111
    v_cvt_pk_bf16_f32 v152, v144, v145
    v_cvt_pk_bf16_f32 v153, v146, v147
    v_cvt_pk_bf16_f32 v154, v148, v149
    v_cvt_pk_bf16_f32 v155, v150, v151
    s_nop 1
    v_permlane16_swap_b32 v152, v154
    v_permlane16_swap_b32 v153, v155
    s_add_u32 s86, s85, 196608
    buffer_store_dwordx4 v[152:155], v10, s[28:31], s86 offen offset:512 sc1
    v_accvgpr_read_b32 v128, a112
    v_accvgpr_read_b32 v129, a113
    v_accvgpr_read_b32 v130, a114
    v_accvgpr_read_b32 v131, a115
    v_accvgpr_read_b32 v132, a116
    v_accvgpr_read_b32 v133, a117
    v_accvgpr_read_b32 v134, a118
    v_accvgpr_read_b32 v135, a119
    v_cvt_pk_bf16_f32 v136, v128, v129
    v_cvt_pk_bf16_f32 v137, v130, v131
    v_cvt_pk_bf16_f32 v138, v132, v133
    v_cvt_pk_bf16_f32 v139, v134, v135
    s_nop 1
    v_permlane16_swap_b32 v136, v138
    v_permlane16_swap_b32 v137, v139
    s_add_u32 s86, s85, 229376
    buffer_store_dwordx4 v[136:139], v10, s[28:31], s86 offen offset:0 sc1
    v_accvgpr_read_b32 v144, a120
    v_accvgpr_read_b32 v145, a121
    v_accvgpr_read_b32 v146, a122
    v_accvgpr_read_b32 v147, a123
    v_accvgpr_read_b32 v148, a124
    v_accvgpr_read_b32 v149, a125
    v_accvgpr_read_b32 v150, a126
    v_accvgpr_read_b32 v151, a127
    v_cvt_pk_bf16_f32 v152, v144, v145
    v_cvt_pk_bf16_f32 v153, v146, v147
    v_cvt_pk_bf16_f32 v154, v148, v149
    v_cvt_pk_bf16_f32 v155, v150, v151
    s_nop 1
    v_permlane16_swap_b32 v152, v154
    v_permlane16_swap_b32 v153, v155
    s_add_u32 s86, s85, 229376
    buffer_store_dwordx4 v[152:155], v10, s[28:31], s86 offen offset:512 sc1
    s_lshl_b32 s32, s36, 3
    s_add_u32 s32, s32, s37
    s_lshl_b32 s32, s32, 6
    s_add_u32 s68, s32, 113270784
    s_mov_b32 s69, 1
    s_branch L_next
L_W2:
    s_call_b64 s[4:5], L_epi
    s_cmp_eq_u32 s69, 0
    s_cbranch_scc1 Fl_171
    s_waitcnt vmcnt(0)
    s_barrier
    s_cmp_lg_u32 s3, 0
    s_cbranch_scc1 Fin_173
    v_mov_b32 v4, s69
    s_mov_b64 exec, 1
    buffer_atomic_add v4, off, s[92:95], s68 sc1
    s_mov_b64 exec, -1
Fin_173:
    s_mov_b32 s69, 0
Fl_171:
    s_lshl_b32 s32, s36, 8
    s_add_u32 s32, s32, 113248640
    s_cmp_lg_u32 s3, 0
    s_cbranch_scc1 Wf_174
    v_and_b32 v5, 1, v1
    v_lshlrev_b32 v5, 7, v5
    s_mov_b32 s30, 0
    s_mov_b32 s21, 0x80
Wp_175:
    buffer_load_dword v4, v5, s[92:95], s32 offen sc1
    s_waitcnt vmcnt(0)
    v_cmp_ne_u32 vcc, s21, v4
    s_cbranch_vccz Wf_174
    s_sleep 8
    s_add_u32 s30, s30, 1
    s_cmp_lt_u32 s30, 65536
    s_cbranch_scc1 Wp_175
    s_branch L_abort
Wf_174:
    s_barrier
    s_add_u32 s8, s66, 71303168
    s_addc_u32 s9, s67, 0
    s_and_b32 s9, s9, 0xffff
    s_mov_b32 s10, 17039360
    s_mov_b32 s11, 0x20000
    s_mov_b32 s12, s50
    s_and_b32 s13, s51, 0xffff
    s_mov_b32 s14, 8388608
    s_mov_b32 s15, 0x20000
    v_lshrrev_b32 v2, 5, v1
    v_and_b32 v3, 31, v1
    v_lshlrev_b32 v3, 4, v3
    v_lshlrev_b32 v4, 7, v2
    v_xor_b32 v3, v3, v4
    s_mul_i32 s21, s3, 16
    v_add_u32 v2, s21, v2
    s_mov_b32 s22, 33280
    v_mul_lo_u32 v2, v2, s22
    v_add_u32 v3, v2, v3
    v_add_u32 v16, 0, v3
    v_add_u32 v17, 66560, v3
    v_add_u32 v18, 133120, v3
    v_add_u32 v19, 199680, v3
    v_add_u32 v20, 266240, v3
    v_add_u32 v21, 332800, v3
    v_add_u32 v22, 399360, v3
    v_add_u32 v23, 465920, v3
    v_lshrrev_b32 v2, 3, v1
    v_and_b32 v3, 7, v1
    v_bfe_u32 v4, v1, 4, 1
    v_lshlrev_b32 v4, 1, v4
    v_xor_b32 v3, v3, v4
    v_lshrrev_b32 v4, 2, v2
    v_lshlrev_b32 v4, 4, v4
    v_and_b32 v2, 3, v2
    v_add_u32 v2, v2, v4
    s_and_b32 s21, s3, 1
    s_lshl_b32 s21, s21, 5
    v_add_u32 v2, s21, v2
    s_mov_b32 s22, 2048
    v_mul_lo_u32 v2, v2, s22
    s_lshr_b32 s23, s3, 1
    s_lshl_b32 s23, s23, 7
    v_add_u32 v2, s23, v2
    v_lshlrev_b32 v3, 4, v3
    v_xor_b32 v4, 64, v3
    v_add_u32 v3, v2, v3
    v_add_u32 v4, v2, v4
    v_add_u32 v24, 0, v3
    v_add_u32 v25, 8192, v4
    v_add_u32 v26, 16384, v3
    v_add_u32 v27, 24576, v4
    s_mul_i32 s18, s3, 8192
    s_lshl_b32 s19, s3, 12
    s_add_u32 s19, s19, 32768
    s_lshr_b32 s21, s3, 1
    s_mul_i32 s21, s21, 16384
    v_bfe_u32 v2, v1, 2, 2
    v_lshlrev_b32 v2, 9, v2
    v_add_u32 v2, s21, v2
    v_and_b32 v3, 3, v1
    v_lshl_add_u32 v2, v3, 5, v2
    v_bfe_u32 v3, v1, 4, 1
    v_lshl_add_u32 v2, v3, 4, v2
    v_lshrrev_b32 v4, 5, v1
    v_bfe_u32 v5, v1, 2, 1
    v_xor_b32 v4, v4, v5
    v_lshl_add_u32 v32, v4, 7, v2
    v_lshrrev_b32 v4, 4, v1
    v_bfe_u32 v5, v1, 2, 2
    v_lshl_add_u32 v2, v4, 3, v5
    v_lshlrev_b32 v2, 7, v2
    v_and_b32 v4, 3, v1
    v_lshl_add_u32 v2, v4, 3, v2
    v_add_u32 v2, 32768, v2
    v_lshrrev_b32 v5, 1, v5
    v_lshl_or_b32 v3, v3, 1, v5
    s_and_b32 s21, s3, 1
    s_lshl_b32 s21, s21, 1
    v_xor_b32 v3, s21, v3
    v_lshl_add_u32 v33, v3, 5, v2
    v_xor_b32 v34, 32, v33
    v_add_u32 v38, 49152, v32
    v_add_u32 v39, 49152, v33
    v_add_u32 v40, 49152, v34
    v_add_u32 v44, 98304, v32
    v_add_u32 v45, 98304, v33
    v_add_u32 v46, 98304, v34
    s_mul_i32 s16, s36, 2129920
    s_lshl_b32 s17, s37, 8
    s_add_u32 m0, s18, 0
    s_nop 0
    buffer_load_dwordx4 v16, s[8:11], s16 offen sc1 lds
    s_add_u32 m0, s19, 0
    s_nop 0
    buffer_load_dwordx4 v24, s[12:15], s17 offen  lds
    s_add_u32 m0, s18, 1024
    s_nop 0
    buffer_load_dwordx4 v17, s[8:11], s16 offen sc1 lds
    s_add_u32 m0, s19, 1024
    s_nop 0
    buffer_load_dwordx4 v25, s[12:15], s17 offen  lds
    s_add_u32 m0, s18, 2048
    s_nop 0
    buffer_load_dwordx4 v18, s[8:11], s16 offen sc1 lds
    s_add_u32 m0, s19, 2048
    s_nop 0
    buffer_load_dwordx4 v26, s[12:15], s17 offen  lds
    s_add_u32 m0, s18, 3072
    s_nop 0
    buffer_load_dwordx4 v19, s[8:11], s16 offen sc1 lds
    s_add_u32 m0, s19, 3072
    s_nop 0
    buffer_load_dwordx4 v27, s[12:15], s17 offen  lds
    s_add_u32 m0, s18, 4096
    s_nop 0
    buffer_load_dwordx4 v20, s[8:11], s16 offen sc1 lds
    s_add_u32 m0, s18, 5120
    s_nop 0
    buffer_load_dwordx4 v21, s[8:11], s16 offen sc1 lds
    s_add_u32 m0, s18, 6144
    s_nop 0
    buffer_load_dwordx4 v22, s[8:11], s16 offen sc1 lds
    s_add_u32 m0, s18, 7168
    s_nop 0
    buffer_load_dwordx4 v23, s[8:11], s16 offen sc1 lds
    s_add_u32 s16, s16, 512
    s_add_u32 s17, s17, 131072
    s_add_u32 m0, s18, 49152
    s_nop 0
    buffer_load_dwordx4 v16, s[8:11], s16 offen sc1 lds
    s_add_u32 m0, s19, 49152
    s_nop 0
    buffer_load_dwordx4 v24, s[12:15], s17 offen  lds
    s_add_u32 m0, s18, 50176
    s_nop 0
    buffer_load_dwordx4 v17, s[8:11], s16 offen sc1 lds
    s_add_u32 m0, s19, 50176
    s_nop 0
    buffer_load_dwordx4 v25, s[12:15], s17 offen  lds
    s_add_u32 m0, s18, 51200
    s_nop 0
    buffer_load_dwordx4 v18, s[8:11], s16 offen sc1 lds
    s_add_u32 m0, s19, 51200
    s_nop 0
    buffer_load_dwordx4 v26, s[12:15], s17 offen  lds
    s_add_u32 m0, s18, 52224
    s_nop 0
    buffer_load_dwordx4 v19, s[8:11], s16 offen sc1 lds
    s_add_u32 m0, s19, 52224
    s_nop 0
    buffer_load_dwordx4 v27, s[12:15], s17 offen  lds
    s_add_u32 m0, s18, 53248
    s_nop 0
    buffer_load_dwordx4 v20, s[8:11], s16 offen sc1 lds
    s_add_u32 m0, s18, 54272
    s_nop 0
    buffer_load_dwordx4 v21, s[8:11], s16 offen sc1 lds
    s_add_u32 m0, s18, 55296
    s_nop 0
    buffer_load_dwordx4 v22, s[8:11], s16 offen sc1 lds
    s_add_u32 m0, s18, 56320
    s_nop 0
    buffer_load_dwordx4 v23, s[8:11], s16 offen sc1 lds
    s_add_u32 s16, s16, 512
    s_add_u32 s17, s17, 131072
    s_add_u32 m0, s18, 98304
    s_nop 0
    buffer_load_dwordx4 v16, s[8:11], s16 offen sc1 lds
    s_add_u32 m0, s19, 98304
    s_nop 0
    buffer_load_dwordx4 v24, s[12:15], s17 offen  lds
    s_add_u32 m0, s18, 99328
    s_nop 0
    buffer_load_dwordx4 v17, s[8:11], s16 offen sc1 lds
    s_add_u32 m0, s19, 99328
    s_nop 0
    buffer_load_dwordx4 v25, s[12:15], s17 offen  lds
    s_add_u32 m0, s18, 100352
    s_nop 0
    buffer_load_dwordx4 v18, s[8:11], s16 offen sc1 lds
    s_add_u32 m0, s19, 100352
    s_nop 0
    buffer_load_dwordx4 v26, s[12:15], s17 offen  lds
    s_add_u32 m0, s18, 101376
    s_nop 0
    buffer_load_dwordx4 v19, s[8:11], s16 offen sc1 lds
    s_add_u32 m0, s19, 101376
    s_nop 0
    buffer_load_dwordx4 v27, s[12:15], s17 offen  lds
    s_add_u32 m0, s18, 102400
    s_nop 0
    buffer_load_dwordx4 v20, s[8:11], s16 offen sc1 lds
    s_add_u32 m0, s18, 103424
    s_nop 0
    buffer_load_dwordx4 v21, s[8:11], s16 offen sc1 lds
    s_add_u32 m0, s18, 104448
    s_nop 0
    buffer_load_dwordx4 v22, s[8:11], s16 offen sc1 lds
    s_add_u32 m0, s18, 105472
    s_nop 0
    buffer_load_dwordx4 v23, s[8:11], s16 offen sc1 lds
    s_add_u32 s16, s16, 512
    s_add_u32 s17, s17, 131072
    s_waitcnt vmcnt(24)
    s_barrier
    ds_read_b64_tr_b16 v[96:97], v33 offset:0
    ds_read_b64_tr_b16 v[98:99], v33 offset:512
    ds_read_b128 v[64:67], v32 offset:0
    ds_read_b128 v[68:71], v32 offset:2048
    ds_read_b128 v[72:75], v32 offset:4096
    ds_read_b128 v[76:79], v32 offset:6144
    ds_read_b128 v[80:83], v32 offset:8192
    ds_read_b128 v[84:87], v32 offset:10240
    ds_read_b128 v[88:91], v32 offset:12288
    ds_read_b128 v[92:95], v32 offset:14336
    ds_read_b64_tr_b16 v[100:101], v34 offset:0
    ds_read_b64_tr_b16 v[102:103], v34 offset:512
    ds_read_b64_tr_b16 v[104:105], v33 offset:8192
    ds_read_b64_tr_b16 v[106:107], v33 offset:8704
    ds_read_b64_tr_b16 v[108:109], v34 offset:8192
    ds_read_b64_tr_b16 v[110:111], v34 offset:8704
    s_waitcnt lgkmcnt(0)
    v_mfma_f32_16x16x32_bf16 a[0:3], v[96:99], v[64:67], 0
    ds_read_b64_tr_b16 v[160:161], v33 offset:4096
    v_mfma_f32_16x16x32_bf16 a[16:19], v[96:99], v[68:71], 0
    v_mfma_f32_16x16x32_bf16 a[32:35], v[96:99], v[72:75], 0
    ds_read_b64_tr_b16 v[162:163], v33 offset:4608
    v_mfma_f32_16x16x32_bf16 a[48:51], v[96:99], v[76:79], 0
    ds_read_b128 v[128:131], v32 offset:256
    v_mfma_f32_16x16x32_bf16 a[64:67], v[96:99], v[80:83], 0
    ds_read_b128 v[132:135], v32 offset:2304
    v_mfma_f32_16x16x32_bf16 a[80:83], v[96:99], v[84:87], 0
    v_mfma_f32_16x16x32_bf16 a[96:99], v[96:99], v[88:91], 0
    ds_read_b128 v[136:139], v32 offset:4352
    v_mfma_f32_16x16x32_bf16 a[112:115], v[96:99], v[92:95], 0
    ds_read_b128 v[140:143], v32 offset:6400
    v_mfma_f32_16x16x32_bf16 a[4:7], v[100:103], v[64:67], 0
    ds_read_b128 v[144:147], v32 offset:8448
    v_mfma_f32_16x16x32_bf16 a[20:23], v[100:103], v[68:71], 0
    v_mfma_f32_16x16x32_bf16 a[36:39], v[100:103], v[72:75], 0
    ds_read_b128 v[148:151], v32 offset:10496
    v_mfma_f32_16x16x32_bf16 a[52:55], v[100:103], v[76:79], 0
    ds_read_b128 v[152:155], v32 offset:12544
    v_mfma_f32_16x16x32_bf16 a[68:71], v[100:103], v[80:83], 0
    ds_read_b128 v[156:159], v32 offset:14592
    v_mfma_f32_16x16x32_bf16 a[84:87], v[100:103], v[84:87], 0
    v_mfma_f32_16x16x32_bf16 a[100:103], v[100:103], v[88:91], 0
    ds_read_b64_tr_b16 v[164:165], v34 offset:4096
    v_mfma_f32_16x16x32_bf16 a[116:119], v[100:103], v[92:95], 0
    ds_read_b64_tr_b16 v[166:167], v34 offset:4608
    v_mfma_f32_16x16x32_bf16 a[8:11], v[104:107], v[64:67], 0
    ds_read_b64_tr_b16 v[168:169], v33 offset:12288
    v_mfma_f32_16x16x32_bf16 a[24:27], v[104:107], v[68:71], 0
    v_mfma_f32_16x16x32_bf16 a[40:43], v[104:107], v[72:75], 0
    ds_read_b64_tr_b16 v[170:171], v33 offset:12800
    v_mfma_f32_16x16x32_bf16 a[56:59], v[104:107], v[76:79], 0
    ds_read_b64_tr_b16 v[172:173], v34 offset:12288
    v_mfma_f32_16x16x32_bf16 a[72:75], v[104:107], v[80:83], 0
    ds_read_b64_tr_b16 v[174:175], v34 offset:12800
    v_mfma_f32_16x16x32_bf16 a[88:91], v[104:107], v[84:87], 0
    v_mfma_f32_16x16x32_bf16 a[104:107], v[104:107], v[88:91], 0
    v_mfma_f32_16x16x32_bf16 a[120:123], v[104:107], v[92:95], 0
    v_mfma_f32_16x16x32_bf16 a[12:15], v[108:111], v[64:67], 0
    v_mfma_f32_16x16x32_bf16 a[28:31], v[108:111], v[68:71], 0
    v_mfma_f32_16x16x32_bf16 a[44:47], v[108:111], v[72:75], 0
    v_mfma_f32_16x16x32_bf16 a[60:63], v[108:111], v[76:79], 0
    s_waitcnt vmcnt(12) lgkmcnt(0)
    s_barrier
    v_mfma_f32_16x16x32_bf16 a[76:79], v[108:111], v[80:83], 0
    v_mfma_f32_16x16x32_bf16 a[92:95], v[108:111], v[84:87], 0
    v_mfma_f32_16x16x32_bf16 a[108:111], v[108:111], v[88:91], 0
    v_mfma_f32_16x16x32_bf16 a[124:127], v[108:111], v[92:95], 0
    s_mov_b32 s20, 20
GW2_176:
    s_waitcnt lgkmcnt(0)
    v_mfma_f32_16x16x32_bf16 a[0:3], v[160:163], v[128:131], a[0:3]
    s_add_u32 m0, s18, 0
    ds_read_b64_tr_b16 v[96:97], v39 offset:0
    v_mfma_f32_16x16x32_bf16 a[16:19], v[160:163], v[132:135], a[16:19]
    buffer_load_dwordx4 v16, s[8:11], s16 offen sc1 lds
    v_mfma_f32_16x16x32_bf16 a[32:35], v[160:163], v[136:139], a[32:35]
    ds_read_b64_tr_b16 v[98:99], v39 offset:512
    v_mfma_f32_16x16x32_bf16 a[48:51], v[160:163], v[140:143], a[48:51]
    ds_read_b128 v[64:67], v38 offset:0
    v_mfma_f32_16x16x32_bf16 a[64:67], v[160:163], v[144:147], a[64:67]
    s_add_u32 m0, s19, 0
    ds_read_b128 v[68:71], v38 offset:2048
    v_mfma_f32_16x16x32_bf16 a[80:83], v[160:163], v[148:151], a[80:83]
    buffer_load_dwordx4 v24, s[12:15], s17 offen  lds
    v_mfma_f32_16x16x32_bf16 a[96:99], v[160:163], v[152:155], a[96:99]
    ds_read_b128 v[72:75], v38 offset:4096
    v_mfma_f32_16x16x32_bf16 a[112:115], v[160:163], v[156:159], a[112:115]
    ds_read_b128 v[76:79], v38 offset:6144
    v_mfma_f32_16x16x32_bf16 a[4:7], v[164:167], v[128:131], a[4:7]
    s_add_u32 m0, s18, 1024
    ds_read_b128 v[80:83], v38 offset:8192
    v_mfma_f32_16x16x32_bf16 a[20:23], v[164:167], v[132:135], a[20:23]
    buffer_load_dwordx4 v17, s[8:11], s16 offen sc1 lds
    v_mfma_f32_16x16x32_bf16 a[36:39], v[164:167], v[136:139], a[36:39]
    ds_read_b128 v[84:87], v38 offset:10240
    v_mfma_f32_16x16x32_bf16 a[52:55], v[164:167], v[140:143], a[52:55]
    v_mfma_f32_16x16x32_bf16 a[68:71], v[164:167], v[144:147], a[68:71]
    s_add_u32 m0, s19, 1024
    ds_read_b128 v[88:91], v38 offset:12288
    v_mfma_f32_16x16x32_bf16 a[84:87], v[164:167], v[148:151], a[84:87]
    buffer_load_dwordx4 v25, s[12:15], s17 offen  lds
    v_mfma_f32_16x16x32_bf16 a[100:103], v[164:167], v[152:155], a[100:103]
    ds_read_b128 v[92:95], v38 offset:14336
    v_mfma_f32_16x16x32_bf16 a[116:119], v[164:167], v[156:159], a[116:119]
    ds_read_b64_tr_b16 v[100:101], v40 offset:0
    v_mfma_f32_16x16x32_bf16 a[8:11], v[168:171], v[128:131], a[8:11]
    s_add_u32 m0, s18, 2048
    ds_read_b64_tr_b16 v[102:103], v40 offset:512
    v_mfma_f32_16x16x32_bf16 a[24:27], v[168:171], v[132:135], a[24:27]
    buffer_load_dwordx4 v18, s[8:11], s16 offen sc1 lds
    v_mfma_f32_16x16x32_bf16 a[40:43], v[168:171], v[136:139], a[40:43]
    ds_read_b64_tr_b16 v[104:105], v39 offset:8192
    v_mfma_f32_16x16x32_bf16 a[56:59], v[168:171], v[140:143], a[56:59]
    ds_read_b64_tr_b16 v[106:107], v39 offset:8704
    v_mfma_f32_16x16x32_bf16 a[72:75], v[168:171], v[144:147], a[72:75]
    s_add_u32 m0, s19, 2048
    ds_read_b64_tr_b16 v[108:109], v40 offset:8192
    v_mfma_f32_16x16x32_bf16 a[88:91], v[168:171], v[148:151], a[88:91]
    buffer_load_dwordx4 v26, s[12:15], s17 offen  lds
    v_mfma_f32_16x16x32_bf16 a[104:107], v[168:171], v[152:155], a[104:107]
    ds_read_b64_tr_b16 v[110:111], v40 offset:8704
    v_mfma_f32_16x16x32_bf16 a[120:123], v[168:171], v[156:159], a[120:123]
    v_mfma_f32_16x16x32_bf16 a[12:15], v[172:175], v[128:131], a[12:15]
    s_add_u32 m0, s18, 3072
    v_mfma_f32_16x16x32_bf16 a[28:31], v[172:175], v[132:135], a[28:31]
    buffer_load_dwordx4 v19, s[8:11], s16 offen sc1 lds
    v_mfma_f32_16x16x32_bf16 a[44:47], v[172:175], v[136:139], a[44:47]
    v_mfma_f32_16x16x32_bf16 a[60:63], v[172:175], v[140:143], a[60:63]
    v_mfma_f32_16x16x32_bf16 a[76:79], v[172:175], v[144:147], a[76:79]
    s_add_u32 m0, s19, 3072
    v_mfma_f32_16x16x32_bf16 a[92:95], v[172:175], v[148:151], a[92:95]
    buffer_load_dwordx4 v27, s[12:15], s17 offen  lds
    v_mfma_f32_16x16x32_bf16 a[108:111], v[172:175], v[152:155], a[108:111]
    v_mfma_f32_16x16x32_bf16 a[124:127], v[172:175], v[156:159], a[124:127]
    s_waitcnt lgkmcnt(0)
    v_mfma_f32_16x16x32_bf16 a[0:3], v[96:99], v[64:67], a[0:3]
    s_add_u32 m0, s18, 4096
    ds_read_b64_tr_b16 v[160:161], v39 offset:4096
    v_mfma_f32_16x16x32_bf16 a[16:19], v[96:99], v[68:71], a[16:19]
    buffer_load_dwordx4 v20, s[8:11], s16 offen sc1 lds
    v_mfma_f32_16x16x32_bf16 a[32:35], v[96:99], v[72:75], a[32:35]
    ds_read_b64_tr_b16 v[162:163], v39 offset:4608
    v_mfma_f32_16x16x32_bf16 a[48:51], v[96:99], v[76:79], a[48:51]
    ds_read_b128 v[128:131], v38 offset:256
    v_mfma_f32_16x16x32_bf16 a[64:67], v[96:99], v[80:83], a[64:67]
    s_add_u32 m0, s18, 5120
    ds_read_b128 v[132:135], v38 offset:2304
    v_mfma_f32_16x16x32_bf16 a[80:83], v[96:99], v[84:87], a[80:83]
    buffer_load_dwordx4 v21, s[8:11], s16 offen sc1 lds
    v_mfma_f32_16x16x32_bf16 a[96:99], v[96:99], v[88:91], a[96:99]
    ds_read_b128 v[136:139], v38 offset:4352
    v_mfma_f32_16x16x32_bf16 a[112:115], v[96:99], v[92:95], a[112:115]
    ds_read_b128 v[140:143], v38 offset:6400
    v_mfma_f32_16x16x32_bf16 a[4:7], v[100:103], v[64:67], a[4:7]
    s_add_u32 m0, s18, 6144
    ds_read_b128 v[144:147], v38 offset:8448
    v_mfma_f32_16x16x32_bf16 a[20:23], v[100:103], v[68:71], a[20:23]
    buffer_load_dwordx4 v22, s[8:11], s16 offen sc1 lds
    v_mfma_f32_16x16x32_bf16 a[36:39], v[100:103], v[72:75], a[36:39]
    ds_read_b128 v[148:151], v38 offset:10496
    v_mfma_f32_16x16x32_bf16 a[52:55], v[100:103], v[76:79], a[52:55]
    ds_read_b128 v[152:155], v38 offset:12544
    v_mfma_f32_16x16x32_bf16 a[68:71], v[100:103], v[80:83], a[68:71]
    s_add_u32 m0, s18, 7168
    ds_read_b128 v[156:159], v38 offset:14592
    v_mfma_f32_16x16x32_bf16 a[84:87], v[100:103], v[84:87], a[84:87]
    buffer_load_dwordx4 v23, s[8:11], s16 offen sc1 lds
    v_mfma_f32_16x16x32_bf16 a[100:103], v[100:103], v[88:91], a[100:103]
    ds_read_b64_tr_b16 v[164:165], v40 offset:4096
    v_mfma_f32_16x16x32_bf16 a[116:119], v[100:103], v[92:95], a[116:119]
    ds_read_b64_tr_b16 v[166:167], v40 offset:4608
    v_mfma_f32_16x16x32_bf16 a[8:11], v[104:107], v[64:67], a[8:11]
    ds_read_b64_tr_b16 v[168:169], v39 offset:12288
    v_mfma_f32_16x16x32_bf16 a[24:27], v[104:107], v[68:71], a[24:27]
    v_mfma_f32_16x16x32_bf16 a[40:43], v[104:107], v[72:75], a[40:43]
    ds_read_b64_tr_b16 v[170:171], v39 offset:12800
    v_mfma_f32_16x16x32_bf16 a[56:59], v[104:107], v[76:79], a[56:59]
    ds_read_b64_tr_b16 v[172:173], v40 offset:12288
    v_mfma_f32_16x16x32_bf16 a[72:75], v[104:107], v[80:83], a[72:75]
    ds_read_b64_tr_b16 v[174:175], v40 offset:12800
    v_mfma_f32_16x16x32_bf16 a[88:91], v[104:107], v[84:87], a[88:91]
    v_mfma_f32_16x16x32_bf16 a[104:107], v[104:107], v[88:91], a[104:107]
    v_mfma_f32_16x16x32_bf16 a[120:123], v[104:107], v[92:95], a[120:123]
    v_mfma_f32_16x16x32_bf16 a[12:15], v[108:111], v[64:67], a[12:15]
    v_mfma_f32_16x16x32_bf16 a[28:31], v[108:111], v[68:71], a[28:31]
    v_mfma_f32_16x16x32_bf16 a[44:47], v[108:111], v[72:75], a[44:47]
    v_mfma_f32_16x16x32_bf16 a[60:63], v[108:111], v[76:79], a[60:63]
    s_waitcnt vmcnt(12) lgkmcnt(0)
    s_barrier
    v_mfma_f32_16x16x32_bf16 a[76:79], v[108:111], v[80:83], a[76:79]
    v_mfma_f32_16x16x32_bf16 a[92:95], v[108:111], v[84:87], a[92:95]
    v_mfma_f32_16x16x32_bf16 a[108:111], v[108:111], v[88:91], a[108:111]
    v_mfma_f32_16x16x32_bf16 a[124:127], v[108:111], v[92:95], a[124:127]
    s_add_u32 s16, s16, 512
    s_add_u32 s17, s17, 131072
    s_waitcnt lgkmcnt(0)
    v_mfma_f32_16x16x32_bf16 a[0:3], v[160:163], v[128:131], a[0:3]
    s_add_u32 m0, s18, 49152
    ds_read_b64_tr_b16 v[96:97], v45 offset:0
    v_mfma_f32_16x16x32_bf16 a[16:19], v[160:163], v[132:135], a[16:19]
    buffer_load_dwordx4 v16, s[8:11], s16 offen sc1 lds
    v_mfma_f32_16x16x32_bf16 a[32:35], v[160:163], v[136:139], a[32:35]
    ds_read_b64_tr_b16 v[98:99], v45 offset:512
    v_mfma_f32_16x16x32_bf16 a[48:51], v[160:163], v[140:143], a[48:51]
    ds_read_b128 v[64:67], v44 offset:0
    v_mfma_f32_16x16x32_bf16 a[64:67], v[160:163], v[144:147], a[64:67]
    s_add_u32 m0, s19, 49152
    ds_read_b128 v[68:71], v44 offset:2048
    v_mfma_f32_16x16x32_bf16 a[80:83], v[160:163], v[148:151], a[80:83]
    buffer_load_dwordx4 v24, s[12:15], s17 offen  lds
    v_mfma_f32_16x16x32_bf16 a[96:99], v[160:163], v[152:155], a[96:99]
    ds_read_b128 v[72:75], v44 offset:4096
    v_mfma_f32_16x16x32_bf16 a[112:115], v[160:163], v[156:159], a[112:115]
    ds_read_b128 v[76:79], v44 offset:6144
    v_mfma_f32_16x16x32_bf16 a[4:7], v[164:167], v[128:131], a[4:7]
    s_add_u32 m0, s18, 50176
    ds_read_b128 v[80:83], v44 offset:8192
    v_mfma_f32_16x16x32_bf16 a[20:23], v[164:167], v[132:135], a[20:23]
    buffer_load_dwordx4 v17, s[8:11], s16 offen sc1 lds
    v_mfma_f32_16x16x32_bf16 a[36:39], v[164:167], v[136:139], a[36:39]
    ds_read_b128 v[84:87], v44 offset:10240
    v_mfma_f32_16x16x32_bf16 a[52:55], v[164:167], v[140:143], a[52:55]
    v_mfma_f32_16x16x32_bf16 a[68:71], v[164:167], v[144:147], a[68:71]
    s_add_u32 m0, s19, 50176
    ds_read_b128 v[88:91], v44 offset:12288
    v_mfma_f32_16x16x32_bf16 a[84:87], v[164:167], v[148:151], a[84:87]
    buffer_load_dwordx4 v25, s[12:15], s17 offen  lds
    v_mfma_f32_16x16x32_bf16 a[100:103], v[164:167], v[152:155], a[100:103]
    ds_read_b128 v[92:95], v44 offset:14336
    v_mfma_f32_16x16x32_bf16 a[116:119], v[164:167], v[156:159], a[116:119]
    ds_read_b64_tr_b16 v[100:101], v46 offset:0
    v_mfma_f32_16x16x32_bf16 a[8:11], v[168:171], v[128:131], a[8:11]
    s_add_u32 m0, s18, 51200
    ds_read_b64_tr_b16 v[102:103], v46 offset:512
    v_mfma_f32_16x16x32_bf16 a[24:27], v[168:171], v[132:135], a[24:27]
    buffer_load_dwordx4 v18, s[8:11], s16 offen sc1 lds
    v_mfma_f32_16x16x32_bf16 a[40:43], v[168:171], v[136:139], a[40:43]
    ds_read_b64_tr_b16 v[104:105], v45 offset:8192
    v_mfma_f32_16x16x32_bf16 a[56:59], v[168:171], v[140:143], a[56:59]
    ds_read_b64_tr_b16 v[106:107], v45 offset:8704
    v_mfma_f32_16x16x32_bf16 a[72:75], v[168:171], v[144:147], a[72:75]
    s_add_u32 m0, s19, 51200
    ds_read_b64_tr_b16 v[108:109], v46 offset:8192
    v_mfma_f32_16x16x32_bf16 a[88:91], v[168:171], v[148:151], a[88:91]
    buffer_load_dwordx4 v26, s[12:15], s17 offen  lds
    v_mfma_f32_16x16x32_bf16 a[104:107], v[168:171], v[152:155], a[104:107]
    ds_read_b64_tr_b16 v[110:111], v46 offset:8704
    v_mfma_f32_16x16x32_bf16 a[120:123], v[168:171], v[156:159], a[120:123]
    v_mfma_f32_16x16x32_bf16 a[12:15], v[172:175], v[128:131], a[12:15]
    s_add_u32 m0, s18, 52224
    v_mfma_f32_16x16x32_bf16 a[28:31], v[172:175], v[132:135], a[28:31]
    buffer_load_dwordx4 v19, s[8:11], s16 offen sc1 lds
    v_mfma_f32_16x16x32_bf16 a[44:47], v[172:175], v[136:139], a[44:47]
    v_mfma_f32_16x16x32_bf16 a[60:63], v[172:175], v[140:143], a[60:63]
    v_mfma_f32_16x16x32_bf16 a[76:79], v[172:175], v[144:147], a[76:79]
    s_add_u32 m0, s19, 52224
    v_mfma_f32_16x16x32_bf16 a[92:95], v[172:175], v[148:151], a[92:95]
    buffer_load_dwordx4 v27, s[12:15], s17 offen  lds
    v_mfma_f32_16x16x32_bf16 a[108:111], v[172:175], v[152:155], a[108:111]
    v_mfma_f32_16x16x32_bf16 a[124:127], v[172:175], v[156:159], a[124:127]
    s_waitcnt lgkmcnt(0)
    v_mfma_f32_16x16x32_bf16 a[0:3], v[96:99], v[64:67], a[0:3]
    s_add_u32 m0, s18, 53248
    ds_read_b64_tr_b16 v[160:161], v45 offset:4096
    v_mfma_f32_16x16x32_bf16 a[16:19], v[96:99], v[68:71], a[16:19]
    buffer_load_dwordx4 v20, s[8:11], s16 offen sc1 lds
    v_mfma_f32_16x16x32_bf16 a[32:35], v[96:99], v[72:75], a[32:35]
    ds_read_b64_tr_b16 v[162:163], v45 offset:4608
    v_mfma_f32_16x16x32_bf16 a[48:51], v[96:99], v[76:79], a[48:51]
    ds_read_b128 v[128:131], v44 offset:256
    v_mfma_f32_16x16x32_bf16 a[64:67], v[96:99], v[80:83], a[64:67]
    s_add_u32 m0, s18, 54272
    ds_read_b128 v[132:135], v44 offset:2304
    v_mfma_f32_16x16x32_bf16 a[80:83], v[96:99], v[84:87], a[80:83]
    buffer_load_dwordx4 v21, s[8:11], s16 offen sc1 lds
    v_mfma_f32_16x16x32_bf16 a[96:99], v[96:99], v[88:91], a[96:99]
    ds_read_b128 v[136:139], v44 offset:4352
    v_mfma_f32_16x16x32_bf16 a[112:115], v[96:99], v[92:95], a[112:115]
    ds_read_b128 v[140:143], v44 offset:6400
    v_mfma_f32_16x16x32_bf16 a[4:7], v[100:103], v[64:67], a[4:7]
    s_add_u32 m0, s18, 55296
    ds_read_b128 v[144:147], v44 offset:8448
    v_mfma_f32_16x16x32_bf16 a[20:23], v[100:103], v[68:71], a[20:23]
    buffer_load_dwordx4 v22, s[8:11], s16 offen sc1 lds
    v_mfma_f32_16x16x32_bf16 a[36:39], v[100:103], v[72:75], a[36:39]
    ds_read_b128 v[148:151], v44 offset:10496
    v_mfma_f32_16x16x32_bf16 a[52:55], v[100:103], v[76:79], a[52:55]
    ds_read_b128 v[152:155], v44 offset:12544
    v_mfma_f32_16x16x32_bf16 a[68:71], v[100:103], v[80:83], a[68:71]
    s_add_u32 m0, s18, 56320
    ds_read_b128 v[156:159], v44 offset:14592
    v_mfma_f32_16x16x32_bf16 a[84:87], v[100:103], v[84:87], a[84:87]
    buffer_load_dwordx4 v23, s[8:11], s16 offen sc1 lds
    v_mfma_f32_16x16x32_bf16 a[100:103], v[100:103], v[88:91], a[100:103]
    ds_read_b64_tr_b16 v[164:165], v46 offset:4096
    v_mfma_f32_16x16x32_bf16 a[116:119], v[100:103], v[92:95], a[116:119]
    ds_read_b64_tr_b16 v[166:167], v46 offset:4608
    v_mfma_f32_16x16x32_bf16 a[8:11], v[104:107], v[64:67], a[8:11]
    ds_read_b64_tr_b16 v[168:169], v45 offset:12288
    v_mfma_f32_16x16x32_bf16 a[24:27], v[104:107], v[68:71], a[24:27]
    v_mfma_f32_16x16x32_bf16 a[40:43], v[104:107], v[72:75], a[40:43]
    ds_read_b64_tr_b16 v[170:171], v45 offset:12800
    v_mfma_f32_16x16x32_bf16 a[56:59], v[104:107], v[76:79], a[56:59]
    ds_read_b64_tr_b16 v[172:173], v46 offset:12288
    v_mfma_f32_16x16x32_bf16 a[72:75], v[104:107], v[80:83], a[72:75]
    ds_read_b64_tr_b16 v[174:175], v46 offset:12800
    v_mfma_f32_16x16x32_bf16 a[88:91], v[104:107], v[84:87], a[88:91]
    v_mfma_f32_16x16x32_bf16 a[104:107], v[104:107], v[88:91], a[104:107]
    v_mfma_f32_16x16x32_bf16 a[120:123], v[104:107], v[92:95], a[120:123]
    v_mfma_f32_16x16x32_bf16 a[12:15], v[108:111], v[64:67], a[12:15]
    v_mfma_f32_16x16x32_bf16 a[28:31], v[108:111], v[68:71], a[28:31]
    v_mfma_f32_16x16x32_bf16 a[44:47], v[108:111], v[72:75], a[44:47]
    v_mfma_f32_16x16x32_bf16 a[60:63], v[108:111], v[76:79], a[60:63]
    s_waitcnt vmcnt(12) lgkmcnt(0)
    s_barrier
    v_mfma_f32_16x16x32_bf16 a[76:79], v[108:111], v[80:83], a[76:79]
    v_mfma_f32_16x16x32_bf16 a[92:95], v[108:111], v[84:87], a[92:95]
    v_mfma_f32_16x16x32_bf16 a[108:111], v[108:111], v[88:91], a[108:111]
    v_mfma_f32_16x16x32_bf16 a[124:127], v[108:111], v[92:95], a[124:127]
    s_add_u32 s16, s16, 512
    s_add_u32 s17, s17, 131072
    s_waitcnt lgkmcnt(0)
    v_mfma_f32_16x16x32_bf16 a[0:3], v[160:163], v[128:131], a[0:3]
    s_add_u32 m0, s18, 98304
    ds_read_b64_tr_b16 v[96:97], v33 offset:0
    v_mfma_f32_16x16x32_bf16 a[16:19], v[160:163], v[132:135], a[16:19]
    buffer_load_dwordx4 v16, s[8:11], s16 offen sc1 lds
    v_mfma_f32_16x16x32_bf16 a[32:35], v[160:163], v[136:139], a[32:35]
    ds_read_b64_tr_b16 v[98:99], v33 offset:512
    v_mfma_f32_16x16x32_bf16 a[48:51], v[160:163], v[140:143], a[48:51]
    ds_read_b128 v[64:67], v32 offset:0
    v_mfma_f32_16x16x32_bf16 a[64:67], v[160:163], v[144:147], a[64:67]
    s_add_u32 m0, s19, 98304
    ds_read_b128 v[68:71], v32 offset:2048
    v_mfma_f32_16x16x32_bf16 a[80:83], v[160:163], v[148:151], a[80:83]
    buffer_load_dwordx4 v24, s[12:15], s17 offen  lds
    v_mfma_f32_16x16x32_bf16 a[96:99], v[160:163], v[152:155], a[96:99]
    ds_read_b128 v[72:75], v32 offset:4096
    v_mfma_f32_16x16x32_bf16 a[112:115], v[160:163], v[156:159], a[112:115]
    ds_read_b128 v[76:79], v32 offset:6144
    v_mfma_f32_16x16x32_bf16 a[4:7], v[164:167], v[128:131], a[4:7]
    s_add_u32 m0, s18, 99328
    ds_read_b128 v[80:83], v32 offset:8192
    v_mfma_f32_16x16x32_bf16 a[20:23], v[164:167], v[132:135], a[20:23]
    buffer_load_dwordx4 v17, s[8:11], s16 offen sc1 lds
    v_mfma_f32_16x16x32_bf16 a[36:39], v[164:167], v[136:139], a[36:39]
    ds_read_b128 v[84:87], v32 offset:10240
    v_mfma_f32_16x16x32_bf16 a[52:55], v[164:167], v[140:143], a[52:55]
    v_mfma_f32_16x16x32_bf16 a[68:71], v[164:167], v[144:147], a[68:71]
    s_add_u32 m0, s19, 99328
    ds_read_b128 v[88:91], v32 offset:12288
    v_mfma_f32_16x16x32_bf16 a[84:87], v[164:167], v[148:151], a[84:87]
    buffer_load_dwordx4 v25, s[12:15], s17 offen  lds
    v_mfma_f32_16x16x32_bf16 a[100:103], v[164:167], v[152:155], a[100:103]
    ds_read_b128 v[92:95], v32 offset:14336
    v_mfma_f32_16x16x32_bf16 a[116:119], v[164:167], v[156:159], a[116:119]
    ds_read_b64_tr_b16 v[100:101], v34 offset:0
    v_mfma_f32_16x16x32_bf16 a[8:11], v[168:171], v[128:131], a[8:11]
    s_add_u32 m0, s18, 100352
    ds_read_b64_tr_b16 v[102:103], v34 offset:512
    v_mfma_f32_16x16x32_bf16 a[24:27], v[168:171], v[132:135], a[24:27]
    buffer_load_dwordx4 v18, s[8:11], s16 offen sc1 lds
    v_mfma_f32_16x16x32_bf16 a[40:43], v[168:171], v[136:139], a[40:43]
    ds_read_b64_tr_b16 v[104:105], v33 offset:8192
    v_mfma_f32_16x16x32_bf16 a[56:59], v[168:171], v[140:143], a[56:59]
    ds_read_b64_tr_b16 v[106:107], v33 offset:8704
    v_mfma_f32_16x16x32_bf16 a[72:75], v[168:171], v[144:147], a[72:75]
    s_add_u32 m0, s19, 100352
    ds_read_b64_tr_b16 v[108:109], v34 offset:8192
    v_mfma_f32_16x16x32_bf16 a[88:91], v[168:171], v[148:151], a[88:91]
    buffer_load_dwordx4 v26, s[12:15], s17 offen  lds
    v_mfma_f32_16x16x32_bf16 a[104:107], v[168:171], v[152:155], a[104:107]
    ds_read_b64_tr_b16 v[110:111], v34 offset:8704
    v_mfma_f32_16x16x32_bf16 a[120:123], v[168:171], v[156:159], a[120:123]
    v_mfma_f32_16x16x32_bf16 a[12:15], v[172:175], v[128:131], a[12:15]
    s_add_u32 m0, s18, 101376
    v_mfma_f32_16x16x32_bf16 a[28:31], v[172:175], v[132:135], a[28:31]
    buffer_load_dwordx4 v19, s[8:11], s16 offen sc1 lds
    v_mfma_f32_16x16x32_bf16 a[44:47], v[172:175], v[136:139], a[44:47]
    v_mfma_f32_16x16x32_bf16 a[60:63], v[172:175], v[140:143], a[60:63]
    v_mfma_f32_16x16x32_bf16 a[76:79], v[172:175], v[144:147], a[76:79]
    s_add_u32 m0, s19, 101376
    v_mfma_f32_16x16x32_bf16 a[92:95], v[172:175], v[148:151], a[92:95]
    buffer_load_dwordx4 v27, s[12:15], s17 offen  lds
    v_mfma_f32_16x16x32_bf16 a[108:111], v[172:175], v[152:155], a[108:111]
    v_mfma_f32_16x16x32_bf16 a[124:127], v[172:175], v[156:159], a[124:127]
    s_waitcnt lgkmcnt(0)
    v_mfma_f32_16x16x32_bf16 a[0:3], v[96:99], v[64:67], a[0:3]
    s_add_u32 m0, s18, 102400
    ds_read_b64_tr_b16 v[160:161], v33 offset:4096
    v_mfma_f32_16x16x32_bf16 a[16:19], v[96:99], v[68:71], a[16:19]
    buffer_load_dwordx4 v20, s[8:11], s16 offen sc1 lds
    v_mfma_f32_16x16x32_bf16 a[32:35], v[96:99], v[72:75], a[32:35]
    ds_read_b64_tr_b16 v[162:163], v33 offset:4608
    v_mfma_f32_16x16x32_bf16 a[48:51], v[96:99], v[76:79], a[48:51]
    ds_read_b128 v[128:131], v32 offset:256
    v_mfma_f32_16x16x32_bf16 a[64:67], v[96:99], v[80:83], a[64:67]
    s_add_u32 m0, s18, 103424
    ds_read_b128 v[132:135], v32 offset:2304
    v_mfma_f32_16x16x32_bf16 a[80:83], v[96:99], v[84:87], a[80:83]
    buffer_load_dwordx4 v21, s[8:11], s16 offen sc1 lds
    v_mfma_f32_16x16x32_bf16 a[96:99], v[96:99], v[88:91], a[96:99]
    ds_read_b128 v[136:139], v32 offset:4352
    v_mfma_f32_16x16x32_bf16 a[112:115], v[96:99], v[92:95], a[112:115]
    ds_read_b128 v[140:143], v32 offset:6400
    v_mfma_f32_16x16x32_bf16 a[4:7], v[100:103], v[64:67], a[4:7]
    s_add_u32 m0, s18, 104448
    ds_read_b128 v[144:147], v32 offset:8448
    v_mfma_f32_16x16x32_bf16 a[20:23], v[100:103], v[68:71], a[20:23]
    buffer_load_dwordx4 v22, s[8:11], s16 offen sc1 lds
    v_mfma_f32_16x16x32_bf16 a[36:39], v[100:103], v[72:75], a[36:39]
    ds_read_b128 v[148:151], v32 offset:10496
    v_mfma_f32_16x16x32_bf16 a[52:55], v[100:103], v[76:79], a[52:55]
    ds_read_b128 v[152:155], v32 offset:12544
    v_mfma_f32_16x16x32_bf16 a[68:71], v[100:103], v[80:83], a[68:71]
    s_add_u32 m0, s18, 105472
    ds_read_b128 v[156:159], v32 offset:14592
    v_mfma_f32_16x16x32_bf16 a[84:87], v[100:103], v[84:87], a[84:87]
    buffer_load_dwordx4 v23, s[8:11], s16 offen sc1 lds
    v_mfma_f32_16x16x32_bf16 a[100:103], v[100:103], v[88:91], a[100:103]
    ds_read_b64_tr_b16 v[164:165], v34 offset:4096
    v_mfma_f32_16x16x32_bf16 a[116:119], v[100:103], v[92:95], a[116:119]
    ds_read_b64_tr_b16 v[166:167], v34 offset:4608
    v_mfma_f32_16x16x32_bf16 a[8:11], v[104:107], v[64:67], a[8:11]
    ds_read_b64_tr_b16 v[168:169], v33 offset:12288
    v_mfma_f32_16x16x32_bf16 a[24:27], v[104:107], v[68:71], a[24:27]
    v_mfma_f32_16x16x32_bf16 a[40:43], v[104:107], v[72:75], a[40:43]
    ds_read_b64_tr_b16 v[170:171], v33 offset:12800
    v_mfma_f32_16x16x32_bf16 a[56:59], v[104:107], v[76:79], a[56:59]
    ds_read_b64_tr_b16 v[172:173], v34 offset:12288
    v_mfma_f32_16x16x32_bf16 a[72:75], v[104:107], v[80:83], a[72:75]
    ds_read_b64_tr_b16 v[174:175], v34 offset:12800
    v_mfma_f32_16x16x32_bf16 a[88:91], v[104:107], v[84:87], a[88:91]
    v_mfma_f32_16x16x32_bf16 a[104:107], v[104:107], v[88:91], a[104:107]
    v_mfma_f32_16x16x32_bf16 a[120:123], v[104:107], v[92:95], a[120:123]
    v_mfma_f32_16x16x32_bf16 a[12:15], v[108:111], v[64:67], a[12:15]
    v_mfma_f32_16x16x32_bf16 a[28:31], v[108:111], v[68:71], a[28:31]
    v_mfma_f32_16x16x32_bf16 a[44:47], v[108:111], v[72:75], a[44:47]
    v_mfma_f32_16x16x32_bf16 a[60:63], v[108:111], v[76:79], a[60:63]
    s_waitcnt vmcnt(12) lgkmcnt(0)
    s_barrier
    v_mfma_f32_16x16x32_bf16 a[76:79], v[108:111], v[80:83], a[76:79]
    v_mfma_f32_16x16x32_bf16 a[92:95], v[108:111], v[84:87], a[92:95]
    v_mfma_f32_16x16x32_bf16 a[108:111], v[108:111], v[88:91], a[108:111]
    v_mfma_f32_16x16x32_bf16 a[124:127], v[108:111], v[92:95], a[124:127]
    s_add_u32 s16, s16, 512
    s_add_u32 s17, s17, 131072
    s_sub_u32 s20, s20, 1
    s_cmp_lg_u32 s20, 0
    s_cbranch_scc1 GW2_176
    s_waitcnt lgkmcnt(0)
    v_mfma_f32_16x16x32_bf16 a[0:3], v[160:163], v[128:131], a[0:3]
    s_add_u32 m0, s18, 0
    ds_read_b64_tr_b16 v[96:97], v39 offset:0
    v_mfma_f32_16x16x32_bf16 a[16:19], v[160:163], v[132:135], a[16:19]
    buffer_load_dwordx4 v16, s[8:11], s16 offen sc1 lds
    v_mfma_f32_16x16x32_bf16 a[32:35], v[160:163], v[136:139], a[32:35]
    ds_read_b64_tr_b16 v[98:99], v39 offset:512
    v_mfma_f32_16x16x32_bf16 a[48:51], v[160:163], v[140:143], a[48:51]
    ds_read_b128 v[64:67], v38 offset:0
    v_mfma_f32_16x16x32_bf16 a[64:67], v[160:163], v[144:147], a[64:67]
    s_add_u32 m0, s19, 0
    ds_read_b128 v[68:71], v38 offset:2048
    v_mfma_f32_16x16x32_bf16 a[80:83], v[160:163], v[148:151], a[80:83]
    buffer_load_dwordx4 v24, s[12:15], s17 offen  lds
    v_mfma_f32_16x16x32_bf16 a[96:99], v[160:163], v[152:155], a[96:99]
    ds_read_b128 v[72:75], v38 offset:4096
    v_mfma_f32_16x16x32_bf16 a[112:115], v[160:163], v[156:159], a[112:115]
    ds_read_b128 v[76:79], v38 offset:6144
    v_mfma_f32_16x16x32_bf16 a[4:7], v[164:167], v[128:131], a[4:7]
    s_add_u32 m0, s18, 1024
    ds_read_b128 v[80:83], v38 offset:8192
    v_mfma_f32_16x16x32_bf16 a[20:23], v[164:167], v[132:135], a[20:23]
    buffer_load_dwordx4 v17, s[8:11], s16 offen sc1 lds
    v_mfma_f32_16x16x32_bf16 a[36:39], v[164:167], v[136:139], a[36:39]
    ds_read_b128 v[84:87], v38 offset:10240
    v_mfma_f32_16x16x32_bf16 a[52:55], v[164:167], v[140:143], a[52:55]
    v_mfma_f32_16x16x32_bf16 a[68:71], v[164:167], v[144:147], a[68:71]
    s_add_u32 m0, s19, 1024
    ds_read_b128 v[88:91], v38 offset:12288
    v_mfma_f32_16x16x32_bf16 a[84:87], v[164:167], v[148:151], a[84:87]
    buffer_load_dwordx4 v25, s[12:15], s17 offen  lds
    v_mfma_f32_16x16x32_bf16 a[100:103], v[164:167], v[152:155], a[100:103]
    ds_read_b128 v[92:95], v38 offset:14336
    v_mfma_f32_16x16x32_bf16 a[116:119], v[164:167], v[156:159], a[116:119]
    ds_read_b64_tr_b16 v[100:101], v40 offset:0
    v_mfma_f32_16x16x32_bf16 a[8:11], v[168:171], v[128:131], a[8:11]
    s_add_u32 m0, s18, 2048
    ds_read_b64_tr_b16 v[102:103], v40 offset:512
    v_mfma_f32_16x16x32_bf16 a[24:27], v[168:171], v[132:135], a[24:27]
    buffer_load_dwordx4 v18, s[8:11], s16 offen sc1 lds
    v_mfma_f32_16x16x32_bf16 a[40:43], v[168:171], v[136:139], a[40:43]
    ds_read_b64_tr_b16 v[104:105], v39 offset:8192
    v_mfma_f32_16x16x32_bf16 a[56:59], v[168:171], v[140:143], a[56:59]
    ds_read_b64_tr_b16 v[106:107], v39 offset:8704
    v_mfma_f32_16x16x32_bf16 a[72:75], v[168:171], v[144:147], a[72:75]
    s_add_u32 m0, s19, 2048
    ds_read_b64_tr_b16 v[108:109], v40 offset:8192
    v_mfma_f32_16x16x32_bf16 a[88:91], v[168:171], v[148:151], a[88:91]
    buffer_load_dwordx4 v26, s[12:15], s17 offen  lds
    v_mfma_f32_16x16x32_bf16 a[104:107], v[168:171], v[152:155], a[104:107]
    ds_read_b64_tr_b16 v[110:111], v40 offset:8704
    v_mfma_f32_16x16x32_bf16 a[120:123], v[168:171], v[156:159], a[120:123]
    v_mfma_f32_16x16x32_bf16 a[12:15], v[172:175], v[128:131], a[12:15]
    s_add_u32 m0, s18, 3072
    v_mfma_f32_16x16x32_bf16 a[28:31], v[172:175], v[132:135], a[28:31]
    buffer_load_dwordx4 v19, s[8:11], s16 offen sc1 lds
    v_mfma_f32_16x16x32_bf16 a[44:47], v[172:175], v[136:139], a[44:47]
    v_mfma_f32_16x16x32_bf16 a[60:63], v[172:175], v[140:143], a[60:63]
    v_mfma_f32_16x16x32_bf16 a[76:79], v[172:175], v[144:147], a[76:79]
    s_add_u32 m0, s19, 3072
    v_mfma_f32_16x16x32_bf16 a[92:95], v[172:175], v[148:151], a[92:95]
    buffer_load_dwordx4 v27, s[12:15], s17 offen  lds
    v_mfma_f32_16x16x32_bf16 a[108:111], v[172:175], v[152:155], a[108:111]
    v_mfma_f32_16x16x32_bf16 a[124:127], v[172:175], v[156:159], a[124:127]
    s_waitcnt lgkmcnt(0)
    v_mfma_f32_16x16x32_bf16 a[0:3], v[96:99], v[64:67], a[0:3]
    s_add_u32 m0, s18, 4096
    ds_read_b64_tr_b16 v[160:161], v39 offset:4096
    v_mfma_f32_16x16x32_bf16 a[16:19], v[96:99], v[68:71], a[16:19]
    buffer_load_dwordx4 v20, s[8:11], s16 offen sc1 lds
    v_mfma_f32_16x16x32_bf16 a[32:35], v[96:99], v[72:75], a[32:35]
    ds_read_b64_tr_b16 v[162:163], v39 offset:4608
    v_mfma_f32_16x16x32_bf16 a[48:51], v[96:99], v[76:79], a[48:51]
    ds_read_b128 v[128:131], v38 offset:256
    v_mfma_f32_16x16x32_bf16 a[64:67], v[96:99], v[80:83], a[64:67]
    s_add_u32 m0, s18, 5120
    ds_read_b128 v[132:135], v38 offset:2304
    v_mfma_f32_16x16x32_bf16 a[80:83], v[96:99], v[84:87], a[80:83]
    buffer_load_dwordx4 v21, s[8:11], s16 offen sc1 lds
    v_mfma_f32_16x16x32_bf16 a[96:99], v[96:99], v[88:91], a[96:99]
    ds_read_b128 v[136:139], v38 offset:4352
    v_mfma_f32_16x16x32_bf16 a[112:115], v[96:99], v[92:95], a[112:115]
    ds_read_b128 v[140:143], v38 offset:6400
    v_mfma_f32_16x16x32_bf16 a[4:7], v[100:103], v[64:67], a[4:7]
    s_add_u32 m0, s18, 6144
    ds_read_b128 v[144:147], v38 offset:8448
    v_mfma_f32_16x16x32_bf16 a[20:23], v[100:103], v[68:71], a[20:23]
    buffer_load_dwordx4 v22, s[8:11], s16 offen sc1 lds
    v_mfma_f32_16x16x32_bf16 a[36:39], v[100:103], v[72:75], a[36:39]
    ds_read_b128 v[148:151], v38 offset:10496
    v_mfma_f32_16x16x32_bf16 a[52:55], v[100:103], v[76:79], a[52:55]
    ds_read_b128 v[152:155], v38 offset:12544
    v_mfma_f32_16x16x32_bf16 a[68:71], v[100:103], v[80:83], a[68:71]
    s_add_u32 m0, s18, 7168
    ds_read_b128 v[156:159], v38 offset:14592
    v_mfma_f32_16x16x32_bf16 a[84:87], v[100:103], v[84:87], a[84:87]
    buffer_load_dwordx4 v23, s[8:11], s16 offen sc1 lds
    v_mfma_f32_16x16x32_bf16 a[100:103], v[100:103], v[88:91], a[100:103]
    ds_read_b64_tr_b16 v[164:165], v40 offset:4096
    v_mfma_f32_16x16x32_bf16 a[116:119], v[100:103], v[92:95], a[116:119]
    ds_read_b64_tr_b16 v[166:167], v40 offset:4608
    v_mfma_f32_16x16x32_bf16 a[8:11], v[104:107], v[64:67], a[8:11]
    ds_read_b64_tr_b16 v[168:169], v39 offset:12288
    v_mfma_f32_16x16x32_bf16 a[24:27], v[104:107], v[68:71], a[24:27]
    v_mfma_f32_16x16x32_bf16 a[40:43], v[104:107], v[72:75], a[40:43]
    ds_read_b64_tr_b16 v[170:171], v39 offset:12800
    v_mfma_f32_16x16x32_bf16 a[56:59], v[104:107], v[76:79], a[56:59]
    ds_read_b64_tr_b16 v[172:173], v40 offset:12288
    v_mfma_f32_16x16x32_bf16 a[72:75], v[104:107], v[80:83], a[72:75]
    ds_read_b64_tr_b16 v[174:175], v40 offset:12800
    v_mfma_f32_16x16x32_bf16 a[88:91], v[104:107], v[84:87], a[88:91]
    v_mfma_f32_16x16x32_bf16 a[104:107], v[104:107], v[88:91], a[104:107]
    v_mfma_f32_16x16x32_bf16 a[120:123], v[104:107], v[92:95], a[120:123]
    v_mfma_f32_16x16x32_bf16 a[12:15], v[108:111], v[64:67], a[12:15]
    v_mfma_f32_16x16x32_bf16 a[28:31], v[108:111], v[68:71], a[28:31]
    v_mfma_f32_16x16x32_bf16 a[44:47], v[108:111], v[72:75], a[44:47]
    v_mfma_f32_16x16x32_bf16 a[60:63], v[108:111], v[76:79], a[60:63]
    s_waitcnt vmcnt(12) lgkmcnt(0)
    s_barrier
    v_mfma_f32_16x16x32_bf16 a[76:79], v[108:111], v[80:83], a[76:79]
    v_mfma_f32_16x16x32_bf16 a[92:95], v[108:111], v[84:87], a[92:95]
    v_mfma_f32_16x16x32_bf16 a[108:111], v[108:111], v[88:91], a[108:111]
    v_mfma_f32_16x16x32_bf16 a[124:127], v[108:111], v[92:95], a[124:127]
    s_add_u32 s16, s16, 512
    s_add_u32 s17, s17, 131072
    s_waitcnt lgkmcnt(0)
    v_mfma_f32_16x16x32_bf16 a[0:3], v[160:163], v[128:131], a[0:3]
    ds_read_b64_tr_b16 v[96:97], v45 offset:0
    v_mfma_f32_16x16x32_bf16 a[16:19], v[160:163], v[132:135], a[16:19]
    v_mfma_f32_16x16x32_bf16 a[32:35], v[160:163], v[136:139], a[32:35]
    ds_read_b64_tr_b16 v[98:99], v45 offset:512
    v_mfma_f32_16x16x32_bf16 a[48:51], v[160:163], v[140:143], a[48:51]
    ds_read_b128 v[64:67], v44 offset:0
    v_mfma_f32_16x16x32_bf16 a[64:67], v[160:163], v[144:147], a[64:67]
    ds_read_b128 v[68:71], v44 offset:2048
    v_mfma_f32_16x16x32_bf16 a[80:83], v[160:163], v[148:151], a[80:83]
    v_mfma_f32_16x16x32_bf16 a[96:99], v[160:163], v[152:155], a[96:99]
    ds_read_b128 v[72:75], v44 offset:4096
    v_mfma_f32_16x16x32_bf16 a[112:115], v[160:163], v[156:159], a[112:115]
    ds_read_b128 v[76:79], v44 offset:6144
    v_mfma_f32_16x16x32_bf16 a[4:7], v[164:167], v[128:131], a[4:7]
    ds_read_b128 v[80:83], v44 offset:8192
    v_mfma_f32_16x16x32_bf16 a[20:23], v[164:167], v[132:135], a[20:23]
    v_mfma_f32_16x16x32_bf16 a[36:39], v[164:167], v[136:139], a[36:39]
    ds_read_b128 v[84:87], v44 offset:10240
    v_mfma_f32_16x16x32_bf16 a[52:55], v[164:167], v[140:143], a[52:55]
    v_mfma_f32_16x16x32_bf16 a[68:71], v[164:167], v[144:147], a[68:71]
    ds_read_b128 v[88:91], v44 offset:12288
    v_mfma_f32_16x16x32_bf16 a[84:87], v[164:167], v[148:151], a[84:87]
    v_mfma_f32_16x16x32_bf16 a[100:103], v[164:167], v[152:155], a[100:103]
    ds_read_b128 v[92:95], v44 offset:14336
    v_mfma_f32_16x16x32_bf16 a[116:119], v[164:167], v[156:159], a[116:119]
    ds_read_b64_tr_b16 v[100:101], v46 offset:0
    v_mfma_f32_16x16x32_bf16 a[8:11], v[168:171], v[128:131], a[8:11]
    ds_read_b64_tr_b16 v[102:103], v46 offset:512
    v_mfma_f32_16x16x32_bf16 a[24:27], v[168:171], v[132:135], a[24:27]
    v_mfma_f32_16x16x32_bf16 a[40:43], v[168:171], v[136:139], a[40:43]
    ds_read_b64_tr_b16 v[104:105], v45 offset:8192
    v_mfma_f32_16x16x32_bf16 a[56:59], v[168:171], v[140:143], a[56:59]
    ds_read_b64_tr_b16 v[106:107], v45 offset:8704
    v_mfma_f32_16x16x32_bf16 a[72:75], v[168:171], v[144:147], a[72:75]
    ds_read_b64_tr_b16 v[108:109], v46 offset:8192
    v_mfma_f32_16x16x32_bf16 a[88:91], v[168:171], v[148:151], a[88:91]
    v_mfma_f32_16x16x32_bf16 a[104:107], v[168:171], v[152:155], a[104:107]
    ds_read_b64_tr_b16 v[110:111], v46 offset:8704
    v_mfma_f32_16x16x32_bf16 a[120:123], v[168:171], v[156:159], a[120:123]
    v_mfma_f32_16x16x32_bf16 a[12:15], v[172:175], v[128:131], a[12:15]
    v_mfma_f32_16x16x32_bf16 a[28:31], v[172:175], v[132:135], a[28:31]
    v_mfma_f32_16x16x32_bf16 a[44:47], v[172:175], v[136:139], a[44:47]
    v_mfma_f32_16x16x32_bf16 a[60:63], v[172:175], v[140:143], a[60:63]
    v_mfma_f32_16x16x32_bf16 a[76:79], v[172:175], v[144:147], a[76:79]
    v_mfma_f32_16x16x32_bf16 a[92:95], v[172:175], v[148:151], a[92:95]
    v_mfma_f32_16x16x32_bf16 a[108:111], v[172:175], v[152:155], a[108:111]
    v_mfma_f32_16x16x32_bf16 a[124:127], v[172:175], v[156:159], a[124:127]
    s_waitcnt lgkmcnt(0)
    v_mfma_f32_16x16x32_bf16 a[0:3], v[96:99], v[64:67], a[0:3]
    ds_read_b64_tr_b16 v[160:161], v45 offset:4096
    v_mfma_f32_16x16x32_bf16 a[16:19], v[96:99], v[68:71], a[16:19]
    v_mfma_f32_16x16x32_bf16 a[32:35], v[96:99], v[72:75], a[32:35]
    ds_read_b64_tr_b16 v[162:163], v45 offset:4608
    v_mfma_f32_16x16x32_bf16 a[48:51], v[96:99], v[76:79], a[48:51]
    ds_read_b128 v[128:131], v44 offset:256
    v_mfma_f32_16x16x32_bf16 a[64:67], v[96:99], v[80:83], a[64:67]
    ds_read_b128 v[132:135], v44 offset:2304
    v_mfma_f32_16x16x32_bf16 a[80:83], v[96:99], v[84:87], a[80:83]
    v_mfma_f32_16x16x32_bf16 a[96:99], v[96:99], v[88:91], a[96:99]
    ds_read_b128 v[136:139], v44 offset:4352
    v_mfma_f32_16x16x32_bf16 a[112:115], v[96:99], v[92:95], a[112:115]
    ds_read_b128 v[140:143], v44 offset:6400
    v_mfma_f32_16x16x32_bf16 a[4:7], v[100:103], v[64:67], a[4:7]
    ds_read_b128 v[144:147], v44 offset:8448
    v_mfma_f32_16x16x32_bf16 a[20:23], v[100:103], v[68:71], a[20:23]
    v_mfma_f32_16x16x32_bf16 a[36:39], v[100:103], v[72:75], a[36:39]
    ds_read_b128 v[148:151], v44 offset:10496
    v_mfma_f32_16x16x32_bf16 a[52:55], v[100:103], v[76:79], a[52:55]
    ds_read_b128 v[152:155], v44 offset:12544
    v_mfma_f32_16x16x32_bf16 a[68:71], v[100:103], v[80:83], a[68:71]
    ds_read_b128 v[156:159], v44 offset:14592
    v_mfma_f32_16x16x32_bf16 a[84:87], v[100:103], v[84:87], a[84:87]
    v_mfma_f32_16x16x32_bf16 a[100:103], v[100:103], v[88:91], a[100:103]
    ds_read_b64_tr_b16 v[164:165], v46 offset:4096
    v_mfma_f32_16x16x32_bf16 a[116:119], v[100:103], v[92:95], a[116:119]
    ds_read_b64_tr_b16 v[166:167], v46 offset:4608
    v_mfma_f32_16x16x32_bf16 a[8:11], v[104:107], v[64:67], a[8:11]
    ds_read_b64_tr_b16 v[168:169], v45 offset:12288
    v_mfma_f32_16x16x32_bf16 a[24:27], v[104:107], v[68:71], a[24:27]
    v_mfma_f32_16x16x32_bf16 a[40:43], v[104:107], v[72:75], a[40:43]
    ds_read_b64_tr_b16 v[170:171], v45 offset:12800
    v_mfma_f32_16x16x32_bf16 a[56:59], v[104:107], v[76:79], a[56:59]
    ds_read_b64_tr_b16 v[172:173], v46 offset:12288
    v_mfma_f32_16x16x32_bf16 a[72:75], v[104:107], v[80:83], a[72:75]
    ds_read_b64_tr_b16 v[174:175], v46 offset:12800
    v_mfma_f32_16x16x32_bf16 a[88:91], v[104:107], v[84:87], a[88:91]
    v_mfma_f32_16x16x32_bf16 a[104:107], v[104:107], v[88:91], a[104:107]
    v_mfma_f32_16x16x32_bf16 a[120:123], v[104:107], v[92:95], a[120:123]
    v_mfma_f32_16x16x32_bf16 a[12:15], v[108:111], v[64:67], a[12:15]
    v_mfma_f32_16x16x32_bf16 a[28:31], v[108:111], v[68:71], a[28:31]
    v_mfma_f32_16x16x32_bf16 a[44:47], v[108:111], v[72:75], a[44:47]
    v_mfma_f32_16x16x32_bf16 a[60:63], v[108:111], v[76:79], a[60:63]
    s_waitcnt vmcnt(0) lgkmcnt(0)
    s_barrier
    v_mfma_f32_16x16x32_bf16 a[76:79], v[108:111], v[80:83], a[76:79]
    v_mfma_f32_16x16x32_bf16 a[92:95], v[108:111], v[84:87], a[92:95]
    v_mfma_f32_16x16x32_bf16 a[108:111], v[108:111], v[88:91], a[108:111]
    v_mfma_f32_16x16x32_bf16 a[124:127], v[108:111], v[92:95], a[124:127]
    s_cmp_lg_u32 s3, 0
    s_cbranch_scc1 Ht_177
    v_mov_b32 v14, 1
    s_mov_b64 exec, 1
    buffer_atomic_add v14, off, s[92:95], s97 sc0 sc1
    s_mov_b64 exec, -1
Ht_177:
    s_waitcnt lgkmcnt(0)
    v_mfma_f32_16x16x32_bf16 a[0:3], v[160:163], v[128:131], a[0:3]
    ds_read_b64_tr_b16 v[96:97], v33 offset:0
    v_mfma_f32_16x16x32_bf16 a[16:19], v[160:163], v[132:135], a[16:19]
    v_mfma_f32_16x16x32_bf16 a[32:35], v[160:163], v[136:139], a[32:35]
    ds_read_b64_tr_b16 v[98:99], v33 offset:512
    v_mfma_f32_16x16x32_bf16 a[48:51], v[160:163], v[140:143], a[48:51]
    ds_read_b128 v[64:67], v32 offset:0
    v_mfma_f32_16x16x32_bf16 a[64:67], v[160:163], v[144:147], a[64:67]
    ds_read_b128 v[68:71], v32 offset:2048
    v_mfma_f32_16x16x32_bf16 a[80:83], v[160:163], v[148:151], a[80:83]
    v_mfma_f32_16x16x32_bf16 a[96:99], v[160:163], v[152:155], a[96:99]
    ds_read_b128 v[72:75], v32 offset:4096
    v_mfma_f32_16x16x32_bf16 a[112:115], v[160:163], v[156:159], a[112:115]
    ds_read_b128 v[76:79], v32 offset:6144
    v_mfma_f32_16x16x32_bf16 a[4:7], v[164:167], v[128:131], a[4:7]
    ds_read_b128 v[80:83], v32 offset:8192
    v_mfma_f32_16x16x32_bf16 a[20:23], v[164:167], v[132:135], a[20:23]
    v_mfma_f32_16x16x32_bf16 a[36:39], v[164:167], v[136:139], a[36:39]
    ds_read_b128 v[84:87], v32 offset:10240
    v_mfma_f32_16x16x32_bf16 a[52:55], v[164:167], v[140:143], a[52:55]
    v_mfma_f32_16x16x32_bf16 a[68:71], v[164:167], v[144:147], a[68:71]
    ds_read_b128 v[88:91], v32 offset:12288
    v_mfma_f32_16x16x32_bf16 a[84:87], v[164:167], v[148:151], a[84:87]
    v_mfma_f32_16x16x32_bf16 a[100:103], v[164:167], v[152:155], a[100:103]
    ds_read_b128 v[92:95], v32 offset:14336
    v_mfma_f32_16x16x32_bf16 a[116:119], v[164:167], v[156:159], a[116:119]
    ds_read_b64_tr_b16 v[100:101], v34 offset:0
    v_mfma_f32_16x16x32_bf16 a[8:11], v[168:171], v[128:131], a[8:11]
    ds_read_b64_tr_b16 v[102:103], v34 offset:512
    v_mfma_f32_16x16x32_bf16 a[24:27], v[168:171], v[132:135], a[24:27]
    v_mfma_f32_16x16x32_bf16 a[40:43], v[168:171], v[136:139], a[40:43]
    ds_read_b64_tr_b16 v[104:105], v33 offset:8192
    v_mfma_f32_16x16x32_bf16 a[56:59], v[168:171], v[140:143], a[56:59]
    ds_read_b64_tr_b16 v[106:107], v33 offset:8704
    v_mfma_f32_16x16x32_bf16 a[72:75], v[168:171], v[144:147], a[72:75]
    ds_read_b64_tr_b16 v[108:109], v34 offset:8192
    v_mfma_f32_16x16x32_bf16 a[88:91], v[168:171], v[148:151], a[88:91]
    v_mfma_f32_16x16x32_bf16 a[104:107], v[168:171], v[152:155], a[104:107]
    ds_read_b64_tr_b16 v[110:111], v34 offset:8704
    v_mfma_f32_16x16x32_bf16 a[120:123], v[168:171], v[156:159], a[120:123]
    v_mfma_f32_16x16x32_bf16 a[12:15], v[172:175], v[128:131], a[12:15]
    v_mfma_f32_16x16x32_bf16 a[28:31], v[172:175], v[132:135], a[28:31]
    v_mfma_f32_16x16x32_bf16 a[44:47], v[172:175], v[136:139], a[44:47]
    v_mfma_f32_16x16x32_bf16 a[60:63], v[172:175], v[140:143], a[60:63]
    v_mfma_f32_16x16x32_bf16 a[76:79], v[172:175], v[144:147], a[76:79]
    v_mfma_f32_16x16x32_bf16 a[92:95], v[172:175], v[148:151], a[92:95]
    v_mfma_f32_16x16x32_bf16 a[108:111], v[172:175], v[152:155], a[108:111]
    v_mfma_f32_16x16x32_bf16 a[124:127], v[172:175], v[156:159], a[124:127]
    s_waitcnt lgkmcnt(0)
    v_mfma_f32_16x16x32_bf16 a[0:3], v[96:99], v[64:67], a[0:3]
    ds_read_b64_tr_b16 v[160:161], v33 offset:4096
    v_mfma_f32_16x16x32_bf16 a[16:19], v[96:99], v[68:71], a[16:19]
    v_mfma_f32_16x16x32_bf16 a[32:35], v[96:99], v[72:75], a[32:35]
    ds_read_b64_tr_b16 v[162:163], v33 offset:4608
    v_mfma_f32_16x16x32_bf16 a[48:51], v[96:99], v[76:79], a[48:51]
    ds_read_b128 v[128:131], v32 offset:256
    v_mfma_f32_16x16x32_bf16 a[64:67], v[96:99], v[80:83], a[64:67]
    ds_read_b128 v[132:135], v32 offset:2304
    v_mfma_f32_16x16x32_bf16 a[80:83], v[96:99], v[84:87], a[80:83]
    v_mfma_f32_16x16x32_bf16 a[96:99], v[96:99], v[88:91], a[96:99]
    ds_read_b128 v[136:139], v32 offset:4352
    v_mfma_f32_16x16x32_bf16 a[112:115], v[96:99], v[92:95], a[112:115]
    ds_read_b128 v[140:143], v32 offset:6400
    v_mfma_f32_16x16x32_bf16 a[4:7], v[100:103], v[64:67], a[4:7]
    ds_read_b128 v[144:147], v32 offset:8448
    v_mfma_f32_16x16x32_bf16 a[20:23], v[100:103], v[68:71], a[20:23]
    v_mfma_f32_16x16x32_bf16 a[36:39], v[100:103], v[72:75], a[36:39]
    ds_read_b128 v[148:151], v32 offset:10496
    v_mfma_f32_16x16x32_bf16 a[52:55], v[100:103], v[76:79], a[52:55]
    ds_read_b128 v[152:155], v32 offset:12544
    v_mfma_f32_16x16x32_bf16 a[68:71], v[100:103], v[80:83], a[68:71]
    ds_read_b128 v[156:159], v32 offset:14592
    v_mfma_f32_16x16x32_bf16 a[84:87], v[100:103], v[84:87], a[84:87]
    v_mfma_f32_16x16x32_bf16 a[100:103], v[100:103], v[88:91], a[100:103]
    ds_read_b64_tr_b16 v[164:165], v34 offset:4096
    v_mfma_f32_16x16x32_bf16 a[116:119], v[100:103], v[92:95], a[116:119]
    ds_read_b64_tr_b16 v[166:167], v34 offset:4608
    v_mfma_f32_16x16x32_bf16 a[8:11], v[104:107], v[64:67], a[8:11]
    ds_read_b64_tr_b16 v[168:169], v33 offset:12288
    v_mfma_f32_16x16x32_bf16 a[24:27], v[104:107], v[68:71], a[24:27]
    v_mfma_f32_16x16x32_bf16 a[40:43], v[104:107], v[72:75], a[40:43]
    ds_read_b64_tr_b16 v[170:171], v33 offset:12800
    v_mfma_f32_16x16x32_bf16 a[56:59], v[104:107], v[76:79], a[56:59]
    ds_read_b64_tr_b16 v[172:173], v34 offset:12288
    v_mfma_f32_16x16x32_bf16 a[72:75], v[104:107], v[80:83], a[72:75]
    ds_read_b64_tr_b16 v[174:175], v34 offset:12800
    v_mfma_f32_16x16x32_bf16 a[88:91], v[104:107], v[84:87], a[88:91]
    v_mfma_f32_16x16x32_bf16 a[104:107], v[104:107], v[88:91], a[104:107]
    v_mfma_f32_16x16x32_bf16 a[120:123], v[104:107], v[92:95], a[120:123]
    v_mfma_f32_16x16x32_bf16 a[12:15], v[108:111], v[64:67], a[12:15]
    v_mfma_f32_16x16x32_bf16 a[28:31], v[108:111], v[68:71], a[28:31]
    v_mfma_f32_16x16x32_bf16 a[44:47], v[108:111], v[72:75], a[44:47]
    v_mfma_f32_16x16x32_bf16 a[60:63], v[108:111], v[76:79], a[60:63]
    s_waitcnt lgkmcnt(0)
    s_barrier
    v_mfma_f32_16x16x32_bf16 a[76:79], v[108:111], v[80:83], a[76:79]
    v_mfma_f32_16x16x32_bf16 a[92:95], v[108:111], v[84:87], a[92:95]
    v_mfma_f32_16x16x32_bf16 a[108:111], v[108:111], v[88:91], a[108:111]
    v_mfma_f32_16x16x32_bf16 a[124:127], v[108:111], v[92:95], a[124:127]
    s_waitcnt lgkmcnt(0)
    v_mfma_f32_16x16x32_bf16 a[0:3], v[160:163], v[128:131], a[0:3]
    v_mfma_f32_16x16x32_bf16 a[16:19], v[160:163], v[132:135], a[16:19]
    v_mfma_f32_16x16x32_bf16 a[32:35], v[160:163], v[136:139], a[32:35]
    v_mfma_f32_16x16x32_bf16 a[48:51], v[160:163], v[140:143], a[48:51]
    v_mfma_f32_16x16x32_bf16 a[64:67], v[160:163], v[144:147], a[64:67]
    v_mfma_f32_16x16x32_bf16 a[80:83], v[160:163], v[148:151], a[80:83]
    v_mfma_f32_16x16x32_bf16 a[96:99], v[160:163], v[152:155], a[96:99]
    v_mfma_f32_16x16x32_bf16 a[112:115], v[160:163], v[156:159], a[112:115]
    v_mfma_f32_16x16x32_bf16 a[4:7], v[164:167], v[128:131], a[4:7]
    v_mfma_f32_16x16x32_bf16 a[20:23], v[164:167], v[132:135], a[20:23]
    v_mfma_f32_16x16x32_bf16 a[36:39], v[164:167], v[136:139], a[36:39]
    v_mfma_f32_16x16x32_bf16 a[52:55], v[164:167], v[140:143], a[52:55]
    v_mfma_f32_16x16x32_bf16 a[68:71], v[164:167], v[144:147], a[68:71]
    v_mfma_f32_16x16x32_bf16 a[84:87], v[164:167], v[148:151], a[84:87]
    v_mfma_f32_16x16x32_bf16 a[100:103], v[164:167], v[152:155], a[100:103]
    v_mfma_f32_16x16x32_bf16 a[116:119], v[164:167], v[156:159], a[116:119]
    v_mfma_f32_16x16x32_bf16 a[8:11], v[168:171], v[128:131], a[8:11]
    v_mfma_f32_16x16x32_bf16 a[24:27], v[168:171], v[132:135], a[24:27]
    v_mfma_f32_16x16x32_bf16 a[40:43], v[168:171], v[136:139], a[40:43]
    v_mfma_f32_16x16x32_bf16 a[56:59], v[168:171], v[140:143], a[56:59]
    v_mfma_f32_16x16x32_bf16 a[72:75], v[168:171], v[144:147], a[72:75]
    v_mfma_f32_16x16x32_bf16 a[88:91], v[168:171], v[148:151], a[88:91]
    v_mfma_f32_16x16x32_bf16 a[104:107], v[168:171], v[152:155], a[104:107]
    v_mfma_f32_16x16x32_bf16 a[120:123], v[168:171], v[156:159], a[120:123]
    v_mfma_f32_16x16x32_bf16 a[12:15], v[172:175], v[128:131], a[12:15]
    v_mfma_f32_16x16x32_bf16 a[28:31], v[172:175], v[132:135], a[28:31]
    v_mfma_f32_16x16x32_bf16 a[44:47], v[172:175], v[136:139], a[44:47]
    v_mfma_f32_16x16x32_bf16 a[60:63], v[172:175], v[140:143], a[60:63]
    v_mfma_f32_16x16x32_bf16 a[76:79], v[172:175], v[144:147], a[76:79]
    v_mfma_f32_16x16x32_bf16 a[92:95], v[172:175], v[148:151], a[92:95]
    v_mfma_f32_16x16x32_bf16 a[108:111], v[172:175], v[152:155], a[108:111]
    v_mfma_f32_16x16x32_bf16 a[124:127], v[172:175], v[156:159], a[124:127]
    s_cmp_lg_u32 s3, 0
    s_cbranch_scc1 Am_178
    s_waitcnt vmcnt(0)
    v_readfirstlane_b32 s25, v14
    s_nop 3
    s_add_u32 s25, s25, s83
    s_cmp_eq_u32 s98, 5
    s_cbranch_scc1 N_180
    s_cmp_eq_u32 s98, 4
    s_cbranch_scc1 N_179
    s_lshr_b32 s22, s25, 5
    s_and_b32 s25, s25, 31
    s_lshl_b32 s22, s22, 2
    s_add_u32 s22, s22, s98
    s_lshl_b32 s22, s22, 5
    s_add_u32 s25, s25, s22
N_179:
    s_cmp_lt_u32 s25, 768
    s_cselect_b32 s25, s25, 96
    s_cbranch_scc1 N_180_e
N_180:
    s_add_u32 s25, s25, 768
    s_cmp_lt_u32 s25, 864
N_180_e:
    s_cselect_b32 s39, 1, 0
    s_cselect_b32 s96, 1, 2
    v_mov_b32 v14, s25
    v_mov_b32 v15, 159744
    ds_write_b32 v15, v14
Am_178:
    s_lshr_b32 s32, s36, 0
    s_lshl_b32 s32, s32, 3
    s_add_u32 s32, s32, s37
    s_lshl_b32 s32, s32, 6
    s_add_u32 s32, s32, 113270784
    s_cmp_lg_u32 s3, 0
    s_cbranch_scc1 Wf_181
    v_mov_b32 v5, 0
    s_mov_b32 s30, 0
    s_mov_b32 s21, 0x1
Wp_182:
    buffer_load_dword v4, v5, s[92:95], s32 offen sc1
    s_waitcnt vmcnt(0)
    v_cmp_ne_u32 vcc, s21, v4
    s_cbranch_vccz Wf_181
    s_sleep 8
    s_add_u32 s30, s30, 1
    s_cmp_lt_u32 s30, 65536
    s_cbranch_scc1 Wp_182
    s_branch L_abort
Wf_181:
    s_barrier
    s_mov_b32 s28, s62
    s_and_b32 s29, s63, 0xffff
    s_mov_b32 s30, 4194304
    s_mov_b32 s31, 0x20000
    s_mov_b32 s8, s40
    s_and_b32 s9, s41, 0xffff
    s_mov_b32 s10, 4194304
    s_mov_b32 s11, 0x20000
    s_add_u32 s12, s66, 89128960
    s_addc_u32 s13, s67, 0
    s_and_b32 s13, s13, 0xffff
    s_mov_b32 s14, 4194304
    s_mov_b32 s15, 0x20000
    s_lshl_b32 s32, s36, 19
    s_lshl_b32 s33, s37, 8
    s_lshr_b32 s21, s3, 1
    s_mul_i32 s21, s21, 262144
    s_add_u32 s21, s21, s32
    s_and_b32 s22, s3, 1
    s_lshl_b32 s22, s22, 6
    s_add_u32 s22, s22, s33
    v_bfe_u32 v3, v1, 4, 1
    v_lshrrev_b32 v4, 5, v1
    v_bfe_u32 v10, v1, 2, 2
    v_lshlrev_b32 v10, 13, v10
    v_lshl_add_u32 v10, v3, 7, v10
    v_lshl_add_u32 v10, v4, 4, v10
    v_and_b32 v5, 3, v1
    v_lshl_add_u32 v10, v5, 5, v10
    v_and_b32 v2, 15, v1
    v_lshlrev_b32 v2, 11, v2
    v_lshl_add_u32 v2, v3, 5, v2
    v_lshl_add_u32 v2, v4, 4, v2
    s_lshl_b32 s23, s22, 2
    s_add_u32 s85, s21, s23
    s_add_u32 s84, s21, s22
    s_add_u32 s86, s84, 0
    buffer_load_dwordx4 v[160:163], v2, s[8:11], s86 offen offset:0
    s_add_u32 s86, s85, 0
    buffer_load_dwordx4 v[164:167], v10, s[12:15], s86 offen offset:0 sc1
    s_add_u32 s86, s84, 0
    buffer_load_dwordx4 v[168:171], v2, s[8:11], s86 offen offset:128
    s_add_u32 s86, s85, 0
    buffer_load_dwordx4 v[172:175], v10, s[12:15], s86 offen offset:512 sc1
    s_add_u32 s86, s84, 32768
    buffer_load_dwordx4 v[176:179], v2, s[8:11], s86 offen offset:0
    s_add_u32 s86, s85, 32768
    buffer_load_dwordx4 v[180:183], v10, s[12:15], s86 offen offset:0 sc1
    s_add_u32 s86, s84, 32768
    buffer_load_dwordx4 v[184:187], v2, s[8:11], s86 offen offset:128
    s_add_u32 s86, s85, 32768
    buffer_load_dwordx4 v[188:191], v10, s[12:15], s86 offen offset:512 sc1
    s_add_u32 s86, s84, 65536
    buffer_load_dwordx4 v[192:195], v2, s[8:11], s86 offen offset:0
    s_add_u32 s86, s85, 65536
    buffer_load_dwordx4 v[196:199], v10, s[12:15], s86 offen offset:0 sc1
    s_add_u32 s86, s84, 65536
    buffer_load_dwordx4 v[200:203], v2, s[8:11], s86 offen offset:128
    s_add_u32 s86, s85, 65536
    buffer_load_dwordx4 v[204:207], v10, s[12:15], s86 offen offset:512 sc1
    s_add_u32 s86, s84, 98304
    buffer_load_dwordx4 v[208:211], v2, s[8:11], s86 offen offset:0
    s_add_u32 s86, s85, 98304
    buffer_load_dwordx4 v[212:215], v10, s[12:15], s86 offen offset:0 sc1
    s_add_u32 s86, s84, 98304
    buffer_load_dwordx4 v[216:219], v2, s[8:11], s86 offen offset:128
    s_add_u32 s86, s85, 98304
    buffer_load_dwordx4 v[220:223], v10, s[12:15], s86 offen offset:512 sc1
    s_add_u32 s86, s84, 131072
    buffer_load_dwordx4 v[224:227], v2, s[8:11], s86 offen offset:0
    s_add_u32 s86, s85, 131072
    buffer_load_dwordx4 v[228:231], v10, s[12:15], s86 offen offset:0 sc1
    s_add_u32 s86, s84, 131072
    buffer_load_dwordx4 v[232:235], v2, s[8:11], s86 offen offset:128
    s_add_u32 s86, s85, 131072
    buffer_load_dwordx4 v[236:239], v10, s[12:15], s86 offen offset:512 sc1
    s_add_u32 s86, s84, 163840
    buffer_load_dwordx4 v[240:243], v2, s[8:11], s86 offen offset:0
    s_add_u32 s86, s85, 163840
    buffer_load_dwordx4 v[244:247], v10, s[12:15], s86 offen offset:0 sc1
    s_nop 7
    v_accvgpr_read_b32 v128, a0
    v_accvgpr_read_b32 v129, a1
    v_accvgpr_read_b32 v130, a2
    v_accvgpr_read_b32 v131, a3
    v_accvgpr_read_b32 v132, a4
    v_accvgpr_read_b32 v133, a5
    v_accvgpr_read_b32 v134, a6
    v_accvgpr_read_b32 v135, a7
    v_cvt_pk_bf16_f32 v136, v128, v129
    v_cvt_pk_bf16_f32 v137, v130, v131
    v_cvt_pk_bf16_f32 v138, v132, v133
    v_cvt_pk_bf16_f32 v139, v134, v135
    s_nop 1
    v_permlane16_swap_b32 v136, v138
    v_permlane16_swap_b32 v137, v139
    s_add_u32 s86, s84, 163840
    buffer_load_dwordx4 v[248:251], v2, s[8:11], s86 offen offset:128
    s_add_u32 s86, s85, 163840
    buffer_load_dwordx4 v[252:255], v10, s[12:15], s86 offen offset:512 sc1
    s_waitcnt vmcnt(22)
    v_lshlrev_b32 v128, 16, v136
    v_and_b32 v129, 0xffff0000, v136
    v_lshlrev_b32 v130, 16, v160
    v_and_b32 v131, 0xffff0000, v160
    v_pk_add_f32 v[128:129], v[128:129], v[130:131]
    v_cvt_pk_bf16_f32 v132, v128, v129
    v_lshlrev_b32 v128, 16, v132
    v_and_b32 v129, 0xffff0000, v132
    v_lshlrev_b32 v130, 16, v164
    v_and_b32 v131, 0xffff0000, v164
    v_pk_add_f32 v[128:129], v[128:129], v[130:131]
    v_cvt_pk_bf16_f32 v136, v128, v129
    v_lshlrev_b32 v128, 16, v137
    v_and_b32 v129, 0xffff0000, v137
    v_lshlrev_b32 v130, 16, v161
    v_and_b32 v131, 0xffff0000, v161
    v_pk_add_f32 v[128:129], v[128:129], v[130:131]
    v_cvt_pk_bf16_f32 v132, v128, v129
    v_lshlrev_b32 v128, 16, v132
    v_and_b32 v129, 0xffff0000, v132
    v_lshlrev_b32 v130, 16, v165
    v_and_b32 v131, 0xffff0000, v165
    v_pk_add_f32 v[128:129], v[128:129], v[130:131]
    v_cvt_pk_bf16_f32 v137, v128, v129
    v_lshlrev_b32 v128, 16, v138
    v_and_b32 v129, 0xffff0000, v138
    v_lshlrev_b32 v130, 16, v162
    v_and_b32 v131, 0xffff0000, v162
    v_pk_add_f32 v[128:129], v[128:129], v[130:131]
    v_cvt_pk_bf16_f32 v132, v128, v129
    v_lshlrev_b32 v128, 16, v132
    v_and_b32 v129, 0xffff0000, v132
    v_lshlrev_b32 v130, 16, v166
    v_and_b32 v131, 0xffff0000, v166
    v_pk_add_f32 v[128:129], v[128:129], v[130:131]
    v_cvt_pk_bf16_f32 v138, v128, v129
    v_lshlrev_b32 v128, 16, v139
    v_and_b32 v129, 0xffff0000, v139
    v_lshlrev_b32 v130, 16, v163
    v_and_b32 v131, 0xffff0000, v163
    v_pk_add_f32 v[128:129], v[128:129], v[130:131]
    v_cvt_pk_bf16_f32 v132, v128, v129
    v_lshlrev_b32 v128, 16, v132
    v_and_b32 v129, 0xffff0000, v132
    v_lshlrev_b32 v130, 16, v167
    v_and_b32 v131, 0xffff0000, v167
    v_pk_add_f32 v[128:129], v[128:129], v[130:131]
    v_cvt_pk_bf16_f32 v139, v128, v129
    s_add_u32 s86, s84, 0
    buffer_store_dwordx4 v[136:139], v2, s[28:31], s86 offen offset:0
    v_accvgpr_read_b32 v144, a8
    v_accvgpr_read_b32 v145, a9
    v_accvgpr_read_b32 v146, a10
    v_accvgpr_read_b32 v147, a11
    v_accvgpr_read_b32 v148, a12
    v_accvgpr_read_b32 v149, a13
    v_accvgpr_read_b32 v150, a14
    v_accvgpr_read_b32 v151, a15
    v_cvt_pk_bf16_f32 v152, v144, v145
    v_cvt_pk_bf16_f32 v153, v146, v147
    v_cvt_pk_bf16_f32 v154, v148, v149
    v_cvt_pk_bf16_f32 v155, v150, v151
    s_nop 1
    v_permlane16_swap_b32 v152, v154
    v_permlane16_swap_b32 v153, v155
    s_add_u32 s86, s84, 196608
    buffer_load_dwordx4 v[160:163], v2, s[8:11], s86 offen offset:0
    s_add_u32 s86, s85, 196608
    buffer_load_dwordx4 v[164:167], v10, s[12:15], s86 offen offset:0 sc1
    s_waitcnt vmcnt(22)
    v_lshlrev_b32 v144, 16, v152
    v_and_b32 v145, 0xffff0000, v152
    v_lshlrev_b32 v146, 16, v168
    v_and_b32 v147, 0xffff0000, v168
    v_pk_add_f32 v[144:145], v[144:145], v[146:147]
    v_cvt_pk_bf16_f32 v148, v144, v145
    v_lshlrev_b32 v144, 16, v148
    v_and_b32 v145, 0xffff0000, v148
    v_lshlrev_b32 v146, 16, v172
    v_and_b32 v147, 0xffff0000, v172
    v_pk_add_f32 v[144:145], v[144:145], v[146:147]
    v_cvt_pk_bf16_f32 v152, v144, v145
    v_lshlrev_b32 v144, 16, v153
    v_and_b32 v145, 0xffff0000, v153
    v_lshlrev_b32 v146, 16, v169
    v_and_b32 v147, 0xffff0000, v169
    v_pk_add_f32 v[144:145], v[144:145], v[146:147]
    v_cvt_pk_bf16_f32 v148, v144, v145
    v_lshlrev_b32 v144, 16, v148
    v_and_b32 v145, 0xffff0000, v148
    v_lshlrev_b32 v146, 16, v173
    v_and_b32 v147, 0xffff0000, v173
    v_pk_add_f32 v[144:145], v[144:145], v[146:147]
    v_cvt_pk_bf16_f32 v153, v144, v145
    v_lshlrev_b32 v144, 16, v154
    v_and_b32 v145, 0xffff0000, v154
    v_lshlrev_b32 v146, 16, v170
    v_and_b32 v147, 0xffff0000, v170
    v_pk_add_f32 v[144:145], v[144:145], v[146:147]
    v_cvt_pk_bf16_f32 v148, v144, v145
    v_lshlrev_b32 v144, 16, v148
    v_and_b32 v145, 0xffff0000, v148
    v_lshlrev_b32 v146, 16, v174
    v_and_b32 v147, 0xffff0000, v174
    v_pk_add_f32 v[144:145], v[144:145], v[146:147]
    v_cvt_pk_bf16_f32 v154, v144, v145
    v_lshlrev_b32 v144, 16, v155
    v_and_b32 v145, 0xffff0000, v155
    v_lshlrev_b32 v146, 16, v171
    v_and_b32 v147, 0xffff0000, v171
    v_pk_add_f32 v[144:145], v[144:145], v[146:147]
    v_cvt_pk_bf16_f32 v148, v144, v145
    v_lshlrev_b32 v144, 16, v148
    v_and_b32 v145, 0xffff0000, v148
    v_lshlrev_b32 v146, 16, v175
    v_and_b32 v147, 0xffff0000, v175
    v_pk_add_f32 v[144:145], v[144:145], v[146:147]
    v_cvt_pk_bf16_f32 v155, v144, v145
    s_add_u32 s86, s84, 0
    buffer_store_dwordx4 v[152:155], v2, s[28:31], s86 offen offset:128
    v_accvgpr_read_b32 v128, a16
    v_accvgpr_read_b32 v129, a17
    v_accvgpr_read_b32 v130, a18
    v_accvgpr_read_b32 v131, a19
    v_accvgpr_read_b32 v132, a20
    v_accvgpr_read_b32 v133, a21
    v_accvgpr_read_b32 v134, a22
    v_accvgpr_read_b32 v135, a23
    v_cvt_pk_bf16_f32 v136, v128, v129
    v_cvt_pk_bf16_f32 v137, v130, v131
    v_cvt_pk_bf16_f32 v138, v132, v133
    v_cvt_pk_bf16_f32 v139, v134, v135
    s_nop 1
    v_permlane16_swap_b32 v136, v138
    v_permlane16_swap_b32 v137, v139
    s_add_u32 s86, s84, 196608
    buffer_load_dwordx4 v[168:171], v2, s[8:11], s86 offen offset:128
    s_add_u32 s86, s85, 196608
    buffer_load_dwordx4 v[172:175], v10, s[12:15], s86 offen offset:512 sc1
    s_waitcnt vmcnt(22)
    v_lshlrev_b32 v128, 16, v136
    v_and_b32 v129, 0xffff0000, v136
    v_lshlrev_b32 v130, 16, v176
    v_and_b32 v131, 0xffff0000, v176
    v_pk_add_f32 v[128:129], v[128:129], v[130:131]
    v_cvt_pk_bf16_f32 v132, v128, v129
    v_lshlrev_b32 v128, 16, v132
    v_and_b32 v129, 0xffff0000, v132
    v_lshlrev_b32 v130, 16, v180
    v_and_b32 v131, 0xffff0000, v180
    v_pk_add_f32 v[128:129], v[128:129], v[130:131]
    v_cvt_pk_bf16_f32 v136, v128, v129
    v_lshlrev_b32 v128, 16, v137
    v_and_b32 v129, 0xffff0000, v137
    v_lshlrev_b32 v130, 16, v177
    v_and_b32 v131, 0xffff0000, v177
    v_pk_add_f32 v[128:129], v[128:129], v[130:131]
    v_cvt_pk_bf16_f32 v132, v128, v129
    v_lshlrev_b32 v128, 16, v132
    v_and_b32 v129, 0xffff0000, v132
    v_lshlrev_b32 v130, 16, v181
    v_and_b32 v131, 0xffff0000, v181
    v_pk_add_f32 v[128:129], v[128:129], v[130:131]
    v_cvt_pk_bf16_f32 v137, v128, v129
    v_lshlrev_b32 v128, 16, v138
    v_and_b32 v129, 0xffff0000, v138
    v_lshlrev_b32 v130, 16, v178
    v_and_b32 v131, 0xffff0000, v178
    v_pk_add_f32 v[128:129], v[128:129], v[130:131]
    v_cvt_pk_bf16_f32 v132, v128, v129
    v_lshlrev_b32 v128, 16, v132
    v_and_b32 v129, 0xffff0000, v132
    v_lshlrev_b32 v130, 16, v182
    v_and_b32 v131, 0xffff0000, v182
    v_pk_add_f32 v[128:129], v[128:129], v[130:131]
    v_cvt_pk_bf16_f32 v138, v128, v129
    v_lshlrev_b32 v128, 16, v139
    v_and_b32 v129, 0xffff0000, v139
    v_lshlrev_b32 v130, 16, v179
    v_and_b32 v131, 0xffff0000, v179
    v_pk_add_f32 v[128:129], v[128:129], v[130:131]
    v_cvt_pk_bf16_f32 v132, v128, v129
    v_lshlrev_b32 v128, 16, v132
    v_and_b32 v129, 0xffff0000, v132
    v_lshlrev_b32 v130, 16, v183
    v_and_b32 v131, 0xffff0000, v183
    v_pk_add_f32 v[128:129], v[128:129], v[130:131]
    v_cvt_pk_bf16_f32 v139, v128, v129
    s_add_u32 s86, s84, 32768
    buffer_store_dwordx4 v[136:139], v2, s[28:31], s86 offen offset:0
    v_accvgpr_read_b32 v144, a24
    v_accvgpr_read_b32 v145, a25
    v_accvgpr_read_b32 v146, a26
    v_accvgpr_read_b32 v147, a27
    v_accvgpr_read_b32 v148, a28
    v_accvgpr_read_b32 v149, a29
    v_accvgpr_read_b32 v150, a30
    v_accvgpr_read_b32 v151, a31
    v_cvt_pk_bf16_f32 v152, v144, v145
    v_cvt_pk_bf16_f32 v153, v146, v147
    v_cvt_pk_bf16_f32 v154, v148, v149
    v_cvt_pk_bf16_f32 v155, v150, v151
    s_nop 1
    v_permlane16_swap_b32 v152, v154
    v_permlane16_swap_b32 v153, v155
    s_add_u32 s86, s84, 229376
    buffer_load_dwordx4 v[176:179], v2, s[8:11], s86 offen offset:0
    s_add_u32 s86, s85, 229376
    buffer_load_dwordx4 v[180:183], v10, s[12:15], s86 offen offset:0 sc1
    s_waitcnt vmcnt(22)
    v_lshlrev_b32 v144, 16, v152
    v_and_b32 v145, 0xffff0000, v152
    v_lshlrev_b32 v146, 16, v184
    v_and_b32 v147, 0xffff0000, v184
    v_pk_add_f32 v[144:145], v[144:145], v[146:147]
    v_cvt_pk_bf16_f32 v148, v144, v145
    v_lshlrev_b32 v144, 16, v148
    v_and_b32 v145, 0xffff0000, v148
    v_lshlrev_b32 v146, 16, v188
    v_and_b32 v147, 0xffff0000, v188
    v_pk_add_f32 v[144:145], v[144:145], v[146:147]
    v_cvt_pk_bf16_f32 v152, v144, v145
    v_lshlrev_b32 v144, 16, v153
    v_and_b32 v145, 0xffff0000, v153
    v_lshlrev_b32 v146, 16, v185
    v_and_b32 v147, 0xffff0000, v185
    v_pk_add_f32 v[144:145], v[144:145], v[146:147]
    v_cvt_pk_bf16_f32 v148, v144, v145
    v_lshlrev_b32 v144, 16, v148
    v_and_b32 v145, 0xffff0000, v148
    v_lshlrev_b32 v146, 16, v189
    v_and_b32 v147, 0xffff0000, v189
    v_pk_add_f32 v[144:145], v[144:145], v[146:147]
    v_cvt_pk_bf16_f32 v153, v144, v145
    v_lshlrev_b32 v144, 16, v154
    v_and_b32 v145, 0xffff0000, v154
    v_lshlrev_b32 v146, 16, v186
    v_and_b32 v147, 0xffff0000, v186
    v_pk_add_f32 v[144:145], v[144:145], v[146:147]
    v_cvt_pk_bf16_f32 v148, v144, v145
    v_lshlrev_b32 v144, 16, v148
    v_and_b32 v145, 0xffff0000, v148
    v_lshlrev_b32 v146, 16, v190
    v_and_b32 v147, 0xffff0000, v190
    v_pk_add_f32 v[144:145], v[144:145], v[146:147]
    v_cvt_pk_bf16_f32 v154, v144, v145
    v_lshlrev_b32 v144, 16, v155
    v_and_b32 v145, 0xffff0000, v155
    v_lshlrev_b32 v146, 16, v187
    v_and_b32 v147, 0xffff0000, v187
    v_pk_add_f32 v[144:145], v[144:145], v[146:147]
    v_cvt_pk_bf16_f32 v148, v144, v145
    v_lshlrev_b32 v144, 16, v148
    v_and_b32 v145, 0xffff0000, v148
    v_lshlrev_b32 v146, 16, v191
    v_and_b32 v147, 0xffff0000, v191
    v_pk_add_f32 v[144:145], v[144:145], v[146:147]
    v_cvt_pk_bf16_f32 v155, v144, v145
    s_add_u32 s86, s84, 32768
    buffer_store_dwordx4 v[152:155], v2, s[28:31], s86 offen offset:128
    v_accvgpr_read_b32 v128, a32
    v_accvgpr_read_b32 v129, a33
    v_accvgpr_read_b32 v130, a34
    v_accvgpr_read_b32 v131, a35
    v_accvgpr_read_b32 v132, a36
    v_accvgpr_read_b32 v133, a37
    v_accvgpr_read_b32 v134, a38
    v_accvgpr_read_b32 v135, a39
    v_cvt_pk_bf16_f32 v136, v128, v129
    v_cvt_pk_bf16_f32 v137, v130, v131
    v_cvt_pk_bf16_f32 v138, v132, v133
    v_cvt_pk_bf16_f32 v139, v134, v135
    s_nop 1
    v_permlane16_swap_b32 v136, v138
    v_permlane16_swap_b32 v137, v139
    s_add_u32 s86, s84, 229376
    buffer_load_dwordx4 v[184:187], v2, s[8:11], s86 offen offset:128
    s_add_u32 s86, s85, 229376
    buffer_load_dwordx4 v[188:191], v10, s[12:15], s86 offen offset:512 sc1
    s_waitcnt vmcnt(22)
    v_lshlrev_b32 v128, 16, v136
    v_and_b32 v129, 0xffff0000, v136
    v_lshlrev_b32 v130, 16, v192
    v_and_b32 v131, 0xffff0000, v192
    v_pk_add_f32 v[128:129], v[128:129], v[130:131]
    v_cvt_pk_bf16_f32 v132, v128, v129
    v_lshlrev_b32 v128, 16, v132
    v_and_b32 v129, 0xffff0000, v132
    v_lshlrev_b32 v130, 16, v196
    v_and_b32 v131, 0xffff0000, v196
    v_pk_add_f32 v[128:129], v[128:129], v[130:131]
    v_cvt_pk_bf16_f32 v136, v128, v129
    v_lshlrev_b32 v128, 16, v137
    v_and_b32 v129, 0xffff0000, v137
    v_lshlrev_b32 v130, 16, v193
    v_and_b32 v131, 0xffff0000, v193
    v_pk_add_f32 v[128:129], v[128:129], v[130:131]
    v_cvt_pk_bf16_f32 v132, v128, v129
    v_lshlrev_b32 v128, 16, v132
    v_and_b32 v129, 0xffff0000, v132
    v_lshlrev_b32 v130, 16, v197
    v_and_b32 v131, 0xffff0000, v197
    v_pk_add_f32 v[128:129], v[128:129], v[130:131]
    v_cvt_pk_bf16_f32 v137, v128, v129
    v_lshlrev_b32 v128, 16, v138
    v_and_b32 v129, 0xffff0000, v138
    v_lshlrev_b32 v130, 16, v194
    v_and_b32 v131, 0xffff0000, v194
    v_pk_add_f32 v[128:129], v[128:129], v[130:131]
    v_cvt_pk_bf16_f32 v132, v128, v129
    v_lshlrev_b32 v128, 16, v132
    v_and_b32 v129, 0xffff0000, v132
    v_lshlrev_b32 v130, 16, v198
    v_and_b32 v131, 0xffff0000, v198
    v_pk_add_f32 v[128:129], v[128:129], v[130:131]
    v_cvt_pk_bf16_f32 v138, v128, v129
    v_lshlrev_b32 v128, 16, v139
    v_and_b32 v129, 0xffff0000, v139
    v_lshlrev_b32 v130, 16, v195
    v_and_b32 v131, 0xffff0000, v195
    v_pk_add_f32 v[128:129], v[128:129], v[130:131]
    v_cvt_pk_bf16_f32 v132, v128, v129
    v_lshlrev_b32 v128, 16, v132
    v_and_b32 v129, 0xffff0000, v132
    v_lshlrev_b32 v130, 16, v199
    v_and_b32 v131, 0xffff0000, v199
    v_pk_add_f32 v[128:129], v[128:129], v[130:131]
    v_cvt_pk_bf16_f32 v139, v128, v129
    s_add_u32 s86, s84, 65536
    buffer_store_dwordx4 v[136:139], v2, s[28:31], s86 offen offset:0
    v_accvgpr_read_b32 v144, a40
    v_accvgpr_read_b32 v145, a41
    v_accvgpr_read_b32 v146, a42
    v_accvgpr_read_b32 v147, a43
    v_accvgpr_read_b32 v148, a44
    v_accvgpr_read_b32 v149, a45
    v_accvgpr_read_b32 v150, a46
    v_accvgpr_read_b32 v151, a47
    v_cvt_pk_bf16_f32 v152, v144, v145
    v_cvt_pk_bf16_f32 v153, v146, v147
    v_cvt_pk_bf16_f32 v154, v148, v149
    v_cvt_pk_bf16_f32 v155, v150, v151
    s_nop 1
    v_permlane16_swap_b32 v152, v154
    v_permlane16_swap_b32 v153, v155
    s_waitcnt vmcnt(20)
    v_lshlrev_b32 v144, 16, v152
    v_and_b32 v145, 0xffff0000, v152
    v_lshlrev_b32 v146, 16, v200
    v_and_b32 v147, 0xffff0000, v200
    v_pk_add_f32 v[144:145], v[144:145], v[146:147]
    v_cvt_pk_bf16_f32 v148, v144, v145
    v_lshlrev_b32 v144, 16, v148
    v_and_b32 v145, 0xffff0000, v148
    v_lshlrev_b32 v146, 16, v204
    v_and_b32 v147, 0xffff0000, v204
    v_pk_add_f32 v[144:145], v[144:145], v[146:147]
    v_cvt_pk_bf16_f32 v152, v144, v145
    v_lshlrev_b32 v144, 16, v153
    v_and_b32 v145, 0xffff0000, v153
    v_lshlrev_b32 v146, 16, v201
    v_and_b32 v147, 0xffff0000, v201
    v_pk_add_f32 v[144:145], v[144:145], v[146:147]
    v_cvt_pk_bf16_f32 v148, v144, v145
    v_lshlrev_b32 v144, 16, v148
    v_and_b32 v145, 0xffff0000, v148
    v_lshlrev_b32 v146, 16, v205
    v_and_b32 v147, 0xffff0000, v205
    v_pk_add_f32 v[144:145], v[144:145], v[146:147]
    v_cvt_pk_bf16_f32 v153, v144, v145
    v_lshlrev_b32 v144, 16, v154
    v_and_b32 v145, 0xffff0000, v154
    v_lshlrev_b32 v146, 16, v202
    v_and_b32 v147, 0xffff0000, v202
    v_pk_add_f32 v[144:145], v[144:145], v[146:147]
    v_cvt_pk_bf16_f32 v148, v144, v145
    v_lshlrev_b32 v144, 16, v148
    v_and_b32 v145, 0xffff0000, v148
    v_lshlrev_b32 v146, 16, v206
    v_and_b32 v147, 0xffff0000, v206
    v_pk_add_f32 v[144:145], v[144:145], v[146:147]
    v_cvt_pk_bf16_f32 v154, v144, v145
    v_lshlrev_b32 v144, 16, v155
    v_and_b32 v145, 0xffff0000, v155
    v_lshlrev_b32 v146, 16, v203
    v_and_b32 v147, 0xffff0000, v203
    v_pk_add_f32 v[144:145], v[144:145], v[146:147]
    v_cvt_pk_bf16_f32 v148, v144, v145
    v_lshlrev_b32 v144, 16, v148
    v_and_b32 v145, 0xffff0000, v148
    v_lshlrev_b32 v146, 16, v207
    v_and_b32 v147, 0xffff0000, v207
    v_pk_add_f32 v[144:145], v[144:145], v[146:147]
    v_cvt_pk_bf16_f32 v155, v144, v145
    s_add_u32 s86, s84, 65536
    buffer_store_dwordx4 v[152:155], v2, s[28:31], s86 offen offset:128
    v_accvgpr_read_b32 v128, a48
    v_accvgpr_read_b32 v129, a49
    v_accvgpr_read_b32 v130, a50
    v_accvgpr_read_b32 v131, a51
    v_accvgpr_read_b32 v132, a52
    v_accvgpr_read_b32 v133, a53
    v_accvgpr_read_b32 v134, a54
    v_accvgpr_read_b32 v135, a55
    v_cvt_pk_bf16_f32 v136, v128, v129
    v_cvt_pk_bf16_f32 v137, v130, v131
    v_cvt_pk_bf16_f32 v138, v132, v133
    v_cvt_pk_bf16_f32 v139, v134, v135
    s_nop 1
    v_permlane16_swap_b32 v136, v138
    v_permlane16_swap_b32 v137, v139
    s_waitcnt vmcnt(18)
    v_lshlrev_b32 v128, 16, v136
    v_and_b32 v129, 0xffff0000, v136
    v_lshlrev_b32 v130, 16, v208
    v_and_b32 v131, 0xffff0000, v208
    v_pk_add_f32 v[128:129], v[128:129], v[130:131]
    v_cvt_pk_bf16_f32 v132, v128, v129
    v_lshlrev_b32 v128, 16, v132
    v_and_b32 v129, 0xffff0000, v132
    v_lshlrev_b32 v130, 16, v212
    v_and_b32 v131, 0xffff0000, v212
    v_pk_add_f32 v[128:129], v[128:129], v[130:131]
    v_cvt_pk_bf16_f32 v136, v128, v129
    v_lshlrev_b32 v128, 16, v137
    v_and_b32 v129, 0xffff0000, v137
    v_lshlrev_b32 v130, 16, v209
    v_and_b32 v131, 0xffff0000, v209
    v_pk_add_f32 v[128:129], v[128:129], v[130:131]
    v_cvt_pk_bf16_f32 v132, v128, v129
    v_lshlrev_b32 v128, 16, v132
    v_and_b32 v129, 0xffff0000, v132
    v_lshlrev_b32 v130, 16, v213
    v_and_b32 v131, 0xffff0000, v213
    v_pk_add_f32 v[128:129], v[128:129], v[130:131]
    v_cvt_pk_bf16_f32 v137, v128, v129
    v_lshlrev_b32 v128, 16, v138
    v_and_b32 v129, 0xffff0000, v138
    v_lshlrev_b32 v130, 16, v210
    v_and_b32 v131, 0xffff0000, v210
    v_pk_add_f32 v[128:129], v[128:129], v[130:131]
    v_cvt_pk_bf16_f32 v132, v128, v129
    v_lshlrev_b32 v128, 16, v132
    v_and_b32 v129, 0xffff0000, v132
    v_lshlrev_b32 v130, 16, v214
    v_and_b32 v131, 0xffff0000, v214
    v_pk_add_f32 v[128:129], v[128:129], v[130:131]
    v_cvt_pk_bf16_f32 v138, v128, v129
    v_lshlrev_b32 v128, 16, v139
    v_and_b32 v129, 0xffff0000, v139
    v_lshlrev_b32 v130, 16, v211
    v_and_b32 v131, 0xffff0000, v211
    v_pk_add_f32 v[128:129], v[128:129], v[130:131]
    v_cvt_pk_bf16_f32 v132, v128, v129
    v_lshlrev_b32 v128, 16, v132
    v_and_b32 v129, 0xffff0000, v132
    v_lshlrev_b32 v130, 16, v215
    v_and_b32 v131, 0xffff0000, v215
    v_pk_add_f32 v[128:129], v[128:129], v[130:131]
    v_cvt_pk_bf16_f32 v139, v128, v129
    s_add_u32 s86, s84, 98304
    buffer_store_dwordx4 v[136:139], v2, s[28:31], s86 offen offset:0
    v_accvgpr_read_b32 v144, a56
    v_accvgpr_read_b32 v145, a57
    v_accvgpr_read_b32 v146, a58
    v_accvgpr_read_b32 v147, a59
    v_accvgpr_read_b32 v148, a60
    v_accvgpr_read_b32 v149, a61
    v_accvgpr_read_b32 v150, a62
    v_accvgpr_read_b32 v151, a63
    v_cvt_pk_bf16_f32 v152, v144, v145
    v_cvt_pk_bf16_f32 v153, v146, v147
    v_cvt_pk_bf16_f32 v154, v148, v149
    v_cvt_pk_bf16_f32 v155, v150, v151
    s_nop 1
    v_permlane16_swap_b32 v152, v154
    v_permlane16_swap_b32 v153, v155
    s_waitcnt vmcnt(16)
    v_lshlrev_b32 v144, 16, v152
    v_and_b32 v145, 0xffff0000, v152
    v_lshlrev_b32 v146, 16, v216
    v_and_b32 v147, 0xffff0000, v216
    v_pk_add_f32 v[144:145], v[144:145], v[146:147]
    v_cvt_pk_bf16_f32 v148, v144, v145
    v_lshlrev_b32 v144, 16, v148
    v_and_b32 v145, 0xffff0000, v148
    v_lshlrev_b32 v146, 16, v220
    v_and_b32 v147, 0xffff0000, v220
    v_pk_add_f32 v[144:145], v[144:145], v[146:147]
    v_cvt_pk_bf16_f32 v152, v144, v145
    v_lshlrev_b32 v144, 16, v153
    v_and_b32 v145, 0xffff0000, v153
    v_lshlrev_b32 v146, 16, v217
    v_and_b32 v147, 0xffff0000, v217
    v_pk_add_f32 v[144:145], v[144:145], v[146:147]
    v_cvt_pk_bf16_f32 v148, v144, v145
    v_lshlrev_b32 v144, 16, v148
    v_and_b32 v145, 0xffff0000, v148
    v_lshlrev_b32 v146, 16, v221
    v_and_b32 v147, 0xffff0000, v221
    v_pk_add_f32 v[144:145], v[144:145], v[146:147]
    v_cvt_pk_bf16_f32 v153, v144, v145
    v_lshlrev_b32 v144, 16, v154
    v_and_b32 v145, 0xffff0000, v154
    v_lshlrev_b32 v146, 16, v218
    v_and_b32 v147, 0xffff0000, v218
    v_pk_add_f32 v[144:145], v[144:145], v[146:147]
    v_cvt_pk_bf16_f32 v148, v144, v145
    v_lshlrev_b32 v144, 16, v148
    v_and_b32 v145, 0xffff0000, v148
    v_lshlrev_b32 v146, 16, v222
    v_and_b32 v147, 0xffff0000, v222
    v_pk_add_f32 v[144:145], v[144:145], v[146:147]
    v_cvt_pk_bf16_f32 v154, v144, v145
    v_lshlrev_b32 v144, 16, v155
    v_and_b32 v145, 0xffff0000, v155
    v_lshlrev_b32 v146, 16, v219
    v_and_b32 v147, 0xffff0000, v219
    v_pk_add_f32 v[144:145], v[144:145], v[146:147]
    v_cvt_pk_bf16_f32 v148, v144, v145
    v_lshlrev_b32 v144, 16, v148
    v_and_b32 v145, 0xffff0000, v148
    v_lshlrev_b32 v146, 16, v223
    v_and_b32 v147, 0xffff0000, v223
    v_pk_add_f32 v[144:145], v[144:145], v[146:147]
    v_cvt_pk_bf16_f32 v155, v144, v145
    s_add_u32 s86, s84, 98304
    buffer_store_dwordx4 v[152:155], v2, s[28:31], s86 offen offset:128
    v_accvgpr_read_b32 v128, a64
    v_accvgpr_read_b32 v129, a65
    v_accvgpr_read_b32 v130, a66
    v_accvgpr_read_b32 v131, a67
    v_accvgpr_read_b32 v132, a68
    v_accvgpr_read_b32 v133, a69
    v_accvgpr_read_b32 v134, a70
    v_accvgpr_read_b32 v135, a71
    v_cvt_pk_bf16_f32 v136, v128, v129
    v_cvt_pk_bf16_f32 v137, v130, v131
    v_cvt_pk_bf16_f32 v138, v132, v133
    v_cvt_pk_bf16_f32 v139, v134, v135
    s_nop 1
    v_permlane16_swap_b32 v136, v138
    v_permlane16_swap_b32 v137, v139
    s_waitcnt vmcnt(14)
    v_lshlrev_b32 v128, 16, v136
    v_and_b32 v129, 0xffff0000, v136
    v_lshlrev_b32 v130, 16, v224
    v_and_b32 v131, 0xffff0000, v224
    v_pk_add_f32 v[128:129], v[128:129], v[130:131]
    v_cvt_pk_bf16_f32 v132, v128, v129
    v_lshlrev_b32 v128, 16, v132
    v_and_b32 v129, 0xffff0000, v132
    v_lshlrev_b32 v130, 16, v228
    v_and_b32 v131, 0xffff0000, v228
    v_pk_add_f32 v[128:129], v[128:129], v[130:131]
    v_cvt_pk_bf16_f32 v136, v128, v129
    v_lshlrev_b32 v128, 16, v137
    v_and_b32 v129, 0xffff0000, v137
    v_lshlrev_b32 v130, 16, v225
    v_and_b32 v131, 0xffff0000, v225
    v_pk_add_f32 v[128:129], v[128:129], v[130:131]
    v_cvt_pk_bf16_f32 v132, v128, v129
    v_lshlrev_b32 v128, 16, v132
    v_and_b32 v129, 0xffff0000, v132
    v_lshlrev_b32 v130, 16, v229
    v_and_b32 v131, 0xffff0000, v229
    v_pk_add_f32 v[128:129], v[128:129], v[130:131]
    v_cvt_pk_bf16_f32 v137, v128, v129
    v_lshlrev_b32 v128, 16, v138
    v_and_b32 v129, 0xffff0000, v138
    v_lshlrev_b32 v130, 16, v226
    v_and_b32 v131, 0xffff0000, v226
    v_pk_add_f32 v[128:129], v[128:129], v[130:131]
    v_cvt_pk_bf16_f32 v132, v128, v129
    v_lshlrev_b32 v128, 16, v132
    v_and_b32 v129, 0xffff0000, v132
    v_lshlrev_b32 v130, 16, v230
    v_and_b32 v131, 0xffff0000, v230
    v_pk_add_f32 v[128:129], v[128:129], v[130:131]
    v_cvt_pk_bf16_f32 v138, v128, v129
    v_lshlrev_b32 v128, 16, v139
    v_and_b32 v129, 0xffff0000, v139
    v_lshlrev_b32 v130, 16, v227
    v_and_b32 v131, 0xffff0000, v227
    v_pk_add_f32 v[128:129], v[128:129], v[130:131]
    v_cvt_pk_bf16_f32 v132, v128, v129
    v_lshlrev_b32 v128, 16, v132
    v_and_b32 v129, 0xffff0000, v132
    v_lshlrev_b32 v130, 16, v231
    v_and_b32 v131, 0xffff0000, v231
    v_pk_add_f32 v[128:129], v[128:129], v[130:131]
    v_cvt_pk_bf16_f32 v139, v128, v129
    s_add_u32 s86, s84, 131072
    buffer_store_dwordx4 v[136:139], v2, s[28:31], s86 offen offset:0
    v_accvgpr_read_b32 v144, a72
    v_accvgpr_read_b32 v145, a73
    v_accvgpr_read_b32 v146, a74
    v_accvgpr_read_b32 v147, a75
    v_accvgpr_read_b32 v148, a76
    v_accvgpr_read_b32 v149, a77
    v_accvgpr_read_b32 v150, a78
    v_accvgpr_read_b32 v151, a79
    v_cvt_pk_bf16_f32 v152, v144, v145
    v_cvt_pk_bf16_f32 v153, v146, v147
    v_cvt_pk_bf16_f32 v154, v148, v149
    v_cvt_pk_bf16_f32 v155, v150, v151
    s_nop 1
    v_permlane16_swap_b32 v152, v154
    v_permlane16_swap_b32 v153, v155
    s_waitcnt vmcnt(12)
    v_lshlrev_b32 v144, 16, v152
    v_and_b32 v145, 0xffff0000, v152
    v_lshlrev_b32 v146, 16, v232
    v_and_b32 v147, 0xffff0000, v232
    v_pk_add_f32 v[144:145], v[144:145], v[146:147]
    v_cvt_pk_bf16_f32 v148, v144, v145
    v_lshlrev_b32 v144, 16, v148
    v_and_b32 v145, 0xffff0000, v148
    v_lshlrev_b32 v146, 16, v236
    v_and_b32 v147, 0xffff0000, v236
    v_pk_add_f32 v[144:145], v[144:145], v[146:147]
    v_cvt_pk_bf16_f32 v152, v144, v145
    v_lshlrev_b32 v144, 16, v153
    v_and_b32 v145, 0xffff0000, v153
    v_lshlrev_b32 v146, 16, v233
    v_and_b32 v147, 0xffff0000, v233
    v_pk_add_f32 v[144:145], v[144:145], v[146:147]
    v_cvt_pk_bf16_f32 v148, v144, v145
    v_lshlrev_b32 v144, 16, v148
    v_and_b32 v145, 0xffff0000, v148
    v_lshlrev_b32 v146, 16, v237
    v_and_b32 v147, 0xffff0000, v237
    v_pk_add_f32 v[144:145], v[144:145], v[146:147]
    v_cvt_pk_bf16_f32 v153, v144, v145
    v_lshlrev_b32 v144, 16, v154
    v_and_b32 v145, 0xffff0000, v154
    v_lshlrev_b32 v146, 16, v234
    v_and_b32 v147, 0xffff0000, v234
    v_pk_add_f32 v[144:145], v[144:145], v[146:147]
    v_cvt_pk_bf16_f32 v148, v144, v145
    v_lshlrev_b32 v144, 16, v148
    v_and_b32 v145, 0xffff0000, v148
    v_lshlrev_b32 v146, 16, v238
    v_and_b32 v147, 0xffff0000, v238
    v_pk_add_f32 v[144:145], v[144:145], v[146:147]
    v_cvt_pk_bf16_f32 v154, v144, v145
    v_lshlrev_b32 v144, 16, v155
    v_and_b32 v145, 0xffff0000, v155
    v_lshlrev_b32 v146, 16, v235
    v_and_b32 v147, 0xffff0000, v235
    v_pk_add_f32 v[144:145], v[144:145], v[146:147]
    v_cvt_pk_bf16_f32 v148, v144, v145
    v_lshlrev_b32 v144, 16, v148
    v_and_b32 v145, 0xffff0000, v148
    v_lshlrev_b32 v146, 16, v239
    v_and_b32 v147, 0xffff0000, v239
    v_pk_add_f32 v[144:145], v[144:145], v[146:147]
    v_cvt_pk_bf16_f32 v155, v144, v145
    s_add_u32 s86, s84, 131072
    buffer_store_dwordx4 v[152:155], v2, s[28:31], s86 offen offset:128
    v_accvgpr_read_b32 v128, a80
    v_accvgpr_read_b32 v129, a81
    v_accvgpr_read_b32 v130, a82
    v_accvgpr_read_b32 v131, a83
    v_accvgpr_read_b32 v132, a84
    v_accvgpr_read_b32 v133, a85
    v_accvgpr_read_b32 v134, a86
    v_accvgpr_read_b32 v135, a87
    v_cvt_pk_bf16_f32 v136, v128, v129
    v_cvt_pk_bf16_f32 v137, v130, v131
    v_cvt_pk_bf16_f32 v138, v132, v133
    v_cvt_pk_bf16_f32 v139, v134, v135
    s_nop 1
    v_permlane16_swap_b32 v136, v138
    v_permlane16_swap_b32 v137, v139
    s_waitcnt vmcnt(10)
    v_lshlrev_b32 v128, 16, v136
    v_and_b32 v129, 0xffff0000, v136
    v_lshlrev_b32 v130, 16, v240
    v_and_b32 v131, 0xffff0000, v240
    v_pk_add_f32 v[128:129], v[128:129], v[130:131]
    v_cvt_pk_bf16_f32 v132, v128, v129
    v_lshlrev_b32 v128, 16, v132
    v_and_b32 v129, 0xffff0000, v132
    v_lshlrev_b32 v130, 16, v244
    v_and_b32 v131, 0xffff0000, v244
    v_pk_add_f32 v[128:129], v[128:129], v[130:131]
    v_cvt_pk_bf16_f32 v136, v128, v129
    v_lshlrev_b32 v128, 16, v137
    v_and_b32 v129, 0xffff0000, v137
    v_lshlrev_b32 v130, 16, v241
    v_and_b32 v131, 0xffff0000, v241
    v_pk_add_f32 v[128:129], v[128:129], v[130:131]
    v_cvt_pk_bf16_f32 v132, v128, v129
    v_lshlrev_b32 v128, 16, v132
    v_and_b32 v129, 0xffff0000, v132
    v_lshlrev_b32 v130, 16, v245
    v_and_b32 v131, 0xffff0000, v245
    v_pk_add_f32 v[128:129], v[128:129], v[130:131]
    v_cvt_pk_bf16_f32 v137, v128, v129
    v_lshlrev_b32 v128, 16, v138
    v_and_b32 v129, 0xffff0000, v138
    v_lshlrev_b32 v130, 16, v242
    v_and_b32 v131, 0xffff0000, v242
    v_pk_add_f32 v[128:129], v[128:129], v[130:131]
    v_cvt_pk_bf16_f32 v132, v128, v129
    v_lshlrev_b32 v128, 16, v132
    v_and_b32 v129, 0xffff0000, v132
    v_lshlrev_b32 v130, 16, v246
    v_and_b32 v131, 0xffff0000, v246
    v_pk_add_f32 v[128:129], v[128:129], v[130:131]
    v_cvt_pk_bf16_f32 v138, v128, v129
    v_lshlrev_b32 v128, 16, v139
    v_and_b32 v129, 0xffff0000, v139
    v_lshlrev_b32 v130, 16, v243
    v_and_b32 v131, 0xffff0000, v243
    v_pk_add_f32 v[128:129], v[128:129], v[130:131]
    v_cvt_pk_bf16_f32 v132, v128, v129
    v_lshlrev_b32 v128, 16, v132
    v_and_b32 v129, 0xffff0000, v132
    v_lshlrev_b32 v130, 16, v247
    v_and_b32 v131, 0xffff0000, v247
    v_pk_add_f32 v[128:129], v[128:129], v[130:131]
    v_cvt_pk_bf16_f32 v139, v128, v129
    s_add_u32 s86, s84, 163840
    buffer_store_dwordx4 v[136:139], v2, s[28:31], s86 offen offset:0
    v_accvgpr_read_b32 v144, a88
    v_accvgpr_read_b32 v145, a89
    v_accvgpr_read_b32 v146, a90
    v_accvgpr_read_b32 v147, a91
    v_accvgpr_read_b32 v148, a92
    v_accvgpr_read_b32 v149, a93
    v_accvgpr_read_b32 v150, a94
    v_accvgpr_read_b32 v151, a95
    v_cvt_pk_bf16_f32 v152, v144, v145
    v_cvt_pk_bf16_f32 v153, v146, v147
    v_cvt_pk_bf16_f32 v154, v148, v149
    v_cvt_pk_bf16_f32 v155, v150, v151
    s_nop 1
    v_permlane16_swap_b32 v152, v154
    v_permlane16_swap_b32 v153, v155
    s_waitcnt vmcnt(8)
    v_lshlrev_b32 v144, 16, v152
    v_and_b32 v145, 0xffff0000, v152
    v_lshlrev_b32 v146, 16, v248
    v_and_b32 v147, 0xffff0000, v248
    v_pk_add_f32 v[144:145], v[144:145], v[146:147]
    v_cvt_pk_bf16_f32 v148, v144, v145
    v_lshlrev_b32 v144, 16, v148
    v_and_b32 v145, 0xffff0000, v148
    v_lshlrev_b32 v146, 16, v252
    v_and_b32 v147, 0xffff0000, v252
    v_pk_add_f32 v[144:145], v[144:145], v[146:147]
    v_cvt_pk_bf16_f32 v152, v144, v145
    v_lshlrev_b32 v144, 16, v153
    v_and_b32 v145, 0xffff0000, v153
    v_lshlrev_b32 v146, 16, v249
    v_and_b32 v147, 0xffff0000, v249
    v_pk_add_f32 v[144:145], v[144:145], v[146:147]
    v_cvt_pk_bf16_f32 v148, v144, v145
    v_lshlrev_b32 v144, 16, v148
    v_and_b32 v145, 0xffff0000, v148
    v_lshlrev_b32 v146, 16, v253
    v_and_b32 v147, 0xffff0000, v253
    v_pk_add_f32 v[144:145], v[144:145], v[146:147]
    v_cvt_pk_bf16_f32 v153, v144, v145
    v_lshlrev_b32 v144, 16, v154
    v_and_b32 v145, 0xffff0000, v154
    v_lshlrev_b32 v146, 16, v250
    v_and_b32 v147, 0xffff0000, v250
    v_pk_add_f32 v[144:145], v[144:145], v[146:147]
    v_cvt_pk_bf16_f32 v148, v144, v145
    v_lshlrev_b32 v144, 16, v148
    v_and_b32 v145, 0xffff0000, v148
    v_lshlrev_b32 v146, 16, v254
    v_and_b32 v147, 0xffff0000, v254
    v_pk_add_f32 v[144:145], v[144:145], v[146:147]
    v_cvt_pk_bf16_f32 v154, v144, v145
    v_lshlrev_b32 v144, 16, v155
    v_and_b32 v145, 0xffff0000, v155
    v_lshlrev_b32 v146, 16, v251
    v_and_b32 v147, 0xffff0000, v251
    v_pk_add_f32 v[144:145], v[144:145], v[146:147]
    v_cvt_pk_bf16_f32 v148, v144, v145
    v_lshlrev_b32 v144, 16, v148
    v_and_b32 v145, 0xffff0000, v148
    v_lshlrev_b32 v146, 16, v255
    v_and_b32 v147, 0xffff0000, v255
    v_pk_add_f32 v[144:145], v[144:145], v[146:147]
    v_cvt_pk_bf16_f32 v155, v144, v145
    s_add_u32 s86, s84, 163840
    buffer_store_dwordx4 v[152:155], v2, s[28:31], s86 offen offset:128
    v_accvgpr_read_b32 v128, a96
    v_accvgpr_read_b32 v129, a97
    v_accvgpr_read_b32 v130, a98
    v_accvgpr_read_b32 v131, a99
    v_accvgpr_read_b32 v132, a100
    v_accvgpr_read_b32 v133, a101
    v_accvgpr_read_b32 v134, a102
    v_accvgpr_read_b32 v135, a103
    v_cvt_pk_bf16_f32 v136, v128, v129
    v_cvt_pk_bf16_f32 v137, v130, v131
    v_cvt_pk_bf16_f32 v138, v132, v133
    v_cvt_pk_bf16_f32 v139, v134, v135
    s_nop 1
    v_permlane16_swap_b32 v136, v138
    v_permlane16_swap_b32 v137, v139
    s_waitcnt vmcnt(6)
    v_lshlrev_b32 v128, 16, v136
    v_and_b32 v129, 0xffff0000, v136
    v_lshlrev_b32 v130, 16, v160
    v_and_b32 v131, 0xffff0000, v160
    v_pk_add_f32 v[128:129], v[128:129], v[130:131]
    v_cvt_pk_bf16_f32 v132, v128, v129
    v_lshlrev_b32 v128, 16, v132
    v_and_b32 v129, 0xffff0000, v132
    v_lshlrev_b32 v130, 16, v164
    v_and_b32 v131, 0xffff0000, v164
    v_pk_add_f32 v[128:129], v[128:129], v[130:131]
    v_cvt_pk_bf16_f32 v136, v128, v129
    v_lshlrev_b32 v128, 16, v137
    v_and_b32 v129, 0xffff0000, v137
    v_lshlrev_b32 v130, 16, v161
    v_and_b32 v131, 0xffff0000, v161
    v_pk_add_f32 v[128:129], v[128:129], v[130:131]
    v_cvt_pk_bf16_f32 v132, v128, v129
    v_lshlrev_b32 v128, 16, v132
    v_and_b32 v129, 0xffff0000, v132
    v_lshlrev_b32 v130, 16, v165
    v_and_b32 v131, 0xffff0000, v165
    v_pk_add_f32 v[128:129], v[128:129], v[130:131]
    v_cvt_pk_bf16_f32 v137, v128, v129
    v_lshlrev_b32 v128, 16, v138
    v_and_b32 v129, 0xffff0000, v138
    v_lshlrev_b32 v130, 16, v162
    v_and_b32 v131, 0xffff0000, v162
    v_pk_add_f32 v[128:129], v[128:129], v[130:131]
    v_cvt_pk_bf16_f32 v132, v128, v129
    v_lshlrev_b32 v128, 16, v132
    v_and_b32 v129, 0xffff0000, v132
    v_lshlrev_b32 v130, 16, v166
    v_and_b32 v131, 0xffff0000, v166
    v_pk_add_f32 v[128:129], v[128:129], v[130:131]
    v_cvt_pk_bf16_f32 v138, v128, v129
    v_lshlrev_b32 v128, 16, v139
    v_and_b32 v129, 0xffff0000, v139
    v_lshlrev_b32 v130, 16, v163
    v_and_b32 v131, 0xffff0000, v163
    v_pk_add_f32 v[128:129], v[128:129], v[130:131]
    v_cvt_pk_bf16_f32 v132, v128, v129
    v_lshlrev_b32 v128, 16, v132
    v_and_b32 v129, 0xffff0000, v132
    v_lshlrev_b32 v130, 16, v167
    v_and_b32 v131, 0xffff0000, v167
    v_pk_add_f32 v[128:129], v[128:129], v[130:131]
    v_cvt_pk_bf16_f32 v139, v128, v129
    s_add_u32 s86, s84, 196608
    buffer_store_dwordx4 v[136:139], v2, s[28:31], s86 offen offset:0
    v_accvgpr_read_b32 v144, a104
    v_accvgpr_read_b32 v145, a105
    v_accvgpr_read_b32 v146, a106
    v_accvgpr_read_b32 v147, a107
    v_accvgpr_read_b32 v148, a108
    v_accvgpr_read_b32 v149, a109
    v_accvgpr_read_b32 v150, a110
    v_accvgpr_read_b32 v151, a111
    v_cvt_pk_bf16_f32 v152, v144, v145
    v_cvt_pk_bf16_f32 v153, v146, v147
    v_cvt_pk_bf16_f32 v154, v148, v149
    v_cvt_pk_bf16_f32 v155, v150, v151
    s_nop 1
    v_permlane16_swap_b32 v152, v154
    v_permlane16_swap_b32 v153, v155
    s_waitcnt vmcnt(4)
    v_lshlrev_b32 v144, 16, v152
    v_and_b32 v145, 0xffff0000, v152
    v_lshlrev_b32 v146, 16, v168
    v_and_b32 v147, 0xffff0000, v168
    v_pk_add_f32 v[144:145], v[144:145], v[146:147]
    v_cvt_pk_bf16_f32 v148, v144, v145
    v_lshlrev_b32 v144, 16, v148
    v_and_b32 v145, 0xffff0000, v148
    v_lshlrev_b32 v146, 16, v172
    v_and_b32 v147, 0xffff0000, v172
    v_pk_add_f32 v[144:145], v[144:145], v[146:147]
    v_cvt_pk_bf16_f32 v152, v144, v145
    v_lshlrev_b32 v144, 16, v153
    v_and_b32 v145, 0xffff0000, v153
    v_lshlrev_b32 v146, 16, v169
    v_and_b32 v147, 0xffff0000, v169
    v_pk_add_f32 v[144:145], v[144:145], v[146:147]
    v_cvt_pk_bf16_f32 v148, v144, v145
    v_lshlrev_b32 v144, 16, v148
    v_and_b32 v145, 0xffff0000, v148
    v_lshlrev_b32 v146, 16, v173
    v_and_b32 v147, 0xffff0000, v173
    v_pk_add_f32 v[144:145], v[144:145], v[146:147]
    v_cvt_pk_bf16_f32 v153, v144, v145
    v_lshlrev_b32 v144, 16, v154
    v_and_b32 v145, 0xffff0000, v154
    v_lshlrev_b32 v146, 16, v170
    v_and_b32 v147, 0xffff0000, v170
    v_pk_add_f32 v[144:145], v[144:145], v[146:147]
    v_cvt_pk_bf16_f32 v148, v144, v145
    v_lshlrev_b32 v144, 16, v148
    v_and_b32 v145, 0xffff0000, v148
    v_lshlrev_b32 v146, 16, v174
    v_and_b32 v147, 0xffff0000, v174
    v_pk_add_f32 v[144:145], v[144:145], v[146:147]
    v_cvt_pk_bf16_f32 v154, v144, v145
    v_lshlrev_b32 v144, 16, v155
    v_and_b32 v145, 0xffff0000, v155
    v_lshlrev_b32 v146, 16, v171
    v_and_b32 v147, 0xffff0000, v171
    v_pk_add_f32 v[144:145], v[144:145], v[146:147]
    v_cvt_pk_bf16_f32 v148, v144, v145
    v_lshlrev_b32 v144, 16, v148
    v_and_b32 v145, 0xffff0000, v148
    v_lshlrev_b32 v146, 16, v175
    v_and_b32 v147, 0xffff0000, v175
    v_pk_add_f32 v[144:145], v[144:145], v[146:147]
    v_cvt_pk_bf16_f32 v155, v144, v145
    s_add_u32 s86, s84, 196608
    buffer_store_dwordx4 v[152:155], v2, s[28:31], s86 offen offset:128
    v_accvgpr_read_b32 v128, a112
    v_accvgpr_read_b32 v129, a113
    v_accvgpr_read_b32 v130, a114
    v_accvgpr_read_b32 v131, a115
    v_accvgpr_read_b32 v132, a116
    v_accvgpr_read_b32 v133, a117
    v_accvgpr_read_b32 v134, a118
    v_accvgpr_read_b32 v135, a119
    v_cvt_pk_bf16_f32 v136, v128, v129
    v_cvt_pk_bf16_f32 v137, v130, v131
    v_cvt_pk_bf16_f32 v138, v132, v133
    v_cvt_pk_bf16_f32 v139, v134, v135
    s_nop 1
    v_permlane16_swap_b32 v136, v138
    v_permlane16_swap_b32 v137, v139
    s_waitcnt vmcnt(2)
    v_lshlrev_b32 v128, 16, v136
    v_and_b32 v129, 0xffff0000, v136
    v_lshlrev_b32 v130, 16, v176
    v_and_b32 v131, 0xffff0000, v176
    v_pk_add_f32 v[128:129], v[128:129], v[130:131]
    v_cvt_pk_bf16_f32 v132, v128, v129
    v_lshlrev_b32 v128, 16, v132
    v_and_b32 v129, 0xffff0000, v132
    v_lshlrev_b32 v130, 16, v180
    v_and_b32 v131, 0xffff0000, v180
    v_pk_add_f32 v[128:129], v[128:129], v[130:131]
    v_cvt_pk_bf16_f32 v136, v128, v129
    v_lshlrev_b32 v128, 16, v137
    v_and_b32 v129, 0xffff0000, v137
    v_lshlrev_b32 v130, 16, v177
    v_and_b32 v131, 0xffff0000, v177
    v_pk_add_f32 v[128:129], v[128:129], v[130:131]
    v_cvt_pk_bf16_f32 v132, v128, v129
    v_lshlrev_b32 v128, 16, v132
    v_and_b32 v129, 0xffff0000, v132
    v_lshlrev_b32 v130, 16, v181
    v_and_b32 v131, 0xffff0000, v181
    v_pk_add_f32 v[128:129], v[128:129], v[130:131]
    v_cvt_pk_bf16_f32 v137, v128, v129
    v_lshlrev_b32 v128, 16, v138
    v_and_b32 v129, 0xffff0000, v138
    v_lshlrev_b32 v130, 16, v178
    v_and_b32 v131, 0xffff0000, v178
    v_pk_add_f32 v[128:129], v[128:129], v[130:131]
    v_cvt_pk_bf16_f32 v132, v128, v129
    v_lshlrev_b32 v128, 16, v132
    v_and_b32 v129, 0xffff0000, v132
    v_lshlrev_b32 v130, 16, v182
    v_and_b32 v131, 0xffff0000, v182
    v_pk_add_f32 v[128:129], v[128:129], v[130:131]
    v_cvt_pk_bf16_f32 v138, v128, v129
    v_lshlrev_b32 v128, 16, v139
    v_and_b32 v129, 0xffff0000, v139
    v_lshlrev_b32 v130, 16, v179
    v_and_b32 v131, 0xffff0000, v179
    v_pk_add_f32 v[128:129], v[128:129], v[130:131]
    v_cvt_pk_bf16_f32 v132, v128, v129
    v_lshlrev_b32 v128, 16, v132
    v_and_b32 v129, 0xffff0000, v132
    v_lshlrev_b32 v130, 16, v183
    v_and_b32 v131, 0xffff0000, v183
    v_pk_add_f32 v[128:129], v[128:129], v[130:131]
    v_cvt_pk_bf16_f32 v139, v128, v129
    s_add_u32 s86, s84, 229376
    buffer_store_dwordx4 v[136:139], v2, s[28:31], s86 offen offset:0
    v_accvgpr_read_b32 v144, a120
    v_accvgpr_read_b32 v145, a121
    v_accvgpr_read_b32 v146, a122
    v_accvgpr_read_b32 v147, a123
    v_accvgpr_read_b32 v148, a124
    v_accvgpr_read_b32 v149, a125
    v_accvgpr_read_b32 v150, a126
    v_accvgpr_read_b32 v151, a127
    v_cvt_pk_bf16_f32 v152, v144, v145
    v_cvt_pk_bf16_f32 v153, v146, v147
    v_cvt_pk_bf16_f32 v154, v148, v149
    v_cvt_pk_bf16_f32 v155, v150, v151
    s_nop 1
    v_permlane16_swap_b32 v152, v154
    v_permlane16_swap_b32 v153, v155
    s_waitcnt vmcnt(0)
    v_lshlrev_b32 v144, 16, v152
    v_and_b32 v145, 0xffff0000, v152
    v_lshlrev_b32 v146, 16, v184
    v_and_b32 v147, 0xffff0000, v184
    v_pk_add_f32 v[144:145], v[144:145], v[146:147]
    v_cvt_pk_bf16_f32 v148, v144, v145
    v_lshlrev_b32 v144, 16, v148
    v_and_b32 v145, 0xffff0000, v148
    v_lshlrev_b32 v146, 16, v188
    v_and_b32 v147, 0xffff0000, v188
    v_pk_add_f32 v[144:145], v[144:145], v[146:147]
    v_cvt_pk_bf16_f32 v152, v144, v145
    v_lshlrev_b32 v144, 16, v153
    v_and_b32 v145, 0xffff0000, v153
    v_lshlrev_b32 v146, 16, v185
    v_and_b32 v147, 0xffff0000, v185
    v_pk_add_f32 v[144:145], v[144:145], v[146:147]
    v_cvt_pk_bf16_f32 v148, v144, v145
    v_lshlrev_b32 v144, 16, v148
    v_and_b32 v145, 0xffff0000, v148
    v_lshlrev_b32 v146, 16, v189
    v_and_b32 v147, 0xffff0000, v189
    v_pk_add_f32 v[144:145], v[144:145], v[146:147]
    v_cvt_pk_bf16_f32 v153, v144, v145
    v_lshlrev_b32 v144, 16, v154
    v_and_b32 v145, 0xffff0000, v154
    v_lshlrev_b32 v146, 16, v186
    v_and_b32 v147, 0xffff0000, v186
    v_pk_add_f32 v[144:145], v[144:145], v[146:147]
    v_cvt_pk_bf16_f32 v148, v144, v145
    v_lshlrev_b32 v144, 16, v148
    v_and_b32 v145, 0xffff0000, v148
    v_lshlrev_b32 v146, 16, v190
    v_and_b32 v147, 0xffff0000, v190
    v_pk_add_f32 v[144:145], v[144:145], v[146:147]
    v_cvt_pk_bf16_f32 v154, v144, v145
    v_lshlrev_b32 v144, 16, v155
    v_and_b32 v145, 0xffff0000, v155
    v_lshlrev_b32 v146, 16, v187
    v_and_b32 v147, 0xffff0000, v187
    v_pk_add_f32 v[144:145], v[144:145], v[146:147]
    v_cvt_pk_bf16_f32 v148, v144, v145
    v_lshlrev_b32 v144, 16, v148
    v_and_b32 v145, 0xffff0000, v148
    v_lshlrev_b32 v146, 16, v191
    v_and_b32 v147, 0xffff0000, v191
    v_pk_add_f32 v[144:145], v[144:145], v[146:147]
    v_cvt_pk_bf16_f32 v155, v144, v145
    s_add_u32 s86, s84, 229376
    buffer_store_dwordx4 v[152:155], v2, s[28:31], s86 offen offset:128
    s_branch L_next
L_W1:
    s_call_b64 s[4:5], L_epi
    s_cmp_eq_u32 s69, 0
    s_cbranch_scc1 Fl_183
    s_waitcnt vmcnt(0)
    s_barrier
    s_cmp_lg_u32 s3, 0
    s_cbranch_scc1 Fin_185
    v_mov_b32 v4, s69
    s_mov_b64 exec, 1
    buffer_atomic_add v4, off, s[92:95], s68 sc1
    s_mov_b64 exec, -1
Fin_185:
    s_mov_b32 s69, 0
Fl_183:
    s_lshl_b32 s32, s36, 7
    s_add_u32 s32, s32, 113248640
    s_cmp_lg_u32 s3, 0
    s_cbranch_scc1 Wf_186
    v_mov_b32 v5, 0
    s_mov_b32 s30, 0
    s_mov_b32 s21, 0x80
Wp_187:
    buffer_load_dword v4, v5, s[92:95], s32 offen sc1
    s_waitcnt vmcnt(0)
    v_cmp_ne_u32 vcc, s21, v4
    s_cbranch_vccz Wf_186
    s_sleep 8
    s_add_u32 s30, s30, 1
    s_cmp_lt_u32 s30, 65536
    s_cbranch_scc1 Wp_187
    s_branch L_abort
Wf_186:
    s_barrier
    s_add_u32 s8, s66, 71303168
    s_addc_u32 s9, s67, 0
    s_and_b32 s9, s9, 0xffff
    s_mov_b32 s10, 17039360
    s_mov_b32 s11, 0x20000
    s_mov_b32 s12, s50
    s_and_b32 s13, s51, 0xffff
    s_mov_b32 s14, 8388608
    s_mov_b32 s15, 0x20000
    v_lshrrev_b32 v2, 5, v1
    v_and_b32 v3, 31, v1
    v_lshlrev_b32 v3, 4, v3
    v_lshlrev_b32 v4, 7, v2
    v_xor_b32 v3, v3, v4
    s_mul_i32 s21, s3, 8
    v_add_u32 v2, s21, v2
    s_mov_b32 s22, 33280
    v_mul_lo_u32 v2, v2, s22
    v_add_u32 v3, v2, v3
    v_add_u32 v16, 0, v3
    v_add_u32 v17, 66560, v3
    v_add_u32 v18, 133120, v3
    v_add_u32 v19, 199680, v3
    v_lshrrev_b32 v2, 3, v1
    v_and_b32 v3, 7, v1
    v_bfe_u32 v4, v1, 4, 1
    v_lshlrev_b32 v4, 1, v4
    v_xor_b32 v3, v3, v4
    v_lshrrev_b32 v4, 2, v2
    v_lshlrev_b32 v4, 4, v4
    v_and_b32 v2, 3, v2
    v_add_u32 v2, v2, v4
    s_and_b32 s21, s3, 1
    s_lshl_b32 s21, s21, 5
    v_add_u32 v2, s21, v2
    s_mov_b32 s22, 2048
    v_mul_lo_u32 v2, v2, s22
    s_lshr_b32 s23, s3, 1
    s_lshl_b32 s23, s23, 7
    v_add_u32 v2, s23, v2
    v_lshlrev_b32 v3, 4, v3
    v_xor_b32 v4, 64, v3
    v_add_u32 v3, v2, v3
    v_add_u32 v4, v2, v4
    v_add_u32 v24, 0, v3
    v_add_u32 v25, 8192, v4
    v_add_u32 v26, 16384, v3
    v_add_u32 v27, 24576, v4
    s_mul_i32 s18, s3, 4096
    s_lshl_b32 s19, s3, 12
    s_add_u32 s19, s19, 16384
    s_lshr_b32 s21, s3, 1
    s_mul_i32 s21, s21, 8192
    v_bfe_u32 v2, v1, 2, 2
    v_lshlrev_b32 v2, 9, v2
    v_add_u32 v2, s21, v2
    v_and_b32 v3, 3, v1
    v_lshl_add_u32 v2, v3, 5, v2
    v_bfe_u32 v3, v1, 4, 1
    v_lshl_add_u32 v2, v3, 4, v2
    v_lshrrev_b32 v4, 5, v1
    v_bfe_u32 v5, v1, 2, 1
    v_xor_b32 v4, v4, v5
    v_lshl_add_u32 v32, v4, 7, v2
    v_lshrrev_b32 v4, 4, v1
    v_bfe_u32 v5, v1, 2, 2
    v_lshl_add_u32 v2, v4, 3, v5
    v_lshlrev_b32 v2, 7, v2
    v_and_b32 v4, 3, v1
    v_lshl_add_u32 v2, v4, 3, v2
    v_add_u32 v2, 16384, v2
    v_lshrrev_b32 v5, 1, v5
    v_lshl_or_b32 v3, v3, 1, v5
    s_and_b32 s21, s3, 1
    s_lshl_b32 s21, s21, 1
    v_xor_b32 v3, s21, v3
    v_lshl_add_u32 v33, v3, 5, v2
    v_xor_b32 v34, 32, v33
    v_add_u32 v38, 32768, v32
    v_add_u32 v39, 32768, v33
    v_add_u32 v40, 32768, v34
    v_add_u32 v44, 65536, v32
    v_add_u32 v45, 65536, v33
    v_add_u32 v46, 65536, v34
    v_add_u32 v50, 98304, v32
    v_add_u32 v51, 98304, v33
    v_add_u32 v52, 98304, v34
    s_mul_i32 s16, s36, 1064960
    s_lshl_b32 s17, s37, 8
    s_add_u32 m0, s18, 0
    s_nop 0
    buffer_load_dwordx4 v16, s[8:11], s16 offen sc1 lds
    s_add_u32 m0, s19, 0
    s_nop 0
    buffer_load_dwordx4 v24, s[12:15], s17 offen  lds
    s_add_u32 m0, s18, 1024
    s_nop 0
    buffer_load_dwordx4 v17, s[8:11], s16 offen sc1 lds
    s_add_u32 m0, s19, 1024
    s_nop 0
    buffer_load_dwordx4 v25, s[12:15], s17 offen  lds
    s_add_u32 m0, s18, 2048
    s_nop 0
    buffer_load_dwordx4 v18, s[8:11], s16 offen sc1 lds
    s_add_u32 m0, s19, 2048
    s_nop 0
    buffer_load_dwordx4 v26, s[12:15], s17 offen  lds
    s_add_u32 m0, s18, 3072
    s_nop 0
    buffer_load_dwordx4 v19, s[8:11], s16 offen sc1 lds
    s_add_u32 m0, s19, 3072
    s_nop 0
    buffer_load_dwordx4 v27, s[12:15], s17 offen  lds
    s_add_u32 s16, s16, 512
    s_add_u32 s17, s17, 131072
    s_add_u32 m0, s18, 32768
    s_nop 0
    buffer_load_dwordx4 v16, s[8:11], s16 offen sc1 lds
    s_add_u32 m0, s19, 32768
    s_nop 0
    buffer_load_dwordx4 v24, s[12:15], s17 offen  lds
    s_add_u32 m0, s18, 33792
    s_nop 0
    buffer_load_dwordx4 v17, s[8:11], s16 offen sc1 lds
    s_add_u32 m0, s19, 33792
    s_nop 0
    buffer_load_dwordx4 v25, s[12:15], s17 offen  lds
    s_add_u32 m0, s18, 34816
    s_nop 0
    buffer_load_dwordx4 v18, s[8:11], s16 offen sc1 lds
    s_add_u32 m0, s19, 34816
    s_nop 0
    buffer_load_dwordx4 v26, s[12:15], s17 offen  lds
    s_add_u32 m0, s18, 35840
    s_nop 0
    buffer_load_dwordx4 v19, s[8:11], s16 offen sc1 lds
    s_add_u32 m0, s19, 35840
    s_nop 0
    buffer_load_dwordx4 v27, s[12:15], s17 offen  lds
    s_add_u32 s16, s16, 512
    s_add_u32 s17, s17, 131072
    s_add_u32 m0, s18, 65536
    s_nop 0
    buffer_load_dwordx4 v16, s[8:11], s16 offen sc1 lds
    s_add_u32 m0, s19, 65536
    s_nop 0
    buffer_load_dwordx4 v24, s[12:15], s17 offen  lds
    s_add_u32 m0, s18, 66560
    s_nop 0
    buffer_load_dwordx4 v17, s[8:11], s16 offen sc1 lds
    s_add_u32 m0, s19, 66560
    s_nop 0
    buffer_load_dwordx4 v25, s[12:15], s17 offen  lds
    s_add_u32 m0, s18, 67584
    s_nop 0
    buffer_load_dwordx4 v18, s[8:11], s16 offen sc1 lds
    s_add_u32 m0, s19, 67584
    s_nop 0
    buffer_load_dwordx4 v26, s[12:15], s17 offen  lds
    s_add_u32 m0, s18, 68608
    s_nop 0
    buffer_load_dwordx4 v19, s[8:11], s16 offen sc1 lds
    s_add_u32 m0, s19, 68608
    s_nop 0
    buffer_load_dwordx4 v27, s[12:15], s17 offen  lds
    s_add_u32 s16, s16, 512
    s_add_u32 s17, s17, 131072
    s_add_u32 m0, s18, 98304
    s_nop 0
    buffer_load_dwordx4 v16, s[8:11], s16 offen sc1 lds
    s_add_u32 m0, s19, 98304
    s_nop 0
    buffer_load_dwordx4 v24, s[12:15], s17 offen  lds
    s_add_u32 m0, s18, 99328
    s_nop 0
    buffer_load_dwordx4 v17, s[8:11], s16 offen sc1 lds
    s_add_u32 m0, s19, 99328
    s_nop 0
    buffer_load_dwordx4 v25, s[12:15], s17 offen  lds
    s_add_u32 m0, s18, 100352
    s_nop 0
    buffer_load_dwordx4 v18, s[8:11], s16 offen sc1 lds
    s_add_u32 m0, s19, 100352
    s_nop 0
    buffer_load_dwordx4 v26, s[12:15], s17 offen  lds
    s_add_u32 m0, s18, 101376
    s_nop 0
    buffer_load_dwordx4 v19, s[8:11], s16 offen sc1 lds
    s_add_u32 m0, s19, 101376
    s_nop 0
    buffer_load_dwordx4 v27, s[12:15], s17 offen  lds
    s_add_u32 s16, s16, 512
    s_add_u32 s17, s17, 131072
    s_waitcnt vmcnt(24)
    s_barrier
    ds_read_b64_tr_b16 v[96:97], v33 offset:0
    ds_read_b64_tr_b16 v[98:99], v33 offset:512
    ds_read_b128 v[64:67], v32 offset:0
    ds_read_b128 v[68:71], v32 offset:2048
    ds_read_b128 v[72:75], v32 offset:4096
    ds_read_b128 v[76:79], v32 offset:6144
    ds_read_b64_tr_b16 v[100:101], v34 offset:0
    ds_read_b64_tr_b16 v[102:103], v34 offset:512
    ds_read_b64_tr_b16 v[104:105], v33 offset:8192
    ds_read_b64_tr_b16 v[106:107], v33 offset:8704
    ds_read_b64_tr_b16 v[108:109], v34 offset:8192
    ds_read_b64_tr_b16 v[110:111], v34 offset:8704
    s_waitcnt lgkmcnt(0)
    v_mfma_f32_16x16x32_bf16 a[0:3], v[96:99], v[64:67], 0
    ds_read_b64_tr_b16 v[160:161], v33 offset:4096
    ds_read_b64_tr_b16 v[162:163], v33 offset:4608
    v_mfma_f32_16x16x32_bf16 a[16:19], v[96:99], v[68:71], 0
    v_mfma_f32_16x16x32_bf16 a[32:35], v[96:99], v[72:75], 0
    ds_read_b128 v[128:131], v32 offset:256
    v_mfma_f32_16x16x32_bf16 a[48:51], v[96:99], v[76:79], 0
    ds_read_b128 v[132:135], v32 offset:2304
    ds_read_b128 v[136:139], v32 offset:4352
    v_mfma_f32_16x16x32_bf16 a[4:7], v[100:103], v[64:67], 0
    ds_read_b128 v[140:143], v32 offset:6400
    v_mfma_f32_16x16x32_bf16 a[20:23], v[100:103], v[68:71], 0
    v_mfma_f32_16x16x32_bf16 a[36:39], v[100:103], v[72:75], 0
    ds_read_b64_tr_b16 v[164:165], v34 offset:4096
    ds_read_b64_tr_b16 v[166:167], v34 offset:4608
    v_mfma_f32_16x16x32_bf16 a[52:55], v[100:103], v[76:79], 0
    ds_read_b64_tr_b16 v[168:169], v33 offset:12288
    v_mfma_f32_16x16x32_bf16 a[8:11], v[104:107], v[64:67], 0
    ds_read_b64_tr_b16 v[170:171], v33 offset:12800
    ds_read_b64_tr_b16 v[172:173], v34 offset:12288
    v_mfma_f32_16x16x32_bf16 a[24:27], v[104:107], v[68:71], 0
    v_mfma_f32_16x16x32_bf16 a[40:43], v[104:107], v[72:75], 0
    ds_read_b64_tr_b16 v[174:175], v34 offset:12800
    v_mfma_f32_16x16x32_bf16 a[56:59], v[104:107], v[76:79], 0
    v_mfma_f32_16x16x32_bf16 a[12:15], v[108:111], v[64:67], 0
    v_mfma_f32_16x16x32_bf16 a[28:31], v[108:111], v[68:71], 0
    s_waitcnt vmcnt(16) lgkmcnt(0)
    s_barrier
    v_mfma_f32_16x16x32_bf16 a[44:47], v[108:111], v[72:75], 0
    v_mfma_f32_16x16x32_bf16 a[60:63], v[108:111], v[76:79], 0
    s_mov_b32 s20, 15
GW1_188:
    s_waitcnt lgkmcnt(0)
    v_mfma_f32_16x16x32_bf16 a[0:3], v[160:163], v[128:131], a[0:3]
    s_add_u32 m0, s18, 0
    ds_read_b64_tr_b16 v[96:97], v39 offset:0
    ds_read_b64_tr_b16 v[98:99], v39 offset:512
    v_mfma_f32_16x16x32_bf16 a[16:19], v[160:163], v[132:135], a[16:19]
    buffer_load_dwordx4 v16, s[8:11], s16 offen sc1 lds
    v_mfma_f32_16x16x32_bf16 a[32:35], v[160:163], v[136:139], a[32:35]
    ds_read_b128 v[64:67], v38 offset:0
    v_mfma_f32_16x16x32_bf16 a[48:51], v[160:163], v[140:143], a[48:51]
    ds_read_b128 v[68:71], v38 offset:2048
    v_mfma_f32_16x16x32_bf16 a[4:7], v[164:167], v[128:131], a[4:7]
    s_add_u32 m0, s19, 0
    ds_read_b128 v[72:75], v38 offset:4096
    ds_read_b128 v[76:79], v38 offset:6144
    v_mfma_f32_16x16x32_bf16 a[20:23], v[164:167], v[132:135], a[20:23]
    buffer_load_dwordx4 v24, s[12:15], s17 offen  lds
    v_mfma_f32_16x16x32_bf16 a[36:39], v[164:167], v[136:139], a[36:39]
    ds_read_b64_tr_b16 v[100:101], v40 offset:0
    v_mfma_f32_16x16x32_bf16 a[52:55], v[164:167], v[140:143], a[52:55]
    ds_read_b64_tr_b16 v[102:103], v40 offset:512
    v_mfma_f32_16x16x32_bf16 a[8:11], v[168:171], v[128:131], a[8:11]
    s_add_u32 m0, s18, 1024
    ds_read_b64_tr_b16 v[104:105], v39 offset:8192
    ds_read_b64_tr_b16 v[106:107], v39 offset:8704
    v_mfma_f32_16x16x32_bf16 a[24:27], v[168:171], v[132:135], a[24:27]
    buffer_load_dwordx4 v17, s[8:11], s16 offen sc1 lds
    v_mfma_f32_16x16x32_bf16 a[40:43], v[168:171], v[136:139], a[40:43]
    ds_read_b64_tr_b16 v[108:109], v40 offset:8192
    v_mfma_f32_16x16x32_bf16 a[56:59], v[168:171], v[140:143], a[56:59]
    ds_read_b64_tr_b16 v[110:111], v40 offset:8704
    v_mfma_f32_16x16x32_bf16 a[12:15], v[172:175], v[128:131], a[12:15]
    s_add_u32 m0, s19, 1024
    v_mfma_f32_16x16x32_bf16 a[28:31], v[172:175], v[132:135], a[28:31]
    buffer_load_dwordx4 v25, s[12:15], s17 offen  lds
    v_mfma_f32_16x16x32_bf16 a[44:47], v[172:175], v[136:139], a[44:47]
    v_mfma_f32_16x16x32_bf16 a[60:63], v[172:175], v[140:143], a[60:63]
    s_waitcnt lgkmcnt(0)
    v_mfma_f32_16x16x32_bf16 a[0:3], v[96:99], v[64:67], a[0:3]
    s_add_u32 m0, s18, 2048
    ds_read_b64_tr_b16 v[160:161], v39 offset:4096
    ds_read_b64_tr_b16 v[162:163], v39 offset:4608
    v_mfma_f32_16x16x32_bf16 a[16:19], v[96:99], v[68:71], a[16:19]
    buffer_load_dwordx4 v18, s[8:11], s16 offen sc1 lds
    v_mfma_f32_16x16x32_bf16 a[32:35], v[96:99], v[72:75], a[32:35]
    ds_read_b128 v[128:131], v38 offset:256
    v_mfma_f32_16x16x32_bf16 a[48:51], v[96:99], v[76:79], a[48:51]
    ds_read_b128 v[132:135], v38 offset:2304
    ds_read_b128 v[136:139], v38 offset:4352
    v_mfma_f32_16x16x32_bf16 a[4:7], v[100:103], v[64:67], a[4:7]
    s_add_u32 m0, s19, 2048
    ds_read_b128 v[140:143], v38 offset:6400
    v_mfma_f32_16x16x32_bf16 a[20:23], v[100:103], v[68:71], a[20:23]
    buffer_load_dwordx4 v26, s[12:15], s17 offen  lds
    v_mfma_f32_16x16x32_bf16 a[36:39], v[100:103], v[72:75], a[36:39]
    ds_read_b64_tr_b16 v[164:165], v40 offset:4096
    ds_read_b64_tr_b16 v[166:167], v40 offset:4608
    v_mfma_f32_16x16x32_bf16 a[52:55], v[100:103], v[76:79], a[52:55]
    ds_read_b64_tr_b16 v[168:169], v39 offset:12288
    v_mfma_f32_16x16x32_bf16 a[8:11], v[104:107], v[64:67], a[8:11]
    s_add_u32 m0, s18, 3072
    ds_read_b64_tr_b16 v[170:171], v39 offset:12800
    ds_read_b64_tr_b16 v[172:173], v40 offset:12288
    v_mfma_f32_16x16x32_bf16 a[24:27], v[104:107], v[68:71], a[24:27]
    buffer_load_dwordx4 v19, s[8:11], s16 offen sc1 lds
    v_mfma_f32_16x16x32_bf16 a[40:43], v[104:107], v[72:75], a[40:43]
    ds_read_b64_tr_b16 v[174:175], v40 offset:12800
    v_mfma_f32_16x16x32_bf16 a[56:59], v[104:107], v[76:79], a[56:59]
    v_mfma_f32_16x16x32_bf16 a[12:15], v[108:111], v[64:67], a[12:15]
    s_add_u32 m0, s19, 3072
    v_mfma_f32_16x16x32_bf16 a[28:31], v[108:111], v[68:71], a[28:31]
    buffer_load_dwordx4 v27, s[12:15], s17 offen  lds
    s_waitcnt vmcnt(16) lgkmcnt(0)
    s_barrier
    v_mfma_f32_16x16x32_bf16 a[44:47], v[108:111], v[72:75], a[44:47]
    v_mfma_f32_16x16x32_bf16 a[60:63], v[108:111], v[76:79], a[60:63]
    s_add_u32 s16, s16, 512
    s_add_u32 s17, s17, 131072
    s_waitcnt lgkmcnt(0)
    v_mfma_f32_16x16x32_bf16 a[0:3], v[160:163], v[128:131], a[0:3]
    s_add_u32 m0, s18, 32768
    ds_read_b64_tr_b16 v[96:97], v45 offset:0
    ds_read_b64_tr_b16 v[98:99], v45 offset:512
    v_mfma_f32_16x16x32_bf16 a[16:19], v[160:163], v[132:135], a[16:19]
    buffer_load_dwordx4 v16, s[8:11], s16 offen sc1 lds
    v_mfma_f32_16x16x32_bf16 a[32:35], v[160:163], v[136:139], a[32:35]
    ds_read_b128 v[64:67], v44 offset:0
    v_mfma_f32_16x16x32_bf16 a[48:51], v[160:163], v[140:143], a[48:51]
    ds_read_b128 v[68:71], v44 offset:2048
    v_mfma_f32_16x16x32_bf16 a[4:7], v[164:167], v[128:131], a[4:7]
    s_add_u32 m0, s19, 32768
    ds_read_b128 v[72:75], v44 offset:4096
    ds_read_b128 v[76:79], v44 offset:6144
    v_mfma_f32_16x16x32_bf16 a[20:23], v[164:167], v[132:135], a[20:23]
    buffer_load_dwordx4 v24, s[12:15], s17 offen  lds
    v_mfma_f32_16x16x32_bf16 a[36:39], v[164:167], v[136:139], a[36:39]
    ds_read_b64_tr_b16 v[100:101], v46 offset:0
    v_mfma_f32_16x16x32_bf16 a[52:55], v[164:167], v[140:143], a[52:55]
    ds_read_b64_tr_b16 v[102:103], v46 offset:512
    v_mfma_f32_16x16x32_bf16 a[8:11], v[168:171], v[128:131], a[8:11]
    s_add_u32 m0, s18, 33792
    ds_read_b64_tr_b16 v[104:105], v45 offset:8192
    ds_read_b64_tr_b16 v[106:107], v45 offset:8704
    v_mfma_f32_16x16x32_bf16 a[24:27], v[168:171], v[132:135], a[24:27]
    buffer_load_dwordx4 v17, s[8:11], s16 offen sc1 lds
    v_mfma_f32_16x16x32_bf16 a[40:43], v[168:171], v[136:139], a[40:43]
    ds_read_b64_tr_b16 v[108:109], v46 offset:8192
    v_mfma_f32_16x16x32_bf16 a[56:59], v[168:171], v[140:143], a[56:59]
    ds_read_b64_tr_b16 v[110:111], v46 offset:8704
    v_mfma_f32_16x16x32_bf16 a[12:15], v[172:175], v[128:131], a[12:15]
    s_add_u32 m0, s19, 33792
    v_mfma_f32_16x16x32_bf16 a[28:31], v[172:175], v[132:135], a[28:31]
    buffer_load_dwordx4 v25, s[12:15], s17 offen  lds
    v_mfma_f32_16x16x32_bf16 a[44:47], v[172:175], v[136:139], a[44:47]
    v_mfma_f32_16x16x32_bf16 a[60:63], v[172:175], v[140:143], a[60:63]
    s_waitcnt lgkmcnt(0)
    v_mfma_f32_16x16x32_bf16 a[0:3], v[96:99], v[64:67], a[0:3]
    s_add_u32 m0, s18, 34816
    ds_read_b64_tr_b16 v[160:161], v45 offset:4096
    ds_read_b64_tr_b16 v[162:163], v45 offset:4608
    v_mfma_f32_16x16x32_bf16 a[16:19], v[96:99], v[68:71], a[16:19]
    buffer_load_dwordx4 v18, s[8:11], s16 offen sc1 lds
    v_mfma_f32_16x16x32_bf16 a[32:35], v[96:99], v[72:75], a[32:35]
    ds_read_b128 v[128:131], v44 offset:256
    v_mfma_f32_16x16x32_bf16 a[48:51], v[96:99], v[76:79], a[48:51]
    ds_read_b128 v[132:135], v44 offset:2304
    ds_read_b128 v[136:139], v44 offset:4352
    v_mfma_f32_16x16x32_bf16 a[4:7], v[100:103], v[64:67], a[4:7]
    s_add_u32 m0, s19, 34816
    ds_read_b128 v[140:143], v44 offset:6400
    v_mfma_f32_16x16x32_bf16 a[20:23], v[100:103], v[68:71], a[20:23]
    buffer_load_dwordx4 v26, s[12:15], s17 offen  lds
    v_mfma_f32_16x16x32_bf16 a[36:39], v[100:103], v[72:75], a[36:39]
    ds_read_b64_tr_b16 v[164:165], v46 offset:4096
    ds_read_b64_tr_b16 v[166:167], v46 offset:4608
    v_mfma_f32_16x16x32_bf16 a[52:55], v[100:103], v[76:79], a[52:55]
    ds_read_b64_tr_b16 v[168:169], v45 offset:12288
    v_mfma_f32_16x16x32_bf16 a[8:11], v[104:107], v[64:67], a[8:11]
    s_add_u32 m0, s18, 35840
    ds_read_b64_tr_b16 v[170:171], v45 offset:12800
    ds_read_b64_tr_b16 v[172:173], v46 offset:12288
    v_mfma_f32_16x16x32_bf16 a[24:27], v[104:107], v[68:71], a[24:27]
    buffer_load_dwordx4 v19, s[8:11], s16 offen sc1 lds
    v_mfma_f32_16x16x32_bf16 a[40:43], v[104:107], v[72:75], a[40:43]
    ds_read_b64_tr_b16 v[174:175], v46 offset:12800
    v_mfma_f32_16x16x32_bf16 a[56:59], v[104:107], v[76:79], a[56:59]
    v_mfma_f32_16x16x32_bf16 a[12:15], v[108:111], v[64:67], a[12:15]
    s_add_u32 m0, s19, 35840
    v_mfma_f32_16x16x32_bf16 a[28:31], v[108:111], v[68:71], a[28:31]
    buffer_load_dwordx4 v27, s[12:15], s17 offen  lds
    s_waitcnt vmcnt(16) lgkmcnt(0)
    s_barrier
    v_mfma_f32_16x16x32_bf16 a[44:47], v[108:111], v[72:75], a[44:47]
    v_mfma_f32_16x16x32_bf16 a[60:63], v[108:111], v[76:79], a[60:63]
    s_add_u32 s16, s16, 512
    s_add_u32 s17, s17, 131072
    s_waitcnt lgkmcnt(0)
    v_mfma_f32_16x16x32_bf16 a[0:3], v[160:163], v[128:131], a[0:3]
    s_add_u32 m0, s18, 65536
    ds_read_b64_tr_b16 v[96:97], v51 offset:0
    ds_read_b64_tr_b16 v[98:99], v51 offset:512
    v_mfma_f32_16x16x32_bf16 a[16:19], v[160:163], v[132:135], a[16:19]
    buffer_load_dwordx4 v16, s[8:11], s16 offen sc1 lds
    v_mfma_f32_16x16x32_bf16 a[32:35], v[160:163], v[136:139], a[32:35]
    ds_read_b128 v[64:67], v50 offset:0
    v_mfma_f32_16x16x32_bf16 a[48:51], v[160:163], v[140:143], a[48:51]
    ds_read_b128 v[68:71], v50 offset:2048
    v_mfma_f32_16x16x32_bf16 a[4:7], v[164:167], v[128:131], a[4:7]
    s_add_u32 m0, s19, 65536
    ds_read_b128 v[72:75], v50 offset:4096
    ds_read_b128 v[76:79], v50 offset:6144
    v_mfma_f32_16x16x32_bf16 a[20:23], v[164:167], v[132:135], a[20:23]
    buffer_load_dwordx4 v24, s[12:15], s17 offen  lds
    v_mfma_f32_16x16x32_bf16 a[36:39], v[164:167], v[136:139], a[36:39]
    ds_read_b64_tr_b16 v[100:101], v52 offset:0
    v_mfma_f32_16x16x32_bf16 a[52:55], v[164:167], v[140:143], a[52:55]
    ds_read_b64_tr_b16 v[102:103], v52 offset:512
    v_mfma_f32_16x16x32_bf16 a[8:11], v[168:171], v[128:131], a[8:11]
    s_add_u32 m0, s18, 66560
    ds_read_b64_tr_b16 v[104:105], v51 offset:8192
    ds_read_b64_tr_b16 v[106:107], v51 offset:8704
    v_mfma_f32_16x16x32_bf16 a[24:27], v[168:171], v[132:135], a[24:27]
    buffer_load_dwordx4 v17, s[8:11], s16 offen sc1 lds
    v_mfma_f32_16x16x32_bf16 a[40:43], v[168:171], v[136:139], a[40:43]
    ds_read_b64_tr_b16 v[108:109], v52 offset:8192
    v_mfma_f32_16x16x32_bf16 a[56:59], v[168:171], v[140:143], a[56:59]
    ds_read_b64_tr_b16 v[110:111], v52 offset:8704
    v_mfma_f32_16x16x32_bf16 a[12:15], v[172:175], v[128:131], a[12:15]
    s_add_u32 m0, s19, 66560
    v_mfma_f32_16x16x32_bf16 a[28:31], v[172:175], v[132:135], a[28:31]
    buffer_load_dwordx4 v25, s[12:15], s17 offen  lds
    v_mfma_f32_16x16x32_bf16 a[44:47], v[172:175], v[136:139], a[44:47]
    v_mfma_f32_16x16x32_bf16 a[60:63], v[172:175], v[140:143], a[60:63]
    s_waitcnt lgkmcnt(0)
    v_mfma_f32_16x16x32_bf16 a[0:3], v[96:99], v[64:67], a[0:3]
    s_add_u32 m0, s18, 67584
    ds_read_b64_tr_b16 v[160:161], v51 offset:4096
    ds_read_b64_tr_b16 v[162:163], v51 offset:4608
    v_mfma_f32_16x16x32_bf16 a[16:19], v[96:99], v[68:71], a[16:19]
    buffer_load_dwordx4 v18, s[8:11], s16 offen sc1 lds
    v_mfma_f32_16x16x32_bf16 a[32:35], v[96:99], v[72:75], a[32:35]
    ds_read_b128 v[128:131], v50 offset:256
    v_mfma_f32_16x16x32_bf16 a[48:51], v[96:99], v[76:79], a[48:51]
    ds_read_b128 v[132:135], v50 offset:2304
    ds_read_b128 v[136:139], v50 offset:4352
    v_mfma_f32_16x16x32_bf16 a[4:7], v[100:103], v[64:67], a[4:7]
    s_add_u32 m0, s19, 67584
    ds_read_b128 v[140:143], v50 offset:6400
    v_mfma_f32_16x16x32_bf16 a[20:23], v[100:103], v[68:71], a[20:23]
    buffer_load_dwordx4 v26, s[12:15], s17 offen  lds
    v_mfma_f32_16x16x32_bf16 a[36:39], v[100:103], v[72:75], a[36:39]
    ds_read_b64_tr_b16 v[164:165], v52 offset:4096
    ds_read_b64_tr_b16 v[166:167], v52 offset:4608
    v_mfma_f32_16x16x32_bf16 a[52:55], v[100:103], v[76:79], a[52:55]
    ds_read_b64_tr_b16 v[168:169], v51 offset:12288
    v_mfma_f32_16x16x32_bf16 a[8:11], v[104:107], v[64:67], a[8:11]
    s_add_u32 m0, s18, 68608
    ds_read_b64_tr_b16 v[170:171], v51 offset:12800
    ds_read_b64_tr_b16 v[172:173], v52 offset:12288
    v_mfma_f32_16x16x32_bf16 a[24:27], v[104:107], v[68:71], a[24:27]
    buffer_load_dwordx4 v19, s[8:11], s16 offen sc1 lds
    v_mfma_f32_16x16x32_bf16 a[40:43], v[104:107], v[72:75], a[40:43]
    ds_read_b64_tr_b16 v[174:175], v52 offset:12800
    v_mfma_f32_16x16x32_bf16 a[56:59], v[104:107], v[76:79], a[56:59]
    v_mfma_f32_16x16x32_bf16 a[12:15], v[108:111], v[64:67], a[12:15]
    s_add_u32 m0, s19, 68608
    v_mfma_f32_16x16x32_bf16 a[28:31], v[108:111], v[68:71], a[28:31]
    buffer_load_dwordx4 v27, s[12:15], s17 offen  lds
    s_waitcnt vmcnt(16) lgkmcnt(0)
    s_barrier
    v_mfma_f32_16x16x32_bf16 a[44:47], v[108:111], v[72:75], a[44:47]
    v_mfma_f32_16x16x32_bf16 a[60:63], v[108:111], v[76:79], a[60:63]
    s_add_u32 s16, s16, 512
    s_add_u32 s17, s17, 131072
    s_waitcnt lgkmcnt(0)
    v_mfma_f32_16x16x32_bf16 a[0:3], v[160:163], v[128:131], a[0:3]
    s_add_u32 m0, s18, 98304
    ds_read_b64_tr_b16 v[96:97], v33 offset:0
    ds_read_b64_tr_b16 v[98:99], v33 offset:512
    v_mfma_f32_16x16x32_bf16 a[16:19], v[160:163], v[132:135], a[16:19]
    buffer_load_dwordx4 v16, s[8:11], s16 offen sc1 lds
    v_mfma_f32_16x16x32_bf16 a[32:35], v[160:163], v[136:139], a[32:35]
    ds_read_b128 v[64:67], v32 offset:0
    v_mfma_f32_16x16x32_bf16 a[48:51], v[160:163], v[140:143], a[48:51]
    ds_read_b128 v[68:71], v32 offset:2048
    v_mfma_f32_16x16x32_bf16 a[4:7], v[164:167], v[128:131], a[4:7]
    s_add_u32 m0, s19, 98304
    ds_read_b128 v[72:75], v32 offset:4096
    ds_read_b128 v[76:79], v32 offset:6144
    v_mfma_f32_16x16x32_bf16 a[20:23], v[164:167], v[132:135], a[20:23]
    buffer_load_dwordx4 v24, s[12:15], s17 offen  lds
    v_mfma_f32_16x16x32_bf16 a[36:39], v[164:167], v[136:139], a[36:39]
    ds_read_b64_tr_b16 v[100:101], v34 offset:0
    v_mfma_f32_16x16x32_bf16 a[52:55], v[164:167], v[140:143], a[52:55]
    ds_read_b64_tr_b16 v[102:103], v34 offset:512
    v_mfma_f32_16x16x32_bf16 a[8:11], v[168:171], v[128:131], a[8:11]
    s_add_u32 m0, s18, 99328
    ds_read_b64_tr_b16 v[104:105], v33 offset:8192
    ds_read_b64_tr_b16 v[106:107], v33 offset:8704
    v_mfma_f32_16x16x32_bf16 a[24:27], v[168:171], v[132:135], a[24:27]
    buffer_load_dwordx4 v17, s[8:11], s16 offen sc1 lds
    v_mfma_f32_16x16x32_bf16 a[40:43], v[168:171], v[136:139], a[40:43]
    ds_read_b64_tr_b16 v[108:109], v34 offset:8192
    v_mfma_f32_16x16x32_bf16 a[56:59], v[168:171], v[140:143], a[56:59]
    ds_read_b64_tr_b16 v[110:111], v34 offset:8704
    v_mfma_f32_16x16x32_bf16 a[12:15], v[172:175], v[128:131], a[12:15]
    s_add_u32 m0, s19, 99328
    v_mfma_f32_16x16x32_bf16 a[28:31], v[172:175], v[132:135], a[28:31]
    buffer_load_dwordx4 v25, s[12:15], s17 offen  lds
    v_mfma_f32_16x16x32_bf16 a[44:47], v[172:175], v[136:139], a[44:47]
    v_mfma_f32_16x16x32_bf16 a[60:63], v[172:175], v[140:143], a[60:63]
    s_waitcnt lgkmcnt(0)
    v_mfma_f32_16x16x32_bf16 a[0:3], v[96:99], v[64:67], a[0:3]
    s_add_u32 m0, s18, 100352
    ds_read_b64_tr_b16 v[160:161], v33 offset:4096
    ds_read_b64_tr_b16 v[162:163], v33 offset:4608
    v_mfma_f32_16x16x32_bf16 a[16:19], v[96:99], v[68:71], a[16:19]
    buffer_load_dwordx4 v18, s[8:11], s16 offen sc1 lds
    v_mfma_f32_16x16x32_bf16 a[32:35], v[96:99], v[72:75], a[32:35]
    ds_read_b128 v[128:131], v32 offset:256
    v_mfma_f32_16x16x32_bf16 a[48:51], v[96:99], v[76:79], a[48:51]
    ds_read_b128 v[132:135], v32 offset:2304
    ds_read_b128 v[136:139], v32 offset:4352
    v_mfma_f32_16x16x32_bf16 a[4:7], v[100:103], v[64:67], a[4:7]
    s_add_u32 m0, s19, 100352
    ds_read_b128 v[140:143], v32 offset:6400
    v_mfma_f32_16x16x32_bf16 a[20:23], v[100:103], v[68:71], a[20:23]
    buffer_load_dwordx4 v26, s[12:15], s17 offen  lds
    v_mfma_f32_16x16x32_bf16 a[36:39], v[100:103], v[72:75], a[36:39]
    ds_read_b64_tr_b16 v[164:165], v34 offset:4096
    ds_read_b64_tr_b16 v[166:167], v34 offset:4608
    v_mfma_f32_16x16x32_bf16 a[52:55], v[100:103], v[76:79], a[52:55]
    ds_read_b64_tr_b16 v[168:169], v33 offset:12288
    v_mfma_f32_16x16x32_bf16 a[8:11], v[104:107], v[64:67], a[8:11]
    s_add_u32 m0, s18, 101376
    ds_read_b64_tr_b16 v[170:171], v33 offset:12800
    ds_read_b64_tr_b16 v[172:173], v34 offset:12288
    v_mfma_f32_16x16x32_bf16 a[24:27], v[104:107], v[68:71], a[24:27]
    buffer_load_dwordx4 v19, s[8:11], s16 offen sc1 lds
    v_mfma_f32_16x16x32_bf16 a[40:43], v[104:107], v[72:75], a[40:43]
    ds_read_b64_tr_b16 v[174:175], v34 offset:12800
    v_mfma_f32_16x16x32_bf16 a[56:59], v[104:107], v[76:79], a[56:59]
    v_mfma_f32_16x16x32_bf16 a[12:15], v[108:111], v[64:67], a[12:15]
    s_add_u32 m0, s19, 101376
    v_mfma_f32_16x16x32_bf16 a[28:31], v[108:111], v[68:71], a[28:31]
    buffer_load_dwordx4 v27, s[12:15], s17 offen  lds
    s_waitcnt vmcnt(16) lgkmcnt(0)
    s_barrier
    v_mfma_f32_16x16x32_bf16 a[44:47], v[108:111], v[72:75], a[44:47]
    v_mfma_f32_16x16x32_bf16 a[60:63], v[108:111], v[76:79], a[60:63]
    s_add_u32 s16, s16, 512
    s_add_u32 s17, s17, 131072
    s_sub_u32 s20, s20, 1
    s_cmp_lg_u32 s20, 0
    s_cbranch_scc1 GW1_188
    s_waitcnt lgkmcnt(0)
    v_mfma_f32_16x16x32_bf16 a[0:3], v[160:163], v[128:131], a[0:3]
    ds_read_b64_tr_b16 v[96:97], v39 offset:0
    ds_read_b64_tr_b16 v[98:99], v39 offset:512
    v_mfma_f32_16x16x32_bf16 a[16:19], v[160:163], v[132:135], a[16:19]
    v_mfma_f32_16x16x32_bf16 a[32:35], v[160:163], v[136:139], a[32:35]
    ds_read_b128 v[64:67], v38 offset:0
    v_mfma_f32_16x16x32_bf16 a[48:51], v[160:163], v[140:143], a[48:51]
    ds_read_b128 v[68:71], v38 offset:2048
    v_mfma_f32_16x16x32_bf16 a[4:7], v[164:167], v[128:131], a[4:7]
    ds_read_b128 v[72:75], v38 offset:4096
    ds_read_b128 v[76:79], v38 offset:6144
    v_mfma_f32_16x16x32_bf16 a[20:23], v[164:167], v[132:135], a[20:23]
    v_mfma_f32_16x16x32_bf16 a[36:39], v[164:167], v[136:139], a[36:39]
    ds_read_b64_tr_b16 v[100:101], v40 offset:0
    v_mfma_f32_16x16x32_bf16 a[52:55], v[164:167], v[140:143], a[52:55]
    ds_read_b64_tr_b16 v[102:103], v40 offset:512
    v_mfma_f32_16x16x32_bf16 a[8:11], v[168:171], v[128:131], a[8:11]
    ds_read_b64_tr_b16 v[104:105], v39 offset:8192
    ds_read_b64_tr_b16 v[106:107], v39 offset:8704
    v_mfma_f32_16x16x32_bf16 a[24:27], v[168:171], v[132:135], a[24:27]
    v_mfma_f32_16x16x32_bf16 a[40:43], v[168:171], v[136:139], a[40:43]
    ds_read_b64_tr_b16 v[108:109], v40 offset:8192
    v_mfma_f32_16x16x32_bf16 a[56:59], v[168:171], v[140:143], a[56:59]
    ds_read_b64_tr_b16 v[110:111], v40 offset:8704
    v_mfma_f32_16x16x32_bf16 a[12:15], v[172:175], v[128:131], a[12:15]
    v_mfma_f32_16x16x32_bf16 a[28:31], v[172:175], v[132:135], a[28:31]
    v_mfma_f32_16x16x32_bf16 a[44:47], v[172:175], v[136:139], a[44:47]
    v_mfma_f32_16x16x32_bf16 a[60:63], v[172:175], v[140:143], a[60:63]
    s_waitcnt lgkmcnt(0)
    v_mfma_f32_16x16x32_bf16 a[0:3], v[96:99], v[64:67], a[0:3]
    ds_read_b64_tr_b16 v[160:161], v39 offset:4096
    ds_read_b64_tr_b16 v[162:163], v39 offset:4608
    v_mfma_f32_16x16x32_bf16 a[16:19], v[96:99], v[68:71], a[16:19]
    v_mfma_f32_16x16x32_bf16 a[32:35], v[96:99], v[72:75], a[32:35]
    ds_read_b128 v[128:131], v38 offset:256
    v_mfma_f32_16x16x32_bf16 a[48:51], v[96:99], v[76:79], a[48:51]
    ds_read_b128 v[132:135], v38 offset:2304
    ds_read_b128 v[136:139], v38 offset:4352
    v_mfma_f32_16x16x32_bf16 a[4:7], v[100:103], v[64:67], a[4:7]
    ds_read_b128 v[140:143], v38 offset:6400
    v_mfma_f32_16x16x32_bf16 a[20:23], v[100:103], v[68:71], a[20:23]
    v_mfma_f32_16x16x32_bf16 a[36:39], v[100:103], v[72:75], a[36:39]
    ds_read_b64_tr_b16 v[164:165], v40 offset:4096
    ds_read_b64_tr_b16 v[166:167], v40 offset:4608
    v_mfma_f32_16x16x32_bf16 a[52:55], v[100:103], v[76:79], a[52:55]
    ds_read_b64_tr_b16 v[168:169], v39 offset:12288
    v_mfma_f32_16x16x32_bf16 a[8:11], v[104:107], v[64:67], a[8:11]
    ds_read_b64_tr_b16 v[170:171], v39 offset:12800
    ds_read_b64_tr_b16 v[172:173], v40 offset:12288
    v_mfma_f32_16x16x32_bf16 a[24:27], v[104:107], v[68:71], a[24:27]
    v_mfma_f32_16x16x32_bf16 a[40:43], v[104:107], v[72:75], a[40:43]
    ds_read_b64_tr_b16 v[174:175], v40 offset:12800
    v_mfma_f32_16x16x32_bf16 a[56:59], v[104:107], v[76:79], a[56:59]
    v_mfma_f32_16x16x32_bf16 a[12:15], v[108:111], v[64:67], a[12:15]
    v_mfma_f32_16x16x32_bf16 a[28:31], v[108:111], v[68:71], a[28:31]
    s_waitcnt vmcnt(8) lgkmcnt(0)
    s_barrier
    v_mfma_f32_16x16x32_bf16 a[44:47], v[108:111], v[72:75], a[44:47]
    v_mfma_f32_16x16x32_bf16 a[60:63], v[108:111], v[76:79], a[60:63]
    s_waitcnt lgkmcnt(0)
    v_mfma_f32_16x16x32_bf16 a[0:3], v[160:163], v[128:131], a[0:3]
    ds_read_b64_tr_b16 v[96:97], v45 offset:0
    ds_read_b64_tr_b16 v[98:99], v45 offset:512
    v_mfma_f32_16x16x32_bf16 a[16:19], v[160:163], v[132:135], a[16:19]
    v_mfma_f32_16x16x32_bf16 a[32:35], v[160:163], v[136:139], a[32:35]
    ds_read_b128 v[64:67], v44 offset:0
    v_mfma_f32_16x16x32_bf16 a[48:51], v[160:163], v[140:143], a[48:51]
    ds_read_b128 v[68:71], v44 offset:2048
    v_mfma_f32_16x16x32_bf16 a[4:7], v[164:167], v[128:131], a[4:7]
    ds_read_b128 v[72:75], v44 offset:4096
    ds_read_b128 v[76:79], v44 offset:6144
    v_mfma_f32_16x16x32_bf16 a[20:23], v[164:167], v[132:135], a[20:23]
    v_mfma_f32_16x16x32_bf16 a[36:39], v[164:167], v[136:139], a[36:39]
    ds_read_b64_tr_b16 v[100:101], v46 offset:0
    v_mfma_f32_16x16x32_bf16 a[52:55], v[164:167], v[140:143], a[52:55]
    ds_read_b64_tr_b16 v[102:103], v46 offset:512
    v_mfma_f32_16x16x32_bf16 a[8:11], v[168:171], v[128:131], a[8:11]
    ds_read_b64_tr_b16 v[104:105], v45 offset:8192
    ds_read_b64_tr_b16 v[106:107], v45 offset:8704
    v_mfma_f32_16x16x32_bf16 a[24:27], v[168:171], v[132:135], a[24:27]
    v_mfma_f32_16x16x32_bf16 a[40:43], v[168:171], v[136:139], a[40:43]
    ds_read_b64_tr_b16 v[108:109], v46 offset:8192
    v_mfma_f32_16x16x32_bf16 a[56:59], v[168:171], v[140:143], a[56:59]
    ds_read_b64_tr_b16 v[110:111], v46 offset:8704
    v_mfma_f32_16x16x32_bf16 a[12:15], v[172:175], v[128:131], a[12:15]
    v_mfma_f32_16x16x32_bf16 a[28:31], v[172:175], v[132:135], a[28:31]
    v_mfma_f32_16x16x32_bf16 a[44:47], v[172:175], v[136:139], a[44:47]
    v_mfma_f32_16x16x32_bf16 a[60:63], v[172:175], v[140:143], a[60:63]
    s_waitcnt lgkmcnt(0)
    v_mfma_f32_16x16x32_bf16 a[0:3], v[96:99], v[64:67], a[0:3]
    ds_read_b64_tr_b16 v[160:161], v45 offset:4096
    ds_read_b64_tr_b16 v[162:163], v45 offset:4608
    v_mfma_f32_16x16x32_bf16 a[16:19], v[96:99], v[68:71], a[16:19]
    v_mfma_f32_16x16x32_bf16 a[32:35], v[96:99], v[72:75], a[32:35]
    ds_read_b128 v[128:131], v44 offset:256
    v_mfma_f32_16x16x32_bf16 a[48:51], v[96:99], v[76:79], a[48:51]
    ds_read_b128 v[132:135], v44 offset:2304
    ds_read_b128 v[136:139], v44 offset:4352
    v_mfma_f32_16x16x32_bf16 a[4:7], v[100:103], v[64:67], a[4:7]
    ds_read_b128 v[140:143], v44 offset:6400
    v_mfma_f32_16x16x32_bf16 a[20:23], v[100:103], v[68:71], a[20:23]
    v_mfma_f32_16x16x32_bf16 a[36:39], v[100:103], v[72:75], a[36:39]
    ds_read_b64_tr_b16 v[164:165], v46 offset:4096
    ds_read_b64_tr_b16 v[166:167], v46 offset:4608
    v_mfma_f32_16x16x32_bf16 a[52:55], v[100:103], v[76:79], a[52:55]
    ds_read_b64_tr_b16 v[168:169], v45 offset:12288
    v_mfma_f32_16x16x32_bf16 a[8:11], v[104:107], v[64:67], a[8:11]
    ds_read_b64_tr_b16 v[170:171], v45 offset:12800
    ds_read_b64_tr_b16 v[172:173], v46 offset:12288
    v_mfma_f32_16x16x32_bf16 a[24:27], v[104:107], v[68:71], a[24:27]
    v_mfma_f32_16x16x32_bf16 a[40:43], v[104:107], v[72:75], a[40:43]
    ds_read_b64_tr_b16 v[174:175], v46 offset:12800
    v_mfma_f32_16x16x32_bf16 a[56:59], v[104:107], v[76:79], a[56:59]
    v_mfma_f32_16x16x32_bf16 a[12:15], v[108:111], v[64:67], a[12:15]
    v_mfma_f32_16x16x32_bf16 a[28:31], v[108:111], v[68:71], a[28:31]
    s_waitcnt vmcnt(0) lgkmcnt(0)
    s_barrier
    v_mfma_f32_16x16x32_bf16 a[44:47], v[108:111], v[72:75], a[44:47]
    v_mfma_f32_16x16x32_bf16 a[60:63], v[108:111], v[76:79], a[60:63]
    s_cmp_lg_u32 s3, 0
    s_cbranch_scc1 Ht_189
    v_mov_b32 v14, 1
    s_mov_b64 exec, 1
    buffer_atomic_add v14, off, s[92:95], s97 sc0 sc1
    s_mov_b64 exec, -1
Ht_189:
    s_waitcnt lgkmcnt(0)
    v_mfma_f32_16x16x32_bf16 a[0:3], v[160:163], v[128:131], a[0:3]
    ds_read_b64_tr_b16 v[96:97], v51 offset:0
    ds_read_b64_tr_b16 v[98:99], v51 offset:512
    v_mfma_f32_16x16x32_bf16 a[16:19], v[160:163], v[132:135], a[16:19]
    v_mfma_f32_16x16x32_bf16 a[32:35], v[160:163], v[136:139], a[32:35]
    ds_read_b128 v[64:67], v50 offset:0
    v_mfma_f32_16x16x32_bf16 a[48:51], v[160:163], v[140:143], a[48:51]
    ds_read_b128 v[68:71], v50 offset:2048
    v_mfma_f32_16x16x32_bf16 a[4:7], v[164:167], v[128:131], a[4:7]
    ds_read_b128 v[72:75], v50 offset:4096
    ds_read_b128 v[76:79], v50 offset:6144
    v_mfma_f32_16x16x32_bf16 a[20:23], v[164:167], v[132:135], a[20:23]
    v_mfma_f32_16x16x32_bf16 a[36:39], v[164:167], v[136:139], a[36:39]
    ds_read_b64_tr_b16 v[100:101], v52 offset:0
    v_mfma_f32_16x16x32_bf16 a[52:55], v[164:167], v[140:143], a[52:55]
    ds_read_b64_tr_b16 v[102:103], v52 offset:512
    v_mfma_f32_16x16x32_bf16 a[8:11], v[168:171], v[128:131], a[8:11]
    ds_read_b64_tr_b16 v[104:105], v51 offset:8192
    ds_read_b64_tr_b16 v[106:107], v51 offset:8704
    v_mfma_f32_16x16x32_bf16 a[24:27], v[168:171], v[132:135], a[24:27]
    v_mfma_f32_16x16x32_bf16 a[40:43], v[168:171], v[136:139], a[40:43]
    ds_read_b64_tr_b16 v[108:109], v52 offset:8192
    v_mfma_f32_16x16x32_bf16 a[56:59], v[168:171], v[140:143], a[56:59]
    ds_read_b64_tr_b16 v[110:111], v52 offset:8704
    v_mfma_f32_16x16x32_bf16 a[12:15], v[172:175], v[128:131], a[12:15]
    v_mfma_f32_16x16x32_bf16 a[28:31], v[172:175], v[132:135], a[28:31]
    v_mfma_f32_16x16x32_bf16 a[44:47], v[172:175], v[136:139], a[44:47]
    v_mfma_f32_16x16x32_bf16 a[60:63], v[172:175], v[140:143], a[60:63]
    s_waitcnt lgkmcnt(0)
    v_mfma_f32_16x16x32_bf16 a[0:3], v[96:99], v[64:67], a[0:3]
    ds_read_b64_tr_b16 v[160:161], v51 offset:4096
    ds_read_b64_tr_b16 v[162:163], v51 offset:4608
    v_mfma_f32_16x16x32_bf16 a[16:19], v[96:99], v[68:71], a[16:19]
    v_mfma_f32_16x16x32_bf16 a[32:35], v[96:99], v[72:75], a[32:35]
    ds_read_b128 v[128:131], v50 offset:256
    v_mfma_f32_16x16x32_bf16 a[48:51], v[96:99], v[76:79], a[48:51]
    ds_read_b128 v[132:135], v50 offset:2304
    ds_read_b128 v[136:139], v50 offset:4352
    v_mfma_f32_16x16x32_bf16 a[4:7], v[100:103], v[64:67], a[4:7]
    ds_read_b128 v[140:143], v50 offset:6400
    v_mfma_f32_16x16x32_bf16 a[20:23], v[100:103], v[68:71], a[20:23]
    v_mfma_f32_16x16x32_bf16 a[36:39], v[100:103], v[72:75], a[36:39]
    ds_read_b64_tr_b16 v[164:165], v52 offset:4096
    ds_read_b64_tr_b16 v[166:167], v52 offset:4608
    v_mfma_f32_16x16x32_bf16 a[52:55], v[100:103], v[76:79], a[52:55]
    ds_read_b64_tr_b16 v[168:169], v51 offset:12288
    v_mfma_f32_16x16x32_bf16 a[8:11], v[104:107], v[64:67], a[8:11]
    ds_read_b64_tr_b16 v[170:171], v51 offset:12800
    ds_read_b64_tr_b16 v[172:173], v52 offset:12288
    v_mfma_f32_16x16x32_bf16 a[24:27], v[104:107], v[68:71], a[24:27]
    v_mfma_f32_16x16x32_bf16 a[40:43], v[104:107], v[72:75], a[40:43]
    ds_read_b64_tr_b16 v[174:175], v52 offset:12800
    v_mfma_f32_16x16x32_bf16 a[56:59], v[104:107], v[76:79], a[56:59]
    v_mfma_f32_16x16x32_bf16 a[12:15], v[108:111], v[64:67], a[12:15]
    v_mfma_f32_16x16x32_bf16 a[28:31], v[108:111], v[68:71], a[28:31]
    s_waitcnt lgkmcnt(0)
    s_barrier
    v_mfma_f32_16x16x32_bf16 a[44:47], v[108:111], v[72:75], a[44:47]
    v_mfma_f32_16x16x32_bf16 a[60:63], v[108:111], v[76:79], a[60:63]
    s_waitcnt lgkmcnt(0)
    v_mfma_f32_16x16x32_bf16 a[0:3], v[160:163], v[128:131], a[0:3]
    v_mfma_f32_16x16x32_bf16 a[16:19], v[160:163], v[132:135], a[16:19]
    v_mfma_f32_16x16x32_bf16 a[32:35], v[160:163], v[136:139], a[32:35]
    v_mfma_f32_16x16x32_bf16 a[48:51], v[160:163], v[140:143], a[48:51]
    v_mfma_f32_16x16x32_bf16 a[4:7], v[164:167], v[128:131], a[4:7]
    v_mfma_f32_16x16x32_bf16 a[20:23], v[164:167], v[132:135], a[20:23]
    v_mfma_f32_16x16x32_bf16 a[36:39], v[164:167], v[136:139], a[36:39]
    v_mfma_f32_16x16x32_bf16 a[52:55], v[164:167], v[140:143], a[52:55]
    v_mfma_f32_16x16x32_bf16 a[8:11], v[168:171], v[128:131], a[8:11]
    v_mfma_f32_16x16x32_bf16 a[24:27], v[168:171], v[132:135], a[24:27]
    v_mfma_f32_16x16x32_bf16 a[40:43], v[168:171], v[136:139], a[40:43]
    v_mfma_f32_16x16x32_bf16 a[56:59], v[168:171], v[140:143], a[56:59]
    v_mfma_f32_16x16x32_bf16 a[12:15], v[172:175], v[128:131], a[12:15]
    v_mfma_f32_16x16x32_bf16 a[28:31], v[172:175], v[132:135], a[28:31]
    v_mfma_f32_16x16x32_bf16 a[44:47], v[172:175], v[136:139], a[44:47]
    v_mfma_f32_16x16x32_bf16 a[60:63], v[172:175], v[140:143], a[60:63]
    s_cmp_lg_u32 s3, 0
    s_cbranch_scc1 Am_190
    s_waitcnt vmcnt(0)
    v_readfirstlane_b32 s25, v14
    s_nop 3
    s_add_u32 s25, s25, s83
    s_cmp_eq_u32 s98, 5
    s_cbranch_scc1 N_192
    s_cmp_eq_u32 s98, 4
    s_cbranch_scc1 N_191
    s_lshr_b32 s22, s25, 5
    s_and_b32 s25, s25, 31
    s_lshl_b32 s22, s22, 2
    s_add_u32 s22, s22, s98
    s_lshl_b32 s22, s22, 5
    s_add_u32 s25, s25, s22
N_191:
    s_cmp_lt_u32 s25, 768
    s_cselect_b32 s25, s25, 96
    s_cbranch_scc1 N_192_e
N_192:
    s_add_u32 s25, s25, 768
    s_cmp_lt_u32 s25, 864
N_192_e:
    s_cselect_b32 s39, 1, 0
    s_cselect_b32 s96, 1, 2
    v_mov_b32 v14, s25
    v_mov_b32 v15, 159744
    ds_write_b32 v15, v14
Am_190:
    s_lshr_b32 s32, s36, 1
    s_lshl_b32 s32, s32, 3
    s_add_u32 s32, s32, s37
    s_lshl_b32 s32, s32, 6
    s_add_u32 s32, s32, 113270784
    s_cmp_lg_u32 s3, 0
    s_cbranch_scc1 Wf_193
    v_mov_b32 v5, 0
    s_mov_b32 s30, 0
    s_mov_b32 s21, 0x1
Wp_194:
    buffer_load_dword v4, v5, s[92:95], s32 offen sc1
    s_waitcnt vmcnt(0)
    v_cmp_ne_u32 vcc, s21, v4
    s_cbranch_vccz Wf_193
    s_sleep 8
    s_add_u32 s30, s30, 1
    s_cmp_lt_u32 s30, 65536
    s_cbranch_scc1 Wp_194
    s_branch L_abort
Wf_193:
    s_barrier
    s_mov_b32 s28, s62
    s_and_b32 s29, s63, 0xffff
    s_mov_b32 s30, 4194304
    s_mov_b32 s31, 0x20000
    s_mov_b32 s8, s40
    s_and_b32 s9, s41, 0xffff
    s_mov_b32 s10, 4194304
    s_mov_b32 s11, 0x20000
    s_add_u32 s12, s66, 89128960
    s_addc_u32 s13, s67, 0
    s_and_b32 s13, s13, 0xffff
    s_mov_b32 s14, 4194304
    s_mov_b32 s15, 0x20000
    s_lshl_b32 s32, s36, 18
    s_lshl_b32 s33, s37, 8
    s_lshr_b32 s21, s3, 1
    s_mul_i32 s21, s21, 131072
    s_add_u32 s21, s21, s32
    s_and_b32 s22, s3, 1
    s_lshl_b32 s22, s22, 6
    s_add_u32 s22, s22, s33
    v_bfe_u32 v3, v1, 4, 1
    v_lshrrev_b32 v4, 5, v1
    v_bfe_u32 v10, v1, 2, 2
    v_lshlrev_b32 v10, 13, v10
    v_lshl_add_u32 v10, v3, 7, v10
    v_lshl_add_u32 v10, v4, 4, v10
    v_and_b32 v5, 3, v1
    v_lshl_add_u32 v10, v5, 5, v10
    v_and_b32 v2, 15, v1
    v_lshlrev_b32 v2, 11, v2
    v_lshl_add_u32 v2, v3, 5, v2
    v_lshl_add_u32 v2, v4, 4, v2
    s_lshl_b32 s23, s22, 2
    s_add_u32 s85, s21, s23
    s_add_u32 s84, s21, s22
    s_add_u32 s86, s84, 0
    buffer_load_dwordx4 v[160:163], v2, s[8:11], s86 offen offset:0
    s_add_u32 s86, s85, 0
    buffer_load_dwordx4 v[164:167], v10, s[12:15], s86 offen offset:0 sc1
    s_add_u32 s86, s84, 0
    buffer_load_dwordx4 v[168:171], v2, s[8:11], s86 offen offset:128
    s_add_u32 s86, s85, 0
    buffer_load_dwordx4 v[172:175], v10, s[12:15], s86 offen offset:512 sc1
    s_add_u32 s86, s84, 32768
    buffer_load_dwordx4 v[176:179], v2, s[8:11], s86 offen offset:0
    s_add_u32 s86, s85, 32768
    buffer_load_dwordx4 v[180:183], v10, s[12:15], s86 offen offset:0 sc1
    s_add_u32 s86, s84, 32768
    buffer_load_dwordx4 v[184:187], v2, s[8:11], s86 offen offset:128
    s_add_u32 s86, s85, 32768
    buffer_load_dwordx4 v[188:191], v10, s[12:15], s86 offen offset:512 sc1
    s_add_u32 s86, s84, 65536
    buffer_load_dwordx4 v[192:195], v2, s[8:11], s86 offen offset:0
    s_add_u32 s86, s85, 65536
    buffer_load_dwordx4 v[196:199], v10, s[12:15], s86 offen offset:0 sc1
    s_add_u32 s86, s84, 65536
    buffer_load_dwordx4 v[200:203], v2, s[8:11], s86 offen offset:128
    s_add_u32 s86, s85, 65536
    buffer_load_dwordx4 v[204:207], v10, s[12:15], s86 offen offset:512 sc1
    s_add_u32 s86, s84, 98304
    buffer_load_dwordx4 v[208:211], v2, s[8:11], s86 offen offset:0
    s_add_u32 s86, s85, 98304
    buffer_load_dwordx4 v[212:215], v10, s[12:15], s86 offen offset:0 sc1
    s_add_u32 s86, s84, 98304
    buffer_load_dwordx4 v[216:219], v2, s[8:11], s86 offen offset:128
    s_add_u32 s86, s85, 98304
    buffer_load_dwordx4 v[220:223], v10, s[12:15], s86 offen offset:512 sc1
    s_nop 7
    v_accvgpr_read_b32 v128, a0
    v_accvgpr_read_b32 v129, a1
    v_accvgpr_read_b32 v130, a2
    v_accvgpr_read_b32 v131, a3
    v_accvgpr_read_b32 v132, a4
    v_accvgpr_read_b32 v133, a5
    v_accvgpr_read_b32 v134, a6
    v_accvgpr_read_b32 v135, a7
    v_cvt_pk_bf16_f32 v136, v128, v129
    v_cvt_pk_bf16_f32 v137, v130, v131
    v_cvt_pk_bf16_f32 v138, v132, v133
    v_cvt_pk_bf16_f32 v139, v134, v135
    s_nop 1
    v_permlane16_swap_b32 v136, v138
    v_permlane16_swap_b32 v137, v139
    s_waitcnt vmcnt(14)
    v_lshlrev_b32 v128, 16, v136
    v_and_b32 v129, 0xffff0000, v136
    v_lshlrev_b32 v130, 16, v160
    v_and_b32 v131, 0xffff0000, v160
    v_pk_add_f32 v[128:129], v[128:129], v[130:131]
    v_cvt_pk_bf16_f32 v132, v128, v129
    v_lshlrev_b32 v128, 16, v132
    v_and_b32 v129, 0xffff0000, v132
    v_lshlrev_b32 v130, 16, v164
    v_and_b32 v131, 0xffff0000, v164
    v_pk_add_f32 v[128:129], v[128:129], v[130:131]
    v_cvt_pk_bf16_f32 v136, v128, v129
    v_lshlrev_b32 v128, 16, v137
    v_and_b32 v129, 0xffff0000, v137
    v_lshlrev_b32 v130, 16, v161
    v_and_b32 v131, 0xffff0000, v161
    v_pk_add_f32 v[128:129], v[128:129], v[130:131]
    v_cvt_pk_bf16_f32 v132, v128, v129
    v_lshlrev_b32 v128, 16, v132
    v_and_b32 v129, 0xffff0000, v132
    v_lshlrev_b32 v130, 16, v165
    v_and_b32 v131, 0xffff0000, v165
    v_pk_add_f32 v[128:129], v[128:129], v[130:131]
    v_cvt_pk_bf16_f32 v137, v128, v129
    v_lshlrev_b32 v128, 16, v138
    v_and_b32 v129, 0xffff0000, v138
    v_lshlrev_b32 v130, 16, v162
    v_and_b32 v131, 0xffff0000, v162
    v_pk_add_f32 v[128:129], v[128:129], v[130:131]
    v_cvt_pk_bf16_f32 v132, v128, v129
    v_lshlrev_b32 v128, 16, v132
    v_and_b32 v129, 0xffff0000, v132
    v_lshlrev_b32 v130, 16, v166
    v_and_b32 v131, 0xffff0000, v166
    v_pk_add_f32 v[128:129], v[128:129], v[130:131]
    v_cvt_pk_bf16_f32 v138, v128, v129
    v_lshlrev_b32 v128, 16, v139
    v_and_b32 v129, 0xffff0000, v139
    v_lshlrev_b32 v130, 16, v163
    v_and_b32 v131, 0xffff0000, v163
    v_pk_add_f32 v[128:129], v[128:129], v[130:131]
    v_cvt_pk_bf16_f32 v132, v128, v129
    v_lshlrev_b32 v128, 16, v132
    v_and_b32 v129, 0xffff0000, v132
    v_lshlrev_b32 v130, 16, v167
    v_and_b32 v131, 0xffff0000, v167
    v_pk_add_f32 v[128:129], v[128:129], v[130:131]
    v_cvt_pk_bf16_f32 v139, v128, v129
    s_add_u32 s86, s84, 0
    buffer_store_dwordx4 v[136:139], v2, s[28:31], s86 offen offset:0
    v_accvgpr_read_b32 v144, a8
    v_accvgpr_read_b32 v145, a9
    v_accvgpr_read_b32 v146, a10
    v_accvgpr_read_b32 v147, a11
    v_accvgpr_read_b32 v148, a12
    v_accvgpr_read_b32 v149, a13
    v_accvgpr_read_b32 v150, a14
    v_accvgpr_read_b32 v151, a15
    v_cvt_pk_bf16_f32 v152, v144, v145
    v_cvt_pk_bf16_f32 v153, v146, v147
    v_cvt_pk_bf16_f32 v154, v148, v149
    v_cvt_pk_bf16_f32 v155, v150, v151
    s_nop 1
    v_permlane16_swap_b32 v152, v154
    v_permlane16_swap_b32 v153, v155
    s_waitcnt vmcnt(12)
    v_lshlrev_b32 v144, 16, v152
    v_and_b32 v145, 0xffff0000, v152
    v_lshlrev_b32 v146, 16, v168
    v_and_b32 v147, 0xffff0000, v168
    v_pk_add_f32 v[144:145], v[144:145], v[146:147]
    v_cvt_pk_bf16_f32 v148, v144, v145
    v_lshlrev_b32 v144, 16, v148
    v_and_b32 v145, 0xffff0000, v148
    v_lshlrev_b32 v146, 16, v172
    v_and_b32 v147, 0xffff0000, v172
    v_pk_add_f32 v[144:145], v[144:145], v[146:147]
    v_cvt_pk_bf16_f32 v152, v144, v145
    v_lshlrev_b32 v144, 16, v153
    v_and_b32 v145, 0xffff0000, v153
    v_lshlrev_b32 v146, 16, v169
    v_and_b32 v147, 0xffff0000, v169
    v_pk_add_f32 v[144:145], v[144:145], v[146:147]
    v_cvt_pk_bf16_f32 v148, v144, v145
    v_lshlrev_b32 v144, 16, v148
    v_and_b32 v145, 0xffff0000, v148
    v_lshlrev_b32 v146, 16, v173
    v_and_b32 v147, 0xffff0000, v173
    v_pk_add_f32 v[144:145], v[144:145], v[146:147]
    v_cvt_pk_bf16_f32 v153, v144, v145
    v_lshlrev_b32 v144, 16, v154
    v_and_b32 v145, 0xffff0000, v154
    v_lshlrev_b32 v146, 16, v170
    v_and_b32 v147, 0xffff0000, v170
    v_pk_add_f32 v[144:145], v[144:145], v[146:147]
    v_cvt_pk_bf16_f32 v148, v144, v145
    v_lshlrev_b32 v144, 16, v148
    v_and_b32 v145, 0xffff0000, v148
    v_lshlrev_b32 v146, 16, v174
    v_and_b32 v147, 0xffff0000, v174
    v_pk_add_f32 v[144:145], v[144:145], v[146:147]
    v_cvt_pk_bf16_f32 v154, v144, v145
    v_lshlrev_b32 v144, 16, v155
    v_and_b32 v145, 0xffff0000, v155
    v_lshlrev_b32 v146, 16, v171
    v_and_b32 v147, 0xffff0000, v171
    v_pk_add_f32 v[144:145], v[144:145], v[146:147]
    v_cvt_pk_bf16_f32 v148, v144, v145
    v_lshlrev_b32 v144, 16, v148
    v_and_b32 v145, 0xffff0000, v148
    v_lshlrev_b32 v146, 16, v175
    v_and_b32 v147, 0xffff0000, v175
    v_pk_add_f32 v[144:145], v[144:145], v[146:147]
    v_cvt_pk_bf16_f32 v155, v144, v145
    s_add_u32 s86, s84, 0
    buffer_store_dwordx4 v[152:155], v2, s[28:31], s86 offen offset:128
    v_accvgpr_read_b32 v128, a16
    v_accvgpr_read_b32 v129, a17
    v_accvgpr_read_b32 v130, a18
    v_accvgpr_read_b32 v131, a19
    v_accvgpr_read_b32 v132, a20
    v_accvgpr_read_b32 v133, a21
    v_accvgpr_read_b32 v134, a22
    v_accvgpr_read_b32 v135, a23
    v_cvt_pk_bf16_f32 v136, v128, v129
    v_cvt_pk_bf16_f32 v137, v130, v131
    v_cvt_pk_bf16_f32 v138, v132, v133
    v_cvt_pk_bf16_f32 v139, v134, v135
    s_nop 1
    v_permlane16_swap_b32 v136, v138
    v_permlane16_swap_b32 v137, v139
    s_waitcnt vmcnt(10)
    v_lshlrev_b32 v128, 16, v136
    v_and_b32 v129, 0xffff0000, v136
    v_lshlrev_b32 v130, 16, v176
    v_and_b32 v131, 0xffff0000, v176
    v_pk_add_f32 v[128:129], v[128:129], v[130:131]
    v_cvt_pk_bf16_f32 v132, v128, v129
    v_lshlrev_b32 v128, 16, v132
    v_and_b32 v129, 0xffff0000, v132
    v_lshlrev_b32 v130, 16, v180
    v_and_b32 v131, 0xffff0000, v180
    v_pk_add_f32 v[128:129], v[128:129], v[130:131]
    v_cvt_pk_bf16_f32 v136, v128, v129
    v_lshlrev_b32 v128, 16, v137
    v_and_b32 v129, 0xffff0000, v137
    v_lshlrev_b32 v130, 16, v177
    v_and_b32 v131, 0xffff0000, v177
    v_pk_add_f32 v[128:129], v[128:129], v[130:131]
    v_cvt_pk_bf16_f32 v132, v128, v129
    v_lshlrev_b32 v128, 16, v132
    v_and_b32 v129, 0xffff0000, v132
    v_lshlrev_b32 v130, 16, v181
    v_and_b32 v131, 0xffff0000, v181
    v_pk_add_f32 v[128:129], v[128:129], v[130:131]
    v_cvt_pk_bf16_f32 v137, v128, v129
    v_lshlrev_b32 v128, 16, v138
    v_and_b32 v129, 0xffff0000, v138
    v_lshlrev_b32 v130, 16, v178
    v_and_b32 v131, 0xffff0000, v178
    v_pk_add_f32 v[128:129], v[128:129], v[130:131]
    v_cvt_pk_bf16_f32 v132, v128, v129
    v_lshlrev_b32 v128, 16, v132
    v_and_b32 v129, 0xffff0000, v132
    v_lshlrev_b32 v130, 16, v182
    v_and_b32 v131, 0xffff0000, v182
    v_pk_add_f32 v[128:129], v[128:129], v[130:131]
    v_cvt_pk_bf16_f32 v138, v128, v129
    v_lshlrev_b32 v128, 16, v139
    v_and_b32 v129, 0xffff0000, v139
    v_lshlrev_b32 v130, 16, v179
    v_and_b32 v131, 0xffff0000, v179
    v_pk_add_f32 v[128:129], v[128:129], v[130:131]
    v_cvt_pk_bf16_f32 v132, v128, v129
    v_lshlrev_b32 v128, 16, v132
    v_and_b32 v129, 0xffff0000, v132
    v_lshlrev_b32 v130, 16, v183
    v_and_b32 v131, 0xffff0000, v183
    v_pk_add_f32 v[128:129], v[128:129], v[130:131]
    v_cvt_pk_bf16_f32 v139, v128, v129
    s_add_u32 s86, s84, 32768
    buffer_store_dwordx4 v[136:139], v2, s[28:31], s86 offen offset:0
    v_accvgpr_read_b32 v144, a24
    v_accvgpr_read_b32 v145, a25
    v_accvgpr_read_b32 v146, a26
    v_accvgpr_read_b32 v147, a27
    v_accvgpr_read_b32 v148, a28
    v_accvgpr_read_b32 v149, a29
    v_accvgpr_read_b32 v150, a30
    v_accvgpr_read_b32 v151, a31
    v_cvt_pk_bf16_f32 v152, v144, v145
    v_cvt_pk_bf16_f32 v153, v146, v147
    v_cvt_pk_bf16_f32 v154, v148, v149
    v_cvt_pk_bf16_f32 v155, v150, v151
    s_nop 1
    v_permlane16_swap_b32 v152, v154
    v_permlane16_swap_b32 v153, v155
    s_waitcnt vmcnt(8)
    v_lshlrev_b32 v144, 16, v152
    v_and_b32 v145, 0xffff0000, v152
    v_lshlrev_b32 v146, 16, v184
    v_and_b32 v147, 0xffff0000, v184
    v_pk_add_f32 v[144:145], v[144:145], v[146:147]
    v_cvt_pk_bf16_f32 v148, v144, v145
    v_lshlrev_b32 v144, 16, v148
    v_and_b32 v145, 0xffff0000, v148
    v_lshlrev_b32 v146, 16, v188
    v_and_b32 v147, 0xffff0000, v188
    v_pk_add_f32 v[144:145], v[144:145], v[146:147]
    v_cvt_pk_bf16_f32 v152, v144, v145
    v_lshlrev_b32 v144, 16, v153
    v_and_b32 v145, 0xffff0000, v153
    v_lshlrev_b32 v146, 16, v185
    v_and_b32 v147, 0xffff0000, v185
    v_pk_add_f32 v[144:145], v[144:145], v[146:147]
    v_cvt_pk_bf16_f32 v148, v144, v145
    v_lshlrev_b32 v144, 16, v148
    v_and_b32 v145, 0xffff0000, v148
    v_lshlrev_b32 v146, 16, v189
    v_and_b32 v147, 0xffff0000, v189
    v_pk_add_f32 v[144:145], v[144:145], v[146:147]
    v_cvt_pk_bf16_f32 v153, v144, v145
    v_lshlrev_b32 v144, 16, v154
    v_and_b32 v145, 0xffff0000, v154
    v_lshlrev_b32 v146, 16, v186
    v_and_b32 v147, 0xffff0000, v186
    v_pk_add_f32 v[144:145], v[144:145], v[146:147]
    v_cvt_pk_bf16_f32 v148, v144, v145
    v_lshlrev_b32 v144, 16, v148
    v_and_b32 v145, 0xffff0000, v148
    v_lshlrev_b32 v146, 16, v190
    v_and_b32 v147, 0xffff0000, v190
    v_pk_add_f32 v[144:145], v[144:145], v[146:147]
    v_cvt_pk_bf16_f32 v154, v144, v145
    v_lshlrev_b32 v144, 16, v155
    v_and_b32 v145, 0xffff0000, v155
    v_lshlrev_b32 v146, 16, v187
    v_and_b32 v147, 0xffff0000, v187
    v_pk_add_f32 v[144:145], v[144:145], v[146:147]
    v_cvt_pk_bf16_f32 v148, v144, v145
    v_lshlrev_b32 v144, 16, v148
    v_and_b32 v145, 0xffff0000, v148
    v_lshlrev_b32 v146, 16, v191
    v_and_b32 v147, 0xffff0000, v191
    v_pk_add_f32 v[144:145], v[144:145], v[146:147]
    v_cvt_pk_bf16_f32 v155, v144, v145
    s_add_u32 s86, s84, 32768
    buffer_store_dwordx4 v[152:155], v2, s[28:31], s86 offen offset:128
    v_accvgpr_read_b32 v128, a32
    v_accvgpr_read_b32 v129, a33
    v_accvgpr_read_b32 v130, a34
    v_accvgpr_read_b32 v131, a35
    v_accvgpr_read_b32 v132, a36
    v_accvgpr_read_b32 v133, a37
    v_accvgpr_read_b32 v134, a38
    v_accvgpr_read_b32 v135, a39
    v_cvt_pk_bf16_f32 v136, v128, v129
    v_cvt_pk_bf16_f32 v137, v130, v131
    v_cvt_pk_bf16_f32 v138, v132, v133
    v_cvt_pk_bf16_f32 v139, v134, v135
    s_nop 1
    v_permlane16_swap_b32 v136, v138
    v_permlane16_swap_b32 v137, v139
    s_waitcnt vmcnt(6)
    v_lshlrev_b32 v128, 16, v136
    v_and_b32 v129, 0xffff0000, v136
    v_lshlrev_b32 v130, 16, v192
    v_and_b32 v131, 0xffff0000, v192
    v_pk_add_f32 v[128:129], v[128:129], v[130:131]
    v_cvt_pk_bf16_f32 v132, v128, v129
    v_lshlrev_b32 v128, 16, v132
    v_and_b32 v129, 0xffff0000, v132
    v_lshlrev_b32 v130, 16, v196
    v_and_b32 v131, 0xffff0000, v196
    v_pk_add_f32 v[128:129], v[128:129], v[130:131]
    v_cvt_pk_bf16_f32 v136, v128, v129
    v_lshlrev_b32 v128, 16, v137
    v_and_b32 v129, 0xffff0000, v137
    v_lshlrev_b32 v130, 16, v193
    v_and_b32 v131, 0xffff0000, v193
    v_pk_add_f32 v[128:129], v[128:129], v[130:131]
    v_cvt_pk_bf16_f32 v132, v128, v129
    v_lshlrev_b32 v128, 16, v132
    v_and_b32 v129, 0xffff0000, v132
    v_lshlrev_b32 v130, 16, v197
    v_and_b32 v131, 0xffff0000, v197
    v_pk_add_f32 v[128:129], v[128:129], v[130:131]
    v_cvt_pk_bf16_f32 v137, v128, v129
    v_lshlrev_b32 v128, 16, v138
    v_and_b32 v129, 0xffff0000, v138
    v_lshlrev_b32 v130, 16, v194
    v_and_b32 v131, 0xffff0000, v194
    v_pk_add_f32 v[128:129], v[128:129], v[130:131]
    v_cvt_pk_bf16_f32 v132, v128, v129
    v_lshlrev_b32 v128, 16, v132
    v_and_b32 v129, 0xffff0000, v132
    v_lshlrev_b32 v130, 16, v198
    v_and_b32 v131, 0xffff0000, v198
    v_pk_add_f32 v[128:129], v[128:129], v[130:131]
    v_cvt_pk_bf16_f32 v138, v128, v129
    v_lshlrev_b32 v128, 16, v139
    v_and_b32 v129, 0xffff0000, v139
    v_lshlrev_b32 v130, 16, v195
    v_and_b32 v131, 0xffff0000, v195
    v_pk_add_f32 v[128:129], v[128:129], v[130:131]
    v_cvt_pk_bf16_f32 v132, v128, v129
    v_lshlrev_b32 v128, 16, v132
    v_and_b32 v129, 0xffff0000, v132
    v_lshlrev_b32 v130, 16, v199
    v_and_b32 v131, 0xffff0000, v199
    v_pk_add_f32 v[128:129], v[128:129], v[130:131]
    v_cvt_pk_bf16_f32 v139, v128, v129
    s_add_u32 s86, s84, 65536
    buffer_store_dwordx4 v[136:139], v2, s[28:31], s86 offen offset:0
    v_accvgpr_read_b32 v144, a40
    v_accvgpr_read_b32 v145, a41
    v_accvgpr_read_b32 v146, a42
    v_accvgpr_read_b32 v147, a43
    v_accvgpr_read_b32 v148, a44
    v_accvgpr_read_b32 v149, a45
    v_accvgpr_read_b32 v150, a46
    v_accvgpr_read_b32 v151, a47
    v_cvt_pk_bf16_f32 v152, v144, v145
    v_cvt_pk_bf16_f32 v153, v146, v147
    v_cvt_pk_bf16_f32 v154, v148, v149
    v_cvt_pk_bf16_f32 v155, v150, v151
    s_nop 1
    v_permlane16_swap_b32 v152, v154
    v_permlane16_swap_b32 v153, v155
    s_waitcnt vmcnt(4)
    v_lshlrev_b32 v144, 16, v152
    v_and_b32 v145, 0xffff0000, v152
    v_lshlrev_b32 v146, 16, v200
    v_and_b32 v147, 0xffff0000, v200
    v_pk_add_f32 v[144:145], v[144:145], v[146:147]
    v_cvt_pk_bf16_f32 v148, v144, v145
    v_lshlrev_b32 v144, 16, v148
    v_and_b32 v145, 0xffff0000, v148
    v_lshlrev_b32 v146, 16, v204
    v_and_b32 v147, 0xffff0000, v204
    v_pk_add_f32 v[144:145], v[144:145], v[146:147]
    v_cvt_pk_bf16_f32 v152, v144, v145
    v_lshlrev_b32 v144, 16, v153
    v_and_b32 v145, 0xffff0000, v153
    v_lshlrev_b32 v146, 16, v201
    v_and_b32 v147, 0xffff0000, v201
    v_pk_add_f32 v[144:145], v[144:145], v[146:147]
    v_cvt_pk_bf16_f32 v148, v144, v145
    v_lshlrev_b32 v144, 16, v148
    v_and_b32 v145, 0xffff0000, v148
    v_lshlrev_b32 v146, 16, v205
    v_and_b32 v147, 0xffff0000, v205
    v_pk_add_f32 v[144:145], v[144:145], v[146:147]
    v_cvt_pk_bf16_f32 v153, v144, v145
    v_lshlrev_b32 v144, 16, v154
    v_and_b32 v145, 0xffff0000, v154
    v_lshlrev_b32 v146, 16, v202
    v_and_b32 v147, 0xffff0000, v202
    v_pk_add_f32 v[144:145], v[144:145], v[146:147]
    v_cvt_pk_bf16_f32 v148, v144, v145
    v_lshlrev_b32 v144, 16, v148
    v_and_b32 v145, 0xffff0000, v148
    v_lshlrev_b32 v146, 16, v206
    v_and_b32 v147, 0xffff0000, v206
    v_pk_add_f32 v[144:145], v[144:145], v[146:147]
    v_cvt_pk_bf16_f32 v154, v144, v145
    v_lshlrev_b32 v144, 16, v155
    v_and_b32 v145, 0xffff0000, v155
    v_lshlrev_b32 v146, 16, v203
    v_and_b32 v147, 0xffff0000, v203
    v_pk_add_f32 v[144:145], v[144:145], v[146:147]
    v_cvt_pk_bf16_f32 v148, v144, v145
    v_lshlrev_b32 v144, 16, v148
    v_and_b32 v145, 0xffff0000, v148
    v_lshlrev_b32 v146, 16, v207
    v_and_b32 v147, 0xffff0000, v207
    v_pk_add_f32 v[144:145], v[144:145], v[146:147]
    v_cvt_pk_bf16_f32 v155, v144, v145
    s_add_u32 s86, s84, 65536
    buffer_store_dwordx4 v[152:155], v2, s[28:31], s86 offen offset:128
    v_accvgpr_read_b32 v128, a48
    v_accvgpr_read_b32 v129, a49
    v_accvgpr_read_b32 v130, a50
    v_accvgpr_read_b32 v131, a51
    v_accvgpr_read_b32 v132, a52
    v_accvgpr_read_b32 v133, a53
    v_accvgpr_read_b32 v134, a54
    v_accvgpr_read_b32 v135, a55
    v_cvt_pk_bf16_f32 v136, v128, v129
    v_cvt_pk_bf16_f32 v137, v130, v131
    v_cvt_pk_bf16_f32 v138, v132, v133
    v_cvt_pk_bf16_f32 v139, v134, v135
    s_nop 1
    v_permlane16_swap_b32 v136, v138
    v_permlane16_swap_b32 v137, v139
    s_waitcnt vmcnt(2)
    v_lshlrev_b32 v128, 16, v136
    v_and_b32 v129, 0xffff0000, v136
    v_lshlrev_b32 v130, 16, v208
    v_and_b32 v131, 0xffff0000, v208
    v_pk_add_f32 v[128:129], v[128:129], v[130:131]
    v_cvt_pk_bf16_f32 v132, v128, v129
    v_lshlrev_b32 v128, 16, v132
    v_and_b32 v129, 0xffff0000, v132
    v_lshlrev_b32 v130, 16, v212
    v_and_b32 v131, 0xffff0000, v212
    v_pk_add_f32 v[128:129], v[128:129], v[130:131]
    v_cvt_pk_bf16_f32 v136, v128, v129
    v_lshlrev_b32 v128, 16, v137
    v_and_b32 v129, 0xffff0000, v137
    v_lshlrev_b32 v130, 16, v209
    v_and_b32 v131, 0xffff0000, v209
    v_pk_add_f32 v[128:129], v[128:129], v[130:131]
    v_cvt_pk_bf16_f32 v132, v128, v129
    v_lshlrev_b32 v128, 16, v132
    v_and_b32 v129, 0xffff0000, v132
    v_lshlrev_b32 v130, 16, v213
    v_and_b32 v131, 0xffff0000, v213
    v_pk_add_f32 v[128:129], v[128:129], v[130:131]
    v_cvt_pk_bf16_f32 v137, v128, v129
    v_lshlrev_b32 v128, 16, v138
    v_and_b32 v129, 0xffff0000, v138
    v_lshlrev_b32 v130, 16, v210
    v_and_b32 v131, 0xffff0000, v210
    v_pk_add_f32 v[128:129], v[128:129], v[130:131]
    v_cvt_pk_bf16_f32 v132, v128, v129
    v_lshlrev_b32 v128, 16, v132
    v_and_b32 v129, 0xffff0000, v132
    v_lshlrev_b32 v130, 16, v214
    v_and_b32 v131, 0xffff0000, v214
    v_pk_add_f32 v[128:129], v[128:129], v[130:131]
    v_cvt_pk_bf16_f32 v138, v128, v129
    v_lshlrev_b32 v128, 16, v139
    v_and_b32 v129, 0xffff0000, v139
    v_lshlrev_b32 v130, 16, v211
    v_and_b32 v131, 0xffff0000, v211
    v_pk_add_f32 v[128:129], v[128:129], v[130:131]
    v_cvt_pk_bf16_f32 v132, v128, v129
    v_lshlrev_b32 v128, 16, v132
    v_and_b32 v129, 0xffff0000, v132
    v_lshlrev_b32 v130, 16, v215
    v_and_b32 v131, 0xffff0000, v215
    v_pk_add_f32 v[128:129], v[128:129], v[130:131]
    v_cvt_pk_bf16_f32 v139, v128, v129
    s_add_u32 s86, s84, 98304
    buffer_store_dwordx4 v[136:139], v2, s[28:31], s86 offen offset:0
    v_accvgpr_read_b32 v144, a56
    v_accvgpr_read_b32 v145, a57
    v_accvgpr_read_b32 v146, a58
    v_accvgpr_read_b32 v147, a59
    v_accvgpr_read_b32 v148, a60
    v_accvgpr_read_b32 v149, a61
    v_accvgpr_read_b32 v150, a62
    v_accvgpr_read_b32 v151, a63
    v_cvt_pk_bf16_f32 v152, v144, v145
    v_cvt_pk_bf16_f32 v153, v146, v147
    v_cvt_pk_bf16_f32 v154, v148, v149
    v_cvt_pk_bf16_f32 v155, v150, v151
    s_nop 1
    v_permlane16_swap_b32 v152, v154
    v_permlane16_swap_b32 v153, v155
    s_waitcnt vmcnt(0)
    v_lshlrev_b32 v144, 16, v152
    v_and_b32 v145, 0xffff0000, v152
    v_lshlrev_b32 v146, 16, v216
    v_and_b32 v147, 0xffff0000, v216
    v_pk_add_f32 v[144:145], v[144:145], v[146:147]
    v_cvt_pk_bf16_f32 v148, v144, v145
    v_lshlrev_b32 v144, 16, v148
    v_and_b32 v145, 0xffff0000, v148
    v_lshlrev_b32 v146, 16, v220
    v_and_b32 v147, 0xffff0000, v220
    v_pk_add_f32 v[144:145], v[144:145], v[146:147]
    v_cvt_pk_bf16_f32 v152, v144, v145
    v_lshlrev_b32 v144, 16, v153
    v_and_b32 v145, 0xffff0000, v153
    v_lshlrev_b32 v146, 16, v217
    v_and_b32 v147, 0xffff0000, v217
    v_pk_add_f32 v[144:145], v[144:145], v[146:147]
    v_cvt_pk_bf16_f32 v148, v144, v145
    v_lshlrev_b32 v144, 16, v148
    v_and_b32 v145, 0xffff0000, v148
    v_lshlrev_b32 v146, 16, v221
    v_and_b32 v147, 0xffff0000, v221
    v_pk_add_f32 v[144:145], v[144:145], v[146:147]
    v_cvt_pk_bf16_f32 v153, v144, v145
    v_lshlrev_b32 v144, 16, v154
    v_and_b32 v145, 0xffff0000, v154
    v_lshlrev_b32 v146, 16, v218
    v_and_b32 v147, 0xffff0000, v218
    v_pk_add_f32 v[144:145], v[144:145], v[146:147]
    v_cvt_pk_bf16_f32 v148, v144, v145
    v_lshlrev_b32 v144, 16, v148
    v_and_b32 v145, 0xffff0000, v148
    v_lshlrev_b32 v146, 16, v222
    v_and_b32 v147, 0xffff0000, v222
    v_pk_add_f32 v[144:145], v[144:145], v[146:147]
    v_cvt_pk_bf16_f32 v154, v144, v145
    v_lshlrev_b32 v144, 16, v155
    v_and_b32 v145, 0xffff0000, v155
    v_lshlrev_b32 v146, 16, v219
    v_and_b32 v147, 0xffff0000, v219
    v_pk_add_f32 v[144:145], v[144:145], v[146:147]
    v_cvt_pk_bf16_f32 v148, v144, v145
    v_lshlrev_b32 v144, 16, v148
    v_and_b32 v145, 0xffff0000, v148
    v_lshlrev_b32 v146, 16, v223
    v_and_b32 v147, 0xffff0000, v223
    v_pk_add_f32 v[144:145], v[144:145], v[146:147]
    v_cvt_pk_bf16_f32 v155, v144, v145
    s_add_u32 s86, s84, 98304
    buffer_store_dwordx4 v[152:155], v2, s[28:31], s86 offen offset:128
    s_branch L_next
L_WR:
    s_call_b64 s[4:5], L_epi
    s_cmp_eq_u32 s69, 0
    s_cbranch_scc1 Fl_195
    s_waitcnt vmcnt(0)
    s_barrier
    s_cmp_lg_u32 s3, 0
    s_cbranch_scc1 Fin_197
    v_mov_b32 v4, s69
    s_mov_b64 exec, 1
    buffer_atomic_add v4, off, s[92:95], s68 sc1
    s_mov_b64 exec, -1
Fin_197:
    s_mov_b32 s69, 0
Fl_195:
    s_mov_b32 s12, s50
    s_and_b32 s13, s51, 0xffff
    s_mov_b32 s14, 8388608
    s_mov_b32 s15, 0x20000
    s_and_b32 s36, s37, 1
    s_lshr_b32 s34, s37, 1
    v_lshrrev_b32 v2, 5, v1
    v_lshlrev_b32 v2, 4, v2
    v_bfe_u32 v3, v1, 3, 2
    v_add_u32 v2, v2, v3
    v_lshlrev_b32 v2, 11, v2
    v_and_b32 v3, 7, v1
    v_lshl_add_u32 v2, v3, 4, v2
    s_lshl_b32 s27, s3, 15
    v_lshrrev_b32 v4, 5, v1
    v_bfe_u32 v5, v1, 2, 2
    v_lshl_add_u32 v4, v4, 3, v5
    v_lshlrev_b32 v4, 7, v4
    v_bfe_u32 v5, v1, 4, 1
    v_lshl_add_u32 v4, v5, 5, v4
    v_and_b32 v3, 3, v1
    v_lshl_add_u32 v4, v3, 3, v4
    v_add_u32 v4, s27, v4
    s_lshl_b32 s22, s3, 20
    s_lshl_b32 s23, s36, 22
    s_add_u32 s22, s22, s23
    s_lshl_b32 s23, s34, 7
    s_add_u32 s22, s22, s23
    s_add_u32 m0, s27, 0
    s_nop 0
    buffer_load_dwordx4 v2, s[12:15], s22 offen lds
    s_add_u32 s22, s22, 8192
    s_add_u32 m0, s27, 1024
    s_nop 0
    buffer_load_dwordx4 v2, s[12:15], s22 offen lds
    s_add_u32 s22, s22, 8192
    s_add_u32 m0, s27, 2048
    s_nop 0
    buffer_load_dwordx4 v2, s[12:15], s22 offen lds
    s_add_u32 s22, s22, 8192
    s_add_u32 m0, s27, 3072
    s_nop 0
    buffer_load_dwordx4 v2, s[12:15], s22 offen lds
    s_add_u32 s22, s22, 40960
    s_add_u32 m0, s27, 4096
    s_nop 0
    buffer_load_dwordx4 v2, s[12:15], s22 offen lds
    s_add_u32 s22, s22, 8192
    s_add_u32 m0, s27, 5120
    s_nop 0
    buffer_load_dwordx4 v2, s[12:15], s22 offen lds
    s_add_u32 s22, s22, 8192
    s_add_u32 m0, s27, 6144
    s_nop 0
    buffer_load_dwordx4 v2, s[12:15], s22 offen lds
    s_add_u32 s22, s22, 8192
    s_add_u32 m0, s27, 7168
    s_nop 0
    buffer_load_dwordx4 v2, s[12:15], s22 offen lds
    s_add_u32 s22, s22, 40960
    s_add_u32 m0, s27, 8192
    s_nop 0
    buffer_load_dwordx4 v2, s[12:15], s22 offen lds
    s_add_u32 s22, s22, 8192
    s_add_u32 m0, s27, 9216
    s_nop 0
    buffer_load_dwordx4 v2, s[12:15], s22 offen lds
    s_add_u32 s22, s22, 8192
    s_add_u32 m0, s27, 10240
    s_nop 0
    buffer_load_dwordx4 v2, s[12:15], s22 offen lds
    s_add_u32 s22, s22, 8192
    s_add_u32 m0, s27, 11264
    s_nop 0
    buffer_load_dwordx4 v2, s[12:15], s22 offen lds
    s_add_u32 s22, s22, 40960
    s_add_u32 m0, s27, 12288
    s_nop 0
    buffer_load_dwordx4 v2, s[12:15], s22 offen lds
    s_add_u32 s22, s22, 8192
    s_add_u32 m0, s27, 13312
    s_nop 0
    buffer_load_dwordx4 v2, s[12:15], s22 offen lds
    s_add_u32 s22, s22, 8192
    s_add_u32 m0, s27, 14336
    s_nop 0
    buffer_load_dwordx4 v2, s[12:15], s22 offen lds
    s_add_u32 s22, s22, 8192
    s_add_u32 m0, s27, 15360
    s_nop 0
    buffer_load_dwordx4 v2, s[12:15], s22 offen lds
    s_add_u32 s22, s22, 40960
    s_add_u32 m0, s27, 16384
    s_nop 0
    buffer_load_dwordx4 v2, s[12:15], s22 offen lds
    s_add_u32 s22, s22, 8192
    s_add_u32 m0, s27, 17408
    s_nop 0
    buffer_load_dwordx4 v2, s[12:15], s22 offen lds
    s_add_u32 s22, s22, 8192
    s_add_u32 m0, s27, 18432
    s_nop 0
    buffer_load_dwordx4 v2, s[12:15], s22 offen lds
    s_add_u32 s22, s22, 8192
    s_add_u32 m0, s27, 19456
    s_nop 0
    buffer_load_dwordx4 v2, s[12:15], s22 offen lds
    s_add_u32 s22, s22, 40960
    s_add_u32 m0, s27, 20480
    s_nop 0
    buffer_load_dwordx4 v2, s[12:15], s22 offen lds
    s_add_u32 s22, s22, 8192
    s_add_u32 m0, s27, 21504
    s_nop 0
    buffer_load_dwordx4 v2, s[12:15], s22 offen lds
    s_add_u32 s22, s22, 8192
    s_add_u32 m0, s27, 22528
    s_nop 0
    buffer_load_dwordx4 v2, s[12:15], s22 offen lds
    s_add_u32 s22, s22, 8192
    s_add_u32 m0, s27, 23552
    s_nop 0
    buffer_load_dwordx4 v2, s[12:15], s22 offen lds
    s_add_u32 s22, s22, 40960
    s_add_u32 m0, s27, 24576
    s_nop 0
    buffer_load_dwordx4 v2, s[12:15], s22 offen lds
    s_add_u32 s22, s22, 8192
    s_add_u32 m0, s27, 25600
    s_nop 0
    buffer_load_dwordx4 v2, s[12:15], s22 offen lds
    s_add_u32 s22, s22, 8192
    s_add_u32 m0, s27, 26624
    s_nop 0
    buffer_load_dwordx4 v2, s[12:15], s22 offen lds
    s_add_u32 s22, s22, 8192
    s_add_u32 m0, s27, 27648
    s_nop 0
    buffer_load_dwordx4 v2, s[12:15], s22 offen lds
    s_add_u32 s22, s22, 40960
    s_add_u32 m0, s27, 28672
    s_nop 0
    buffer_load_dwordx4 v2, s[12:15], s22 offen lds
    s_add_u32 s22, s22, 8192
    s_add_u32 m0, s27, 29696
    s_nop 0
    buffer_load_dwordx4 v2, s[12:15], s22 offen lds
    s_add_u32 s22, s22, 8192
    s_add_u32 m0, s27, 30720
    s_nop 0
    buffer_load_dwordx4 v2, s[12:15], s22 offen lds
    s_add_u32 s22, s22, 8192
    s_add_u32 m0, s27, 31744
    s_nop 0
    buffer_load_dwordx4 v2, s[12:15], s22 offen lds
    s_add_u32 s22, s22, 40960
    s_waitcnt vmcnt(0)
    ds_read_b64_tr_b16 a[0:1], v4 offset:0
    ds_read_b64_tr_b16 a[2:3], v4 offset:512
    ds_read_b64_tr_b16 a[4:5], v4 offset:64
    ds_read_b64_tr_b16 a[6:7], v4 offset:576
    ds_read_b64_tr_b16 a[8:9], v4 offset:2048
    ds_read_b64_tr_b16 a[10:11], v4 offset:2560
    ds_read_b64_tr_b16 a[12:13], v4 offset:2112
    ds_read_b64_tr_b16 a[14:15], v4 offset:2624
    s_waitcnt lgkmcnt(0)
    ds_read_b64_tr_b16 a[16:17], v4 offset:4096
    ds_read_b64_tr_b16 a[18:19], v4 offset:4608
    ds_read_b64_tr_b16 a[20:21], v4 offset:4160
    ds_read_b64_tr_b16 a[22:23], v4 offset:4672
    ds_read_b64_tr_b16 a[24:25], v4 offset:6144
    ds_read_b64_tr_b16 a[26:27], v4 offset:6656
    ds_read_b64_tr_b16 a[28:29], v4 offset:6208
    ds_read_b64_tr_b16 a[30:31], v4 offset:6720
    s_waitcnt lgkmcnt(0)
    ds_read_b64_tr_b16 a[32:33], v4 offset:8192
    ds_read_b64_tr_b16 a[34:35], v4 offset:8704
    ds_read_b64_tr_b16 a[36:37], v4 offset:8256
    ds_read_b64_tr_b16 a[38:39], v4 offset:8768
    ds_read_b64_tr_b16 a[40:41], v4 offset:10240
    ds_read_b64_tr_b16 a[42:43], v4 offset:10752
    ds_read_b64_tr_b16 a[44:45], v4 offset:10304
    ds_read_b64_tr_b16 a[46:47], v4 offset:10816
    s_waitcnt lgkmcnt(0)
    ds_read_b64_tr_b16 a[48:49], v4 offset:12288
    ds_read_b64_tr_b16 a[50:51], v4 offset:12800
    ds_read_b64_tr_b16 a[52:53], v4 offset:12352
    ds_read_b64_tr_b16 a[54:55], v4 offset:12864
    ds_read_b64_tr_b16 a[56:57], v4 offset:14336
    ds_read_b64_tr_b16 a[58:59], v4 offset:14848
    ds_read_b64_tr_b16 a[60:61], v4 offset:14400
    ds_read_b64_tr_b16 a[62:63], v4 offset:14912
    s_waitcnt lgkmcnt(0)
    ds_read_b64_tr_b16 a[64:65], v4 offset:16384
    ds_read_b64_tr_b16 a[66:67], v4 offset:16896
    ds_read_b64_tr_b16 a[68:69], v4 offset:16448
    ds_read_b64_tr_b16 a[70:71], v4 offset:16960
    ds_read_b64_tr_b16 a[72:73], v4 offset:18432
    ds_read_b64_tr_b16 a[74:75], v4 offset:18944
    ds_read_b64_tr_b16 a[76:77], v4 offset:18496
    ds_read_b64_tr_b16 a[78:79], v4 offset:19008
    s_waitcnt lgkmcnt(0)
    ds_read_b64_tr_b16 a[80:81], v4 offset:20480
    ds_read_b64_tr_b16 a[82:83], v4 offset:20992
    ds_read_b64_tr_b16 a[84:85], v4 offset:20544
    ds_read_b64_tr_b16 a[86:87], v4 offset:21056
    ds_read_b64_tr_b16 a[88:89], v4 offset:22528
    ds_read_b64_tr_b16 a[90:91], v4 offset:23040
    ds_read_b64_tr_b16 a[92:93], v4 offset:22592
    ds_read_b64_tr_b16 a[94:95], v4 offset:23104
    s_waitcnt lgkmcnt(0)
    ds_read_b64_tr_b16 a[96:97], v4 offset:24576
    ds_read_b64_tr_b16 a[98:99], v4 offset:25088
    ds_read_b64_tr_b16 a[100:101], v4 offset:24640
    ds_read_b64_tr_b16 a[102:103], v4 offset:25152
    ds_read_b64_tr_b16 a[104:105], v4 offset:26624
    ds_read_b64_tr_b16 a[106:107], v4 offset:27136
    ds_read_b64_tr_b16 a[108:109], v4 offset:26688
    ds_read_b64_tr_b16 a[110:111], v4 offset:27200
    s_waitcnt lgkmcnt(0)
    ds_read_b64_tr_b16 a[112:113], v4 offset:28672
    ds_read_b64_tr_b16 a[114:115], v4 offset:29184
    ds_read_b64_tr_b16 a[116:117], v4 offset:28736
    ds_read_b64_tr_b16 a[118:119], v4 offset:29248
    ds_read_b64_tr_b16 a[120:121], v4 offset:30720
    ds_read_b64_tr_b16 a[122:123], v4 offset:31232
    ds_read_b64_tr_b16 a[124:125], v4 offset:30784
    ds_read_b64_tr_b16 a[126:127], v4 offset:31296
    s_waitcnt lgkmcnt(0)
    s_add_u32 m0, s27, 0
    s_nop 0
    buffer_load_dwordx4 v2, s[12:15], s22 offen lds
    s_add_u32 s22, s22, 8192
    s_add_u32 m0, s27, 1024
    s_nop 0
    buffer_load_dwordx4 v2, s[12:15], s22 offen lds
    s_add_u32 s22, s22, 8192
    s_add_u32 m0, s27, 2048
    s_nop 0
    buffer_load_dwordx4 v2, s[12:15], s22 offen lds
    s_add_u32 s22, s22, 8192
    s_add_u32 m0, s27, 3072
    s_nop 0
    buffer_load_dwordx4 v2, s[12:15], s22 offen lds
    s_add_u32 s22, s22, 40960
    s_add_u32 m0, s27, 4096
    s_nop 0
    buffer_load_dwordx4 v2, s[12:15], s22 offen lds
    s_add_u32 s22, s22, 8192
    s_add_u32 m0, s27, 5120
    s_nop 0
    buffer_load_dwordx4 v2, s[12:15], s22 offen lds
    s_add_u32 s22, s22, 8192
    s_add_u32 m0, s27, 6144
    s_nop 0
    buffer_load_dwordx4 v2, s[12:15], s22 offen lds
    s_add_u32 s22, s22, 8192
    s_add_u32 m0, s27, 7168
    s_nop 0
    buffer_load_dwordx4 v2, s[12:15], s22 offen lds
    s_add_u32 s22, s22, 40960
    s_add_u32 m0, s27, 8192
    s_nop 0
    buffer_load_dwordx4 v2, s[12:15], s22 offen lds
    s_add_u32 s22, s22, 8192
    s_add_u32 m0, s27, 9216
    s_nop 0
    buffer_load_dwordx4 v2, s[12:15], s22 offen lds
    s_add_u32 s22, s22, 8192
    s_add_u32 m0, s27, 10240
    s_nop 0
    buffer_load_dwordx4 v2, s[12:15], s22 offen lds
    s_add_u32 s22, s22, 8192
    s_add_u32 m0, s27, 11264
    s_nop 0
    buffer_load_dwordx4 v2, s[12:15], s22 offen lds
    s_add_u32 s22, s22, 40960
    s_add_u32 m0, s27, 12288
    s_nop 0
    buffer_load_dwordx4 v2, s[12:15], s22 offen lds
    s_add_u32 s22, s22, 8192
    s_add_u32 m0, s27, 13312
    s_nop 0
    buffer_load_dwordx4 v2, s[12:15], s22 offen lds
    s_add_u32 s22, s22, 8192
    s_add_u32 m0, s27, 14336
    s_nop 0
    buffer_load_dwordx4 v2, s[12:15], s22 offen lds
    s_add_u32 s22, s22, 8192
    s_add_u32 m0, s27, 15360
    s_nop 0
    buffer_load_dwordx4 v2, s[12:15], s22 offen lds
    s_add_u32 s22, s22, 40960
    s_add_u32 m0, s27, 16384
    s_nop 0
    buffer_load_dwordx4 v2, s[12:15], s22 offen lds
    s_add_u32 s22, s22, 8192
    s_add_u32 m0, s27, 17408
    s_nop 0
    buffer_load_dwordx4 v2, s[12:15], s22 offen lds
    s_add_u32 s22, s22, 8192
    s_add_u32 m0, s27, 18432
    s_nop 0
    buffer_load_dwordx4 v2, s[12:15], s22 offen lds
    s_add_u32 s22, s22, 8192
    s_add_u32 m0, s27, 19456
    s_nop 0
    buffer_load_dwordx4 v2, s[12:15], s22 offen lds
    s_add_u32 s22, s22, 40960
    s_add_u32 m0, s27, 20480
    s_nop 0
    buffer_load_dwordx4 v2, s[12:15], s22 offen lds
    s_add_u32 s22, s22, 8192
    s_add_u32 m0, s27, 21504
    s_nop 0
    buffer_load_dwordx4 v2, s[12:15], s22 offen lds
    s_add_u32 s22, s22, 8192
    s_add_u32 m0, s27, 22528
    s_nop 0
    buffer_load_dwordx4 v2, s[12:15], s22 offen lds
    s_add_u32 s22, s22, 8192
    s_add_u32 m0, s27, 23552
    s_nop 0
    buffer_load_dwordx4 v2, s[12:15], s22 offen lds
    s_add_u32 s22, s22, 40960
    s_add_u32 m0, s27, 24576
    s_nop 0
    buffer_load_dwordx4 v2, s[12:15], s22 offen lds
    s_add_u32 s22, s22, 8192
    s_add_u32 m0, s27, 25600
    s_nop 0
    buffer_load_dwordx4 v2, s[12:15], s22 offen lds
    s_add_u32 s22, s22, 8192
    s_add_u32 m0, s27, 26624
    s_nop 0
    buffer_load_dwordx4 v2, s[12:15], s22 offen lds
    s_add_u32 s22, s22, 8192
    s_add_u32 m0, s27, 27648
    s_nop 0
    buffer_load_dwordx4 v2, s[12:15], s22 offen lds
    s_add_u32 s22, s22, 40960
    s_add_u32 m0, s27, 28672
    s_nop 0
    buffer_load_dwordx4 v2, s[12:15], s22 offen lds
    s_add_u32 s22, s22, 8192
    s_add_u32 m0, s27, 29696
    s_nop 0
    buffer_load_dwordx4 v2, s[12:15], s22 offen lds
    s_add_u32 s22, s22, 8192
    s_add_u32 m0, s27, 30720
    s_nop 0
    buffer_load_dwordx4 v2, s[12:15], s22 offen lds
    s_add_u32 s22, s22, 8192
    s_add_u32 m0, s27, 31744
    s_nop 0
    buffer_load_dwordx4 v2, s[12:15], s22 offen lds
    s_add_u32 s22, s22, 40960
    s_waitcnt vmcnt(0)
    ds_read_b64_tr_b16 a[128:129], v4 offset:0
    ds_read_b64_tr_b16 a[130:131], v4 offset:512
    ds_read_b64_tr_b16 a[132:133], v4 offset:64
    ds_read_b64_tr_b16 a[134:135], v4 offset:576
    ds_read_b64_tr_b16 a[136:137], v4 offset:2048
    ds_read_b64_tr_b16 a[138:139], v4 offset:2560
    ds_read_b64_tr_b16 a[140:141], v4 offset:2112
    ds_read_b64_tr_b16 a[142:143], v4 offset:2624
    s_waitcnt lgkmcnt(0)
    ds_read_b64_tr_b16 a[144:145], v4 offset:4096
    ds_read_b64_tr_b16 a[146:147], v4 offset:4608
    ds_read_b64_tr_b16 a[148:149], v4 offset:4160
    ds_read_b64_tr_b16 a[150:151], v4 offset:4672
    ds_read_b64_tr_b16 a[152:153], v4 offset:6144
    ds_read_b64_tr_b16 a[154:155], v4 offset:6656
    ds_read_b64_tr_b16 a[156:157], v4 offset:6208
    ds_read_b64_tr_b16 a[158:159], v4 offset:6720
    s_waitcnt lgkmcnt(0)
    ds_read_b64_tr_b16 a[160:161], v4 offset:8192
    ds_read_b64_tr_b16 a[162:163], v4 offset:8704
    ds_read_b64_tr_b16 a[164:165], v4 offset:8256
    ds_read_b64_tr_b16 a[166:167], v4 offset:8768
    ds_read_b64_tr_b16 a[168:169], v4 offset:10240
    ds_read_b64_tr_b16 a[170:171], v4 offset:10752
    ds_read_b64_tr_b16 a[172:173], v4 offset:10304
    ds_read_b64_tr_b16 a[174:175], v4 offset:10816
    s_waitcnt lgkmcnt(0)
    ds_read_b64_tr_b16 a[176:177], v4 offset:12288
    ds_read_b64_tr_b16 a[178:179], v4 offset:12800
    ds_read_b64_tr_b16 a[180:181], v4 offset:12352
    ds_read_b64_tr_b16 a[182:183], v4 offset:12864
    ds_read_b64_tr_b16 a[184:185], v4 offset:14336
    ds_read_b64_tr_b16 a[186:187], v4 offset:14848
    ds_read_b64_tr_b16 a[188:189], v4 offset:14400
    ds_read_b64_tr_b16 a[190:191], v4 offset:14912
    s_waitcnt lgkmcnt(0)
    ds_read_b64_tr_b16 a[192:193], v4 offset:16384
    ds_read_b64_tr_b16 a[194:195], v4 offset:16896
    ds_read_b64_tr_b16 a[196:197], v4 offset:16448
    ds_read_b64_tr_b16 a[198:199], v4 offset:16960
    ds_read_b64_tr_b16 a[200:201], v4 offset:18432
    ds_read_b64_tr_b16 a[202:203], v4 offset:18944
    ds_read_b64_tr_b16 a[204:205], v4 offset:18496
    ds_read_b64_tr_b16 a[206:207], v4 offset:19008
    s_waitcnt lgkmcnt(0)
    ds_read_b64_tr_b16 a[208:209], v4 offset:20480
    ds_read_b64_tr_b16 a[210:211], v4 offset:20992
    ds_read_b64_tr_b16 a[212:213], v4 offset:20544
    ds_read_b64_tr_b16 a[214:215], v4 offset:21056
    ds_read_b64_tr_b16 a[216:217], v4 offset:22528
    ds_read_b64_tr_b16 a[218:219], v4 offset:23040
    ds_read_b64_tr_b16 a[220:221], v4 offset:22592
    ds_read_b64_tr_b16 a[222:223], v4 offset:23104
    s_waitcnt lgkmcnt(0)
    ds_read_b64_tr_b16 a[224:225], v4 offset:24576
    ds_read_b64_tr_b16 a[226:227], v4 offset:25088
    ds_read_b64_tr_b16 a[228:229], v4 offset:24640
    ds_read_b64_tr_b16 a[230:231], v4 offset:25152
    ds_read_b64_tr_b16 a[232:233], v4 offset:26624
    ds_read_b64_tr_b16 a[234:235], v4 offset:27136
    ds_read_b64_tr_b16 a[236:237], v4 offset:26688
    ds_read_b64_tr_b16 a[238:239], v4 offset:27200
    s_waitcnt lgkmcnt(0)
    ds_read_b64_tr_b16 a[240:241], v4 offset:28672
    ds_read_b64_tr_b16 a[242:243], v4 offset:29184
    ds_read_b64_tr_b16 a[244:245], v4 offset:28736
    ds_read_b64_tr_b16 a[246:247], v4 offset:29248
    ds_read_b64_tr_b16 a[248:249], v4 offset:30720
    ds_read_b64_tr_b16 a[250:251], v4 offset:31232
    ds_read_b64_tr_b16 a[252:253], v4 offset:30784
    ds_read_b64_tr_b16 a[254:255], v4 offset:31296
    s_waitcnt lgkmcnt(0)
    s_mov_b32 s32, 113252864
    s_cmp_lg_u32 s3, 0
    s_cbranch_scc1 Wf_198
    v_mov_b32 v15, 0
    s_mov_b32 s30, 0
    s_mov_b32 s21, 0x20
Wp_199:
    buffer_load_dword v14, v15, s[92:95], s32 offen sc1
    s_waitcnt vmcnt(0)
    v_cmp_ne_u32 vcc, s21, v14
    s_cbranch_vccz Wf_198
    s_sleep 8
    s_add_u32 s30, s30, 1
    s_cmp_lt_u32 s30, 65536
    s_cbranch_scc1 Wp_199
    s_branch L_abort
Wf_198:
    s_barrier
    s_add_u32 s8, s66, 117440512
    s_addc_u32 s9, s67, 0
    s_and_b32 s9, s9, 0xffff
    s_mov_b32 s10, 16777216
    s_mov_b32 s11, 0x20000
    s_mov_b32 s84, s62
    s_and_b32 s85, s63, 0xffff
    s_mov_b32 s86, 4194304
    s_mov_b32 s87, 0x20000
    s_mov_b32 s12, s40
    s_and_b32 s13, s41, 0xffff
    s_mov_b32 s14, 4194304
    s_mov_b32 s15, 0x20000
    s_lshl_b32 s37, s34, 1
    s_add_u32 s37, s37, s36
    v_bfe_u32 v10, v1, 2, 3
    v_and_b32 v11, 3, v1
    v_lshrrev_b32 v12, 5, v1
    v_and_b32 v13, 31, v1
    v_lshlrev_b32 v3, 11, v13
    v_lshl_add_u32 v3, v12, 3, v3
    s_lshl_b32 s22, s37, 6
    s_lshl_b32 s23, s3, 4
    s_add_u32 s22, s22, s23
    v_add_u32 v3, s22, v3
    v_lshlrev_b32 v6, 13, v10
    v_lshl_add_u32 v6, v11, 5, v6
    v_lshl_add_u32 v6, v12, 3, v6
    s_lshl_b32 s22, s37, 8
    s_lshr_b32 s23, s3, 1
    s_lshl_b32 s23, s23, 7
    s_add_u32 s22, s22, s23
    s_and_b32 s23, s3, 1
    s_lshl_b32 s23, s23, 4
    s_add_u32 s22, s22, s23
    s_add_u32 s22, s22, 89128960
    v_add_u32 v6, s22, v6
    v_lshlrev_b32 v13, 4, v1
    s_lshl_b32 s22, s3, 15
    s_lshl_b32 s23, s36, 17
    s_add_u32 s22, s22, s23
    v_add_u32 v64, s22, v13
    v_add_u32 v65, 4096, v64
    v_add_u32 v66, 8192, v64
    v_add_u32 v67, 12288, v64
    v_add_u32 v68, 16384, v64
    v_add_u32 v69, 20480, v64
    v_add_u32 v70, 24576, v64
    v_add_u32 v71, 28672, v64
    s_lshl_b32 s22, s3, 13
    v_add_u32 v7, s22, v13
    s_lshl_b32 s22, s3, 10
    s_lshl_b32 s23, s36, 12
    s_add_u32 s23, s23, s22
    v_add_u32 v8, s23, v13
    s_lshl_b32 s23, s37, 12
    s_add_u32 s22, s22, s23
    s_add_u32 s22, s22, 102760448
    v_add_u32 v10, s22, v13
    v_xor_b32 v11, 4096, v10
    s_mov_b32 s38, 48
    s_mov_b32 s35, 0
    s_mov_b32 s90, 0
    s_mov_b32 s91, 0
    v_mov_b32 v9, 159808
L_WORseg:
    s_and_b32 s32, s38, 7
    s_cmp_eq_u32 s38, 48
    s_cselect_b32 s32, 0, s32
    s_cmp_lg_u32 s32, 0
    s_cbranch_scc1 Wd_200
    s_lshr_b32 s32, s38, 3
    s_lshl_b32 s32, s32, 3
    s_lshr_b32 s33, s37, 2
    s_add_u32 s32, s32, s33
    s_lshl_b32 s32, s32, 6
    s_add_u32 s32, s32, 113270784
    s_cmp_lg_u32 s3, 0
    s_cbranch_scc1 Wf_201
    v_mov_b32 v15, 0
    s_mov_b32 s30, 0
    s_mov_b32 s21, 0x1
Wp_202:
    buffer_load_dword v14, v15, s[92:95], s32 offen sc1
    s_waitcnt vmcnt(0)
    v_cmp_ne_u32 vcc, s21, v14
    s_cbranch_vccz Wf_201
    s_sleep 8
    s_add_u32 s30, s30, 1
    s_cmp_lt_u32 s30, 65536
    s_cbranch_scc1 Wp_202
    s_branch L_abort
Wf_201:
    s_barrier
Wd_200:
    s_lshl_b32 s33, s38, 16
    s_sub_u32 s32, s38, 48
    s_lshl_b32 s32, s32, 7
    s_lshl_b32 s34, s36, 6
    s_add_u32 s32, s32, s34
    s_add_u32 s32, s32, 113250816
    s_lshl_b32 s34, s38, 18
    s_lshl_b32 s26, s38, 17
    s_cmp_eq_u32 s35, 16
    s_cbranch_scc1 Wr_203
    s_mov_b32 s91, 0
    s_cmp_lg_u32 s3, 0
    s_cbranch_scc1 Wf_204
    v_mov_b32 v15, 0
    s_mov_b32 s30, 0
    s_mov_b32 s21, 0x10
Wp_205:
    buffer_load_dword v14, v15, s[92:95], s32 offen sc1
    s_waitcnt vmcnt(0)
    v_cmp_ne_u32 vcc, s21, v14
    s_cbranch_vccz Wf_204
    s_sleep 1
    s_add_u32 s30, s30, 1
    s_cmp_lt_u32 s30, 65536
    s_cbranch_scc1 Wp_205
    s_branch L_abort
Wf_204:
    s_barrier
Wr_203:
    s_add_u32 s32, s32, 128
    s_bfe_u32 s22, s37, 0x20001
    s_cmp_eq_u32 s22, 1
    s_cbranch_scc1 L_WORe1
    s_cmp_eq_u32 s22, 2
    s_cbranch_scc1 L_WORe2
    s_cmp_eq_u32 s22, 3
    s_cbranch_scc1 L_WORe3
L_WORe0:
    s_cmp_lg_u32 s91, 0
    s_cbranch_scc1 L_WORf0
    buffer_load_dwordx4 v[128:131], v64, s[8:11], s34 offen offset:0 sc1
    buffer_load_dwordx4 v[132:135], v64, s[8:11], s34 offen offset:1024 sc1
    buffer_load_dwordx4 v[136:139], v64, s[8:11], s34 offen offset:2048 sc1
    buffer_load_dwordx4 v[140:143], v64, s[8:11], s34 offen offset:3072 sc1
    buffer_load_dwordx4 v[144:147], v65, s[8:11], s34 offen offset:0 sc1
    buffer_load_dwordx4 v[148:151], v65, s[8:11], s34 offen offset:1024 sc1
    buffer_load_dwordx4 v[152:155], v65, s[8:11], s34 offen offset:2048 sc1
    buffer_load_dwordx4 v[156:159], v65, s[8:11], s34 offen offset:3072 sc1
L_WORf0:
    s_waitcnt vmcnt(7)
    v_mfma_f32_32x32x16_bf16 v[16:31], a[0:3], v[128:131], 0
    buffer_load_dwordx4 v[160:163], v66, s[8:11], s34 offen offset:0 sc1
    v_mfma_f32_32x32x16_bf16 v[32:47], a[4:7], v[128:131], 0
    buffer_load_dwordx4 v[164:167], v66, s[8:11], s34 offen offset:1024 sc1
    s_waitcnt vmcnt(8)
    v_mfma_f32_32x32x16_bf16 v[16:31], a[8:11], v[132:135], v[16:31]
    buffer_load_dwordx4 v[168:171], v66, s[8:11], s34 offen offset:2048 sc1
    v_mfma_f32_32x32x16_bf16 v[32:47], a[12:15], v[132:135], v[32:47]
    buffer_load_dwordx4 v[172:175], v66, s[8:11], s34 offen offset:3072 sc1
    s_waitcnt vmcnt(9)
    v_mfma_f32_32x32x16_bf16 v[16:31], a[16:19], v[136:139], v[16:31]
    buffer_load_dwordx4 v[176:179], v67, s[8:11], s34 offen offset:0 sc1
    v_mfma_f32_32x32x16_bf16 v[32:47], a[20:23], v[136:139], v[32:47]
    buffer_load_dwordx4 v[180:183], v67, s[8:11], s34 offen offset:1024 sc1
    s_waitcnt vmcnt(10)
    v_mfma_f32_32x32x16_bf16 v[16:31], a[24:27], v[140:143], v[16:31]
    buffer_load_dwordx4 v[184:187], v67, s[8:11], s34 offen offset:2048 sc1
    v_mfma_f32_32x32x16_bf16 v[32:47], a[28:31], v[140:143], v[32:47]
    buffer_load_dwordx4 v[188:191], v67, s[8:11], s34 offen offset:3072 sc1
    s_waitcnt vmcnt(11)
    v_mfma_f32_32x32x16_bf16 v[16:31], a[32:35], v[144:147], v[16:31]
    buffer_load_dwordx4 v[192:195], v68, s[8:11], s34 offen offset:0 sc1
    v_mfma_f32_32x32x16_bf16 v[32:47], a[36:39], v[144:147], v[32:47]
    buffer_load_dwordx4 v[196:199], v68, s[8:11], s34 offen offset:1024 sc1
    s_waitcnt vmcnt(12)
    v_mfma_f32_32x32x16_bf16 v[16:31], a[40:43], v[148:151], v[16:31]
    buffer_load_dwordx4 v[200:203], v68, s[8:11], s34 offen offset:2048 sc1
    v_mfma_f32_32x32x16_bf16 v[32:47], a[44:47], v[148:151], v[32:47]
    buffer_load_dwordx4 v[204:207], v68, s[8:11], s34 offen offset:3072 sc1
    s_waitcnt vmcnt(13)
    v_mfma_f32_32x32x16_bf16 v[16:31], a[48:51], v[152:155], v[16:31]
    buffer_load_dwordx4 v[208:211], v69, s[8:11], s34 offen offset:0 sc1
    v_mfma_f32_32x32x16_bf16 v[32:47], a[52:55], v[152:155], v[32:47]
    buffer_load_dwordx4 v[212:215], v69, s[8:11], s34 offen offset:1024 sc1
    s_waitcnt vmcnt(14)
    v_mfma_f32_32x32x16_bf16 v[16:31], a[56:59], v[156:159], v[16:31]
    buffer_load_dwordx4 v[216:219], v69, s[8:11], s34 offen offset:2048 sc1
    v_mfma_f32_32x32x16_bf16 v[32:47], a[60:63], v[156:159], v[32:47]
    buffer_load_dwordx4 v[220:223], v69, s[8:11], s34 offen offset:3072 sc1
    s_waitcnt vmcnt(15)
    v_mfma_f32_32x32x16_bf16 v[16:31], a[64:67], v[160:163], v[16:31]
    buffer_load_dwordx4 v[224:227], v70, s[8:11], s34 offen offset:0 sc1
    v_mfma_f32_32x32x16_bf16 v[32:47], a[68:71], v[160:163], v[32:47]
    s_waitcnt vmcnt(15)
    v_mfma_f32_32x32x16_bf16 v[16:31], a[72:75], v[164:167], v[16:31]
    buffer_load_dwordx4 v[228:231], v70, s[8:11], s34 offen offset:1024 sc1
    v_mfma_f32_32x32x16_bf16 v[32:47], a[76:79], v[164:167], v[32:47]
    s_waitcnt vmcnt(15)
    v_mfma_f32_32x32x16_bf16 v[16:31], a[80:83], v[168:171], v[16:31]
    buffer_load_dwordx4 v[232:235], v70, s[8:11], s34 offen offset:2048 sc1
    v_mfma_f32_32x32x16_bf16 v[32:47], a[84:87], v[168:171], v[32:47]
    s_waitcnt vmcnt(15)
    v_mfma_f32_32x32x16_bf16 v[16:31], a[88:91], v[172:175], v[16:31]
    buffer_load_dwordx4 v[236:239], v70, s[8:11], s34 offen offset:3072 sc1
    v_mfma_f32_32x32x16_bf16 v[32:47], a[92:95], v[172:175], v[32:47]
    s_waitcnt vmcnt(15)
    v_mfma_f32_32x32x16_bf16 v[16:31], a[96:99], v[176:179], v[16:31]
    buffer_load_dwordx4 v[240:243], v71, s[8:11], s34 offen offset:0 sc1
    v_mfma_f32_32x32x16_bf16 v[32:47], a[100:103], v[176:179], v[32:47]
    s_waitcnt vmcnt(15)
    v_mfma_f32_32x32x16_bf16 v[16:31], a[104:107], v[180:183], v[16:31]
    buffer_load_dwordx4 v[244:247], v71, s[8:11], s34 offen offset:1024 sc1
    v_mfma_f32_32x32x16_bf16 v[32:47], a[108:111], v[180:183], v[32:47]
    s_waitcnt vmcnt(15)
    v_mfma_f32_32x32x16_bf16 v[16:31], a[112:115], v[184:187], v[16:31]
    buffer_load_dwordx4 v[248:251], v71, s[8:11], s34 offen offset:2048 sc1
    v_mfma_f32_32x32x16_bf16 v[32:47], a[116:119], v[184:187], v[32:47]
    s_waitcnt vmcnt(15)
    v_mfma_f32_32x32x16_bf16 v[16:31], a[120:123], v[188:191], v[16:31]
    buffer_load_dwordx4 v[252:255], v71, s[8:11], s34 offen offset:3072 sc1
    v_mfma_f32_32x32x16_bf16 v[32:47], a[124:127], v[188:191], v[32:47]
    s_waitcnt vmcnt(15)
    v_mfma_f32_32x32x16_bf16 v[16:31], a[128:131], v[192:195], v[16:31]
    buffer_load_dwordx2 v[48:49], v3, s[12:15], s33 offen
    v_mfma_f32_32x32x16_bf16 v[32:47], a[132:135], v[192:195], v[32:47]
    s_waitcnt vmcnt(15)
    v_mfma_f32_32x32x16_bf16 v[16:31], a[136:139], v[196:199], v[16:31]
    buffer_load_dwordx2 v[50:51], v6, s[92:95], s33 offen sc1
    v_mfma_f32_32x32x16_bf16 v[32:47], a[140:143], v[196:199], v[32:47]
    s_waitcnt vmcnt(15)
    v_mfma_f32_32x32x16_bf16 v[16:31], a[144:147], v[200:203], v[16:31]
    buffer_load_dwordx4 v[116:119], v11, s[92:95], s26 offen sc1
    v_mfma_f32_32x32x16_bf16 v[32:47], a[148:151], v[200:203], v[32:47]
    s_waitcnt vmcnt(15)
    v_mfma_f32_32x32x16_bf16 v[16:31], a[152:155], v[204:207], v[16:31]
    buffer_load_dword v14, off, s[92:95], s32 sc1
    v_mfma_f32_32x32x16_bf16 v[32:47], a[156:159], v[204:207], v[32:47]
    s_waitcnt vmcnt(15)
    v_mfma_f32_32x32x16_bf16 v[16:31], a[160:163], v[208:211], v[16:31]
    v_mfma_f32_32x32x16_bf16 v[32:47], a[164:167], v[208:211], v[32:47]
    s_waitcnt vmcnt(14)
    v_mfma_f32_32x32x16_bf16 v[16:31], a[168:171], v[212:215], v[16:31]
    v_mfma_f32_32x32x16_bf16 v[32:47], a[172:175], v[212:215], v[32:47]
    s_waitcnt vmcnt(13)
    v_mfma_f32_32x32x16_bf16 v[16:31], a[176:179], v[216:219], v[16:31]
    v_mfma_f32_32x32x16_bf16 v[32:47], a[180:183], v[216:219], v[32:47]
    s_waitcnt vmcnt(12)
    v_mfma_f32_32x32x16_bf16 v[16:31], a[184:187], v[220:223], v[16:31]
    v_mfma_f32_32x32x16_bf16 v[32:47], a[188:191], v[220:223], v[32:47]
    s_waitcnt vmcnt(11)
    v_mfma_f32_32x32x16_bf16 v[16:31], a[192:195], v[224:227], v[16:31]
    v_mfma_f32_32x32x16_bf16 v[32:47], a[196:199], v[224:227], v[32:47]
    s_waitcnt vmcnt(10)
    v_mfma_f32_32x32x16_bf16 v[16:31], a[200:203], v[228:231], v[16:31]
    v_mfma_f32_32x32x16_bf16 v[32:47], a[204:207], v[228:231], v[32:47]
    s_waitcnt vmcnt(9)
    v_mfma_f32_32x32x16_bf16 v[16:31], a[208:211], v[232:235], v[16:31]
    v_mfma_f32_32x32x16_bf16 v[32:47], a[212:215], v[232:235], v[32:47]
    s_waitcnt vmcnt(8)
    v_mfma_f32_32x32x16_bf16 v[16:31], a[216:219], v[236:239], v[16:31]
    v_mfma_f32_32x32x16_bf16 v[32:47], a[220:223], v[236:239], v[32:47]
    s_waitcnt vmcnt(7)
    v_mfma_f32_32x32x16_bf16 v[16:31], a[224:227], v[240:243], v[16:31]
    v_mfma_f32_32x32x16_bf16 v[32:47], a[228:231], v[240:243], v[32:47]
    s_waitcnt vmcnt(6)
    v_mfma_f32_32x32x16_bf16 v[16:31], a[232:235], v[244:247], v[16:31]
    v_mfma_f32_32x32x16_bf16 v[32:47], a[236:239], v[244:247], v[32:47]
    s_waitcnt vmcnt(5)
    v_mfma_f32_32x32x16_bf16 v[16:31], a[240:243], v[248:251], v[16:31]
    v_mfma_f32_32x32x16_bf16 v[32:47], a[244:247], v[248:251], v[32:47]
    s_waitcnt vmcnt(4)
    v_mfma_f32_32x32x16_bf16 v[16:31], a[248:251], v[252:255], v[16:31]
    v_mfma_f32_32x32x16_bf16 v[32:47], a[252:255], v[252:255], v[32:47]
    s_waitcnt vmcnt(0)
    v_readfirstlane_b32 s91, v14
    s_add_u32 s23, s38, 1
    s_and_b32 s23, s23, 7
    s_cselect_b32 s23, 16, 17
    s_cmp_eq_u32 s91, s23
    s_cselect_b32 s91, 1, 0
    s_cbranch_scc0 L_WORj
    s_add_u32 s23, s34, 262144
    buffer_load_dwordx4 v[128:131], v64, s[8:11], s23 offen offset:0 sc1
    buffer_load_dwordx4 v[132:135], v64, s[8:11], s23 offen offset:1024 sc1
    buffer_load_dwordx4 v[136:139], v64, s[8:11], s23 offen offset:2048 sc1
    buffer_load_dwordx4 v[140:143], v64, s[8:11], s23 offen offset:3072 sc1
    buffer_load_dwordx4 v[144:147], v65, s[8:11], s23 offen offset:0 sc1
    buffer_load_dwordx4 v[148:151], v65, s[8:11], s23 offen offset:1024 sc1
    buffer_load_dwordx4 v[152:155], v65, s[8:11], s23 offen offset:2048 sc1
    buffer_load_dwordx4 v[156:159], v65, s[8:11], s23 offen offset:3072 sc1
    s_branch L_WORj
L_WORe1:
    s_cmp_lg_u32 s91, 0
    s_cbranch_scc1 L_WORf1
    buffer_load_dwordx4 v[160:163], v66, s[8:11], s34 offen offset:0 sc1
    buffer_load_dwordx4 v[164:167], v66, s[8:11], s34 offen offset:1024 sc1
    buffer_load_dwordx4 v[168:171], v66, s[8:11], s34 offen offset:2048 sc1
    buffer_load_dwordx4 v[172:175], v66, s[8:11], s34 offen offset:3072 sc1
    buffer_load_dwordx4 v[176:179], v67, s[8:11], s34 offen offset:0 sc1
    buffer_load_dwordx4 v[180:183], v67, s[8:11], s34 offen offset:1024 sc1
    buffer_load_dwordx4 v[184:187], v67, s[8:11], s34 offen offset:2048 sc1
    buffer_load_dwordx4 v[188:191], v67, s[8:11], s34 offen offset:3072 sc1
L_WORf1:
    s_waitcnt vmcnt(7)
    v_mfma_f32_32x32x16_bf16 v[16:31], a[64:67], v[160:163], 0
    buffer_load_dwordx4 v[192:195], v68, s[8:11], s34 offen offset:0 sc1
    v_mfma_f32_32x32x16_bf16 v[32:47], a[68:71], v[160:163], 0
    buffer_load_dwordx4 v[196:199], v68, s[8:11], s34 offen offset:1024 sc1
    s_waitcnt vmcnt(8)
    v_mfma_f32_32x32x16_bf16 v[16:31], a[72:75], v[164:167], v[16:31]
    buffer_load_dwordx4 v[200:203], v68, s[8:11], s34 offen offset:2048 sc1
    v_mfma_f32_32x32x16_bf16 v[32:47], a[76:79], v[164:167], v[32:47]
    buffer_load_dwordx4 v[204:207], v68, s[8:11], s34 offen offset:3072 sc1
    s_waitcnt vmcnt(9)
    v_mfma_f32_32x32x16_bf16 v[16:31], a[80:83], v[168:171], v[16:31]
    buffer_load_dwordx4 v[208:211], v69, s[8:11], s34 offen offset:0 sc1
    v_mfma_f32_32x32x16_bf16 v[32:47], a[84:87], v[168:171], v[32:47]
    buffer_load_dwordx4 v[212:215], v69, s[8:11], s34 offen offset:1024 sc1
    s_waitcnt vmcnt(10)
    v_mfma_f32_32x32x16_bf16 v[16:31], a[88:91], v[172:175], v[16:31]
    buffer_load_dwordx4 v[216:219], v69, s[8:11], s34 offen offset:2048 sc1
    v_mfma_f32_32x32x16_bf16 v[32:47], a[92:95], v[172:175], v[32:47]
    buffer_load_dwordx4 v[220:223], v69, s[8:11], s34 offen offset:3072 sc1
    s_waitcnt vmcnt(11)
    v_mfma_f32_32x32x16_bf16 v[16:31], a[96:99], v[176:179], v[16:31]
    buffer_load_dwordx4 v[224:227], v70, s[8:11], s34 offen offset:0 sc1
    v_mfma_f32_32x32x16_bf16 v[32:47], a[100:103], v[176:179], v[32:47]
    buffer_load_dwordx4 v[228:231], v70, s[8:11], s34 offen offset:1024 sc1
    s_waitcnt vmcnt(12)
    v_mfma_f32_32x32x16_bf16 v[16:31], a[104:107], v[180:183], v[16:31]
    buffer_load_dwordx4 v[232:235], v70, s[8:11], s34 offen offset:2048 sc1
    v_mfma_f32_32x32x16_bf16 v[32:47], a[108:111], v[180:183], v[32:47]
    buffer_load_dwordx4 v[236:239], v70, s[8:11], s34 offen offset:3072 sc1
    s_waitcnt vmcnt(13)
    v_mfma_f32_32x32x16_bf16 v[16:31], a[112:115], v[184:187], v[16:31]
    buffer_load_dwordx4 v[240:243], v71, s[8:11], s34 offen offset:0 sc1
    v_mfma_f32_32x32x16_bf16 v[32:47], a[116:119], v[184:187], v[32:47]
    buffer_load_dwordx4 v[244:247], v71, s[8:11], s34 offen offset:1024 sc1
    s_waitcnt vmcnt(14)
    v_mfma_f32_32x32x16_bf16 v[16:31], a[120:123], v[188:191], v[16:31]
    buffer_load_dwordx4 v[248:251], v71, s[8:11], s34 offen offset:2048 sc1
    v_mfma_f32_32x32x16_bf16 v[32:47], a[124:127], v[188:191], v[32:47]
    buffer_load_dwordx4 v[252:255], v71, s[8:11], s34 offen offset:3072 sc1
    s_waitcnt vmcnt(15)
    v_mfma_f32_32x32x16_bf16 v[16:31], a[128:131], v[192:195], v[16:31]
    buffer_load_dwordx4 v[128:131], v64, s[8:11], s34 offen offset:0 sc1
    v_mfma_f32_32x32x16_bf16 v[32:47], a[132:135], v[192:195], v[32:47]
    s_waitcnt vmcnt(15)
    v_mfma_f32_32x32x16_bf16 v[16:31], a[136:139], v[196:199], v[16:31]
    buffer_load_dwordx4 v[132:135], v64, s[8:11], s34 offen offset:1024 sc1
    v_mfma_f32_32x32x16_bf16 v[32:47], a[140:143], v[196:199], v[32:47]
    s_waitcnt vmcnt(15)
    v_mfma_f32_32x32x16_bf16 v[16:31], a[144:147], v[200:203], v[16:31]
    buffer_load_dwordx4 v[136:139], v64, s[8:11], s34 offen offset:2048 sc1
    v_mfma_f32_32x32x16_bf16 v[32:47], a[148:151], v[200:203], v[32:47]
    s_waitcnt vmcnt(15)
    v_mfma_f32_32x32x16_bf16 v[16:31], a[152:155], v[204:207], v[16:31]
    buffer_load_dwordx4 v[140:143], v64, s[8:11], s34 offen offset:3072 sc1
    v_mfma_f32_32x32x16_bf16 v[32:47], a[156:159], v[204:207], v[32:47]
    s_waitcnt vmcnt(15)
    v_mfma_f32_32x32x16_bf16 v[16:31], a[160:163], v[208:211], v[16:31]
    buffer_load_dwordx4 v[144:147], v65, s[8:11], s34 offen offset:0 sc1
    v_mfma_f32_32x32x16_bf16 v[32:47], a[164:167], v[208:211], v[32:47]
    s_waitcnt vmcnt(15)
    v_mfma_f32_32x32x16_bf16 v[16:31], a[168:171], v[212:215], v[16:31]
    buffer_load_dwordx4 v[148:151], v65, s[8:11], s34 offen offset:1024 sc1
    v_mfma_f32_32x32x16_bf16 v[32:47], a[172:175], v[212:215], v[32:47]
    s_waitcnt vmcnt(15)
    v_mfma_f32_32x32x16_bf16 v[16:31], a[176:179], v[216:219], v[16:31]
    buffer_load_dwordx4 v[152:155], v65, s[8:11], s34 offen offset:2048 sc1
    v_mfma_f32_32x32x16_bf16 v[32:47], a[180:183], v[216:219], v[32:47]
    s_waitcnt vmcnt(15)
    v_mfma_f32_32x32x16_bf16 v[16:31], a[184:187], v[220:223], v[16:31]
    buffer_load_dwordx4 v[156:159], v65, s[8:11], s34 offen offset:3072 sc1
    v_mfma_f32_32x32x16_bf16 v[32:47], a[188:191], v[220:223], v[32:47]
    s_waitcnt vmcnt(15)
    v_mfma_f32_32x32x16_bf16 v[16:31], a[192:195], v[224:227], v[16:31]
    buffer_load_dwordx2 v[48:49], v3, s[12:15], s33 offen
    v_mfma_f32_32x32x16_bf16 v[32:47], a[196:199], v[224:227], v[32:47]
    s_waitcnt vmcnt(15)
    v_mfma_f32_32x32x16_bf16 v[16:31], a[200:203], v[228:231], v[16:31]
    buffer_load_dwordx2 v[50:51], v6, s[92:95], s33 offen sc1
    v_mfma_f32_32x32x16_bf16 v[32:47], a[204:207], v[228:231], v[32:47]
    s_waitcnt vmcnt(15)
    v_mfma_f32_32x32x16_bf16 v[16:31], a[208:211], v[232:235], v[16:31]
    buffer_load_dwordx4 v[116:119], v11, s[92:95], s26 offen sc1
    v_mfma_f32_32x32x16_bf16 v[32:47], a[212:215], v[232:235], v[32:47]
    s_waitcnt vmcnt(15)
    v_mfma_f32_32x32x16_bf16 v[16:31], a[216:219], v[236:239], v[16:31]
    buffer_load_dword v14, off, s[92:95], s32 sc1
    v_mfma_f32_32x32x16_bf16 v[32:47], a[220:223], v[236:239], v[32:47]
    s_waitcnt vmcnt(15)
    v_mfma_f32_32x32x16_bf16 v[16:31], a[224:227], v[240:243], v[16:31]
    v_mfma_f32_32x32x16_bf16 v[32:47], a[228:231], v[240:243], v[32:47]
    s_waitcnt vmcnt(14)
    v_mfma_f32_32x32x16_bf16 v[16:31], a[232:235], v[244:247], v[16:31]
    v_mfma_f32_32x32x16_bf16 v[32:47], a[236:239], v[244:247], v[32:47]
    s_waitcnt vmcnt(13)
    v_mfma_f32_32x32x16_bf16 v[16:31], a[240:243], v[248:251], v[16:31]
    v_mfma_f32_32x32x16_bf16 v[32:47], a[244:247], v[248:251], v[32:47]
    s_waitcnt vmcnt(12)
    v_mfma_f32_32x32x16_bf16 v[16:31], a[248:251], v[252:255], v[16:31]
    v_mfma_f32_32x32x16_bf16 v[32:47], a[252:255], v[252:255], v[32:47]
    s_waitcnt vmcnt(11)
    v_mfma_f32_32x32x16_bf16 v[16:31], a[0:3], v[128:131], v[16:31]
    v_mfma_f32_32x32x16_bf16 v[32:47], a[4:7], v[128:131], v[32:47]
    s_waitcnt vmcnt(10)
    v_mfma_f32_32x32x16_bf16 v[16:31], a[8:11], v[132:135], v[16:31]
    v_mfma_f32_32x32x16_bf16 v[32:47], a[12:15], v[132:135], v[32:47]
    s_waitcnt vmcnt(9)
    v_mfma_f32_32x32x16_bf16 v[16:31], a[16:19], v[136:139], v[16:31]
    v_mfma_f32_32x32x16_bf16 v[32:47], a[20:23], v[136:139], v[32:47]
    s_waitcnt vmcnt(8)
    v_mfma_f32_32x32x16_bf16 v[16:31], a[24:27], v[140:143], v[16:31]
    v_mfma_f32_32x32x16_bf16 v[32:47], a[28:31], v[140:143], v[32:47]
    s_waitcnt vmcnt(7)
    v_mfma_f32_32x32x16_bf16 v[16:31], a[32:35], v[144:147], v[16:31]
    v_mfma_f32_32x32x16_bf16 v[32:47], a[36:39], v[144:147], v[32:47]
    s_waitcnt vmcnt(6)
    v_mfma_f32_32x32x16_bf16 v[16:31], a[40:43], v[148:151], v[16:31]
    v_mfma_f32_32x32x16_bf16 v[32:47], a[44:47], v[148:151], v[32:47]
    s_waitcnt vmcnt(5)
    v_mfma_f32_32x32x16_bf16 v[16:31], a[48:51], v[152:155], v[16:31]
    v_mfma_f32_32x32x16_bf16 v[32:47], a[52:55], v[152:155], v[32:47]
    s_waitcnt vmcnt(4)
    v_mfma_f32_32x32x16_bf16 v[16:31], a[56:59], v[156:159], v[16:31]
    v_mfma_f32_32x32x16_bf16 v[32:47], a[60:63], v[156:159], v[32:47]
    s_waitcnt vmcnt(0)
    v_readfirstlane_b32 s91, v14
    s_add_u32 s23, s38, 1
    s_and_b32 s23, s23, 7
    s_cselect_b32 s23, 16, 17
    s_cmp_eq_u32 s91, s23
    s_cselect_b32 s91, 1, 0
    s_cbranch_scc0 L_WORj
    s_add_u32 s23, s34, 262144
    buffer_load_dwordx4 v[160:163], v66, s[8:11], s23 offen offset:0 sc1
    buffer_load_dwordx4 v[164:167], v66, s[8:11], s23 offen offset:1024 sc1
    buffer_load_dwordx4 v[168:171], v66, s[8:11], s23 offen offset:2048 sc1
    buffer_load_dwordx4 v[172:175], v66, s[8:11], s23 offen offset:3072 sc1
    buffer_load_dwordx4 v[176:179], v67, s[8:11], s23 offen offset:0 sc1
    buffer_load_dwordx4 v[180:183], v67, s[8:11], s23 offen offset:1024 sc1
    buffer_load_dwordx4 v[184:187], v67, s[8:11], s23 offen offset:2048 sc1
    buffer_load_dwordx4 v[188:191], v67, s[8:11], s23 offen offset:3072 sc1
    s_branch L_WORj
L_WORe2:
    s_cmp_lg_u32 s91, 0
    s_cbranch_scc1 L_WORf2
    buffer_load_dwordx4 v[192:195], v68, s[8:11], s34 offen offset:0 sc1
    buffer_load_dwordx4 v[196:199], v68, s[8:11], s34 offen offset:1024 sc1
    buffer_load_dwordx4 v[200:203], v68, s[8:11], s34 offen offset:2048 sc1
    buffer_load_dwordx4 v[204:207], v68, s[8:11], s34 offen offset:3072 sc1
    buffer_load_dwordx4 v[208:211], v69, s[8:11], s34 offen offset:0 sc1
    buffer_load_dwordx4 v[212:215], v69, s[8:11], s34 offen offset:1024 sc1
    buffer_load_dwordx4 v[216:219], v69, s[8:11], s34 offen offset:2048 sc1
    buffer_load_dwordx4 v[220:223], v69, s[8:11], s34 offen offset:3072 sc1
L_WORf2:
    s_waitcnt vmcnt(7)
    v_mfma_f32_32x32x16_bf16 v[16:31], a[128:131], v[192:195], 0
    buffer_load_dwordx4 v[224:227], v70, s[8:11], s34 offen offset:0 sc1
    v_mfma_f32_32x32x16_bf16 v[32:47], a[132:135], v[192:195], 0
    buffer_load_dwordx4 v[228:231], v70, s[8:11], s34 offen offset:1024 sc1
    s_waitcnt vmcnt(8)
    v_mfma_f32_32x32x16_bf16 v[16:31], a[136:139], v[196:199], v[16:31]
    buffer_load_dwordx4 v[232:235], v70, s[8:11], s34 offen offset:2048 sc1
    v_mfma_f32_32x32x16_bf16 v[32:47], a[140:143], v[196:199], v[32:47]
    buffer_load_dwordx4 v[236:239], v70, s[8:11], s34 offen offset:3072 sc1
    s_waitcnt vmcnt(9)
    v_mfma_f32_32x32x16_bf16 v[16:31], a[144:147], v[200:203], v[16:31]
    buffer_load_dwordx4 v[240:243], v71, s[8:11], s34 offen offset:0 sc1
    v_mfma_f32_32x32x16_bf16 v[32:47], a[148:151], v[200:203], v[32:47]
    buffer_load_dwordx4 v[244:247], v71, s[8:11], s34 offen offset:1024 sc1
    s_waitcnt vmcnt(10)
    v_mfma_f32_32x32x16_bf16 v[16:31], a[152:155], v[204:207], v[16:31]
    buffer_load_dwordx4 v[248:251], v71, s[8:11], s34 offen offset:2048 sc1
    v_mfma_f32_32x32x16_bf16 v[32:47], a[156:159], v[204:207], v[32:47]
    buffer_load_dwordx4 v[252:255], v71, s[8:11], s34 offen offset:3072 sc1
    s_waitcnt vmcnt(11)
    v_mfma_f32_32x32x16_bf16 v[16:31], a[160:163], v[208:211], v[16:31]
    buffer_load_dwordx4 v[128:131], v64, s[8:11], s34 offen offset:0 sc1
    v_mfma_f32_32x32x16_bf16 v[32:47], a[164:167], v[208:211], v[32:47]
    buffer_load_dwordx4 v[132:135], v64, s[8:11], s34 offen offset:1024 sc1
    s_waitcnt vmcnt(12)
    v_mfma_f32_32x32x16_bf16 v[16:31], a[168:171], v[212:215], v[16:31]
    buffer_load_dwordx4 v[136:139], v64, s[8:11], s34 offen offset:2048 sc1
    v_mfma_f32_32x32x16_bf16 v[32:47], a[172:175], v[212:215], v[32:47]
    buffer_load_dwordx4 v[140:143], v64, s[8:11], s34 offen offset:3072 sc1
    s_waitcnt vmcnt(13)
    v_mfma_f32_32x32x16_bf16 v[16:31], a[176:179], v[216:219], v[16:31]
    buffer_load_dwordx4 v[144:147], v65, s[8:11], s34 offen offset:0 sc1
    v_mfma_f32_32x32x16_bf16 v[32:47], a[180:183], v[216:219], v[32:47]
    buffer_load_dwordx4 v[148:151], v65, s[8:11], s34 offen offset:1024 sc1
    s_waitcnt vmcnt(14)
    v_mfma_f32_32x32x16_bf16 v[16:31], a[184:187], v[220:223], v[16:31]
    buffer_load_dwordx4 v[152:155], v65, s[8:11], s34 offen offset:2048 sc1
    v_mfma_f32_32x32x16_bf16 v[32:47], a[188:191], v[220:223], v[32:47]
    buffer_load_dwordx4 v[156:159], v65, s[8:11], s34 offen offset:3072 sc1
    s_waitcnt vmcnt(15)
    v_mfma_f32_32x32x16_bf16 v[16:31], a[192:195], v[224:227], v[16:31]
    buffer_load_dwordx4 v[160:163], v66, s[8:11], s34 offen offset:0 sc1
    v_mfma_f32_32x32x16_bf16 v[32:47], a[196:199], v[224:227], v[32:47]
    s_waitcnt vmcnt(15)
    v_mfma_f32_32x32x16_bf16 v[16:31], a[200:203], v[228:231], v[16:31]
    buffer_load_dwordx4 v[164:167], v66, s[8:11], s34 offen offset:1024 sc1
    v_mfma_f32_32x32x16_bf16 v[32:47], a[204:207], v[228:231], v[32:47]
    s_waitcnt vmcnt(15)
    v_mfma_f32_32x32x16_bf16 v[16:31], a[208:211], v[232:235], v[16:31]
    buffer_load_dwordx4 v[168:171], v66, s[8:11], s34 offen offset:2048 sc1
    v_mfma_f32_32x32x16_bf16 v[32:47], a[212:215], v[232:235], v[32:47]
    s_waitcnt vmcnt(15)
    v_mfma_f32_32x32x16_bf16 v[16:31], a[216:219], v[236:239], v[16:31]
    buffer_load_dwordx4 v[172:175], v66, s[8:11], s34 offen offset:3072 sc1
    v_mfma_f32_32x32x16_bf16 v[32:47], a[220:223], v[236:239], v[32:47]
    s_waitcnt vmcnt(15)
    v_mfma_f32_32x32x16_bf16 v[16:31], a[224:227], v[240:243], v[16:31]
    buffer_load_dwordx4 v[176:179], v67, s[8:11], s34 offen offset:0 sc1
    v_mfma_f32_32x32x16_bf16 v[32:47], a[228:231], v[240:243], v[32:47]
    s_waitcnt vmcnt(15)
    v_mfma_f32_32x32x16_bf16 v[16:31], a[232:235], v[244:247], v[16:31]
    buffer_load_dwordx4 v[180:183], v67, s[8:11], s34 offen offset:1024 sc1
    v_mfma_f32_32x32x16_bf16 v[32:47], a[236:239], v[244:247], v[32:47]
    s_waitcnt vmcnt(15)
    v_mfma_f32_32x32x16_bf16 v[16:31], a[240:243], v[248:251], v[16:31]
    buffer_load_dwordx4 v[184:187], v67, s[8:11], s34 offen offset:2048 sc1
    v_mfma_f32_32x32x16_bf16 v[32:47], a[244:247], v[248:251], v[32:47]
    s_waitcnt vmcnt(15)
    v_mfma_f32_32x32x16_bf16 v[16:31], a[248:251], v[252:255], v[16:31]
    buffer_load_dwordx4 v[188:191], v67, s[8:11], s34 offen offset:3072 sc1
    v_mfma_f32_32x32x16_bf16 v[32:47], a[252:255], v[252:255], v[32:47]
    s_waitcnt vmcnt(15)
    v_mfma_f32_32x32x16_bf16 v[16:31], a[0:3], v[128:131], v[16:31]
    buffer_load_dwordx2 v[48:49], v3, s[12:15], s33 offen
    v_mfma_f32_32x32x16_bf16 v[32:47], a[4:7], v[128:131], v[32:47]
    s_waitcnt vmcnt(15)
    v_mfma_f32_32x32x16_bf16 v[16:31], a[8:11], v[132:135], v[16:31]
    buffer_load_dwordx2 v[50:51], v6, s[92:95], s33 offen sc1
    v_mfma_f32_32x32x16_bf16 v[32:47], a[12:15], v[132:135], v[32:47]
    s_waitcnt vmcnt(15)
    v_mfma_f32_32x32x16_bf16 v[16:31], a[16:19], v[136:139], v[16:31]
    buffer_load_dwordx4 v[116:119], v11, s[92:95], s26 offen sc1
    v_mfma_f32_32x32x16_bf16 v[32:47], a[20:23], v[136:139], v[32:47]
    s_waitcnt vmcnt(15)
    v_mfma_f32_32x32x16_bf16 v[16:31], a[24:27], v[140:143], v[16:31]
    buffer_load_dword v14, off, s[92:95], s32 sc1
    v_mfma_f32_32x32x16_bf16 v[32:47], a[28:31], v[140:143], v[32:47]
    s_waitcnt vmcnt(15)
    v_mfma_f32_32x32x16_bf16 v[16:31], a[32:35], v[144:147], v[16:31]
    v_mfma_f32_32x32x16_bf16 v[32:47], a[36:39], v[144:147], v[32:47]
    s_waitcnt vmcnt(14)
    v_mfma_f32_32x32x16_bf16 v[16:31], a[40:43], v[148:151], v[16:31]
    v_mfma_f32_32x32x16_bf16 v[32:47], a[44:47], v[148:151], v[32:47]
    s_waitcnt vmcnt(13)
    v_mfma_f32_32x32x16_bf16 v[16:31], a[48:51], v[152:155], v[16:31]
    v_mfma_f32_32x32x16_bf16 v[32:47], a[52:55], v[152:155], v[32:47]
    s_waitcnt vmcnt(12)
    v_mfma_f32_32x32x16_bf16 v[16:31], a[56:59], v[156:159], v[16:31]
    v_mfma_f32_32x32x16_bf16 v[32:47], a[60:63], v[156:159], v[32:47]
    s_waitcnt vmcnt(11)
    v_mfma_f32_32x32x16_bf16 v[16:31], a[64:67], v[160:163], v[16:31]
    v_mfma_f32_32x32x16_bf16 v[32:47], a[68:71], v[160:163], v[32:47]
    s_waitcnt vmcnt(10)
    v_mfma_f32_32x32x16_bf16 v[16:31], a[72:75], v[164:167], v[16:31]
    v_mfma_f32_32x32x16_bf16 v[32:47], a[76:79], v[164:167], v[32:47]
    s_waitcnt vmcnt(9)
    v_mfma_f32_32x32x16_bf16 v[16:31], a[80:83], v[168:171], v[16:31]
    v_mfma_f32_32x32x16_bf16 v[32:47], a[84:87], v[168:171], v[32:47]
    s_waitcnt vmcnt(8)
    v_mfma_f32_32x32x16_bf16 v[16:31], a[88:91], v[172:175], v[16:31]
    v_mfma_f32_32x32x16_bf16 v[32:47], a[92:95], v[172:175], v[32:47]
    s_waitcnt vmcnt(7)
    v_mfma_f32_32x32x16_bf16 v[16:31], a[96:99], v[176:179], v[16:31]
    v_mfma_f32_32x32x16_bf16 v[32:47], a[100:103], v[176:179], v[32:47]
    s_waitcnt vmcnt(6)
    v_mfma_f32_32x32x16_bf16 v[16:31], a[104:107], v[180:183], v[16:31]
    v_mfma_f32_32x32x16_bf16 v[32:47], a[108:111], v[180:183], v[32:47]
    s_waitcnt vmcnt(5)
    v_mfma_f32_32x32x16_bf16 v[16:31], a[112:115], v[184:187], v[16:31]
    v_mfma_f32_32x32x16_bf16 v[32:47], a[116:119], v[184:187], v[32:47]
    s_waitcnt vmcnt(4)
    v_mfma_f32_32x32x16_bf16 v[16:31], a[120:123], v[188:191], v[16:31]
    v_mfma_f32_32x32x16_bf16 v[32:47], a[124:127], v[188:191], v[32:47]
    s_waitcnt vmcnt(0)
    v_readfirstlane_b32 s91, v14
    s_add_u32 s23, s38, 1
    s_and_b32 s23, s23, 7
    s_cselect_b32 s23, 16, 17
    s_cmp_eq_u32 s91, s23
    s_cselect_b32 s91, 1, 0
    s_cbranch_scc0 L_WORj
    s_add_u32 s23, s34, 262144
    buffer_load_dwordx4 v[192:195], v68, s[8:11], s23 offen offset:0 sc1
    buffer_load_dwordx4 v[196:199], v68, s[8:11], s23 offen offset:1024 sc1
    buffer_load_dwordx4 v[200:203], v68, s[8:11], s23 offen offset:2048 sc1
    buffer_load_dwordx4 v[204:207], v68, s[8:11], s23 offen offset:3072 sc1
    buffer_load_dwordx4 v[208:211], v69, s[8:11], s23 offen offset:0 sc1
    buffer_load_dwordx4 v[212:215], v69, s[8:11], s23 offen offset:1024 sc1
    buffer_load_dwordx4 v[216:219], v69, s[8:11], s23 offen offset:2048 sc1
    buffer_load_dwordx4 v[220:223], v69, s[8:11], s23 offen offset:3072 sc1
    s_branch L_WORj
L_WORe3:
    s_cmp_lg_u32 s91, 0
    s_cbranch_scc1 L_WORf3
    buffer_load_dwordx4 v[224:227], v70, s[8:11], s34 offen offset:0 sc1
    buffer_load_dwordx4 v[228:231], v70, s[8:11], s34 offen offset:1024 sc1
    buffer_load_dwordx4 v[232:235], v70, s[8:11], s34 offen offset:2048 sc1
    buffer_load_dwordx4 v[236:239], v70, s[8:11], s34 offen offset:3072 sc1
    buffer_load_dwordx4 v[240:243], v71, s[8:11], s34 offen offset:0 sc1
    buffer_load_dwordx4 v[244:247], v71, s[8:11], s34 offen offset:1024 sc1
    buffer_load_dwordx4 v[248:251], v71, s[8:11], s34 offen offset:2048 sc1
    buffer_load_dwordx4 v[252:255], v71, s[8:11], s34 offen offset:3072 sc1
L_WORf3:
    s_waitcnt vmcnt(7)
    v_mfma_f32_32x32x16_bf16 v[16:31], a[192:195], v[224:227], 0
    buffer_load_dwordx4 v[128:131], v64, s[8:11], s34 offen offset:0 sc1
    v_mfma_f32_32x32x16_bf16 v[32:47], a[196:199], v[224:227], 0
    buffer_load_dwordx4 v[132:135], v64, s[8:11], s34 offen offset:1024 sc1
    s_waitcnt vmcnt(8)
    v_mfma_f32_32x32x16_bf16 v[16:31], a[200:203], v[228:231], v[16:31]
    buffer_load_dwordx4 v[136:139], v64, s[8:11], s34 offen offset:2048 sc1
    v_mfma_f32_32x32x16_bf16 v[32:47], a[204:207], v[228:231], v[32:47]
    buffer_load_dwordx4 v[140:143], v64, s[8:11], s34 offen offset:3072 sc1
    s_waitcnt vmcnt(9)
    v_mfma_f32_32x32x16_bf16 v[16:31], a[208:211], v[232:235], v[16:31]
    buffer_load_dwordx4 v[144:147], v65, s[8:11], s34 offen offset:0 sc1
    v_mfma_f32_32x32x16_bf16 v[32:47], a[212:215], v[232:235], v[32:47]
    buffer_load_dwordx4 v[148:151], v65, s[8:11], s34 offen offset:1024 sc1
    s_waitcnt vmcnt(10)
    v_mfma_f32_32x32x16_bf16 v[16:31], a[216:219], v[236:239], v[16:31]
    buffer_load_dwordx4 v[152:155], v65, s[8:11], s34 offen offset:2048 sc1
    v_mfma_f32_32x32x16_bf16 v[32:47], a[220:223], v[236:239], v[32:47]
    buffer_load_dwordx4 v[156:159], v65, s[8:11], s34 offen offset:3072 sc1
    s_waitcnt vmcnt(11)
    v_mfma_f32_32x32x16_bf16 v[16:31], a[224:227], v[240:243], v[16:31]
    buffer_load_dwordx4 v[160:163], v66, s[8:11], s34 offen offset:0 sc1
    v_mfma_f32_32x32x16_bf16 v[32:47], a[228:231], v[240:243], v[32:47]
    buffer_load_dwordx4 v[164:167], v66, s[8:11], s34 offen offset:1024 sc1
    s_waitcnt vmcnt(12)
    v_mfma_f32_32x32x16_bf16 v[16:31], a[232:235], v[244:247], v[16:31]
    buffer_load_dwordx4 v[168:171], v66, s[8:11], s34 offen offset:2048 sc1
    v_mfma_f32_32x32x16_bf16 v[32:47], a[236:239], v[244:247], v[32:47]
    buffer_load_dwordx4 v[172:175], v66, s[8:11], s34 offen offset:3072 sc1
    s_waitcnt vmcnt(13)
    v_mfma_f32_32x32x16_bf16 v[16:31], a[240:243], v[248:251], v[16:31]
    buffer_load_dwordx4 v[176:179], v67, s[8:11], s34 offen offset:0 sc1
    v_mfma_f32_32x32x16_bf16 v[32:47], a[244:247], v[248:251], v[32:47]
    buffer_load_dwordx4 v[180:183], v67, s[8:11], s34 offen offset:1024 sc1
    s_waitcnt vmcnt(14)
    v_mfma_f32_32x32x16_bf16 v[16:31], a[248:251], v[252:255], v[16:31]
    buffer_load_dwordx4 v[184:187], v67, s[8:11], s34 offen offset:2048 sc1
    v_mfma_f32_32x32x16_bf16 v[32:47], a[252:255], v[252:255], v[32:47]
    buffer_load_dwordx4 v[188:191], v67, s[8:11], s34 offen offset:3072 sc1
    s_waitcnt vmcnt(15)
    v_mfma_f32_32x32x16_bf16 v[16:31], a[0:3], v[128:131], v[16:31]
    buffer_load_dwordx4 v[192:195], v68, s[8:11], s34 offen offset:0 sc1
    v_mfma_f32_32x32x16_bf16 v[32:47], a[4:7], v[128:131], v[32:47]
    s_waitcnt vmcnt(15)
    v_mfma_f32_32x32x16_bf16 v[16:31], a[8:11], v[132:135], v[16:31]
    buffer_load_dwordx4 v[196:199], v68, s[8:11], s34 offen offset:1024 sc1
    v_mfma_f32_32x32x16_bf16 v[32:47], a[12:15], v[132:135], v[32:47]
    s_waitcnt vmcnt(15)
    v_mfma_f32_32x32x16_bf16 v[16:31], a[16:19], v[136:139], v[16:31]
    buffer_load_dwordx4 v[200:203], v68, s[8:11], s34 offen offset:2048 sc1
    v_mfma_f32_32x32x16_bf16 v[32:47], a[20:23], v[136:139], v[32:47]
    s_waitcnt vmcnt(15)
    v_mfma_f32_32x32x16_bf16 v[16:31], a[24:27], v[140:143], v[16:31]
    buffer_load_dwordx4 v[204:207], v68, s[8:11], s34 offen offset:3072 sc1
    v_mfma_f32_32x32x16_bf16 v[32:47], a[28:31], v[140:143], v[32:47]
    s_waitcnt vmcnt(15)
    v_mfma_f32_32x32x16_bf16 v[16:31], a[32:35], v[144:147], v[16:31]
    buffer_load_dwordx4 v[208:211], v69, s[8:11], s34 offen offset:0 sc1
    v_mfma_f32_32x32x16_bf16 v[32:47], a[36:39], v[144:147], v[32:47]
    s_waitcnt vmcnt(15)
    v_mfma_f32_32x32x16_bf16 v[16:31], a[40:43], v[148:151], v[16:31]
    buffer_load_dwordx4 v[212:215], v69, s[8:11], s34 offen offset:1024 sc1
    v_mfma_f32_32x32x16_bf16 v[32:47], a[44:47], v[148:151], v[32:47]
    s_waitcnt vmcnt(15)
    v_mfma_f32_32x32x16_bf16 v[16:31], a[48:51], v[152:155], v[16:31]
    buffer_load_dwordx4 v[216:219], v69, s[8:11], s34 offen offset:2048 sc1
    v_mfma_f32_32x32x16_bf16 v[32:47], a[52:55], v[152:155], v[32:47]
    s_waitcnt vmcnt(15)
    v_mfma_f32_32x32x16_bf16 v[16:31], a[56:59], v[156:159], v[16:31]
    buffer_load_dwordx4 v[220:223], v69, s[8:11], s34 offen offset:3072 sc1
    v_mfma_f32_32x32x16_bf16 v[32:47], a[60:63], v[156:159], v[32:47]
    s_waitcnt vmcnt(15)
    v_mfma_f32_32x32x16_bf16 v[16:31], a[64:67], v[160:163], v[16:31]
    buffer_load_dwordx2 v[48:49], v3, s[12:15], s33 offen
    v_mfma_f32_32x32x16_bf16 v[32:47], a[68:71], v[160:163], v[32:47]
    s_waitcnt vmcnt(15)
    v_mfma_f32_32x32x16_bf16 v[16:31], a[72:75], v[164:167], v[16:31]
    buffer_load_dwordx2 v[50:51], v6, s[92:95], s33 offen sc1
    v_mfma_f32_32x32x16_bf16 v[32:47], a[76:79], v[164:167], v[32:47]
    s_waitcnt vmcnt(15)
    v_mfma_f32_32x32x16_bf16 v[16:31], a[80:83], v[168:171], v[16:31]
    buffer_load_dwordx4 v[116:119], v11, s[92:95], s26 offen sc1
    v_mfma_f32_32x32x16_bf16 v[32:47], a[84:87], v[168:171], v[32:47]
    s_waitcnt vmcnt(15)
    v_mfma_f32_32x32x16_bf16 v[16:31], a[88:91], v[172:175], v[16:31]
    buffer_load_dword v14, off, s[92:95], s32 sc1
    v_mfma_f32_32x32x16_bf16 v[32:47], a[92:95], v[172:175], v[32:47]
    s_waitcnt vmcnt(15)
    v_mfma_f32_32x32x16_bf16 v[16:31], a[96:99], v[176:179], v[16:31]
    v_mfma_f32_32x32x16_bf16 v[32:47], a[100:103], v[176:179], v[32:47]
    s_waitcnt vmcnt(14)
    v_mfma_f32_32x32x16_bf16 v[16:31], a[104:107], v[180:183], v[16:31]
    v_mfma_f32_32x32x16_bf16 v[32:47], a[108:111], v[180:183], v[32:47]
    s_waitcnt vmcnt(13)
    v_mfma_f32_32x32x16_bf16 v[16:31], a[112:115], v[184:187], v[16:31]
    v_mfma_f32_32x32x16_bf16 v[32:47], a[116:119], v[184:187], v[32:47]
    s_waitcnt vmcnt(12)
    v_mfma_f32_32x32x16_bf16 v[16:31], a[120:123], v[188:191], v[16:31]
    v_mfma_f32_32x32x16_bf16 v[32:47], a[124:127], v[188:191], v[32:47]
    s_waitcnt vmcnt(11)
    v_mfma_f32_32x32x16_bf16 v[16:31], a[128:131], v[192:195], v[16:31]
    v_mfma_f32_32x32x16_bf16 v[32:47], a[132:135], v[192:195], v[32:47]
    s_waitcnt vmcnt(10)
    v_mfma_f32_32x32x16_bf16 v[16:31], a[136:139], v[196:199], v[16:31]
    v_mfma_f32_32x32x16_bf16 v[32:47], a[140:143], v[196:199], v[32:47]
    s_waitcnt vmcnt(9)
    v_mfma_f32_32x32x16_bf16 v[16:31], a[144:147], v[200:203], v[16:31]
    v_mfma_f32_32x32x16_bf16 v[32:47], a[148:151], v[200:203], v[32:47]
    s_waitcnt vmcnt(8)
    v_mfma_f32_32x32x16_bf16 v[16:31], a[152:155], v[204:207], v[16:31]
    v_mfma_f32_32x32x16_bf16 v[32:47], a[156:159], v[204:207], v[32:47]
    s_waitcnt vmcnt(7)
    v_mfma_f32_32x32x16_bf16 v[16:31], a[160:163], v[208:211], v[16:31]
    v_mfma_f32_32x32x16_bf16 v[32:47], a[164:167], v[208:211], v[32:47]
    s_waitcnt vmcnt(6)
    v_mfma_f32_32x32x16_bf16 v[16:31], a[168:171], v[212:215], v[16:31]
    v_mfma_f32_32x32x16_bf16 v[32:47], a[172:175], v[212:215], v[32:47]
    s_waitcnt vmcnt(5)
    v_mfma_f32_32x32x16_bf16 v[16:31], a[176:179], v[216:219], v[16:31]
    v_mfma_f32_32x32x16_bf16 v[32:47], a[180:183], v[216:219], v[32:47]
    s_waitcnt vmcnt(4)
    v_mfma_f32_32x32x16_bf16 v[16:31], a[184:187], v[220:223], v[16:31]
    v_mfma_f32_32x32x16_bf16 v[32:47], a[188:191], v[220:223], v[32:47]
    s_waitcnt vmcnt(0)
    v_readfirstlane_b32 s91, v14
    s_add_u32 s23, s38, 1
    s_and_b32 s23, s23, 7
    s_cselect_b32 s23, 16, 17
    s_cmp_eq_u32 s91, s23
    s_cselect_b32 s91, 1, 0
    s_cbranch_scc0 L_WORj
    s_add_u32 s23, s34, 262144
    buffer_load_dwordx4 v[224:227], v70, s[8:11], s23 offen offset:0 sc1
    buffer_load_dwordx4 v[228:231], v70, s[8:11], s23 offen offset:1024 sc1
    buffer_load_dwordx4 v[232:235], v70, s[8:11], s23 offen offset:2048 sc1
    buffer_load_dwordx4 v[236:239], v70, s[8:11], s23 offen offset:3072 sc1
    buffer_load_dwordx4 v[240:243], v71, s[8:11], s23 offen offset:0 sc1
    buffer_load_dwordx4 v[244:247], v71, s[8:11], s23 offen offset:1024 sc1
    buffer_load_dwordx4 v[248:251], v71, s[8:11], s23 offen offset:2048 sc1
    buffer_load_dwordx4 v[252:255], v71, s[8:11], s23 offen offset:3072 sc1
L_WORj:
    s_nop 10
    ds_write_b128 v7, v[16:19] offset:0
    ds_write_b128 v7, v[20:23] offset:1024
    ds_write_b128 v7, v[24:27] offset:2048
    ds_write_b128 v7, v[28:31] offset:3072
    ds_write_b128 v7, v[32:35] offset:4096
    ds_write_b128 v7, v[36:39] offset:5120
    ds_write_b128 v7, v[40:43] offset:6144
    ds_write_b128 v7, v[44:47] offset:7168
    s_cmp_lg_u32 s3, 0
    s_cbranch_scc1 Wz_206
    ds_write_b32 v9, v14
Wz_206:
    v_xor_b32 v13, 4096, v8
    s_waitcnt lgkmcnt(0)
    s_barrier
    ds_read_b128 v[96:99], v13 offset:0
    ds_read_b128 v[100:103], v13 offset:8192
    ds_read_b128 v[104:107], v13 offset:16384
    ds_read_b128 v[108:111], v13 offset:24576
    ds_read_b128 v[80:83], v8 offset:0
    ds_read_b128 v[84:87], v8 offset:8192
    ds_read_b128 v[88:91], v8 offset:16384
    ds_read_b128 v[92:95], v8 offset:24576
    ds_read_b32 v14, v9
    v_xor_b32 v7, 32768, v7
    v_xor_b32 v8, 32768, v8
    v_xor_b32 v9, 4, v9
    s_waitcnt lgkmcnt(5)
    v_pk_add_f32 v[96:97], v[96:97], v[100:101]
    v_pk_add_f32 v[104:105], v[104:105], v[108:109]
    v_pk_add_f32 v[98:99], v[98:99], v[102:103]
    v_pk_add_f32 v[106:107], v[106:107], v[110:111]
    v_pk_add_f32 v[96:97], v[96:97], v[104:105]
    v_pk_add_f32 v[98:99], v[98:99], v[106:107]
    s_cmp_eq_u32 s98, 4
    s_cbranch_scc1 We_207
    buffer_store_dwordx4 v[96:99], v10, s[92:95], s26 offen
    s_branch We_208
We_207:
    buffer_store_dwordx4 v[96:99], v10, s[92:95], s26 offen sc1
We_208:
    s_waitcnt lgkmcnt(0)
    v_pk_add_f32 v[80:81], v[80:81], v[84:85]
    v_pk_add_f32 v[88:89], v[88:89], v[92:93]
    v_pk_add_f32 v[82:83], v[82:83], v[86:87]
    v_pk_add_f32 v[90:91], v[90:91], v[94:95]
    v_pk_add_f32 v[80:81], v[80:81], v[88:89]
    v_pk_add_f32 v[82:83], v[82:83], v[90:91]
    v_readfirstlane_b32 s35, v14
    s_cmp_eq_u32 s90, 0
    s_cbranch_scc1 Wn_209
    v_lshlrev_b32 v52, 16, v124
    v_and_b32 v53, 0xffff0000, v124
    v_lshlrev_b32 v54, 16, v125
    v_and_b32 v55, 0xffff0000, v125
    v_lshlrev_b32 v56, 16, v126
    v_and_b32 v57, 0xffff0000, v126
    v_lshlrev_b32 v58, 16, v127
    v_and_b32 v59, 0xffff0000, v127
    s_mov_b32 s30, 0
Wp_210:
    buffer_load_dwordx4 v[108:111], v11, s[92:95], s89 offen sc1
    s_waitcnt vmcnt(0)
    v_max3_u32 v15, v108, v109, v110
    v_max_u32 v15, v15, v111
    v_cmp_eq_u32 vcc, -1, v15
    s_cbranch_vccz Wg_211
    s_add_u32 s30, s30, 1
    s_cmp_lt_u32 s30, 65536
    s_cbranch_scc1 Wp_210
    s_branch L_abort
Wg_211:
    v_pk_add_f32 v[108:109], v[108:109], v[120:121]
    v_pk_add_f32 v[110:111], v[110:111], v[122:123]
    v_cvt_pk_bf16_f32 v112, v108, v109
    v_cvt_pk_bf16_f32 v113, v110, v111
    v_lshlrev_b32 v108, 16, v112
    v_and_b32 v109, 0xffff0000, v112
    v_lshlrev_b32 v110, 16, v113
    v_and_b32 v111, 0xffff0000, v113
    v_pk_add_f32 v[108:109], v[108:109], v[52:53]
    v_pk_add_f32 v[110:111], v[110:111], v[54:55]
    v_cvt_pk_bf16_f32 v112, v108, v109
    v_cvt_pk_bf16_f32 v113, v110, v111
    v_lshlrev_b32 v108, 16, v112
    v_and_b32 v109, 0xffff0000, v112
    v_lshlrev_b32 v110, 16, v113
    v_and_b32 v111, 0xffff0000, v113
    v_pk_add_f32 v[108:109], v[108:109], v[56:57]
    v_pk_add_f32 v[110:111], v[110:111], v[58:59]
    v_cvt_pk_bf16_f32 v112, v108, v109
    v_cvt_pk_bf16_f32 v113, v110, v111
    buffer_store_dwordx2 v[112:113], v3, s[84:87], s88 offen
Wn_209:
    v_mov_b32 v120, v80
    v_mov_b32 v124, v48
    v_mov_b32 v121, v81
    v_mov_b32 v125, v49
    v_mov_b32 v122, v82
    v_mov_b32 v126, v50
    v_mov_b32 v123, v83
    v_mov_b32 v127, v51
    s_mov_b32 s88, s33
    s_mov_b32 s89, s26
    s_mov_b32 s90, 1
    s_add_u32 s38, s38, 1
    s_and_b32 s34, s38, 7
    s_cselect_b32 s34, s35, 0
    s_cmp_eq_u32 s34, 16
    s_cbranch_scc1 L_WORseg
    s_and_b32 s34, s38, 7
    s_cbranch_scc0 Wv_213
    s_cmp_lg_u32 s3, 0
    s_cbranch_scc1 Wv_212
    buffer_load_dword v14, off, s[92:95], s32 sc1
    s_waitcnt vmcnt(0)
    ds_write_b32 v9, v14 offset:8
    s_waitcnt lgkmcnt(0)
Wv_212:
    s_barrier
    ds_read_b32 v14, v9 offset:8
    s_waitcnt lgkmcnt(0)
    v_readfirstlane_b32 s35, v14
    s_nop 3
    s_cmp_eq_u32 s35, 16
    s_cbranch_scc1 L_WORseg
Wv_213:
    v_lshlrev_b32 v52, 16, v124
    v_and_b32 v53, 0xffff0000, v124
    v_lshlrev_b32 v54, 16, v125
    v_and_b32 v55, 0xffff0000, v125
    v_lshlrev_b32 v56, 16, v126
    v_and_b32 v57, 0xffff0000, v126
    v_lshlrev_b32 v58, 16, v127
    v_and_b32 v59, 0xffff0000, v127
    s_mov_b32 s30, 0
    s_sleep 1
Wp_214:
    buffer_load_dwordx4 v[108:111], v11, s[92:95], s89 offen sc1
    s_waitcnt vmcnt(0)
    v_max3_u32 v15, v108, v109, v110
    v_max_u32 v15, v15, v111
    v_cmp_eq_u32 vcc, -1, v15
    s_cbranch_vccz Wg_215
    s_add_u32 s30, s30, 1
    s_cmp_lt_u32 s30, 65536
    s_cbranch_scc1 Wp_214
    s_branch L_abort
Wg_215:
    v_pk_add_f32 v[108:109], v[108:109], v[120:121]
    v_pk_add_f32 v[110:111], v[110:111], v[122:123]
    v_cvt_pk_bf16_f32 v112, v108, v109
    v_cvt_pk_bf16_f32 v113, v110, v111
    v_lshlrev_b32 v108, 16, v112
    v_and_b32 v109, 0xffff0000, v112
    v_lshlrev_b32 v110, 16, v113
    v_and_b32 v111, 0xffff0000, v113
    v_pk_add_f32 v[108:109], v[108:109], v[52:53]
    v_pk_add_f32 v[110:111], v[110:111], v[54:55]
    v_cvt_pk_bf16_f32 v112, v108, v109
    v_cvt_pk_bf16_f32 v113, v110, v111
    v_lshlrev_b32 v108, 16, v112
    v_and_b32 v109, 0xffff0000, v112
    v_lshlrev_b32 v110, 16, v113
    v_and_b32 v111, 0xffff0000, v113
    v_pk_add_f32 v[108:109], v[108:109], v[56:57]
    v_pk_add_f32 v[110:111], v[110:111], v[58:59]
    v_cvt_pk_bf16_f32 v112, v108, v109
    v_cvt_pk_bf16_f32 v113, v110, v111
    buffer_store_dwordx2 v[112:113], v3, s[84:87], s88 offen
    s_mov_b32 s90, 0
    s_cmp_lt_u32 s38, 64
    s_cbranch_scc1 L_WORseg
    s_branch L_next
L_qa:
    s_call_b64 s[4:5], L_epi
    s_cmp_eq_u32 s69, 0
    s_cbranch_scc1 Fl_216
    s_waitcnt vmcnt(0)
    s_barrier
    s_cmp_lg_u32 s3, 0
    s_cbranch_scc1 Fin_218
    v_mov_b32 v4, s69
    s_mov_b64 exec, 1
    buffer_atomic_add v4, off, s[92:95], s68 sc1
    s_mov_b64 exec, -1
Fin_218:
    s_mov_b32 s69, 0
Fl_216:
    s_sub_u32 s20, s99, 0x1000
    s_cmp_ge_u32 s20, 352
    s_cbranch_scc1 L_abort
    s_cmp_ge_u32 s20, 32
    s_cbranch_scc1 Px_219
    v_mov_b32 v4, -1
    v_mov_b32 v5, -1
    v_mov_b32 v6, -1
    v_mov_b32 v7, -1
    v_lshlrev_b32 v3, 4, v1
    s_lshl_b32 s21, s20, 16
    s_lshl_b32 s22, s3, 14
    s_add_u32 s21, s21, s22
    s_add_u32 s21, s21, 109051904
    buffer_store_dwordx4 v[4:7], v3, s[92:95], s21 offen offset:0 sc1
    buffer_store_dwordx4 v[4:7], v3, s[92:95], s21 offen offset:1024 sc1
    buffer_store_dwordx4 v[4:7], v3, s[92:95], s21 offen offset:2048 sc1
    buffer_store_dwordx4 v[4:7], v3, s[92:95], s21 offen offset:3072 sc1
    s_add_u32 s21, s21, 4096
    buffer_store_dwordx4 v[4:7], v3, s[92:95], s21 offen offset:0 sc1
    buffer_store_dwordx4 v[4:7], v3, s[92:95], s21 offen offset:1024 sc1
    buffer_store_dwordx4 v[4:7], v3, s[92:95], s21 offen offset:2048 sc1
    buffer_store_dwordx4 v[4:7], v3, s[92:95], s21 offen offset:3072 sc1
    s_add_u32 s21, s21, 4096
    buffer_store_dwordx4 v[4:7], v3, s[92:95], s21 offen offset:0 sc1
    buffer_store_dwordx4 v[4:7], v3, s[92:95], s21 offen offset:1024 sc1
    buffer_store_dwordx4 v[4:7], v3, s[92:95], s21 offen offset:2048 sc1
    buffer_store_dwordx4 v[4:7], v3, s[92:95], s21 offen offset:3072 sc1
    s_add_u32 s21, s21, 4096
    buffer_store_dwordx4 v[4:7], v3, s[92:95], s21 offen offset:0 sc1
    buffer_store_dwordx4 v[4:7], v3, s[92:95], s21 offen offset:1024 sc1
    buffer_store_dwordx4 v[4:7], v3, s[92:95], s21 offen offset:2048 sc1
    buffer_store_dwordx4 v[4:7], v3, s[92:95], s21 offen offset:3072 sc1
    s_add_u32 s21, s21, 4096
    s_mov_b32 s36, 113252864
    s_waitcnt vmcnt(0)
    s_barrier
    s_cmp_lg_u32 s3, 0
    s_cbranch_scc1 Fin_220
    v_mov_b32 v4, 1
    s_mov_b64 exec, 1
    buffer_atomic_add v4, off, s[92:95], s36 sc1
    s_mov_b64 exec, -1
Fin_220:
    s_mov_b32 m0, 160768
    s_lshl_b32 s21, s20, 2
    s_add_u32 s21, s21, s3
    s_branch L_next
Px_219:
    s_sub_u32 s20, s20, 32
    s_cmp_ge_u32 s20, 192
    s_cbranch_scc1 L_AT4
    s_branch L_AT8
L_A8:
    s_call_b64 s[4:5], L_epi
    s_cmp_eq_u32 s69, 0
    s_cbranch_scc1 Fl_221
    s_waitcnt vmcnt(0)
    s_barrier
    s_cmp_lg_u32 s3, 0
    s_cbranch_scc1 Fin_223
    v_mov_b32 v4, s69
    s_mov_b64 exec, 1
    buffer_atomic_add v4, off, s[92:95], s68 sc1
    s_mov_b64 exec, -1
Fin_223:
    s_mov_b32 s69, 0
Fl_221:
    s_mov_b32 s20, s36
L_AT8:
    s_lshr_b32 s38, s20, 2
    s_and_b32 s37, s20, 3
    s_lshr_b32 s36, s20, 4
    s_lshl_b32 s36, s36, 7
    s_add_u32 s36, s36, 113248640
    s_lshr_b32 s32, s38, 3
    s_lshl_b32 s32, s32, 10
    s_lshr_b32 s34, s37, 0
    s_lshl_b32 s33, s34, 8
    s_add_u32 s32, s32, s33
    s_add_u32 s32, s32, 113262592
    s_cmp_lg_u32 s3, 0
    s_cbranch_scc1 Wf_224
    v_and_b32 v5, 3, v1
    v_lshlrev_b32 v5, 6, v5
    s_mov_b32 s30, 0
    s_mov_b32 s21, 0x40404
Wp_225:
    buffer_load_dword v4, v5, s[92:95], s32 offen sc1
    s_waitcnt vmcnt(0)
    v_and_b32 v4, 0xffffff, v4
    v_cmp_ne_u32 vcc, s21, v4
    s_cbranch_vccz Wf_224
    s_sleep 8
    s_add_u32 s30, s30, 1
    s_cmp_lt_u32 s30, 65536
    s_cbranch_scc1 Wp_225
    s_branch L_abort
Wf_224:
    s_barrier
    s_lshl_b32 s32, s38, 2
    s_add_u32 s32, s32, s34
    s_lshl_b32 s32, s32, 7
    s_add_u32 s32, s32, 113278976
    v_lshlrev_b32 v2, 4, v1
    v_add_u32 v3, 4096, v2
    v_bfe_u32 v10, v1, 4, 1
    v_lshrrev_b32 v9, 5, v1
    v_lshlrev_b32 v9, 7, v9
    v_and_b32 v11, 3, v1
    v_lshl_add_u32 v9, v11, 5, v9
    v_lshl_add_u32 v9, v10, 4, v9
    v_bfe_u32 v11, v1, 2, 2
    s_mov_b32 s21, 33280
    v_mul_lo_u32 v8, v11, s21
    v_add_u32 v8, v8, v9
    v_lshrrev_b32 v9, 4, v1
    v_and_b32 v11, 7, v1
    v_lshlrev_b32 v11, 4, v11
    v_lshl_add_u32 v4, v9, 7, v11
    v_and_b32 v11, 15, v1
    v_lshlrev_b32 v7, 4, v11
    v_lshl_add_u32 v7, v10, 3, v7
    v_lshrrev_b32 v10, 4, v1
    v_lshlrev_b32 v10, 2, v10
    v_add_u32 v9, 0, v10
    v_cmp_gt_u32 s[72:73], v9, v11
    v_add_u32 v9, 1, v10
    v_cmp_gt_u32 s[74:75], v9, v11
    v_add_u32 v9, 2, v10
    v_cmp_gt_u32 s[76:77], v9, v11
    v_add_u32 v9, 3, v10
    v_cmp_gt_u32 s[78:79], v9, v11
    s_mov_b32 s80, 0
    s_mov_b32 s81, -1
    v_mov_b32 v12, 0xce6e6b28
    v_mov_b32 v13, 0
    s_mul_i32 s25, s37, 8
    s_mul_i32 s26, s3, 2
    s_add_u32 s25, s25, s26
    s_lshl_b32 s26, s38, 5
    s_add_u32 s26, s26, s25
    s_add_u32 s27, s26, 1
    s_lshl_b32 s21, s26, 13
    s_add_u32 s22, s21, 22020096
    s_add_u32 s23, s21, 38797312
    s_add_u32 s21, s21, 5242880
    buffer_load_dwordx4 a[0:3], v2, s[92:95], s21 offen offset:0 sc1
    buffer_load_dwordx4 a[32:35], v2, s[92:95], s22 offen offset:0 sc1
    buffer_load_dwordx4 a[16:19], v3, s[92:95], s21 offen offset:0 sc1
    buffer_load_dwordx4 a[48:51], v3, s[92:95], s22 offen offset:0 sc1
    buffer_load_dwordx4 a[4:7], v2, s[92:95], s21 offen offset:1024 sc1
    buffer_load_dwordx4 a[36:39], v2, s[92:95], s22 offen offset:1024 sc1
    buffer_load_dwordx4 a[20:23], v3, s[92:95], s21 offen offset:1024 sc1
    buffer_load_dwordx4 a[52:55], v3, s[92:95], s22 offen offset:1024 sc1
    buffer_load_dwordx4 a[8:11], v2, s[92:95], s21 offen offset:2048 sc1
    buffer_load_dwordx4 a[40:43], v2, s[92:95], s22 offen offset:2048 sc1
    buffer_load_dwordx4 a[24:27], v3, s[92:95], s21 offen offset:2048 sc1
    buffer_load_dwordx4 a[56:59], v3, s[92:95], s22 offen offset:2048 sc1
    buffer_load_dwordx4 a[12:15], v2, s[92:95], s21 offen offset:3072 sc1
    buffer_load_dwordx4 a[44:47], v2, s[92:95], s22 offen offset:3072 sc1
    buffer_load_dwordx4 a[28:31], v3, s[92:95], s21 offen offset:3072 sc1
    buffer_load_dwordx4 a[60:63], v3, s[92:95], s22 offen offset:3072 sc1
    buffer_load_dwordx4 a[80:83], v2, s[92:95], s23 offen offset:0 sc1
    buffer_load_dwordx4 a[84:87], v2, s[92:95], s23 offen offset:1024 sc1
    buffer_load_dwordx4 a[88:91], v2, s[92:95], s23 offen offset:2048 sc1
    buffer_load_dwordx4 a[92:95], v2, s[92:95], s23 offen offset:3072 sc1
    buffer_load_dwordx4 a[96:99], v3, s[92:95], s23 offen offset:0 sc1
    buffer_load_dwordx4 a[100:103], v3, s[92:95], s23 offen offset:1024 sc1
    buffer_load_dwordx4 a[104:107], v3, s[92:95], s23 offen offset:2048 sc1
    buffer_load_dwordx4 a[108:111], v3, s[92:95], s23 offen offset:3072 sc1
    s_lshl_b32 s21, s27, 13
    s_add_u32 s22, s21, 22020096
    s_add_u32 s23, s21, 38797312
    s_add_u32 s21, s21, 5242880
    buffer_load_dwordx4 a[128:131], v2, s[92:95], s21 offen offset:0 sc1
    buffer_load_dwordx4 a[160:163], v2, s[92:95], s22 offen offset:0 sc1
    buffer_load_dwordx4 a[144:147], v3, s[92:95], s21 offen offset:0 sc1
    buffer_load_dwordx4 a[176:179], v3, s[92:95], s22 offen offset:0 sc1
    buffer_load_dwordx4 a[132:135], v2, s[92:95], s21 offen offset:1024 sc1
    buffer_load_dwordx4 a[164:167], v2, s[92:95], s22 offen offset:1024 sc1
    buffer_load_dwordx4 a[148:151], v3, s[92:95], s21 offen offset:1024 sc1
    buffer_load_dwordx4 a[180:183], v3, s[92:95], s22 offen offset:1024 sc1
    buffer_load_dwordx4 a[136:139], v2, s[92:95], s21 offen offset:2048 sc1
    buffer_load_dwordx4 a[168:171], v2, s[92:95], s22 offen offset:2048 sc1
    buffer_load_dwordx4 a[152:155], v3, s[92:95], s21 offen offset:2048 sc1
    buffer_load_dwordx4 a[184:187], v3, s[92:95], s22 offen offset:2048 sc1
    buffer_load_dwordx4 a[140:143], v2, s[92:95], s21 offen offset:3072 sc1
    buffer_load_dwordx4 a[172:175], v2, s[92:95], s22 offen offset:3072 sc1
    buffer_load_dwordx4 a[156:159], v3, s[92:95], s21 offen offset:3072 sc1
    buffer_load_dwordx4 a[188:191], v3, s[92:95], s22 offen offset:3072 sc1
    buffer_load_dwordx4 a[208:211], v2, s[92:95], s23 offen offset:0 sc1
    buffer_load_dwordx4 a[212:215], v2, s[92:95], s23 offen offset:1024 sc1
    buffer_load_dwordx4 a[216:219], v2, s[92:95], s23 offen offset:2048 sc1
    buffer_load_dwordx4 a[220:223], v2, s[92:95], s23 offen offset:3072 sc1
    buffer_load_dwordx4 a[224:227], v3, s[92:95], s23 offen offset:0 sc1
    buffer_load_dwordx4 a[228:231], v3, s[92:95], s23 offen offset:1024 sc1
    buffer_load_dwordx4 a[232:235], v3, s[92:95], s23 offen offset:2048 sc1
    buffer_load_dwordx4 a[236:239], v3, s[92:95], s23 offen offset:3072 sc1
    s_cmp_lg_u32 s3, 0
    s_cbranch_scc1 Wf_226
    v_mov_b32 v15, 0
    s_mov_b32 s30, 0
    s_mov_b32 s21, 0x30
Wp_227:
    buffer_load_dword v14, v15, s[92:95], s32 offen sc1
    s_waitcnt vmcnt(0)
    v_cmp_ne_u32 vcc, s21, v14
    s_cbranch_vccz Wf_226
    s_sleep 2
    s_add_u32 s30, s30, 1
    s_cmp_lt_u32 s30, 65536
    s_cbranch_scc1 Wp_227
    s_branch L_abort
Wf_226:
    s_barrier
    s_lshl_b32 s24, s26, 12
    s_add_u32 s24, s24, 94371840
    buffer_load_dwordx4 a[64:67], v4, s[92:95], s24 offen offset:0 sc1
    buffer_load_dwordx4 a[68:71], v4, s[92:95], s24 offen offset:512 sc1
    buffer_load_dwordx4 a[72:75], v4, s[92:95], s24 offen offset:1024 sc1
    buffer_load_dwordx4 a[76:79], v4, s[92:95], s24 offen offset:1536 sc1
    buffer_load_dwordx2 a[112:113], v7, s[92:95], s24 offen offset:2048 sc1
    buffer_load_dwordx2 a[114:115], v7, s[92:95], s24 offen offset:2304 sc1
    buffer_load_dwordx2 a[116:117], v7, s[92:95], s24 offen offset:2560 sc1
    buffer_load_dwordx2 a[118:119], v7, s[92:95], s24 offen offset:2816 sc1
    buffer_load_dwordx2 a[120:121], v7, s[92:95], s24 offen offset:3072 sc1
    buffer_load_dwordx2 a[122:123], v7, s[92:95], s24 offen offset:3328 sc1
    buffer_load_dwordx2 a[124:125], v7, s[92:95], s24 offen offset:3584 sc1
    buffer_load_dwordx2 a[126:127], v7, s[92:95], s24 offen offset:3840 sc1
    s_lshl_b32 s24, s27, 12
    s_add_u32 s24, s24, 94371840
    buffer_load_dwordx4 a[192:195], v4, s[92:95], s24 offen offset:0 sc1
    buffer_load_dwordx4 a[196:199], v4, s[92:95], s24 offen offset:512 sc1
    buffer_load_dwordx4 a[200:203], v4, s[92:95], s24 offen offset:1024 sc1
    buffer_load_dwordx4 a[204:207], v4, s[92:95], s24 offen offset:1536 sc1
    buffer_load_dwordx2 a[240:241], v7, s[92:95], s24 offen offset:2048 sc1
    buffer_load_dwordx2 a[242:243], v7, s[92:95], s24 offen offset:2304 sc1
    buffer_load_dwordx2 a[244:245], v7, s[92:95], s24 offen offset:2560 sc1
    buffer_load_dwordx2 a[246:247], v7, s[92:95], s24 offen offset:2816 sc1
    buffer_load_dwordx2 a[248:249], v7, s[92:95], s24 offen offset:3072 sc1
    buffer_load_dwordx2 a[250:251], v7, s[92:95], s24 offen offset:3328 sc1
    buffer_load_dwordx2 a[252:253], v7, s[92:95], s24 offen offset:3584 sc1
    buffer_load_dwordx2 a[254:255], v7, s[92:95], s24 offen offset:3840 sc1
    s_waitcnt vmcnt(20)
    v_mfma_f32_16x16x32_bf16 v[64:67], a[32:35], a[0:3], 0
    v_mfma_f32_16x16x32_bf16 v[72:75], a[32:35], a[16:19], 0
    v_mfma_f32_16x16x32_bf16 v[76:79], a[48:51], a[16:19], 0
    v_mfma_f32_16x16x32_bf16 v[68:71], a[64:67], a[0:3], 0
    v_mfma_f32_16x16x32_bf16 v[80:83], a[64:67], a[16:19], 0
    v_mfma_f32_16x16x32_bf16 v[64:67], a[36:39], a[4:7], v[64:67]
    v_mfma_f32_16x16x32_bf16 v[72:75], a[36:39], a[20:23], v[72:75]
    v_mfma_f32_16x16x32_bf16 v[76:79], a[52:55], a[20:23], v[76:79]
    v_mfma_f32_16x16x32_bf16 v[68:71], a[68:71], a[4:7], v[68:71]
    v_mfma_f32_16x16x32_bf16 v[80:83], a[68:71], a[20:23], v[80:83]
    v_mfma_f32_16x16x32_bf16 v[64:67], a[40:43], a[8:11], v[64:67]
    v_mfma_f32_16x16x32_bf16 v[72:75], a[40:43], a[24:27], v[72:75]
    v_mfma_f32_16x16x32_bf16 v[76:79], a[56:59], a[24:27], v[76:79]
    v_mfma_f32_16x16x32_bf16 v[68:71], a[72:75], a[8:11], v[68:71]
    v_mfma_f32_16x16x32_bf16 v[80:83], a[72:75], a[24:27], v[80:83]
    v_mfma_f32_16x16x32_bf16 v[64:67], a[44:47], a[12:15], v[64:67]
    v_mfma_f32_16x16x32_bf16 v[72:75], a[44:47], a[28:31], v[72:75]
    v_mfma_f32_16x16x32_bf16 v[76:79], a[60:63], a[28:31], v[76:79]
    v_mfma_f32_16x16x32_bf16 v[68:71], a[76:79], a[12:15], v[68:71]
    v_mfma_f32_16x16x32_bf16 v[80:83], a[76:79], a[28:31], v[80:83]
    s_mov_b32 s21, 0x3db504f3
    s_mov_b32 s22, 0x3fb8aa3b
    s_nop 3
    v_cvt_pk_bf16_f32 v84, v64, v65
    v_cvt_pk_bf16_f32 v85, v66, v67
    v_cvt_pk_bf16_f32 v86, v68, v69
    v_cvt_pk_bf16_f32 v87, v70, v71
    v_cvt_pk_bf16_f32 v88, v72, v73
    v_cvt_pk_bf16_f32 v89, v74, v75
    v_cvt_pk_bf16_f32 v90, v76, v77
    v_cvt_pk_bf16_f32 v91, v78, v79
    v_cvt_pk_bf16_f32 v92, v80, v81
    v_cvt_pk_bf16_f32 v93, v82, v83
    v_lshlrev_b32 v64, 16, v84
    v_and_b32 v65, 0xffff0000, v84
    v_lshlrev_b32 v66, 16, v85
    v_and_b32 v67, 0xffff0000, v85
    v_lshlrev_b32 v68, 16, v86
    v_and_b32 v69, 0xffff0000, v86
    v_lshlrev_b32 v70, 16, v87
    v_and_b32 v71, 0xffff0000, v87
    v_lshlrev_b32 v72, 16, v88
    v_and_b32 v73, 0xffff0000, v88
    v_lshlrev_b32 v74, 16, v89
    v_and_b32 v75, 0xffff0000, v89
    v_lshlrev_b32 v76, 16, v90
    v_and_b32 v77, 0xffff0000, v90
    v_lshlrev_b32 v78, 16, v91
    v_and_b32 v79, 0xffff0000, v91
    v_lshlrev_b32 v80, 16, v92
    v_and_b32 v81, 0xffff0000, v92
    v_lshlrev_b32 v82, 16, v93
    v_and_b32 v83, 0xffff0000, v93
    v_mul_f32 v64, s21, v64
    v_mul_f32 v65, s21, v65
    v_mul_f32 v66, s21, v66
    v_mul_f32 v67, s21, v67
    v_mul_f32 v68, s21, v68
    v_mul_f32 v69, s21, v69
    v_mul_f32 v70, s21, v70
    v_mul_f32 v71, s21, v71
    v_mul_f32 v72, s21, v72
    v_mul_f32 v73, s21, v73
    v_mul_f32 v74, s21, v74
    v_mul_f32 v75, s21, v75
    v_mul_f32 v76, s21, v76
    v_mul_f32 v77, s21, v77
    v_mul_f32 v78, s21, v78
    v_mul_f32 v79, s21, v79
    v_mul_f32 v80, s21, v80
    v_mul_f32 v81, s21, v81
    v_mul_f32 v82, s21, v82
    v_mul_f32 v83, s21, v83
    v_cvt_pk_bf16_f32 v84, v64, v65
    v_cvt_pk_bf16_f32 v85, v66, v67
    v_cvt_pk_bf16_f32 v86, v68, v69
    v_cvt_pk_bf16_f32 v87, v70, v71
    v_cvt_pk_bf16_f32 v88, v72, v73
    v_cvt_pk_bf16_f32 v89, v74, v75
    v_cvt_pk_bf16_f32 v90, v76, v77
    v_cvt_pk_bf16_f32 v91, v78, v79
    v_cvt_pk_bf16_f32 v92, v80, v81
    v_cvt_pk_bf16_f32 v93, v82, v83
    v_lshlrev_b32 v64, 16, v84
    v_and_b32 v65, 0xffff0000, v84
    v_lshlrev_b32 v66, 16, v85
    v_and_b32 v67, 0xffff0000, v85
    v_lshlrev_b32 v68, 16, v86
    v_and_b32 v69, 0xffff0000, v86
    v_lshlrev_b32 v70, 16, v87
    v_and_b32 v71, 0xffff0000, v87
    v_lshlrev_b32 v72, 16, v88
    v_and_b32 v73, 0xffff0000, v88
    v_lshlrev_b32 v74, 16, v89
    v_and_b32 v75, 0xffff0000, v89
    v_lshlrev_b32 v76, 16, v90
    v_and_b32 v77, 0xffff0000, v90
    v_lshlrev_b32 v78, 16, v91
    v_and_b32 v79, 0xffff0000, v91
    v_lshlrev_b32 v80, 16, v92
    v_and_b32 v81, 0xffff0000, v92
    v_lshlrev_b32 v82, 16, v93
    v_and_b32 v83, 0xffff0000, v93
    v_cndmask_b32 v64, v64, v12, s[72:73]
    v_cndmask_b32 v76, v76, v12, s[72:73]
    v_cndmask_b32 v68, v68, v12, s[80:81]
    v_cndmask_b32 v80, v80, v12, s[80:81]
    v_cndmask_b32 v65, v65, v12, s[74:75]
    v_cndmask_b32 v77, v77, v12, s[74:75]
    v_cndmask_b32 v69, v69, v12, s[80:81]
    v_cndmask_b32 v81, v81, v12, s[80:81]
    v_cndmask_b32 v66, v66, v12, s[76:77]
    v_cndmask_b32 v78, v78, v12, s[76:77]
    v_cndmask_b32 v70, v70, v12, s[80:81]
    v_cndmask_b32 v82, v82, v12, s[80:81]
    v_cndmask_b32 v67, v67, v12, s[78:79]
    v_cndmask_b32 v79, v79, v12, s[78:79]
    v_cndmask_b32 v71, v71, v12, s[80:81]
    v_cndmask_b32 v83, v83, v12, s[80:81]
    v_max3_f32 v96, v64, v65, v66
    v_max3_f32 v96, v96, v67, v68
    v_max3_f32 v96, v96, v69, v70
    v_max_f32 v96, v96, v71
    v_max3_f32 v97, v72, v73, v74
    v_max3_f32 v97, v97, v75, v76
    v_max3_f32 v97, v97, v77, v78
    v_max3_f32 v97, v97, v79, v80
    v_max3_f32 v97, v97, v81, v82
    v_max_f32 v97, v97, v83
    v_mov_b32 v98, v96
    v_mov_b32 v99, v97
    s_nop 0
    v_permlane16_swap_b32 v96, v98
    v_permlane16_swap_b32 v97, v99
    v_max_f32 v96, v96, v98
    v_max_f32 v97, v97, v99
    v_mov_b32 v98, v96
    v_mov_b32 v99, v97
    s_nop 0
    v_permlane32_swap_b32 v96, v98
    v_permlane32_swap_b32 v97, v99
    v_max_f32 v96, v96, v98
    v_max_f32 v97, v97, v99
    v_sub_f32 v64, v64, v96
    v_sub_f32 v65, v65, v96
    v_sub_f32 v66, v66, v96
    v_sub_f32 v67, v67, v96
    v_sub_f32 v68, v68, v96
    v_sub_f32 v69, v69, v96
    v_sub_f32 v70, v70, v96
    v_sub_f32 v71, v71, v96
    v_sub_f32 v72, v72, v97
    v_sub_f32 v73, v73, v97
    v_sub_f32 v74, v74, v97
    v_sub_f32 v75, v75, v97
    v_sub_f32 v76, v76, v97
    v_sub_f32 v77, v77, v97
    v_sub_f32 v78, v78, v97
    v_sub_f32 v79, v79, v97
    v_sub_f32 v80, v80, v97
    v_sub_f32 v81, v81, v97
    v_sub_f32 v82, v82, v97
    v_sub_f32 v83, v83, v97
    v_mul_f32 v64, s22, v64
    v_mul_f32 v65, s22, v65
    v_mul_f32 v66, s22, v66
    v_mul_f32 v67, s22, v67
    v_mul_f32 v68, s22, v68
    v_mul_f32 v69, s22, v69
    v_mul_f32 v70, s22, v70
    v_mul_f32 v71, s22, v71
    v_mul_f32 v72, s22, v72
    v_mul_f32 v73, s22, v73
    v_mul_f32 v74, s22, v74
    v_mul_f32 v75, s22, v75
    v_mul_f32 v76, s22, v76
    v_mul_f32 v77, s22, v77
    v_mul_f32 v78, s22, v78
    v_mul_f32 v79, s22, v79
    v_mul_f32 v80, s22, v80
    v_mul_f32 v81, s22, v81
    v_mul_f32 v82, s22, v82
    v_mul_f32 v83, s22, v83
    v_exp_f32 v64, v64
    v_exp_f32 v65, v65
    v_exp_f32 v66, v66
    v_exp_f32 v67, v67
    v_exp_f32 v68, v68
    v_exp_f32 v69, v69
    v_exp_f32 v70, v70
    v_exp_f32 v71, v71
    v_exp_f32 v72, v72
    v_exp_f32 v73, v73
    v_exp_f32 v74, v74
    v_exp_f32 v75, v75
    v_exp_f32 v76, v76
    v_exp_f32 v77, v77
    v_exp_f32 v78, v78
    v_exp_f32 v79, v79
    v_exp_f32 v80, v80
    v_exp_f32 v81, v81
    v_exp_f32 v82, v82
    v_exp_f32 v83, v83
    s_nop 0
    v_add_f32 v96, v64, v65
    v_add_f32 v96, v96, v66
    v_add_f32 v96, v96, v67
    v_add_f32 v96, v96, v68
    v_add_f32 v96, v96, v69
    v_add_f32 v96, v96, v70
    v_add_f32 v96, v96, v71
    v_add_f32 v97, v72, v73
    v_add_f32 v97, v97, v74
    v_add_f32 v97, v97, v75
    v_add_f32 v97, v97, v76
    v_add_f32 v97, v97, v77
    v_add_f32 v97, v97, v78
    v_add_f32 v97, v97, v79
    v_add_f32 v97, v97, v80
    v_add_f32 v97, v97, v81
    v_add_f32 v97, v97, v82
    v_add_f32 v97, v97, v83
    v_mov_b32 v98, v96
    v_mov_b32 v99, v97
    s_nop 0
    v_permlane16_swap_b32 v96, v98
    v_permlane16_swap_b32 v97, v99
    v_add_f32 v96, v96, v98
    v_add_f32 v97, v97, v99
    v_mov_b32 v98, v96
    v_mov_b32 v99, v97
    s_nop 0
    v_permlane32_swap_b32 v96, v98
    v_permlane32_swap_b32 v97, v99
    v_add_f32 v96, v96, v98
    v_add_f32 v97, v97, v99
    v_rcp_f32 v96, v96
    v_rcp_f32 v97, v97
    s_nop 0
    v_mul_f32 v64, v64, v96
    v_mul_f32 v65, v65, v96
    v_mul_f32 v66, v66, v96
    v_mul_f32 v67, v67, v96
    v_mul_f32 v68, v68, v96
    v_mul_f32 v69, v69, v96
    v_mul_f32 v70, v70, v96
    v_mul_f32 v71, v71, v96
    v_mul_f32 v72, v72, v97
    v_mul_f32 v73, v73, v97
    v_mul_f32 v74, v74, v97
    v_mul_f32 v75, v75, v97
    v_mul_f32 v76, v76, v97
    v_mul_f32 v77, v77, v97
    v_mul_f32 v78, v78, v97
    v_mul_f32 v79, v79, v97
    v_mul_f32 v80, v80, v97
    v_mul_f32 v81, v81, v97
    v_mul_f32 v82, v82, v97
    v_mul_f32 v83, v83, v97
    v_cvt_pk_bf16_f32 v84, v64, v65
    v_cvt_pk_bf16_f32 v85, v66, v67
    v_mov_b32 v86, 0
    v_mov_b32 v87, 0
    v_cvt_pk_bf16_f32 v88, v72, v73
    v_cvt_pk_bf16_f32 v89, v74, v75
    v_cvt_pk_bf16_f32 v90, v76, v77
    v_cvt_pk_bf16_f32 v91, v78, v79
    v_cvt_pk_bf16_f32 v92, v68, v69
    v_cvt_pk_bf16_f32 v93, v70, v71
    v_cvt_pk_bf16_f32 v94, v80, v81
    v_cvt_pk_bf16_f32 v95, v82, v83
    s_waitcnt vmcnt(12)
    s_mul_i32 s21, s38, 266240
    s_lshl_b32 s22, s25, 10
    s_add_u32 s21, s21, s22
    s_add_u32 s21, s21, 71303168
    s_add_u32 s22, s21, 133120
    v_mfma_f32_16x16x32_bf16 v[128:131], a[80:83], v[84:87], 0
    v_mfma_f32_16x16x32_bf16 v[132:135], a[84:87], v[84:87], 0
    v_mfma_f32_16x16x32_bf16 v[136:139], a[88:91], v[84:87], 0
    v_mfma_f32_16x16x32_bf16 v[140:143], a[92:95], v[84:87], 0
    v_mfma_f32_16x16x32_bf16 v[144:147], a[96:99], v[84:87], 0
    v_mfma_f32_16x16x32_bf16 v[148:151], a[100:103], v[84:87], 0
    v_mfma_f32_16x16x32_bf16 v[152:155], a[104:107], v[84:87], 0
    v_mfma_f32_16x16x32_bf16 v[156:159], a[108:111], v[84:87], 0
    v_mfma_f32_16x16x32_bf16 v[160:163], a[80:83], v[88:91], 0
    v_mfma_f32_16x16x32_bf16 v[164:167], a[84:87], v[88:91], 0
    v_mfma_f32_16x16x32_bf16 v[168:171], a[88:91], v[88:91], 0
    v_mfma_f32_16x16x32_bf16 v[172:175], a[92:95], v[88:91], 0
    v_mfma_f32_16x16x32_bf16 v[176:179], a[96:99], v[88:91], 0
    v_mfma_f32_16x16x32_bf16 v[180:183], a[100:103], v[88:91], 0
    v_mfma_f32_16x16x32_bf16 v[184:187], a[104:107], v[88:91], 0
    v_mfma_f32_16x16x32_bf16 v[188:191], a[108:111], v[88:91], 0
    v_mfma_f32_16x16x16_bf16 v[128:131], a[112:113], v[92:93], v[128:131]
    v_mfma_f32_16x16x16_bf16 v[132:135], a[114:115], v[92:93], v[132:135]
    v_mfma_f32_16x16x16_bf16 v[136:139], a[116:117], v[92:93], v[136:139]
    v_mfma_f32_16x16x16_bf16 v[140:143], a[118:119], v[92:93], v[140:143]
    v_mfma_f32_16x16x16_bf16 v[144:147], a[120:121], v[92:93], v[144:147]
    v_mfma_f32_16x16x16_bf16 v[148:151], a[122:123], v[92:93], v[148:151]
    v_mfma_f32_16x16x16_bf16 v[152:155], a[124:125], v[92:93], v[152:155]
    v_mfma_f32_16x16x16_bf16 v[156:159], a[126:127], v[92:93], v[156:159]
    v_mfma_f32_16x16x16_bf16 v[160:163], a[112:113], v[94:95], v[160:163]
    v_mfma_f32_16x16x16_bf16 v[164:167], a[114:115], v[94:95], v[164:167]
    v_mfma_f32_16x16x16_bf16 v[168:171], a[116:117], v[94:95], v[168:171]
    v_mfma_f32_16x16x16_bf16 v[172:175], a[118:119], v[94:95], v[172:175]
    v_mfma_f32_16x16x16_bf16 v[176:179], a[120:121], v[94:95], v[176:179]
    v_mfma_f32_16x16x16_bf16 v[180:183], a[122:123], v[94:95], v[180:183]
    v_mfma_f32_16x16x16_bf16 v[184:187], a[124:125], v[94:95], v[184:187]
    v_mfma_f32_16x16x16_bf16 v[188:191], a[126:127], v[94:95], v[188:191]
    s_nop 7
    v_cvt_pk_bf16_f32 v192, v128, v129
    v_cvt_pk_bf16_f32 v193, v130, v131
    v_cvt_pk_bf16_f32 v194, v132, v133
    v_cvt_pk_bf16_f32 v195, v134, v135
    buffer_store_dwordx4 v[192:195], v8, s[92:95], s21 offen offset:0 sc1
    v_cvt_pk_bf16_f32 v196, v136, v137
    v_cvt_pk_bf16_f32 v197, v138, v139
    v_cvt_pk_bf16_f32 v198, v140, v141
    v_cvt_pk_bf16_f32 v199, v142, v143
    buffer_store_dwordx4 v[196:199], v8, s[92:95], s21 offen offset:256 sc1
    v_cvt_pk_bf16_f32 v200, v144, v145
    v_cvt_pk_bf16_f32 v201, v146, v147
    v_cvt_pk_bf16_f32 v202, v148, v149
    v_cvt_pk_bf16_f32 v203, v150, v151
    buffer_store_dwordx4 v[200:203], v8, s[92:95], s21 offen offset:512 sc1
    v_cvt_pk_bf16_f32 v204, v152, v153
    v_cvt_pk_bf16_f32 v205, v154, v155
    v_cvt_pk_bf16_f32 v206, v156, v157
    v_cvt_pk_bf16_f32 v207, v158, v159
    buffer_store_dwordx4 v[204:207], v8, s[92:95], s21 offen offset:768 sc1
    v_cvt_pk_bf16_f32 v208, v160, v161
    v_cvt_pk_bf16_f32 v209, v162, v163
    v_cvt_pk_bf16_f32 v210, v164, v165
    v_cvt_pk_bf16_f32 v211, v166, v167
    buffer_store_dwordx4 v[208:211], v8, s[92:95], s22 offen offset:0 sc1
    v_cvt_pk_bf16_f32 v212, v168, v169
    v_cvt_pk_bf16_f32 v213, v170, v171
    v_cvt_pk_bf16_f32 v214, v172, v173
    v_cvt_pk_bf16_f32 v215, v174, v175
    buffer_store_dwordx4 v[212:215], v8, s[92:95], s22 offen offset:256 sc1
    v_cvt_pk_bf16_f32 v216, v176, v177
    v_cvt_pk_bf16_f32 v217, v178, v179
    v_cvt_pk_bf16_f32 v218, v180, v181
    v_cvt_pk_bf16_f32 v219, v182, v183
    buffer_store_dwordx4 v[216:219], v8, s[92:95], s22 offen offset:512 sc1
    v_cvt_pk_bf16_f32 v220, v184, v185
    v_cvt_pk_bf16_f32 v221, v186, v187
    v_cvt_pk_bf16_f32 v222, v188, v189
    v_cvt_pk_bf16_f32 v223, v190, v191
    buffer_store_dwordx4 v[220:223], v8, s[92:95], s22 offen offset:768 sc1
    s_add_u32 s25, s25, 1
    s_waitcnt vmcnt(16)
    v_mfma_f32_16x16x32_bf16 v[64:67], a[160:163], a[128:131], 0
    v_mfma_f32_16x16x32_bf16 v[72:75], a[160:163], a[144:147], 0
    v_mfma_f32_16x16x32_bf16 v[76:79], a[176:179], a[144:147], 0
    v_mfma_f32_16x16x32_bf16 v[68:71], a[192:195], a[128:131], 0
    v_mfma_f32_16x16x32_bf16 v[80:83], a[192:195], a[144:147], 0
    v_mfma_f32_16x16x32_bf16 v[64:67], a[164:167], a[132:135], v[64:67]
    v_mfma_f32_16x16x32_bf16 v[72:75], a[164:167], a[148:151], v[72:75]
    v_mfma_f32_16x16x32_bf16 v[76:79], a[180:183], a[148:151], v[76:79]
    v_mfma_f32_16x16x32_bf16 v[68:71], a[196:199], a[132:135], v[68:71]
    v_mfma_f32_16x16x32_bf16 v[80:83], a[196:199], a[148:151], v[80:83]
    v_mfma_f32_16x16x32_bf16 v[64:67], a[168:171], a[136:139], v[64:67]
    v_mfma_f32_16x16x32_bf16 v[72:75], a[168:171], a[152:155], v[72:75]
    v_mfma_f32_16x16x32_bf16 v[76:79], a[184:187], a[152:155], v[76:79]
    v_mfma_f32_16x16x32_bf16 v[68:71], a[200:203], a[136:139], v[68:71]
    v_mfma_f32_16x16x32_bf16 v[80:83], a[200:203], a[152:155], v[80:83]
    v_mfma_f32_16x16x32_bf16 v[64:67], a[172:175], a[140:143], v[64:67]
    v_mfma_f32_16x16x32_bf16 v[72:75], a[172:175], a[156:159], v[72:75]
    v_mfma_f32_16x16x32_bf16 v[76:79], a[188:191], a[156:159], v[76:79]
    v_mfma_f32_16x16x32_bf16 v[68:71], a[204:207], a[140:143], v[68:71]
    v_mfma_f32_16x16x32_bf16 v[80:83], a[204:207], a[156:159], v[80:83]
    s_mov_b32 s21, 0x3db504f3
    s_mov_b32 s22, 0x3fb8aa3b
    s_nop 3
    v_cvt_pk_bf16_f32 v84, v64, v65
    v_cvt_pk_bf16_f32 v85, v66, v67
    v_cvt_pk_bf16_f32 v86, v68, v69
    v_cvt_pk_bf16_f32 v87, v70, v71
    v_cvt_pk_bf16_f32 v88, v72, v73
    v_cvt_pk_bf16_f32 v89, v74, v75
    v_cvt_pk_bf16_f32 v90, v76, v77
    v_cvt_pk_bf16_f32 v91, v78, v79
    v_cvt_pk_bf16_f32 v92, v80, v81
    v_cvt_pk_bf16_f32 v93, v82, v83
    v_lshlrev_b32 v64, 16, v84
    v_and_b32 v65, 0xffff0000, v84
    v_lshlrev_b32 v66, 16, v85
    v_and_b32 v67, 0xffff0000, v85
    v_lshlrev_b32 v68, 16, v86
    v_and_b32 v69, 0xffff0000, v86
    v_lshlrev_b32 v70, 16, v87
    v_and_b32 v71, 0xffff0000, v87
    v_lshlrev_b32 v72, 16, v88
    v_and_b32 v73, 0xffff0000, v88
    v_lshlrev_b32 v74, 16, v89
    v_and_b32 v75, 0xffff0000, v89
    v_lshlrev_b32 v76, 16, v90
    v_and_b32 v77, 0xffff0000, v90
    v_lshlrev_b32 v78, 16, v91
    v_and_b32 v79, 0xffff0000, v91
    v_lshlrev_b32 v80, 16, v92
    v_and_b32 v81, 0xffff0000, v92
    v_lshlrev_b32 v82, 16, v93
    v_and_b32 v83, 0xffff0000, v93
    v_mul_f32 v64, s21, v64
    v_mul_f32 v65, s21, v65
    v_mul_f32 v66, s21, v66
    v_mul_f32 v67, s21, v67
    v_mul_f32 v68, s21, v68
    v_mul_f32 v69, s21, v69
    v_mul_f32 v70, s21, v70
    v_mul_f32 v71, s21, v71
    v_mul_f32 v72, s21, v72
    v_mul_f32 v73, s21, v73
    v_mul_f32 v74, s21, v74
    v_mul_f32 v75, s21, v75
    v_mul_f32 v76, s21, v76
    v_mul_f32 v77, s21, v77
    v_mul_f32 v78, s21, v78
    v_mul_f32 v79, s21, v79
    v_mul_f32 v80, s21, v80
    v_mul_f32 v81, s21, v81
    v_mul_f32 v82, s21, v82
    v_mul_f32 v83, s21, v83
    v_cvt_pk_bf16_f32 v84, v64, v65
    v_cvt_pk_bf16_f32 v85, v66, v67
    v_cvt_pk_bf16_f32 v86, v68, v69
    v_cvt_pk_bf16_f32 v87, v70, v71
    v_cvt_pk_bf16_f32 v88, v72, v73
    v_cvt_pk_bf16_f32 v89, v74, v75
    v_cvt_pk_bf16_f32 v90, v76, v77
    v_cvt_pk_bf16_f32 v91, v78, v79
    v_cvt_pk_bf16_f32 v92, v80, v81
    v_cvt_pk_bf16_f32 v93, v82, v83
    v_lshlrev_b32 v64, 16, v84
    v_and_b32 v65, 0xffff0000, v84
    v_lshlrev_b32 v66, 16, v85
    v_and_b32 v67, 0xffff0000, v85
    v_lshlrev_b32 v68, 16, v86
    v_and_b32 v69, 0xffff0000, v86
    v_lshlrev_b32 v70, 16, v87
    v_and_b32 v71, 0xffff0000, v87
    v_lshlrev_b32 v72, 16, v88
    v_and_b32 v73, 0xffff0000, v88
    v_lshlrev_b32 v74, 16, v89
    v_and_b32 v75, 0xffff0000, v89
    v_lshlrev_b32 v76, 16, v90
    v_and_b32 v77, 0xffff0000, v90
    v_lshlrev_b32 v78, 16, v91
    v_and_b32 v79, 0xffff0000, v91
    v_lshlrev_b32 v80, 16, v92
    v_and_b32 v81, 0xffff0000, v92
    v_lshlrev_b32 v82, 16, v93
    v_and_b32 v83, 0xffff0000, v93
    v_cndmask_b32 v64, v64, v12, s[72:73]
    v_cndmask_b32 v76, v76, v12, s[72:73]
    v_cndmask_b32 v68, v68, v12, s[80:81]
    v_cndmask_b32 v80, v80, v12, s[80:81]
    v_cndmask_b32 v65, v65, v12, s[74:75]
    v_cndmask_b32 v77, v77, v12, s[74:75]
    v_cndmask_b32 v69, v69, v12, s[80:81]
    v_cndmask_b32 v81, v81, v12, s[80:81]
    v_cndmask_b32 v66, v66, v12, s[76:77]
    v_cndmask_b32 v78, v78, v12, s[76:77]
    v_cndmask_b32 v70, v70, v12, s[80:81]
    v_cndmask_b32 v82, v82, v12, s[80:81]
    v_cndmask_b32 v67, v67, v12, s[78:79]
    v_cndmask_b32 v79, v79, v12, s[78:79]
    v_cndmask_b32 v71, v71, v12, s[80:81]
    v_cndmask_b32 v83, v83, v12, s[80:81]
    v_max3_f32 v96, v64, v65, v66
    v_max3_f32 v96, v96, v67, v68
    v_max3_f32 v96, v96, v69, v70
    v_max_f32 v96, v96, v71
    v_max3_f32 v97, v72, v73, v74
    v_max3_f32 v97, v97, v75, v76
    v_max3_f32 v97, v97, v77, v78
    v_max3_f32 v97, v97, v79, v80
    v_max3_f32 v97, v97, v81, v82
    v_max_f32 v97, v97, v83
    v_mov_b32 v98, v96
    v_mov_b32 v99, v97
    s_nop 0
    v_permlane16_swap_b32 v96, v98
    v_permlane16_swap_b32 v97, v99
    v_max_f32 v96, v96, v98
    v_max_f32 v97, v97, v99
    v_mov_b32 v98, v96
    v_mov_b32 v99, v97
    s_nop 0
    v_permlane32_swap_b32 v96, v98
    v_permlane32_swap_b32 v97, v99
    v_max_f32 v96, v96, v98
    v_max_f32 v97, v97, v99
    v_sub_f32 v64, v64, v96
    v_sub_f32 v65, v65, v96
    v_sub_f32 v66, v66, v96
    v_sub_f32 v67, v67, v96
    v_sub_f32 v68, v68, v96
    v_sub_f32 v69, v69, v96
    v_sub_f32 v70, v70, v96
    v_sub_f32 v71, v71, v96
    v_sub_f32 v72, v72, v97
    v_sub_f32 v73, v73, v97
    v_sub_f32 v74, v74, v97
    v_sub_f32 v75, v75, v97
    v_sub_f32 v76, v76, v97
    v_sub_f32 v77, v77, v97
    v_sub_f32 v78, v78, v97
    v_sub_f32 v79, v79, v97
    v_sub_f32 v80, v80, v97
    v_sub_f32 v81, v81, v97
    v_sub_f32 v82, v82, v97
    v_sub_f32 v83, v83, v97
    v_mul_f32 v64, s22, v64
    v_mul_f32 v65, s22, v65
    v_mul_f32 v66, s22, v66
    v_mul_f32 v67, s22, v67
    v_mul_f32 v68, s22, v68
    v_mul_f32 v69, s22, v69
    v_mul_f32 v70, s22, v70
    v_mul_f32 v71, s22, v71
    v_mul_f32 v72, s22, v72
    v_mul_f32 v73, s22, v73
    v_mul_f32 v74, s22, v74
    v_mul_f32 v75, s22, v75
    v_mul_f32 v76, s22, v76
    v_mul_f32 v77, s22, v77
    v_mul_f32 v78, s22, v78
    v_mul_f32 v79, s22, v79
    v_mul_f32 v80, s22, v80
    v_mul_f32 v81, s22, v81
    v_mul_f32 v82, s22, v82
    v_mul_f32 v83, s22, v83
    v_exp_f32 v64, v64
    v_exp_f32 v65, v65
    v_exp_f32 v66, v66
    v_exp_f32 v67, v67
    v_exp_f32 v68, v68
    v_exp_f32 v69, v69
    v_exp_f32 v70, v70
    v_exp_f32 v71, v71
    v_exp_f32 v72, v72
    v_exp_f32 v73, v73
    v_exp_f32 v74, v74
    v_exp_f32 v75, v75
    v_exp_f32 v76, v76
    v_exp_f32 v77, v77
    v_exp_f32 v78, v78
    v_exp_f32 v79, v79
    v_exp_f32 v80, v80
    v_exp_f32 v81, v81
    v_exp_f32 v82, v82
    v_exp_f32 v83, v83
    s_nop 0
    v_add_f32 v96, v64, v65
    v_add_f32 v96, v96, v66
    v_add_f32 v96, v96, v67
    v_add_f32 v96, v96, v68
    v_add_f32 v96, v96, v69
    v_add_f32 v96, v96, v70
    v_add_f32 v96, v96, v71
    v_add_f32 v97, v72, v73
    v_add_f32 v97, v97, v74
    v_add_f32 v97, v97, v75
    v_add_f32 v97, v97, v76
    v_add_f32 v97, v97, v77
    v_add_f32 v97, v97, v78
    v_add_f32 v97, v97, v79
    v_add_f32 v97, v97, v80
    v_add_f32 v97, v97, v81
    v_add_f32 v97, v97, v82
    v_add_f32 v97, v97, v83
    v_mov_b32 v98, v96
    v_mov_b32 v99, v97
    s_nop 0
    v_permlane16_swap_b32 v96, v98
    v_permlane16_swap_b32 v97, v99
    v_add_f32 v96, v96, v98
    v_add_f32 v97, v97, v99
    v_mov_b32 v98, v96
    v_mov_b32 v99, v97
    s_nop 0
    v_permlane32_swap_b32 v96, v98
    v_permlane32_swap_b32 v97, v99
    v_add_f32 v96, v96, v98
    v_add_f32 v97, v97, v99
    v_rcp_f32 v96, v96
    v_rcp_f32 v97, v97
    s_nop 0
    v_mul_f32 v64, v64, v96
    v_mul_f32 v65, v65, v96
    v_mul_f32 v66, v66, v96
    v_mul_f32 v67, v67, v96
    v_mul_f32 v68, v68, v96
    v_mul_f32 v69, v69, v96
    v_mul_f32 v70, v70, v96
    v_mul_f32 v71, v71, v96
    v_mul_f32 v72, v72, v97
    v_mul_f32 v73, v73, v97
    v_mul_f32 v74, v74, v97
    v_mul_f32 v75, v75, v97
    v_mul_f32 v76, v76, v97
    v_mul_f32 v77, v77, v97
    v_mul_f32 v78, v78, v97
    v_mul_f32 v79, v79, v97
    v_mul_f32 v80, v80, v97
    v_mul_f32 v81, v81, v97
    v_mul_f32 v82, v82, v97
    v_mul_f32 v83, v83, v97
    v_cvt_pk_bf16_f32 v84, v64, v65
    v_cvt_pk_bf16_f32 v85, v66, v67
    v_mov_b32 v86, 0
    v_mov_b32 v87, 0
    v_cvt_pk_bf16_f32 v88, v72, v73
    v_cvt_pk_bf16_f32 v89, v74, v75
    v_cvt_pk_bf16_f32 v90, v76, v77
    v_cvt_pk_bf16_f32 v91, v78, v79
    v_cvt_pk_bf16_f32 v92, v68, v69
    v_cvt_pk_bf16_f32 v93, v70, v71
    v_cvt_pk_bf16_f32 v94, v80, v81
    v_cvt_pk_bf16_f32 v95, v82, v83
    s_waitcnt vmcnt(8)
    s_mul_i32 s21, s38, 266240
    s_lshl_b32 s22, s25, 10
    s_add_u32 s21, s21, s22
    s_add_u32 s21, s21, 71303168
    s_add_u32 s22, s21, 133120
    v_mfma_f32_16x16x32_bf16 v[128:131], a[208:211], v[84:87], 0
    v_mfma_f32_16x16x32_bf16 v[132:135], a[212:215], v[84:87], 0
    v_mfma_f32_16x16x32_bf16 v[136:139], a[216:219], v[84:87], 0
    v_mfma_f32_16x16x32_bf16 v[140:143], a[220:223], v[84:87], 0
    v_mfma_f32_16x16x32_bf16 v[144:147], a[224:227], v[84:87], 0
    v_mfma_f32_16x16x32_bf16 v[148:151], a[228:231], v[84:87], 0
    v_mfma_f32_16x16x32_bf16 v[152:155], a[232:235], v[84:87], 0
    v_mfma_f32_16x16x32_bf16 v[156:159], a[236:239], v[84:87], 0
    v_mfma_f32_16x16x32_bf16 v[160:163], a[208:211], v[88:91], 0
    v_mfma_f32_16x16x32_bf16 v[164:167], a[212:215], v[88:91], 0
    v_mfma_f32_16x16x32_bf16 v[168:171], a[216:219], v[88:91], 0
    v_mfma_f32_16x16x32_bf16 v[172:175], a[220:223], v[88:91], 0
    v_mfma_f32_16x16x32_bf16 v[176:179], a[224:227], v[88:91], 0
    v_mfma_f32_16x16x32_bf16 v[180:183], a[228:231], v[88:91], 0
    v_mfma_f32_16x16x32_bf16 v[184:187], a[232:235], v[88:91], 0
    v_mfma_f32_16x16x32_bf16 v[188:191], a[236:239], v[88:91], 0
    v_mfma_f32_16x16x16_bf16 v[128:131], a[240:241], v[92:93], v[128:131]
    v_mfma_f32_16x16x16_bf16 v[132:135], a[242:243], v[92:93], v[132:135]
    v_mfma_f32_16x16x16_bf16 v[136:139], a[244:245], v[92:93], v[136:139]
    v_mfma_f32_16x16x16_bf16 v[140:143], a[246:247], v[92:93], v[140:143]
    v_mfma_f32_16x16x16_bf16 v[144:147], a[248:249], v[92:93], v[144:147]
    v_mfma_f32_16x16x16_bf16 v[148:151], a[250:251], v[92:93], v[148:151]
    v_mfma_f32_16x16x16_bf16 v[152:155], a[252:253], v[92:93], v[152:155]
    v_mfma_f32_16x16x16_bf16 v[156:159], a[254:255], v[92:93], v[156:159]
    v_mfma_f32_16x16x16_bf16 v[160:163], a[240:241], v[94:95], v[160:163]
    v_mfma_f32_16x16x16_bf16 v[164:167], a[242:243], v[94:95], v[164:167]
    v_mfma_f32_16x16x16_bf16 v[168:171], a[244:245], v[94:95], v[168:171]
    v_mfma_f32_16x16x16_bf16 v[172:175], a[246:247], v[94:95], v[172:175]
    v_mfma_f32_16x16x16_bf16 v[176:179], a[248:249], v[94:95], v[176:179]
    v_mfma_f32_16x16x16_bf16 v[180:183], a[250:251], v[94:95], v[180:183]
    v_mfma_f32_16x16x16_bf16 v[184:187], a[252:253], v[94:95], v[184:187]
    v_mfma_f32_16x16x16_bf16 v[188:191], a[254:255], v[94:95], v[188:191]
    s_nop 7
    v_cvt_pk_bf16_f32 v192, v128, v129
    v_cvt_pk_bf16_f32 v193, v130, v131
    v_cvt_pk_bf16_f32 v194, v132, v133
    v_cvt_pk_bf16_f32 v195, v134, v135
    buffer_store_dwordx4 v[192:195], v8, s[92:95], s21 offen offset:0 sc1
    v_cvt_pk_bf16_f32 v196, v136, v137
    v_cvt_pk_bf16_f32 v197, v138, v139
    v_cvt_pk_bf16_f32 v198, v140, v141
    v_cvt_pk_bf16_f32 v199, v142, v143
    buffer_store_dwordx4 v[196:199], v8, s[92:95], s21 offen offset:256 sc1
    v_cvt_pk_bf16_f32 v200, v144, v145
    v_cvt_pk_bf16_f32 v201, v146, v147
    v_cvt_pk_bf16_f32 v202, v148, v149
    v_cvt_pk_bf16_f32 v203, v150, v151
    buffer_store_dwordx4 v[200:203], v8, s[92:95], s21 offen offset:512 sc1
    v_cvt_pk_bf16_f32 v204, v152, v153
    v_cvt_pk_bf16_f32 v205, v154, v155
    v_cvt_pk_bf16_f32 v206, v156, v157
    v_cvt_pk_bf16_f32 v207, v158, v159
    buffer_store_dwordx4 v[204:207], v8, s[92:95], s21 offen offset:768 sc1
    v_cvt_pk_bf16_f32 v208, v160, v161
    v_cvt_pk_bf16_f32 v209, v162, v163
    v_cvt_pk_bf16_f32 v210, v164, v165
    v_cvt_pk_bf16_f32 v211, v166, v167
    buffer_store_dwordx4 v[208:211], v8, s[92:95], s22 offen offset:0 sc1
    v_cvt_pk_bf16_f32 v212, v168, v169
    v_cvt_pk_bf16_f32 v213, v170, v171
    v_cvt_pk_bf16_f32 v214, v172, v173
    v_cvt_pk_bf16_f32 v215, v174, v175
    buffer_store_dwordx4 v[212:215], v8, s[92:95], s22 offen offset:256 sc1
    v_cvt_pk_bf16_f32 v216, v176, v177
    v_cvt_pk_bf16_f32 v217, v178, v179
    v_cvt_pk_bf16_f32 v218, v180, v181
    v_cvt_pk_bf16_f32 v219, v182, v183
    buffer_store_dwordx4 v[216:219], v8, s[92:95], s22 offen offset:512 sc1
    v_cvt_pk_bf16_f32 v220, v184, v185
    v_cvt_pk_bf16_f32 v221, v186, v187
    v_cvt_pk_bf16_f32 v222, v188, v189
    v_cvt_pk_bf16_f32 v223, v190, v191
    buffer_store_dwordx4 v[220:223], v8, s[92:95], s22 offen offset:768 sc1
    s_waitcnt vmcnt(0)
    s_barrier
    s_cmp_lg_u32 s3, 0
    s_cbranch_scc1 Fin_228
    v_mov_b32 v4, 8
    s_mov_b64 exec, 1
    buffer_atomic_add v4, off, s[92:95], s36 sc1
    s_mov_b64 exec, -1
Fin_228:
    s_branch L_next
L_AT4:
    s_sub_u32 s20, s20, 192
    s_lshr_b32 s38, s20, 3
    s_and_b32 s37, s20, 7
    s_lshl_b32 s36, s38, 7
    s_lshr_b32 s21, s37, 2
    s_lshl_b32 s21, s21, 6
    s_add_u32 s36, s36, s21
    s_add_u32 s36, s36, 113250816
    s_add_u32 s38, s38, 48
    s_lshr_b32 s32, s38, 3
    s_lshl_b32 s32, s32, 10
    s_lshr_b32 s34, s37, 1
    s_lshl_b32 s33, s34, 8
    s_add_u32 s32, s32, s33
    s_add_u32 s32, s32, 113262592
    s_cmp_lg_u32 s3, 0
    s_cbranch_scc1 Wf_229
    v_and_b32 v5, 3, v1
    v_lshlrev_b32 v5, 6, v5
    s_mov_b32 s30, 0
    s_mov_b32 s21, 0x40404
Wp_230:
    buffer_load_dword v4, v5, s[92:95], s32 offen sc1
    s_waitcnt vmcnt(0)
    v_and_b32 v4, 0xffffff, v4
    v_cmp_ne_u32 vcc, s21, v4
    s_cbranch_vccz Wf_229
    s_sleep 8
    s_add_u32 s30, s30, 1
    s_cmp_lt_u32 s30, 65536
    s_cbranch_scc1 Wp_230
    s_branch L_abort
Wf_229:
    s_barrier
    s_lshl_b32 s32, s38, 2
    s_add_u32 s32, s32, s34
    s_lshl_b32 s32, s32, 7
    s_add_u32 s32, s32, 113278976
    v_lshlrev_b32 v2, 4, v1
    v_add_u32 v3, 4096, v2
    v_bfe_u32 v10, v1, 4, 1
    v_lshrrev_b32 v9, 4, v1
    v_and_b32 v11, 15, v1
    v_lshlrev_b32 v11, 4, v11
    v_lshl_add_u32 v8, v9, 9, v11
    v_lshrrev_b32 v9, 4, v1
    v_and_b32 v11, 7, v1
    v_lshlrev_b32 v11, 4, v11
    v_lshl_add_u32 v4, v9, 7, v11
    v_and_b32 v11, 15, v1
    v_lshlrev_b32 v7, 4, v11
    v_lshl_add_u32 v7, v10, 3, v7
    v_lshrrev_b32 v10, 4, v1
    v_lshlrev_b32 v10, 2, v10
    v_add_u32 v9, 0, v10
    v_cmp_gt_u32 s[72:73], v9, v11
    v_add_u32 v9, 1, v10
    v_cmp_gt_u32 s[74:75], v9, v11
    v_add_u32 v9, 2, v10
    v_cmp_gt_u32 s[76:77], v9, v11
    v_add_u32 v9, 3, v10
    v_cmp_gt_u32 s[78:79], v9, v11
    s_mov_b32 s80, 0
    s_mov_b32 s81, -1
    v_mov_b32 v12, 0xce6e6b28
    v_mov_b32 v13, 0
    s_mul_i32 s25, s37, 4
    s_mul_i32 s26, s3, 1
    s_add_u32 s25, s25, s26
    s_lshl_b32 s26, s38, 5
    s_add_u32 s26, s26, s25
    s_add_u32 s27, s26, 1
    s_lshl_b32 s21, s26, 13
    s_add_u32 s22, s21, 22020096
    s_add_u32 s23, s21, 38797312
    s_add_u32 s21, s21, 5242880
    buffer_load_dwordx4 a[0:3], v2, s[92:95], s21 offen offset:0 sc1
    buffer_load_dwordx4 a[32:35], v2, s[92:95], s22 offen offset:0 sc1
    buffer_load_dwordx4 a[16:19], v3, s[92:95], s21 offen offset:0 sc1
    buffer_load_dwordx4 a[48:51], v3, s[92:95], s22 offen offset:0 sc1
    buffer_load_dwordx4 a[4:7], v2, s[92:95], s21 offen offset:1024 sc1
    buffer_load_dwordx4 a[36:39], v2, s[92:95], s22 offen offset:1024 sc1
    buffer_load_dwordx4 a[20:23], v3, s[92:95], s21 offen offset:1024 sc1
    buffer_load_dwordx4 a[52:55], v3, s[92:95], s22 offen offset:1024 sc1
    buffer_load_dwordx4 a[8:11], v2, s[92:95], s21 offen offset:2048 sc1
    buffer_load_dwordx4 a[40:43], v2, s[92:95], s22 offen offset:2048 sc1
    buffer_load_dwordx4 a[24:27], v3, s[92:95], s21 offen offset:2048 sc1
    buffer_load_dwordx4 a[56:59], v3, s[92:95], s22 offen offset:2048 sc1
    buffer_load_dwordx4 a[12:15], v2, s[92:95], s21 offen offset:3072 sc1
    buffer_load_dwordx4 a[44:47], v2, s[92:95], s22 offen offset:3072 sc1
    buffer_load_dwordx4 a[28:31], v3, s[92:95], s21 offen offset:3072 sc1
    buffer_load_dwordx4 a[60:63], v3, s[92:95], s22 offen offset:3072 sc1
    buffer_load_dwordx4 a[80:83], v2, s[92:95], s23 offen offset:0 sc1
    buffer_load_dwordx4 a[84:87], v2, s[92:95], s23 offen offset:1024 sc1
    buffer_load_dwordx4 a[88:91], v2, s[92:95], s23 offen offset:2048 sc1
    buffer_load_dwordx4 a[92:95], v2, s[92:95], s23 offen offset:3072 sc1
    buffer_load_dwordx4 a[96:99], v3, s[92:95], s23 offen offset:0 sc1
    buffer_load_dwordx4 a[100:103], v3, s[92:95], s23 offen offset:1024 sc1
    buffer_load_dwordx4 a[104:107], v3, s[92:95], s23 offen offset:2048 sc1
    buffer_load_dwordx4 a[108:111], v3, s[92:95], s23 offen offset:3072 sc1
    s_cmp_lg_u32 s3, 0
    s_cbranch_scc1 Wf_231
    v_mov_b32 v15, 0
    s_mov_b32 s30, 0
    s_mov_b32 s21, 0x30
Wp_232:
    buffer_load_dword v14, v15, s[92:95], s32 offen sc1
    s_waitcnt vmcnt(0)
    v_cmp_ne_u32 vcc, s21, v14
    s_cbranch_vccz Wf_231
    s_sleep 2
    s_add_u32 s30, s30, 1
    s_cmp_lt_u32 s30, 65536
    s_cbranch_scc1 Wp_232
    s_branch L_abort
Wf_231:
    s_barrier
    s_lshl_b32 s24, s26, 12
    s_add_u32 s24, s24, 94371840
    buffer_load_dwordx4 a[64:67], v4, s[92:95], s24 offen offset:0 sc1
    buffer_load_dwordx4 a[68:71], v4, s[92:95], s24 offen offset:512 sc1
    buffer_load_dwordx4 a[72:75], v4, s[92:95], s24 offen offset:1024 sc1
    buffer_load_dwordx4 a[76:79], v4, s[92:95], s24 offen offset:1536 sc1
    buffer_load_dwordx2 a[112:113], v7, s[92:95], s24 offen offset:2048 sc1
    buffer_load_dwordx2 a[114:115], v7, s[92:95], s24 offen offset:2304 sc1
    buffer_load_dwordx2 a[116:117], v7, s[92:95], s24 offen offset:2560 sc1
    buffer_load_dwordx2 a[118:119], v7, s[92:95], s24 offen offset:2816 sc1
    buffer_load_dwordx2 a[120:121], v7, s[92:95], s24 offen offset:3072 sc1
    buffer_load_dwordx2 a[122:123], v7, s[92:95], s24 offen offset:3328 sc1
    buffer_load_dwordx2 a[124:125], v7, s[92:95], s24 offen offset:3584 sc1
    buffer_load_dwordx2 a[126:127], v7, s[92:95], s24 offen offset:3840 sc1
    s_waitcnt vmcnt(8)
    v_mfma_f32_16x16x32_bf16 v[64:67], a[32:35], a[0:3], 0
    v_mfma_f32_16x16x32_bf16 v[72:75], a[32:35], a[16:19], 0
    v_mfma_f32_16x16x32_bf16 v[76:79], a[48:51], a[16:19], 0
    v_mfma_f32_16x16x32_bf16 v[68:71], a[64:67], a[0:3], 0
    v_mfma_f32_16x16x32_bf16 v[80:83], a[64:67], a[16:19], 0
    v_mfma_f32_16x16x32_bf16 v[64:67], a[36:39], a[4:7], v[64:67]
    v_mfma_f32_16x16x32_bf16 v[72:75], a[36:39], a[20:23], v[72:75]
    v_mfma_f32_16x16x32_bf16 v[76:79], a[52:55], a[20:23], v[76:79]
    v_mfma_f32_16x16x32_bf16 v[68:71], a[68:71], a[4:7], v[68:71]
    v_mfma_f32_16x16x32_bf16 v[80:83], a[68:71], a[20:23], v[80:83]
    v_mfma_f32_16x16x32_bf16 v[64:67], a[40:43], a[8:11], v[64:67]
    v_mfma_f32_16x16x32_bf16 v[72:75], a[40:43], a[24:27], v[72:75]
    v_mfma_f32_16x16x32_bf16 v[76:79], a[56:59], a[24:27], v[76:79]
    v_mfma_f32_16x16x32_bf16 v[68:71], a[72:75], a[8:11], v[68:71]
    v_mfma_f32_16x16x32_bf16 v[80:83], a[72:75], a[24:27], v[80:83]
    v_mfma_f32_16x16x32_bf16 v[64:67], a[44:47], a[12:15], v[64:67]
    v_mfma_f32_16x16x32_bf16 v[72:75], a[44:47], a[28:31], v[72:75]
    v_mfma_f32_16x16x32_bf16 v[76:79], a[60:63], a[28:31], v[76:79]
    v_mfma_f32_16x16x32_bf16 v[68:71], a[76:79], a[12:15], v[68:71]
    v_mfma_f32_16x16x32_bf16 v[80:83], a[76:79], a[28:31], v[80:83]
    s_mov_b32 s21, 0x3db504f3
    s_mov_b32 s22, 0x3fb8aa3b
    s_nop 3
    v_cvt_pk_bf16_f32 v84, v64, v65
    v_cvt_pk_bf16_f32 v85, v66, v67
    v_cvt_pk_bf16_f32 v86, v68, v69
    v_cvt_pk_bf16_f32 v87, v70, v71
    v_cvt_pk_bf16_f32 v88, v72, v73
    v_cvt_pk_bf16_f32 v89, v74, v75
    v_cvt_pk_bf16_f32 v90, v76, v77
    v_cvt_pk_bf16_f32 v91, v78, v79
    v_cvt_pk_bf16_f32 v92, v80, v81
    v_cvt_pk_bf16_f32 v93, v82, v83
    v_lshlrev_b32 v64, 16, v84
    v_and_b32 v65, 0xffff0000, v84
    v_lshlrev_b32 v66, 16, v85
    v_and_b32 v67, 0xffff0000, v85
    v_lshlrev_b32 v68, 16, v86
    v_and_b32 v69, 0xffff0000, v86
    v_lshlrev_b32 v70, 16, v87
    v_and_b32 v71, 0xffff0000, v87
    v_lshlrev_b32 v72, 16, v88
    v_and_b32 v73, 0xffff0000, v88
    v_lshlrev_b32 v74, 16, v89
    v_and_b32 v75, 0xffff0000, v89
    v_lshlrev_b32 v76, 16, v90
    v_and_b32 v77, 0xffff0000, v90
    v_lshlrev_b32 v78, 16, v91
    v_and_b32 v79, 0xffff0000, v91
    v_lshlrev_b32 v80, 16, v92
    v_and_b32 v81, 0xffff0000, v92
    v_lshlrev_b32 v82, 16, v93
    v_and_b32 v83, 0xffff0000, v93
    v_mul_f32 v64, s21, v64
    v_mul_f32 v65, s21, v65
    v_mul_f32 v66, s21, v66
    v_mul_f32 v67, s21, v67
    v_mul_f32 v68, s21, v68
    v_mul_f32 v69, s21, v69
    v_mul_f32 v70, s21, v70
    v_mul_f32 v71, s21, v71
    v_mul_f32 v72, s21, v72
    v_mul_f32 v73, s21, v73
    v_mul_f32 v74, s21, v74
    v_mul_f32 v75, s21, v75
    v_mul_f32 v76, s21, v76
    v_mul_f32 v77, s21, v77
    v_mul_f32 v78, s21, v78
    v_mul_f32 v79, s21, v79
    v_mul_f32 v80, s21, v80
    v_mul_f32 v81, s21, v81
    v_mul_f32 v82, s21, v82
    v_mul_f32 v83, s21, v83
    v_cvt_pk_bf16_f32 v84, v64, v65
    v_cvt_pk_bf16_f32 v85, v66, v67
    v_cvt_pk_bf16_f32 v86, v68, v69
    v_cvt_pk_bf16_f32 v87, v70, v71
    v_cvt_pk_bf16_f32 v88, v72, v73
    v_cvt_pk_bf16_f32 v89, v74, v75
    v_cvt_pk_bf16_f32 v90, v76, v77
    v_cvt_pk_bf16_f32 v91, v78, v79
    v_cvt_pk_bf16_f32 v92, v80, v81
    v_cvt_pk_bf16_f32 v93, v82, v83
    v_lshlrev_b32 v64, 16, v84
    v_and_b32 v65, 0xffff0000, v84
    v_lshlrev_b32 v66, 16, v85
    v_and_b32 v67, 0xffff0000, v85
    v_lshlrev_b32 v68, 16, v86
    v_and_b32 v69, 0xffff0000, v86
    v_lshlrev_b32 v70, 16, v87
    v_and_b32 v71, 0xffff0000, v87
    v_lshlrev_b32 v72, 16, v88
    v_and_b32 v73, 0xffff0000, v88
    v_lshlrev_b32 v74, 16, v89
    v_and_b32 v75, 0xffff0000, v89
    v_lshlrev_b32 v76, 16, v90
    v_and_b32 v77, 0xffff0000, v90
    v_lshlrev_b32 v78, 16, v91
    v_and_b32 v79, 0xffff0000, v91
    v_lshlrev_b32 v80, 16, v92
    v_and_b32 v81, 0xffff0000, v92
    v_lshlrev_b32 v82, 16, v93
    v_and_b32 v83, 0xffff0000, v93
    v_cndmask_b32 v64, v64, v12, s[72:73]
    v_cndmask_b32 v76, v76, v12, s[72:73]
    v_cndmask_b32 v68, v68, v12, s[80:81]
    v_cndmask_b32 v80, v80, v12, s[80:81]
    v_cndmask_b32 v65, v65, v12, s[74:75]
    v_cndmask_b32 v77, v77, v12, s[74:75]
    v_cndmask_b32 v69, v69, v12, s[80:81]
    v_cndmask_b32 v81, v81, v12, s[80:81]
    v_cndmask_b32 v66, v66, v12, s[76:77]
    v_cndmask_b32 v78, v78, v12, s[76:77]
    v_cndmask_b32 v70, v70, v12, s[80:81]
    v_cndmask_b32 v82, v82, v12, s[80:81]
    v_cndmask_b32 v67, v67, v12, s[78:79]
    v_cndmask_b32 v79, v79, v12, s[78:79]
    v_cndmask_b32 v71, v71, v12, s[80:81]
    v_cndmask_b32 v83, v83, v12, s[80:81]
    v_max3_f32 v96, v64, v65, v66
    v_max3_f32 v96, v96, v67, v68
    v_max3_f32 v96, v96, v69, v70
    v_max_f32 v96, v96, v71
    v_max3_f32 v97, v72, v73, v74
    v_max3_f32 v97, v97, v75, v76
    v_max3_f32 v97, v97, v77, v78
    v_max3_f32 v97, v97, v79, v80
    v_max3_f32 v97, v97, v81, v82
    v_max_f32 v97, v97, v83
    v_mov_b32 v98, v96
    v_mov_b32 v99, v97
    s_nop 0
    v_permlane16_swap_b32 v96, v98
    v_permlane16_swap_b32 v97, v99
    v_max_f32 v96, v96, v98
    v_max_f32 v97, v97, v99
    v_mov_b32 v98, v96
    v_mov_b32 v99, v97
    s_nop 0
    v_permlane32_swap_b32 v96, v98
    v_permlane32_swap_b32 v97, v99
    v_max_f32 v96, v96, v98
    v_max_f32 v97, v97, v99
    v_sub_f32 v64, v64, v96
    v_sub_f32 v65, v65, v96
    v_sub_f32 v66, v66, v96
    v_sub_f32 v67, v67, v96
    v_sub_f32 v68, v68, v96
    v_sub_f32 v69, v69, v96
    v_sub_f32 v70, v70, v96
    v_sub_f32 v71, v71, v96
    v_sub_f32 v72, v72, v97
    v_sub_f32 v73, v73, v97
    v_sub_f32 v74, v74, v97
    v_sub_f32 v75, v75, v97
    v_sub_f32 v76, v76, v97
    v_sub_f32 v77, v77, v97
    v_sub_f32 v78, v78, v97
    v_sub_f32 v79, v79, v97
    v_sub_f32 v80, v80, v97
    v_sub_f32 v81, v81, v97
    v_sub_f32 v82, v82, v97
    v_sub_f32 v83, v83, v97
    v_mul_f32 v64, s22, v64
    v_mul_f32 v65, s22, v65
    v_mul_f32 v66, s22, v66
    v_mul_f32 v67, s22, v67
    v_mul_f32 v68, s22, v68
    v_mul_f32 v69, s22, v69
    v_mul_f32 v70, s22, v70
    v_mul_f32 v71, s22, v71
    v_mul_f32 v72, s22, v72
    v_mul_f32 v73, s22, v73
    v_mul_f32 v74, s22, v74
    v_mul_f32 v75, s22, v75
    v_mul_f32 v76, s22, v76
    v_mul_f32 v77, s22, v77
    v_mul_f32 v78, s22, v78
    v_mul_f32 v79, s22, v79
    v_mul_f32 v80, s22, v80
    v_mul_f32 v81, s22, v81
    v_mul_f32 v82, s22, v82
    v_mul_f32 v83, s22, v83
    v_exp_f32 v64, v64
    v_exp_f32 v65, v65
    v_exp_f32 v66, v66
    v_exp_f32 v67, v67
    v_exp_f32 v68, v68
    v_exp_f32 v69, v69
    v_exp_f32 v70, v70
    v_exp_f32 v71, v71
    v_exp_f32 v72, v72
    v_exp_f32 v73, v73
    v_exp_f32 v74, v74
    v_exp_f32 v75, v75
    v_exp_f32 v76, v76
    v_exp_f32 v77, v77
    v_exp_f32 v78, v78
    v_exp_f32 v79, v79
    v_exp_f32 v80, v80
    v_exp_f32 v81, v81
    v_exp_f32 v82, v82
    v_exp_f32 v83, v83
    s_nop 0
    v_add_f32 v96, v64, v65
    v_add_f32 v96, v96, v66
    v_add_f32 v96, v96, v67
    v_add_f32 v96, v96, v68
    v_add_f32 v96, v96, v69
    v_add_f32 v96, v96, v70
    v_add_f32 v96, v96, v71
    v_add_f32 v97, v72, v73
    v_add_f32 v97, v97, v74
    v_add_f32 v97, v97, v75
    v_add_f32 v97, v97, v76
    v_add_f32 v97, v97, v77
    v_add_f32 v97, v97, v78
    v_add_f32 v97, v97, v79
    v_add_f32 v97, v97, v80
    v_add_f32 v97, v97, v81
    v_add_f32 v97, v97, v82
    v_add_f32 v97, v97, v83
    v_mov_b32 v98, v96
    v_mov_b32 v99, v97
    s_nop 0
    v_permlane16_swap_b32 v96, v98
    v_permlane16_swap_b32 v97, v99
    v_add_f32 v96, v96, v98
    v_add_f32 v97, v97, v99
    v_mov_b32 v98, v96
    v_mov_b32 v99, v97
    s_nop 0
    v_permlane32_swap_b32 v96, v98
    v_permlane32_swap_b32 v97, v99
    v_add_f32 v96, v96, v98
    v_add_f32 v97, v97, v99
    v_rcp_f32 v96, v96
    v_rcp_f32 v97, v97
    s_nop 0
    v_mul_f32 v64, v64, v96
    v_mul_f32 v65, v65, v96
    v_mul_f32 v66, v66, v96
    v_mul_f32 v67, v67, v96
    v_mul_f32 v68, v68, v96
    v_mul_f32 v69, v69, v96
    v_mul_f32 v70, v70, v96
    v_mul_f32 v71, v71, v96
    v_mul_f32 v72, v72, v97
    v_mul_f32 v73, v73, v97
    v_mul_f32 v74, v74, v97
    v_mul_f32 v75, v75, v97
    v_mul_f32 v76, v76, v97
    v_mul_f32 v77, v77, v97
    v_mul_f32 v78, v78, v97
    v_mul_f32 v79, v79, v97
    v_mul_f32 v80, v80, v97
    v_mul_f32 v81, v81, v97
    v_mul_f32 v82, v82, v97
    v_mul_f32 v83, v83, v97
    v_cvt_pk_bf16_f32 v84, v64, v65
    v_cvt_pk_bf16_f32 v85, v66, v67
    v_mov_b32 v86, 0
    v_mov_b32 v87, 0
    v_cvt_pk_bf16_f32 v88, v72, v73
    v_cvt_pk_bf16_f32 v89, v74, v75
    v_cvt_pk_bf16_f32 v90, v76, v77
    v_cvt_pk_bf16_f32 v91, v78, v79
    v_cvt_pk_bf16_f32 v92, v68, v69
    v_cvt_pk_bf16_f32 v93, v70, v71
    v_cvt_pk_bf16_f32 v94, v80, v81
    v_cvt_pk_bf16_f32 v95, v82, v83
    s_waitcnt vmcnt(0)
    s_lshl_b32 s21, s38, 18
    s_lshl_b32 s22, s25, 13
    s_add_u32 s21, s21, s22
    s_add_u32 s21, s21, 117440512
    s_add_u32 s22, s21, 4096
    v_mfma_f32_16x16x32_bf16 v[128:131], a[80:83], v[84:87], 0
    v_mfma_f32_16x16x32_bf16 v[132:135], a[84:87], v[84:87], 0
    v_mfma_f32_16x16x32_bf16 v[136:139], a[88:91], v[84:87], 0
    v_mfma_f32_16x16x32_bf16 v[140:143], a[92:95], v[84:87], 0
    v_mfma_f32_16x16x32_bf16 v[144:147], a[96:99], v[84:87], 0
    v_mfma_f32_16x16x32_bf16 v[148:151], a[100:103], v[84:87], 0
    v_mfma_f32_16x16x32_bf16 v[152:155], a[104:107], v[84:87], 0
    v_mfma_f32_16x16x32_bf16 v[156:159], a[108:111], v[84:87], 0
    v_mfma_f32_16x16x32_bf16 v[160:163], a[80:83], v[88:91], 0
    v_mfma_f32_16x16x32_bf16 v[164:167], a[84:87], v[88:91], 0
    v_mfma_f32_16x16x32_bf16 v[168:171], a[88:91], v[88:91], 0
    v_mfma_f32_16x16x32_bf16 v[172:175], a[92:95], v[88:91], 0
    v_mfma_f32_16x16x32_bf16 v[176:179], a[96:99], v[88:91], 0
    v_mfma_f32_16x16x32_bf16 v[180:183], a[100:103], v[88:91], 0
    v_mfma_f32_16x16x32_bf16 v[184:187], a[104:107], v[88:91], 0
    v_mfma_f32_16x16x32_bf16 v[188:191], a[108:111], v[88:91], 0
    v_mfma_f32_16x16x16_bf16 v[128:131], a[112:113], v[92:93], v[128:131]
    v_mfma_f32_16x16x16_bf16 v[132:135], a[114:115], v[92:93], v[132:135]
    v_mfma_f32_16x16x16_bf16 v[136:139], a[116:117], v[92:93], v[136:139]
    v_mfma_f32_16x16x16_bf16 v[140:143], a[118:119], v[92:93], v[140:143]
    v_mfma_f32_16x16x16_bf16 v[144:147], a[120:121], v[92:93], v[144:147]
    v_mfma_f32_16x16x16_bf16 v[148:151], a[122:123], v[92:93], v[148:151]
    v_mfma_f32_16x16x16_bf16 v[152:155], a[124:125], v[92:93], v[152:155]
    v_mfma_f32_16x16x16_bf16 v[156:159], a[126:127], v[92:93], v[156:159]
    v_mfma_f32_16x16x16_bf16 v[160:163], a[112:113], v[94:95], v[160:163]
    v_mfma_f32_16x16x16_bf16 v[164:167], a[114:115], v[94:95], v[164:167]
    v_mfma_f32_16x16x16_bf16 v[168:171], a[116:117], v[94:95], v[168:171]
    v_mfma_f32_16x16x16_bf16 v[172:175], a[118:119], v[94:95], v[172:175]
    v_mfma_f32_16x16x16_bf16 v[176:179], a[120:121], v[94:95], v[176:179]
    v_mfma_f32_16x16x16_bf16 v[180:183], a[122:123], v[94:95], v[180:183]
    v_mfma_f32_16x16x16_bf16 v[184:187], a[124:125], v[94:95], v[184:187]
    v_mfma_f32_16x16x16_bf16 v[188:191], a[126:127], v[94:95], v[188:191]
    s_nop 7
    v_cvt_pk_bf16_f32 v192, v128, v129
    v_cvt_pk_bf16_f32 v193, v130, v131
    v_cvt_pk_bf16_f32 v194, v132, v133
    v_cvt_pk_bf16_f32 v195, v134, v135
    buffer_store_dwordx4 v[192:195], v8, s[92:95], s21 offen offset:0 sc1
    v_cvt_pk_bf16_f32 v196, v136, v137
    v_cvt_pk_bf16_f32 v197, v138, v139
    v_cvt_pk_bf16_f32 v198, v140, v141
    v_cvt_pk_bf16_f32 v199, v142, v143
    buffer_store_dwordx4 v[196:199], v8, s[92:95], s21 offen offset:2048 sc1
    v_cvt_pk_bf16_f32 v200, v144, v145
    v_cvt_pk_bf16_f32 v201, v146, v147
    v_cvt_pk_bf16_f32 v202, v148, v149
    v_cvt_pk_bf16_f32 v203, v150, v151
    buffer_store_dwordx4 v[200:203], v8, s[92:95], s22 offen offset:0 sc1
    v_cvt_pk_bf16_f32 v204, v152, v153
    v_cvt_pk_bf16_f32 v205, v154, v155
    v_cvt_pk_bf16_f32 v206, v156, v157
    v_cvt_pk_bf16_f32 v207, v158, v159
    buffer_store_dwordx4 v[204:207], v8, s[92:95], s22 offen offset:2048 sc1
    v_cvt_pk_bf16_f32 v208, v160, v161
    v_cvt_pk_bf16_f32 v209, v162, v163
    v_cvt_pk_bf16_f32 v210, v164, v165
    v_cvt_pk_bf16_f32 v211, v166, v167
    buffer_store_dwordx4 v[208:211], v8, s[92:95], s21 offen offset:256 sc1
    v_cvt_pk_bf16_f32 v212, v168, v169
    v_cvt_pk_bf16_f32 v213, v170, v171
    v_cvt_pk_bf16_f32 v214, v172, v173
    v_cvt_pk_bf16_f32 v215, v174, v175
    buffer_store_dwordx4 v[212:215], v8, s[92:95], s21 offen offset:2304 sc1
    v_cvt_pk_bf16_f32 v216, v176, v177
    v_cvt_pk_bf16_f32 v217, v178, v179
    v_cvt_pk_bf16_f32 v218, v180, v181
    v_cvt_pk_bf16_f32 v219, v182, v183
    buffer_store_dwordx4 v[216:219], v8, s[92:95], s22 offen offset:256 sc1
    v_cvt_pk_bf16_f32 v220, v184, v185
    v_cvt_pk_bf16_f32 v221, v186, v187
    v_cvt_pk_bf16_f32 v222, v188, v189
    v_cvt_pk_bf16_f32 v223, v190, v191
    buffer_store_dwordx4 v[220:223], v8, s[92:95], s22 offen offset:2304 sc1
    s_waitcnt vmcnt(0)
    s_barrier
    s_cmp_lg_u32 s3, 0
    s_cbranch_scc1 Fin_233
    v_mov_b32 v4, 4
    s_mov_b64 exec, 1
    buffer_atomic_add v4, off, s[92:95], s36 sc1
    s_mov_b64 exec, -1
Fin_233:
    s_branch L_next
.section .rodata,"a"
.p2align 6
.amdhsa_kernel parallel_sum__memory_aug_recurrent_mem_tr__glu_gated_geglu__prompt_kernel
  .amdhsa_next_free_vgpr 512
  .amdhsa_next_free_sgpr 102
  .amdhsa_accum_offset 256
  .amdhsa_group_segment_fixed_size 0
  .amdhsa_kernarg_size 112
  .amdhsa_user_sgpr_count 2
  .amdhsa_user_sgpr_kernarg_segment_ptr 1
  .amdhsa_system_sgpr_workgroup_id_x 1
  .amdhsa_float_denorm_mode_32 3
  .amdhsa_float_denorm_mode_16_64 3
.end_amdhsa_kernel
```
